```python
import torch

def _softmax(x, axis=-1):
    return torch.softmax(x, dim=axis)
def _gelu(x):
    return torch.nn.functional.gelu(x, approximate="tanh")
def _silu(x):
    return torch.nn.functional.silu(x)
def _sigmoid(x):
    return torch.sigmoid(x)
def _layernorm(x, axis=-1, eps=1e-5):
    m = x.mean(dim=axis, keepdim=True)
    v = x.var(dim=axis, keepdim=True, unbiased=False)
    return (x - m) / torch.sqrt(v + eps)
def _scatter_add(tgt, idx, src, axis=0):
    return tgt.clone().index_add_(axis, idx, src)
def _segment_sum(src, seg, n):
    out = torch.zeros((n,) + src.shape[1:], dtype=src.dtype)
    return out.index_add_(0, seg, src)
def _pad(x, pw):
    flat = tuple(v for pair in reversed(pw) for v in pair)
    return torch.nn.functional.pad(x, flat)

kernel_name = 'interleave_layers__sliding_local_dilated__ssm_conv_s4d__prompt'

def setup_inputs():

    _w = (lambda a: (lambda t: t.to(torch.bfloat16) if t.is_floating_point() else t)(torch.as_tensor(a)))
    def _A_setup():
        B, S, D = 1, 2048, 640
        return {
            "x": _w((lambda *s: torch.randn(*s, dtype=torch.bfloat16) * 0.05)(B, S, D)),
            "wqkv": _w((lambda *s: torch.randn(*s, dtype=torch.bfloat16) * 0.05)(D, 3 * D)),
            "wo": _w((lambda *s: torch.randn(*s, dtype=torch.bfloat16) * 0.05)(D, D)),
        }
    _A_in = _A_setup()

    def _B_setup():
        Bsz, L, D, N = 1, 2048, 640, 192
        return {
            "u": _w((lambda *s: torch.randn(*s, dtype=torch.bfloat16) * 0.05)(Bsz, L, D)),
            "log_A_real": _w((lambda *s: torch.randn(*s, dtype=torch.bfloat16) * 3.2)(D, N) * 0.5),
            "A_imag": _w((lambda *s: torch.randn(*s, dtype=torch.bfloat16) * 0.1)(D, N) * 3.14),
            "C_real": _w((lambda *s: torch.randn(*s, dtype=torch.bfloat16) * 0.4)(D, N) / N ** 0.5),
            "C_imag": _w((lambda *s: torch.randn(*s, dtype=torch.bfloat16) * 0.4)(D, N) / N ** 0.5),
            "log_dt": _w((lambda *s: torch.randn(*s, dtype=torch.bfloat16) * 0.1)(D) * 0.5 - 4.0),
            "D_skip": _w((lambda *s: torch.randn(*s, dtype=torch.bfloat16) * 0.1)(D)),
        }
    _B_in = _B_setup()

    return {
        "A_x": _A_in["x"],
        "A_wqkv": _A_in["wqkv"],
        "A_wo": _A_in["wo"],
        "B_u": _B_in["u"],
        "B_log_A_real": _B_in["log_A_real"],
        "B_A_imag": _B_in["A_imag"],
        "B_C_real": _B_in["C_real"],
        "B_C_imag": _B_in["C_imag"],
        "B_log_dt": _B_in["log_dt"],
        "B_D_skip": _B_in["D_skip"],
    }

def reference(A_x, A_wqkv, A_wo, B_u, B_log_A_real, B_A_imag, B_C_real, B_C_imag, B_log_dt, B_D_skip):
    def _A_ref(x, wqkv, wo):
        B, S, D = x.shape
        H = 32; Dh = D // H
        W, dil = 8, 2
        qkv = (lambda x, *d: x.permute(*d))((x @ wqkv).reshape(B, S, 3, H, Dh), 2, 0, 3, 1, 4)
        q, k, v = qkv[0], qkv[1], qkv[2]
        scale = Dh ** -0.5
        pos = torch.arange(S)
        off = torch.arange(W) * dil
        idx = pos[:, None] - off[None, :]
        mask = idx >= 0
        idx_c = torch.where(mask, idx, 0).reshape(-1)
        kg = k[:, :, idx_c, :].reshape(B, H, S, W, Dh)
        vg = v[:, :, idx_c, :].reshape(B, H, S, W, Dh)
        logits = torch.einsum("bhsd,bhswd->bhsw", q, kg) * scale
        logits = torch.where(mask[None, None, :, :], logits, -1e9)
        attn = _softmax(logits, axis=-1)
        o = torch.einsum("bhsw,bhswd->bhsd", attn, vg)
        return (lambda x, *d: x.permute(*d))(o, 0, 2, 1, 3).reshape(B, S, D) @ wo

    def _B_ref(u, log_A_real, A_imag, C_real, C_imag, log_dt, D_skip):
        L = u.shape[1]
        dt = torch.exp(log_dt)
        A = -torch.exp(log_A_real) + 1j * A_imag
        C = (C_real + 1j * C_imag) * dt[:, None]
        pos = (lambda x, dt: x.to(dt))(torch.arange(L), log_dt.dtype)
        P = torch.exp((A * dt[:, None])[:, :, None] * pos[None, None, :])
        K = 2.0 * torch.einsum("dn,dnl->dl", C, P).real
        L2 = 2 * L
        u_t = (lambda x, *d: x.permute(*d))(u, 0, 2, 1)
        Kf = (lambda x, *a, **k: torch.fft.rfft(x.float(), *a, **k))(K, L2)
        Uf = (lambda x, *a, **k: torch.fft.rfft(x.float(), *a, **k))(u_t, L2)
        y = (lambda x, *a, **k: torch.fft.irfft(x, *a, **k).to(torch.bfloat16))(Uf * Kf[None, :, :], L2)[:, :, :L]
        y = (lambda x, *d: x.permute(*d))(y, 0, 2, 1)
        return y + u * D_skip[None, None, :]

    x = A_x
    x = x + _A_ref(_layernorm(x, axis=-1), A_wqkv, A_wo)
    x = x + _B_ref(_layernorm(x, axis=-1), B_log_A_real, B_A_imag, B_C_real, B_C_imag, B_log_dt, B_D_skip)
    x = x + _A_ref(_layernorm(x, axis=-1), A_wqkv, A_wo)
    x = x + _B_ref(_layernorm(x, axis=-1), B_log_A_real, B_A_imag, B_C_real, B_C_imag, B_log_dt, B_D_skip)
    return x
```

```asm
; @launch grid=(256,1,1) block=(512,1,1) lds=163840
.amdgcn_target "amdgcn-amd-amdhsa--gfx950"
.text
.globl interleave_layers__sliding_local_dilated__ssm_conv_s4d__prompt_kernel
.p2align 8
.type interleave_layers__sliding_local_dilated__ssm_conv_s4d__prompt_kernel,@function
interleave_layers__sliding_local_dilated__ssm_conv_s4d__prompt_kernel:
    s_cmp_ge_u32 s2, 256
    s_cbranch_scc1 L_end
    s_load_dwordx16 s[8:23], s[0:1], 0
    s_load_dwordx8 s[24:31], s[0:1], 64
    s_load_dwordx2 s[32:33], s[0:1], 96
    v_lshrrev_b32 v2, 6, v0
    v_and_b32 v1, 63, v0
    v_readfirstlane_b32 s3, v2
    s_and_b32 s42, s2, 7
    s_lshr_b32 s43, s2, 3
    s_and_b32 s6, s43, 3
    s_lshr_b32 s5, s42, 1
    s_lshl_b32 s5, s5, 3
    s_and_b32 s4, s43, 7
    s_add_u32 s5, s5, s4
    s_and_b32 s4, s42, 1
    s_lshl_b32 s4, s4, 2
    s_lshr_b32 s44, s43, 3
    s_add_u32 s4, s4, s44
    s_and_b32 s36, s43, 1
    s_lshr_b32 s43, s43, 1
    s_lshl_b32 s42, s42, 4
    s_add_u32 s42, s42, s43
    s_mul_i32 s42, s42, 5
    s_mul_i32 s43, s36, 3
    s_add_u32 s37, s42, s43
    s_add_u32 s38, s37, 1
    s_add_u32 s39, s42, 2
    s_mov_b32 s7, 0
    s_mov_b32 s40, 0
    s_mov_b32 s41, 0
    s_mul_i32 s42, s3, 11
    s_lshr_b32 s42, s42, 5
    s_mul_i32 s43, s42, 3
    s_sub_u32 s43, s3, s43
    s_cmp_eq_u32 s42, 1
    s_cselect_b32 s44, s38, s37
    s_cmp_eq_u32 s42, 2
    s_cselect_b32 s44, s39, s44
    v_mov_b32 v16, 0
    v_mov_b32 v17, 0
    v_mov_b32 v18, 0
    v_mov_b32 v19, 0
    s_mul_i32 s54, s44, 384
    s_lshl_b32 s55, s43, 7
    s_add_u32 s54, s54, s55
    v_lshl_add_u32 v2, v1, 1, s54
    s_lshl_b32 s55, s44, 1
    v_mov_b32 v3, s55
    s_cmp_ge_u32 s3, 3
    s_cbranch_scc1 L_st_x
    s_min_u32 s45, s2, 239
    s_mul_i32 s45, s45, 6
    s_lshl_b32 s46, s3, 1
    s_add_u32 s45, s45, s46
    v_and_b32 v4, 15, v1
    v_lshrrev_b32 v5, 4, v1
    v_mul_u32_u24 v5, 30720, v5
    v_mov_b32 v246, 0
    v_mov_b32 v247, 0
    v_mov_b32 v248, 0
    v_mov_b32 v249, 0
    s_add_u32 s49, s45, 0
    s_mul_i32 s46, s49, 46604
    s_lshr_b32 s46, s46, 23
    s_mul_i32 s47, s46, 180
    s_sub_u32 s47, s49, s47
    s_mul_i32 s48, s47, 57
    s_lshr_b32 s48, s48, 9
    s_mul_i32 s49, s48, 9
    s_sub_u32 s49, s47, s49
    s_mov_b32 s54, 2499870976
    s_mov_b32 s55, 1420116314
    s_mul_i32 s47, s49, 7
    s_lshr_b64 s[54:55], s[54:55], s47
    s_and_b32 s47, s54, 127
    s_lshl_b32 s47, s47, 5
    s_mul_i32 s54, s46, 160
    s_add_u32 s47, s47, s54
    s_mul_i32 s54, s48, 122880
    s_add_u32 s50, s47, s54
    s_lshr_b32 s52, 0x10c, s49
    s_and_b32 s52, s52, 1
    s_cselect_b32 s47, 1, 2
    s_cselect_b32 s54, 14, 15
    v_and_b32 v24, s54, v4
    v_lshlrev_b32 v24, s47, v24
    v_add_u32 v24, v24, v5
    v_add_u32 v25, 7680, v24
    v_add_u32 v26, 15360, v24
    v_add_u32 v27, 23040, v24
    s_mov_b32 s54, 3397678624
    s_mov_b32 s55, 14
    s_lshl_b32 s47, s49, 2
    s_lshr_b64 s[54:55], s[54:55], s47
    s_and_b32 s47, s54, 15
    s_mul_i32 s54, s46, 15
    s_add_u32 s47, s47, s54
    s_mul_i32 s47, s47, 20
    s_add_u32 s47, s47, s48
    s_lshl_b32 s47, s47, 10
    s_add_u32 s47, s47, 1048576
    v_lshl_add_u32 v10, v1, 4, s47
    v_add_u32 v11, 20480, v10
    v_and_b32 v14, s52, v1
    v_mul_u32_u24 v14, 0x020202, v14
    v_lshl_or_b32 v14, v14, 8, v14
    v_add_u32 v14, 0x05040100, v14
    s_add_u32 s49, s45, 1
    s_mul_i32 s46, s49, 46604
    s_lshr_b32 s46, s46, 23
    s_mul_i32 s47, s46, 180
    s_sub_u32 s47, s49, s47
    s_mul_i32 s48, s47, 57
    s_lshr_b32 s48, s48, 9
    s_mul_i32 s49, s48, 9
    s_sub_u32 s49, s47, s49
    s_mov_b32 s54, 2499870976
    s_mov_b32 s55, 1420116314
    s_mul_i32 s47, s49, 7
    s_lshr_b64 s[54:55], s[54:55], s47
    s_and_b32 s47, s54, 127
    s_lshl_b32 s47, s47, 5
    s_mul_i32 s54, s46, 160
    s_add_u32 s47, s47, s54
    s_mul_i32 s54, s48, 122880
    s_add_u32 s51, s47, s54
    s_lshr_b32 s53, 0x10c, s49
    s_and_b32 s53, s53, 1
    s_cselect_b32 s47, 1, 2
    s_cselect_b32 s54, 14, 15
    v_and_b32 v28, s54, v4
    v_lshlrev_b32 v28, s47, v28
    v_add_u32 v28, v28, v5
    v_add_u32 v29, 7680, v28
    v_add_u32 v30, 15360, v28
    v_add_u32 v31, 23040, v28
    s_mov_b32 s54, 3397678624
    s_mov_b32 s55, 14
    s_lshl_b32 s47, s49, 2
    s_lshr_b64 s[54:55], s[54:55], s47
    s_and_b32 s47, s54, 15
    s_mul_i32 s54, s46, 15
    s_add_u32 s47, s47, s54
    s_mul_i32 s47, s47, 20
    s_add_u32 s47, s47, s48
    s_lshl_b32 s47, s47, 10
    s_add_u32 s47, s47, 1048576
    v_lshl_add_u32 v12, v1, 4, s47
    v_add_u32 v13, 20480, v12
    v_and_b32 v15, s53, v1
    v_mul_u32_u24 v15, 0x020202, v15
    v_lshl_or_b32 v15, v15, 8, v15
    v_add_u32 v15, 0x05040100, v15
    s_lshl_b32 s46, s5, 3
    s_add_u32 s46, s46, s4
    s_lshl_b32 s46, s46, 10
    s_add_u32 s46, s46, 262144
    v_lshl_add_u32 v6, v1, 4, s46
    v_add_u32 v7, 262144, v6
    v_and_b32 v8, 3, v1
    v_lshlrev_b32 v8, 4, v8
    v_add_u32 v8, 45312, v8
    v_mov_b32 v9, 46976
    ds_write_b128 v8, v[16:19]
    ds_write_b128 v9, v[16:19]
    s_waitcnt lgkmcnt(0)
    s_cmp_ge_u32 s2, 240
    s_cbranch_scc1 L_st_nopack
    s_add_u32 s54, s10, s50
    s_addc_u32 s55, s11, 0
    global_load_dword v192, v24, s[54:55] offset:0
    global_load_dword v193, v24, s[54:55] offset:3840
    global_load_dword v194, v25, s[54:55] offset:0
    global_load_dword v195, v25, s[54:55] offset:3840
    global_load_dword v196, v26, s[54:55] offset:0
    global_load_dword v197, v26, s[54:55] offset:3840
    global_load_dword v198, v27, s[54:55] offset:0
    global_load_dword v199, v27, s[54:55] offset:3840
    s_add_u32 s54, s10, s51
    s_addc_u32 s55, s11, 0
    global_load_dword v208, v28, s[54:55] offset:0
    global_load_dword v209, v28, s[54:55] offset:3840
    global_load_dword v210, v29, s[54:55] offset:0
    global_load_dword v211, v29, s[54:55] offset:3840
    global_load_dword v212, v30, s[54:55] offset:0
    global_load_dword v213, v30, s[54:55] offset:3840
    global_load_dword v214, v31, s[54:55] offset:0
    global_load_dword v215, v31, s[54:55] offset:3840
L_st_nopack:
    global_load_ushort v240, v2, s[16:17]
    global_load_ushort v244, v3, s[24:25]
    global_load_ushort v241, v2, s[18:19]
    global_load_ushort v242, v2, s[20:21]
    global_load_ushort v243, v2, s[22:23]
    global_load_dwordx2 v[20:21], v16, s[32:33] sc1
    s_cmp_eq_u32 s3, 2
    s_cbranch_scc0 L_st_b0
    global_store_dwordx4 v6, v[16:19], s[32:33] sc1
    global_store_dwordx4 v7, v[16:19], s[32:33] sc1
    s_cmp_eq_u32 s2, 255
    s_cbranch_scc0 L_st_b0
    v_and_b32 v6, 1, v1
    v_lshlrev_b32 v6, 4, v6
    v_add_u32 v6, 19922912, v6
    s_mov_b64 exec, 3
    global_store_dwordx4 v6, v[16:19], s[32:33] sc1
    s_mov_b64 exec, -1
L_st_b0:
    s_barrier
    s_waitcnt vmcnt(0)
    s_cmp_ge_u32 s2, 240
    s_cbranch_scc1 L_st_unit
    s_mov_b32 s50, 0x07060302
    v_perm_b32 v200, v193, v192, v14
    v_perm_b32 v201, v195, v194, v14
    v_perm_b32 v202, v197, v196, v14
    v_perm_b32 v203, v199, v198, v14
    global_store_dwordx4 v10, v[200:203], s[32:33] sc1
    v_perm_b32 v216, v209, v208, v15
    v_perm_b32 v217, v211, v210, v15
    v_perm_b32 v218, v213, v212, v15
    v_perm_b32 v219, v215, v214, v15
    global_store_dwordx4 v12, v[216:219], s[32:33] sc1
    s_cmp_eq_u32 s52, 1
    s_cbranch_scc1 L_st_sg0
    v_perm_b32 v204, v193, v192, s50
    v_perm_b32 v205, v195, v194, s50
    v_perm_b32 v206, v197, v196, s50
    v_perm_b32 v207, v199, v198, s50
    global_store_dwordx4 v11, v[204:207], s[32:33] sc1
L_st_sg0:
    s_cmp_eq_u32 s53, 1
    s_cbranch_scc1 L_st_sg1
    v_perm_b32 v220, v209, v208, s50
    v_perm_b32 v221, v211, v210, s50
    v_perm_b32 v222, v213, v212, s50
    v_perm_b32 v223, v215, v214, s50
    global_store_dwordx4 v13, v[220:223], s[32:33] sc1
L_st_sg1:
    s_nop 0
    s_branch L_st_unit
L_st_x:
    s_lshl_b32 s46, s3, 6
    v_add_u32 v6, s46, v1
    v_subrev_u32 v6, 192, v6
    v_mul_u32_u24 v7, 205, v6
    v_lshrrev_b32 v7, 14, v7
    v_mul_u32_u24 v8, 80, v7
    v_sub_u32 v8, v6, v8
    v_xor_b32 v8, v8, v7
    v_lshlrev_b32 v8, 4, v8
    v_mul_u32_u24 v7, 1280, v7
    v_add_u32 v7, v7, v8
    s_lshl_b32 s46, s6, 6
    v_xor_b32 v246, s46, v7
    v_xor_b32 v247, 64, v246
    v_xor_b32 v248, 128, v246
    v_xor_b32 v249, 192, v246
    s_waitcnt lgkmcnt(0)
    global_load_ushort v240, v2, s[16:17]
    global_load_ushort v244, v3, s[24:25]
    global_load_ushort v241, v2, s[18:19]
    global_load_ushort v242, v2, s[20:21]
    global_load_ushort v243, v2, s[22:23]
    global_load_dwordx2 v[20:21], v16, s[32:33] sc1
    s_barrier
    s_sub_u32 s48, s3, 3
    s_lshl_b32 s48, s48, 10
    s_mul_i32 s49, s5, 81920
    s_max_u32 s47, s49, 20480
    s_and_b32 s52, s4, 3
    s_cmp_eq_u32 s52, 1
    s_cbranch_scc1 L_xd1_1
    s_cmp_eq_u32 s52, 2
    s_cbranch_scc1 L_xd1_2
    s_cmp_eq_u32 s52, 3
    s_cbranch_scc1 L_xd1_3
    s_add_u32 m0, s48, 61440
    s_add_u32 s52, s47, -20480
    s_add_u32 s50, s8, s52
    s_addc_u32 s51, s9, 0
    global_load_lds_dwordx4 v246, s[50:51]
    s_add_u32 m0, s48, 66560
    s_add_u32 s50, s50, 5120
    s_addc_u32 s51, s51, 0
    global_load_lds_dwordx4 v247, s[50:51]
    s_add_u32 m0, s48, 71680
    s_add_u32 s50, s50, 5120
    s_addc_u32 s51, s51, 0
    global_load_lds_dwordx4 v248, s[50:51]
    s_add_u32 m0, s48, 76800
    s_add_u32 s50, s50, 5120
    s_addc_u32 s51, s51, 0
    global_load_lds_dwordx4 v249, s[50:51]
    s_add_u32 m0, s48, 81920
    s_add_u32 s52, s49, 0
    s_add_u32 s50, s8, s52
    s_addc_u32 s51, s9, 0
    global_load_lds_dwordx4 v246, s[50:51]
    s_branch L_xd1
L_xd1_1:
    s_add_u32 m0, s48, 87040
    s_add_u32 s52, s49, 5120
    s_add_u32 s50, s8, s52
    s_addc_u32 s51, s9, 0
    global_load_lds_dwordx4 v247, s[50:51]
    s_add_u32 m0, s48, 92160
    s_add_u32 s50, s50, 5120
    s_addc_u32 s51, s51, 0
    global_load_lds_dwordx4 v248, s[50:51]
    s_add_u32 m0, s48, 97280
    s_add_u32 s50, s50, 5120
    s_addc_u32 s51, s51, 0
    global_load_lds_dwordx4 v249, s[50:51]
    s_add_u32 m0, s48, 102400
    s_add_u32 s50, s50, 5120
    s_addc_u32 s51, s51, 0
    global_load_lds_dwordx4 v246, s[50:51]
    s_add_u32 m0, s48, 107520
    s_add_u32 s50, s50, 5120
    s_addc_u32 s51, s51, 0
    global_load_lds_dwordx4 v247, s[50:51]
    s_branch L_xd1
L_xd1_2:
    s_add_u32 m0, s48, 112640
    s_add_u32 s52, s49, 30720
    s_add_u32 s50, s8, s52
    s_addc_u32 s51, s9, 0
    global_load_lds_dwordx4 v248, s[50:51]
    s_add_u32 m0, s48, 117760
    s_add_u32 s50, s50, 5120
    s_addc_u32 s51, s51, 0
    global_load_lds_dwordx4 v249, s[50:51]
    s_add_u32 m0, s48, 122880
    s_add_u32 s50, s50, 5120
    s_addc_u32 s51, s51, 0
    global_load_lds_dwordx4 v246, s[50:51]
    s_add_u32 m0, s48, 128000
    s_add_u32 s50, s50, 5120
    s_addc_u32 s51, s51, 0
    global_load_lds_dwordx4 v247, s[50:51]
    s_add_u32 m0, s48, 133120
    s_add_u32 s50, s50, 5120
    s_addc_u32 s51, s51, 0
    global_load_lds_dwordx4 v248, s[50:51]
    s_branch L_xd1
L_xd1_3:
    s_add_u32 m0, s48, 138240
    s_add_u32 s52, s49, 56320
    s_add_u32 s50, s8, s52
    s_addc_u32 s51, s9, 0
    global_load_lds_dwordx4 v249, s[50:51]
    s_add_u32 m0, s48, 143360
    s_add_u32 s50, s50, 5120
    s_addc_u32 s51, s51, 0
    global_load_lds_dwordx4 v246, s[50:51]
    s_add_u32 m0, s48, 148480
    s_add_u32 s50, s50, 5120
    s_addc_u32 s51, s51, 0
    global_load_lds_dwordx4 v247, s[50:51]
    s_add_u32 m0, s48, 153600
    s_add_u32 s50, s50, 5120
    s_addc_u32 s51, s51, 0
    global_load_lds_dwordx4 v248, s[50:51]
    s_add_u32 m0, s48, 158720
    s_add_u32 s50, s50, 5120
    s_addc_u32 s51, s51, 0
    global_load_lds_dwordx4 v249, s[50:51]
L_xd1:
    s_waitcnt vmcnt(5)
L_st_unit:
    v_readfirstlane_b32 s34, v20
    v_readfirstlane_b32 s35, v21
    s_nop 0
    s_add_u32 s34, s34, 1
    s_addc_u32 s35, s35, 0
    s_mul_i32 s46, s3, 4608
    s_add_u32 s46, s46, 0
    v_lshlrev_b32 v52, 16, v240
    v_lshlrev_b32 v56, 16, v244
    v_mul_f32 v52, 1069066811, v52
    v_mul_f32 v56, 1069066811, v56
    v_exp_f32 v52, v52
    v_exp_f32 v56, v56
    v_lshlrev_b32 v53, 16, v241
    v_lshlrev_b32 v54, 16, v242
    v_lshlrev_b32 v55, 16, v243
    v_cvt_pk_bf16_f32 v52, v52, v56
    v_and_b32 v3, 15, v1
    v_mul_u32_u24 v3, 288, v3
    v_and_b32 v2, 0x30, v1
    v_add3_u32 v3, v3, v2, s46
    s_mov_b32 m0, s46
    v_and_b32 v56, 0xffff0000, v52
    v_lshlrev_b32 v52, 16, v52
    v_mul_f32 v52, v52, v56
    v_mul_f32 v53, v53, v56
    v_mul_f32 v84, v54, v56
    v_mul_f32 v85, v55, v56
    v_mul_f32 v52, 3216550459, v52
    v_mul_f32 v53, 1042479491, v53
    v_mul_f32 v84, 0x44000000, v84
    v_mul_f32 v85, 0x44000000, v85
    v_mul_f32 v54, 1065353216, v52
    v_mul_f32 v60, 1065353216, v53
    v_mul_f32 v55, 1090519040, v52
    v_mul_f32 v61, 1090519040, v53
    v_mul_f32 v56, 1124073472, v52
    v_mul_f32 v62, 1124073472, v53
    v_mul_f32 v57, 1132462080, v52
    v_mul_f32 v63, 1132462080, v53
    v_mul_f32 v58, 1140850688, v52
    v_mul_f32 v64, 1140850688, v53
    v_mul_f32 v59, 1149239296, v52
    v_mul_f32 v65, 1149239296, v53
    v_exp_f32 v54, v54
    v_fract_f32 v60, v60
    v_exp_f32 v55, v55
    v_fract_f32 v61, v61
    v_exp_f32 v56, v56
    v_fract_f32 v62, v62
    v_exp_f32 v57, v57
    v_fract_f32 v63, v63
    v_exp_f32 v58, v58
    v_fract_f32 v64, v64
    v_exp_f32 v59, v59
    v_fract_f32 v65, v65
    v_cos_f32 v4, v60
    v_sin_f32 v5, v60
    v_cos_f32 v6, v61
    v_sin_f32 v7, v61
    v_cos_f32 v8, v62
    v_sin_f32 v9, v62
    v_cos_f32 v10, v63
    v_sin_f32 v11, v63
    v_cos_f32 v12, v64
    v_sin_f32 v13, v64
    v_cos_f32 v14, v65
    v_sin_f32 v15, v65
    v_mul_f32 v4, v4, v54
    v_mul_f32 v5, v5, v54
    v_mul_f32 v6, v6, v55
    v_mul_f32 v7, v7, v55
    v_mul_f32 v8, v8, v56
    v_mul_f32 v9, v9, v56
    v_mul_f32 v10, v10, v57
    v_mul_f32 v11, v11, v57
    v_mul_f32 v12, v12, v58
    v_mul_f32 v13, v13, v58
    v_mul_f32 v14, v14, v59
    v_mul_f32 v15, v15, v59
    s_cmp_lt_u32 s3, 3
    s_cbranch_scc1 L_xs2
    s_sub_u32 s48, s3, 3
    s_lshl_b32 s48, s48, 10
    s_mul_i32 s49, s5, 81920
    s_max_u32 s47, s49, 20480
    s_and_b32 s52, s4, 3
    s_cmp_eq_u32 s52, 1
    s_cbranch_scc1 L_xd3_1
    s_cmp_eq_u32 s52, 2
    s_cbranch_scc1 L_xd3_2
    s_cmp_eq_u32 s52, 3
    s_cbranch_scc1 L_xd3_3
    s_add_u32 m0, s48, 87040
    s_add_u32 s52, s49, 5120
    s_add_u32 s50, s8, s52
    s_addc_u32 s51, s9, 0
    global_load_lds_dwordx4 v247, s[50:51]
    s_add_u32 m0, s48, 92160
    s_add_u32 s50, s50, 5120
    s_addc_u32 s51, s51, 0
    global_load_lds_dwordx4 v248, s[50:51]
    s_add_u32 m0, s48, 97280
    s_add_u32 s50, s50, 5120
    s_addc_u32 s51, s51, 0
    global_load_lds_dwordx4 v249, s[50:51]
    s_add_u32 m0, s48, 102400
    s_add_u32 s50, s50, 5120
    s_addc_u32 s51, s51, 0
    global_load_lds_dwordx4 v246, s[50:51]
    s_add_u32 m0, s48, 107520
    s_add_u32 s50, s50, 5120
    s_addc_u32 s51, s51, 0
    global_load_lds_dwordx4 v247, s[50:51]
    s_add_u32 m0, s48, 112640
    s_add_u32 s50, s50, 5120
    s_addc_u32 s51, s51, 0
    global_load_lds_dwordx4 v248, s[50:51]
    s_add_u32 m0, s48, 117760
    s_add_u32 s50, s50, 5120
    s_addc_u32 s51, s51, 0
    global_load_lds_dwordx4 v249, s[50:51]
    s_branch L_xd3
L_xd3_1:
    s_add_u32 m0, s48, 112640
    s_add_u32 s52, s49, 30720
    s_add_u32 s50, s8, s52
    s_addc_u32 s51, s9, 0
    global_load_lds_dwordx4 v248, s[50:51]
    s_add_u32 m0, s48, 117760
    s_add_u32 s50, s50, 5120
    s_addc_u32 s51, s51, 0
    global_load_lds_dwordx4 v249, s[50:51]
    s_add_u32 m0, s48, 122880
    s_add_u32 s50, s50, 5120
    s_addc_u32 s51, s51, 0
    global_load_lds_dwordx4 v246, s[50:51]
    s_add_u32 m0, s48, 128000
    s_add_u32 s50, s50, 5120
    s_addc_u32 s51, s51, 0
    global_load_lds_dwordx4 v247, s[50:51]
    s_add_u32 m0, s48, 133120
    s_add_u32 s50, s50, 5120
    s_addc_u32 s51, s51, 0
    global_load_lds_dwordx4 v248, s[50:51]
    s_add_u32 m0, s48, 138240
    s_add_u32 s50, s50, 5120
    s_addc_u32 s51, s51, 0
    global_load_lds_dwordx4 v249, s[50:51]
    s_add_u32 m0, s48, 143360
    s_add_u32 s50, s50, 5120
    s_addc_u32 s51, s51, 0
    global_load_lds_dwordx4 v246, s[50:51]
    s_branch L_xd3
L_xd3_2:
    s_add_u32 m0, s48, 138240
    s_add_u32 s52, s49, 56320
    s_add_u32 s50, s8, s52
    s_addc_u32 s51, s9, 0
    global_load_lds_dwordx4 v249, s[50:51]
    s_add_u32 m0, s48, 143360
    s_add_u32 s50, s50, 5120
    s_addc_u32 s51, s51, 0
    global_load_lds_dwordx4 v246, s[50:51]
    s_add_u32 m0, s48, 148480
    s_add_u32 s50, s50, 5120
    s_addc_u32 s51, s51, 0
    global_load_lds_dwordx4 v247, s[50:51]
    s_add_u32 m0, s48, 153600
    s_add_u32 s50, s50, 5120
    s_addc_u32 s51, s51, 0
    global_load_lds_dwordx4 v248, s[50:51]
    s_add_u32 m0, s48, 158720
    s_add_u32 s50, s50, 5120
    s_addc_u32 s51, s51, 0
    global_load_lds_dwordx4 v249, s[50:51]
    s_add_u32 m0, s48, 61440
    s_add_u32 s52, s47, -20480
    s_add_u32 s50, s8, s52
    s_addc_u32 s51, s9, 0
    global_load_lds_dwordx4 v246, s[50:51]
    s_add_u32 m0, s48, 66560
    s_add_u32 s50, s50, 5120
    s_addc_u32 s51, s51, 0
    global_load_lds_dwordx4 v247, s[50:51]
    s_branch L_xd3
L_xd3_3:
    s_add_u32 m0, s48, 61440
    s_add_u32 s52, s47, -20480
    s_add_u32 s50, s8, s52
    s_addc_u32 s51, s9, 0
    global_load_lds_dwordx4 v246, s[50:51]
    s_add_u32 m0, s48, 66560
    s_add_u32 s50, s50, 5120
    s_addc_u32 s51, s51, 0
    global_load_lds_dwordx4 v247, s[50:51]
    s_add_u32 m0, s48, 71680
    s_add_u32 s50, s50, 5120
    s_addc_u32 s51, s51, 0
    global_load_lds_dwordx4 v248, s[50:51]
    s_add_u32 m0, s48, 76800
    s_add_u32 s50, s50, 5120
    s_addc_u32 s51, s51, 0
    global_load_lds_dwordx4 v249, s[50:51]
    s_add_u32 m0, s48, 81920
    s_add_u32 s52, s49, 0
    s_add_u32 s50, s8, s52
    s_addc_u32 s51, s9, 0
    global_load_lds_dwordx4 v246, s[50:51]
    s_add_u32 m0, s48, 87040
    s_add_u32 s50, s50, 5120
    s_addc_u32 s51, s51, 0
    global_load_lds_dwordx4 v247, s[50:51]
    s_add_u32 m0, s48, 92160
    s_add_u32 s50, s50, 5120
    s_addc_u32 s51, s51, 0
    global_load_lds_dwordx4 v248, s[50:51]
L_xd3:
L_xs2:
    s_mov_b32 m0, s46
    v_mov_b32 v16, 1.0
    v_mov_b32 v17, 0
    v_mov_b32 v18, v6
    v_mov_b32 v19, v7
    v_pk_mul_f32 v[20:21], v[6:7], v[6:7] op_sel:[0,0] op_sel_hi:[1,0]
    v_pk_mul_f32 v[48:49], v[4:5], v[4:5] op_sel:[0,0] op_sel_hi:[1,0]
    v_pk_fma_f32 v[20:21], v[6:7], v[6:7], v[20:21] op_sel:[1,1,0] op_sel_hi:[0,1,1] neg_lo:[1,0,0]
    v_pk_fma_f32 v[48:49], v[4:5], v[4:5], v[48:49] op_sel:[1,1,0] op_sel_hi:[0,1,1] neg_lo:[1,0,0]
    v_pk_mul_f32 v[22:23], v[20:21], v[6:7] op_sel:[0,0] op_sel_hi:[1,0]
    v_pk_mul_f32 v[24:25], v[20:21], v[20:21] op_sel:[0,0] op_sel_hi:[1,0]
    v_pk_mul_f32 v[50:51], v[48:49], v[48:49] op_sel:[0,0] op_sel_hi:[1,0]
    v_pk_fma_f32 v[22:23], v[20:21], v[6:7], v[22:23] op_sel:[1,1,0] op_sel_hi:[0,1,1] neg_lo:[1,0,0]
    v_pk_fma_f32 v[24:25], v[20:21], v[20:21], v[24:25] op_sel:[1,1,0] op_sel_hi:[0,1,1] neg_lo:[1,0,0]
    v_pk_fma_f32 v[50:51], v[48:49], v[48:49], v[50:51] op_sel:[1,1,0] op_sel_hi:[0,1,1] neg_lo:[1,0,0]
    v_pk_mul_f32 v[26:27], v[18:19], v[24:25] op_sel:[0,0] op_sel_hi:[1,0]
    v_pk_mul_f32 v[28:29], v[20:21], v[24:25] op_sel:[0,0] op_sel_hi:[1,0]
    v_pk_mul_f32 v[30:31], v[22:23], v[24:25] op_sel:[0,0] op_sel_hi:[1,0]
    v_pk_mul_f32 v[32:33], v[24:25], v[24:25] op_sel:[0,0] op_sel_hi:[1,0]
    v_pk_fma_f32 v[26:27], v[18:19], v[24:25], v[26:27] op_sel:[1,1,0] op_sel_hi:[0,1,1] neg_lo:[1,0,0]
    v_pk_fma_f32 v[28:29], v[20:21], v[24:25], v[28:29] op_sel:[1,1,0] op_sel_hi:[0,1,1] neg_lo:[1,0,0]
    v_pk_fma_f32 v[30:31], v[22:23], v[24:25], v[30:31] op_sel:[1,1,0] op_sel_hi:[0,1,1] neg_lo:[1,0,0]
    v_pk_fma_f32 v[32:33], v[24:25], v[24:25], v[32:33] op_sel:[1,1,0] op_sel_hi:[0,1,1] neg_lo:[1,0,0]
    v_pk_mul_f32 v[34:35], v[26:27], v[24:25] op_sel:[0,0] op_sel_hi:[1,0]
    v_pk_mul_f32 v[36:37], v[28:29], v[24:25] op_sel:[0,0] op_sel_hi:[1,0]
    v_pk_mul_f32 v[38:39], v[30:31], v[24:25] op_sel:[0,0] op_sel_hi:[1,0]
    v_pk_mul_f32 v[40:41], v[32:33], v[24:25] op_sel:[0,0] op_sel_hi:[1,0]
    v_pk_fma_f32 v[34:35], v[26:27], v[24:25], v[34:35] op_sel:[1,1,0] op_sel_hi:[0,1,1] neg_lo:[1,0,0]
    v_pk_fma_f32 v[36:37], v[28:29], v[24:25], v[36:37] op_sel:[1,1,0] op_sel_hi:[0,1,1] neg_lo:[1,0,0]
    v_pk_fma_f32 v[38:39], v[30:31], v[24:25], v[38:39] op_sel:[1,1,0] op_sel_hi:[0,1,1] neg_lo:[1,0,0]
    v_pk_fma_f32 v[40:41], v[32:33], v[24:25], v[40:41] op_sel:[1,1,0] op_sel_hi:[0,1,1] neg_lo:[1,0,0]
    v_pk_mul_f32 v[42:43], v[34:35], v[24:25] op_sel:[0,0] op_sel_hi:[1,0]
    v_pk_mul_f32 v[44:45], v[36:37], v[24:25] op_sel:[0,0] op_sel_hi:[1,0]
    v_pk_mul_f32 v[46:47], v[38:39], v[24:25] op_sel:[0,0] op_sel_hi:[1,0]
    v_pk_fma_f32 v[42:43], v[34:35], v[24:25], v[42:43] op_sel:[1,1,0] op_sel_hi:[0,1,1] neg_lo:[1,0,0]
    v_pk_fma_f32 v[44:45], v[36:37], v[24:25], v[44:45] op_sel:[1,1,0] op_sel_hi:[0,1,1] neg_lo:[1,0,0]
    v_pk_fma_f32 v[46:47], v[38:39], v[24:25], v[46:47] op_sel:[1,1,0] op_sel_hi:[0,1,1] neg_lo:[1,0,0]
    v_cvt_pk_f16_f32 v52, v16, -v17
    v_cvt_pk_f16_f32 v53, v18, -v19
    v_cvt_pk_f16_f32 v54, v20, -v21
    v_cvt_pk_f16_f32 v55, v22, -v23
    v_cvt_pk_f16_f32 v56, v24, -v25
    v_cvt_pk_f16_f32 v57, v26, -v27
    v_cvt_pk_f16_f32 v58, v28, -v29
    v_cvt_pk_f16_f32 v59, v30, -v31
    v_cvt_pk_f16_f32 v60, v32, -v33
    v_cvt_pk_f16_f32 v61, v34, -v35
    v_cvt_pk_f16_f32 v62, v36, -v37
    v_cvt_pk_f16_f32 v63, v38, -v39
    v_cvt_pk_f16_f32 v64, v40, -v41
    v_cvt_pk_f16_f32 v65, v42, -v43
    v_cvt_pk_f16_f32 v66, v44, -v45
    v_cvt_pk_f16_f32 v67, v46, -v47
    ds_write_addtid_b32 v52 offset:0
    ds_write_addtid_b32 v53 offset:288
    ds_write_addtid_b32 v54 offset:576
    ds_write_addtid_b32 v55 offset:864
    ds_write_addtid_b32 v56 offset:1152
    ds_write_addtid_b32 v57 offset:1440
    ds_write_addtid_b32 v58 offset:1728
    ds_write_addtid_b32 v59 offset:2016
    ds_write_addtid_b32 v60 offset:2304
    ds_write_addtid_b32 v61 offset:2592
    ds_write_addtid_b32 v62 offset:2880
    ds_write_addtid_b32 v63 offset:3168
    ds_write_addtid_b32 v64 offset:3456
    ds_write_addtid_b32 v65 offset:3744
    ds_write_addtid_b32 v66 offset:4032
    ds_write_addtid_b32 v67 offset:4320
    v_mov_b32 v16, v84
    v_mov_b32 v17, v85
    v_pk_mul_f32 v[18:19], v[16:17], v[4:5] op_sel:[0,0] op_sel_hi:[1,0]
    v_pk_mul_f32 v[20:21], v[16:17], v[48:49] op_sel:[0,0] op_sel_hi:[1,0]
    v_pk_mul_f32 v[24:25], v[16:17], v[50:51] op_sel:[0,0] op_sel_hi:[1,0]
    v_pk_mul_f32 v[32:33], v[16:17], v[8:9] op_sel:[0,0] op_sel_hi:[1,0]
    v_pk_fma_f32 v[18:19], v[16:17], v[4:5], v[18:19] op_sel:[1,1,0] op_sel_hi:[0,1,1] neg_lo:[1,0,0]
    v_pk_fma_f32 v[20:21], v[16:17], v[48:49], v[20:21] op_sel:[1,1,0] op_sel_hi:[0,1,1] neg_lo:[1,0,0]
    v_pk_fma_f32 v[24:25], v[16:17], v[50:51], v[24:25] op_sel:[1,1,0] op_sel_hi:[0,1,1] neg_lo:[1,0,0]
    v_pk_fma_f32 v[32:33], v[16:17], v[8:9], v[32:33] op_sel:[1,1,0] op_sel_hi:[0,1,1] neg_lo:[1,0,0]
    s_waitcnt lgkmcnt(0)
    ds_read_b128 v[68:71], v3 offset:0
    ds_read_b128 v[72:75], v3 offset:64
    ds_read_b128 v[76:79], v3 offset:128
    ds_read_b128 v[80:83], v3 offset:192
    v_pk_mul_f32 v[22:23], v[18:19], v[48:49] op_sel:[0,0] op_sel_hi:[1,0]
    v_pk_mul_f32 v[26:27], v[18:19], v[50:51] op_sel:[0,0] op_sel_hi:[1,0]
    v_pk_mul_f32 v[28:29], v[20:21], v[50:51] op_sel:[0,0] op_sel_hi:[1,0]
    v_pk_mul_f32 v[34:35], v[18:19], v[8:9] op_sel:[0,0] op_sel_hi:[1,0]
    v_pk_mul_f32 v[36:37], v[20:21], v[8:9] op_sel:[0,0] op_sel_hi:[1,0]
    v_pk_mul_f32 v[40:41], v[24:25], v[8:9] op_sel:[0,0] op_sel_hi:[1,0]
    v_pk_fma_f32 v[22:23], v[18:19], v[48:49], v[22:23] op_sel:[1,1,0] op_sel_hi:[0,1,1] neg_lo:[1,0,0]
    v_pk_fma_f32 v[26:27], v[18:19], v[50:51], v[26:27] op_sel:[1,1,0] op_sel_hi:[0,1,1] neg_lo:[1,0,0]
    v_pk_fma_f32 v[28:29], v[20:21], v[50:51], v[28:29] op_sel:[1,1,0] op_sel_hi:[0,1,1] neg_lo:[1,0,0]
    v_pk_fma_f32 v[34:35], v[18:19], v[8:9], v[34:35] op_sel:[1,1,0] op_sel_hi:[0,1,1] neg_lo:[1,0,0]
    v_pk_fma_f32 v[36:37], v[20:21], v[8:9], v[36:37] op_sel:[1,1,0] op_sel_hi:[0,1,1] neg_lo:[1,0,0]
    v_pk_fma_f32 v[40:41], v[24:25], v[8:9], v[40:41] op_sel:[1,1,0] op_sel_hi:[0,1,1] neg_lo:[1,0,0]
    v_pk_mul_f32 v[30:31], v[22:23], v[50:51] op_sel:[0,0] op_sel_hi:[1,0]
    v_pk_mul_f32 v[38:39], v[22:23], v[8:9] op_sel:[0,0] op_sel_hi:[1,0]
    v_pk_mul_f32 v[42:43], v[26:27], v[8:9] op_sel:[0,0] op_sel_hi:[1,0]
    v_pk_mul_f32 v[44:45], v[28:29], v[8:9] op_sel:[0,0] op_sel_hi:[1,0]
    v_pk_fma_f32 v[30:31], v[22:23], v[50:51], v[30:31] op_sel:[1,1,0] op_sel_hi:[0,1,1] neg_lo:[1,0,0]
    v_pk_fma_f32 v[38:39], v[22:23], v[8:9], v[38:39] op_sel:[1,1,0] op_sel_hi:[0,1,1] neg_lo:[1,0,0]
    v_pk_fma_f32 v[42:43], v[26:27], v[8:9], v[42:43] op_sel:[1,1,0] op_sel_hi:[0,1,1] neg_lo:[1,0,0]
    v_pk_fma_f32 v[44:45], v[28:29], v[8:9], v[44:45] op_sel:[1,1,0] op_sel_hi:[0,1,1] neg_lo:[1,0,0]
    v_pk_mul_f32 v[46:47], v[30:31], v[8:9] op_sel:[0,0] op_sel_hi:[1,0]
    v_pk_fma_f32 v[46:47], v[30:31], v[8:9], v[46:47] op_sel:[1,1,0] op_sel_hi:[0,1,1] neg_lo:[1,0,0]
    s_cmp_ge_u32 s3, 3
    s_cbranch_scc1 L_st_mid
    s_waitcnt vmcnt(0)
    v_mov_b32 v192, 45312
    v_mov_b32 v194, 1
    s_mov_b64 exec, 1
    ds_add_rtn_u32 v194, v192, v194
    s_waitcnt lgkmcnt(0)
    s_mov_b64 exec, -1
    v_readfirstlane_b32 s56, v194
    s_nop 1
    s_cmp_eq_u32 s56, 2
    s_nop 0
    s_cbranch_scc0 L_st_mid
    s_lshl_b32 s50, s2, 7
    s_add_u32 s50, s50, 4096
    v_mov_b32 v192, s50
    v_mov_b32 v194, s34
    v_mov_b32 v195, s35
    s_mov_b64 exec, 1
    global_store_dwordx2 v192, v[194:195], s[32:33] sc1
    s_mov_b64 exec, -1
L_st_mid:
    s_mov_b32 m0, s46
    s_waitcnt lgkmcnt(0)
    v_cvt_pk_f16_f32 v52, v16, v17
    v_cvt_pk_f16_f32 v53, v18, v19
    v_cvt_pk_f16_f32 v54, v20, v21
    v_cvt_pk_f16_f32 v55, v22, v23
    v_cvt_pk_f16_f32 v56, v24, v25
    v_cvt_pk_f16_f32 v57, v26, v27
    v_cvt_pk_f16_f32 v58, v28, v29
    v_cvt_pk_f16_f32 v59, v30, v31
    v_cvt_pk_f16_f32 v60, v32, v33
    v_cvt_pk_f16_f32 v61, v34, v35
    v_cvt_pk_f16_f32 v62, v36, v37
    v_cvt_pk_f16_f32 v63, v38, v39
    v_cvt_pk_f16_f32 v64, v40, v41
    v_cvt_pk_f16_f32 v65, v42, v43
    v_cvt_pk_f16_f32 v66, v44, v45
    v_cvt_pk_f16_f32 v67, v46, v47
    ds_write_addtid_b32 v52 offset:0
    ds_write_addtid_b32 v53 offset:288
    ds_write_addtid_b32 v54 offset:576
    ds_write_addtid_b32 v55 offset:864
    ds_write_addtid_b32 v56 offset:1152
    ds_write_addtid_b32 v57 offset:1440
    ds_write_addtid_b32 v58 offset:1728
    ds_write_addtid_b32 v59 offset:2016
    ds_write_addtid_b32 v60 offset:2304
    ds_write_addtid_b32 v61 offset:2592
    ds_write_addtid_b32 v62 offset:2880
    ds_write_addtid_b32 v63 offset:3168
    ds_write_addtid_b32 v64 offset:3456
    ds_write_addtid_b32 v65 offset:3744
    ds_write_addtid_b32 v66 offset:4032
    ds_write_addtid_b32 v67 offset:4320
    v_pk_mul_f32 v[18:19], v[16:17], v[10:11] op_sel:[0,0] op_sel_hi:[1,0]
    v_pk_mul_f32 v[22:23], v[20:21], v[10:11] op_sel:[0,0] op_sel_hi:[1,0]
    v_pk_mul_f32 v[26:27], v[24:25], v[10:11] op_sel:[0,0] op_sel_hi:[1,0]
    v_pk_mul_f32 v[30:31], v[28:29], v[10:11] op_sel:[0,0] op_sel_hi:[1,0]
    v_pk_mul_f32 v[34:35], v[32:33], v[10:11] op_sel:[0,0] op_sel_hi:[1,0]
    v_pk_mul_f32 v[38:39], v[36:37], v[10:11] op_sel:[0,0] op_sel_hi:[1,0]
    v_pk_mul_f32 v[42:43], v[40:41], v[10:11] op_sel:[0,0] op_sel_hi:[1,0]
    v_pk_mul_f32 v[46:47], v[44:45], v[10:11] op_sel:[0,0] op_sel_hi:[1,0]
    v_pk_fma_f32 v[18:19], v[16:17], v[10:11], v[18:19] op_sel:[1,1,0] op_sel_hi:[0,1,1] neg_lo:[1,0,0]
    v_pk_fma_f32 v[22:23], v[20:21], v[10:11], v[22:23] op_sel:[1,1,0] op_sel_hi:[0,1,1] neg_lo:[1,0,0]
    v_pk_fma_f32 v[26:27], v[24:25], v[10:11], v[26:27] op_sel:[1,1,0] op_sel_hi:[0,1,1] neg_lo:[1,0,0]
    v_pk_fma_f32 v[30:31], v[28:29], v[10:11], v[30:31] op_sel:[1,1,0] op_sel_hi:[0,1,1] neg_lo:[1,0,0]
    v_pk_fma_f32 v[34:35], v[32:33], v[10:11], v[34:35] op_sel:[1,1,0] op_sel_hi:[0,1,1] neg_lo:[1,0,0]
    v_pk_fma_f32 v[38:39], v[36:37], v[10:11], v[38:39] op_sel:[1,1,0] op_sel_hi:[0,1,1] neg_lo:[1,0,0]
    v_pk_fma_f32 v[42:43], v[40:41], v[10:11], v[42:43] op_sel:[1,1,0] op_sel_hi:[0,1,1] neg_lo:[1,0,0]
    v_pk_fma_f32 v[46:47], v[44:45], v[10:11], v[46:47] op_sel:[1,1,0] op_sel_hi:[0,1,1] neg_lo:[1,0,0]
    s_waitcnt lgkmcnt(0)
    ds_read_b128 v[52:55], v3 offset:0
    ds_read_b128 v[56:59], v3 offset:64
    ds_read_b128 v[60:63], v3 offset:128
    ds_read_b128 v[64:67], v3 offset:192
    v_pk_mul_f32 v[20:21], v[16:17], v[12:13] op_sel:[0,0] op_sel_hi:[1,0]
    v_pk_mul_f32 v[28:29], v[24:25], v[12:13] op_sel:[0,0] op_sel_hi:[1,0]
    v_pk_mul_f32 v[36:37], v[32:33], v[12:13] op_sel:[0,0] op_sel_hi:[1,0]
    v_pk_mul_f32 v[44:45], v[40:41], v[12:13] op_sel:[0,0] op_sel_hi:[1,0]
    v_pk_fma_f32 v[20:21], v[16:17], v[12:13], v[20:21] op_sel:[1,1,0] op_sel_hi:[0,1,1] neg_lo:[1,0,0]
    v_pk_fma_f32 v[28:29], v[24:25], v[12:13], v[28:29] op_sel:[1,1,0] op_sel_hi:[0,1,1] neg_lo:[1,0,0]
    v_pk_fma_f32 v[36:37], v[32:33], v[12:13], v[36:37] op_sel:[1,1,0] op_sel_hi:[0,1,1] neg_lo:[1,0,0]
    v_pk_fma_f32 v[44:45], v[40:41], v[12:13], v[44:45] op_sel:[1,1,0] op_sel_hi:[0,1,1] neg_lo:[1,0,0]
    v_pk_mul_f32 v[24:25], v[20:21], v[10:11] op_sel:[0,0] op_sel_hi:[1,0]
    v_pk_mul_f32 v[40:41], v[28:29], v[10:11] op_sel:[0,0] op_sel_hi:[1,0]
    v_pk_mul_f32 v[48:49], v[36:37], v[10:11] op_sel:[0,0] op_sel_hi:[1,0]
    v_pk_mul_f32 v[50:51], v[44:45], v[10:11] op_sel:[0,0] op_sel_hi:[1,0]
    v_pk_fma_f32 v[24:25], v[20:21], v[10:11], v[24:25] op_sel:[1,1,0] op_sel_hi:[0,1,1] neg_lo:[1,0,0]
    v_pk_fma_f32 v[40:41], v[28:29], v[10:11], v[40:41] op_sel:[1,1,0] op_sel_hi:[0,1,1] neg_lo:[1,0,0]
    v_pk_fma_f32 v[48:49], v[36:37], v[10:11], v[48:49] op_sel:[1,1,0] op_sel_hi:[0,1,1] neg_lo:[1,0,0]
    v_pk_fma_f32 v[50:51], v[44:45], v[10:11], v[50:51] op_sel:[1,1,0] op_sel_hi:[0,1,1] neg_lo:[1,0,0]
    s_cmp_lt_u32 s3, 3
    s_cbranch_scc1 L_xs4
    s_sub_u32 s48, s3, 3
    s_lshl_b32 s48, s48, 10
    s_mul_i32 s49, s5, 81920
    s_max_u32 s47, s49, 20480
    s_and_b32 s52, s4, 3
    s_cmp_eq_u32 s52, 1
    s_cbranch_scc1 L_xd5_1
    s_cmp_eq_u32 s52, 2
    s_cbranch_scc1 L_xd5_2
    s_cmp_eq_u32 s52, 3
    s_cbranch_scc1 L_xd5_3
    s_add_u32 m0, s48, 122880
    s_add_u32 s52, s49, 40960
    s_add_u32 s50, s8, s52
    s_addc_u32 s51, s9, 0
    global_load_lds_dwordx4 v246, s[50:51]
    s_add_u32 m0, s48, 128000
    s_add_u32 s50, s50, 5120
    s_addc_u32 s51, s51, 0
    global_load_lds_dwordx4 v247, s[50:51]
    s_add_u32 m0, s48, 133120
    s_add_u32 s50, s50, 5120
    s_addc_u32 s51, s51, 0
    global_load_lds_dwordx4 v248, s[50:51]
    s_add_u32 m0, s48, 138240
    s_add_u32 s50, s50, 5120
    s_addc_u32 s51, s51, 0
    global_load_lds_dwordx4 v249, s[50:51]
    s_add_u32 m0, s48, 143360
    s_add_u32 s50, s50, 5120
    s_addc_u32 s51, s51, 0
    global_load_lds_dwordx4 v246, s[50:51]
    s_add_u32 m0, s48, 148480
    s_add_u32 s50, s50, 5120
    s_addc_u32 s51, s51, 0
    global_load_lds_dwordx4 v247, s[50:51]
    s_add_u32 m0, s48, 153600
    s_add_u32 s50, s50, 5120
    s_addc_u32 s51, s51, 0
    global_load_lds_dwordx4 v248, s[50:51]
    s_add_u32 m0, s48, 158720
    s_add_u32 s50, s50, 5120
    s_addc_u32 s51, s51, 0
    global_load_lds_dwordx4 v249, s[50:51]
    s_branch L_xd5
L_xd5_1:
    s_add_u32 m0, s48, 148480
    s_add_u32 s52, s49, 66560
    s_add_u32 s50, s8, s52
    s_addc_u32 s51, s9, 0
    global_load_lds_dwordx4 v247, s[50:51]
    s_add_u32 m0, s48, 153600
    s_add_u32 s50, s50, 5120
    s_addc_u32 s51, s51, 0
    global_load_lds_dwordx4 v248, s[50:51]
    s_add_u32 m0, s48, 158720
    s_add_u32 s50, s50, 5120
    s_addc_u32 s51, s51, 0
    global_load_lds_dwordx4 v249, s[50:51]
    s_add_u32 m0, s48, 61440
    s_add_u32 s52, s47, -20480
    s_add_u32 s50, s8, s52
    s_addc_u32 s51, s9, 0
    global_load_lds_dwordx4 v246, s[50:51]
    s_add_u32 m0, s48, 66560
    s_add_u32 s50, s50, 5120
    s_addc_u32 s51, s51, 0
    global_load_lds_dwordx4 v247, s[50:51]
    s_add_u32 m0, s48, 71680
    s_add_u32 s50, s50, 5120
    s_addc_u32 s51, s51, 0
    global_load_lds_dwordx4 v248, s[50:51]
    s_add_u32 m0, s48, 76800
    s_add_u32 s50, s50, 5120
    s_addc_u32 s51, s51, 0
    global_load_lds_dwordx4 v249, s[50:51]
    s_add_u32 m0, s48, 81920
    s_add_u32 s52, s49, 0
    s_add_u32 s50, s8, s52
    s_addc_u32 s51, s9, 0
    global_load_lds_dwordx4 v246, s[50:51]
    s_branch L_xd5
L_xd5_2:
    s_add_u32 m0, s48, 71680
    s_add_u32 s52, s47, -10240
    s_add_u32 s50, s8, s52
    s_addc_u32 s51, s9, 0
    global_load_lds_dwordx4 v248, s[50:51]
    s_add_u32 m0, s48, 76800
    s_add_u32 s50, s50, 5120
    s_addc_u32 s51, s51, 0
    global_load_lds_dwordx4 v249, s[50:51]
    s_add_u32 m0, s48, 81920
    s_add_u32 s52, s49, 0
    s_add_u32 s50, s8, s52
    s_addc_u32 s51, s9, 0
    global_load_lds_dwordx4 v246, s[50:51]
    s_add_u32 m0, s48, 87040
    s_add_u32 s50, s50, 5120
    s_addc_u32 s51, s51, 0
    global_load_lds_dwordx4 v247, s[50:51]
    s_add_u32 m0, s48, 92160
    s_add_u32 s50, s50, 5120
    s_addc_u32 s51, s51, 0
    global_load_lds_dwordx4 v248, s[50:51]
    s_add_u32 m0, s48, 97280
    s_add_u32 s50, s50, 5120
    s_addc_u32 s51, s51, 0
    global_load_lds_dwordx4 v249, s[50:51]
    s_add_u32 m0, s48, 102400
    s_add_u32 s50, s50, 5120
    s_addc_u32 s51, s51, 0
    global_load_lds_dwordx4 v246, s[50:51]
    s_add_u32 m0, s48, 107520
    s_add_u32 s50, s50, 5120
    s_addc_u32 s51, s51, 0
    global_load_lds_dwordx4 v247, s[50:51]
    s_branch L_xd5
L_xd5_3:
    s_add_u32 m0, s48, 97280
    s_add_u32 s52, s49, 15360
    s_add_u32 s50, s8, s52
    s_addc_u32 s51, s9, 0
    global_load_lds_dwordx4 v249, s[50:51]
    s_add_u32 m0, s48, 102400
    s_add_u32 s50, s50, 5120
    s_addc_u32 s51, s51, 0
    global_load_lds_dwordx4 v246, s[50:51]
    s_add_u32 m0, s48, 107520
    s_add_u32 s50, s50, 5120
    s_addc_u32 s51, s51, 0
    global_load_lds_dwordx4 v247, s[50:51]
    s_add_u32 m0, s48, 112640
    s_add_u32 s50, s50, 5120
    s_addc_u32 s51, s51, 0
    global_load_lds_dwordx4 v248, s[50:51]
    s_add_u32 m0, s48, 117760
    s_add_u32 s50, s50, 5120
    s_addc_u32 s51, s51, 0
    global_load_lds_dwordx4 v249, s[50:51]
    s_add_u32 m0, s48, 122880
    s_add_u32 s50, s50, 5120
    s_addc_u32 s51, s51, 0
    global_load_lds_dwordx4 v246, s[50:51]
    s_add_u32 m0, s48, 128000
    s_add_u32 s50, s50, 5120
    s_addc_u32 s51, s51, 0
    global_load_lds_dwordx4 v247, s[50:51]
    s_add_u32 m0, s48, 133120
    s_add_u32 s50, s50, 5120
    s_addc_u32 s51, s51, 0
    global_load_lds_dwordx4 v248, s[50:51]
L_xd5:
L_xs4:
    s_mov_b32 m0, s46
    s_waitcnt lgkmcnt(0)
    v_mfma_f32_16x16x32_f16 v[84:87], v[52:55], v[68:71], 0
    v_mfma_f32_16x16x32_f16 v[84:87], v[56:59], v[72:75], v[84:87]
    v_mfma_f32_16x16x32_f16 v[84:87], v[60:63], v[76:79], v[84:87]
    v_mfma_f32_16x16x32_f16 v[84:87], v[64:67], v[80:83], v[84:87]
    v_cvt_pk_f16_f32 v52, v18, v19
    v_cvt_pk_f16_f32 v53, v22, v23
    v_cvt_pk_f16_f32 v54, v26, v27
    v_cvt_pk_f16_f32 v55, v30, v31
    v_cvt_pk_f16_f32 v56, v34, v35
    v_cvt_pk_f16_f32 v57, v38, v39
    v_cvt_pk_f16_f32 v58, v42, v43
    v_cvt_pk_f16_f32 v59, v46, v47
    v_cvt_pk_f16_f32 v60, v20, v21
    v_cvt_pk_f16_f32 v61, v28, v29
    v_cvt_pk_f16_f32 v62, v36, v37
    v_cvt_pk_f16_f32 v63, v44, v45
    v_cvt_pk_f16_f32 v64, v24, v25
    v_cvt_pk_f16_f32 v65, v40, v41
    v_cvt_pk_f16_f32 v66, v48, v49
    v_cvt_pk_f16_f32 v67, v50, v51
    ds_write_addtid_b32 v52 offset:0
    ds_write_addtid_b32 v53 offset:288
    ds_write_addtid_b32 v54 offset:576
    ds_write_addtid_b32 v55 offset:864
    ds_write_addtid_b32 v56 offset:1152
    ds_write_addtid_b32 v57 offset:1440
    ds_write_addtid_b32 v58 offset:1728
    ds_write_addtid_b32 v59 offset:2016
    ds_write_addtid_b32 v60 offset:2304
    ds_write_addtid_b32 v61 offset:2592
    ds_write_addtid_b32 v62 offset:2880
    ds_write_addtid_b32 v63 offset:3168
    ds_write_addtid_b32 v64 offset:3456
    ds_write_addtid_b32 v65 offset:3744
    ds_write_addtid_b32 v66 offset:4032
    ds_write_addtid_b32 v67 offset:4320
    v_pk_mul_f32 v[18:19], v[16:17], v[14:15] op_sel:[0,0] op_sel_hi:[1,0]
    v_pk_mul_f32 v[22:23], v[32:33], v[14:15] op_sel:[0,0] op_sel_hi:[1,0]
    v_pk_fma_f32 v[18:19], v[16:17], v[14:15], v[18:19] op_sel:[1,1,0] op_sel_hi:[0,1,1] neg_lo:[1,0,0]
    v_pk_fma_f32 v[22:23], v[32:33], v[14:15], v[22:23] op_sel:[1,1,0] op_sel_hi:[0,1,1] neg_lo:[1,0,0]
    s_waitcnt lgkmcnt(0)
    ds_read_b128 v[52:55], v3 offset:0
    ds_read_b128 v[56:59], v3 offset:64
    ds_read_b128 v[60:63], v3 offset:128
    ds_read_b128 v[64:67], v3 offset:192
    v_pk_mul_f32 v[26:27], v[18:19], v[10:11] op_sel:[0,0] op_sel_hi:[1,0]
    v_pk_mul_f32 v[30:31], v[22:23], v[10:11] op_sel:[0,0] op_sel_hi:[1,0]
    v_pk_mul_f32 v[34:35], v[18:19], v[12:13] op_sel:[0,0] op_sel_hi:[1,0]
    v_pk_mul_f32 v[38:39], v[22:23], v[12:13] op_sel:[0,0] op_sel_hi:[1,0]
    v_pk_mul_f32 v[20:21], v[18:19], v[14:15] op_sel:[0,0] op_sel_hi:[1,0]
    v_pk_fma_f32 v[26:27], v[18:19], v[10:11], v[26:27] op_sel:[1,1,0] op_sel_hi:[0,1,1] neg_lo:[1,0,0]
    v_pk_fma_f32 v[30:31], v[22:23], v[10:11], v[30:31] op_sel:[1,1,0] op_sel_hi:[0,1,1] neg_lo:[1,0,0]
    v_pk_fma_f32 v[34:35], v[18:19], v[12:13], v[34:35] op_sel:[1,1,0] op_sel_hi:[0,1,1] neg_lo:[1,0,0]
    v_pk_fma_f32 v[38:39], v[22:23], v[12:13], v[38:39] op_sel:[1,1,0] op_sel_hi:[0,1,1] neg_lo:[1,0,0]
    v_pk_fma_f32 v[20:21], v[18:19], v[14:15], v[20:21] op_sel:[1,1,0] op_sel_hi:[0,1,1] neg_lo:[1,0,0]
    v_pk_mul_f32 v[42:43], v[34:35], v[10:11] op_sel:[0,0] op_sel_hi:[1,0]
    v_pk_mul_f32 v[46:47], v[38:39], v[10:11] op_sel:[0,0] op_sel_hi:[1,0]
    v_pk_fma_f32 v[42:43], v[34:35], v[10:11], v[42:43] op_sel:[1,1,0] op_sel_hi:[0,1,1] neg_lo:[1,0,0]
    v_pk_fma_f32 v[46:47], v[38:39], v[10:11], v[46:47] op_sel:[1,1,0] op_sel_hi:[0,1,1] neg_lo:[1,0,0]
    s_lshr_b32 s47, s2, 3
    s_cmp_eq_u32 s3, 7
    s_cbranch_scc1 L_st_pc
    s_cmp_eq_u32 s3, 6
    s_cbranch_scc0 L_st_wu
    s_mul_i32 s47, s47, 25600
    v_min_u32 v192, 49, v1
    v_lshlrev_b32 v192, 7, v192
    v_add_u32 v192, s47, v192
    v_add_u32 v193, 6400, v192
    v_add_u32 v194, 12800, v192
    v_add_u32 v195, 19200, v192
    global_load_dword v192, v192, s[12:13]
    global_load_dword v193, v193, s[12:13]
    global_load_dword v194, v194, s[12:13]
    global_load_dword v195, v195, s[12:13]
    s_branch L_st_wu
L_st_pc:
    s_getpc_b64 s[50:51]
L_pcref:
    s_lshl_b32 s47, s47, 5
    v_and_b32 v192, 31, v1
    v_add_u32 v192, s47, v192
    v_lshlrev_b32 v192, 7, v192
    v_min_u32 v192, L_code_end-L_pcref-4, v192
    global_load_dword v192, v192, s[50:51]
L_st_wu:
    s_mov_b32 m0, s46
    s_waitcnt lgkmcnt(0)
    v_mfma_f32_16x16x32_f16 v[88:91], v[52:55], v[68:71], 0
    v_mfma_f32_16x16x32_f16 v[88:91], v[56:59], v[72:75], v[88:91]
    v_mfma_f32_16x16x32_f16 v[88:91], v[60:63], v[76:79], v[88:91]
    v_mfma_f32_16x16x32_f16 v[88:91], v[64:67], v[80:83], v[88:91]
    v_cvt_pk_f16_f32 v52, v18, v19
    v_cvt_pk_f16_f32 v53, v22, v23
    v_cvt_pk_f16_f32 v54, v26, v27
    v_cvt_pk_f16_f32 v55, v30, v31
    v_cvt_pk_f16_f32 v56, v34, v35
    v_cvt_pk_f16_f32 v57, v38, v39
    v_cvt_pk_f16_f32 v58, v42, v43
    v_cvt_pk_f16_f32 v59, v46, v47
    v_cvt_pk_f16_f32 v60, v20, v21
    ds_write_addtid_b32 v52 offset:0
    ds_write_addtid_b32 v53 offset:288
    ds_write_addtid_b32 v54 offset:576
    ds_write_addtid_b32 v55 offset:864
    ds_write_addtid_b32 v56 offset:1152
    ds_write_addtid_b32 v57 offset:1440
    ds_write_addtid_b32 v58 offset:1728
    ds_write_addtid_b32 v59 offset:2016
    ds_write_addtid_b32 v60 offset:2304
    s_waitcnt lgkmcnt(0)
    ds_read_b128 v[52:55], v3 offset:0
    ds_read_b128 v[56:59], v3 offset:64
    ds_read_b128 v[60:63], v3 offset:128
    ds_read_b128 v[64:67], v3 offset:192
    v_lshl_add_u32 v2, v1, 4, s46
    v_mov_b32 v4, 0
    s_waitcnt lgkmcnt(0)
    v_mfma_f32_16x16x32_f16 v[92:95], v[52:55], v[68:71], 0
    v_mfma_f32_16x16x32_f16 v[92:95], v[56:59], v[72:75], v[92:95]
    v_mfma_f32_16x16x32_f16 v[92:95], v[60:63], v[76:79], v[92:95]
    v_mfma_f32_16x16x32_f16 v[92:95], v[64:67], v[80:83], v[92:95]
    ds_write_b128 v2, v[84:87]
    ds_write_b128 v2, v[88:91] offset:1024
    ds_write_addtid_b32 v4 offset:3072
    s_nop 4
    ds_write_b128 v2, v[92:95] offset:2048
    s_cmp_eq_u32 s3, 0
    s_cbranch_scc0 L_st_np
    s_mul_i32 s46, s4, 30
    v_min_u32 v2, 29, v1
    v_add_u32 v2, s46, v2
    v_lshlrev_b32 v2, 7, v2
    v_add_u32 v2, 4096, v2
    s_mov_b32 s57, 0
L_poll6:
    global_load_dwordx2 v[4:5], v2, s[32:33] sc1
    s_add_u32 s57, s57, 1
    s_waitcnt vmcnt(0)
    v_cmp_ne_u64 vcc, s[34:35], v[4:5]
    s_cmp_gt_u32 s57, 200000
    s_nop 2
    s_cbranch_scc1 L_end
    s_cbranch_vccnz L_poll6
    v_mov_b32 v2, 45316
    v_mov_b32 v3, 1
    ds_write_b32 v2, v3
L_st_np:
    v_and_b32 v16, 15, v1
    v_lshrrev_b32 v17, 4, v1
    v_lshrrev_b32 v18, 2, v16
    v_and_b32 v19, 3, v1
    s_and_b32 s42, s3, 3
    s_lshr_b32 s43, s3, 2
    s_mul_i32 s43, s43, 48
    s_mul_i32 s44, s4, 80
    s_add_u32 s43, s43, s44
    v_mov_b32 v10, 0x3f803f80
    v_mov_b32 v11, 0x3f803f80
    v_mov_b32 v12, 0x3f803f80
    v_mov_b32 v13, 0x3f803f80
    s_mul_i32 s46, s4, 15
    s_lshl_b32 s47, s3, 1
    s_add_u32 s46, s46, s47
    s_mul_i32 s46, s46, 20480
    s_add_u32 s46, s46, 1048576
    s_add_u32 s48, s32, s46
    s_addc_u32 s49, s33, 0
    s_add_u32 s50, s48, 20480
    s_addc_u32 s51, s49, 0
    s_xor_b32 s46, s6, 0
    s_lshl_b32 s46, s46, 10
    v_lshl_add_u32 v44, v1, 4, s46
    s_xor_b32 s46, s6, 1
    s_lshl_b32 s46, s46, 10
    v_lshl_add_u32 v45, v1, 4, s46
    s_xor_b32 s46, s6, 2
    s_lshl_b32 s46, s46, 10
    v_lshl_add_u32 v46, v1, 4, s46
    s_xor_b32 s46, s6, 3
    s_lshl_b32 s46, s46, 10
    v_lshl_add_u32 v47, v1, 4, s46
    v_mul_u32_u24 v20, 1280, v16
    v_add_u32 v20, 61440, v20
    v_add_u32 v21, 0, v17
    v_xor_b32 v21, v21, v16
    v_lshl_add_u32 v2, v21, 4, v20
    v_add_u32 v21, 4, v17
    v_xor_b32 v21, v21, v16
    v_lshl_add_u32 v3, v21, 4, v20
    v_add_u32 v21, 8, v17
    v_xor_b32 v21, v21, v16
    v_lshl_add_u32 v4, v21, 4, v20
    v_add_u32 v21, 12, v17
    v_xor_b32 v21, v21, v16
    v_lshl_add_u32 v5, v21, 4, v20
    v_lshl_add_u32 v20, v17, 2, v18
    s_lshl_b32 s44, s6, 2
    v_xor_b32 v21, s44, v20
    s_lshl_b32 s44, s42, 4
    s_add_u32 s44, s44, 16
    v_add_u32 v20, s44, v20
    v_mul_u32_u24 v20, 1280, v20
    v_add_u32 v20, 61440, v20
    v_and_b32 v22, 1, v19
    v_lshl_add_u32 v20, v22, 3, v20
    v_lshrrev_b32 v22, 1, v19
    s_lshr_b32 s44, s43, 3
    v_add_u32 v22, s44, v22
    v_add_u32 v23, 0, v22
    v_min_u32 v23, 79, v23
    v_xor_b32 v23, v23, v21
    v_lshl_add_u32 v7, v23, 4, v20
    v_add_u32 v23, 2, v22
    v_min_u32 v23, 79, v23
    v_xor_b32 v23, v23, v21
    v_lshl_add_u32 v8, v23, 4, v20
    v_add_u32 v23, 4, v22
    v_min_u32 v23, 79, v23
    v_xor_b32 v23, v23, v21
    v_lshl_add_u32 v9, v23, 4, v20
    s_waitcnt vmcnt(0)
    s_sub_u32 s46, s3, 3
    s_cmp_lt_u32 s46, 2
    s_cbranch_scc0 L_st_w
    s_lshl_b32 s46, s46, 10
    s_add_u32 s46, s46, 61440
    v_lshl_add_u32 v24, v1, 4, s46
    v_min_u32 v24, 62704, v24
    ds_write_b128 v24, v[10:13]
L_st_w:
    v_mov_b32 v24, 45316
    s_mov_b32 s57, 0
L_sp7:
    ds_read_b32 v25, v24
    s_add_u32 s57, s57, 1
    s_waitcnt lgkmcnt(0)
    v_readfirstlane_b32 s56, v25
    s_cmp_gt_u32 s57, 2000000
    s_nop 2
    s_cbranch_scc1 L_end
    s_cmp_lt_u32 s56, 1
    s_cbranch_scc1 L_sp7
    s_cmp_eq_u32 s3, 0
    s_cbranch_scc1 L_g1A
    s_cmp_eq_u32 s3, 1
    s_cbranch_scc1 L_g1B
    s_cmp_eq_u32 s3, 3
    s_cbranch_scc1 L_g1D
    s_cmp_eq_u32 s3, 7
    s_cbranch_scc1 L_g1E
    global_load_dwordx4 v[96:99], v44, s[48:49] sc1
    global_load_dwordx4 v[176:179], v44, s[50:51] sc1
    global_load_dwordx4 v[100:103], v45, s[48:49] sc1
    global_load_dwordx4 v[180:183], v45, s[50:51] sc1
    global_load_dwordx4 v[104:107], v46, s[48:49] sc1
    global_load_dwordx4 v[184:187], v46, s[50:51] sc1
    global_load_dwordx4 v[108:111], v47, s[48:49] sc1
    global_load_dwordx4 v[188:191], v47, s[50:51] sc1
    s_add_u32 s48, s48, 4096
    s_addc_u32 s49, s49, 0
    s_add_u32 s50, s50, 4096
    s_addc_u32 s51, s51, 0
    s_waitcnt lgkmcnt(0)
    s_barrier
    global_load_dwordx4 v[112:115], v44, s[48:49] sc1
    global_load_dwordx4 v[192:195], v44, s[50:51] sc1
    global_load_dwordx4 v[116:119], v45, s[48:49] sc1
    global_load_dwordx4 v[196:199], v45, s[50:51] sc1
    global_load_dwordx4 v[120:123], v46, s[48:49] sc1
    global_load_dwordx4 v[200:203], v46, s[50:51] sc1
    global_load_dwordx4 v[124:127], v47, s[48:49] sc1
    global_load_dwordx4 v[204:207], v47, s[50:51] sc1
    s_add_u32 s48, s48, 4096
    s_addc_u32 s49, s49, 0
    s_add_u32 s50, s50, 4096
    s_addc_u32 s51, s51, 0
    ds_read_b128 v[16:19], v2 offset:0
    ds_read_b128 v[20:23], v2 offset:20480
    ds_read_b128 v[24:27], v2 offset:40960
    ds_read_b128 v[28:31], v2 offset:61440
    v_add_u32 v6, 81920, v2
    ds_read_b128 v[32:35], v6 offset:0
    ds_read_b128 v[36:39], v3 offset:0
    global_load_dwordx4 v[128:131], v44, s[48:49] sc1
    global_load_dwordx4 v[208:211], v44, s[50:51] sc1
    ds_read_b128 v[40:43], v3 offset:20480
    s_waitcnt vmcnt(16) lgkmcnt(6)
    v_mfma_f32_16x16x32_bf16 v[48:51], v[96:99], v[16:19], 0
    v_mfma_f32_16x16x32_bf16 v[52:55], v[176:179], v[16:19], 0
    ds_read_b128 v[16:19], v3 offset:40960
    s_waitcnt lgkmcnt(6)
    v_mfma_f32_16x16x32_bf16 v[56:59], v[96:99], v[20:23], 0
    v_mfma_f32_16x16x32_bf16 v[60:63], v[176:179], v[20:23], 0
    ds_read_b128 v[20:23], v3 offset:61440
    s_waitcnt lgkmcnt(6)
    v_mfma_f32_16x16x32_bf16 v[64:67], v[96:99], v[24:27], 0
    v_mfma_f32_16x16x32_bf16 v[68:71], v[176:179], v[24:27], 0
    v_add_u32 v6, 81920, v3
    ds_read_b128 v[24:27], v6 offset:0
    s_waitcnt lgkmcnt(6)
    v_mfma_f32_16x16x32_bf16 v[72:75], v[96:99], v[28:31], 0
    v_mfma_f32_16x16x32_bf16 v[76:79], v[176:179], v[28:31], 0
    ds_read_b128 v[28:31], v4 offset:0
    s_waitcnt lgkmcnt(6)
    v_mfma_f32_16x16x32_bf16 v[80:83], v[96:99], v[32:35], 0
    v_mfma_f32_16x16x32_bf16 v[84:87], v[176:179], v[32:35], 0
    global_load_dwordx4 v[132:135], v45, s[48:49] sc1
    global_load_dwordx4 v[212:215], v45, s[50:51] sc1
    ds_read_b128 v[32:35], v4 offset:20480
    s_waitcnt vmcnt(16) lgkmcnt(6)
    v_mfma_f32_16x16x32_bf16 v[48:51], v[100:103], v[36:39], v[48:51]
    v_mfma_f32_16x16x32_bf16 v[52:55], v[180:183], v[36:39], v[52:55]
    ds_read_b128 v[36:39], v4 offset:40960
    s_waitcnt lgkmcnt(6)
    v_mfma_f32_16x16x32_bf16 v[56:59], v[100:103], v[40:43], v[56:59]
    v_mfma_f32_16x16x32_bf16 v[60:63], v[180:183], v[40:43], v[60:63]
    ds_read_b128 v[40:43], v4 offset:61440
    s_waitcnt lgkmcnt(6)
    v_mfma_f32_16x16x32_bf16 v[64:67], v[100:103], v[16:19], v[64:67]
    v_mfma_f32_16x16x32_bf16 v[68:71], v[180:183], v[16:19], v[68:71]
    v_add_u32 v6, 81920, v4
    ds_read_b128 v[16:19], v6 offset:0
    s_waitcnt lgkmcnt(6)
    v_mfma_f32_16x16x32_bf16 v[72:75], v[100:103], v[20:23], v[72:75]
    v_mfma_f32_16x16x32_bf16 v[76:79], v[180:183], v[20:23], v[76:79]
    ds_read_b128 v[20:23], v5 offset:0
    s_waitcnt lgkmcnt(6)
    v_mfma_f32_16x16x32_bf16 v[80:83], v[100:103], v[24:27], v[80:83]
    v_mfma_f32_16x16x32_bf16 v[84:87], v[180:183], v[24:27], v[84:87]
    global_load_dwordx4 v[136:139], v46, s[48:49] sc1
    global_load_dwordx4 v[216:219], v46, s[50:51] sc1
    ds_read_b128 v[24:27], v5 offset:20480
    s_waitcnt vmcnt(16) lgkmcnt(6)
    v_mfma_f32_16x16x32_bf16 v[48:51], v[104:107], v[28:31], v[48:51]
    v_mfma_f32_16x16x32_bf16 v[52:55], v[184:187], v[28:31], v[52:55]
    ds_read_b128 v[28:31], v5 offset:40960
    s_waitcnt lgkmcnt(6)
    v_mfma_f32_16x16x32_bf16 v[56:59], v[104:107], v[32:35], v[56:59]
    v_mfma_f32_16x16x32_bf16 v[60:63], v[184:187], v[32:35], v[60:63]
    ds_read_b128 v[32:35], v5 offset:61440
    s_waitcnt lgkmcnt(6)
    v_mfma_f32_16x16x32_bf16 v[64:67], v[104:107], v[36:39], v[64:67]
    v_mfma_f32_16x16x32_bf16 v[68:71], v[184:187], v[36:39], v[68:71]
    v_add_u32 v6, 81920, v5
    ds_read_b128 v[36:39], v6 offset:0
    s_waitcnt lgkmcnt(6)
    v_mfma_f32_16x16x32_bf16 v[72:75], v[104:107], v[40:43], v[72:75]
    v_mfma_f32_16x16x32_bf16 v[76:79], v[184:187], v[40:43], v[76:79]
    ds_read_b128 v[40:43], v2 offset:256
    s_waitcnt lgkmcnt(6)
    v_mfma_f32_16x16x32_bf16 v[80:83], v[104:107], v[16:19], v[80:83]
    v_mfma_f32_16x16x32_bf16 v[84:87], v[184:187], v[16:19], v[84:87]
    global_load_dwordx4 v[140:143], v47, s[48:49] sc1
    global_load_dwordx4 v[220:223], v47, s[50:51] sc1
    s_add_u32 s48, s48, 4096
    s_addc_u32 s49, s49, 0
    s_add_u32 s50, s50, 4096
    s_addc_u32 s51, s51, 0
    ds_read_b128 v[16:19], v2 offset:20736
    s_waitcnt vmcnt(16) lgkmcnt(6)
    v_mfma_f32_16x16x32_bf16 v[48:51], v[108:111], v[20:23], v[48:51]
    v_mfma_f32_16x16x32_bf16 v[52:55], v[188:191], v[20:23], v[52:55]
    ds_read_b128 v[20:23], v2 offset:41216
    s_waitcnt lgkmcnt(6)
    v_mfma_f32_16x16x32_bf16 v[56:59], v[108:111], v[24:27], v[56:59]
    v_mfma_f32_16x16x32_bf16 v[60:63], v[188:191], v[24:27], v[60:63]
    ds_read_b128 v[24:27], v2 offset:61696
    s_waitcnt lgkmcnt(6)
    v_mfma_f32_16x16x32_bf16 v[64:67], v[108:111], v[28:31], v[64:67]
    v_mfma_f32_16x16x32_bf16 v[68:71], v[188:191], v[28:31], v[68:71]
    v_add_u32 v6, 81920, v2
    ds_read_b128 v[28:31], v6 offset:256
    s_waitcnt lgkmcnt(6)
    v_mfma_f32_16x16x32_bf16 v[72:75], v[108:111], v[32:35], v[72:75]
    v_mfma_f32_16x16x32_bf16 v[76:79], v[188:191], v[32:35], v[76:79]
    ds_read_b128 v[32:35], v3 offset:256
    s_waitcnt lgkmcnt(6)
    v_mfma_f32_16x16x32_bf16 v[80:83], v[108:111], v[36:39], v[80:83]
    v_mfma_f32_16x16x32_bf16 v[84:87], v[188:191], v[36:39], v[84:87]
    global_load_dwordx4 v[144:147], v44, s[48:49] sc1
    global_load_dwordx4 v[224:227], v44, s[50:51] sc1
    ds_read_b128 v[36:39], v3 offset:20736
    s_waitcnt vmcnt(16) lgkmcnt(6)
    v_mfma_f32_16x16x32_bf16 v[48:51], v[112:115], v[40:43], v[48:51]
    v_mfma_f32_16x16x32_bf16 v[52:55], v[192:195], v[40:43], v[52:55]
    ds_read_b128 v[40:43], v3 offset:41216
    s_waitcnt lgkmcnt(6)
    v_mfma_f32_16x16x32_bf16 v[56:59], v[112:115], v[16:19], v[56:59]
    v_mfma_f32_16x16x32_bf16 v[60:63], v[192:195], v[16:19], v[60:63]
    ds_read_b128 v[16:19], v3 offset:61696
    s_waitcnt lgkmcnt(6)
    v_mfma_f32_16x16x32_bf16 v[64:67], v[112:115], v[20:23], v[64:67]
    v_mfma_f32_16x16x32_bf16 v[68:71], v[192:195], v[20:23], v[68:71]
    v_add_u32 v6, 81920, v3
    ds_read_b128 v[20:23], v6 offset:256
    s_waitcnt lgkmcnt(6)
    v_mfma_f32_16x16x32_bf16 v[72:75], v[112:115], v[24:27], v[72:75]
    v_mfma_f32_16x16x32_bf16 v[76:79], v[192:195], v[24:27], v[76:79]
    ds_read_b128 v[24:27], v4 offset:256
    s_waitcnt lgkmcnt(6)
    v_mfma_f32_16x16x32_bf16 v[80:83], v[112:115], v[28:31], v[80:83]
    v_mfma_f32_16x16x32_bf16 v[84:87], v[192:195], v[28:31], v[84:87]
    global_load_dwordx4 v[148:151], v45, s[48:49] sc1
    global_load_dwordx4 v[228:231], v45, s[50:51] sc1
    ds_read_b128 v[28:31], v4 offset:20736
    s_waitcnt vmcnt(16) lgkmcnt(6)
    v_mfma_f32_16x16x32_bf16 v[48:51], v[116:119], v[32:35], v[48:51]
    v_mfma_f32_16x16x32_bf16 v[52:55], v[196:199], v[32:35], v[52:55]
    ds_read_b128 v[32:35], v4 offset:41216
    s_waitcnt lgkmcnt(6)
    v_mfma_f32_16x16x32_bf16 v[56:59], v[116:119], v[36:39], v[56:59]
    v_mfma_f32_16x16x32_bf16 v[60:63], v[196:199], v[36:39], v[60:63]
    ds_read_b128 v[36:39], v4 offset:61696
    s_waitcnt lgkmcnt(6)
    v_mfma_f32_16x16x32_bf16 v[64:67], v[116:119], v[40:43], v[64:67]
    v_mfma_f32_16x16x32_bf16 v[68:71], v[196:199], v[40:43], v[68:71]
    v_add_u32 v6, 81920, v4
    ds_read_b128 v[40:43], v6 offset:256
    s_waitcnt lgkmcnt(6)
    v_mfma_f32_16x16x32_bf16 v[72:75], v[116:119], v[16:19], v[72:75]
    v_mfma_f32_16x16x32_bf16 v[76:79], v[196:199], v[16:19], v[76:79]
    ds_read_b128 v[16:19], v5 offset:256
    s_waitcnt lgkmcnt(6)
    v_mfma_f32_16x16x32_bf16 v[80:83], v[116:119], v[20:23], v[80:83]
    v_mfma_f32_16x16x32_bf16 v[84:87], v[196:199], v[20:23], v[84:87]
    global_load_dwordx4 v[152:155], v46, s[48:49] sc1
    global_load_dwordx4 v[232:235], v46, s[50:51] sc1
    ds_read_b128 v[20:23], v5 offset:20736
    s_waitcnt vmcnt(16) lgkmcnt(6)
    v_mfma_f32_16x16x32_bf16 v[48:51], v[120:123], v[24:27], v[48:51]
    v_mfma_f32_16x16x32_bf16 v[52:55], v[200:203], v[24:27], v[52:55]
    ds_read_b128 v[24:27], v5 offset:41216
    s_waitcnt lgkmcnt(6)
    v_mfma_f32_16x16x32_bf16 v[56:59], v[120:123], v[28:31], v[56:59]
    v_mfma_f32_16x16x32_bf16 v[60:63], v[200:203], v[28:31], v[60:63]
    ds_read_b128 v[28:31], v5 offset:61696
    s_waitcnt lgkmcnt(6)
    v_mfma_f32_16x16x32_bf16 v[64:67], v[120:123], v[32:35], v[64:67]
    v_mfma_f32_16x16x32_bf16 v[68:71], v[200:203], v[32:35], v[68:71]
    v_add_u32 v6, 81920, v5
    ds_read_b128 v[32:35], v6 offset:256
    s_waitcnt lgkmcnt(6)
    v_mfma_f32_16x16x32_bf16 v[72:75], v[120:123], v[36:39], v[72:75]
    v_mfma_f32_16x16x32_bf16 v[76:79], v[200:203], v[36:39], v[76:79]
    ds_read_b128 v[36:39], v2 offset:512
    s_waitcnt lgkmcnt(6)
    v_mfma_f32_16x16x32_bf16 v[80:83], v[120:123], v[40:43], v[80:83]
    v_mfma_f32_16x16x32_bf16 v[84:87], v[200:203], v[40:43], v[84:87]
    global_load_dwordx4 v[156:159], v47, s[48:49] sc1
    global_load_dwordx4 v[236:239], v47, s[50:51] sc1
    s_add_u32 s48, s48, 4096
    s_addc_u32 s49, s49, 0
    s_add_u32 s50, s50, 4096
    s_addc_u32 s51, s51, 0
    ds_read_b128 v[40:43], v2 offset:20992
    s_waitcnt vmcnt(16) lgkmcnt(6)
    v_mfma_f32_16x16x32_bf16 v[48:51], v[124:127], v[16:19], v[48:51]
    v_mfma_f32_16x16x32_bf16 v[52:55], v[204:207], v[16:19], v[52:55]
    ds_read_b128 v[16:19], v2 offset:41472
    s_waitcnt lgkmcnt(6)
    v_mfma_f32_16x16x32_bf16 v[56:59], v[124:127], v[20:23], v[56:59]
    v_mfma_f32_16x16x32_bf16 v[60:63], v[204:207], v[20:23], v[60:63]
    ds_read_b128 v[20:23], v2 offset:61952
    s_waitcnt lgkmcnt(6)
    v_mfma_f32_16x16x32_bf16 v[64:67], v[124:127], v[24:27], v[64:67]
    v_mfma_f32_16x16x32_bf16 v[68:71], v[204:207], v[24:27], v[68:71]
    v_add_u32 v6, 81920, v2
    ds_read_b128 v[24:27], v6 offset:512
    s_waitcnt lgkmcnt(6)
    v_mfma_f32_16x16x32_bf16 v[72:75], v[124:127], v[28:31], v[72:75]
    v_mfma_f32_16x16x32_bf16 v[76:79], v[204:207], v[28:31], v[76:79]
    ds_read_b128 v[28:31], v3 offset:512
    s_waitcnt lgkmcnt(6)
    v_mfma_f32_16x16x32_bf16 v[80:83], v[124:127], v[32:35], v[80:83]
    v_mfma_f32_16x16x32_bf16 v[84:87], v[204:207], v[32:35], v[84:87]
    global_load_dwordx4 v[160:163], v44, s[48:49] sc1
    global_load_dwordx4 v[240:243], v44, s[50:51] sc1
    ds_read_b128 v[32:35], v3 offset:20992
    s_waitcnt vmcnt(16) lgkmcnt(6)
    v_mfma_f32_16x16x32_bf16 v[48:51], v[128:131], v[36:39], v[48:51]
    v_mfma_f32_16x16x32_bf16 v[52:55], v[208:211], v[36:39], v[52:55]
    ds_read_b128 v[36:39], v3 offset:41472
    s_waitcnt lgkmcnt(6)
    v_mfma_f32_16x16x32_bf16 v[56:59], v[128:131], v[40:43], v[56:59]
    v_mfma_f32_16x16x32_bf16 v[60:63], v[208:211], v[40:43], v[60:63]
    ds_read_b128 v[40:43], v3 offset:61952
    s_waitcnt lgkmcnt(6)
    v_mfma_f32_16x16x32_bf16 v[64:67], v[128:131], v[16:19], v[64:67]
    v_mfma_f32_16x16x32_bf16 v[68:71], v[208:211], v[16:19], v[68:71]
    v_add_u32 v6, 81920, v3
    ds_read_b128 v[16:19], v6 offset:512
    s_waitcnt lgkmcnt(6)
    v_mfma_f32_16x16x32_bf16 v[72:75], v[128:131], v[20:23], v[72:75]
    v_mfma_f32_16x16x32_bf16 v[76:79], v[208:211], v[20:23], v[76:79]
    ds_read_b128 v[20:23], v4 offset:512
    s_waitcnt lgkmcnt(6)
    v_mfma_f32_16x16x32_bf16 v[80:83], v[128:131], v[24:27], v[80:83]
    v_mfma_f32_16x16x32_bf16 v[84:87], v[208:211], v[24:27], v[84:87]
    global_load_dwordx4 v[164:167], v45, s[48:49] sc1
    global_load_dwordx4 v[244:247], v45, s[50:51] sc1
    ds_read_b128 v[24:27], v4 offset:20992
    s_waitcnt vmcnt(16) lgkmcnt(6)
    v_mfma_f32_16x16x32_bf16 v[48:51], v[132:135], v[28:31], v[48:51]
    v_mfma_f32_16x16x32_bf16 v[52:55], v[212:215], v[28:31], v[52:55]
    ds_read_b128 v[28:31], v4 offset:41472
    s_waitcnt lgkmcnt(6)
    v_mfma_f32_16x16x32_bf16 v[56:59], v[132:135], v[32:35], v[56:59]
    v_mfma_f32_16x16x32_bf16 v[60:63], v[212:215], v[32:35], v[60:63]
    ds_read_b128 v[32:35], v4 offset:61952
    s_waitcnt lgkmcnt(6)
    v_mfma_f32_16x16x32_bf16 v[64:67], v[132:135], v[36:39], v[64:67]
    v_mfma_f32_16x16x32_bf16 v[68:71], v[212:215], v[36:39], v[68:71]
    v_add_u32 v6, 81920, v4
    ds_read_b128 v[36:39], v6 offset:512
    s_waitcnt lgkmcnt(6)
    v_mfma_f32_16x16x32_bf16 v[72:75], v[132:135], v[40:43], v[72:75]
    v_mfma_f32_16x16x32_bf16 v[76:79], v[212:215], v[40:43], v[76:79]
    ds_read_b128 v[40:43], v5 offset:512
    s_waitcnt lgkmcnt(6)
    v_mfma_f32_16x16x32_bf16 v[80:83], v[132:135], v[16:19], v[80:83]
    v_mfma_f32_16x16x32_bf16 v[84:87], v[212:215], v[16:19], v[84:87]
    global_load_dwordx4 v[168:171], v46, s[48:49] sc1
    global_load_dwordx4 v[248:251], v46, s[50:51] sc1
    ds_read_b128 v[16:19], v5 offset:20992
    s_waitcnt vmcnt(16) lgkmcnt(6)
    v_mfma_f32_16x16x32_bf16 v[48:51], v[136:139], v[20:23], v[48:51]
    v_mfma_f32_16x16x32_bf16 v[52:55], v[216:219], v[20:23], v[52:55]
    ds_read_b128 v[20:23], v5 offset:41472
    s_waitcnt lgkmcnt(6)
    v_mfma_f32_16x16x32_bf16 v[56:59], v[136:139], v[24:27], v[56:59]
    v_mfma_f32_16x16x32_bf16 v[60:63], v[216:219], v[24:27], v[60:63]
    ds_read_b128 v[24:27], v5 offset:61952
    s_waitcnt lgkmcnt(6)
    v_mfma_f32_16x16x32_bf16 v[64:67], v[136:139], v[28:31], v[64:67]
    v_mfma_f32_16x16x32_bf16 v[68:71], v[216:219], v[28:31], v[68:71]
    v_add_u32 v6, 81920, v5
    ds_read_b128 v[28:31], v6 offset:512
    s_waitcnt lgkmcnt(6)
    v_mfma_f32_16x16x32_bf16 v[72:75], v[136:139], v[32:35], v[72:75]
    v_mfma_f32_16x16x32_bf16 v[76:79], v[216:219], v[32:35], v[76:79]
    ds_read_b128 v[32:35], v2 offset:768
    s_waitcnt lgkmcnt(6)
    v_mfma_f32_16x16x32_bf16 v[80:83], v[136:139], v[36:39], v[80:83]
    v_mfma_f32_16x16x32_bf16 v[84:87], v[216:219], v[36:39], v[84:87]
    global_load_dwordx4 v[172:175], v47, s[48:49] sc1
    global_load_dwordx4 v[252:255], v47, s[50:51] sc1
    ds_read_b128 v[36:39], v2 offset:21248
    s_waitcnt vmcnt(16) lgkmcnt(6)
    v_mfma_f32_16x16x32_bf16 v[48:51], v[140:143], v[40:43], v[48:51]
    v_mfma_f32_16x16x32_bf16 v[52:55], v[220:223], v[40:43], v[52:55]
    ds_read_b128 v[40:43], v2 offset:41728
    s_waitcnt lgkmcnt(6)
    v_mfma_f32_16x16x32_bf16 v[56:59], v[140:143], v[16:19], v[56:59]
    v_mfma_f32_16x16x32_bf16 v[60:63], v[220:223], v[16:19], v[60:63]
    ds_read_b128 v[16:19], v2 offset:62208
    s_waitcnt lgkmcnt(6)
    v_mfma_f32_16x16x32_bf16 v[64:67], v[140:143], v[20:23], v[64:67]
    v_mfma_f32_16x16x32_bf16 v[68:71], v[220:223], v[20:23], v[68:71]
    v_add_u32 v6, 81920, v2
    ds_read_b128 v[20:23], v6 offset:768
    s_waitcnt lgkmcnt(6)
    v_mfma_f32_16x16x32_bf16 v[72:75], v[140:143], v[24:27], v[72:75]
    v_mfma_f32_16x16x32_bf16 v[76:79], v[220:223], v[24:27], v[76:79]
    ds_read_b128 v[24:27], v3 offset:768
    s_waitcnt lgkmcnt(6)
    v_mfma_f32_16x16x32_bf16 v[80:83], v[140:143], v[28:31], v[80:83]
    v_mfma_f32_16x16x32_bf16 v[84:87], v[220:223], v[28:31], v[84:87]
    ds_read_b128 v[28:31], v3 offset:21248
    s_waitcnt vmcnt(14) lgkmcnt(6)
    v_mfma_f32_16x16x32_bf16 v[48:51], v[144:147], v[32:35], v[48:51]
    v_mfma_f32_16x16x32_bf16 v[52:55], v[224:227], v[32:35], v[52:55]
    ds_read_b128 v[32:35], v3 offset:41728
    s_waitcnt lgkmcnt(6)
    v_mfma_f32_16x16x32_bf16 v[56:59], v[144:147], v[36:39], v[56:59]
    v_mfma_f32_16x16x32_bf16 v[60:63], v[224:227], v[36:39], v[60:63]
    ds_read_b128 v[36:39], v3 offset:62208
    s_waitcnt lgkmcnt(6)
    v_mfma_f32_16x16x32_bf16 v[64:67], v[144:147], v[40:43], v[64:67]
    v_mfma_f32_16x16x32_bf16 v[68:71], v[224:227], v[40:43], v[68:71]
    v_add_u32 v6, 81920, v3
    ds_read_b128 v[40:43], v6 offset:768
    s_waitcnt lgkmcnt(6)
    v_mfma_f32_16x16x32_bf16 v[72:75], v[144:147], v[16:19], v[72:75]
    v_mfma_f32_16x16x32_bf16 v[76:79], v[224:227], v[16:19], v[76:79]
    ds_read_b128 v[16:19], v4 offset:768
    s_waitcnt lgkmcnt(6)
    v_mfma_f32_16x16x32_bf16 v[80:83], v[144:147], v[20:23], v[80:83]
    v_mfma_f32_16x16x32_bf16 v[84:87], v[224:227], v[20:23], v[84:87]
    ds_read_b128 v[20:23], v4 offset:21248
    s_waitcnt vmcnt(12) lgkmcnt(6)
    v_mfma_f32_16x16x32_bf16 v[48:51], v[148:151], v[24:27], v[48:51]
    v_mfma_f32_16x16x32_bf16 v[52:55], v[228:231], v[24:27], v[52:55]
    ds_read_b128 v[24:27], v4 offset:41728
    s_waitcnt lgkmcnt(6)
    v_mfma_f32_16x16x32_bf16 v[56:59], v[148:151], v[28:31], v[56:59]
    v_mfma_f32_16x16x32_bf16 v[60:63], v[228:231], v[28:31], v[60:63]
    ds_read_b128 v[28:31], v4 offset:62208
    s_waitcnt lgkmcnt(6)
    v_mfma_f32_16x16x32_bf16 v[64:67], v[148:151], v[32:35], v[64:67]
    v_mfma_f32_16x16x32_bf16 v[68:71], v[228:231], v[32:35], v[68:71]
    v_add_u32 v6, 81920, v4
    ds_read_b128 v[32:35], v6 offset:768
    s_waitcnt lgkmcnt(6)
    v_mfma_f32_16x16x32_bf16 v[72:75], v[148:151], v[36:39], v[72:75]
    v_mfma_f32_16x16x32_bf16 v[76:79], v[228:231], v[36:39], v[76:79]
    ds_read_b128 v[36:39], v5 offset:768
    s_waitcnt lgkmcnt(6)
    v_mfma_f32_16x16x32_bf16 v[80:83], v[148:151], v[40:43], v[80:83]
    v_mfma_f32_16x16x32_bf16 v[84:87], v[228:231], v[40:43], v[84:87]
    ds_read_b128 v[40:43], v5 offset:21248
    s_waitcnt vmcnt(10) lgkmcnt(6)
    v_mfma_f32_16x16x32_bf16 v[48:51], v[152:155], v[16:19], v[48:51]
    v_mfma_f32_16x16x32_bf16 v[52:55], v[232:235], v[16:19], v[52:55]
    ds_read_b128 v[16:19], v5 offset:41728
    s_waitcnt lgkmcnt(6)
    v_mfma_f32_16x16x32_bf16 v[56:59], v[152:155], v[20:23], v[56:59]
    v_mfma_f32_16x16x32_bf16 v[60:63], v[232:235], v[20:23], v[60:63]
    ds_read_b128 v[20:23], v5 offset:62208
    s_waitcnt lgkmcnt(6)
    v_mfma_f32_16x16x32_bf16 v[64:67], v[152:155], v[24:27], v[64:67]
    v_mfma_f32_16x16x32_bf16 v[68:71], v[232:235], v[24:27], v[68:71]
    v_add_u32 v6, 81920, v5
    ds_read_b128 v[24:27], v6 offset:768
    s_waitcnt lgkmcnt(6)
    v_mfma_f32_16x16x32_bf16 v[72:75], v[152:155], v[28:31], v[72:75]
    v_mfma_f32_16x16x32_bf16 v[76:79], v[232:235], v[28:31], v[76:79]
    ds_read_b128 v[28:31], v2 offset:1024
    s_waitcnt lgkmcnt(6)
    v_mfma_f32_16x16x32_bf16 v[80:83], v[152:155], v[32:35], v[80:83]
    v_mfma_f32_16x16x32_bf16 v[84:87], v[232:235], v[32:35], v[84:87]
    ds_read_b128 v[32:35], v2 offset:21504
    s_waitcnt vmcnt(8) lgkmcnt(6)
    v_mfma_f32_16x16x32_bf16 v[48:51], v[156:159], v[36:39], v[48:51]
    v_mfma_f32_16x16x32_bf16 v[52:55], v[236:239], v[36:39], v[52:55]
    ds_read_b128 v[36:39], v2 offset:41984
    s_waitcnt lgkmcnt(6)
    v_mfma_f32_16x16x32_bf16 v[56:59], v[156:159], v[40:43], v[56:59]
    v_mfma_f32_16x16x32_bf16 v[60:63], v[236:239], v[40:43], v[60:63]
    ds_read_b128 v[40:43], v2 offset:62464
    s_waitcnt lgkmcnt(6)
    v_mfma_f32_16x16x32_bf16 v[64:67], v[156:159], v[16:19], v[64:67]
    v_mfma_f32_16x16x32_bf16 v[68:71], v[236:239], v[16:19], v[68:71]
    v_add_u32 v6, 81920, v2
    ds_read_b128 v[16:19], v6 offset:1024
    s_waitcnt lgkmcnt(6)
    v_mfma_f32_16x16x32_bf16 v[72:75], v[156:159], v[20:23], v[72:75]
    v_mfma_f32_16x16x32_bf16 v[76:79], v[236:239], v[20:23], v[76:79]
    ds_read_b128 v[20:23], v3 offset:1024
    s_waitcnt lgkmcnt(6)
    v_mfma_f32_16x16x32_bf16 v[80:83], v[156:159], v[24:27], v[80:83]
    v_mfma_f32_16x16x32_bf16 v[84:87], v[236:239], v[24:27], v[84:87]
    ds_read_b128 v[24:27], v3 offset:21504
    s_waitcnt vmcnt(6) lgkmcnt(6)
    v_mfma_f32_16x16x32_bf16 v[48:51], v[160:163], v[28:31], v[48:51]
    v_mfma_f32_16x16x32_bf16 v[52:55], v[240:243], v[28:31], v[52:55]
    ds_read_b128 v[28:31], v3 offset:41984
    s_waitcnt lgkmcnt(6)
    v_mfma_f32_16x16x32_bf16 v[56:59], v[160:163], v[32:35], v[56:59]
    v_mfma_f32_16x16x32_bf16 v[60:63], v[240:243], v[32:35], v[60:63]
    ds_read_b128 v[32:35], v3 offset:62464
    s_waitcnt lgkmcnt(6)
    v_mfma_f32_16x16x32_bf16 v[64:67], v[160:163], v[36:39], v[64:67]
    v_mfma_f32_16x16x32_bf16 v[68:71], v[240:243], v[36:39], v[68:71]
    v_add_u32 v6, 81920, v3
    ds_read_b128 v[36:39], v6 offset:1024
    s_waitcnt lgkmcnt(6)
    v_mfma_f32_16x16x32_bf16 v[72:75], v[160:163], v[40:43], v[72:75]
    v_mfma_f32_16x16x32_bf16 v[76:79], v[240:243], v[40:43], v[76:79]
    ds_read_b128 v[40:43], v4 offset:1024
    s_waitcnt lgkmcnt(6)
    v_mfma_f32_16x16x32_bf16 v[80:83], v[160:163], v[16:19], v[80:83]
    v_mfma_f32_16x16x32_bf16 v[84:87], v[240:243], v[16:19], v[84:87]
    ds_read_b128 v[16:19], v4 offset:21504
    s_waitcnt vmcnt(4) lgkmcnt(6)
    v_mfma_f32_16x16x32_bf16 v[48:51], v[164:167], v[20:23], v[48:51]
    v_mfma_f32_16x16x32_bf16 v[52:55], v[244:247], v[20:23], v[52:55]
    ds_read_b128 v[20:23], v4 offset:41984
    s_waitcnt lgkmcnt(6)
    v_mfma_f32_16x16x32_bf16 v[56:59], v[164:167], v[24:27], v[56:59]
    v_mfma_f32_16x16x32_bf16 v[60:63], v[244:247], v[24:27], v[60:63]
    ds_read_b128 v[24:27], v4 offset:62464
    s_waitcnt lgkmcnt(6)
    v_mfma_f32_16x16x32_bf16 v[64:67], v[164:167], v[28:31], v[64:67]
    v_mfma_f32_16x16x32_bf16 v[68:71], v[244:247], v[28:31], v[68:71]
    v_add_u32 v6, 81920, v4
    ds_read_b128 v[28:31], v6 offset:1024
    s_waitcnt lgkmcnt(6)
    v_mfma_f32_16x16x32_bf16 v[72:75], v[164:167], v[32:35], v[72:75]
    v_mfma_f32_16x16x32_bf16 v[76:79], v[244:247], v[32:35], v[76:79]
    ds_read_b128 v[32:35], v5 offset:1024
    s_waitcnt lgkmcnt(6)
    v_mfma_f32_16x16x32_bf16 v[80:83], v[164:167], v[36:39], v[80:83]
    v_mfma_f32_16x16x32_bf16 v[84:87], v[244:247], v[36:39], v[84:87]
    ds_read_b128 v[36:39], v5 offset:21504
    s_waitcnt vmcnt(2) lgkmcnt(6)
    v_mfma_f32_16x16x32_bf16 v[48:51], v[168:171], v[40:43], v[48:51]
    v_mfma_f32_16x16x32_bf16 v[52:55], v[248:251], v[40:43], v[52:55]
    ds_read_b128 v[40:43], v5 offset:41984
    s_waitcnt lgkmcnt(6)
    v_mfma_f32_16x16x32_bf16 v[56:59], v[168:171], v[16:19], v[56:59]
    v_mfma_f32_16x16x32_bf16 v[60:63], v[248:251], v[16:19], v[60:63]
    ds_read_b128 v[16:19], v5 offset:62464
    s_waitcnt lgkmcnt(6)
    v_mfma_f32_16x16x32_bf16 v[64:67], v[168:171], v[20:23], v[64:67]
    v_mfma_f32_16x16x32_bf16 v[68:71], v[248:251], v[20:23], v[68:71]
    v_add_u32 v6, 81920, v5
    ds_read_b128 v[20:23], v6 offset:1024
    s_waitcnt lgkmcnt(6)
    v_mfma_f32_16x16x32_bf16 v[72:75], v[168:171], v[24:27], v[72:75]
    v_mfma_f32_16x16x32_bf16 v[76:79], v[248:251], v[24:27], v[76:79]
    s_waitcnt lgkmcnt(5)
    v_mfma_f32_16x16x32_bf16 v[80:83], v[168:171], v[28:31], v[80:83]
    v_mfma_f32_16x16x32_bf16 v[84:87], v[248:251], v[28:31], v[84:87]
    s_waitcnt vmcnt(0) lgkmcnt(4)
    v_mfma_f32_16x16x32_bf16 v[48:51], v[172:175], v[32:35], v[48:51]
    v_mfma_f32_16x16x32_bf16 v[52:55], v[252:255], v[32:35], v[52:55]
    s_waitcnt lgkmcnt(3)
    v_mfma_f32_16x16x32_bf16 v[56:59], v[172:175], v[36:39], v[56:59]
    v_mfma_f32_16x16x32_bf16 v[60:63], v[252:255], v[36:39], v[60:63]
    s_waitcnt lgkmcnt(2)
    v_mfma_f32_16x16x32_bf16 v[64:67], v[172:175], v[40:43], v[64:67]
    v_mfma_f32_16x16x32_bf16 v[68:71], v[252:255], v[40:43], v[68:71]
    s_waitcnt lgkmcnt(1)
    v_mfma_f32_16x16x32_bf16 v[72:75], v[172:175], v[16:19], v[72:75]
    v_mfma_f32_16x16x32_bf16 v[76:79], v[252:255], v[16:19], v[76:79]
    s_waitcnt lgkmcnt(0)
    v_mfma_f32_16x16x32_bf16 v[80:83], v[172:175], v[20:23], v[80:83]
    v_mfma_f32_16x16x32_bf16 v[84:87], v[252:255], v[20:23], v[84:87]
    ds_read_b64_tr_b16 v[10:11], v7
    ds_read_b64_tr_b16 v[12:13], v8
    ds_read_b64_tr_b16 v[14:15], v9
    v_and_b32 v16, 15, v1
    v_lshrrev_b32 v17, 4, v1
    s_lshl_b32 s42, s3, 7
    s_add_u32 s42, s42, 46016
    v_lshl_add_u32 v19, v17, 4, s42
    s_mov_b64 exec, 0x10001
    s_mov_b32 exec_hi, 0x10001
    ds_write_b128 v19, v[48:51] offset:0
    ds_write_b128 v19, v[52:55] offset:64
    s_mov_b64 exec, -1
    s_lshl_b32 s42, s3, 6
    s_cmp_eq_u32 s3, 2
    s_cselect_b32 s42, 192, s42
    s_cmp_eq_u32 s3, 3
    s_cselect_b32 s42, 128, s42
    s_add_u32 s42, s42, 61440
    v_mul_u32_u24 v20, 496, v16
    v_lshl_add_u32 v20, v17, 4, v20
    v_add_u32 v20, s42, v20
    v_lshlrev_b32 v18, 3, v16
    v_add_u32 v18, 45376, v18
    s_waitcnt lgkmcnt(0)
    s_barrier
    ds_read_b64 v[24:25], v18 offset:0
    ds_read_b64 v[26:27], v18 offset:128
    ds_read_b64 v[28:29], v18 offset:256
    ds_read_b64 v[30:31], v18 offset:384
    ds_read_b64 v[32:33], v18 offset:512
    ds_read_b128 v[36:39], v19 offset:0
    ds_read_b128 v[40:43], v19 offset:64
    s_waitcnt lgkmcnt(0)
    v_fma_f32 v48, -v24, v36, v48
    v_fma_f32 v49, -v24, v37, v49
    v_fma_f32 v50, -v24, v38, v50
    v_fma_f32 v51, -v24, v39, v51
    v_fma_f32 v52, -v24, v40, v52
    v_fma_f32 v53, -v24, v41, v53
    v_fma_f32 v54, -v24, v42, v54
    v_fma_f32 v55, -v24, v43, v55
    v_fma_f32 v56, -v26, v36, v56
    v_fma_f32 v57, -v26, v37, v57
    v_fma_f32 v58, -v26, v38, v58
    v_fma_f32 v59, -v26, v39, v59
    v_fma_f32 v60, -v26, v40, v60
    v_fma_f32 v61, -v26, v41, v61
    v_fma_f32 v62, -v26, v42, v62
    v_fma_f32 v63, -v26, v43, v63
    v_fma_f32 v64, -v28, v36, v64
    v_fma_f32 v65, -v28, v37, v65
    v_fma_f32 v66, -v28, v38, v66
    v_fma_f32 v67, -v28, v39, v67
    v_fma_f32 v68, -v28, v40, v68
    v_fma_f32 v69, -v28, v41, v69
    v_fma_f32 v70, -v28, v42, v70
    v_fma_f32 v71, -v28, v43, v71
    v_fma_f32 v72, -v30, v36, v72
    v_fma_f32 v73, -v30, v37, v73
    v_fma_f32 v74, -v30, v38, v74
    v_fma_f32 v75, -v30, v39, v75
    v_fma_f32 v76, -v30, v40, v76
    v_fma_f32 v77, -v30, v41, v77
    v_fma_f32 v78, -v30, v42, v78
    v_fma_f32 v79, -v30, v43, v79
    v_fma_f32 v80, -v32, v36, v80
    v_fma_f32 v81, -v32, v37, v81
    v_fma_f32 v82, -v32, v38, v82
    v_fma_f32 v83, -v32, v39, v83
    v_fma_f32 v84, -v32, v40, v84
    v_fma_f32 v85, -v32, v41, v85
    v_fma_f32 v86, -v32, v42, v86
    v_fma_f32 v87, -v32, v43, v87
    v_mul_f32 v48, v48, v25
    v_mul_f32 v49, v49, v25
    v_mul_f32 v50, v50, v25
    v_mul_f32 v51, v51, v25
    v_mul_f32 v52, v52, v25
    v_mul_f32 v53, v53, v25
    v_mul_f32 v54, v54, v25
    v_mul_f32 v55, v55, v25
    v_mul_f32 v56, v56, v27
    v_mul_f32 v57, v57, v27
    v_mul_f32 v58, v58, v27
    v_mul_f32 v59, v59, v27
    v_mul_f32 v60, v60, v27
    v_mul_f32 v61, v61, v27
    v_mul_f32 v62, v62, v27
    v_mul_f32 v63, v63, v27
    v_mul_f32 v64, v64, v29
    v_mul_f32 v65, v65, v29
    v_mul_f32 v66, v66, v29
    v_mul_f32 v67, v67, v29
    v_mul_f32 v68, v68, v29
    v_mul_f32 v69, v69, v29
    v_mul_f32 v70, v70, v29
    v_mul_f32 v71, v71, v29
    v_mul_f32 v72, v72, v31
    v_mul_f32 v73, v73, v31
    v_mul_f32 v74, v74, v31
    v_mul_f32 v75, v75, v31
    v_mul_f32 v76, v76, v31
    v_mul_f32 v77, v77, v31
    v_mul_f32 v78, v78, v31
    v_mul_f32 v79, v79, v31
    v_mul_f32 v80, v80, v33
    v_mul_f32 v81, v81, v33
    v_mul_f32 v82, v82, v33
    v_mul_f32 v83, v83, v33
    v_mul_f32 v84, v84, v33
    v_mul_f32 v85, v85, v33
    v_mul_f32 v86, v86, v33
    v_mul_f32 v87, v87, v33
    v_cvt_pk_bf16_f32 v48, v48, v52
    v_cvt_pk_bf16_f32 v49, v49, v53
    v_cvt_pk_bf16_f32 v50, v50, v54
    v_cvt_pk_bf16_f32 v51, v51, v55
    ds_write_b128 v20, v[48:51] offset:0
    v_cvt_pk_bf16_f32 v56, v56, v60
    v_cvt_pk_bf16_f32 v57, v57, v61
    v_cvt_pk_bf16_f32 v58, v58, v62
    v_cvt_pk_bf16_f32 v59, v59, v63
    ds_write_b128 v20, v[56:59] offset:7936
    v_cvt_pk_bf16_f32 v64, v64, v68
    v_cvt_pk_bf16_f32 v65, v65, v69
    v_cvt_pk_bf16_f32 v66, v66, v70
    v_cvt_pk_bf16_f32 v67, v67, v71
    ds_write_b128 v20, v[64:67] offset:15872
    v_cvt_pk_bf16_f32 v72, v72, v76
    v_cvt_pk_bf16_f32 v73, v73, v77
    v_cvt_pk_bf16_f32 v74, v74, v78
    v_cvt_pk_bf16_f32 v75, v75, v79
    ds_write_b128 v20, v[72:75] offset:23808
    v_cvt_pk_bf16_f32 v80, v80, v84
    v_cvt_pk_bf16_f32 v81, v81, v85
    v_cvt_pk_bf16_f32 v82, v82, v86
    v_cvt_pk_bf16_f32 v83, v83, v87
    ds_write_b128 v20, v[80:83] offset:31744
    s_branch L_a1_post
L_g1A:
    global_load_dwordx4 v[96:99], v44, s[48:49] sc1
    global_load_dwordx4 v[176:179], v44, s[50:51] sc1
    global_load_dwordx4 v[100:103], v45, s[48:49] sc1
    global_load_dwordx4 v[180:183], v45, s[50:51] sc1
    global_load_dwordx4 v[104:107], v46, s[48:49] sc1
    global_load_dwordx4 v[184:187], v46, s[50:51] sc1
    global_load_dwordx4 v[108:111], v47, s[48:49] sc1
    global_load_dwordx4 v[188:191], v47, s[50:51] sc1
    s_add_u32 s48, s48, 4096
    s_addc_u32 s49, s49, 0
    s_add_u32 s50, s50, 4096
    s_addc_u32 s51, s51, 0
    s_waitcnt lgkmcnt(0)
    s_barrier
    global_load_dwordx4 v[112:115], v44, s[48:49] sc1
    global_load_dwordx4 v[192:195], v44, s[50:51] sc1
    global_load_dwordx4 v[116:119], v45, s[48:49] sc1
    global_load_dwordx4 v[196:199], v45, s[50:51] sc1
    global_load_dwordx4 v[120:123], v46, s[48:49] sc1
    global_load_dwordx4 v[200:203], v46, s[50:51] sc1
    global_load_dwordx4 v[124:127], v47, s[48:49] sc1
    global_load_dwordx4 v[204:207], v47, s[50:51] sc1
    s_add_u32 s48, s48, 4096
    s_addc_u32 s49, s49, 0
    s_add_u32 s50, s50, 4096
    s_addc_u32 s51, s51, 0
    ds_read_b128 v[16:19], v2 offset:0
    ds_read_b128 v[20:23], v2 offset:20480
    ds_read_b128 v[24:27], v2 offset:40960
    ds_read_b128 v[28:31], v2 offset:61440
    v_add_u32 v6, 81920, v2
    ds_read_b128 v[32:35], v6 offset:0
    ds_read_b128 v[36:39], v3 offset:0
    global_load_dwordx4 v[128:131], v44, s[48:49] sc1
    global_load_dwordx4 v[208:211], v44, s[50:51] sc1
    ds_read_b128 v[40:43], v3 offset:20480
    s_waitcnt vmcnt(16) lgkmcnt(6)
    v_mfma_f32_16x16x32_bf16 v[48:51], v[96:99], v[16:19], 0
    v_mfma_f32_16x16x32_bf16 v[52:55], v[176:179], v[16:19], 0
    ds_read_b128 v[16:19], v3 offset:40960
    s_waitcnt lgkmcnt(6)
    v_mfma_f32_16x16x32_bf16 v[56:59], v[96:99], v[20:23], 0
    v_mfma_f32_16x16x32_bf16 v[60:63], v[176:179], v[20:23], 0
    v_mfma_f32_16x16x32_bf16 v[64:67], v[20:23], v[20:23], 0
    v_mfma_f32_16x16x32_bf16 v[68:71], v[10:13], v[20:23], 0
    ds_read_b128 v[20:23], v3 offset:61440
    s_waitcnt lgkmcnt(6)
    v_mfma_f32_16x16x32_bf16 v[72:75], v[96:99], v[24:27], 0
    v_mfma_f32_16x16x32_bf16 v[76:79], v[176:179], v[24:27], 0
    v_add_u32 v6, 81920, v3
    ds_read_b128 v[24:27], v6 offset:0
    s_waitcnt lgkmcnt(6)
    v_mfma_f32_16x16x32_bf16 v[80:83], v[96:99], v[28:31], 0
    v_mfma_f32_16x16x32_bf16 v[84:87], v[176:179], v[28:31], 0
    ds_read_b128 v[28:31], v4 offset:0
    s_waitcnt lgkmcnt(6)
    v_mfma_f32_16x16x32_bf16 v[88:91], v[96:99], v[32:35], 0
    v_mfma_f32_16x16x32_bf16 v[92:95], v[176:179], v[32:35], 0
    global_load_dwordx4 v[132:135], v45, s[48:49] sc1
    global_load_dwordx4 v[212:215], v45, s[50:51] sc1
    ds_read_b128 v[32:35], v4 offset:20480
    s_waitcnt vmcnt(16) lgkmcnt(6)
    v_mfma_f32_16x16x32_bf16 v[48:51], v[100:103], v[36:39], v[48:51]
    v_mfma_f32_16x16x32_bf16 v[52:55], v[180:183], v[36:39], v[52:55]
    ds_read_b128 v[36:39], v4 offset:40960
    s_waitcnt lgkmcnt(6)
    v_mfma_f32_16x16x32_bf16 v[56:59], v[100:103], v[40:43], v[56:59]
    v_mfma_f32_16x16x32_bf16 v[60:63], v[180:183], v[40:43], v[60:63]
    v_mfma_f32_16x16x32_bf16 v[64:67], v[40:43], v[40:43], v[64:67]
    v_mfma_f32_16x16x32_bf16 v[68:71], v[10:13], v[40:43], v[68:71]
    ds_read_b128 v[40:43], v4 offset:61440
    s_waitcnt lgkmcnt(6)
    v_mfma_f32_16x16x32_bf16 v[72:75], v[100:103], v[16:19], v[72:75]
    v_mfma_f32_16x16x32_bf16 v[76:79], v[180:183], v[16:19], v[76:79]
    v_add_u32 v6, 81920, v4
    ds_read_b128 v[16:19], v6 offset:0
    s_waitcnt lgkmcnt(6)
    v_mfma_f32_16x16x32_bf16 v[80:83], v[100:103], v[20:23], v[80:83]
    v_mfma_f32_16x16x32_bf16 v[84:87], v[180:183], v[20:23], v[84:87]
    ds_read_b128 v[20:23], v5 offset:0
    s_waitcnt lgkmcnt(6)
    v_mfma_f32_16x16x32_bf16 v[88:91], v[100:103], v[24:27], v[88:91]
    v_mfma_f32_16x16x32_bf16 v[92:95], v[180:183], v[24:27], v[92:95]
    global_load_dwordx4 v[136:139], v46, s[48:49] sc1
    global_load_dwordx4 v[216:219], v46, s[50:51] sc1
    ds_read_b128 v[24:27], v5 offset:20480
    s_waitcnt vmcnt(16) lgkmcnt(6)
    v_mfma_f32_16x16x32_bf16 v[48:51], v[104:107], v[28:31], v[48:51]
    v_mfma_f32_16x16x32_bf16 v[52:55], v[184:187], v[28:31], v[52:55]
    ds_read_b128 v[28:31], v5 offset:40960
    s_waitcnt lgkmcnt(6)
    v_mfma_f32_16x16x32_bf16 v[56:59], v[104:107], v[32:35], v[56:59]
    v_mfma_f32_16x16x32_bf16 v[60:63], v[184:187], v[32:35], v[60:63]
    v_mfma_f32_16x16x32_bf16 v[64:67], v[32:35], v[32:35], v[64:67]
    v_mfma_f32_16x16x32_bf16 v[68:71], v[10:13], v[32:35], v[68:71]
    ds_read_b128 v[32:35], v5 offset:61440
    s_waitcnt lgkmcnt(6)
    v_mfma_f32_16x16x32_bf16 v[72:75], v[104:107], v[36:39], v[72:75]
    v_mfma_f32_16x16x32_bf16 v[76:79], v[184:187], v[36:39], v[76:79]
    v_add_u32 v6, 81920, v5
    ds_read_b128 v[36:39], v6 offset:0
    s_waitcnt lgkmcnt(6)
    v_mfma_f32_16x16x32_bf16 v[80:83], v[104:107], v[40:43], v[80:83]
    v_mfma_f32_16x16x32_bf16 v[84:87], v[184:187], v[40:43], v[84:87]
    ds_read_b128 v[40:43], v2 offset:256
    s_waitcnt lgkmcnt(6)
    v_mfma_f32_16x16x32_bf16 v[88:91], v[104:107], v[16:19], v[88:91]
    v_mfma_f32_16x16x32_bf16 v[92:95], v[184:187], v[16:19], v[92:95]
    global_load_dwordx4 v[140:143], v47, s[48:49] sc1
    global_load_dwordx4 v[220:223], v47, s[50:51] sc1
    s_add_u32 s48, s48, 4096
    s_addc_u32 s49, s49, 0
    s_add_u32 s50, s50, 4096
    s_addc_u32 s51, s51, 0
    ds_read_b128 v[16:19], v2 offset:20736
    s_waitcnt vmcnt(16) lgkmcnt(6)
    v_mfma_f32_16x16x32_bf16 v[48:51], v[108:111], v[20:23], v[48:51]
    v_mfma_f32_16x16x32_bf16 v[52:55], v[188:191], v[20:23], v[52:55]
    ds_read_b128 v[20:23], v2 offset:41216
    s_waitcnt lgkmcnt(6)
    v_mfma_f32_16x16x32_bf16 v[56:59], v[108:111], v[24:27], v[56:59]
    v_mfma_f32_16x16x32_bf16 v[60:63], v[188:191], v[24:27], v[60:63]
    v_mfma_f32_16x16x32_bf16 v[64:67], v[24:27], v[24:27], v[64:67]
    v_mfma_f32_16x16x32_bf16 v[68:71], v[10:13], v[24:27], v[68:71]
    ds_read_b128 v[24:27], v2 offset:61696
    s_waitcnt lgkmcnt(6)
    v_mfma_f32_16x16x32_bf16 v[72:75], v[108:111], v[28:31], v[72:75]
    v_mfma_f32_16x16x32_bf16 v[76:79], v[188:191], v[28:31], v[76:79]
    v_add_u32 v6, 81920, v2
    ds_read_b128 v[28:31], v6 offset:256
    s_waitcnt lgkmcnt(6)
    v_mfma_f32_16x16x32_bf16 v[80:83], v[108:111], v[32:35], v[80:83]
    v_mfma_f32_16x16x32_bf16 v[84:87], v[188:191], v[32:35], v[84:87]
    ds_read_b128 v[32:35], v3 offset:256
    s_waitcnt lgkmcnt(6)
    v_mfma_f32_16x16x32_bf16 v[88:91], v[108:111], v[36:39], v[88:91]
    v_mfma_f32_16x16x32_bf16 v[92:95], v[188:191], v[36:39], v[92:95]
    global_load_dwordx4 v[144:147], v44, s[48:49] sc1
    global_load_dwordx4 v[224:227], v44, s[50:51] sc1
    ds_read_b128 v[36:39], v3 offset:20736
    s_waitcnt vmcnt(16) lgkmcnt(6)
    v_mfma_f32_16x16x32_bf16 v[48:51], v[112:115], v[40:43], v[48:51]
    v_mfma_f32_16x16x32_bf16 v[52:55], v[192:195], v[40:43], v[52:55]
    ds_read_b128 v[40:43], v3 offset:41216
    s_waitcnt lgkmcnt(6)
    v_mfma_f32_16x16x32_bf16 v[56:59], v[112:115], v[16:19], v[56:59]
    v_mfma_f32_16x16x32_bf16 v[60:63], v[192:195], v[16:19], v[60:63]
    v_mfma_f32_16x16x32_bf16 v[64:67], v[16:19], v[16:19], v[64:67]
    v_mfma_f32_16x16x32_bf16 v[68:71], v[10:13], v[16:19], v[68:71]
    ds_read_b128 v[16:19], v3 offset:61696
    s_waitcnt lgkmcnt(6)
    v_mfma_f32_16x16x32_bf16 v[72:75], v[112:115], v[20:23], v[72:75]
    v_mfma_f32_16x16x32_bf16 v[76:79], v[192:195], v[20:23], v[76:79]
    v_add_u32 v6, 81920, v3
    ds_read_b128 v[20:23], v6 offset:256
    s_waitcnt lgkmcnt(6)
    v_mfma_f32_16x16x32_bf16 v[80:83], v[112:115], v[24:27], v[80:83]
    v_mfma_f32_16x16x32_bf16 v[84:87], v[192:195], v[24:27], v[84:87]
    ds_read_b128 v[24:27], v4 offset:256
    s_waitcnt lgkmcnt(6)
    v_mfma_f32_16x16x32_bf16 v[88:91], v[112:115], v[28:31], v[88:91]
    v_mfma_f32_16x16x32_bf16 v[92:95], v[192:195], v[28:31], v[92:95]
    global_load_dwordx4 v[148:151], v45, s[48:49] sc1
    global_load_dwordx4 v[228:231], v45, s[50:51] sc1
    ds_read_b128 v[28:31], v4 offset:20736
    s_waitcnt vmcnt(16) lgkmcnt(6)
    v_mfma_f32_16x16x32_bf16 v[48:51], v[116:119], v[32:35], v[48:51]
    v_mfma_f32_16x16x32_bf16 v[52:55], v[196:199], v[32:35], v[52:55]
    ds_read_b128 v[32:35], v4 offset:41216
    s_waitcnt lgkmcnt(6)
    v_mfma_f32_16x16x32_bf16 v[56:59], v[116:119], v[36:39], v[56:59]
    v_mfma_f32_16x16x32_bf16 v[60:63], v[196:199], v[36:39], v[60:63]
    v_mfma_f32_16x16x32_bf16 v[64:67], v[36:39], v[36:39], v[64:67]
    v_mfma_f32_16x16x32_bf16 v[68:71], v[10:13], v[36:39], v[68:71]
    ds_read_b128 v[36:39], v4 offset:61696
    s_waitcnt lgkmcnt(6)
    v_mfma_f32_16x16x32_bf16 v[72:75], v[116:119], v[40:43], v[72:75]
    v_mfma_f32_16x16x32_bf16 v[76:79], v[196:199], v[40:43], v[76:79]
    v_add_u32 v6, 81920, v4
    ds_read_b128 v[40:43], v6 offset:256
    s_waitcnt lgkmcnt(6)
    v_mfma_f32_16x16x32_bf16 v[80:83], v[116:119], v[16:19], v[80:83]
    v_mfma_f32_16x16x32_bf16 v[84:87], v[196:199], v[16:19], v[84:87]
    ds_read_b128 v[16:19], v5 offset:256
    s_waitcnt lgkmcnt(6)
    v_mfma_f32_16x16x32_bf16 v[88:91], v[116:119], v[20:23], v[88:91]
    v_mfma_f32_16x16x32_bf16 v[92:95], v[196:199], v[20:23], v[92:95]
    global_load_dwordx4 v[152:155], v46, s[48:49] sc1
    global_load_dwordx4 v[232:235], v46, s[50:51] sc1
    ds_read_b128 v[20:23], v5 offset:20736
    s_waitcnt vmcnt(16) lgkmcnt(6)
    v_mfma_f32_16x16x32_bf16 v[48:51], v[120:123], v[24:27], v[48:51]
    v_mfma_f32_16x16x32_bf16 v[52:55], v[200:203], v[24:27], v[52:55]
    ds_read_b128 v[24:27], v5 offset:41216
    s_waitcnt lgkmcnt(6)
    v_mfma_f32_16x16x32_bf16 v[56:59], v[120:123], v[28:31], v[56:59]
    v_mfma_f32_16x16x32_bf16 v[60:63], v[200:203], v[28:31], v[60:63]
    v_mfma_f32_16x16x32_bf16 v[64:67], v[28:31], v[28:31], v[64:67]
    v_mfma_f32_16x16x32_bf16 v[68:71], v[10:13], v[28:31], v[68:71]
    ds_read_b128 v[28:31], v5 offset:61696
    s_waitcnt lgkmcnt(6)
    v_mfma_f32_16x16x32_bf16 v[72:75], v[120:123], v[32:35], v[72:75]
    v_mfma_f32_16x16x32_bf16 v[76:79], v[200:203], v[32:35], v[76:79]
    v_add_u32 v6, 81920, v5
    ds_read_b128 v[32:35], v6 offset:256
    s_waitcnt lgkmcnt(6)
    v_mfma_f32_16x16x32_bf16 v[80:83], v[120:123], v[36:39], v[80:83]
    v_mfma_f32_16x16x32_bf16 v[84:87], v[200:203], v[36:39], v[84:87]
    ds_read_b128 v[36:39], v2 offset:512
    s_waitcnt lgkmcnt(6)
    v_mfma_f32_16x16x32_bf16 v[88:91], v[120:123], v[40:43], v[88:91]
    v_mfma_f32_16x16x32_bf16 v[92:95], v[200:203], v[40:43], v[92:95]
    global_load_dwordx4 v[156:159], v47, s[48:49] sc1
    global_load_dwordx4 v[236:239], v47, s[50:51] sc1
    s_add_u32 s48, s48, 4096
    s_addc_u32 s49, s49, 0
    s_add_u32 s50, s50, 4096
    s_addc_u32 s51, s51, 0
    ds_read_b128 v[40:43], v2 offset:20992
    s_waitcnt vmcnt(16) lgkmcnt(6)
    v_mfma_f32_16x16x32_bf16 v[48:51], v[124:127], v[16:19], v[48:51]
    v_mfma_f32_16x16x32_bf16 v[52:55], v[204:207], v[16:19], v[52:55]
    ds_read_b128 v[16:19], v2 offset:41472
    s_waitcnt lgkmcnt(6)
    v_mfma_f32_16x16x32_bf16 v[56:59], v[124:127], v[20:23], v[56:59]
    v_mfma_f32_16x16x32_bf16 v[60:63], v[204:207], v[20:23], v[60:63]
    v_mfma_f32_16x16x32_bf16 v[64:67], v[20:23], v[20:23], v[64:67]
    v_mfma_f32_16x16x32_bf16 v[68:71], v[10:13], v[20:23], v[68:71]
    ds_read_b128 v[20:23], v2 offset:61952
    s_waitcnt lgkmcnt(6)
    v_mfma_f32_16x16x32_bf16 v[72:75], v[124:127], v[24:27], v[72:75]
    v_mfma_f32_16x16x32_bf16 v[76:79], v[204:207], v[24:27], v[76:79]
    v_add_u32 v6, 81920, v2
    ds_read_b128 v[24:27], v6 offset:512
    s_waitcnt lgkmcnt(6)
    v_mfma_f32_16x16x32_bf16 v[80:83], v[124:127], v[28:31], v[80:83]
    v_mfma_f32_16x16x32_bf16 v[84:87], v[204:207], v[28:31], v[84:87]
    ds_read_b128 v[28:31], v3 offset:512
    s_waitcnt lgkmcnt(6)
    v_mfma_f32_16x16x32_bf16 v[88:91], v[124:127], v[32:35], v[88:91]
    v_mfma_f32_16x16x32_bf16 v[92:95], v[204:207], v[32:35], v[92:95]
    global_load_dwordx4 v[160:163], v44, s[48:49] sc1
    global_load_dwordx4 v[240:243], v44, s[50:51] sc1
    ds_read_b128 v[32:35], v3 offset:20992
    s_waitcnt vmcnt(16) lgkmcnt(6)
    v_mfma_f32_16x16x32_bf16 v[48:51], v[128:131], v[36:39], v[48:51]
    v_mfma_f32_16x16x32_bf16 v[52:55], v[208:211], v[36:39], v[52:55]
    ds_read_b128 v[36:39], v3 offset:41472
    s_waitcnt lgkmcnt(6)
    v_mfma_f32_16x16x32_bf16 v[56:59], v[128:131], v[40:43], v[56:59]
    v_mfma_f32_16x16x32_bf16 v[60:63], v[208:211], v[40:43], v[60:63]
    v_mfma_f32_16x16x32_bf16 v[64:67], v[40:43], v[40:43], v[64:67]
    v_mfma_f32_16x16x32_bf16 v[68:71], v[10:13], v[40:43], v[68:71]
    ds_read_b128 v[40:43], v3 offset:61952
    s_waitcnt lgkmcnt(6)
    v_mfma_f32_16x16x32_bf16 v[72:75], v[128:131], v[16:19], v[72:75]
    v_mfma_f32_16x16x32_bf16 v[76:79], v[208:211], v[16:19], v[76:79]
    v_add_u32 v6, 81920, v3
    ds_read_b128 v[16:19], v6 offset:512
    s_waitcnt lgkmcnt(6)
    v_mfma_f32_16x16x32_bf16 v[80:83], v[128:131], v[20:23], v[80:83]
    v_mfma_f32_16x16x32_bf16 v[84:87], v[208:211], v[20:23], v[84:87]
    ds_read_b128 v[20:23], v4 offset:512
    s_waitcnt lgkmcnt(6)
    v_mfma_f32_16x16x32_bf16 v[88:91], v[128:131], v[24:27], v[88:91]
    v_mfma_f32_16x16x32_bf16 v[92:95], v[208:211], v[24:27], v[92:95]
    global_load_dwordx4 v[164:167], v45, s[48:49] sc1
    global_load_dwordx4 v[244:247], v45, s[50:51] sc1
    ds_read_b128 v[24:27], v4 offset:20992
    s_waitcnt vmcnt(16) lgkmcnt(6)
    v_mfma_f32_16x16x32_bf16 v[48:51], v[132:135], v[28:31], v[48:51]
    v_mfma_f32_16x16x32_bf16 v[52:55], v[212:215], v[28:31], v[52:55]
    ds_read_b128 v[28:31], v4 offset:41472
    s_waitcnt lgkmcnt(6)
    v_mfma_f32_16x16x32_bf16 v[56:59], v[132:135], v[32:35], v[56:59]
    v_mfma_f32_16x16x32_bf16 v[60:63], v[212:215], v[32:35], v[60:63]
    v_mfma_f32_16x16x32_bf16 v[64:67], v[32:35], v[32:35], v[64:67]
    v_mfma_f32_16x16x32_bf16 v[68:71], v[10:13], v[32:35], v[68:71]
    ds_read_b128 v[32:35], v4 offset:61952
    s_waitcnt lgkmcnt(6)
    v_mfma_f32_16x16x32_bf16 v[72:75], v[132:135], v[36:39], v[72:75]
    v_mfma_f32_16x16x32_bf16 v[76:79], v[212:215], v[36:39], v[76:79]
    v_add_u32 v6, 81920, v4
    ds_read_b128 v[36:39], v6 offset:512
    s_waitcnt lgkmcnt(6)
    v_mfma_f32_16x16x32_bf16 v[80:83], v[132:135], v[40:43], v[80:83]
    v_mfma_f32_16x16x32_bf16 v[84:87], v[212:215], v[40:43], v[84:87]
    ds_read_b128 v[40:43], v5 offset:512
    s_waitcnt lgkmcnt(6)
    v_mfma_f32_16x16x32_bf16 v[88:91], v[132:135], v[16:19], v[88:91]
    v_mfma_f32_16x16x32_bf16 v[92:95], v[212:215], v[16:19], v[92:95]
    global_load_dwordx4 v[168:171], v46, s[48:49] sc1
    global_load_dwordx4 v[248:251], v46, s[50:51] sc1
    ds_read_b128 v[16:19], v5 offset:20992
    s_waitcnt vmcnt(16) lgkmcnt(6)
    v_mfma_f32_16x16x32_bf16 v[48:51], v[136:139], v[20:23], v[48:51]
    v_mfma_f32_16x16x32_bf16 v[52:55], v[216:219], v[20:23], v[52:55]
    ds_read_b128 v[20:23], v5 offset:41472
    s_waitcnt lgkmcnt(6)
    v_mfma_f32_16x16x32_bf16 v[56:59], v[136:139], v[24:27], v[56:59]
    v_mfma_f32_16x16x32_bf16 v[60:63], v[216:219], v[24:27], v[60:63]
    v_mfma_f32_16x16x32_bf16 v[64:67], v[24:27], v[24:27], v[64:67]
    v_mfma_f32_16x16x32_bf16 v[68:71], v[10:13], v[24:27], v[68:71]
    ds_read_b128 v[24:27], v5 offset:61952
    s_waitcnt lgkmcnt(6)
    v_mfma_f32_16x16x32_bf16 v[72:75], v[136:139], v[28:31], v[72:75]
    v_mfma_f32_16x16x32_bf16 v[76:79], v[216:219], v[28:31], v[76:79]
    v_add_u32 v6, 81920, v5
    ds_read_b128 v[28:31], v6 offset:512
    s_waitcnt lgkmcnt(6)
    v_mfma_f32_16x16x32_bf16 v[80:83], v[136:139], v[32:35], v[80:83]
    v_mfma_f32_16x16x32_bf16 v[84:87], v[216:219], v[32:35], v[84:87]
    ds_read_b128 v[32:35], v2 offset:768
    s_waitcnt lgkmcnt(6)
    v_mfma_f32_16x16x32_bf16 v[88:91], v[136:139], v[36:39], v[88:91]
    v_mfma_f32_16x16x32_bf16 v[92:95], v[216:219], v[36:39], v[92:95]
    global_load_dwordx4 v[172:175], v47, s[48:49] sc1
    global_load_dwordx4 v[252:255], v47, s[50:51] sc1
    ds_read_b128 v[36:39], v2 offset:21248
    s_waitcnt vmcnt(16) lgkmcnt(6)
    v_mfma_f32_16x16x32_bf16 v[48:51], v[140:143], v[40:43], v[48:51]
    v_mfma_f32_16x16x32_bf16 v[52:55], v[220:223], v[40:43], v[52:55]
    ds_read_b128 v[40:43], v2 offset:41728
    s_waitcnt lgkmcnt(6)
    v_mfma_f32_16x16x32_bf16 v[56:59], v[140:143], v[16:19], v[56:59]
    v_mfma_f32_16x16x32_bf16 v[60:63], v[220:223], v[16:19], v[60:63]
    v_mfma_f32_16x16x32_bf16 v[64:67], v[16:19], v[16:19], v[64:67]
    v_mfma_f32_16x16x32_bf16 v[68:71], v[10:13], v[16:19], v[68:71]
    ds_read_b128 v[16:19], v2 offset:62208
    s_waitcnt lgkmcnt(6)
    v_mfma_f32_16x16x32_bf16 v[72:75], v[140:143], v[20:23], v[72:75]
    v_mfma_f32_16x16x32_bf16 v[76:79], v[220:223], v[20:23], v[76:79]
    v_add_u32 v6, 81920, v2
    ds_read_b128 v[20:23], v6 offset:768
    s_waitcnt lgkmcnt(6)
    v_mfma_f32_16x16x32_bf16 v[80:83], v[140:143], v[24:27], v[80:83]
    v_mfma_f32_16x16x32_bf16 v[84:87], v[220:223], v[24:27], v[84:87]
    ds_read_b128 v[24:27], v3 offset:768
    s_waitcnt lgkmcnt(6)
    v_mfma_f32_16x16x32_bf16 v[88:91], v[140:143], v[28:31], v[88:91]
    v_mfma_f32_16x16x32_bf16 v[92:95], v[220:223], v[28:31], v[92:95]
    ds_read_b128 v[28:31], v3 offset:21248
    s_waitcnt vmcnt(14) lgkmcnt(6)
    v_mfma_f32_16x16x32_bf16 v[48:51], v[144:147], v[32:35], v[48:51]
    v_mfma_f32_16x16x32_bf16 v[52:55], v[224:227], v[32:35], v[52:55]
    ds_read_b128 v[32:35], v3 offset:41728
    s_waitcnt lgkmcnt(6)
    v_mfma_f32_16x16x32_bf16 v[56:59], v[144:147], v[36:39], v[56:59]
    v_mfma_f32_16x16x32_bf16 v[60:63], v[224:227], v[36:39], v[60:63]
    v_mfma_f32_16x16x32_bf16 v[64:67], v[36:39], v[36:39], v[64:67]
    v_mfma_f32_16x16x32_bf16 v[68:71], v[10:13], v[36:39], v[68:71]
    ds_read_b128 v[36:39], v3 offset:62208
    s_waitcnt lgkmcnt(6)
    v_mfma_f32_16x16x32_bf16 v[72:75], v[144:147], v[40:43], v[72:75]
    v_mfma_f32_16x16x32_bf16 v[76:79], v[224:227], v[40:43], v[76:79]
    v_add_u32 v6, 81920, v3
    ds_read_b128 v[40:43], v6 offset:768
    s_waitcnt lgkmcnt(6)
    v_mfma_f32_16x16x32_bf16 v[80:83], v[144:147], v[16:19], v[80:83]
    v_mfma_f32_16x16x32_bf16 v[84:87], v[224:227], v[16:19], v[84:87]
    ds_read_b128 v[16:19], v4 offset:768
    s_waitcnt lgkmcnt(6)
    v_mfma_f32_16x16x32_bf16 v[88:91], v[144:147], v[20:23], v[88:91]
    v_mfma_f32_16x16x32_bf16 v[92:95], v[224:227], v[20:23], v[92:95]
    ds_read_b128 v[20:23], v4 offset:21248
    s_waitcnt vmcnt(12) lgkmcnt(6)
    v_mfma_f32_16x16x32_bf16 v[48:51], v[148:151], v[24:27], v[48:51]
    v_mfma_f32_16x16x32_bf16 v[52:55], v[228:231], v[24:27], v[52:55]
    ds_read_b128 v[24:27], v4 offset:41728
    s_waitcnt lgkmcnt(6)
    v_mfma_f32_16x16x32_bf16 v[56:59], v[148:151], v[28:31], v[56:59]
    v_mfma_f32_16x16x32_bf16 v[60:63], v[228:231], v[28:31], v[60:63]
    v_mfma_f32_16x16x32_bf16 v[64:67], v[28:31], v[28:31], v[64:67]
    v_mfma_f32_16x16x32_bf16 v[68:71], v[10:13], v[28:31], v[68:71]
    ds_read_b128 v[28:31], v4 offset:62208
    s_waitcnt lgkmcnt(6)
    v_mfma_f32_16x16x32_bf16 v[72:75], v[148:151], v[32:35], v[72:75]
    v_mfma_f32_16x16x32_bf16 v[76:79], v[228:231], v[32:35], v[76:79]
    v_add_u32 v6, 81920, v4
    ds_read_b128 v[32:35], v6 offset:768
    s_waitcnt lgkmcnt(6)
    v_mfma_f32_16x16x32_bf16 v[80:83], v[148:151], v[36:39], v[80:83]
    v_mfma_f32_16x16x32_bf16 v[84:87], v[228:231], v[36:39], v[84:87]
    ds_read_b128 v[36:39], v5 offset:768
    s_waitcnt lgkmcnt(6)
    v_mfma_f32_16x16x32_bf16 v[88:91], v[148:151], v[40:43], v[88:91]
    v_mfma_f32_16x16x32_bf16 v[92:95], v[228:231], v[40:43], v[92:95]
    ds_read_b128 v[40:43], v5 offset:21248
    s_waitcnt vmcnt(10) lgkmcnt(6)
    v_mfma_f32_16x16x32_bf16 v[48:51], v[152:155], v[16:19], v[48:51]
    v_mfma_f32_16x16x32_bf16 v[52:55], v[232:235], v[16:19], v[52:55]
    ds_read_b128 v[16:19], v5 offset:41728
    s_waitcnt lgkmcnt(6)
    v_mfma_f32_16x16x32_bf16 v[56:59], v[152:155], v[20:23], v[56:59]
    v_mfma_f32_16x16x32_bf16 v[60:63], v[232:235], v[20:23], v[60:63]
    v_mfma_f32_16x16x32_bf16 v[64:67], v[20:23], v[20:23], v[64:67]
    v_mfma_f32_16x16x32_bf16 v[68:71], v[10:13], v[20:23], v[68:71]
    ds_read_b128 v[20:23], v5 offset:62208
    s_waitcnt lgkmcnt(6)
    v_mfma_f32_16x16x32_bf16 v[72:75], v[152:155], v[24:27], v[72:75]
    v_mfma_f32_16x16x32_bf16 v[76:79], v[232:235], v[24:27], v[76:79]
    v_add_u32 v6, 81920, v5
    ds_read_b128 v[24:27], v6 offset:768
    s_waitcnt lgkmcnt(6)
    v_mfma_f32_16x16x32_bf16 v[80:83], v[152:155], v[28:31], v[80:83]
    v_mfma_f32_16x16x32_bf16 v[84:87], v[232:235], v[28:31], v[84:87]
    ds_read_b128 v[28:31], v2 offset:1024
    s_waitcnt lgkmcnt(6)
    v_mfma_f32_16x16x32_bf16 v[88:91], v[152:155], v[32:35], v[88:91]
    v_mfma_f32_16x16x32_bf16 v[92:95], v[232:235], v[32:35], v[92:95]
    ds_read_b128 v[32:35], v2 offset:21504
    s_waitcnt vmcnt(8) lgkmcnt(6)
    v_mfma_f32_16x16x32_bf16 v[48:51], v[156:159], v[36:39], v[48:51]
    v_mfma_f32_16x16x32_bf16 v[52:55], v[236:239], v[36:39], v[52:55]
    ds_read_b128 v[36:39], v2 offset:41984
    s_waitcnt lgkmcnt(6)
    v_mfma_f32_16x16x32_bf16 v[56:59], v[156:159], v[40:43], v[56:59]
    v_mfma_f32_16x16x32_bf16 v[60:63], v[236:239], v[40:43], v[60:63]
    v_mfma_f32_16x16x32_bf16 v[64:67], v[40:43], v[40:43], v[64:67]
    v_mfma_f32_16x16x32_bf16 v[68:71], v[10:13], v[40:43], v[68:71]
    ds_read_b128 v[40:43], v2 offset:62464
    s_waitcnt lgkmcnt(6)
    v_mfma_f32_16x16x32_bf16 v[72:75], v[156:159], v[16:19], v[72:75]
    v_mfma_f32_16x16x32_bf16 v[76:79], v[236:239], v[16:19], v[76:79]
    v_add_u32 v6, 81920, v2
    ds_read_b128 v[16:19], v6 offset:1024
    s_waitcnt lgkmcnt(6)
    v_mfma_f32_16x16x32_bf16 v[80:83], v[156:159], v[20:23], v[80:83]
    v_mfma_f32_16x16x32_bf16 v[84:87], v[236:239], v[20:23], v[84:87]
    ds_read_b128 v[20:23], v3 offset:1024
    s_waitcnt lgkmcnt(6)
    v_mfma_f32_16x16x32_bf16 v[88:91], v[156:159], v[24:27], v[88:91]
    v_mfma_f32_16x16x32_bf16 v[92:95], v[236:239], v[24:27], v[92:95]
    ds_read_b128 v[24:27], v3 offset:21504
    s_waitcnt vmcnt(6) lgkmcnt(6)
    v_mfma_f32_16x16x32_bf16 v[48:51], v[160:163], v[28:31], v[48:51]
    v_mfma_f32_16x16x32_bf16 v[52:55], v[240:243], v[28:31], v[52:55]
    ds_read_b128 v[28:31], v3 offset:41984
    s_waitcnt lgkmcnt(6)
    v_mfma_f32_16x16x32_bf16 v[56:59], v[160:163], v[32:35], v[56:59]
    v_mfma_f32_16x16x32_bf16 v[60:63], v[240:243], v[32:35], v[60:63]
    v_mfma_f32_16x16x32_bf16 v[64:67], v[32:35], v[32:35], v[64:67]
    v_mfma_f32_16x16x32_bf16 v[68:71], v[10:13], v[32:35], v[68:71]
    ds_read_b128 v[32:35], v3 offset:62464
    s_waitcnt lgkmcnt(6)
    v_mfma_f32_16x16x32_bf16 v[72:75], v[160:163], v[36:39], v[72:75]
    v_mfma_f32_16x16x32_bf16 v[76:79], v[240:243], v[36:39], v[76:79]
    v_add_u32 v6, 81920, v3
    ds_read_b128 v[36:39], v6 offset:1024
    s_waitcnt lgkmcnt(6)
    v_mfma_f32_16x16x32_bf16 v[80:83], v[160:163], v[40:43], v[80:83]
    v_mfma_f32_16x16x32_bf16 v[84:87], v[240:243], v[40:43], v[84:87]
    ds_read_b128 v[40:43], v4 offset:1024
    s_waitcnt lgkmcnt(6)
    v_mfma_f32_16x16x32_bf16 v[88:91], v[160:163], v[16:19], v[88:91]
    v_mfma_f32_16x16x32_bf16 v[92:95], v[240:243], v[16:19], v[92:95]
    ds_read_b128 v[16:19], v4 offset:21504
    s_waitcnt vmcnt(4) lgkmcnt(6)
    v_mfma_f32_16x16x32_bf16 v[48:51], v[164:167], v[20:23], v[48:51]
    v_mfma_f32_16x16x32_bf16 v[52:55], v[244:247], v[20:23], v[52:55]
    ds_read_b128 v[20:23], v4 offset:41984
    s_waitcnt lgkmcnt(6)
    v_mfma_f32_16x16x32_bf16 v[56:59], v[164:167], v[24:27], v[56:59]
    v_mfma_f32_16x16x32_bf16 v[60:63], v[244:247], v[24:27], v[60:63]
    v_mfma_f32_16x16x32_bf16 v[64:67], v[24:27], v[24:27], v[64:67]
    v_mfma_f32_16x16x32_bf16 v[68:71], v[10:13], v[24:27], v[68:71]
    ds_read_b128 v[24:27], v4 offset:62464
    s_waitcnt lgkmcnt(6)
    v_mfma_f32_16x16x32_bf16 v[72:75], v[164:167], v[28:31], v[72:75]
    v_mfma_f32_16x16x32_bf16 v[76:79], v[244:247], v[28:31], v[76:79]
    v_add_u32 v6, 81920, v4
    ds_read_b128 v[28:31], v6 offset:1024
    s_waitcnt lgkmcnt(6)
    v_mfma_f32_16x16x32_bf16 v[80:83], v[164:167], v[32:35], v[80:83]
    v_mfma_f32_16x16x32_bf16 v[84:87], v[244:247], v[32:35], v[84:87]
    ds_read_b128 v[32:35], v5 offset:1024
    s_waitcnt lgkmcnt(6)
    v_mfma_f32_16x16x32_bf16 v[88:91], v[164:167], v[36:39], v[88:91]
    v_mfma_f32_16x16x32_bf16 v[92:95], v[244:247], v[36:39], v[92:95]
    ds_read_b128 v[36:39], v5 offset:21504
    s_waitcnt vmcnt(2) lgkmcnt(6)
    v_mfma_f32_16x16x32_bf16 v[48:51], v[168:171], v[40:43], v[48:51]
    v_mfma_f32_16x16x32_bf16 v[52:55], v[248:251], v[40:43], v[52:55]
    ds_read_b128 v[40:43], v5 offset:41984
    s_waitcnt lgkmcnt(6)
    v_mfma_f32_16x16x32_bf16 v[56:59], v[168:171], v[16:19], v[56:59]
    v_mfma_f32_16x16x32_bf16 v[60:63], v[248:251], v[16:19], v[60:63]
    v_mfma_f32_16x16x32_bf16 v[64:67], v[16:19], v[16:19], v[64:67]
    v_mfma_f32_16x16x32_bf16 v[68:71], v[10:13], v[16:19], v[68:71]
    ds_read_b128 v[16:19], v5 offset:62464
    s_waitcnt lgkmcnt(6)
    v_mfma_f32_16x16x32_bf16 v[72:75], v[168:171], v[20:23], v[72:75]
    v_mfma_f32_16x16x32_bf16 v[76:79], v[248:251], v[20:23], v[76:79]
    v_add_u32 v6, 81920, v5
    ds_read_b128 v[20:23], v6 offset:1024
    s_waitcnt lgkmcnt(6)
    v_mfma_f32_16x16x32_bf16 v[80:83], v[168:171], v[24:27], v[80:83]
    v_mfma_f32_16x16x32_bf16 v[84:87], v[248:251], v[24:27], v[84:87]
    s_waitcnt lgkmcnt(5)
    v_mfma_f32_16x16x32_bf16 v[88:91], v[168:171], v[28:31], v[88:91]
    v_mfma_f32_16x16x32_bf16 v[92:95], v[248:251], v[28:31], v[92:95]
    s_waitcnt vmcnt(0) lgkmcnt(4)
    v_mfma_f32_16x16x32_bf16 v[48:51], v[172:175], v[32:35], v[48:51]
    v_mfma_f32_16x16x32_bf16 v[52:55], v[252:255], v[32:35], v[52:55]
    s_waitcnt lgkmcnt(3)
    v_mfma_f32_16x16x32_bf16 v[56:59], v[172:175], v[36:39], v[56:59]
    v_mfma_f32_16x16x32_bf16 v[60:63], v[252:255], v[36:39], v[60:63]
    v_mfma_f32_16x16x32_bf16 v[64:67], v[36:39], v[36:39], v[64:67]
    v_mfma_f32_16x16x32_bf16 v[68:71], v[10:13], v[36:39], v[68:71]
    s_waitcnt lgkmcnt(2)
    v_mfma_f32_16x16x32_bf16 v[72:75], v[172:175], v[40:43], v[72:75]
    v_mfma_f32_16x16x32_bf16 v[76:79], v[252:255], v[40:43], v[76:79]
    s_waitcnt lgkmcnt(1)
    v_mfma_f32_16x16x32_bf16 v[80:83], v[172:175], v[16:19], v[80:83]
    v_mfma_f32_16x16x32_bf16 v[84:87], v[252:255], v[16:19], v[84:87]
    s_waitcnt lgkmcnt(0)
    v_mfma_f32_16x16x32_bf16 v[88:91], v[172:175], v[20:23], v[88:91]
    v_mfma_f32_16x16x32_bf16 v[92:95], v[252:255], v[20:23], v[92:95]
    ds_read_b64_tr_b16 v[10:11], v7
    ds_read_b64_tr_b16 v[12:13], v8
    ds_read_b64_tr_b16 v[14:15], v9
    v_and_b32 v16, 15, v1
    v_lshrrev_b32 v17, 4, v1
    v_and_b32 v18, 3, v1
    v_lshrrev_b32 v19, 2, v16
    v_cmp_eq_u32 s[42:43], 1, v18
    v_cmp_eq_u32 s[44:45], 2, v18
    v_cmp_eq_u32 s[46:47], 3, v18
    v_cmp_eq_u32 s[48:49], v19, v17
    v_lshlrev_b32 v18, 3, v16
    v_add_u32 v18, 45376, v18
    v_cndmask_b32 v64, v64, v65, s[42:43]
    v_cndmask_b32 v64, v64, v66, s[44:45]
    v_cndmask_b32 v64, v64, v67, s[46:47]
    v_mul_f32 v68, 0x3acccccd, v68
    v_mul_f32 v64, 0x3acccccd, v64
    v_fma_f32 v64, -v68, v68, v64
    v_max_f32 v64, 0, v64
    v_cvt_pk_bf16_f32 v68, v68, v64
    v_and_b32 v64, 0xffff0000, v68
    v_lshlrev_b32 v68, 16, v68
    v_add_f32 v64, 0x3727c5ac, v64
    v_cvt_pk_bf16_f32 v64, v64, v64
    v_lshlrev_b32 v64, 16, v64
    v_sqrt_f32 v64, v64
    s_nop 0
    v_cvt_pk_bf16_f32 v64, v64, v64
    v_lshlrev_b32 v64, 16, v64
    v_rcp_f32 v69, v64
    s_mov_b64 exec, s[48:49]
    ds_write_b64 v18, v[68:69] offset:128
    s_mov_b64 exec, -1
    s_lshl_b32 s42, s3, 7
    s_add_u32 s42, s42, 46016
    v_lshl_add_u32 v19, v17, 4, s42
    s_mov_b64 exec, 0x10001
    s_mov_b32 exec_hi, 0x10001
    ds_write_b128 v19, v[48:51] offset:0
    ds_write_b128 v19, v[52:55] offset:64
    s_mov_b64 exec, -1
    s_lshl_b32 s42, s3, 6
    s_cmp_eq_u32 s3, 2
    s_cselect_b32 s42, 192, s42
    s_cmp_eq_u32 s3, 3
    s_cselect_b32 s42, 128, s42
    s_add_u32 s42, s42, 61440
    v_mul_u32_u24 v20, 496, v16
    v_lshl_add_u32 v20, v17, 4, v20
    v_add_u32 v20, s42, v20
    v_lshlrev_b32 v18, 3, v16
    v_add_u32 v18, 45376, v18
    s_waitcnt lgkmcnt(0)
    s_barrier
    ds_read_b64 v[26:27], v18 offset:128
    ds_read_b64 v[28:29], v18 offset:256
    ds_read_b64 v[30:31], v18 offset:384
    ds_read_b64 v[32:33], v18 offset:512
    ds_read_b128 v[36:39], v19 offset:0
    ds_read_b128 v[40:43], v19 offset:64
    s_waitcnt lgkmcnt(0)
    v_fma_f32 v56, -v26, v36, v56
    v_fma_f32 v57, -v26, v37, v57
    v_fma_f32 v58, -v26, v38, v58
    v_fma_f32 v59, -v26, v39, v59
    v_fma_f32 v60, -v26, v40, v60
    v_fma_f32 v61, -v26, v41, v61
    v_fma_f32 v62, -v26, v42, v62
    v_fma_f32 v63, -v26, v43, v63
    v_fma_f32 v72, -v28, v36, v72
    v_fma_f32 v73, -v28, v37, v73
    v_fma_f32 v74, -v28, v38, v74
    v_fma_f32 v75, -v28, v39, v75
    v_fma_f32 v76, -v28, v40, v76
    v_fma_f32 v77, -v28, v41, v77
    v_fma_f32 v78, -v28, v42, v78
    v_fma_f32 v79, -v28, v43, v79
    v_fma_f32 v80, -v30, v36, v80
    v_fma_f32 v81, -v30, v37, v81
    v_fma_f32 v82, -v30, v38, v82
    v_fma_f32 v83, -v30, v39, v83
    v_fma_f32 v84, -v30, v40, v84
    v_fma_f32 v85, -v30, v41, v85
    v_fma_f32 v86, -v30, v42, v86
    v_fma_f32 v87, -v30, v43, v87
    v_fma_f32 v88, -v32, v36, v88
    v_fma_f32 v89, -v32, v37, v89
    v_fma_f32 v90, -v32, v38, v90
    v_fma_f32 v91, -v32, v39, v91
    v_fma_f32 v92, -v32, v40, v92
    v_fma_f32 v93, -v32, v41, v93
    v_fma_f32 v94, -v32, v42, v94
    v_fma_f32 v95, -v32, v43, v95
    v_mul_f32 v56, v56, v27
    v_mul_f32 v57, v57, v27
    v_mul_f32 v58, v58, v27
    v_mul_f32 v59, v59, v27
    v_mul_f32 v60, v60, v27
    v_mul_f32 v61, v61, v27
    v_mul_f32 v62, v62, v27
    v_mul_f32 v63, v63, v27
    v_mul_f32 v72, v72, v29
    v_mul_f32 v73, v73, v29
    v_mul_f32 v74, v74, v29
    v_mul_f32 v75, v75, v29
    v_mul_f32 v76, v76, v29
    v_mul_f32 v77, v77, v29
    v_mul_f32 v78, v78, v29
    v_mul_f32 v79, v79, v29
    v_mul_f32 v80, v80, v31
    v_mul_f32 v81, v81, v31
    v_mul_f32 v82, v82, v31
    v_mul_f32 v83, v83, v31
    v_mul_f32 v84, v84, v31
    v_mul_f32 v85, v85, v31
    v_mul_f32 v86, v86, v31
    v_mul_f32 v87, v87, v31
    v_mul_f32 v88, v88, v33
    v_mul_f32 v89, v89, v33
    v_mul_f32 v90, v90, v33
    v_mul_f32 v91, v91, v33
    v_mul_f32 v92, v92, v33
    v_mul_f32 v93, v93, v33
    v_mul_f32 v94, v94, v33
    v_mul_f32 v95, v95, v33
    v_cvt_pk_bf16_f32 v56, v56, v60
    v_cvt_pk_bf16_f32 v57, v57, v61
    v_cvt_pk_bf16_f32 v58, v58, v62
    v_cvt_pk_bf16_f32 v59, v59, v63
    ds_write_b128 v20, v[56:59] offset:7936
    v_cvt_pk_bf16_f32 v72, v72, v76
    v_cvt_pk_bf16_f32 v73, v73, v77
    v_cvt_pk_bf16_f32 v74, v74, v78
    v_cvt_pk_bf16_f32 v75, v75, v79
    ds_write_b128 v20, v[72:75] offset:15872
    v_cvt_pk_bf16_f32 v80, v80, v84
    v_cvt_pk_bf16_f32 v81, v81, v85
    v_cvt_pk_bf16_f32 v82, v82, v86
    v_cvt_pk_bf16_f32 v83, v83, v87
    ds_write_b128 v20, v[80:83] offset:23808
    v_cvt_pk_bf16_f32 v88, v88, v92
    v_cvt_pk_bf16_f32 v89, v89, v93
    v_cvt_pk_bf16_f32 v90, v90, v94
    v_cvt_pk_bf16_f32 v91, v91, v95
    ds_write_b128 v20, v[88:91] offset:31744
    s_branch L_a1_post
L_g1B:
    global_load_dwordx4 v[96:99], v44, s[48:49] sc1
    global_load_dwordx4 v[176:179], v44, s[50:51] sc1
    global_load_dwordx4 v[100:103], v45, s[48:49] sc1
    global_load_dwordx4 v[180:183], v45, s[50:51] sc1
    global_load_dwordx4 v[104:107], v46, s[48:49] sc1
    global_load_dwordx4 v[184:187], v46, s[50:51] sc1
    global_load_dwordx4 v[108:111], v47, s[48:49] sc1
    global_load_dwordx4 v[188:191], v47, s[50:51] sc1
    s_add_u32 s48, s48, 4096
    s_addc_u32 s49, s49, 0
    s_add_u32 s50, s50, 4096
    s_addc_u32 s51, s51, 0
    s_waitcnt lgkmcnt(0)
    s_barrier
    global_load_dwordx4 v[112:115], v44, s[48:49] sc1
    global_load_dwordx4 v[192:195], v44, s[50:51] sc1
    global_load_dwordx4 v[116:119], v45, s[48:49] sc1
    global_load_dwordx4 v[196:199], v45, s[50:51] sc1
    global_load_dwordx4 v[120:123], v46, s[48:49] sc1
    global_load_dwordx4 v[200:203], v46, s[50:51] sc1
    global_load_dwordx4 v[124:127], v47, s[48:49] sc1
    global_load_dwordx4 v[204:207], v47, s[50:51] sc1
    s_add_u32 s48, s48, 4096
    s_addc_u32 s49, s49, 0
    s_add_u32 s50, s50, 4096
    s_addc_u32 s51, s51, 0
    ds_read_b128 v[16:19], v2 offset:0
    ds_read_b128 v[20:23], v2 offset:20480
    ds_read_b128 v[24:27], v2 offset:40960
    ds_read_b128 v[28:31], v2 offset:61440
    v_add_u32 v6, 81920, v2
    ds_read_b128 v[32:35], v6 offset:0
    ds_read_b128 v[36:39], v3 offset:0
    global_load_dwordx4 v[128:131], v44, s[48:49] sc1
    global_load_dwordx4 v[208:211], v44, s[50:51] sc1
    ds_read_b128 v[40:43], v3 offset:20480
    s_waitcnt vmcnt(16) lgkmcnt(6)
    v_mfma_f32_16x16x32_bf16 v[48:51], v[96:99], v[16:19], 0
    v_mfma_f32_16x16x32_bf16 v[52:55], v[176:179], v[16:19], 0
    ds_read_b128 v[16:19], v3 offset:40960
    s_waitcnt lgkmcnt(6)
    v_mfma_f32_16x16x32_bf16 v[56:59], v[96:99], v[20:23], 0
    v_mfma_f32_16x16x32_bf16 v[60:63], v[176:179], v[20:23], 0
    ds_read_b128 v[20:23], v3 offset:61440
    s_waitcnt lgkmcnt(6)
    v_mfma_f32_16x16x32_bf16 v[64:67], v[96:99], v[24:27], 0
    v_mfma_f32_16x16x32_bf16 v[68:71], v[176:179], v[24:27], 0
    v_mfma_f32_16x16x32_bf16 v[72:75], v[24:27], v[24:27], 0
    v_mfma_f32_16x16x32_bf16 v[76:79], v[10:13], v[24:27], 0
    v_add_u32 v6, 81920, v3
    ds_read_b128 v[24:27], v6 offset:0
    s_waitcnt lgkmcnt(6)
    v_mfma_f32_16x16x32_bf16 v[80:83], v[96:99], v[28:31], 0
    v_mfma_f32_16x16x32_bf16 v[84:87], v[176:179], v[28:31], 0
    ds_read_b128 v[28:31], v4 offset:0
    s_waitcnt lgkmcnt(6)
    v_mfma_f32_16x16x32_bf16 v[88:91], v[96:99], v[32:35], 0
    v_mfma_f32_16x16x32_bf16 v[92:95], v[176:179], v[32:35], 0
    global_load_dwordx4 v[132:135], v45, s[48:49] sc1
    global_load_dwordx4 v[212:215], v45, s[50:51] sc1
    ds_read_b128 v[32:35], v4 offset:20480
    s_waitcnt vmcnt(16) lgkmcnt(6)
    v_mfma_f32_16x16x32_bf16 v[48:51], v[100:103], v[36:39], v[48:51]
    v_mfma_f32_16x16x32_bf16 v[52:55], v[180:183], v[36:39], v[52:55]
    ds_read_b128 v[36:39], v4 offset:40960
    s_waitcnt lgkmcnt(6)
    v_mfma_f32_16x16x32_bf16 v[56:59], v[100:103], v[40:43], v[56:59]
    v_mfma_f32_16x16x32_bf16 v[60:63], v[180:183], v[40:43], v[60:63]
    ds_read_b128 v[40:43], v4 offset:61440
    s_waitcnt lgkmcnt(6)
    v_mfma_f32_16x16x32_bf16 v[64:67], v[100:103], v[16:19], v[64:67]
    v_mfma_f32_16x16x32_bf16 v[68:71], v[180:183], v[16:19], v[68:71]
    v_mfma_f32_16x16x32_bf16 v[72:75], v[16:19], v[16:19], v[72:75]
    v_mfma_f32_16x16x32_bf16 v[76:79], v[10:13], v[16:19], v[76:79]
    v_add_u32 v6, 81920, v4
    ds_read_b128 v[16:19], v6 offset:0
    s_waitcnt lgkmcnt(6)
    v_mfma_f32_16x16x32_bf16 v[80:83], v[100:103], v[20:23], v[80:83]
    v_mfma_f32_16x16x32_bf16 v[84:87], v[180:183], v[20:23], v[84:87]
    ds_read_b128 v[20:23], v5 offset:0
    s_waitcnt lgkmcnt(6)
    v_mfma_f32_16x16x32_bf16 v[88:91], v[100:103], v[24:27], v[88:91]
    v_mfma_f32_16x16x32_bf16 v[92:95], v[180:183], v[24:27], v[92:95]
    global_load_dwordx4 v[136:139], v46, s[48:49] sc1
    global_load_dwordx4 v[216:219], v46, s[50:51] sc1
    ds_read_b128 v[24:27], v5 offset:20480
    s_waitcnt vmcnt(16) lgkmcnt(6)
    v_mfma_f32_16x16x32_bf16 v[48:51], v[104:107], v[28:31], v[48:51]
    v_mfma_f32_16x16x32_bf16 v[52:55], v[184:187], v[28:31], v[52:55]
    ds_read_b128 v[28:31], v5 offset:40960
    s_waitcnt lgkmcnt(6)
    v_mfma_f32_16x16x32_bf16 v[56:59], v[104:107], v[32:35], v[56:59]
    v_mfma_f32_16x16x32_bf16 v[60:63], v[184:187], v[32:35], v[60:63]
    ds_read_b128 v[32:35], v5 offset:61440
    s_waitcnt lgkmcnt(6)
    v_mfma_f32_16x16x32_bf16 v[64:67], v[104:107], v[36:39], v[64:67]
    v_mfma_f32_16x16x32_bf16 v[68:71], v[184:187], v[36:39], v[68:71]
    v_mfma_f32_16x16x32_bf16 v[72:75], v[36:39], v[36:39], v[72:75]
    v_mfma_f32_16x16x32_bf16 v[76:79], v[10:13], v[36:39], v[76:79]
    v_add_u32 v6, 81920, v5
    ds_read_b128 v[36:39], v6 offset:0
    s_waitcnt lgkmcnt(6)
    v_mfma_f32_16x16x32_bf16 v[80:83], v[104:107], v[40:43], v[80:83]
    v_mfma_f32_16x16x32_bf16 v[84:87], v[184:187], v[40:43], v[84:87]
    ds_read_b128 v[40:43], v2 offset:256
    s_waitcnt lgkmcnt(6)
    v_mfma_f32_16x16x32_bf16 v[88:91], v[104:107], v[16:19], v[88:91]
    v_mfma_f32_16x16x32_bf16 v[92:95], v[184:187], v[16:19], v[92:95]
    global_load_dwordx4 v[140:143], v47, s[48:49] sc1
    global_load_dwordx4 v[220:223], v47, s[50:51] sc1
    s_add_u32 s48, s48, 4096
    s_addc_u32 s49, s49, 0
    s_add_u32 s50, s50, 4096
    s_addc_u32 s51, s51, 0
    ds_read_b128 v[16:19], v2 offset:20736
    s_waitcnt vmcnt(16) lgkmcnt(6)
    v_mfma_f32_16x16x32_bf16 v[48:51], v[108:111], v[20:23], v[48:51]
    v_mfma_f32_16x16x32_bf16 v[52:55], v[188:191], v[20:23], v[52:55]
    ds_read_b128 v[20:23], v2 offset:41216
    s_waitcnt lgkmcnt(6)
    v_mfma_f32_16x16x32_bf16 v[56:59], v[108:111], v[24:27], v[56:59]
    v_mfma_f32_16x16x32_bf16 v[60:63], v[188:191], v[24:27], v[60:63]
    ds_read_b128 v[24:27], v2 offset:61696
    s_waitcnt lgkmcnt(6)
    v_mfma_f32_16x16x32_bf16 v[64:67], v[108:111], v[28:31], v[64:67]
    v_mfma_f32_16x16x32_bf16 v[68:71], v[188:191], v[28:31], v[68:71]
    v_mfma_f32_16x16x32_bf16 v[72:75], v[28:31], v[28:31], v[72:75]
    v_mfma_f32_16x16x32_bf16 v[76:79], v[10:13], v[28:31], v[76:79]
    v_add_u32 v6, 81920, v2
    ds_read_b128 v[28:31], v6 offset:256
    s_waitcnt lgkmcnt(6)
    v_mfma_f32_16x16x32_bf16 v[80:83], v[108:111], v[32:35], v[80:83]
    v_mfma_f32_16x16x32_bf16 v[84:87], v[188:191], v[32:35], v[84:87]
    ds_read_b128 v[32:35], v3 offset:256
    s_waitcnt lgkmcnt(6)
    v_mfma_f32_16x16x32_bf16 v[88:91], v[108:111], v[36:39], v[88:91]
    v_mfma_f32_16x16x32_bf16 v[92:95], v[188:191], v[36:39], v[92:95]
    global_load_dwordx4 v[144:147], v44, s[48:49] sc1
    global_load_dwordx4 v[224:227], v44, s[50:51] sc1
    ds_read_b128 v[36:39], v3 offset:20736
    s_waitcnt vmcnt(16) lgkmcnt(6)
    v_mfma_f32_16x16x32_bf16 v[48:51], v[112:115], v[40:43], v[48:51]
    v_mfma_f32_16x16x32_bf16 v[52:55], v[192:195], v[40:43], v[52:55]
    ds_read_b128 v[40:43], v3 offset:41216
    s_waitcnt lgkmcnt(6)
    v_mfma_f32_16x16x32_bf16 v[56:59], v[112:115], v[16:19], v[56:59]
    v_mfma_f32_16x16x32_bf16 v[60:63], v[192:195], v[16:19], v[60:63]
    ds_read_b128 v[16:19], v3 offset:61696
    s_waitcnt lgkmcnt(6)
    v_mfma_f32_16x16x32_bf16 v[64:67], v[112:115], v[20:23], v[64:67]
    v_mfma_f32_16x16x32_bf16 v[68:71], v[192:195], v[20:23], v[68:71]
    v_mfma_f32_16x16x32_bf16 v[72:75], v[20:23], v[20:23], v[72:75]
    v_mfma_f32_16x16x32_bf16 v[76:79], v[10:13], v[20:23], v[76:79]
    v_add_u32 v6, 81920, v3
    ds_read_b128 v[20:23], v6 offset:256
    s_waitcnt lgkmcnt(6)
    v_mfma_f32_16x16x32_bf16 v[80:83], v[112:115], v[24:27], v[80:83]
    v_mfma_f32_16x16x32_bf16 v[84:87], v[192:195], v[24:27], v[84:87]
    ds_read_b128 v[24:27], v4 offset:256
    s_waitcnt lgkmcnt(6)
    v_mfma_f32_16x16x32_bf16 v[88:91], v[112:115], v[28:31], v[88:91]
    v_mfma_f32_16x16x32_bf16 v[92:95], v[192:195], v[28:31], v[92:95]
    global_load_dwordx4 v[148:151], v45, s[48:49] sc1
    global_load_dwordx4 v[228:231], v45, s[50:51] sc1
    ds_read_b128 v[28:31], v4 offset:20736
    s_waitcnt vmcnt(16) lgkmcnt(6)
    v_mfma_f32_16x16x32_bf16 v[48:51], v[116:119], v[32:35], v[48:51]
    v_mfma_f32_16x16x32_bf16 v[52:55], v[196:199], v[32:35], v[52:55]
    ds_read_b128 v[32:35], v4 offset:41216
    s_waitcnt lgkmcnt(6)
    v_mfma_f32_16x16x32_bf16 v[56:59], v[116:119], v[36:39], v[56:59]
    v_mfma_f32_16x16x32_bf16 v[60:63], v[196:199], v[36:39], v[60:63]
    ds_read_b128 v[36:39], v4 offset:61696
    s_waitcnt lgkmcnt(6)
    v_mfma_f32_16x16x32_bf16 v[64:67], v[116:119], v[40:43], v[64:67]
    v_mfma_f32_16x16x32_bf16 v[68:71], v[196:199], v[40:43], v[68:71]
    v_mfma_f32_16x16x32_bf16 v[72:75], v[40:43], v[40:43], v[72:75]
    v_mfma_f32_16x16x32_bf16 v[76:79], v[10:13], v[40:43], v[76:79]
    v_add_u32 v6, 81920, v4
    ds_read_b128 v[40:43], v6 offset:256
    s_waitcnt lgkmcnt(6)
    v_mfma_f32_16x16x32_bf16 v[80:83], v[116:119], v[16:19], v[80:83]
    v_mfma_f32_16x16x32_bf16 v[84:87], v[196:199], v[16:19], v[84:87]
    ds_read_b128 v[16:19], v5 offset:256
    s_waitcnt lgkmcnt(6)
    v_mfma_f32_16x16x32_bf16 v[88:91], v[116:119], v[20:23], v[88:91]
    v_mfma_f32_16x16x32_bf16 v[92:95], v[196:199], v[20:23], v[92:95]
    global_load_dwordx4 v[152:155], v46, s[48:49] sc1
    global_load_dwordx4 v[232:235], v46, s[50:51] sc1
    ds_read_b128 v[20:23], v5 offset:20736
    s_waitcnt vmcnt(16) lgkmcnt(6)
    v_mfma_f32_16x16x32_bf16 v[48:51], v[120:123], v[24:27], v[48:51]
    v_mfma_f32_16x16x32_bf16 v[52:55], v[200:203], v[24:27], v[52:55]
    ds_read_b128 v[24:27], v5 offset:41216
    s_waitcnt lgkmcnt(6)
    v_mfma_f32_16x16x32_bf16 v[56:59], v[120:123], v[28:31], v[56:59]
    v_mfma_f32_16x16x32_bf16 v[60:63], v[200:203], v[28:31], v[60:63]
    ds_read_b128 v[28:31], v5 offset:61696
    s_waitcnt lgkmcnt(6)
    v_mfma_f32_16x16x32_bf16 v[64:67], v[120:123], v[32:35], v[64:67]
    v_mfma_f32_16x16x32_bf16 v[68:71], v[200:203], v[32:35], v[68:71]
    v_mfma_f32_16x16x32_bf16 v[72:75], v[32:35], v[32:35], v[72:75]
    v_mfma_f32_16x16x32_bf16 v[76:79], v[10:13], v[32:35], v[76:79]
    v_add_u32 v6, 81920, v5
    ds_read_b128 v[32:35], v6 offset:256
    s_waitcnt lgkmcnt(6)
    v_mfma_f32_16x16x32_bf16 v[80:83], v[120:123], v[36:39], v[80:83]
    v_mfma_f32_16x16x32_bf16 v[84:87], v[200:203], v[36:39], v[84:87]
    ds_read_b128 v[36:39], v2 offset:512
    s_waitcnt lgkmcnt(6)
    v_mfma_f32_16x16x32_bf16 v[88:91], v[120:123], v[40:43], v[88:91]
    v_mfma_f32_16x16x32_bf16 v[92:95], v[200:203], v[40:43], v[92:95]
    global_load_dwordx4 v[156:159], v47, s[48:49] sc1
    global_load_dwordx4 v[236:239], v47, s[50:51] sc1
    s_add_u32 s48, s48, 4096
    s_addc_u32 s49, s49, 0
    s_add_u32 s50, s50, 4096
    s_addc_u32 s51, s51, 0
    ds_read_b128 v[40:43], v2 offset:20992
    s_waitcnt vmcnt(16) lgkmcnt(6)
    v_mfma_f32_16x16x32_bf16 v[48:51], v[124:127], v[16:19], v[48:51]
    v_mfma_f32_16x16x32_bf16 v[52:55], v[204:207], v[16:19], v[52:55]
    ds_read_b128 v[16:19], v2 offset:41472
    s_waitcnt lgkmcnt(6)
    v_mfma_f32_16x16x32_bf16 v[56:59], v[124:127], v[20:23], v[56:59]
    v_mfma_f32_16x16x32_bf16 v[60:63], v[204:207], v[20:23], v[60:63]
    ds_read_b128 v[20:23], v2 offset:61952
    s_waitcnt lgkmcnt(6)
    v_mfma_f32_16x16x32_bf16 v[64:67], v[124:127], v[24:27], v[64:67]
    v_mfma_f32_16x16x32_bf16 v[68:71], v[204:207], v[24:27], v[68:71]
    v_mfma_f32_16x16x32_bf16 v[72:75], v[24:27], v[24:27], v[72:75]
    v_mfma_f32_16x16x32_bf16 v[76:79], v[10:13], v[24:27], v[76:79]
    v_add_u32 v6, 81920, v2
    ds_read_b128 v[24:27], v6 offset:512
    s_waitcnt lgkmcnt(6)
    v_mfma_f32_16x16x32_bf16 v[80:83], v[124:127], v[28:31], v[80:83]
    v_mfma_f32_16x16x32_bf16 v[84:87], v[204:207], v[28:31], v[84:87]
    ds_read_b128 v[28:31], v3 offset:512
    s_waitcnt lgkmcnt(6)
    v_mfma_f32_16x16x32_bf16 v[88:91], v[124:127], v[32:35], v[88:91]
    v_mfma_f32_16x16x32_bf16 v[92:95], v[204:207], v[32:35], v[92:95]
    global_load_dwordx4 v[160:163], v44, s[48:49] sc1
    global_load_dwordx4 v[240:243], v44, s[50:51] sc1
    ds_read_b128 v[32:35], v3 offset:20992
    s_waitcnt vmcnt(16) lgkmcnt(6)
    v_mfma_f32_16x16x32_bf16 v[48:51], v[128:131], v[36:39], v[48:51]
    v_mfma_f32_16x16x32_bf16 v[52:55], v[208:211], v[36:39], v[52:55]
    ds_read_b128 v[36:39], v3 offset:41472
    s_waitcnt lgkmcnt(6)
    v_mfma_f32_16x16x32_bf16 v[56:59], v[128:131], v[40:43], v[56:59]
    v_mfma_f32_16x16x32_bf16 v[60:63], v[208:211], v[40:43], v[60:63]
    ds_read_b128 v[40:43], v3 offset:61952
    s_waitcnt lgkmcnt(6)
    v_mfma_f32_16x16x32_bf16 v[64:67], v[128:131], v[16:19], v[64:67]
    v_mfma_f32_16x16x32_bf16 v[68:71], v[208:211], v[16:19], v[68:71]
    v_mfma_f32_16x16x32_bf16 v[72:75], v[16:19], v[16:19], v[72:75]
    v_mfma_f32_16x16x32_bf16 v[76:79], v[10:13], v[16:19], v[76:79]
    v_add_u32 v6, 81920, v3
    ds_read_b128 v[16:19], v6 offset:512
    s_waitcnt lgkmcnt(6)
    v_mfma_f32_16x16x32_bf16 v[80:83], v[128:131], v[20:23], v[80:83]
    v_mfma_f32_16x16x32_bf16 v[84:87], v[208:211], v[20:23], v[84:87]
    ds_read_b128 v[20:23], v4 offset:512
    s_waitcnt lgkmcnt(6)
    v_mfma_f32_16x16x32_bf16 v[88:91], v[128:131], v[24:27], v[88:91]
    v_mfma_f32_16x16x32_bf16 v[92:95], v[208:211], v[24:27], v[92:95]
    global_load_dwordx4 v[164:167], v45, s[48:49] sc1
    global_load_dwordx4 v[244:247], v45, s[50:51] sc1
    ds_read_b128 v[24:27], v4 offset:20992
    s_waitcnt vmcnt(16) lgkmcnt(6)
    v_mfma_f32_16x16x32_bf16 v[48:51], v[132:135], v[28:31], v[48:51]
    v_mfma_f32_16x16x32_bf16 v[52:55], v[212:215], v[28:31], v[52:55]
    ds_read_b128 v[28:31], v4 offset:41472
    s_waitcnt lgkmcnt(6)
    v_mfma_f32_16x16x32_bf16 v[56:59], v[132:135], v[32:35], v[56:59]
    v_mfma_f32_16x16x32_bf16 v[60:63], v[212:215], v[32:35], v[60:63]
    ds_read_b128 v[32:35], v4 offset:61952
    s_waitcnt lgkmcnt(6)
    v_mfma_f32_16x16x32_bf16 v[64:67], v[132:135], v[36:39], v[64:67]
    v_mfma_f32_16x16x32_bf16 v[68:71], v[212:215], v[36:39], v[68:71]
    v_mfma_f32_16x16x32_bf16 v[72:75], v[36:39], v[36:39], v[72:75]
    v_mfma_f32_16x16x32_bf16 v[76:79], v[10:13], v[36:39], v[76:79]
    v_add_u32 v6, 81920, v4
    ds_read_b128 v[36:39], v6 offset:512
    s_waitcnt lgkmcnt(6)
    v_mfma_f32_16x16x32_bf16 v[80:83], v[132:135], v[40:43], v[80:83]
    v_mfma_f32_16x16x32_bf16 v[84:87], v[212:215], v[40:43], v[84:87]
    ds_read_b128 v[40:43], v5 offset:512
    s_waitcnt lgkmcnt(6)
    v_mfma_f32_16x16x32_bf16 v[88:91], v[132:135], v[16:19], v[88:91]
    v_mfma_f32_16x16x32_bf16 v[92:95], v[212:215], v[16:19], v[92:95]
    global_load_dwordx4 v[168:171], v46, s[48:49] sc1
    global_load_dwordx4 v[248:251], v46, s[50:51] sc1
    ds_read_b128 v[16:19], v5 offset:20992
    s_waitcnt vmcnt(16) lgkmcnt(6)
    v_mfma_f32_16x16x32_bf16 v[48:51], v[136:139], v[20:23], v[48:51]
    v_mfma_f32_16x16x32_bf16 v[52:55], v[216:219], v[20:23], v[52:55]
    ds_read_b128 v[20:23], v5 offset:41472
    s_waitcnt lgkmcnt(6)
    v_mfma_f32_16x16x32_bf16 v[56:59], v[136:139], v[24:27], v[56:59]
    v_mfma_f32_16x16x32_bf16 v[60:63], v[216:219], v[24:27], v[60:63]
    ds_read_b128 v[24:27], v5 offset:61952
    s_waitcnt lgkmcnt(6)
    v_mfma_f32_16x16x32_bf16 v[64:67], v[136:139], v[28:31], v[64:67]
    v_mfma_f32_16x16x32_bf16 v[68:71], v[216:219], v[28:31], v[68:71]
    v_mfma_f32_16x16x32_bf16 v[72:75], v[28:31], v[28:31], v[72:75]
    v_mfma_f32_16x16x32_bf16 v[76:79], v[10:13], v[28:31], v[76:79]
    v_add_u32 v6, 81920, v5
    ds_read_b128 v[28:31], v6 offset:512
    s_waitcnt lgkmcnt(6)
    v_mfma_f32_16x16x32_bf16 v[80:83], v[136:139], v[32:35], v[80:83]
    v_mfma_f32_16x16x32_bf16 v[84:87], v[216:219], v[32:35], v[84:87]
    ds_read_b128 v[32:35], v2 offset:768
    s_waitcnt lgkmcnt(6)
    v_mfma_f32_16x16x32_bf16 v[88:91], v[136:139], v[36:39], v[88:91]
    v_mfma_f32_16x16x32_bf16 v[92:95], v[216:219], v[36:39], v[92:95]
    global_load_dwordx4 v[172:175], v47, s[48:49] sc1
    global_load_dwordx4 v[252:255], v47, s[50:51] sc1
    ds_read_b128 v[36:39], v2 offset:21248
    s_waitcnt vmcnt(16) lgkmcnt(6)
    v_mfma_f32_16x16x32_bf16 v[48:51], v[140:143], v[40:43], v[48:51]
    v_mfma_f32_16x16x32_bf16 v[52:55], v[220:223], v[40:43], v[52:55]
    ds_read_b128 v[40:43], v2 offset:41728
    s_waitcnt lgkmcnt(6)
    v_mfma_f32_16x16x32_bf16 v[56:59], v[140:143], v[16:19], v[56:59]
    v_mfma_f32_16x16x32_bf16 v[60:63], v[220:223], v[16:19], v[60:63]
    ds_read_b128 v[16:19], v2 offset:62208
    s_waitcnt lgkmcnt(6)
    v_mfma_f32_16x16x32_bf16 v[64:67], v[140:143], v[20:23], v[64:67]
    v_mfma_f32_16x16x32_bf16 v[68:71], v[220:223], v[20:23], v[68:71]
    v_mfma_f32_16x16x32_bf16 v[72:75], v[20:23], v[20:23], v[72:75]
    v_mfma_f32_16x16x32_bf16 v[76:79], v[10:13], v[20:23], v[76:79]
    v_add_u32 v6, 81920, v2
    ds_read_b128 v[20:23], v6 offset:768
    s_waitcnt lgkmcnt(6)
    v_mfma_f32_16x16x32_bf16 v[80:83], v[140:143], v[24:27], v[80:83]
    v_mfma_f32_16x16x32_bf16 v[84:87], v[220:223], v[24:27], v[84:87]
    ds_read_b128 v[24:27], v3 offset:768
    s_waitcnt lgkmcnt(6)
    v_mfma_f32_16x16x32_bf16 v[88:91], v[140:143], v[28:31], v[88:91]
    v_mfma_f32_16x16x32_bf16 v[92:95], v[220:223], v[28:31], v[92:95]
    ds_read_b128 v[28:31], v3 offset:21248
    s_waitcnt vmcnt(14) lgkmcnt(6)
    v_mfma_f32_16x16x32_bf16 v[48:51], v[144:147], v[32:35], v[48:51]
    v_mfma_f32_16x16x32_bf16 v[52:55], v[224:227], v[32:35], v[52:55]
    ds_read_b128 v[32:35], v3 offset:41728
    s_waitcnt lgkmcnt(6)
    v_mfma_f32_16x16x32_bf16 v[56:59], v[144:147], v[36:39], v[56:59]
    v_mfma_f32_16x16x32_bf16 v[60:63], v[224:227], v[36:39], v[60:63]
    ds_read_b128 v[36:39], v3 offset:62208
    s_waitcnt lgkmcnt(6)
    v_mfma_f32_16x16x32_bf16 v[64:67], v[144:147], v[40:43], v[64:67]
    v_mfma_f32_16x16x32_bf16 v[68:71], v[224:227], v[40:43], v[68:71]
    v_mfma_f32_16x16x32_bf16 v[72:75], v[40:43], v[40:43], v[72:75]
    v_mfma_f32_16x16x32_bf16 v[76:79], v[10:13], v[40:43], v[76:79]
    v_add_u32 v6, 81920, v3
    ds_read_b128 v[40:43], v6 offset:768
    s_waitcnt lgkmcnt(6)
    v_mfma_f32_16x16x32_bf16 v[80:83], v[144:147], v[16:19], v[80:83]
    v_mfma_f32_16x16x32_bf16 v[84:87], v[224:227], v[16:19], v[84:87]
    ds_read_b128 v[16:19], v4 offset:768
    s_waitcnt lgkmcnt(6)
    v_mfma_f32_16x16x32_bf16 v[88:91], v[144:147], v[20:23], v[88:91]
    v_mfma_f32_16x16x32_bf16 v[92:95], v[224:227], v[20:23], v[92:95]
    ds_read_b128 v[20:23], v4 offset:21248
    s_waitcnt vmcnt(12) lgkmcnt(6)
    v_mfma_f32_16x16x32_bf16 v[48:51], v[148:151], v[24:27], v[48:51]
    v_mfma_f32_16x16x32_bf16 v[52:55], v[228:231], v[24:27], v[52:55]
    ds_read_b128 v[24:27], v4 offset:41728
    s_waitcnt lgkmcnt(6)
    v_mfma_f32_16x16x32_bf16 v[56:59], v[148:151], v[28:31], v[56:59]
    v_mfma_f32_16x16x32_bf16 v[60:63], v[228:231], v[28:31], v[60:63]
    ds_read_b128 v[28:31], v4 offset:62208
    s_waitcnt lgkmcnt(6)
    v_mfma_f32_16x16x32_bf16 v[64:67], v[148:151], v[32:35], v[64:67]
    v_mfma_f32_16x16x32_bf16 v[68:71], v[228:231], v[32:35], v[68:71]
    v_mfma_f32_16x16x32_bf16 v[72:75], v[32:35], v[32:35], v[72:75]
    v_mfma_f32_16x16x32_bf16 v[76:79], v[10:13], v[32:35], v[76:79]
    v_add_u32 v6, 81920, v4
    ds_read_b128 v[32:35], v6 offset:768
    s_waitcnt lgkmcnt(6)
    v_mfma_f32_16x16x32_bf16 v[80:83], v[148:151], v[36:39], v[80:83]
    v_mfma_f32_16x16x32_bf16 v[84:87], v[228:231], v[36:39], v[84:87]
    ds_read_b128 v[36:39], v5 offset:768
    s_waitcnt lgkmcnt(6)
    v_mfma_f32_16x16x32_bf16 v[88:91], v[148:151], v[40:43], v[88:91]
    v_mfma_f32_16x16x32_bf16 v[92:95], v[228:231], v[40:43], v[92:95]
    ds_read_b128 v[40:43], v5 offset:21248
    s_waitcnt vmcnt(10) lgkmcnt(6)
    v_mfma_f32_16x16x32_bf16 v[48:51], v[152:155], v[16:19], v[48:51]
    v_mfma_f32_16x16x32_bf16 v[52:55], v[232:235], v[16:19], v[52:55]
    ds_read_b128 v[16:19], v5 offset:41728
    s_waitcnt lgkmcnt(6)
    v_mfma_f32_16x16x32_bf16 v[56:59], v[152:155], v[20:23], v[56:59]
    v_mfma_f32_16x16x32_bf16 v[60:63], v[232:235], v[20:23], v[60:63]
    ds_read_b128 v[20:23], v5 offset:62208
    s_waitcnt lgkmcnt(6)
    v_mfma_f32_16x16x32_bf16 v[64:67], v[152:155], v[24:27], v[64:67]
    v_mfma_f32_16x16x32_bf16 v[68:71], v[232:235], v[24:27], v[68:71]
    v_mfma_f32_16x16x32_bf16 v[72:75], v[24:27], v[24:27], v[72:75]
    v_mfma_f32_16x16x32_bf16 v[76:79], v[10:13], v[24:27], v[76:79]
    v_add_u32 v6, 81920, v5
    ds_read_b128 v[24:27], v6 offset:768
    s_waitcnt lgkmcnt(6)
    v_mfma_f32_16x16x32_bf16 v[80:83], v[152:155], v[28:31], v[80:83]
    v_mfma_f32_16x16x32_bf16 v[84:87], v[232:235], v[28:31], v[84:87]
    ds_read_b128 v[28:31], v2 offset:1024
    s_waitcnt lgkmcnt(6)
    v_mfma_f32_16x16x32_bf16 v[88:91], v[152:155], v[32:35], v[88:91]
    v_mfma_f32_16x16x32_bf16 v[92:95], v[232:235], v[32:35], v[92:95]
    ds_read_b128 v[32:35], v2 offset:21504
    s_waitcnt vmcnt(8) lgkmcnt(6)
    v_mfma_f32_16x16x32_bf16 v[48:51], v[156:159], v[36:39], v[48:51]
    v_mfma_f32_16x16x32_bf16 v[52:55], v[236:239], v[36:39], v[52:55]
    ds_read_b128 v[36:39], v2 offset:41984
    s_waitcnt lgkmcnt(6)
    v_mfma_f32_16x16x32_bf16 v[56:59], v[156:159], v[40:43], v[56:59]
    v_mfma_f32_16x16x32_bf16 v[60:63], v[236:239], v[40:43], v[60:63]
    ds_read_b128 v[40:43], v2 offset:62464
    s_waitcnt lgkmcnt(6)
    v_mfma_f32_16x16x32_bf16 v[64:67], v[156:159], v[16:19], v[64:67]
    v_mfma_f32_16x16x32_bf16 v[68:71], v[236:239], v[16:19], v[68:71]
    v_mfma_f32_16x16x32_bf16 v[72:75], v[16:19], v[16:19], v[72:75]
    v_mfma_f32_16x16x32_bf16 v[76:79], v[10:13], v[16:19], v[76:79]
    v_add_u32 v6, 81920, v2
    ds_read_b128 v[16:19], v6 offset:1024
    s_waitcnt lgkmcnt(6)
    v_mfma_f32_16x16x32_bf16 v[80:83], v[156:159], v[20:23], v[80:83]
    v_mfma_f32_16x16x32_bf16 v[84:87], v[236:239], v[20:23], v[84:87]
    ds_read_b128 v[20:23], v3 offset:1024
    s_waitcnt lgkmcnt(6)
    v_mfma_f32_16x16x32_bf16 v[88:91], v[156:159], v[24:27], v[88:91]
    v_mfma_f32_16x16x32_bf16 v[92:95], v[236:239], v[24:27], v[92:95]
    ds_read_b128 v[24:27], v3 offset:21504
    s_waitcnt vmcnt(6) lgkmcnt(6)
    v_mfma_f32_16x16x32_bf16 v[48:51], v[160:163], v[28:31], v[48:51]
    v_mfma_f32_16x16x32_bf16 v[52:55], v[240:243], v[28:31], v[52:55]
    ds_read_b128 v[28:31], v3 offset:41984
    s_waitcnt lgkmcnt(6)
    v_mfma_f32_16x16x32_bf16 v[56:59], v[160:163], v[32:35], v[56:59]
    v_mfma_f32_16x16x32_bf16 v[60:63], v[240:243], v[32:35], v[60:63]
    ds_read_b128 v[32:35], v3 offset:62464
    s_waitcnt lgkmcnt(6)
    v_mfma_f32_16x16x32_bf16 v[64:67], v[160:163], v[36:39], v[64:67]
    v_mfma_f32_16x16x32_bf16 v[68:71], v[240:243], v[36:39], v[68:71]
    v_mfma_f32_16x16x32_bf16 v[72:75], v[36:39], v[36:39], v[72:75]
    v_mfma_f32_16x16x32_bf16 v[76:79], v[10:13], v[36:39], v[76:79]
    v_add_u32 v6, 81920, v3
    ds_read_b128 v[36:39], v6 offset:1024
    s_waitcnt lgkmcnt(6)
    v_mfma_f32_16x16x32_bf16 v[80:83], v[160:163], v[40:43], v[80:83]
    v_mfma_f32_16x16x32_bf16 v[84:87], v[240:243], v[40:43], v[84:87]
    ds_read_b128 v[40:43], v4 offset:1024
    s_waitcnt lgkmcnt(6)
    v_mfma_f32_16x16x32_bf16 v[88:91], v[160:163], v[16:19], v[88:91]
    v_mfma_f32_16x16x32_bf16 v[92:95], v[240:243], v[16:19], v[92:95]
    ds_read_b128 v[16:19], v4 offset:21504
    s_waitcnt vmcnt(4) lgkmcnt(6)
    v_mfma_f32_16x16x32_bf16 v[48:51], v[164:167], v[20:23], v[48:51]
    v_mfma_f32_16x16x32_bf16 v[52:55], v[244:247], v[20:23], v[52:55]
    ds_read_b128 v[20:23], v4 offset:41984
    s_waitcnt lgkmcnt(6)
    v_mfma_f32_16x16x32_bf16 v[56:59], v[164:167], v[24:27], v[56:59]
    v_mfma_f32_16x16x32_bf16 v[60:63], v[244:247], v[24:27], v[60:63]
    ds_read_b128 v[24:27], v4 offset:62464
    s_waitcnt lgkmcnt(6)
    v_mfma_f32_16x16x32_bf16 v[64:67], v[164:167], v[28:31], v[64:67]
    v_mfma_f32_16x16x32_bf16 v[68:71], v[244:247], v[28:31], v[68:71]
    v_mfma_f32_16x16x32_bf16 v[72:75], v[28:31], v[28:31], v[72:75]
    v_mfma_f32_16x16x32_bf16 v[76:79], v[10:13], v[28:31], v[76:79]
    v_add_u32 v6, 81920, v4
    ds_read_b128 v[28:31], v6 offset:1024
    s_waitcnt lgkmcnt(6)
    v_mfma_f32_16x16x32_bf16 v[80:83], v[164:167], v[32:35], v[80:83]
    v_mfma_f32_16x16x32_bf16 v[84:87], v[244:247], v[32:35], v[84:87]
    ds_read_b128 v[32:35], v5 offset:1024
    s_waitcnt lgkmcnt(6)
    v_mfma_f32_16x16x32_bf16 v[88:91], v[164:167], v[36:39], v[88:91]
    v_mfma_f32_16x16x32_bf16 v[92:95], v[244:247], v[36:39], v[92:95]
    ds_read_b128 v[36:39], v5 offset:21504
    s_waitcnt vmcnt(2) lgkmcnt(6)
    v_mfma_f32_16x16x32_bf16 v[48:51], v[168:171], v[40:43], v[48:51]
    v_mfma_f32_16x16x32_bf16 v[52:55], v[248:251], v[40:43], v[52:55]
    ds_read_b128 v[40:43], v5 offset:41984
    s_waitcnt lgkmcnt(6)
    v_mfma_f32_16x16x32_bf16 v[56:59], v[168:171], v[16:19], v[56:59]
    v_mfma_f32_16x16x32_bf16 v[60:63], v[248:251], v[16:19], v[60:63]
    ds_read_b128 v[16:19], v5 offset:62464
    s_waitcnt lgkmcnt(6)
    v_mfma_f32_16x16x32_bf16 v[64:67], v[168:171], v[20:23], v[64:67]
    v_mfma_f32_16x16x32_bf16 v[68:71], v[248:251], v[20:23], v[68:71]
    v_mfma_f32_16x16x32_bf16 v[72:75], v[20:23], v[20:23], v[72:75]
    v_mfma_f32_16x16x32_bf16 v[76:79], v[10:13], v[20:23], v[76:79]
    v_add_u32 v6, 81920, v5
    ds_read_b128 v[20:23], v6 offset:1024
    s_waitcnt lgkmcnt(6)
    v_mfma_f32_16x16x32_bf16 v[80:83], v[168:171], v[24:27], v[80:83]
    v_mfma_f32_16x16x32_bf16 v[84:87], v[248:251], v[24:27], v[84:87]
    s_waitcnt lgkmcnt(5)
    v_mfma_f32_16x16x32_bf16 v[88:91], v[168:171], v[28:31], v[88:91]
    v_mfma_f32_16x16x32_bf16 v[92:95], v[248:251], v[28:31], v[92:95]
    s_waitcnt vmcnt(0) lgkmcnt(4)
    v_mfma_f32_16x16x32_bf16 v[48:51], v[172:175], v[32:35], v[48:51]
    v_mfma_f32_16x16x32_bf16 v[52:55], v[252:255], v[32:35], v[52:55]
    s_waitcnt lgkmcnt(3)
    v_mfma_f32_16x16x32_bf16 v[56:59], v[172:175], v[36:39], v[56:59]
    v_mfma_f32_16x16x32_bf16 v[60:63], v[252:255], v[36:39], v[60:63]
    s_waitcnt lgkmcnt(2)
    v_mfma_f32_16x16x32_bf16 v[64:67], v[172:175], v[40:43], v[64:67]
    v_mfma_f32_16x16x32_bf16 v[68:71], v[252:255], v[40:43], v[68:71]
    v_mfma_f32_16x16x32_bf16 v[72:75], v[40:43], v[40:43], v[72:75]
    v_mfma_f32_16x16x32_bf16 v[76:79], v[10:13], v[40:43], v[76:79]
    s_waitcnt lgkmcnt(1)
    v_mfma_f32_16x16x32_bf16 v[80:83], v[172:175], v[16:19], v[80:83]
    v_mfma_f32_16x16x32_bf16 v[84:87], v[252:255], v[16:19], v[84:87]
    s_waitcnt lgkmcnt(0)
    v_mfma_f32_16x16x32_bf16 v[88:91], v[172:175], v[20:23], v[88:91]
    v_mfma_f32_16x16x32_bf16 v[92:95], v[252:255], v[20:23], v[92:95]
    ds_read_b64_tr_b16 v[10:11], v7
    ds_read_b64_tr_b16 v[12:13], v8
    ds_read_b64_tr_b16 v[14:15], v9
    v_and_b32 v16, 15, v1
    v_lshrrev_b32 v17, 4, v1
    v_and_b32 v18, 3, v1
    v_lshrrev_b32 v19, 2, v16
    v_cmp_eq_u32 s[42:43], 1, v18
    v_cmp_eq_u32 s[44:45], 2, v18
    v_cmp_eq_u32 s[46:47], 3, v18
    v_cmp_eq_u32 s[48:49], v19, v17
    v_lshlrev_b32 v18, 3, v16
    v_add_u32 v18, 45376, v18
    v_cndmask_b32 v72, v72, v73, s[42:43]
    v_cndmask_b32 v72, v72, v74, s[44:45]
    v_cndmask_b32 v72, v72, v75, s[46:47]
    v_mul_f32 v76, 0x3acccccd, v76
    v_mul_f32 v72, 0x3acccccd, v72
    v_fma_f32 v72, -v76, v76, v72
    v_max_f32 v72, 0, v72
    v_cvt_pk_bf16_f32 v76, v76, v72
    v_and_b32 v72, 0xffff0000, v76
    v_lshlrev_b32 v76, 16, v76
    v_add_f32 v72, 0x3727c5ac, v72
    v_cvt_pk_bf16_f32 v72, v72, v72
    v_lshlrev_b32 v72, 16, v72
    v_sqrt_f32 v72, v72
    s_nop 0
    v_cvt_pk_bf16_f32 v72, v72, v72
    v_lshlrev_b32 v72, 16, v72
    v_rcp_f32 v77, v72
    s_mov_b64 exec, s[48:49]
    ds_write_b64 v18, v[76:77] offset:256
    s_mov_b64 exec, -1
    s_lshl_b32 s42, s3, 7
    s_add_u32 s42, s42, 46016
    v_lshl_add_u32 v19, v17, 4, s42
    s_mov_b64 exec, 0x10001
    s_mov_b32 exec_hi, 0x10001
    ds_write_b128 v19, v[48:51] offset:0
    ds_write_b128 v19, v[52:55] offset:64
    s_mov_b64 exec, -1
    s_lshl_b32 s42, s3, 6
    s_cmp_eq_u32 s3, 2
    s_cselect_b32 s42, 192, s42
    s_cmp_eq_u32 s3, 3
    s_cselect_b32 s42, 128, s42
    s_add_u32 s42, s42, 61440
    v_mul_u32_u24 v20, 496, v16
    v_lshl_add_u32 v20, v17, 4, v20
    v_add_u32 v20, s42, v20
    v_lshlrev_b32 v18, 3, v16
    v_add_u32 v18, 45376, v18
    s_waitcnt lgkmcnt(0)
    s_barrier
    ds_read_b64 v[26:27], v18 offset:128
    ds_read_b64 v[28:29], v18 offset:256
    ds_read_b64 v[30:31], v18 offset:384
    ds_read_b64 v[32:33], v18 offset:512
    ds_read_b128 v[36:39], v19 offset:0
    ds_read_b128 v[40:43], v19 offset:64
    s_waitcnt lgkmcnt(0)
    v_fma_f32 v56, -v26, v36, v56
    v_fma_f32 v57, -v26, v37, v57
    v_fma_f32 v58, -v26, v38, v58
    v_fma_f32 v59, -v26, v39, v59
    v_fma_f32 v60, -v26, v40, v60
    v_fma_f32 v61, -v26, v41, v61
    v_fma_f32 v62, -v26, v42, v62
    v_fma_f32 v63, -v26, v43, v63
    v_fma_f32 v64, -v28, v36, v64
    v_fma_f32 v65, -v28, v37, v65
    v_fma_f32 v66, -v28, v38, v66
    v_fma_f32 v67, -v28, v39, v67
    v_fma_f32 v68, -v28, v40, v68
    v_fma_f32 v69, -v28, v41, v69
    v_fma_f32 v70, -v28, v42, v70
    v_fma_f32 v71, -v28, v43, v71
    v_fma_f32 v80, -v30, v36, v80
    v_fma_f32 v81, -v30, v37, v81
    v_fma_f32 v82, -v30, v38, v82
    v_fma_f32 v83, -v30, v39, v83
    v_fma_f32 v84, -v30, v40, v84
    v_fma_f32 v85, -v30, v41, v85
    v_fma_f32 v86, -v30, v42, v86
    v_fma_f32 v87, -v30, v43, v87
    v_fma_f32 v88, -v32, v36, v88
    v_fma_f32 v89, -v32, v37, v89
    v_fma_f32 v90, -v32, v38, v90
    v_fma_f32 v91, -v32, v39, v91
    v_fma_f32 v92, -v32, v40, v92
    v_fma_f32 v93, -v32, v41, v93
    v_fma_f32 v94, -v32, v42, v94
    v_fma_f32 v95, -v32, v43, v95
    v_mul_f32 v56, v56, v27
    v_mul_f32 v57, v57, v27
    v_mul_f32 v58, v58, v27
    v_mul_f32 v59, v59, v27
    v_mul_f32 v60, v60, v27
    v_mul_f32 v61, v61, v27
    v_mul_f32 v62, v62, v27
    v_mul_f32 v63, v63, v27
    v_mul_f32 v64, v64, v29
    v_mul_f32 v65, v65, v29
    v_mul_f32 v66, v66, v29
    v_mul_f32 v67, v67, v29
    v_mul_f32 v68, v68, v29
    v_mul_f32 v69, v69, v29
    v_mul_f32 v70, v70, v29
    v_mul_f32 v71, v71, v29
    v_mul_f32 v80, v80, v31
    v_mul_f32 v81, v81, v31
    v_mul_f32 v82, v82, v31
    v_mul_f32 v83, v83, v31
    v_mul_f32 v84, v84, v31
    v_mul_f32 v85, v85, v31
    v_mul_f32 v86, v86, v31
    v_mul_f32 v87, v87, v31
    v_mul_f32 v88, v88, v33
    v_mul_f32 v89, v89, v33
    v_mul_f32 v90, v90, v33
    v_mul_f32 v91, v91, v33
    v_mul_f32 v92, v92, v33
    v_mul_f32 v93, v93, v33
    v_mul_f32 v94, v94, v33
    v_mul_f32 v95, v95, v33
    v_cvt_pk_bf16_f32 v56, v56, v60
    v_cvt_pk_bf16_f32 v57, v57, v61
    v_cvt_pk_bf16_f32 v58, v58, v62
    v_cvt_pk_bf16_f32 v59, v59, v63
    ds_write_b128 v20, v[56:59] offset:7936
    v_cvt_pk_bf16_f32 v64, v64, v68
    v_cvt_pk_bf16_f32 v65, v65, v69
    v_cvt_pk_bf16_f32 v66, v66, v70
    v_cvt_pk_bf16_f32 v67, v67, v71
    ds_write_b128 v20, v[64:67] offset:15872
    v_cvt_pk_bf16_f32 v80, v80, v84
    v_cvt_pk_bf16_f32 v81, v81, v85
    v_cvt_pk_bf16_f32 v82, v82, v86
    v_cvt_pk_bf16_f32 v83, v83, v87
    ds_write_b128 v20, v[80:83] offset:23808
    v_cvt_pk_bf16_f32 v88, v88, v92
    v_cvt_pk_bf16_f32 v89, v89, v93
    v_cvt_pk_bf16_f32 v90, v90, v94
    v_cvt_pk_bf16_f32 v91, v91, v95
    ds_write_b128 v20, v[88:91] offset:31744
    s_branch L_a1_post
L_g1D:
    global_load_dwordx4 v[96:99], v44, s[48:49] sc1
    global_load_dwordx4 v[176:179], v44, s[50:51] sc1
    global_load_dwordx4 v[100:103], v45, s[48:49] sc1
    global_load_dwordx4 v[180:183], v45, s[50:51] sc1
    global_load_dwordx4 v[104:107], v46, s[48:49] sc1
    global_load_dwordx4 v[184:187], v46, s[50:51] sc1
    global_load_dwordx4 v[108:111], v47, s[48:49] sc1
    global_load_dwordx4 v[188:191], v47, s[50:51] sc1
    s_add_u32 s48, s48, 4096
    s_addc_u32 s49, s49, 0
    s_add_u32 s50, s50, 4096
    s_addc_u32 s51, s51, 0
    s_waitcnt lgkmcnt(0)
    s_barrier
    global_load_dwordx4 v[112:115], v44, s[48:49] sc1
    global_load_dwordx4 v[192:195], v44, s[50:51] sc1
    global_load_dwordx4 v[116:119], v45, s[48:49] sc1
    global_load_dwordx4 v[196:199], v45, s[50:51] sc1
    global_load_dwordx4 v[120:123], v46, s[48:49] sc1
    global_load_dwordx4 v[200:203], v46, s[50:51] sc1
    global_load_dwordx4 v[124:127], v47, s[48:49] sc1
    global_load_dwordx4 v[204:207], v47, s[50:51] sc1
    s_add_u32 s48, s48, 4096
    s_addc_u32 s49, s49, 0
    s_add_u32 s50, s50, 4096
    s_addc_u32 s51, s51, 0
    ds_read_b128 v[16:19], v2 offset:0
    ds_read_b128 v[20:23], v2 offset:20480
    ds_read_b128 v[24:27], v2 offset:40960
    ds_read_b128 v[28:31], v2 offset:61440
    v_add_u32 v6, 81920, v2
    ds_read_b128 v[32:35], v6 offset:0
    ds_read_b128 v[36:39], v3 offset:0
    global_load_dwordx4 v[128:131], v44, s[48:49] sc1
    global_load_dwordx4 v[208:211], v44, s[50:51] sc1
    ds_read_b128 v[40:43], v3 offset:20480
    s_waitcnt vmcnt(16) lgkmcnt(6)
    v_mfma_f32_16x16x32_bf16 v[48:51], v[96:99], v[16:19], 0
    v_mfma_f32_16x16x32_bf16 v[52:55], v[176:179], v[16:19], 0
    v_mfma_f32_16x16x32_bf16 v[56:59], v[16:19], v[16:19], 0
    v_mfma_f32_16x16x32_bf16 v[60:63], v[10:13], v[16:19], 0
    ds_read_b128 v[16:19], v3 offset:40960
    s_waitcnt lgkmcnt(6)
    v_mfma_f32_16x16x32_bf16 v[64:67], v[96:99], v[20:23], 0
    v_mfma_f32_16x16x32_bf16 v[68:71], v[176:179], v[20:23], 0
    ds_read_b128 v[20:23], v3 offset:61440
    s_waitcnt lgkmcnt(6)
    v_mfma_f32_16x16x32_bf16 v[72:75], v[96:99], v[24:27], 0
    v_mfma_f32_16x16x32_bf16 v[76:79], v[176:179], v[24:27], 0
    v_add_u32 v6, 81920, v3
    ds_read_b128 v[24:27], v6 offset:0
    s_waitcnt lgkmcnt(6)
    v_mfma_f32_16x16x32_bf16 v[80:83], v[96:99], v[28:31], 0
    v_mfma_f32_16x16x32_bf16 v[84:87], v[176:179], v[28:31], 0
    ds_read_b128 v[28:31], v4 offset:0
    s_waitcnt lgkmcnt(6)
    v_mfma_f32_16x16x32_bf16 v[88:91], v[96:99], v[32:35], 0
    v_mfma_f32_16x16x32_bf16 v[92:95], v[176:179], v[32:35], 0
    global_load_dwordx4 v[132:135], v45, s[48:49] sc1
    global_load_dwordx4 v[212:215], v45, s[50:51] sc1
    ds_read_b128 v[32:35], v4 offset:20480
    s_waitcnt vmcnt(16) lgkmcnt(6)
    v_mfma_f32_16x16x32_bf16 v[48:51], v[100:103], v[36:39], v[48:51]
    v_mfma_f32_16x16x32_bf16 v[52:55], v[180:183], v[36:39], v[52:55]
    v_mfma_f32_16x16x32_bf16 v[56:59], v[36:39], v[36:39], v[56:59]
    v_mfma_f32_16x16x32_bf16 v[60:63], v[10:13], v[36:39], v[60:63]
    ds_read_b128 v[36:39], v4 offset:40960
    s_waitcnt lgkmcnt(6)
    v_mfma_f32_16x16x32_bf16 v[64:67], v[100:103], v[40:43], v[64:67]
    v_mfma_f32_16x16x32_bf16 v[68:71], v[180:183], v[40:43], v[68:71]
    ds_read_b128 v[40:43], v4 offset:61440
    s_waitcnt lgkmcnt(6)
    v_mfma_f32_16x16x32_bf16 v[72:75], v[100:103], v[16:19], v[72:75]
    v_mfma_f32_16x16x32_bf16 v[76:79], v[180:183], v[16:19], v[76:79]
    v_add_u32 v6, 81920, v4
    ds_read_b128 v[16:19], v6 offset:0
    s_waitcnt lgkmcnt(6)
    v_mfma_f32_16x16x32_bf16 v[80:83], v[100:103], v[20:23], v[80:83]
    v_mfma_f32_16x16x32_bf16 v[84:87], v[180:183], v[20:23], v[84:87]
    ds_read_b128 v[20:23], v5 offset:0
    s_waitcnt lgkmcnt(6)
    v_mfma_f32_16x16x32_bf16 v[88:91], v[100:103], v[24:27], v[88:91]
    v_mfma_f32_16x16x32_bf16 v[92:95], v[180:183], v[24:27], v[92:95]
    global_load_dwordx4 v[136:139], v46, s[48:49] sc1
    global_load_dwordx4 v[216:219], v46, s[50:51] sc1
    ds_read_b128 v[24:27], v5 offset:20480
    s_waitcnt vmcnt(16) lgkmcnt(6)
    v_mfma_f32_16x16x32_bf16 v[48:51], v[104:107], v[28:31], v[48:51]
    v_mfma_f32_16x16x32_bf16 v[52:55], v[184:187], v[28:31], v[52:55]
    v_mfma_f32_16x16x32_bf16 v[56:59], v[28:31], v[28:31], v[56:59]
    v_mfma_f32_16x16x32_bf16 v[60:63], v[10:13], v[28:31], v[60:63]
    ds_read_b128 v[28:31], v5 offset:40960
    s_waitcnt lgkmcnt(6)
    v_mfma_f32_16x16x32_bf16 v[64:67], v[104:107], v[32:35], v[64:67]
    v_mfma_f32_16x16x32_bf16 v[68:71], v[184:187], v[32:35], v[68:71]
    ds_read_b128 v[32:35], v5 offset:61440
    s_waitcnt lgkmcnt(6)
    v_mfma_f32_16x16x32_bf16 v[72:75], v[104:107], v[36:39], v[72:75]
    v_mfma_f32_16x16x32_bf16 v[76:79], v[184:187], v[36:39], v[76:79]
    v_add_u32 v6, 81920, v5
    ds_read_b128 v[36:39], v6 offset:0
    s_waitcnt lgkmcnt(6)
    v_mfma_f32_16x16x32_bf16 v[80:83], v[104:107], v[40:43], v[80:83]
    v_mfma_f32_16x16x32_bf16 v[84:87], v[184:187], v[40:43], v[84:87]
    ds_read_b128 v[40:43], v2 offset:256
    s_waitcnt lgkmcnt(6)
    v_mfma_f32_16x16x32_bf16 v[88:91], v[104:107], v[16:19], v[88:91]
    v_mfma_f32_16x16x32_bf16 v[92:95], v[184:187], v[16:19], v[92:95]
    global_load_dwordx4 v[140:143], v47, s[48:49] sc1
    global_load_dwordx4 v[220:223], v47, s[50:51] sc1
    s_add_u32 s48, s48, 4096
    s_addc_u32 s49, s49, 0
    s_add_u32 s50, s50, 4096
    s_addc_u32 s51, s51, 0
    ds_read_b128 v[16:19], v2 offset:20736
    s_waitcnt vmcnt(16) lgkmcnt(6)
    v_mfma_f32_16x16x32_bf16 v[48:51], v[108:111], v[20:23], v[48:51]
    v_mfma_f32_16x16x32_bf16 v[52:55], v[188:191], v[20:23], v[52:55]
    v_mfma_f32_16x16x32_bf16 v[56:59], v[20:23], v[20:23], v[56:59]
    v_mfma_f32_16x16x32_bf16 v[60:63], v[10:13], v[20:23], v[60:63]
    ds_read_b128 v[20:23], v2 offset:41216
    s_waitcnt lgkmcnt(6)
    v_mfma_f32_16x16x32_bf16 v[64:67], v[108:111], v[24:27], v[64:67]
    v_mfma_f32_16x16x32_bf16 v[68:71], v[188:191], v[24:27], v[68:71]
    ds_read_b128 v[24:27], v2 offset:61696
    s_waitcnt lgkmcnt(6)
    v_mfma_f32_16x16x32_bf16 v[72:75], v[108:111], v[28:31], v[72:75]
    v_mfma_f32_16x16x32_bf16 v[76:79], v[188:191], v[28:31], v[76:79]
    v_add_u32 v6, 81920, v2
    ds_read_b128 v[28:31], v6 offset:256
    s_waitcnt lgkmcnt(6)
    v_mfma_f32_16x16x32_bf16 v[80:83], v[108:111], v[32:35], v[80:83]
    v_mfma_f32_16x16x32_bf16 v[84:87], v[188:191], v[32:35], v[84:87]
    ds_read_b128 v[32:35], v3 offset:256
    s_waitcnt lgkmcnt(6)
    v_mfma_f32_16x16x32_bf16 v[88:91], v[108:111], v[36:39], v[88:91]
    v_mfma_f32_16x16x32_bf16 v[92:95], v[188:191], v[36:39], v[92:95]
    global_load_dwordx4 v[144:147], v44, s[48:49] sc1
    global_load_dwordx4 v[224:227], v44, s[50:51] sc1
    ds_read_b128 v[36:39], v3 offset:20736
    s_waitcnt vmcnt(16) lgkmcnt(6)
    v_mfma_f32_16x16x32_bf16 v[48:51], v[112:115], v[40:43], v[48:51]
    v_mfma_f32_16x16x32_bf16 v[52:55], v[192:195], v[40:43], v[52:55]
    v_mfma_f32_16x16x32_bf16 v[56:59], v[40:43], v[40:43], v[56:59]
    v_mfma_f32_16x16x32_bf16 v[60:63], v[10:13], v[40:43], v[60:63]
    ds_read_b128 v[40:43], v3 offset:41216
    s_waitcnt lgkmcnt(6)
    v_mfma_f32_16x16x32_bf16 v[64:67], v[112:115], v[16:19], v[64:67]
    v_mfma_f32_16x16x32_bf16 v[68:71], v[192:195], v[16:19], v[68:71]
    ds_read_b128 v[16:19], v3 offset:61696
    s_waitcnt lgkmcnt(6)
    v_mfma_f32_16x16x32_bf16 v[72:75], v[112:115], v[20:23], v[72:75]
    v_mfma_f32_16x16x32_bf16 v[76:79], v[192:195], v[20:23], v[76:79]
    v_add_u32 v6, 81920, v3
    ds_read_b128 v[20:23], v6 offset:256
    s_waitcnt lgkmcnt(6)
    v_mfma_f32_16x16x32_bf16 v[80:83], v[112:115], v[24:27], v[80:83]
    v_mfma_f32_16x16x32_bf16 v[84:87], v[192:195], v[24:27], v[84:87]
    ds_read_b128 v[24:27], v4 offset:256
    s_waitcnt lgkmcnt(6)
    v_mfma_f32_16x16x32_bf16 v[88:91], v[112:115], v[28:31], v[88:91]
    v_mfma_f32_16x16x32_bf16 v[92:95], v[192:195], v[28:31], v[92:95]
    global_load_dwordx4 v[148:151], v45, s[48:49] sc1
    global_load_dwordx4 v[228:231], v45, s[50:51] sc1
    ds_read_b128 v[28:31], v4 offset:20736
    s_waitcnt vmcnt(16) lgkmcnt(6)
    v_mfma_f32_16x16x32_bf16 v[48:51], v[116:119], v[32:35], v[48:51]
    v_mfma_f32_16x16x32_bf16 v[52:55], v[196:199], v[32:35], v[52:55]
    v_mfma_f32_16x16x32_bf16 v[56:59], v[32:35], v[32:35], v[56:59]
    v_mfma_f32_16x16x32_bf16 v[60:63], v[10:13], v[32:35], v[60:63]
    ds_read_b128 v[32:35], v4 offset:41216
    s_waitcnt lgkmcnt(6)
    v_mfma_f32_16x16x32_bf16 v[64:67], v[116:119], v[36:39], v[64:67]
    v_mfma_f32_16x16x32_bf16 v[68:71], v[196:199], v[36:39], v[68:71]
    ds_read_b128 v[36:39], v4 offset:61696
    s_waitcnt lgkmcnt(6)
    v_mfma_f32_16x16x32_bf16 v[72:75], v[116:119], v[40:43], v[72:75]
    v_mfma_f32_16x16x32_bf16 v[76:79], v[196:199], v[40:43], v[76:79]
    v_add_u32 v6, 81920, v4
    ds_read_b128 v[40:43], v6 offset:256
    s_waitcnt lgkmcnt(6)
    v_mfma_f32_16x16x32_bf16 v[80:83], v[116:119], v[16:19], v[80:83]
    v_mfma_f32_16x16x32_bf16 v[84:87], v[196:199], v[16:19], v[84:87]
    ds_read_b128 v[16:19], v5 offset:256
    s_waitcnt lgkmcnt(6)
    v_mfma_f32_16x16x32_bf16 v[88:91], v[116:119], v[20:23], v[88:91]
    v_mfma_f32_16x16x32_bf16 v[92:95], v[196:199], v[20:23], v[92:95]
    global_load_dwordx4 v[152:155], v46, s[48:49] sc1
    global_load_dwordx4 v[232:235], v46, s[50:51] sc1
    ds_read_b128 v[20:23], v5 offset:20736
    s_waitcnt vmcnt(16) lgkmcnt(6)
    v_mfma_f32_16x16x32_bf16 v[48:51], v[120:123], v[24:27], v[48:51]
    v_mfma_f32_16x16x32_bf16 v[52:55], v[200:203], v[24:27], v[52:55]
    v_mfma_f32_16x16x32_bf16 v[56:59], v[24:27], v[24:27], v[56:59]
    v_mfma_f32_16x16x32_bf16 v[60:63], v[10:13], v[24:27], v[60:63]
    ds_read_b128 v[24:27], v5 offset:41216
    s_waitcnt lgkmcnt(6)
    v_mfma_f32_16x16x32_bf16 v[64:67], v[120:123], v[28:31], v[64:67]
    v_mfma_f32_16x16x32_bf16 v[68:71], v[200:203], v[28:31], v[68:71]
    ds_read_b128 v[28:31], v5 offset:61696
    s_waitcnt lgkmcnt(6)
    v_mfma_f32_16x16x32_bf16 v[72:75], v[120:123], v[32:35], v[72:75]
    v_mfma_f32_16x16x32_bf16 v[76:79], v[200:203], v[32:35], v[76:79]
    v_add_u32 v6, 81920, v5
    ds_read_b128 v[32:35], v6 offset:256
    s_waitcnt lgkmcnt(6)
    v_mfma_f32_16x16x32_bf16 v[80:83], v[120:123], v[36:39], v[80:83]
    v_mfma_f32_16x16x32_bf16 v[84:87], v[200:203], v[36:39], v[84:87]
    ds_read_b128 v[36:39], v2 offset:512
    s_waitcnt lgkmcnt(6)
    v_mfma_f32_16x16x32_bf16 v[88:91], v[120:123], v[40:43], v[88:91]
    v_mfma_f32_16x16x32_bf16 v[92:95], v[200:203], v[40:43], v[92:95]
    global_load_dwordx4 v[156:159], v47, s[48:49] sc1
    global_load_dwordx4 v[236:239], v47, s[50:51] sc1
    s_add_u32 s48, s48, 4096
    s_addc_u32 s49, s49, 0
    s_add_u32 s50, s50, 4096
    s_addc_u32 s51, s51, 0
    ds_read_b128 v[40:43], v2 offset:20992
    s_waitcnt vmcnt(16) lgkmcnt(6)
    v_mfma_f32_16x16x32_bf16 v[48:51], v[124:127], v[16:19], v[48:51]
    v_mfma_f32_16x16x32_bf16 v[52:55], v[204:207], v[16:19], v[52:55]
    v_mfma_f32_16x16x32_bf16 v[56:59], v[16:19], v[16:19], v[56:59]
    v_mfma_f32_16x16x32_bf16 v[60:63], v[10:13], v[16:19], v[60:63]
    ds_read_b128 v[16:19], v2 offset:41472
    s_waitcnt lgkmcnt(6)
    v_mfma_f32_16x16x32_bf16 v[64:67], v[124:127], v[20:23], v[64:67]
    v_mfma_f32_16x16x32_bf16 v[68:71], v[204:207], v[20:23], v[68:71]
    ds_read_b128 v[20:23], v2 offset:61952
    s_waitcnt lgkmcnt(6)
    v_mfma_f32_16x16x32_bf16 v[72:75], v[124:127], v[24:27], v[72:75]
    v_mfma_f32_16x16x32_bf16 v[76:79], v[204:207], v[24:27], v[76:79]
    v_add_u32 v6, 81920, v2
    ds_read_b128 v[24:27], v6 offset:512
    s_waitcnt lgkmcnt(6)
    v_mfma_f32_16x16x32_bf16 v[80:83], v[124:127], v[28:31], v[80:83]
    v_mfma_f32_16x16x32_bf16 v[84:87], v[204:207], v[28:31], v[84:87]
    ds_read_b128 v[28:31], v3 offset:512
    s_waitcnt lgkmcnt(6)
    v_mfma_f32_16x16x32_bf16 v[88:91], v[124:127], v[32:35], v[88:91]
    v_mfma_f32_16x16x32_bf16 v[92:95], v[204:207], v[32:35], v[92:95]
    global_load_dwordx4 v[160:163], v44, s[48:49] sc1
    global_load_dwordx4 v[240:243], v44, s[50:51] sc1
    ds_read_b128 v[32:35], v3 offset:20992
    s_waitcnt vmcnt(16) lgkmcnt(6)
    v_mfma_f32_16x16x32_bf16 v[48:51], v[128:131], v[36:39], v[48:51]
    v_mfma_f32_16x16x32_bf16 v[52:55], v[208:211], v[36:39], v[52:55]
    v_mfma_f32_16x16x32_bf16 v[56:59], v[36:39], v[36:39], v[56:59]
    v_mfma_f32_16x16x32_bf16 v[60:63], v[10:13], v[36:39], v[60:63]
    ds_read_b128 v[36:39], v3 offset:41472
    s_waitcnt lgkmcnt(6)
    v_mfma_f32_16x16x32_bf16 v[64:67], v[128:131], v[40:43], v[64:67]
    v_mfma_f32_16x16x32_bf16 v[68:71], v[208:211], v[40:43], v[68:71]
    ds_read_b128 v[40:43], v3 offset:61952
    s_waitcnt lgkmcnt(6)
    v_mfma_f32_16x16x32_bf16 v[72:75], v[128:131], v[16:19], v[72:75]
    v_mfma_f32_16x16x32_bf16 v[76:79], v[208:211], v[16:19], v[76:79]
    v_add_u32 v6, 81920, v3
    ds_read_b128 v[16:19], v6 offset:512
    s_waitcnt lgkmcnt(6)
    v_mfma_f32_16x16x32_bf16 v[80:83], v[128:131], v[20:23], v[80:83]
    v_mfma_f32_16x16x32_bf16 v[84:87], v[208:211], v[20:23], v[84:87]
    ds_read_b128 v[20:23], v4 offset:512
    s_waitcnt lgkmcnt(6)
    v_mfma_f32_16x16x32_bf16 v[88:91], v[128:131], v[24:27], v[88:91]
    v_mfma_f32_16x16x32_bf16 v[92:95], v[208:211], v[24:27], v[92:95]
    global_load_dwordx4 v[164:167], v45, s[48:49] sc1
    global_load_dwordx4 v[244:247], v45, s[50:51] sc1
    ds_read_b128 v[24:27], v4 offset:20992
    s_waitcnt vmcnt(16) lgkmcnt(6)
    v_mfma_f32_16x16x32_bf16 v[48:51], v[132:135], v[28:31], v[48:51]
    v_mfma_f32_16x16x32_bf16 v[52:55], v[212:215], v[28:31], v[52:55]
    v_mfma_f32_16x16x32_bf16 v[56:59], v[28:31], v[28:31], v[56:59]
    v_mfma_f32_16x16x32_bf16 v[60:63], v[10:13], v[28:31], v[60:63]
    ds_read_b128 v[28:31], v4 offset:41472
    s_waitcnt lgkmcnt(6)
    v_mfma_f32_16x16x32_bf16 v[64:67], v[132:135], v[32:35], v[64:67]
    v_mfma_f32_16x16x32_bf16 v[68:71], v[212:215], v[32:35], v[68:71]
    ds_read_b128 v[32:35], v4 offset:61952
    s_waitcnt lgkmcnt(6)
    v_mfma_f32_16x16x32_bf16 v[72:75], v[132:135], v[36:39], v[72:75]
    v_mfma_f32_16x16x32_bf16 v[76:79], v[212:215], v[36:39], v[76:79]
    v_add_u32 v6, 81920, v4
    ds_read_b128 v[36:39], v6 offset:512
    s_waitcnt lgkmcnt(6)
    v_mfma_f32_16x16x32_bf16 v[80:83], v[132:135], v[40:43], v[80:83]
    v_mfma_f32_16x16x32_bf16 v[84:87], v[212:215], v[40:43], v[84:87]
    ds_read_b128 v[40:43], v5 offset:512
    s_waitcnt lgkmcnt(6)
    v_mfma_f32_16x16x32_bf16 v[88:91], v[132:135], v[16:19], v[88:91]
    v_mfma_f32_16x16x32_bf16 v[92:95], v[212:215], v[16:19], v[92:95]
    global_load_dwordx4 v[168:171], v46, s[48:49] sc1
    global_load_dwordx4 v[248:251], v46, s[50:51] sc1
    ds_read_b128 v[16:19], v5 offset:20992
    s_waitcnt vmcnt(16) lgkmcnt(6)
    v_mfma_f32_16x16x32_bf16 v[48:51], v[136:139], v[20:23], v[48:51]
    v_mfma_f32_16x16x32_bf16 v[52:55], v[216:219], v[20:23], v[52:55]
    v_mfma_f32_16x16x32_bf16 v[56:59], v[20:23], v[20:23], v[56:59]
    v_mfma_f32_16x16x32_bf16 v[60:63], v[10:13], v[20:23], v[60:63]
    ds_read_b128 v[20:23], v5 offset:41472
    s_waitcnt lgkmcnt(6)
    v_mfma_f32_16x16x32_bf16 v[64:67], v[136:139], v[24:27], v[64:67]
    v_mfma_f32_16x16x32_bf16 v[68:71], v[216:219], v[24:27], v[68:71]
    ds_read_b128 v[24:27], v5 offset:61952
    s_waitcnt lgkmcnt(6)
    v_mfma_f32_16x16x32_bf16 v[72:75], v[136:139], v[28:31], v[72:75]
    v_mfma_f32_16x16x32_bf16 v[76:79], v[216:219], v[28:31], v[76:79]
    v_add_u32 v6, 81920, v5
    ds_read_b128 v[28:31], v6 offset:512
    s_waitcnt lgkmcnt(6)
    v_mfma_f32_16x16x32_bf16 v[80:83], v[136:139], v[32:35], v[80:83]
    v_mfma_f32_16x16x32_bf16 v[84:87], v[216:219], v[32:35], v[84:87]
    ds_read_b128 v[32:35], v2 offset:768
    s_waitcnt lgkmcnt(6)
    v_mfma_f32_16x16x32_bf16 v[88:91], v[136:139], v[36:39], v[88:91]
    v_mfma_f32_16x16x32_bf16 v[92:95], v[216:219], v[36:39], v[92:95]
    global_load_dwordx4 v[172:175], v47, s[48:49] sc1
    global_load_dwordx4 v[252:255], v47, s[50:51] sc1
    ds_read_b128 v[36:39], v2 offset:21248
    s_waitcnt vmcnt(16) lgkmcnt(6)
    v_mfma_f32_16x16x32_bf16 v[48:51], v[140:143], v[40:43], v[48:51]
    v_mfma_f32_16x16x32_bf16 v[52:55], v[220:223], v[40:43], v[52:55]
    v_mfma_f32_16x16x32_bf16 v[56:59], v[40:43], v[40:43], v[56:59]
    v_mfma_f32_16x16x32_bf16 v[60:63], v[10:13], v[40:43], v[60:63]
    ds_read_b128 v[40:43], v2 offset:41728
    s_waitcnt lgkmcnt(6)
    v_mfma_f32_16x16x32_bf16 v[64:67], v[140:143], v[16:19], v[64:67]
    v_mfma_f32_16x16x32_bf16 v[68:71], v[220:223], v[16:19], v[68:71]
    ds_read_b128 v[16:19], v2 offset:62208
    s_waitcnt lgkmcnt(6)
    v_mfma_f32_16x16x32_bf16 v[72:75], v[140:143], v[20:23], v[72:75]
    v_mfma_f32_16x16x32_bf16 v[76:79], v[220:223], v[20:23], v[76:79]
    v_add_u32 v6, 81920, v2
    ds_read_b128 v[20:23], v6 offset:768
    s_waitcnt lgkmcnt(6)
    v_mfma_f32_16x16x32_bf16 v[80:83], v[140:143], v[24:27], v[80:83]
    v_mfma_f32_16x16x32_bf16 v[84:87], v[220:223], v[24:27], v[84:87]
    ds_read_b128 v[24:27], v3 offset:768
    s_waitcnt lgkmcnt(6)
    v_mfma_f32_16x16x32_bf16 v[88:91], v[140:143], v[28:31], v[88:91]
    v_mfma_f32_16x16x32_bf16 v[92:95], v[220:223], v[28:31], v[92:95]
    ds_read_b128 v[28:31], v3 offset:21248
    s_waitcnt vmcnt(14) lgkmcnt(6)
    v_mfma_f32_16x16x32_bf16 v[48:51], v[144:147], v[32:35], v[48:51]
    v_mfma_f32_16x16x32_bf16 v[52:55], v[224:227], v[32:35], v[52:55]
    v_mfma_f32_16x16x32_bf16 v[56:59], v[32:35], v[32:35], v[56:59]
    v_mfma_f32_16x16x32_bf16 v[60:63], v[10:13], v[32:35], v[60:63]
    ds_read_b128 v[32:35], v3 offset:41728
    s_waitcnt lgkmcnt(6)
    v_mfma_f32_16x16x32_bf16 v[64:67], v[144:147], v[36:39], v[64:67]
    v_mfma_f32_16x16x32_bf16 v[68:71], v[224:227], v[36:39], v[68:71]
    ds_read_b128 v[36:39], v3 offset:62208
    s_waitcnt lgkmcnt(6)
    v_mfma_f32_16x16x32_bf16 v[72:75], v[144:147], v[40:43], v[72:75]
    v_mfma_f32_16x16x32_bf16 v[76:79], v[224:227], v[40:43], v[76:79]
    v_add_u32 v6, 81920, v3
    ds_read_b128 v[40:43], v6 offset:768
    s_waitcnt lgkmcnt(6)
    v_mfma_f32_16x16x32_bf16 v[80:83], v[144:147], v[16:19], v[80:83]
    v_mfma_f32_16x16x32_bf16 v[84:87], v[224:227], v[16:19], v[84:87]
    ds_read_b128 v[16:19], v4 offset:768
    s_waitcnt lgkmcnt(6)
    v_mfma_f32_16x16x32_bf16 v[88:91], v[144:147], v[20:23], v[88:91]
    v_mfma_f32_16x16x32_bf16 v[92:95], v[224:227], v[20:23], v[92:95]
    ds_read_b128 v[20:23], v4 offset:21248
    s_waitcnt vmcnt(12) lgkmcnt(6)
    v_mfma_f32_16x16x32_bf16 v[48:51], v[148:151], v[24:27], v[48:51]
    v_mfma_f32_16x16x32_bf16 v[52:55], v[228:231], v[24:27], v[52:55]
    v_mfma_f32_16x16x32_bf16 v[56:59], v[24:27], v[24:27], v[56:59]
    v_mfma_f32_16x16x32_bf16 v[60:63], v[10:13], v[24:27], v[60:63]
    ds_read_b128 v[24:27], v4 offset:41728
    s_waitcnt lgkmcnt(6)
    v_mfma_f32_16x16x32_bf16 v[64:67], v[148:151], v[28:31], v[64:67]
    v_mfma_f32_16x16x32_bf16 v[68:71], v[228:231], v[28:31], v[68:71]
    ds_read_b128 v[28:31], v4 offset:62208
    s_waitcnt lgkmcnt(6)
    v_mfma_f32_16x16x32_bf16 v[72:75], v[148:151], v[32:35], v[72:75]
    v_mfma_f32_16x16x32_bf16 v[76:79], v[228:231], v[32:35], v[76:79]
    v_add_u32 v6, 81920, v4
    ds_read_b128 v[32:35], v6 offset:768
    s_waitcnt lgkmcnt(6)
    v_mfma_f32_16x16x32_bf16 v[80:83], v[148:151], v[36:39], v[80:83]
    v_mfma_f32_16x16x32_bf16 v[84:87], v[228:231], v[36:39], v[84:87]
    ds_read_b128 v[36:39], v5 offset:768
    s_waitcnt lgkmcnt(6)
    v_mfma_f32_16x16x32_bf16 v[88:91], v[148:151], v[40:43], v[88:91]
    v_mfma_f32_16x16x32_bf16 v[92:95], v[228:231], v[40:43], v[92:95]
    ds_read_b128 v[40:43], v5 offset:21248
    s_waitcnt vmcnt(10) lgkmcnt(6)
    v_mfma_f32_16x16x32_bf16 v[48:51], v[152:155], v[16:19], v[48:51]
    v_mfma_f32_16x16x32_bf16 v[52:55], v[232:235], v[16:19], v[52:55]
    v_mfma_f32_16x16x32_bf16 v[56:59], v[16:19], v[16:19], v[56:59]
    v_mfma_f32_16x16x32_bf16 v[60:63], v[10:13], v[16:19], v[60:63]
    ds_read_b128 v[16:19], v5 offset:41728
    s_waitcnt lgkmcnt(6)
    v_mfma_f32_16x16x32_bf16 v[64:67], v[152:155], v[20:23], v[64:67]
    v_mfma_f32_16x16x32_bf16 v[68:71], v[232:235], v[20:23], v[68:71]
    ds_read_b128 v[20:23], v5 offset:62208
    s_waitcnt lgkmcnt(6)
    v_mfma_f32_16x16x32_bf16 v[72:75], v[152:155], v[24:27], v[72:75]
    v_mfma_f32_16x16x32_bf16 v[76:79], v[232:235], v[24:27], v[76:79]
    v_add_u32 v6, 81920, v5
    ds_read_b128 v[24:27], v6 offset:768
    s_waitcnt lgkmcnt(6)
    v_mfma_f32_16x16x32_bf16 v[80:83], v[152:155], v[28:31], v[80:83]
    v_mfma_f32_16x16x32_bf16 v[84:87], v[232:235], v[28:31], v[84:87]
    ds_read_b128 v[28:31], v2 offset:1024
    s_waitcnt lgkmcnt(6)
    v_mfma_f32_16x16x32_bf16 v[88:91], v[152:155], v[32:35], v[88:91]
    v_mfma_f32_16x16x32_bf16 v[92:95], v[232:235], v[32:35], v[92:95]
    ds_read_b128 v[32:35], v2 offset:21504
    s_waitcnt vmcnt(8) lgkmcnt(6)
    v_mfma_f32_16x16x32_bf16 v[48:51], v[156:159], v[36:39], v[48:51]
    v_mfma_f32_16x16x32_bf16 v[52:55], v[236:239], v[36:39], v[52:55]
    v_mfma_f32_16x16x32_bf16 v[56:59], v[36:39], v[36:39], v[56:59]
    v_mfma_f32_16x16x32_bf16 v[60:63], v[10:13], v[36:39], v[60:63]
    ds_read_b128 v[36:39], v2 offset:41984
    s_waitcnt lgkmcnt(6)
    v_mfma_f32_16x16x32_bf16 v[64:67], v[156:159], v[40:43], v[64:67]
    v_mfma_f32_16x16x32_bf16 v[68:71], v[236:239], v[40:43], v[68:71]
    ds_read_b128 v[40:43], v2 offset:62464
    s_waitcnt lgkmcnt(6)
    v_mfma_f32_16x16x32_bf16 v[72:75], v[156:159], v[16:19], v[72:75]
    v_mfma_f32_16x16x32_bf16 v[76:79], v[236:239], v[16:19], v[76:79]
    v_add_u32 v6, 81920, v2
    ds_read_b128 v[16:19], v6 offset:1024
    s_waitcnt lgkmcnt(6)
    v_mfma_f32_16x16x32_bf16 v[80:83], v[156:159], v[20:23], v[80:83]
    v_mfma_f32_16x16x32_bf16 v[84:87], v[236:239], v[20:23], v[84:87]
    ds_read_b128 v[20:23], v3 offset:1024
    s_waitcnt lgkmcnt(6)
    v_mfma_f32_16x16x32_bf16 v[88:91], v[156:159], v[24:27], v[88:91]
    v_mfma_f32_16x16x32_bf16 v[92:95], v[236:239], v[24:27], v[92:95]
    ds_read_b128 v[24:27], v3 offset:21504
    s_waitcnt vmcnt(6) lgkmcnt(6)
    v_mfma_f32_16x16x32_bf16 v[48:51], v[160:163], v[28:31], v[48:51]
    v_mfma_f32_16x16x32_bf16 v[52:55], v[240:243], v[28:31], v[52:55]
    v_mfma_f32_16x16x32_bf16 v[56:59], v[28:31], v[28:31], v[56:59]
    v_mfma_f32_16x16x32_bf16 v[60:63], v[10:13], v[28:31], v[60:63]
    ds_read_b128 v[28:31], v3 offset:41984
    s_waitcnt lgkmcnt(6)
    v_mfma_f32_16x16x32_bf16 v[64:67], v[160:163], v[32:35], v[64:67]
    v_mfma_f32_16x16x32_bf16 v[68:71], v[240:243], v[32:35], v[68:71]
    ds_read_b128 v[32:35], v3 offset:62464
    s_waitcnt lgkmcnt(6)
    v_mfma_f32_16x16x32_bf16 v[72:75], v[160:163], v[36:39], v[72:75]
    v_mfma_f32_16x16x32_bf16 v[76:79], v[240:243], v[36:39], v[76:79]
    v_add_u32 v6, 81920, v3
    ds_read_b128 v[36:39], v6 offset:1024
    s_waitcnt lgkmcnt(6)
    v_mfma_f32_16x16x32_bf16 v[80:83], v[160:163], v[40:43], v[80:83]
    v_mfma_f32_16x16x32_bf16 v[84:87], v[240:243], v[40:43], v[84:87]
    ds_read_b128 v[40:43], v4 offset:1024
    s_waitcnt lgkmcnt(6)
    v_mfma_f32_16x16x32_bf16 v[88:91], v[160:163], v[16:19], v[88:91]
    v_mfma_f32_16x16x32_bf16 v[92:95], v[240:243], v[16:19], v[92:95]
    ds_read_b128 v[16:19], v4 offset:21504
    s_waitcnt vmcnt(4) lgkmcnt(6)
    v_mfma_f32_16x16x32_bf16 v[48:51], v[164:167], v[20:23], v[48:51]
    v_mfma_f32_16x16x32_bf16 v[52:55], v[244:247], v[20:23], v[52:55]
    v_mfma_f32_16x16x32_bf16 v[56:59], v[20:23], v[20:23], v[56:59]
    v_mfma_f32_16x16x32_bf16 v[60:63], v[10:13], v[20:23], v[60:63]
    ds_read_b128 v[20:23], v4 offset:41984
    s_waitcnt lgkmcnt(6)
    v_mfma_f32_16x16x32_bf16 v[64:67], v[164:167], v[24:27], v[64:67]
    v_mfma_f32_16x16x32_bf16 v[68:71], v[244:247], v[24:27], v[68:71]
    ds_read_b128 v[24:27], v4 offset:62464
    s_waitcnt lgkmcnt(6)
    v_mfma_f32_16x16x32_bf16 v[72:75], v[164:167], v[28:31], v[72:75]
    v_mfma_f32_16x16x32_bf16 v[76:79], v[244:247], v[28:31], v[76:79]
    v_add_u32 v6, 81920, v4
    ds_read_b128 v[28:31], v6 offset:1024
    s_waitcnt lgkmcnt(6)
    v_mfma_f32_16x16x32_bf16 v[80:83], v[164:167], v[32:35], v[80:83]
    v_mfma_f32_16x16x32_bf16 v[84:87], v[244:247], v[32:35], v[84:87]
    ds_read_b128 v[32:35], v5 offset:1024
    s_waitcnt lgkmcnt(6)
    v_mfma_f32_16x16x32_bf16 v[88:91], v[164:167], v[36:39], v[88:91]
    v_mfma_f32_16x16x32_bf16 v[92:95], v[244:247], v[36:39], v[92:95]
    ds_read_b128 v[36:39], v5 offset:21504
    s_waitcnt vmcnt(2) lgkmcnt(6)
    v_mfma_f32_16x16x32_bf16 v[48:51], v[168:171], v[40:43], v[48:51]
    v_mfma_f32_16x16x32_bf16 v[52:55], v[248:251], v[40:43], v[52:55]
    v_mfma_f32_16x16x32_bf16 v[56:59], v[40:43], v[40:43], v[56:59]
    v_mfma_f32_16x16x32_bf16 v[60:63], v[10:13], v[40:43], v[60:63]
    ds_read_b128 v[40:43], v5 offset:41984
    s_waitcnt lgkmcnt(6)
    v_mfma_f32_16x16x32_bf16 v[64:67], v[168:171], v[16:19], v[64:67]
    v_mfma_f32_16x16x32_bf16 v[68:71], v[248:251], v[16:19], v[68:71]
    ds_read_b128 v[16:19], v5 offset:62464
    s_waitcnt lgkmcnt(6)
    v_mfma_f32_16x16x32_bf16 v[72:75], v[168:171], v[20:23], v[72:75]
    v_mfma_f32_16x16x32_bf16 v[76:79], v[248:251], v[20:23], v[76:79]
    v_add_u32 v6, 81920, v5
    ds_read_b128 v[20:23], v6 offset:1024
    s_waitcnt lgkmcnt(6)
    v_mfma_f32_16x16x32_bf16 v[80:83], v[168:171], v[24:27], v[80:83]
    v_mfma_f32_16x16x32_bf16 v[84:87], v[248:251], v[24:27], v[84:87]
    s_waitcnt lgkmcnt(5)
    v_mfma_f32_16x16x32_bf16 v[88:91], v[168:171], v[28:31], v[88:91]
    v_mfma_f32_16x16x32_bf16 v[92:95], v[248:251], v[28:31], v[92:95]
    s_waitcnt vmcnt(0) lgkmcnt(4)
    v_mfma_f32_16x16x32_bf16 v[48:51], v[172:175], v[32:35], v[48:51]
    v_mfma_f32_16x16x32_bf16 v[52:55], v[252:255], v[32:35], v[52:55]
    v_mfma_f32_16x16x32_bf16 v[56:59], v[32:35], v[32:35], v[56:59]
    v_mfma_f32_16x16x32_bf16 v[60:63], v[10:13], v[32:35], v[60:63]
    s_waitcnt lgkmcnt(3)
    v_mfma_f32_16x16x32_bf16 v[64:67], v[172:175], v[36:39], v[64:67]
    v_mfma_f32_16x16x32_bf16 v[68:71], v[252:255], v[36:39], v[68:71]
    s_waitcnt lgkmcnt(2)
    v_mfma_f32_16x16x32_bf16 v[72:75], v[172:175], v[40:43], v[72:75]
    v_mfma_f32_16x16x32_bf16 v[76:79], v[252:255], v[40:43], v[76:79]
    s_waitcnt lgkmcnt(1)
    v_mfma_f32_16x16x32_bf16 v[80:83], v[172:175], v[16:19], v[80:83]
    v_mfma_f32_16x16x32_bf16 v[84:87], v[252:255], v[16:19], v[84:87]
    s_waitcnt lgkmcnt(0)
    v_mfma_f32_16x16x32_bf16 v[88:91], v[172:175], v[20:23], v[88:91]
    v_mfma_f32_16x16x32_bf16 v[92:95], v[252:255], v[20:23], v[92:95]
    ds_read_b64_tr_b16 v[10:11], v7
    ds_read_b64_tr_b16 v[12:13], v8
    ds_read_b64_tr_b16 v[14:15], v9
    v_and_b32 v16, 15, v1
    v_lshrrev_b32 v17, 4, v1
    v_and_b32 v18, 3, v1
    v_lshrrev_b32 v19, 2, v16
    v_cmp_eq_u32 s[42:43], 1, v18
    v_cmp_eq_u32 s[44:45], 2, v18
    v_cmp_eq_u32 s[46:47], 3, v18
    v_cmp_eq_u32 s[48:49], v19, v17
    v_lshlrev_b32 v18, 3, v16
    v_add_u32 v18, 45376, v18
    v_cndmask_b32 v56, v56, v57, s[42:43]
    v_cndmask_b32 v56, v56, v58, s[44:45]
    v_cndmask_b32 v56, v56, v59, s[46:47]
    v_mul_f32 v60, 0x3acccccd, v60
    v_mul_f32 v56, 0x3acccccd, v56
    v_fma_f32 v56, -v60, v60, v56
    v_max_f32 v56, 0, v56
    v_cvt_pk_bf16_f32 v60, v60, v56
    v_and_b32 v56, 0xffff0000, v60
    v_lshlrev_b32 v60, 16, v60
    v_add_f32 v56, 0x3727c5ac, v56
    v_cvt_pk_bf16_f32 v56, v56, v56
    v_lshlrev_b32 v56, 16, v56
    v_sqrt_f32 v56, v56
    s_nop 0
    v_cvt_pk_bf16_f32 v56, v56, v56
    v_lshlrev_b32 v56, 16, v56
    v_rcp_f32 v61, v56
    s_mov_b64 exec, s[48:49]
    ds_write_b64 v18, v[60:61] offset:0
    s_mov_b64 exec, -1
    s_lshl_b32 s42, s3, 7
    s_add_u32 s42, s42, 46016
    v_lshl_add_u32 v19, v17, 4, s42
    s_mov_b64 exec, 0x10001
    s_mov_b32 exec_hi, 0x10001
    ds_write_b128 v19, v[48:51] offset:0
    ds_write_b128 v19, v[52:55] offset:64
    s_mov_b64 exec, -1
    s_lshl_b32 s42, s3, 6
    s_cmp_eq_u32 s3, 2
    s_cselect_b32 s42, 192, s42
    s_cmp_eq_u32 s3, 3
    s_cselect_b32 s42, 128, s42
    s_add_u32 s42, s42, 61440
    v_mul_u32_u24 v20, 496, v16
    v_lshl_add_u32 v20, v17, 3, v20
    v_add_u32 v20, s42, v20
    v_lshlrev_b32 v18, 3, v16
    v_add_u32 v18, 45376, v18
    s_waitcnt lgkmcnt(0)
    s_barrier
    ds_read_b64 v[24:25], v18 offset:0
    ds_read_b64 v[26:27], v18 offset:128
    ds_read_b64 v[28:29], v18 offset:256
    ds_read_b64 v[30:31], v18 offset:384
    ds_read_b64 v[32:33], v18 offset:512
    ds_read_b128 v[36:39], v19 offset:0
    ds_read_b128 v[40:43], v19 offset:64
    s_waitcnt lgkmcnt(0)
    v_fma_f32 v52, -v24, v40, v52
    v_fma_f32 v53, -v24, v41, v53
    v_fma_f32 v54, -v24, v42, v54
    v_fma_f32 v55, -v24, v43, v55
    v_fma_f32 v64, -v26, v36, v64
    v_fma_f32 v65, -v26, v37, v65
    v_fma_f32 v66, -v26, v38, v66
    v_fma_f32 v67, -v26, v39, v67
    v_fma_f32 v68, -v26, v40, v68
    v_fma_f32 v69, -v26, v41, v69
    v_fma_f32 v70, -v26, v42, v70
    v_fma_f32 v71, -v26, v43, v71
    v_fma_f32 v72, -v28, v36, v72
    v_fma_f32 v73, -v28, v37, v73
    v_fma_f32 v74, -v28, v38, v74
    v_fma_f32 v75, -v28, v39, v75
    v_fma_f32 v76, -v28, v40, v76
    v_fma_f32 v77, -v28, v41, v77
    v_fma_f32 v78, -v28, v42, v78
    v_fma_f32 v79, -v28, v43, v79
    v_fma_f32 v80, -v30, v36, v80
    v_fma_f32 v81, -v30, v37, v81
    v_fma_f32 v82, -v30, v38, v82
    v_fma_f32 v83, -v30, v39, v83
    v_fma_f32 v84, -v30, v40, v84
    v_fma_f32 v85, -v30, v41, v85
    v_fma_f32 v86, -v30, v42, v86
    v_fma_f32 v87, -v30, v43, v87
    v_fma_f32 v88, -v32, v36, v88
    v_fma_f32 v89, -v32, v37, v89
    v_fma_f32 v90, -v32, v38, v90
    v_fma_f32 v91, -v32, v39, v91
    v_fma_f32 v92, -v32, v40, v92
    v_fma_f32 v93, -v32, v41, v93
    v_fma_f32 v94, -v32, v42, v94
    v_fma_f32 v95, -v32, v43, v95
    v_mul_f32 v52, v52, v25
    v_mul_f32 v53, v53, v25
    v_mul_f32 v54, v54, v25
    v_mul_f32 v55, v55, v25
    v_mul_f32 v64, v64, v27
    v_mul_f32 v65, v65, v27
    v_mul_f32 v66, v66, v27
    v_mul_f32 v67, v67, v27
    v_mul_f32 v68, v68, v27
    v_mul_f32 v69, v69, v27
    v_mul_f32 v70, v70, v27
    v_mul_f32 v71, v71, v27
    v_mul_f32 v72, v72, v29
    v_mul_f32 v73, v73, v29
    v_mul_f32 v74, v74, v29
    v_mul_f32 v75, v75, v29
    v_mul_f32 v76, v76, v29
    v_mul_f32 v77, v77, v29
    v_mul_f32 v78, v78, v29
    v_mul_f32 v79, v79, v29
    v_mul_f32 v80, v80, v31
    v_mul_f32 v81, v81, v31
    v_mul_f32 v82, v82, v31
    v_mul_f32 v83, v83, v31
    v_mul_f32 v84, v84, v31
    v_mul_f32 v85, v85, v31
    v_mul_f32 v86, v86, v31
    v_mul_f32 v87, v87, v31
    v_mul_f32 v88, v88, v33
    v_mul_f32 v89, v89, v33
    v_mul_f32 v90, v90, v33
    v_mul_f32 v91, v91, v33
    v_mul_f32 v92, v92, v33
    v_mul_f32 v93, v93, v33
    v_mul_f32 v94, v94, v33
    v_mul_f32 v95, v95, v33
    v_cvt_pk_bf16_f32 v52, v52, v53
    v_cvt_pk_bf16_f32 v53, v54, v55
    ds_write_b64 v20, v[52:53] offset:32
    v_cvt_pk_bf16_f32 v64, v64, v65
    v_cvt_pk_bf16_f32 v65, v66, v67
    ds_write_b64 v20, v[64:65] offset:7936
    v_cvt_pk_bf16_f32 v68, v68, v69
    v_cvt_pk_bf16_f32 v69, v70, v71
    ds_write_b64 v20, v[68:69] offset:7968
    v_cvt_pk_bf16_f32 v72, v72, v73
    v_cvt_pk_bf16_f32 v73, v74, v75
    ds_write_b64 v20, v[72:73] offset:15872
    v_cvt_pk_bf16_f32 v76, v76, v77
    v_cvt_pk_bf16_f32 v77, v78, v79
    ds_write_b64 v20, v[76:77] offset:15904
    v_cvt_pk_bf16_f32 v80, v80, v81
    v_cvt_pk_bf16_f32 v81, v82, v83
    ds_write_b64 v20, v[80:81] offset:23808
    v_cvt_pk_bf16_f32 v84, v84, v85
    v_cvt_pk_bf16_f32 v85, v86, v87
    ds_write_b64 v20, v[84:85] offset:23840
    v_cvt_pk_bf16_f32 v88, v88, v89
    v_cvt_pk_bf16_f32 v89, v90, v91
    ds_write_b64 v20, v[88:89] offset:31744
    v_cvt_pk_bf16_f32 v92, v92, v93
    v_cvt_pk_bf16_f32 v93, v94, v95
    ds_write_b64 v20, v[92:93] offset:31776
    s_branch L_a1_post
L_g1E:
    global_load_dwordx4 v[96:99], v44, s[48:49] sc1
    global_load_dwordx4 v[100:103], v45, s[48:49] sc1
    global_load_dwordx4 v[104:107], v46, s[48:49] sc1
    global_load_dwordx4 v[108:111], v47, s[48:49] sc1
    s_add_u32 s48, s48, 4096
    s_addc_u32 s49, s49, 0
    s_waitcnt lgkmcnt(0)
    s_barrier
    global_load_dwordx4 v[112:115], v44, s[48:49] sc1
    global_load_dwordx4 v[116:119], v45, s[48:49] sc1
    global_load_dwordx4 v[120:123], v46, s[48:49] sc1
    global_load_dwordx4 v[124:127], v47, s[48:49] sc1
    s_add_u32 s48, s48, 4096
    s_addc_u32 s49, s49, 0
    ds_read_b128 v[16:19], v2 offset:0
    ds_read_b128 v[20:23], v2 offset:20480
    ds_read_b128 v[24:27], v2 offset:40960
    ds_read_b128 v[28:31], v2 offset:61440
    v_add_u32 v6, 81920, v2
    ds_read_b128 v[32:35], v6 offset:0
    ds_read_b128 v[36:39], v3 offset:0
    global_load_dwordx4 v[128:131], v44, s[48:49] sc1
    ds_read_b128 v[40:43], v3 offset:20480
    s_waitcnt vmcnt(8) lgkmcnt(6)
    v_mfma_f32_16x16x32_bf16 v[48:51], v[96:99], v[16:19], 0
    ds_read_b128 v[16:19], v3 offset:40960
    s_waitcnt lgkmcnt(6)
    v_mfma_f32_16x16x32_bf16 v[52:55], v[96:99], v[20:23], 0
    ds_read_b128 v[20:23], v3 offset:61440
    s_waitcnt lgkmcnt(6)
    v_mfma_f32_16x16x32_bf16 v[56:59], v[96:99], v[24:27], 0
    v_add_u32 v6, 81920, v3
    ds_read_b128 v[24:27], v6 offset:0
    s_waitcnt lgkmcnt(6)
    v_mfma_f32_16x16x32_bf16 v[60:63], v[96:99], v[28:31], 0
    v_mfma_f32_16x16x32_bf16 v[64:67], v[28:31], v[28:31], 0
    v_mfma_f32_16x16x32_bf16 v[68:71], v[10:13], v[28:31], 0
    ds_read_b128 v[28:31], v4 offset:0
    s_waitcnt lgkmcnt(6)
    v_mfma_f32_16x16x32_bf16 v[72:75], v[96:99], v[32:35], 0
    v_mfma_f32_16x16x32_bf16 v[76:79], v[32:35], v[32:35], 0
    v_mfma_f32_16x16x32_bf16 v[80:83], v[10:13], v[32:35], 0
    global_load_dwordx4 v[132:135], v45, s[48:49] sc1
    ds_read_b128 v[32:35], v4 offset:20480
    s_waitcnt vmcnt(8) lgkmcnt(6)
    v_mfma_f32_16x16x32_bf16 v[48:51], v[100:103], v[36:39], v[48:51]
    ds_read_b128 v[36:39], v4 offset:40960
    s_waitcnt lgkmcnt(6)
    v_mfma_f32_16x16x32_bf16 v[52:55], v[100:103], v[40:43], v[52:55]
    ds_read_b128 v[40:43], v4 offset:61440
    s_waitcnt lgkmcnt(6)
    v_mfma_f32_16x16x32_bf16 v[56:59], v[100:103], v[16:19], v[56:59]
    v_add_u32 v6, 81920, v4
    ds_read_b128 v[16:19], v6 offset:0
    s_waitcnt lgkmcnt(6)
    v_mfma_f32_16x16x32_bf16 v[60:63], v[100:103], v[20:23], v[60:63]
    v_mfma_f32_16x16x32_bf16 v[64:67], v[20:23], v[20:23], v[64:67]
    v_mfma_f32_16x16x32_bf16 v[68:71], v[10:13], v[20:23], v[68:71]
    ds_read_b128 v[20:23], v5 offset:0
    s_waitcnt lgkmcnt(6)
    v_mfma_f32_16x16x32_bf16 v[72:75], v[100:103], v[24:27], v[72:75]
    v_mfma_f32_16x16x32_bf16 v[76:79], v[24:27], v[24:27], v[76:79]
    v_mfma_f32_16x16x32_bf16 v[80:83], v[10:13], v[24:27], v[80:83]
    global_load_dwordx4 v[136:139], v46, s[48:49] sc1
    ds_read_b128 v[24:27], v5 offset:20480
    s_waitcnt vmcnt(8) lgkmcnt(6)
    v_mfma_f32_16x16x32_bf16 v[48:51], v[104:107], v[28:31], v[48:51]
    ds_read_b128 v[28:31], v5 offset:40960
    s_waitcnt lgkmcnt(6)
    v_mfma_f32_16x16x32_bf16 v[52:55], v[104:107], v[32:35], v[52:55]
    ds_read_b128 v[32:35], v5 offset:61440
    s_waitcnt lgkmcnt(6)
    v_mfma_f32_16x16x32_bf16 v[56:59], v[104:107], v[36:39], v[56:59]
    v_add_u32 v6, 81920, v5
    ds_read_b128 v[36:39], v6 offset:0
    s_waitcnt lgkmcnt(6)
    v_mfma_f32_16x16x32_bf16 v[60:63], v[104:107], v[40:43], v[60:63]
    v_mfma_f32_16x16x32_bf16 v[64:67], v[40:43], v[40:43], v[64:67]
    v_mfma_f32_16x16x32_bf16 v[68:71], v[10:13], v[40:43], v[68:71]
    ds_read_b128 v[40:43], v2 offset:256
    s_waitcnt lgkmcnt(6)
    v_mfma_f32_16x16x32_bf16 v[72:75], v[104:107], v[16:19], v[72:75]
    v_mfma_f32_16x16x32_bf16 v[76:79], v[16:19], v[16:19], v[76:79]
    v_mfma_f32_16x16x32_bf16 v[80:83], v[10:13], v[16:19], v[80:83]
    global_load_dwordx4 v[140:143], v47, s[48:49] sc1
    s_add_u32 s48, s48, 4096
    s_addc_u32 s49, s49, 0
    ds_read_b128 v[16:19], v2 offset:20736
    s_waitcnt vmcnt(8) lgkmcnt(6)
    v_mfma_f32_16x16x32_bf16 v[48:51], v[108:111], v[20:23], v[48:51]
    ds_read_b128 v[20:23], v2 offset:41216
    s_waitcnt lgkmcnt(6)
    v_mfma_f32_16x16x32_bf16 v[52:55], v[108:111], v[24:27], v[52:55]
    ds_read_b128 v[24:27], v2 offset:61696
    s_waitcnt lgkmcnt(6)
    v_mfma_f32_16x16x32_bf16 v[56:59], v[108:111], v[28:31], v[56:59]
    v_add_u32 v6, 81920, v2
    ds_read_b128 v[28:31], v6 offset:256
    s_waitcnt lgkmcnt(6)
    v_mfma_f32_16x16x32_bf16 v[60:63], v[108:111], v[32:35], v[60:63]
    v_mfma_f32_16x16x32_bf16 v[64:67], v[32:35], v[32:35], v[64:67]
    v_mfma_f32_16x16x32_bf16 v[68:71], v[10:13], v[32:35], v[68:71]
    ds_read_b128 v[32:35], v3 offset:256
    s_waitcnt lgkmcnt(6)
    v_mfma_f32_16x16x32_bf16 v[72:75], v[108:111], v[36:39], v[72:75]
    v_mfma_f32_16x16x32_bf16 v[76:79], v[36:39], v[36:39], v[76:79]
    v_mfma_f32_16x16x32_bf16 v[80:83], v[10:13], v[36:39], v[80:83]
    global_load_dwordx4 v[144:147], v44, s[48:49] sc1
    ds_read_b128 v[36:39], v3 offset:20736
    s_waitcnt vmcnt(8) lgkmcnt(6)
    v_mfma_f32_16x16x32_bf16 v[48:51], v[112:115], v[40:43], v[48:51]
    ds_read_b128 v[40:43], v3 offset:41216
    s_waitcnt lgkmcnt(6)
    v_mfma_f32_16x16x32_bf16 v[52:55], v[112:115], v[16:19], v[52:55]
    ds_read_b128 v[16:19], v3 offset:61696
    s_waitcnt lgkmcnt(6)
    v_mfma_f32_16x16x32_bf16 v[56:59], v[112:115], v[20:23], v[56:59]
    v_add_u32 v6, 81920, v3
    ds_read_b128 v[20:23], v6 offset:256
    s_waitcnt lgkmcnt(6)
    v_mfma_f32_16x16x32_bf16 v[60:63], v[112:115], v[24:27], v[60:63]
    v_mfma_f32_16x16x32_bf16 v[64:67], v[24:27], v[24:27], v[64:67]
    v_mfma_f32_16x16x32_bf16 v[68:71], v[10:13], v[24:27], v[68:71]
    ds_read_b128 v[24:27], v4 offset:256
    s_waitcnt lgkmcnt(6)
    v_mfma_f32_16x16x32_bf16 v[72:75], v[112:115], v[28:31], v[72:75]
    v_mfma_f32_16x16x32_bf16 v[76:79], v[28:31], v[28:31], v[76:79]
    v_mfma_f32_16x16x32_bf16 v[80:83], v[10:13], v[28:31], v[80:83]
    global_load_dwordx4 v[148:151], v45, s[48:49] sc1
    ds_read_b128 v[28:31], v4 offset:20736
    s_waitcnt vmcnt(8) lgkmcnt(6)
    v_mfma_f32_16x16x32_bf16 v[48:51], v[116:119], v[32:35], v[48:51]
    ds_read_b128 v[32:35], v4 offset:41216
    s_waitcnt lgkmcnt(6)
    v_mfma_f32_16x16x32_bf16 v[52:55], v[116:119], v[36:39], v[52:55]
    ds_read_b128 v[36:39], v4 offset:61696
    s_waitcnt lgkmcnt(6)
    v_mfma_f32_16x16x32_bf16 v[56:59], v[116:119], v[40:43], v[56:59]
    v_add_u32 v6, 81920, v4
    ds_read_b128 v[40:43], v6 offset:256
    s_waitcnt lgkmcnt(6)
    v_mfma_f32_16x16x32_bf16 v[60:63], v[116:119], v[16:19], v[60:63]
    v_mfma_f32_16x16x32_bf16 v[64:67], v[16:19], v[16:19], v[64:67]
    v_mfma_f32_16x16x32_bf16 v[68:71], v[10:13], v[16:19], v[68:71]
    ds_read_b128 v[16:19], v5 offset:256
    s_waitcnt lgkmcnt(6)
    v_mfma_f32_16x16x32_bf16 v[72:75], v[116:119], v[20:23], v[72:75]
    v_mfma_f32_16x16x32_bf16 v[76:79], v[20:23], v[20:23], v[76:79]
    v_mfma_f32_16x16x32_bf16 v[80:83], v[10:13], v[20:23], v[80:83]
    global_load_dwordx4 v[152:155], v46, s[48:49] sc1
    ds_read_b128 v[20:23], v5 offset:20736
    s_waitcnt vmcnt(8) lgkmcnt(6)
    v_mfma_f32_16x16x32_bf16 v[48:51], v[120:123], v[24:27], v[48:51]
    ds_read_b128 v[24:27], v5 offset:41216
    s_waitcnt lgkmcnt(6)
    v_mfma_f32_16x16x32_bf16 v[52:55], v[120:123], v[28:31], v[52:55]
    ds_read_b128 v[28:31], v5 offset:61696
    s_waitcnt lgkmcnt(6)
    v_mfma_f32_16x16x32_bf16 v[56:59], v[120:123], v[32:35], v[56:59]
    v_add_u32 v6, 81920, v5
    ds_read_b128 v[32:35], v6 offset:256
    s_waitcnt lgkmcnt(6)
    v_mfma_f32_16x16x32_bf16 v[60:63], v[120:123], v[36:39], v[60:63]
    v_mfma_f32_16x16x32_bf16 v[64:67], v[36:39], v[36:39], v[64:67]
    v_mfma_f32_16x16x32_bf16 v[68:71], v[10:13], v[36:39], v[68:71]
    ds_read_b128 v[36:39], v2 offset:512
    s_waitcnt lgkmcnt(6)
    v_mfma_f32_16x16x32_bf16 v[72:75], v[120:123], v[40:43], v[72:75]
    v_mfma_f32_16x16x32_bf16 v[76:79], v[40:43], v[40:43], v[76:79]
    v_mfma_f32_16x16x32_bf16 v[80:83], v[10:13], v[40:43], v[80:83]
    global_load_dwordx4 v[156:159], v47, s[48:49] sc1
    s_add_u32 s48, s48, 4096
    s_addc_u32 s49, s49, 0
    ds_read_b128 v[40:43], v2 offset:20992
    s_waitcnt vmcnt(8) lgkmcnt(6)
    v_mfma_f32_16x16x32_bf16 v[48:51], v[124:127], v[16:19], v[48:51]
    ds_read_b128 v[16:19], v2 offset:41472
    s_waitcnt lgkmcnt(6)
    v_mfma_f32_16x16x32_bf16 v[52:55], v[124:127], v[20:23], v[52:55]
    ds_read_b128 v[20:23], v2 offset:61952
    s_waitcnt lgkmcnt(6)
    v_mfma_f32_16x16x32_bf16 v[56:59], v[124:127], v[24:27], v[56:59]
    v_add_u32 v6, 81920, v2
    ds_read_b128 v[24:27], v6 offset:512
    s_waitcnt lgkmcnt(6)
    v_mfma_f32_16x16x32_bf16 v[60:63], v[124:127], v[28:31], v[60:63]
    v_mfma_f32_16x16x32_bf16 v[64:67], v[28:31], v[28:31], v[64:67]
    v_mfma_f32_16x16x32_bf16 v[68:71], v[10:13], v[28:31], v[68:71]
    ds_read_b128 v[28:31], v3 offset:512
    s_waitcnt lgkmcnt(6)
    v_mfma_f32_16x16x32_bf16 v[72:75], v[124:127], v[32:35], v[72:75]
    v_mfma_f32_16x16x32_bf16 v[76:79], v[32:35], v[32:35], v[76:79]
    v_mfma_f32_16x16x32_bf16 v[80:83], v[10:13], v[32:35], v[80:83]
    global_load_dwordx4 v[160:163], v44, s[48:49] sc1
    ds_read_b128 v[32:35], v3 offset:20992
    s_waitcnt vmcnt(8) lgkmcnt(6)
    v_mfma_f32_16x16x32_bf16 v[48:51], v[128:131], v[36:39], v[48:51]
    ds_read_b128 v[36:39], v3 offset:41472
    s_waitcnt lgkmcnt(6)
    v_mfma_f32_16x16x32_bf16 v[52:55], v[128:131], v[40:43], v[52:55]
    ds_read_b128 v[40:43], v3 offset:61952
    s_waitcnt lgkmcnt(6)
    v_mfma_f32_16x16x32_bf16 v[56:59], v[128:131], v[16:19], v[56:59]
    v_add_u32 v6, 81920, v3
    ds_read_b128 v[16:19], v6 offset:512
    s_waitcnt lgkmcnt(6)
    v_mfma_f32_16x16x32_bf16 v[60:63], v[128:131], v[20:23], v[60:63]
    v_mfma_f32_16x16x32_bf16 v[64:67], v[20:23], v[20:23], v[64:67]
    v_mfma_f32_16x16x32_bf16 v[68:71], v[10:13], v[20:23], v[68:71]
    ds_read_b128 v[20:23], v4 offset:512
    s_waitcnt lgkmcnt(6)
    v_mfma_f32_16x16x32_bf16 v[72:75], v[128:131], v[24:27], v[72:75]
    v_mfma_f32_16x16x32_bf16 v[76:79], v[24:27], v[24:27], v[76:79]
    v_mfma_f32_16x16x32_bf16 v[80:83], v[10:13], v[24:27], v[80:83]
    global_load_dwordx4 v[164:167], v45, s[48:49] sc1
    ds_read_b128 v[24:27], v4 offset:20992
    s_waitcnt vmcnt(8) lgkmcnt(6)
    v_mfma_f32_16x16x32_bf16 v[48:51], v[132:135], v[28:31], v[48:51]
    ds_read_b128 v[28:31], v4 offset:41472
    s_waitcnt lgkmcnt(6)
    v_mfma_f32_16x16x32_bf16 v[52:55], v[132:135], v[32:35], v[52:55]
    ds_read_b128 v[32:35], v4 offset:61952
    s_waitcnt lgkmcnt(6)
    v_mfma_f32_16x16x32_bf16 v[56:59], v[132:135], v[36:39], v[56:59]
    v_add_u32 v6, 81920, v4
    ds_read_b128 v[36:39], v6 offset:512
    s_waitcnt lgkmcnt(6)
    v_mfma_f32_16x16x32_bf16 v[60:63], v[132:135], v[40:43], v[60:63]
    v_mfma_f32_16x16x32_bf16 v[64:67], v[40:43], v[40:43], v[64:67]
    v_mfma_f32_16x16x32_bf16 v[68:71], v[10:13], v[40:43], v[68:71]
    ds_read_b128 v[40:43], v5 offset:512
    s_waitcnt lgkmcnt(6)
    v_mfma_f32_16x16x32_bf16 v[72:75], v[132:135], v[16:19], v[72:75]
    v_mfma_f32_16x16x32_bf16 v[76:79], v[16:19], v[16:19], v[76:79]
    v_mfma_f32_16x16x32_bf16 v[80:83], v[10:13], v[16:19], v[80:83]
    global_load_dwordx4 v[168:171], v46, s[48:49] sc1
    ds_read_b128 v[16:19], v5 offset:20992
    s_waitcnt vmcnt(8) lgkmcnt(6)
    v_mfma_f32_16x16x32_bf16 v[48:51], v[136:139], v[20:23], v[48:51]
    ds_read_b128 v[20:23], v5 offset:41472
    s_waitcnt lgkmcnt(6)
    v_mfma_f32_16x16x32_bf16 v[52:55], v[136:139], v[24:27], v[52:55]
    ds_read_b128 v[24:27], v5 offset:61952
    s_waitcnt lgkmcnt(6)
    v_mfma_f32_16x16x32_bf16 v[56:59], v[136:139], v[28:31], v[56:59]
    v_add_u32 v6, 81920, v5
    ds_read_b128 v[28:31], v6 offset:512
    s_waitcnt lgkmcnt(6)
    v_mfma_f32_16x16x32_bf16 v[60:63], v[136:139], v[32:35], v[60:63]
    v_mfma_f32_16x16x32_bf16 v[64:67], v[32:35], v[32:35], v[64:67]
    v_mfma_f32_16x16x32_bf16 v[68:71], v[10:13], v[32:35], v[68:71]
    ds_read_b128 v[32:35], v2 offset:768
    s_waitcnt lgkmcnt(6)
    v_mfma_f32_16x16x32_bf16 v[72:75], v[136:139], v[36:39], v[72:75]
    v_mfma_f32_16x16x32_bf16 v[76:79], v[36:39], v[36:39], v[76:79]
    v_mfma_f32_16x16x32_bf16 v[80:83], v[10:13], v[36:39], v[80:83]
    global_load_dwordx4 v[172:175], v47, s[48:49] sc1
    ds_read_b128 v[36:39], v2 offset:21248
    s_waitcnt vmcnt(8) lgkmcnt(6)
    v_mfma_f32_16x16x32_bf16 v[48:51], v[140:143], v[40:43], v[48:51]
    ds_read_b128 v[40:43], v2 offset:41728
    s_waitcnt lgkmcnt(6)
    v_mfma_f32_16x16x32_bf16 v[52:55], v[140:143], v[16:19], v[52:55]
    ds_read_b128 v[16:19], v2 offset:62208
    s_waitcnt lgkmcnt(6)
    v_mfma_f32_16x16x32_bf16 v[56:59], v[140:143], v[20:23], v[56:59]
    v_add_u32 v6, 81920, v2
    ds_read_b128 v[20:23], v6 offset:768
    s_waitcnt lgkmcnt(6)
    v_mfma_f32_16x16x32_bf16 v[60:63], v[140:143], v[24:27], v[60:63]
    v_mfma_f32_16x16x32_bf16 v[64:67], v[24:27], v[24:27], v[64:67]
    v_mfma_f32_16x16x32_bf16 v[68:71], v[10:13], v[24:27], v[68:71]
    ds_read_b128 v[24:27], v3 offset:768
    s_waitcnt lgkmcnt(6)
    v_mfma_f32_16x16x32_bf16 v[72:75], v[140:143], v[28:31], v[72:75]
    v_mfma_f32_16x16x32_bf16 v[76:79], v[28:31], v[28:31], v[76:79]
    v_mfma_f32_16x16x32_bf16 v[80:83], v[10:13], v[28:31], v[80:83]
    ds_read_b128 v[28:31], v3 offset:21248
    s_waitcnt vmcnt(7) lgkmcnt(6)
    v_mfma_f32_16x16x32_bf16 v[48:51], v[144:147], v[32:35], v[48:51]
    ds_read_b128 v[32:35], v3 offset:41728
    s_waitcnt lgkmcnt(6)
    v_mfma_f32_16x16x32_bf16 v[52:55], v[144:147], v[36:39], v[52:55]
    ds_read_b128 v[36:39], v3 offset:62208
    s_waitcnt lgkmcnt(6)
    v_mfma_f32_16x16x32_bf16 v[56:59], v[144:147], v[40:43], v[56:59]
    v_add_u32 v6, 81920, v3
    ds_read_b128 v[40:43], v6 offset:768
    s_waitcnt lgkmcnt(6)
    v_mfma_f32_16x16x32_bf16 v[60:63], v[144:147], v[16:19], v[60:63]
    v_mfma_f32_16x16x32_bf16 v[64:67], v[16:19], v[16:19], v[64:67]
    v_mfma_f32_16x16x32_bf16 v[68:71], v[10:13], v[16:19], v[68:71]
    ds_read_b128 v[16:19], v4 offset:768
    s_waitcnt lgkmcnt(6)
    v_mfma_f32_16x16x32_bf16 v[72:75], v[144:147], v[20:23], v[72:75]
    v_mfma_f32_16x16x32_bf16 v[76:79], v[20:23], v[20:23], v[76:79]
    v_mfma_f32_16x16x32_bf16 v[80:83], v[10:13], v[20:23], v[80:83]
    ds_read_b128 v[20:23], v4 offset:21248
    s_waitcnt vmcnt(6) lgkmcnt(6)
    v_mfma_f32_16x16x32_bf16 v[48:51], v[148:151], v[24:27], v[48:51]
    ds_read_b128 v[24:27], v4 offset:41728
    s_waitcnt lgkmcnt(6)
    v_mfma_f32_16x16x32_bf16 v[52:55], v[148:151], v[28:31], v[52:55]
    ds_read_b128 v[28:31], v4 offset:62208
    s_waitcnt lgkmcnt(6)
    v_mfma_f32_16x16x32_bf16 v[56:59], v[148:151], v[32:35], v[56:59]
    v_add_u32 v6, 81920, v4
    ds_read_b128 v[32:35], v6 offset:768
    s_waitcnt lgkmcnt(6)
    v_mfma_f32_16x16x32_bf16 v[60:63], v[148:151], v[36:39], v[60:63]
    v_mfma_f32_16x16x32_bf16 v[64:67], v[36:39], v[36:39], v[64:67]
    v_mfma_f32_16x16x32_bf16 v[68:71], v[10:13], v[36:39], v[68:71]
    ds_read_b128 v[36:39], v5 offset:768
    s_waitcnt lgkmcnt(6)
    v_mfma_f32_16x16x32_bf16 v[72:75], v[148:151], v[40:43], v[72:75]
    v_mfma_f32_16x16x32_bf16 v[76:79], v[40:43], v[40:43], v[76:79]
    v_mfma_f32_16x16x32_bf16 v[80:83], v[10:13], v[40:43], v[80:83]
    ds_read_b128 v[40:43], v5 offset:21248
    s_waitcnt vmcnt(5) lgkmcnt(6)
    v_mfma_f32_16x16x32_bf16 v[48:51], v[152:155], v[16:19], v[48:51]
    ds_read_b128 v[16:19], v5 offset:41728
    s_waitcnt lgkmcnt(6)
    v_mfma_f32_16x16x32_bf16 v[52:55], v[152:155], v[20:23], v[52:55]
    ds_read_b128 v[20:23], v5 offset:62208
    s_waitcnt lgkmcnt(6)
    v_mfma_f32_16x16x32_bf16 v[56:59], v[152:155], v[24:27], v[56:59]
    v_add_u32 v6, 81920, v5
    ds_read_b128 v[24:27], v6 offset:768
    s_waitcnt lgkmcnt(6)
    v_mfma_f32_16x16x32_bf16 v[60:63], v[152:155], v[28:31], v[60:63]
    v_mfma_f32_16x16x32_bf16 v[64:67], v[28:31], v[28:31], v[64:67]
    v_mfma_f32_16x16x32_bf16 v[68:71], v[10:13], v[28:31], v[68:71]
    ds_read_b128 v[28:31], v2 offset:1024
    s_waitcnt lgkmcnt(6)
    v_mfma_f32_16x16x32_bf16 v[72:75], v[152:155], v[32:35], v[72:75]
    v_mfma_f32_16x16x32_bf16 v[76:79], v[32:35], v[32:35], v[76:79]
    v_mfma_f32_16x16x32_bf16 v[80:83], v[10:13], v[32:35], v[80:83]
    ds_read_b128 v[32:35], v2 offset:21504
    s_waitcnt vmcnt(4) lgkmcnt(6)
    v_mfma_f32_16x16x32_bf16 v[48:51], v[156:159], v[36:39], v[48:51]
    ds_read_b128 v[36:39], v2 offset:41984
    s_waitcnt lgkmcnt(6)
    v_mfma_f32_16x16x32_bf16 v[52:55], v[156:159], v[40:43], v[52:55]
    ds_read_b128 v[40:43], v2 offset:62464
    s_waitcnt lgkmcnt(6)
    v_mfma_f32_16x16x32_bf16 v[56:59], v[156:159], v[16:19], v[56:59]
    v_add_u32 v6, 81920, v2
    ds_read_b128 v[16:19], v6 offset:1024
    s_waitcnt lgkmcnt(6)
    v_mfma_f32_16x16x32_bf16 v[60:63], v[156:159], v[20:23], v[60:63]
    v_mfma_f32_16x16x32_bf16 v[64:67], v[20:23], v[20:23], v[64:67]
    v_mfma_f32_16x16x32_bf16 v[68:71], v[10:13], v[20:23], v[68:71]
    ds_read_b128 v[20:23], v3 offset:1024
    s_waitcnt lgkmcnt(6)
    v_mfma_f32_16x16x32_bf16 v[72:75], v[156:159], v[24:27], v[72:75]
    v_mfma_f32_16x16x32_bf16 v[76:79], v[24:27], v[24:27], v[76:79]
    v_mfma_f32_16x16x32_bf16 v[80:83], v[10:13], v[24:27], v[80:83]
    ds_read_b128 v[24:27], v3 offset:21504
    s_waitcnt vmcnt(3) lgkmcnt(6)
    v_mfma_f32_16x16x32_bf16 v[48:51], v[160:163], v[28:31], v[48:51]
    ds_read_b128 v[28:31], v3 offset:41984
    s_waitcnt lgkmcnt(6)
    v_mfma_f32_16x16x32_bf16 v[52:55], v[160:163], v[32:35], v[52:55]
    ds_read_b128 v[32:35], v3 offset:62464
    s_waitcnt lgkmcnt(6)
    v_mfma_f32_16x16x32_bf16 v[56:59], v[160:163], v[36:39], v[56:59]
    v_add_u32 v6, 81920, v3
    ds_read_b128 v[36:39], v6 offset:1024
    s_waitcnt lgkmcnt(6)
    v_mfma_f32_16x16x32_bf16 v[60:63], v[160:163], v[40:43], v[60:63]
    v_mfma_f32_16x16x32_bf16 v[64:67], v[40:43], v[40:43], v[64:67]
    v_mfma_f32_16x16x32_bf16 v[68:71], v[10:13], v[40:43], v[68:71]
    ds_read_b128 v[40:43], v4 offset:1024
    s_waitcnt lgkmcnt(6)
    v_mfma_f32_16x16x32_bf16 v[72:75], v[160:163], v[16:19], v[72:75]
    v_mfma_f32_16x16x32_bf16 v[76:79], v[16:19], v[16:19], v[76:79]
    v_mfma_f32_16x16x32_bf16 v[80:83], v[10:13], v[16:19], v[80:83]
    ds_read_b128 v[16:19], v4 offset:21504
    s_waitcnt vmcnt(2) lgkmcnt(6)
    v_mfma_f32_16x16x32_bf16 v[48:51], v[164:167], v[20:23], v[48:51]
    ds_read_b128 v[20:23], v4 offset:41984
    s_waitcnt lgkmcnt(6)
    v_mfma_f32_16x16x32_bf16 v[52:55], v[164:167], v[24:27], v[52:55]
    ds_read_b128 v[24:27], v4 offset:62464
    s_waitcnt lgkmcnt(6)
    v_mfma_f32_16x16x32_bf16 v[56:59], v[164:167], v[28:31], v[56:59]
    v_add_u32 v6, 81920, v4
    ds_read_b128 v[28:31], v6 offset:1024
    s_waitcnt lgkmcnt(6)
    v_mfma_f32_16x16x32_bf16 v[60:63], v[164:167], v[32:35], v[60:63]
    v_mfma_f32_16x16x32_bf16 v[64:67], v[32:35], v[32:35], v[64:67]
    v_mfma_f32_16x16x32_bf16 v[68:71], v[10:13], v[32:35], v[68:71]
    ds_read_b128 v[32:35], v5 offset:1024
    s_waitcnt lgkmcnt(6)
    v_mfma_f32_16x16x32_bf16 v[72:75], v[164:167], v[36:39], v[72:75]
    v_mfma_f32_16x16x32_bf16 v[76:79], v[36:39], v[36:39], v[76:79]
    v_mfma_f32_16x16x32_bf16 v[80:83], v[10:13], v[36:39], v[80:83]
    ds_read_b128 v[36:39], v5 offset:21504
    s_waitcnt vmcnt(1) lgkmcnt(6)
    v_mfma_f32_16x16x32_bf16 v[48:51], v[168:171], v[40:43], v[48:51]
    ds_read_b128 v[40:43], v5 offset:41984
    s_waitcnt lgkmcnt(6)
    v_mfma_f32_16x16x32_bf16 v[52:55], v[168:171], v[16:19], v[52:55]
    ds_read_b128 v[16:19], v5 offset:62464
    s_waitcnt lgkmcnt(6)
    v_mfma_f32_16x16x32_bf16 v[56:59], v[168:171], v[20:23], v[56:59]
    v_add_u32 v6, 81920, v5
    ds_read_b128 v[20:23], v6 offset:1024
    s_waitcnt lgkmcnt(6)
    v_mfma_f32_16x16x32_bf16 v[60:63], v[168:171], v[24:27], v[60:63]
    v_mfma_f32_16x16x32_bf16 v[64:67], v[24:27], v[24:27], v[64:67]
    v_mfma_f32_16x16x32_bf16 v[68:71], v[10:13], v[24:27], v[68:71]
    s_waitcnt lgkmcnt(5)
    v_mfma_f32_16x16x32_bf16 v[72:75], v[168:171], v[28:31], v[72:75]
    v_mfma_f32_16x16x32_bf16 v[76:79], v[28:31], v[28:31], v[76:79]
    v_mfma_f32_16x16x32_bf16 v[80:83], v[10:13], v[28:31], v[80:83]
    s_waitcnt vmcnt(0) lgkmcnt(4)
    v_mfma_f32_16x16x32_bf16 v[48:51], v[172:175], v[32:35], v[48:51]
    s_waitcnt lgkmcnt(3)
    v_mfma_f32_16x16x32_bf16 v[52:55], v[172:175], v[36:39], v[52:55]
    s_waitcnt lgkmcnt(2)
    v_mfma_f32_16x16x32_bf16 v[56:59], v[172:175], v[40:43], v[56:59]
    s_waitcnt lgkmcnt(1)
    v_mfma_f32_16x16x32_bf16 v[60:63], v[172:175], v[16:19], v[60:63]
    v_mfma_f32_16x16x32_bf16 v[64:67], v[16:19], v[16:19], v[64:67]
    v_mfma_f32_16x16x32_bf16 v[68:71], v[10:13], v[16:19], v[68:71]
    s_waitcnt lgkmcnt(0)
    v_mfma_f32_16x16x32_bf16 v[72:75], v[172:175], v[20:23], v[72:75]
    v_mfma_f32_16x16x32_bf16 v[76:79], v[20:23], v[20:23], v[76:79]
    v_mfma_f32_16x16x32_bf16 v[80:83], v[10:13], v[20:23], v[80:83]
    ds_read_b64_tr_b16 v[10:11], v7
    ds_read_b64_tr_b16 v[12:13], v8
    ds_read_b64_tr_b16 v[14:15], v9
    v_and_b32 v16, 15, v1
    v_lshrrev_b32 v17, 4, v1
    v_and_b32 v18, 3, v1
    v_lshrrev_b32 v19, 2, v16
    v_cmp_eq_u32 s[42:43], 1, v18
    v_cmp_eq_u32 s[44:45], 2, v18
    v_cmp_eq_u32 s[46:47], 3, v18
    v_cmp_eq_u32 s[48:49], v19, v17
    v_lshlrev_b32 v18, 3, v16
    v_add_u32 v18, 45376, v18
    v_cndmask_b32 v64, v64, v65, s[42:43]
    v_cndmask_b32 v76, v76, v77, s[42:43]
    v_cndmask_b32 v64, v64, v66, s[44:45]
    v_cndmask_b32 v76, v76, v78, s[44:45]
    v_cndmask_b32 v64, v64, v67, s[46:47]
    v_cndmask_b32 v76, v76, v79, s[46:47]
    v_mul_f32 v68, 0x3acccccd, v68
    v_mul_f32 v64, 0x3acccccd, v64
    v_mul_f32 v80, 0x3acccccd, v80
    v_mul_f32 v76, 0x3acccccd, v76
    v_fma_f32 v64, -v68, v68, v64
    v_fma_f32 v76, -v80, v80, v76
    v_max_f32 v64, 0, v64
    v_max_f32 v76, 0, v76
    v_cvt_pk_bf16_f32 v68, v68, v64
    v_cvt_pk_bf16_f32 v80, v80, v76
    v_and_b32 v64, 0xffff0000, v68
    v_lshlrev_b32 v68, 16, v68
    v_and_b32 v76, 0xffff0000, v80
    v_lshlrev_b32 v80, 16, v80
    v_add_f32 v64, 0x3727c5ac, v64
    v_add_f32 v76, 0x3727c5ac, v76
    v_cvt_pk_bf16_f32 v64, v64, v64
    v_cvt_pk_bf16_f32 v76, v76, v76
    v_lshlrev_b32 v64, 16, v64
    v_lshlrev_b32 v76, 16, v76
    v_sqrt_f32 v64, v64
    v_sqrt_f32 v76, v76
    v_cvt_pk_bf16_f32 v64, v64, v64
    v_cvt_pk_bf16_f32 v76, v76, v76
    v_lshlrev_b32 v64, 16, v64
    v_lshlrev_b32 v76, 16, v76
    v_rcp_f32 v69, v64
    v_rcp_f32 v81, v76
    s_mov_b64 exec, s[48:49]
    ds_write_b64 v18, v[68:69] offset:384
    ds_write_b64 v18, v[80:81] offset:512
    s_mov_b64 exec, -1
    s_lshl_b32 s42, s3, 7
    s_add_u32 s42, s42, 46016
    v_lshl_add_u32 v19, v17, 4, s42
    s_mov_b64 exec, 0x10001
    s_mov_b32 exec_hi, 0x10001
    ds_write_b128 v19, v[48:51] offset:0
    s_mov_b64 exec, -1
    s_lshl_b32 s42, s3, 6
    s_cmp_eq_u32 s3, 2
    s_cselect_b32 s42, 192, s42
    s_cmp_eq_u32 s3, 3
    s_cselect_b32 s42, 128, s42
    s_add_u32 s42, s42, 61440
    v_mul_u32_u24 v20, 496, v16
    v_lshl_add_u32 v20, v17, 3, v20
    v_add_u32 v20, s42, v20
    v_lshlrev_b32 v18, 3, v16
    v_add_u32 v18, 45376, v18
    s_waitcnt lgkmcnt(0)
    s_barrier
    ds_read_b64 v[24:25], v18 offset:0
    ds_read_b64 v[26:27], v18 offset:128
    ds_read_b64 v[28:29], v18 offset:256
    ds_read_b64 v[30:31], v18 offset:384
    ds_read_b64 v[32:33], v18 offset:512
    ds_read_b128 v[36:39], v19 offset:0
    s_waitcnt lgkmcnt(0)
    v_fma_f32 v48, -v24, v36, v48
    v_fma_f32 v49, -v24, v37, v49
    v_fma_f32 v50, -v24, v38, v50
    v_fma_f32 v51, -v24, v39, v51
    v_fma_f32 v52, -v26, v36, v52
    v_fma_f32 v53, -v26, v37, v53
    v_fma_f32 v54, -v26, v38, v54
    v_fma_f32 v55, -v26, v39, v55
    v_fma_f32 v56, -v28, v36, v56
    v_fma_f32 v57, -v28, v37, v57
    v_fma_f32 v58, -v28, v38, v58
    v_fma_f32 v59, -v28, v39, v59
    v_fma_f32 v60, -v30, v36, v60
    v_fma_f32 v61, -v30, v37, v61
    v_fma_f32 v62, -v30, v38, v62
    v_fma_f32 v63, -v30, v39, v63
    v_fma_f32 v72, -v32, v36, v72
    v_fma_f32 v73, -v32, v37, v73
    v_fma_f32 v74, -v32, v38, v74
    v_fma_f32 v75, -v32, v39, v75
    v_mul_f32 v48, v48, v25
    v_mul_f32 v49, v49, v25
    v_mul_f32 v50, v50, v25
    v_mul_f32 v51, v51, v25
    v_mul_f32 v52, v52, v27
    v_mul_f32 v53, v53, v27
    v_mul_f32 v54, v54, v27
    v_mul_f32 v55, v55, v27
    v_mul_f32 v56, v56, v29
    v_mul_f32 v57, v57, v29
    v_mul_f32 v58, v58, v29
    v_mul_f32 v59, v59, v29
    v_mul_f32 v60, v60, v31
    v_mul_f32 v61, v61, v31
    v_mul_f32 v62, v62, v31
    v_mul_f32 v63, v63, v31
    v_mul_f32 v72, v72, v33
    v_mul_f32 v73, v73, v33
    v_mul_f32 v74, v74, v33
    v_mul_f32 v75, v75, v33
    v_cvt_pk_bf16_f32 v48, v48, v49
    v_cvt_pk_bf16_f32 v49, v50, v51
    ds_write_b64 v20, v[48:49] offset:0
    v_cvt_pk_bf16_f32 v52, v52, v53
    v_cvt_pk_bf16_f32 v53, v54, v55
    ds_write_b64 v20, v[52:53] offset:7936
    v_cvt_pk_bf16_f32 v56, v56, v57
    v_cvt_pk_bf16_f32 v57, v58, v59
    ds_write_b64 v20, v[56:57] offset:15872
    v_cvt_pk_bf16_f32 v60, v60, v61
    v_cvt_pk_bf16_f32 v61, v62, v63
    ds_write_b64 v20, v[60:61] offset:23808
    v_cvt_pk_bf16_f32 v72, v72, v73
    v_cvt_pk_bf16_f32 v73, v74, v75
    ds_write_b64 v20, v[72:73] offset:31744
    s_branch L_a1_post
L_a1_post:
    s_cmp_lt_u32 s3, 4
    s_cbranch_scc1 L_pg_lo
    s_cmp_eq_u32 s3, 7
    s_cbranch_scc0 L_pg_n9
    s_cmp_eq_u32 s7, 0
    s_cbranch_scc0 L_pg_n9
    s_mov_b32 s43, 2
    s_mul_i32 s54, s39, 384
    s_lshl_b32 s55, s43, 7
    s_add_u32 s54, s54, s55
    v_lshl_add_u32 v2, v1, 1, s54
    s_lshl_b32 s55, s39, 1
    v_mov_b32 v3, s55
    global_load_ushort v240, v2, s[16:17]
    global_load_ushort v244, v3, s[24:25]
    global_load_ushort v241, v2, s[18:19]
    global_load_ushort v242, v2, s[20:21]
    global_load_ushort v243, v2, s[22:23]
L_pg_n9:
    v_add_u32 v24, 0, v1
    v_mul_u32_u24 v29, 205, v24
    v_lshrrev_b32 v29, 11, v29
    v_mul_u32_u24 v30, 10, v29
    v_sub_u32 v24, v24, v30
    v_and_b32 v30, 3, v29
    v_bfe_u32 v31, v29, 2, 2
    v_lshl_or_b32 v30, v31, 3, v30
    v_lshrrev_b32 v31, 4, v29
    v_lshl_or_b32 v30, v31, 2, v30
    v_mul_u32_u24 v30, 1280, v30
    v_lshl_add_u32 v24, v24, 4, v30
    v_add_u32 v25, 64, v1
    v_mul_u32_u24 v29, 205, v25
    v_lshrrev_b32 v29, 11, v29
    v_mul_u32_u24 v30, 10, v29
    v_sub_u32 v25, v25, v30
    v_and_b32 v30, 3, v29
    v_bfe_u32 v31, v29, 2, 2
    v_lshl_or_b32 v30, v31, 3, v30
    v_lshrrev_b32 v31, 4, v29
    v_lshl_or_b32 v30, v31, 2, v30
    v_mul_u32_u24 v30, 1280, v30
    v_lshl_add_u32 v25, v25, 4, v30
    v_add_u32 v26, 128, v1
    v_mul_u32_u24 v29, 205, v26
    v_lshrrev_b32 v29, 11, v29
    v_mul_u32_u24 v30, 10, v29
    v_sub_u32 v26, v26, v30
    v_and_b32 v30, 3, v29
    v_bfe_u32 v31, v29, 2, 2
    v_lshl_or_b32 v30, v31, 3, v30
    v_lshrrev_b32 v31, 4, v29
    v_lshl_or_b32 v30, v31, 2, v30
    v_mul_u32_u24 v30, 1280, v30
    v_lshl_add_u32 v26, v26, 4, v30
    v_add_u32 v27, 192, v1
    v_mul_u32_u24 v29, 205, v27
    v_lshrrev_b32 v29, 11, v29
    v_mul_u32_u24 v30, 10, v29
    v_sub_u32 v27, v27, v30
    v_and_b32 v30, 3, v29
    v_bfe_u32 v31, v29, 2, 2
    v_lshl_or_b32 v30, v31, 3, v30
    v_lshrrev_b32 v31, 4, v29
    v_lshl_or_b32 v30, v31, 2, v30
    v_mul_u32_u24 v30, 1280, v30
    v_lshl_add_u32 v27, v27, 4, v30
    v_add_u32 v28, 256, v1
    v_mul_u32_u24 v29, 205, v28
    v_lshrrev_b32 v29, 11, v29
    v_mul_u32_u24 v30, 10, v29
    v_sub_u32 v28, v28, v30
    v_and_b32 v30, 3, v29
    v_bfe_u32 v31, v29, 2, 2
    v_lshl_or_b32 v30, v31, 3, v30
    v_lshrrev_b32 v31, 4, v29
    v_lshl_or_b32 v30, v31, 2, v30
    v_mul_u32_u24 v30, 1280, v30
    v_lshl_add_u32 v28, v28, 4, v30
    s_sub_u32 s42, s3, 4
    s_mul_i32 s42, s42, 3
    s_add_u32 s42, s42, 8
    s_mul_i32 s43, s42, 40960
    s_mul_i32 s44, s4, 160
    s_add_u32 s43, s43, s44
    s_mul_i32 s42, s42, 5120
    s_add_u32 s44, s12, s43
    s_addc_u32 s45, s13, 0
    s_add_u32 m0, s42, 61440
    s_nop 0
    global_load_lds_dwordx4 v24, s[44:45]
    s_add_u32 m0, s42, 62464
    s_nop 0
    global_load_lds_dwordx4 v25, s[44:45]
    s_add_u32 m0, s42, 63488
    s_nop 0
    global_load_lds_dwordx4 v26, s[44:45]
    s_add_u32 m0, s42, 64512
    s_nop 0
    global_load_lds_dwordx4 v27, s[44:45]
    s_add_u32 m0, s42, 65536
    s_nop 0
    global_load_lds_dwordx4 v28, s[44:45]
    s_add_u32 s44, s44, 40960
    s_addc_u32 s45, s45, 0
    s_add_u32 m0, s42, 66560
    s_nop 0
    global_load_lds_dwordx4 v24, s[44:45]
    s_add_u32 m0, s42, 67584
    s_nop 0
    global_load_lds_dwordx4 v25, s[44:45]
    s_add_u32 m0, s42, 68608
    s_nop 0
    global_load_lds_dwordx4 v26, s[44:45]
    s_add_u32 m0, s42, 69632
    s_nop 0
    global_load_lds_dwordx4 v27, s[44:45]
    s_add_u32 m0, s42, 70656
    s_nop 0
    global_load_lds_dwordx4 v28, s[44:45]
    s_add_u32 s44, s44, 40960
    s_addc_u32 s45, s45, 0
    s_add_u32 m0, s42, 71680
    s_nop 0
    global_load_lds_dwordx4 v24, s[44:45]
    s_add_u32 m0, s42, 72704
    s_nop 0
    global_load_lds_dwordx4 v25, s[44:45]
    s_add_u32 m0, s42, 73728
    s_nop 0
    global_load_lds_dwordx4 v26, s[44:45]
    s_add_u32 m0, s42, 74752
    s_nop 0
    global_load_lds_dwordx4 v27, s[44:45]
    s_add_u32 m0, s42, 75776
    s_nop 0
    global_load_lds_dwordx4 v28, s[44:45]
    s_waitcnt lgkmcnt(0)
    s_barrier
    s_barrier
    s_sub_u32 s42, s3, 4
    s_mul_i32 s42, s42, 2
    s_add_u32 s42, s42, 0
    s_mul_i32 s43, s42, 40960
    s_mul_i32 s44, s4, 160
    s_add_u32 s43, s43, s44
    s_mul_i32 s42, s42, 5120
    s_add_u32 s44, s12, s43
    s_addc_u32 s45, s13, 0
    s_add_u32 m0, s42, 61440
    s_nop 0
    global_load_lds_dwordx4 v24, s[44:45]
    s_add_u32 m0, s42, 62464
    s_nop 0
    global_load_lds_dwordx4 v25, s[44:45]
    s_add_u32 m0, s42, 63488
    s_nop 0
    global_load_lds_dwordx4 v26, s[44:45]
    s_add_u32 m0, s42, 64512
    s_nop 0
    global_load_lds_dwordx4 v27, s[44:45]
    s_add_u32 m0, s42, 65536
    s_nop 0
    global_load_lds_dwordx4 v28, s[44:45]
    s_add_u32 s44, s44, 40960
    s_addc_u32 s45, s45, 0
    s_add_u32 m0, s42, 66560
    s_nop 0
    global_load_lds_dwordx4 v24, s[44:45]
    s_add_u32 m0, s42, 67584
    s_nop 0
    global_load_lds_dwordx4 v25, s[44:45]
    s_add_u32 m0, s42, 68608
    s_nop 0
    global_load_lds_dwordx4 v26, s[44:45]
    s_add_u32 m0, s42, 69632
    s_nop 0
    global_load_lds_dwordx4 v27, s[44:45]
    s_add_u32 m0, s42, 70656
    s_nop 0
    global_load_lds_dwordx4 v28, s[44:45]
    s_cmp_eq_u32 s3, 7
    s_cbranch_scc0 L_pg_join
    s_cmp_eq_u32 s7, 0
    s_cbranch_scc0 L_pg_join
    v_mov_b32 v180, v10
    v_mov_b32 v181, v11
    v_mov_b32 v182, v12
    v_mov_b32 v183, v13
    v_mov_b32 v184, v14
    v_mov_b32 v185, v15
    s_mov_b32 s46, 36864
    s_waitcnt vmcnt(25)
    v_lshlrev_b32 v52, 16, v240
    v_lshlrev_b32 v56, 16, v244
    v_mul_f32 v52, 1069066811, v52
    v_mul_f32 v56, 1069066811, v56
    v_exp_f32 v52, v52
    v_exp_f32 v56, v56
    v_lshlrev_b32 v53, 16, v241
    v_lshlrev_b32 v54, 16, v242
    v_lshlrev_b32 v55, 16, v243
    v_cvt_pk_bf16_f32 v52, v52, v56
    v_and_b32 v3, 15, v1
    v_mul_u32_u24 v3, 288, v3
    v_and_b32 v2, 0x30, v1
    v_add3_u32 v3, v3, v2, s46
    s_mov_b32 m0, s46
    v_and_b32 v56, 0xffff0000, v52
    v_lshlrev_b32 v52, 16, v52
    v_mul_f32 v52, v52, v56
    v_mul_f32 v53, v53, v56
    v_mul_f32 v84, v54, v56
    v_mul_f32 v85, v55, v56
    v_mul_f32 v52, 3216550459, v52
    v_mul_f32 v53, 1042479491, v53
    v_mul_f32 v84, 0x44000000, v84
    v_mul_f32 v85, 0x44000000, v85
    v_mul_f32 v54, 1065353216, v52
    v_mul_f32 v60, 1065353216, v53
    v_mul_f32 v55, 1090519040, v52
    v_mul_f32 v61, 1090519040, v53
    v_mul_f32 v56, 1124073472, v52
    v_mul_f32 v62, 1124073472, v53
    v_mul_f32 v57, 1132462080, v52
    v_mul_f32 v63, 1132462080, v53
    v_mul_f32 v58, 1140850688, v52
    v_mul_f32 v64, 1140850688, v53
    v_mul_f32 v59, 1149239296, v52
    v_mul_f32 v65, 1149239296, v53
    v_exp_f32 v54, v54
    v_fract_f32 v60, v60
    v_exp_f32 v55, v55
    v_fract_f32 v61, v61
    v_exp_f32 v56, v56
    v_fract_f32 v62, v62
    v_exp_f32 v57, v57
    v_fract_f32 v63, v63
    v_exp_f32 v58, v58
    v_fract_f32 v64, v64
    v_exp_f32 v59, v59
    v_fract_f32 v65, v65
    v_cos_f32 v4, v60
    v_sin_f32 v5, v60
    v_cos_f32 v6, v61
    v_sin_f32 v7, v61
    v_cos_f32 v8, v62
    v_sin_f32 v9, v62
    v_cos_f32 v10, v63
    v_sin_f32 v11, v63
    v_cos_f32 v12, v64
    v_sin_f32 v13, v64
    v_cos_f32 v14, v65
    v_sin_f32 v15, v65
    v_mul_f32 v4, v4, v54
    v_mul_f32 v5, v5, v54
    v_mul_f32 v6, v6, v55
    v_mul_f32 v7, v7, v55
    v_mul_f32 v8, v8, v56
    v_mul_f32 v9, v9, v56
    v_mul_f32 v10, v10, v57
    v_mul_f32 v11, v11, v57
    v_mul_f32 v12, v12, v58
    v_mul_f32 v13, v13, v58
    v_mul_f32 v14, v14, v59
    v_mul_f32 v15, v15, v59
    v_mov_b32 v16, 1.0
    v_mov_b32 v17, 0
    v_mov_b32 v18, v6
    v_mov_b32 v19, v7
    v_pk_mul_f32 v[20:21], v[6:7], v[6:7] op_sel:[0,0] op_sel_hi:[1,0]
    v_pk_mul_f32 v[48:49], v[4:5], v[4:5] op_sel:[0,0] op_sel_hi:[1,0]
    v_pk_fma_f32 v[20:21], v[6:7], v[6:7], v[20:21] op_sel:[1,1,0] op_sel_hi:[0,1,1] neg_lo:[1,0,0]
    v_pk_fma_f32 v[48:49], v[4:5], v[4:5], v[48:49] op_sel:[1,1,0] op_sel_hi:[0,1,1] neg_lo:[1,0,0]
    v_pk_mul_f32 v[22:23], v[20:21], v[6:7] op_sel:[0,0] op_sel_hi:[1,0]
    v_pk_mul_f32 v[24:25], v[20:21], v[20:21] op_sel:[0,0] op_sel_hi:[1,0]
    v_pk_mul_f32 v[50:51], v[48:49], v[48:49] op_sel:[0,0] op_sel_hi:[1,0]
    v_pk_fma_f32 v[22:23], v[20:21], v[6:7], v[22:23] op_sel:[1,1,0] op_sel_hi:[0,1,1] neg_lo:[1,0,0]
    v_pk_fma_f32 v[24:25], v[20:21], v[20:21], v[24:25] op_sel:[1,1,0] op_sel_hi:[0,1,1] neg_lo:[1,0,0]
    v_pk_fma_f32 v[50:51], v[48:49], v[48:49], v[50:51] op_sel:[1,1,0] op_sel_hi:[0,1,1] neg_lo:[1,0,0]
    v_pk_mul_f32 v[26:27], v[18:19], v[24:25] op_sel:[0,0] op_sel_hi:[1,0]
    v_pk_mul_f32 v[28:29], v[20:21], v[24:25] op_sel:[0,0] op_sel_hi:[1,0]
    v_pk_mul_f32 v[30:31], v[22:23], v[24:25] op_sel:[0,0] op_sel_hi:[1,0]
    v_pk_mul_f32 v[32:33], v[24:25], v[24:25] op_sel:[0,0] op_sel_hi:[1,0]
    v_pk_fma_f32 v[26:27], v[18:19], v[24:25], v[26:27] op_sel:[1,1,0] op_sel_hi:[0,1,1] neg_lo:[1,0,0]
    v_pk_fma_f32 v[28:29], v[20:21], v[24:25], v[28:29] op_sel:[1,1,0] op_sel_hi:[0,1,1] neg_lo:[1,0,0]
    v_pk_fma_f32 v[30:31], v[22:23], v[24:25], v[30:31] op_sel:[1,1,0] op_sel_hi:[0,1,1] neg_lo:[1,0,0]
    v_pk_fma_f32 v[32:33], v[24:25], v[24:25], v[32:33] op_sel:[1,1,0] op_sel_hi:[0,1,1] neg_lo:[1,0,0]
    v_pk_mul_f32 v[34:35], v[26:27], v[24:25] op_sel:[0,0] op_sel_hi:[1,0]
    v_pk_mul_f32 v[36:37], v[28:29], v[24:25] op_sel:[0,0] op_sel_hi:[1,0]
    v_pk_mul_f32 v[38:39], v[30:31], v[24:25] op_sel:[0,0] op_sel_hi:[1,0]
    v_pk_mul_f32 v[40:41], v[32:33], v[24:25] op_sel:[0,0] op_sel_hi:[1,0]
    v_pk_fma_f32 v[34:35], v[26:27], v[24:25], v[34:35] op_sel:[1,1,0] op_sel_hi:[0,1,1] neg_lo:[1,0,0]
    v_pk_fma_f32 v[36:37], v[28:29], v[24:25], v[36:37] op_sel:[1,1,0] op_sel_hi:[0,1,1] neg_lo:[1,0,0]
    v_pk_fma_f32 v[38:39], v[30:31], v[24:25], v[38:39] op_sel:[1,1,0] op_sel_hi:[0,1,1] neg_lo:[1,0,0]
    v_pk_fma_f32 v[40:41], v[32:33], v[24:25], v[40:41] op_sel:[1,1,0] op_sel_hi:[0,1,1] neg_lo:[1,0,0]
    v_pk_mul_f32 v[42:43], v[34:35], v[24:25] op_sel:[0,0] op_sel_hi:[1,0]
    v_pk_mul_f32 v[44:45], v[36:37], v[24:25] op_sel:[0,0] op_sel_hi:[1,0]
    v_pk_mul_f32 v[46:47], v[38:39], v[24:25] op_sel:[0,0] op_sel_hi:[1,0]
    v_pk_fma_f32 v[42:43], v[34:35], v[24:25], v[42:43] op_sel:[1,1,0] op_sel_hi:[0,1,1] neg_lo:[1,0,0]
    v_pk_fma_f32 v[44:45], v[36:37], v[24:25], v[44:45] op_sel:[1,1,0] op_sel_hi:[0,1,1] neg_lo:[1,0,0]
    v_pk_fma_f32 v[46:47], v[38:39], v[24:25], v[46:47] op_sel:[1,1,0] op_sel_hi:[0,1,1] neg_lo:[1,0,0]
    v_cvt_pk_f16_f32 v52, v16, -v17
    v_cvt_pk_f16_f32 v53, v18, -v19
    v_cvt_pk_f16_f32 v54, v20, -v21
    v_cvt_pk_f16_f32 v55, v22, -v23
    v_cvt_pk_f16_f32 v56, v24, -v25
    v_cvt_pk_f16_f32 v57, v26, -v27
    v_cvt_pk_f16_f32 v58, v28, -v29
    v_cvt_pk_f16_f32 v59, v30, -v31
    v_cvt_pk_f16_f32 v60, v32, -v33
    v_cvt_pk_f16_f32 v61, v34, -v35
    v_cvt_pk_f16_f32 v62, v36, -v37
    v_cvt_pk_f16_f32 v63, v38, -v39
    v_cvt_pk_f16_f32 v64, v40, -v41
    v_cvt_pk_f16_f32 v65, v42, -v43
    v_cvt_pk_f16_f32 v66, v44, -v45
    v_cvt_pk_f16_f32 v67, v46, -v47
    ds_write_addtid_b32 v52 offset:0
    ds_write_addtid_b32 v53 offset:288
    ds_write_addtid_b32 v54 offset:576
    ds_write_addtid_b32 v55 offset:864
    ds_write_addtid_b32 v56 offset:1152
    ds_write_addtid_b32 v57 offset:1440
    ds_write_addtid_b32 v58 offset:1728
    ds_write_addtid_b32 v59 offset:2016
    ds_write_addtid_b32 v60 offset:2304
    ds_write_addtid_b32 v61 offset:2592
    ds_write_addtid_b32 v62 offset:2880
    ds_write_addtid_b32 v63 offset:3168
    ds_write_addtid_b32 v64 offset:3456
    ds_write_addtid_b32 v65 offset:3744
    ds_write_addtid_b32 v66 offset:4032
    ds_write_addtid_b32 v67 offset:4320
    v_mov_b32 v16, v84
    v_mov_b32 v17, v85
    v_pk_mul_f32 v[18:19], v[16:17], v[4:5] op_sel:[0,0] op_sel_hi:[1,0]
    v_pk_mul_f32 v[20:21], v[16:17], v[48:49] op_sel:[0,0] op_sel_hi:[1,0]
    v_pk_mul_f32 v[24:25], v[16:17], v[50:51] op_sel:[0,0] op_sel_hi:[1,0]
    v_pk_mul_f32 v[32:33], v[16:17], v[8:9] op_sel:[0,0] op_sel_hi:[1,0]
    v_pk_fma_f32 v[18:19], v[16:17], v[4:5], v[18:19] op_sel:[1,1,0] op_sel_hi:[0,1,1] neg_lo:[1,0,0]
    v_pk_fma_f32 v[20:21], v[16:17], v[48:49], v[20:21] op_sel:[1,1,0] op_sel_hi:[0,1,1] neg_lo:[1,0,0]
    v_pk_fma_f32 v[24:25], v[16:17], v[50:51], v[24:25] op_sel:[1,1,0] op_sel_hi:[0,1,1] neg_lo:[1,0,0]
    v_pk_fma_f32 v[32:33], v[16:17], v[8:9], v[32:33] op_sel:[1,1,0] op_sel_hi:[0,1,1] neg_lo:[1,0,0]
    s_waitcnt lgkmcnt(0)
    ds_read_b128 v[68:71], v3 offset:0
    ds_read_b128 v[72:75], v3 offset:64
    ds_read_b128 v[76:79], v3 offset:128
    ds_read_b128 v[80:83], v3 offset:192
    v_pk_mul_f32 v[22:23], v[18:19], v[48:49] op_sel:[0,0] op_sel_hi:[1,0]
    v_pk_mul_f32 v[26:27], v[18:19], v[50:51] op_sel:[0,0] op_sel_hi:[1,0]
    v_pk_mul_f32 v[28:29], v[20:21], v[50:51] op_sel:[0,0] op_sel_hi:[1,0]
    v_pk_mul_f32 v[34:35], v[18:19], v[8:9] op_sel:[0,0] op_sel_hi:[1,0]
    v_pk_mul_f32 v[36:37], v[20:21], v[8:9] op_sel:[0,0] op_sel_hi:[1,0]
    v_pk_mul_f32 v[40:41], v[24:25], v[8:9] op_sel:[0,0] op_sel_hi:[1,0]
    v_pk_fma_f32 v[22:23], v[18:19], v[48:49], v[22:23] op_sel:[1,1,0] op_sel_hi:[0,1,1] neg_lo:[1,0,0]
    v_pk_fma_f32 v[26:27], v[18:19], v[50:51], v[26:27] op_sel:[1,1,0] op_sel_hi:[0,1,1] neg_lo:[1,0,0]
    v_pk_fma_f32 v[28:29], v[20:21], v[50:51], v[28:29] op_sel:[1,1,0] op_sel_hi:[0,1,1] neg_lo:[1,0,0]
    v_pk_fma_f32 v[34:35], v[18:19], v[8:9], v[34:35] op_sel:[1,1,0] op_sel_hi:[0,1,1] neg_lo:[1,0,0]
    v_pk_fma_f32 v[36:37], v[20:21], v[8:9], v[36:37] op_sel:[1,1,0] op_sel_hi:[0,1,1] neg_lo:[1,0,0]
    v_pk_fma_f32 v[40:41], v[24:25], v[8:9], v[40:41] op_sel:[1,1,0] op_sel_hi:[0,1,1] neg_lo:[1,0,0]
    v_pk_mul_f32 v[30:31], v[22:23], v[50:51] op_sel:[0,0] op_sel_hi:[1,0]
    v_pk_mul_f32 v[38:39], v[22:23], v[8:9] op_sel:[0,0] op_sel_hi:[1,0]
    v_pk_mul_f32 v[42:43], v[26:27], v[8:9] op_sel:[0,0] op_sel_hi:[1,0]
    v_pk_mul_f32 v[44:45], v[28:29], v[8:9] op_sel:[0,0] op_sel_hi:[1,0]
    v_pk_fma_f32 v[30:31], v[22:23], v[50:51], v[30:31] op_sel:[1,1,0] op_sel_hi:[0,1,1] neg_lo:[1,0,0]
    v_pk_fma_f32 v[38:39], v[22:23], v[8:9], v[38:39] op_sel:[1,1,0] op_sel_hi:[0,1,1] neg_lo:[1,0,0]
    v_pk_fma_f32 v[42:43], v[26:27], v[8:9], v[42:43] op_sel:[1,1,0] op_sel_hi:[0,1,1] neg_lo:[1,0,0]
    v_pk_fma_f32 v[44:45], v[28:29], v[8:9], v[44:45] op_sel:[1,1,0] op_sel_hi:[0,1,1] neg_lo:[1,0,0]
    v_pk_mul_f32 v[46:47], v[30:31], v[8:9] op_sel:[0,0] op_sel_hi:[1,0]
    v_pk_fma_f32 v[46:47], v[30:31], v[8:9], v[46:47] op_sel:[1,1,0] op_sel_hi:[0,1,1] neg_lo:[1,0,0]
    s_waitcnt lgkmcnt(0)
    v_cvt_pk_f16_f32 v52, v16, v17
    v_cvt_pk_f16_f32 v53, v18, v19
    v_cvt_pk_f16_f32 v54, v20, v21
    v_cvt_pk_f16_f32 v55, v22, v23
    v_cvt_pk_f16_f32 v56, v24, v25
    v_cvt_pk_f16_f32 v57, v26, v27
    v_cvt_pk_f16_f32 v58, v28, v29
    v_cvt_pk_f16_f32 v59, v30, v31
    v_cvt_pk_f16_f32 v60, v32, v33
    v_cvt_pk_f16_f32 v61, v34, v35
    v_cvt_pk_f16_f32 v62, v36, v37
    v_cvt_pk_f16_f32 v63, v38, v39
    v_cvt_pk_f16_f32 v64, v40, v41
    v_cvt_pk_f16_f32 v65, v42, v43
    v_cvt_pk_f16_f32 v66, v44, v45
    v_cvt_pk_f16_f32 v67, v46, v47
    ds_write_addtid_b32 v52 offset:0
    ds_write_addtid_b32 v53 offset:288
    ds_write_addtid_b32 v54 offset:576
    ds_write_addtid_b32 v55 offset:864
    ds_write_addtid_b32 v56 offset:1152
    ds_write_addtid_b32 v57 offset:1440
    ds_write_addtid_b32 v58 offset:1728
    ds_write_addtid_b32 v59 offset:2016
    ds_write_addtid_b32 v60 offset:2304
    ds_write_addtid_b32 v61 offset:2592
    ds_write_addtid_b32 v62 offset:2880
    ds_write_addtid_b32 v63 offset:3168
    ds_write_addtid_b32 v64 offset:3456
    ds_write_addtid_b32 v65 offset:3744
    ds_write_addtid_b32 v66 offset:4032
    ds_write_addtid_b32 v67 offset:4320
    v_pk_mul_f32 v[18:19], v[16:17], v[10:11] op_sel:[0,0] op_sel_hi:[1,0]
    v_pk_mul_f32 v[22:23], v[20:21], v[10:11] op_sel:[0,0] op_sel_hi:[1,0]
    v_pk_mul_f32 v[26:27], v[24:25], v[10:11] op_sel:[0,0] op_sel_hi:[1,0]
    v_pk_mul_f32 v[30:31], v[28:29], v[10:11] op_sel:[0,0] op_sel_hi:[1,0]
    v_pk_mul_f32 v[34:35], v[32:33], v[10:11] op_sel:[0,0] op_sel_hi:[1,0]
    v_pk_mul_f32 v[38:39], v[36:37], v[10:11] op_sel:[0,0] op_sel_hi:[1,0]
    v_pk_mul_f32 v[42:43], v[40:41], v[10:11] op_sel:[0,0] op_sel_hi:[1,0]
    v_pk_mul_f32 v[46:47], v[44:45], v[10:11] op_sel:[0,0] op_sel_hi:[1,0]
    v_pk_fma_f32 v[18:19], v[16:17], v[10:11], v[18:19] op_sel:[1,1,0] op_sel_hi:[0,1,1] neg_lo:[1,0,0]
    v_pk_fma_f32 v[22:23], v[20:21], v[10:11], v[22:23] op_sel:[1,1,0] op_sel_hi:[0,1,1] neg_lo:[1,0,0]
    v_pk_fma_f32 v[26:27], v[24:25], v[10:11], v[26:27] op_sel:[1,1,0] op_sel_hi:[0,1,1] neg_lo:[1,0,0]
    v_pk_fma_f32 v[30:31], v[28:29], v[10:11], v[30:31] op_sel:[1,1,0] op_sel_hi:[0,1,1] neg_lo:[1,0,0]
    v_pk_fma_f32 v[34:35], v[32:33], v[10:11], v[34:35] op_sel:[1,1,0] op_sel_hi:[0,1,1] neg_lo:[1,0,0]
    v_pk_fma_f32 v[38:39], v[36:37], v[10:11], v[38:39] op_sel:[1,1,0] op_sel_hi:[0,1,1] neg_lo:[1,0,0]
    v_pk_fma_f32 v[42:43], v[40:41], v[10:11], v[42:43] op_sel:[1,1,0] op_sel_hi:[0,1,1] neg_lo:[1,0,0]
    v_pk_fma_f32 v[46:47], v[44:45], v[10:11], v[46:47] op_sel:[1,1,0] op_sel_hi:[0,1,1] neg_lo:[1,0,0]
    s_waitcnt lgkmcnt(0)
    ds_read_b128 v[52:55], v3 offset:0
    ds_read_b128 v[56:59], v3 offset:64
    ds_read_b128 v[60:63], v3 offset:128
    ds_read_b128 v[64:67], v3 offset:192
    v_pk_mul_f32 v[20:21], v[16:17], v[12:13] op_sel:[0,0] op_sel_hi:[1,0]
    v_pk_mul_f32 v[28:29], v[24:25], v[12:13] op_sel:[0,0] op_sel_hi:[1,0]
    v_pk_mul_f32 v[36:37], v[32:33], v[12:13] op_sel:[0,0] op_sel_hi:[1,0]
    v_pk_mul_f32 v[44:45], v[40:41], v[12:13] op_sel:[0,0] op_sel_hi:[1,0]
    v_pk_fma_f32 v[20:21], v[16:17], v[12:13], v[20:21] op_sel:[1,1,0] op_sel_hi:[0,1,1] neg_lo:[1,0,0]
    v_pk_fma_f32 v[28:29], v[24:25], v[12:13], v[28:29] op_sel:[1,1,0] op_sel_hi:[0,1,1] neg_lo:[1,0,0]
    v_pk_fma_f32 v[36:37], v[32:33], v[12:13], v[36:37] op_sel:[1,1,0] op_sel_hi:[0,1,1] neg_lo:[1,0,0]
    v_pk_fma_f32 v[44:45], v[40:41], v[12:13], v[44:45] op_sel:[1,1,0] op_sel_hi:[0,1,1] neg_lo:[1,0,0]
    v_pk_mul_f32 v[24:25], v[20:21], v[10:11] op_sel:[0,0] op_sel_hi:[1,0]
    v_pk_mul_f32 v[40:41], v[28:29], v[10:11] op_sel:[0,0] op_sel_hi:[1,0]
    v_pk_mul_f32 v[48:49], v[36:37], v[10:11] op_sel:[0,0] op_sel_hi:[1,0]
    v_pk_mul_f32 v[50:51], v[44:45], v[10:11] op_sel:[0,0] op_sel_hi:[1,0]
    v_pk_fma_f32 v[24:25], v[20:21], v[10:11], v[24:25] op_sel:[1,1,0] op_sel_hi:[0,1,1] neg_lo:[1,0,0]
    v_pk_fma_f32 v[40:41], v[28:29], v[10:11], v[40:41] op_sel:[1,1,0] op_sel_hi:[0,1,1] neg_lo:[1,0,0]
    v_pk_fma_f32 v[48:49], v[36:37], v[10:11], v[48:49] op_sel:[1,1,0] op_sel_hi:[0,1,1] neg_lo:[1,0,0]
    v_pk_fma_f32 v[50:51], v[44:45], v[10:11], v[50:51] op_sel:[1,1,0] op_sel_hi:[0,1,1] neg_lo:[1,0,0]
    s_waitcnt lgkmcnt(0)
    v_mfma_f32_16x16x32_f16 v[84:87], v[52:55], v[68:71], 0
    v_mfma_f32_16x16x32_f16 v[84:87], v[56:59], v[72:75], v[84:87]
    v_mfma_f32_16x16x32_f16 v[84:87], v[60:63], v[76:79], v[84:87]
    v_mfma_f32_16x16x32_f16 v[84:87], v[64:67], v[80:83], v[84:87]
    v_cvt_pk_f16_f32 v52, v18, v19
    v_cvt_pk_f16_f32 v53, v22, v23
    v_cvt_pk_f16_f32 v54, v26, v27
    v_cvt_pk_f16_f32 v55, v30, v31
    v_cvt_pk_f16_f32 v56, v34, v35
    v_cvt_pk_f16_f32 v57, v38, v39
    v_cvt_pk_f16_f32 v58, v42, v43
    v_cvt_pk_f16_f32 v59, v46, v47
    v_cvt_pk_f16_f32 v60, v20, v21
    v_cvt_pk_f16_f32 v61, v28, v29
    v_cvt_pk_f16_f32 v62, v36, v37
    v_cvt_pk_f16_f32 v63, v44, v45
    v_cvt_pk_f16_f32 v64, v24, v25
    v_cvt_pk_f16_f32 v65, v40, v41
    v_cvt_pk_f16_f32 v66, v48, v49
    v_cvt_pk_f16_f32 v67, v50, v51
    ds_write_addtid_b32 v52 offset:0
    ds_write_addtid_b32 v53 offset:288
    ds_write_addtid_b32 v54 offset:576
    ds_write_addtid_b32 v55 offset:864
    ds_write_addtid_b32 v56 offset:1152
    ds_write_addtid_b32 v57 offset:1440
    ds_write_addtid_b32 v58 offset:1728
    ds_write_addtid_b32 v59 offset:2016
    ds_write_addtid_b32 v60 offset:2304
    ds_write_addtid_b32 v61 offset:2592
    ds_write_addtid_b32 v62 offset:2880
    ds_write_addtid_b32 v63 offset:3168
    ds_write_addtid_b32 v64 offset:3456
    ds_write_addtid_b32 v65 offset:3744
    ds_write_addtid_b32 v66 offset:4032
    ds_write_addtid_b32 v67 offset:4320
    v_pk_mul_f32 v[18:19], v[16:17], v[14:15] op_sel:[0,0] op_sel_hi:[1,0]
    v_pk_mul_f32 v[22:23], v[32:33], v[14:15] op_sel:[0,0] op_sel_hi:[1,0]
    v_pk_fma_f32 v[18:19], v[16:17], v[14:15], v[18:19] op_sel:[1,1,0] op_sel_hi:[0,1,1] neg_lo:[1,0,0]
    v_pk_fma_f32 v[22:23], v[32:33], v[14:15], v[22:23] op_sel:[1,1,0] op_sel_hi:[0,1,1] neg_lo:[1,0,0]
    s_waitcnt lgkmcnt(0)
    ds_read_b128 v[52:55], v3 offset:0
    ds_read_b128 v[56:59], v3 offset:64
    ds_read_b128 v[60:63], v3 offset:128
    ds_read_b128 v[64:67], v3 offset:192
    v_pk_mul_f32 v[26:27], v[18:19], v[10:11] op_sel:[0,0] op_sel_hi:[1,0]
    v_pk_mul_f32 v[30:31], v[22:23], v[10:11] op_sel:[0,0] op_sel_hi:[1,0]
    v_pk_mul_f32 v[34:35], v[18:19], v[12:13] op_sel:[0,0] op_sel_hi:[1,0]
    v_pk_mul_f32 v[38:39], v[22:23], v[12:13] op_sel:[0,0] op_sel_hi:[1,0]
    v_pk_mul_f32 v[20:21], v[18:19], v[14:15] op_sel:[0,0] op_sel_hi:[1,0]
    v_pk_fma_f32 v[26:27], v[18:19], v[10:11], v[26:27] op_sel:[1,1,0] op_sel_hi:[0,1,1] neg_lo:[1,0,0]
    v_pk_fma_f32 v[30:31], v[22:23], v[10:11], v[30:31] op_sel:[1,1,0] op_sel_hi:[0,1,1] neg_lo:[1,0,0]
    v_pk_fma_f32 v[34:35], v[18:19], v[12:13], v[34:35] op_sel:[1,1,0] op_sel_hi:[0,1,1] neg_lo:[1,0,0]
    v_pk_fma_f32 v[38:39], v[22:23], v[12:13], v[38:39] op_sel:[1,1,0] op_sel_hi:[0,1,1] neg_lo:[1,0,0]
    v_pk_fma_f32 v[20:21], v[18:19], v[14:15], v[20:21] op_sel:[1,1,0] op_sel_hi:[0,1,1] neg_lo:[1,0,0]
    v_pk_mul_f32 v[42:43], v[34:35], v[10:11] op_sel:[0,0] op_sel_hi:[1,0]
    v_pk_mul_f32 v[46:47], v[38:39], v[10:11] op_sel:[0,0] op_sel_hi:[1,0]
    v_pk_fma_f32 v[42:43], v[34:35], v[10:11], v[42:43] op_sel:[1,1,0] op_sel_hi:[0,1,1] neg_lo:[1,0,0]
    v_pk_fma_f32 v[46:47], v[38:39], v[10:11], v[46:47] op_sel:[1,1,0] op_sel_hi:[0,1,1] neg_lo:[1,0,0]
    s_waitcnt lgkmcnt(0)
    v_mfma_f32_16x16x32_f16 v[88:91], v[52:55], v[68:71], 0
    v_mfma_f32_16x16x32_f16 v[88:91], v[56:59], v[72:75], v[88:91]
    v_mfma_f32_16x16x32_f16 v[88:91], v[60:63], v[76:79], v[88:91]
    v_mfma_f32_16x16x32_f16 v[88:91], v[64:67], v[80:83], v[88:91]
    v_cvt_pk_f16_f32 v52, v18, v19
    v_cvt_pk_f16_f32 v53, v22, v23
    v_cvt_pk_f16_f32 v54, v26, v27
    v_cvt_pk_f16_f32 v55, v30, v31
    v_cvt_pk_f16_f32 v56, v34, v35
    v_cvt_pk_f16_f32 v57, v38, v39
    v_cvt_pk_f16_f32 v58, v42, v43
    v_cvt_pk_f16_f32 v59, v46, v47
    v_cvt_pk_f16_f32 v60, v20, v21
    ds_write_addtid_b32 v52 offset:0
    ds_write_addtid_b32 v53 offset:288
    ds_write_addtid_b32 v54 offset:576
    ds_write_addtid_b32 v55 offset:864
    ds_write_addtid_b32 v56 offset:1152
    ds_write_addtid_b32 v57 offset:1440
    ds_write_addtid_b32 v58 offset:1728
    ds_write_addtid_b32 v59 offset:2016
    ds_write_addtid_b32 v60 offset:2304
    s_waitcnt lgkmcnt(0)
    ds_read_b128 v[52:55], v3 offset:0
    ds_read_b128 v[56:59], v3 offset:64
    ds_read_b128 v[60:63], v3 offset:128
    ds_read_b128 v[64:67], v3 offset:192
    v_lshl_add_u32 v2, v1, 4, s46
    v_mov_b32 v4, 0
    s_waitcnt lgkmcnt(0)
    v_mfma_f32_16x16x32_f16 v[92:95], v[52:55], v[68:71], 0
    v_mfma_f32_16x16x32_f16 v[92:95], v[56:59], v[72:75], v[92:95]
    v_mfma_f32_16x16x32_f16 v[92:95], v[60:63], v[76:79], v[92:95]
    v_mfma_f32_16x16x32_f16 v[92:95], v[64:67], v[80:83], v[92:95]
    ds_write_b128 v2, v[84:87]
    ds_write_b128 v2, v[88:91] offset:1024
    ds_write_addtid_b32 v4 offset:3072
    s_nop 4
    ds_write_b128 v2, v[92:95] offset:2048
    v_mov_b32 v10, v180
    v_mov_b32 v11, v181
    v_mov_b32 v12, v182
    v_mov_b32 v13, v183
    v_mov_b32 v14, v184
    v_mov_b32 v15, v185
    s_nop 0
    s_branch L_pg_join
L_pg_lo:
    s_waitcnt lgkmcnt(0)
    s_barrier
    v_bfe_u32 v2, v1, 4, 1
    v_lshrrev_b32 v3, 5, v1
    v_bfe_u32 v4, v1, 2, 2
    v_and_b32 v5, 3, v1
    v_lshl_add_u32 v6, v3, 2, v4
    v_lshl_add_u32 v7, v6, 2, v5
    v_lshl_add_u32 v7, v7, 1, v2
    s_mul_i32 s42, s3, 40
    s_add_u32 s42, s42, 61440
    v_mul_u32_u24 v8, 496, v7
    v_add_u32 v8, s42, v8
    v_lshl_add_u32 v9, v3, 2, v5
    v_lshl_add_u32 v9, v9, 2, v4
    v_lshl_add_u32 v9, v9, 1, v2
    v_mul_u32_u24 v9, 496, v9
    v_add_u32 v9, s42, v9
    ds_read_b64 v[16:17], v8 offset:7936
    ds_read_b64 v[18:19], v8 offset:7944
    ds_read_b64 v[20:21], v8 offset:7952
    ds_read_b64 v[22:23], v8 offset:7960
    ds_read_b64 v[24:25], v8 offset:7968
    ds_read_b64 v[36:37], v8 offset:4128
    ds_read_b64 v[38:39], v8 offset:4136
    ds_read_b64 v[40:41], v8 offset:4144
    ds_read_b64 v[42:43], v8 offset:4152
    ds_read_b64 v[44:45], v8 offset:4160
    ds_read_b64 v[26:27], v8 offset:8096
    ds_read_b64 v[28:29], v8 offset:8104
    ds_read_b64 v[30:31], v8 offset:8112
    ds_read_b64 v[32:33], v8 offset:8120
    ds_read_b64 v[34:35], v8 offset:8128
    s_waitcnt lgkmcnt(10)
    ds_read_b64 v[46:47], v8 offset:160
    ds_read_b64 v[48:49], v8 offset:168
    ds_read_b64 v[50:51], v8 offset:176
    ds_read_b64 v[52:53], v8 offset:184
    ds_read_b64 v[54:55], v8 offset:192
    s_mul_i32 s42, s4, 10
    s_mul_i32 s43, s3, 5
    s_lshr_b32 s43, s43, 1
    s_add_u32 s42, s42, s43
    s_lshl_b32 s42, s42, 8
    s_mul_i32 s43, s5, 81920
    s_add_u32 s42, s42, s43
    s_add_u32 s42, s42, s41
    s_add_u32 s42, s42, 4194304
    v_lshrrev_b32 v2, 4, v7
    v_mul_u32_u24 v2, 20480, v2
    v_and_b32 v3, 15, v7
    v_lshl_add_u32 v2, v3, 4, v2
    v_add_u32 v2, s42, v2
    v_cmp_le_u32 s[44:45], 1, v5
    v_cmp_le_u32 s[46:47], 2, v5
    v_cmp_le_u32 s[48:49], 3, v5
    v_mov_b32 v3, 0xffff
    v_cndmask_b32 v4, 0, v3, s[46:47]
    v_cndmask_b32 v3, v3, -1, s[44:45]
    v_cndmask_b32 v4, v4, -1, s[48:49]
    s_waitcnt lgkmcnt(5)
    v_mfma_f32_4x4x4_16b_bf16 v[60:63], v[36:37], v[16:17], 0
    v_mfma_f32_4x4x4_16b_bf16 v[56:59], v[26:27], v[16:17], 0
    s_nop 0
    v_mfma_f32_4x4x4_16b_bf16 v[60:63], v[38:39], v[18:19], v[60:63]
    v_mfma_f32_4x4x4_16b_bf16 v[56:59], v[28:29], v[18:19], v[56:59]
    s_nop 0
    v_mfma_f32_4x4x4_16b_bf16 v[60:63], v[40:41], v[20:21], v[60:63]
    v_mfma_f32_4x4x4_16b_bf16 v[56:59], v[30:31], v[20:21], v[56:59]
    s_nop 0
    v_mfma_f32_4x4x4_16b_bf16 v[60:63], v[42:43], v[22:23], v[60:63]
    v_mfma_f32_4x4x4_16b_bf16 v[56:59], v[32:33], v[22:23], v[56:59]
    s_nop 0
    v_mfma_f32_4x4x4_16b_bf16 v[60:63], v[44:45], v[24:25], v[60:63]
    v_mfma_f32_4x4x4_16b_bf16 v[56:59], v[34:35], v[24:25], v[56:59]
    s_waitcnt lgkmcnt(0)
    v_mfma_f32_4x4x4_16b_bf16 v[64:67], v[46:47], v[16:17], 0
    s_nop 1
    v_mfma_f32_4x4x4_16b_bf16 v[64:67], v[48:49], v[18:19], v[64:67]
    s_nop 1
    v_mfma_f32_4x4x4_16b_bf16 v[64:67], v[50:51], v[20:21], v[64:67]
    s_nop 1
    v_mfma_f32_4x4x4_16b_bf16 v[64:67], v[52:53], v[22:23], v[64:67]
    s_nop 1
    v_mfma_f32_4x4x4_16b_bf16 v[64:67], v[54:55], v[24:25], v[64:67]
    ds_read_b64_tr_b16 v[26:27], v9 offset:8256
    ds_read_b64_tr_b16 v[28:29], v9 offset:8264
    ds_read_b64_tr_b16 v[30:31], v9 offset:8272
    ds_read_b64_tr_b16 v[32:33], v9 offset:8280
    ds_read_b64_tr_b16 v[34:35], v9 offset:8288
    ds_read_b64_tr_b16 v[36:37], v9 offset:4288
    ds_read_b64_tr_b16 v[38:39], v9 offset:4296
    ds_read_b64_tr_b16 v[40:41], v9 offset:4304
    ds_read_b64_tr_b16 v[42:43], v9 offset:4312
    ds_read_b64_tr_b16 v[44:45], v9 offset:4320
    ds_read_b64_tr_b16 v[46:47], v9 offset:320
    ds_read_b64_tr_b16 v[48:49], v9 offset:328
    ds_read_b64_tr_b16 v[50:51], v9 offset:336
    ds_read_b64_tr_b16 v[52:53], v9 offset:344
    ds_read_b64_tr_b16 v[54:55], v9 offset:352
    s_cmp_lg_u32 s5, 0
    s_cbranch_scc1 L_at_nomask
    v_mov_b32 v88, 0xce6e6b28
    v_cmp_eq_u32 vcc, 0, v6
    v_cmp_ge_u32 s[50:51], 1, v6
    s_nop 0
    v_cndmask_b32 v60, v60, v88, vcc
    v_cndmask_b32 v61, v61, v88, vcc
    v_cndmask_b32 v62, v62, v88, vcc
    v_cndmask_b32 v63, v63, v88, vcc
    v_cndmask_b32 v65, v65, v88, s[50:51]
    v_cndmask_b32 v66, v66, v88, s[50:51]
    v_cndmask_b32 v67, v67, v88, s[50:51]
L_at_nomask:
    v_cndmask_b32 v57, v65, v57, s[44:45]
    v_cndmask_b32 v58, v66, v58, s[46:47]
    v_cndmask_b32 v59, v67, v59, s[48:49]
    v_cvt_pk_bf16_f32 v88, v56, v57
    v_cvt_pk_bf16_f32 v89, v58, v59
    v_cvt_pk_bf16_f32 v90, v60, v61
    v_cvt_pk_bf16_f32 v91, v62, v63
    v_lshlrev_b32 v56, 16, v88
    v_and_b32 v57, 0xffff0000, v88
    v_lshlrev_b32 v58, 16, v89
    v_and_b32 v59, 0xffff0000, v89
    v_lshlrev_b32 v60, 16, v90
    v_and_b32 v61, 0xffff0000, v90
    v_lshlrev_b32 v62, 16, v91
    v_and_b32 v63, 0xffff0000, v91
    s_mov_b32 s50, 1046804782
    s_mov_b32 s51, 1046804782
    v_pk_mul_f32 v[56:57], v[56:57], s[50:51]
    v_pk_mul_f32 v[58:59], v[58:59], s[50:51]
    v_pk_mul_f32 v[60:61], v[60:61], s[50:51]
    v_pk_mul_f32 v[62:63], v[62:63], s[50:51]
    v_cvt_pk_bf16_f32 v88, v56, v57
    v_cvt_pk_bf16_f32 v89, v58, v59
    v_cvt_pk_bf16_f32 v90, v60, v61
    v_cvt_pk_bf16_f32 v91, v62, v63
    v_lshlrev_b32 v56, 16, v88
    v_and_b32 v57, 0xffff0000, v88
    v_lshlrev_b32 v58, 16, v89
    v_and_b32 v59, 0xffff0000, v89
    v_lshlrev_b32 v60, 16, v90
    v_and_b32 v61, 0xffff0000, v90
    v_lshlrev_b32 v62, 16, v91
    v_and_b32 v63, 0xffff0000, v91
    v_max3_f32 v88, v56, v57, v58
    v_max3_f32 v89, v59, v60, v61
    v_max3_f32 v88, v88, v62, v63
    v_max_f32 v88, v88, v89
    s_mov_b32 s50, 1069066811
    s_mov_b32 s51, 1069066811
    v_mov_b32 v89, v88
    v_pk_add_f32 v[56:57], v[56:57], v[88:89] neg_lo:[0,1] neg_hi:[0,1]
    v_pk_add_f32 v[58:59], v[58:59], v[88:89] neg_lo:[0,1] neg_hi:[0,1]
    v_pk_add_f32 v[60:61], v[60:61], v[88:89] neg_lo:[0,1] neg_hi:[0,1]
    v_pk_add_f32 v[62:63], v[62:63], v[88:89] neg_lo:[0,1] neg_hi:[0,1]
    v_pk_mul_f32 v[56:57], v[56:57], s[50:51]
    v_pk_mul_f32 v[58:59], v[58:59], s[50:51]
    v_pk_mul_f32 v[60:61], v[60:61], s[50:51]
    v_pk_mul_f32 v[62:63], v[62:63], s[50:51]
    v_exp_f32 v56, v56
    v_exp_f32 v57, v57
    v_exp_f32 v58, v58
    v_exp_f32 v59, v59
    v_exp_f32 v60, v60
    v_exp_f32 v61, v61
    v_exp_f32 v62, v62
    v_exp_f32 v63, v63
    v_add_f32 v88, v56, v57
    v_add_f32 v89, v58, v59
    v_add_f32 v90, v60, v61
    v_add_f32 v91, v62, v63
    v_add_f32 v88, v88, v89
    v_add_f32 v90, v90, v91
    v_add_f32 v88, v88, v90
    v_rcp_f32 v88, v88
    s_nop 0
    v_mul_f32 v56, v56, v88
    v_mul_f32 v57, v57, v88
    v_mul_f32 v58, v58, v88
    v_mul_f32 v59, v59, v88
    v_mul_f32 v60, v60, v88
    v_mul_f32 v61, v61, v88
    v_mul_f32 v62, v62, v88
    v_mul_f32 v63, v63, v88
    v_cvt_pk_bf16_f32 v92, v56, v57
    v_cvt_pk_bf16_f32 v93, v58, v59
    v_cvt_pk_bf16_f32 v90, v60, v61
    v_cvt_pk_bf16_f32 v91, v62, v63
    v_and_b32 v88, v3, v92
    v_and_b32 v89, v4, v93
    v_xor_b32 v92, v88, v92
    v_xor_b32 v93, v89, v93
    s_waitcnt lgkmcnt(0)
    s_barrier
    v_mfma_f32_4x4x4_16b_bf16 v[68:71], v[36:37], v[90:91], 0
    v_mfma_f32_4x4x4_16b_bf16 v[72:75], v[38:39], v[90:91], 0
    v_mfma_f32_4x4x4_16b_bf16 v[76:79], v[40:41], v[90:91], 0
    v_mfma_f32_4x4x4_16b_bf16 v[80:83], v[42:43], v[90:91], 0
    v_mfma_f32_4x4x4_16b_bf16 v[84:87], v[44:45], v[90:91], 0
    v_mfma_f32_4x4x4_16b_bf16 v[68:71], v[26:27], v[88:89], v[68:71]
    v_mfma_f32_4x4x4_16b_bf16 v[72:75], v[28:29], v[88:89], v[72:75]
    v_mfma_f32_4x4x4_16b_bf16 v[76:79], v[30:31], v[88:89], v[76:79]
    v_mfma_f32_4x4x4_16b_bf16 v[80:83], v[32:33], v[88:89], v[80:83]
    v_mfma_f32_4x4x4_16b_bf16 v[84:87], v[34:35], v[88:89], v[84:87]
    v_mfma_f32_4x4x4_16b_bf16 v[68:71], v[46:47], v[92:93], v[68:71]
    v_mfma_f32_4x4x4_16b_bf16 v[72:75], v[48:49], v[92:93], v[72:75]
    v_mfma_f32_4x4x4_16b_bf16 v[76:79], v[50:51], v[92:93], v[76:79]
    v_mfma_f32_4x4x4_16b_bf16 v[80:83], v[52:53], v[92:93], v[80:83]
    v_mfma_f32_4x4x4_16b_bf16 v[84:87], v[54:55], v[92:93], v[84:87]
    s_nop 0
    v_cvt_pk_bf16_f32 v16, v68, v69
    v_cvt_pk_bf16_f32 v17, v70, v71
    v_cvt_pk_bf16_f32 v18, v72, v73
    v_cvt_pk_bf16_f32 v19, v74, v75
    v_cvt_pk_bf16_f32 v20, v76, v77
    v_cvt_pk_bf16_f32 v21, v78, v79
    v_cvt_pk_bf16_f32 v22, v80, v81
    v_cvt_pk_bf16_f32 v23, v82, v83
    v_cvt_pk_bf16_f32 v24, v84, v85
    v_cvt_pk_bf16_f32 v25, v86, v87
    s_bitcmp1_b32 s3, 0
    s_cbranch_scc1 L_at_odd
    global_store_dwordx4 v2, v[16:19], s[32:33] sc1
    global_store_dwordx4 v2, v[20:23], s[32:33] offset:256 sc1
    global_store_dwordx2 v2, v[24:25], s[32:33] offset:512 sc1
    s_branch L_at_st
L_at_odd:
    global_store_dwordx2 v2, v[16:17], s[32:33] offset:8 sc1
    global_store_dwordx4 v2, v[18:21], s[32:33] offset:256 sc1
    global_store_dwordx4 v2, v[22:25], s[32:33] offset:512 sc1
L_at_st:
    s_lshl_b32 s42, s7, 2
    s_add_u32 s42, s42, 45328
    s_waitcnt vmcnt(0)
    v_mov_b32 v2, s42
    v_mov_b32 v4, 1
    s_mov_b64 exec, 1
    ds_add_rtn_u32 v4, v2, v4
    s_waitcnt lgkmcnt(0)
    s_mov_b64 exec, -1
    v_readfirstlane_b32 s56, v4
    s_nop 1
    s_cmp_eq_u32 s56, 3
    s_nop 0
    s_cbranch_scc0 L_pg_np
    s_lshl_b32 s42, s5, 3
    s_add_u32 s43, s42, s4
    s_lshl_b32 s43, s43, 7
    s_add_u32 s43, s43, s40
    s_add_u32 s43, s43, 36864
    v_mov_b32 v2, s43
    v_mov_b32 v4, s34
    v_mov_b32 v5, s35
    s_mov_b64 exec, 1
    global_store_dwordx2 v2, v[4:5], s[32:33] sc1
    s_mov_b64 exec, -1
L_pg_np:
    s_cmp_eq_u32 s3, 0
    s_cbranch_scc0 L_pg_join
    s_lshl_b32 s42, s5, 10
    s_add_u32 s42, s42, s40
    s_add_u32 s42, s42, 36864
    v_and_b32 v2, 7, v1
    v_lshl_add_u32 v2, v2, 7, s42
    s_mov_b32 s57, 0
L_poll8:
    global_load_dwordx2 v[4:5], v2, s[32:33] sc1
    s_add_u32 s57, s57, 1
    s_waitcnt vmcnt(0)
    v_cmp_ne_u64 vcc, s[34:35], v[4:5]
    s_cmp_gt_u32 s57, 200000
    s_nop 2
    s_cbranch_scc1 L_end
    s_cbranch_vccnz L_poll8
L_pg_join:
    v_and_b32 v6, 15, v1
    v_lshrrev_b32 v7, 4, v1
    s_and_b32 s42, s3, 3
    s_lshr_b32 s43, s3, 2
    s_lshl_b32 s44, s5, 2
    s_add_u32 s44, s44, s42
    s_mul_i32 s44, s44, 20480
    s_mul_i32 s45, s43, 10240
    s_add_u32 s44, s44, s45
    s_add_u32 s44, s44, s41
    s_add_u32 s44, s44, 4194304
    v_lshl_add_u32 v2, v1, 4, s44
    v_add_u32 v3, 4096, v2
    v_add_u32 v4, 8192, v2
    s_mul_i32 s45, s43, 51200
    s_add_u32 s45, s45, 61440
    v_lshrrev_b32 v5, 2, v1
    v_mul_u32_u24 v5, 160, v5
    v_and_b32 v8, 3, v1
    v_lshl_add_u32 v5, v8, 3, v5
    v_add_u32 v5, s45, v5
    s_waitcnt vmcnt(0) lgkmcnt(0)
    s_barrier
    global_load_dwordx4 v[16:19], v2, s[32:33] offset:0 sc1
    global_load_dwordx4 v[20:23], v2, s[32:33] offset:1024 sc1
    global_load_dwordx4 v[24:27], v2, s[32:33] offset:2048 sc1
    global_load_dwordx4 v[28:31], v2, s[32:33] offset:3072 sc1
    global_load_dwordx4 v[32:35], v3, s[32:33] offset:0 sc1
    global_load_dwordx4 v[36:39], v3, s[32:33] offset:1024 sc1
    global_load_dwordx4 v[40:43], v3, s[32:33] offset:2048 sc1
    global_load_dwordx4 v[44:47], v3, s[32:33] offset:3072 sc1
    global_load_dwordx4 v[48:51], v4, s[32:33] offset:0 sc1
    global_load_dwordx4 v[52:55], v4, s[32:33] offset:1024 sc1
    ds_read_b64_tr_b16 v[76:77], v5 offset:0
    ds_read_b64_tr_b16 v[78:79], v5 offset:2560
    ds_read_b64_tr_b16 v[80:81], v5 offset:32
    ds_read_b64_tr_b16 v[82:83], v5 offset:2592
    ds_read_b64_tr_b16 v[84:85], v5 offset:64
    ds_read_b64_tr_b16 v[86:87], v5 offset:2624
    ds_read_b64_tr_b16 v[88:89], v5 offset:96
    ds_read_b64_tr_b16 v[90:91], v5 offset:2656
    s_mul_i32 s44, s42, 5120
    s_add_u32 s44, s44, 61440
    v_lshl_add_u32 v2, v1, 4, s44
    s_mul_i32 s44, s4, 80
    s_mul_i32 s45, s43, 48
    s_add_u32 s44, s44, s45
    s_lshl_b32 s44, s44, 12
    s_lshl_b32 s45, s5, 7
    s_add_u32 s44, s44, s45
    s_lshl_b32 s45, s42, 5
    s_add_u32 s44, s44, s45
    s_add_u32 s44, s44, s41
    s_add_u32 s44, s44, 9437184
    v_lshl_add_u32 v3, v6, 12, s44
    v_lshl_add_u32 v3, v7, 3, v3
    s_mul_i32 s44, s7, 262144
    s_lshl_b32 s45, s5, 13
    s_add_u32 s44, s44, s45
    s_lshl_b32 s45, s42, 7
    s_add_u32 s44, s44, s45
    s_add_u32 s44, s44, 262144
    v_lshl_add_u32 v4, v6, 9, s44
    v_lshl_add_u32 v4, v7, 5, v4
    s_lshl_b32 s45, s4, 1
    s_add_u32 s45, s45, s43
    s_lshl_b32 s45, s45, 9
    s_add_u32 s44, s44, s45
    v_lshl_add_u32 v9, v7, 2, v8
    v_lshl_add_u32 v9, v9, 3, s44
    v_and_b32 v8, 1, v1
    v_cmp_eq_u32 s[46:47], 0, v8
    v_and_b32 v8, 2, v1
    v_cmp_eq_u32 s[48:49], 0, v8
    ds_read_b64_tr_b16 v[92:93], v5 offset:128
    ds_read_b64_tr_b16 v[94:95], v5 offset:2688
    s_waitcnt vmcnt(9) lgkmcnt(8)
    v_mfma_f32_16x16x32_bf16 v[56:59], v[16:19], v[76:79], 0
    ds_read_b64_tr_b16 v[76:77], v5 offset:5120
    ds_read_b64_tr_b16 v[78:79], v5 offset:7680
    s_waitcnt lgkmcnt(8)
    v_mfma_f32_16x16x32_bf16 v[60:63], v[16:19], v[80:83], 0
    ds_read_b64_tr_b16 v[80:81], v5 offset:5152
    ds_read_b64_tr_b16 v[82:83], v5 offset:7712
    s_waitcnt lgkmcnt(8)
    v_mfma_f32_16x16x32_bf16 v[64:67], v[16:19], v[84:87], 0
    ds_read_b64_tr_b16 v[84:85], v5 offset:5184
    ds_read_b64_tr_b16 v[86:87], v5 offset:7744
    s_waitcnt lgkmcnt(8)
    v_mfma_f32_16x16x32_bf16 v[68:71], v[16:19], v[88:91], 0
    ds_read_b64_tr_b16 v[88:89], v5 offset:5216
    ds_read_b64_tr_b16 v[90:91], v5 offset:7776
    s_waitcnt lgkmcnt(8)
    v_mfma_f32_16x16x32_bf16 v[72:75], v[16:19], v[92:95], 0
    ds_read_b64_tr_b16 v[92:93], v5 offset:5248
    ds_read_b64_tr_b16 v[94:95], v5 offset:7808
    s_waitcnt vmcnt(8) lgkmcnt(8)
    v_mfma_f32_16x16x32_bf16 v[56:59], v[20:23], v[76:79], v[56:59]
    ds_read_b64_tr_b16 v[76:77], v5 offset:10240
    ds_read_b64_tr_b16 v[78:79], v5 offset:12800
    s_waitcnt lgkmcnt(8)
    v_mfma_f32_16x16x32_bf16 v[60:63], v[20:23], v[80:83], v[60:63]
    ds_read_b64_tr_b16 v[80:81], v5 offset:10272
    ds_read_b64_tr_b16 v[82:83], v5 offset:12832
    s_waitcnt lgkmcnt(8)
    v_mfma_f32_16x16x32_bf16 v[64:67], v[20:23], v[84:87], v[64:67]
    ds_read_b64_tr_b16 v[84:85], v5 offset:10304
    ds_read_b64_tr_b16 v[86:87], v5 offset:12864
    s_waitcnt lgkmcnt(8)
    v_mfma_f32_16x16x32_bf16 v[68:71], v[20:23], v[88:91], v[68:71]
    ds_read_b64_tr_b16 v[88:89], v5 offset:10336
    ds_read_b64_tr_b16 v[90:91], v5 offset:12896
    s_waitcnt lgkmcnt(8)
    v_mfma_f32_16x16x32_bf16 v[72:75], v[20:23], v[92:95], v[72:75]
    ds_read_b64_tr_b16 v[92:93], v5 offset:10368
    ds_read_b64_tr_b16 v[94:95], v5 offset:12928
    s_waitcnt vmcnt(7) lgkmcnt(8)
    v_mfma_f32_16x16x32_bf16 v[56:59], v[24:27], v[76:79], v[56:59]
    ds_read_b64_tr_b16 v[76:77], v5 offset:15360
    ds_read_b64_tr_b16 v[78:79], v5 offset:17920
    s_waitcnt lgkmcnt(8)
    v_mfma_f32_16x16x32_bf16 v[60:63], v[24:27], v[80:83], v[60:63]
    ds_read_b64_tr_b16 v[80:81], v5 offset:15392
    ds_read_b64_tr_b16 v[82:83], v5 offset:17952
    s_waitcnt lgkmcnt(8)
    v_mfma_f32_16x16x32_bf16 v[64:67], v[24:27], v[84:87], v[64:67]
    ds_read_b64_tr_b16 v[84:85], v5 offset:15424
    ds_read_b64_tr_b16 v[86:87], v5 offset:17984
    s_waitcnt lgkmcnt(8)
    v_mfma_f32_16x16x32_bf16 v[68:71], v[24:27], v[88:91], v[68:71]
    ds_read_b64_tr_b16 v[88:89], v5 offset:15456
    ds_read_b64_tr_b16 v[90:91], v5 offset:18016
    s_waitcnt lgkmcnt(8)
    v_mfma_f32_16x16x32_bf16 v[72:75], v[24:27], v[92:95], v[72:75]
    ds_read_b64_tr_b16 v[92:93], v5 offset:15488
    ds_read_b64_tr_b16 v[94:95], v5 offset:18048
    s_waitcnt vmcnt(6) lgkmcnt(8)
    v_mfma_f32_16x16x32_bf16 v[56:59], v[28:31], v[76:79], v[56:59]
    ds_read_b64_tr_b16 v[76:77], v5 offset:20480
    ds_read_b64_tr_b16 v[78:79], v5 offset:23040
    s_waitcnt lgkmcnt(8)
    v_mfma_f32_16x16x32_bf16 v[60:63], v[28:31], v[80:83], v[60:63]
    ds_read_b64_tr_b16 v[80:81], v5 offset:20512
    ds_read_b64_tr_b16 v[82:83], v5 offset:23072
    s_waitcnt lgkmcnt(8)
    v_mfma_f32_16x16x32_bf16 v[64:67], v[28:31], v[84:87], v[64:67]
    ds_read_b64_tr_b16 v[84:85], v5 offset:20544
    ds_read_b64_tr_b16 v[86:87], v5 offset:23104
    s_waitcnt lgkmcnt(8)
    v_mfma_f32_16x16x32_bf16 v[68:71], v[28:31], v[88:91], v[68:71]
    ds_read_b64_tr_b16 v[88:89], v5 offset:20576
    ds_read_b64_tr_b16 v[90:91], v5 offset:23136
    s_waitcnt lgkmcnt(8)
    v_mfma_f32_16x16x32_bf16 v[72:75], v[28:31], v[92:95], v[72:75]
    ds_read_b64_tr_b16 v[92:93], v5 offset:20608
    ds_read_b64_tr_b16 v[94:95], v5 offset:23168
    s_waitcnt vmcnt(5) lgkmcnt(8)
    v_mfma_f32_16x16x32_bf16 v[56:59], v[32:35], v[76:79], v[56:59]
    ds_read_b64_tr_b16 v[76:77], v5 offset:25600
    ds_read_b64_tr_b16 v[78:79], v5 offset:28160
    s_waitcnt lgkmcnt(8)
    v_mfma_f32_16x16x32_bf16 v[60:63], v[32:35], v[80:83], v[60:63]
    ds_read_b64_tr_b16 v[80:81], v5 offset:25632
    ds_read_b64_tr_b16 v[82:83], v5 offset:28192
    s_waitcnt lgkmcnt(8)
    v_mfma_f32_16x16x32_bf16 v[64:67], v[32:35], v[84:87], v[64:67]
    ds_read_b64_tr_b16 v[84:85], v5 offset:25664
    ds_read_b64_tr_b16 v[86:87], v5 offset:28224
    s_waitcnt lgkmcnt(8)
    v_mfma_f32_16x16x32_bf16 v[68:71], v[32:35], v[88:91], v[68:71]
    ds_read_b64_tr_b16 v[88:89], v5 offset:25696
    ds_read_b64_tr_b16 v[90:91], v5 offset:28256
    s_waitcnt lgkmcnt(8)
    v_mfma_f32_16x16x32_bf16 v[72:75], v[32:35], v[92:95], v[72:75]
    ds_read_b64_tr_b16 v[92:93], v5 offset:25728
    ds_read_b64_tr_b16 v[94:95], v5 offset:28288
    s_waitcnt vmcnt(4) lgkmcnt(8)
    v_mfma_f32_16x16x32_bf16 v[56:59], v[36:39], v[76:79], v[56:59]
    ds_read_b64_tr_b16 v[76:77], v5 offset:30720
    ds_read_b64_tr_b16 v[78:79], v5 offset:33280
    s_waitcnt lgkmcnt(8)
    v_mfma_f32_16x16x32_bf16 v[60:63], v[36:39], v[80:83], v[60:63]
    ds_read_b64_tr_b16 v[80:81], v5 offset:30752
    ds_read_b64_tr_b16 v[82:83], v5 offset:33312
    s_waitcnt lgkmcnt(8)
    v_mfma_f32_16x16x32_bf16 v[64:67], v[36:39], v[84:87], v[64:67]
    ds_read_b64_tr_b16 v[84:85], v5 offset:30784
    ds_read_b64_tr_b16 v[86:87], v5 offset:33344
    s_waitcnt lgkmcnt(8)
    v_mfma_f32_16x16x32_bf16 v[68:71], v[36:39], v[88:91], v[68:71]
    ds_read_b64_tr_b16 v[88:89], v5 offset:30816
    ds_read_b64_tr_b16 v[90:91], v5 offset:33376
    s_waitcnt lgkmcnt(8)
    v_mfma_f32_16x16x32_bf16 v[72:75], v[36:39], v[92:95], v[72:75]
    ds_read_b64_tr_b16 v[92:93], v5 offset:30848
    ds_read_b64_tr_b16 v[94:95], v5 offset:33408
    s_waitcnt vmcnt(3) lgkmcnt(8)
    v_mfma_f32_16x16x32_bf16 v[56:59], v[40:43], v[76:79], v[56:59]
    ds_read_b64_tr_b16 v[76:77], v5 offset:35840
    ds_read_b64_tr_b16 v[78:79], v5 offset:38400
    s_waitcnt lgkmcnt(8)
    v_mfma_f32_16x16x32_bf16 v[60:63], v[40:43], v[80:83], v[60:63]
    ds_read_b64_tr_b16 v[80:81], v5 offset:35872
    ds_read_b64_tr_b16 v[82:83], v5 offset:38432
    s_waitcnt lgkmcnt(8)
    v_mfma_f32_16x16x32_bf16 v[64:67], v[40:43], v[84:87], v[64:67]
    ds_read_b64_tr_b16 v[84:85], v5 offset:35904
    ds_read_b64_tr_b16 v[86:87], v5 offset:38464
    s_waitcnt lgkmcnt(8)
    v_mfma_f32_16x16x32_bf16 v[68:71], v[40:43], v[88:91], v[68:71]
    ds_read_b64_tr_b16 v[88:89], v5 offset:35936
    ds_read_b64_tr_b16 v[90:91], v5 offset:38496
    s_waitcnt lgkmcnt(8)
    v_mfma_f32_16x16x32_bf16 v[72:75], v[40:43], v[92:95], v[72:75]
    ds_read_b64_tr_b16 v[92:93], v5 offset:35968
    ds_read_b64_tr_b16 v[94:95], v5 offset:38528
    s_waitcnt vmcnt(2) lgkmcnt(8)
    v_mfma_f32_16x16x32_bf16 v[56:59], v[44:47], v[76:79], v[56:59]
    ds_read_b64_tr_b16 v[76:77], v5 offset:40960
    ds_read_b64_tr_b16 v[78:79], v5 offset:43520
    s_waitcnt lgkmcnt(8)
    v_mfma_f32_16x16x32_bf16 v[60:63], v[44:47], v[80:83], v[60:63]
    ds_read_b64_tr_b16 v[80:81], v5 offset:40992
    ds_read_b64_tr_b16 v[82:83], v5 offset:43552
    s_waitcnt lgkmcnt(8)
    v_mfma_f32_16x16x32_bf16 v[64:67], v[44:47], v[84:87], v[64:67]
    ds_read_b64_tr_b16 v[84:85], v5 offset:41024
    ds_read_b64_tr_b16 v[86:87], v5 offset:43584
    s_waitcnt lgkmcnt(8)
    v_mfma_f32_16x16x32_bf16 v[68:71], v[44:47], v[88:91], v[68:71]
    ds_read_b64_tr_b16 v[88:89], v5 offset:41056
    ds_read_b64_tr_b16 v[90:91], v5 offset:43616
    s_waitcnt lgkmcnt(8)
    v_mfma_f32_16x16x32_bf16 v[72:75], v[44:47], v[92:95], v[72:75]
    ds_read_b64_tr_b16 v[92:93], v5 offset:41088
    ds_read_b64_tr_b16 v[94:95], v5 offset:43648
    s_waitcnt vmcnt(1) lgkmcnt(8)
    v_mfma_f32_16x16x32_bf16 v[56:59], v[48:51], v[76:79], v[56:59]
    ds_read_b64_tr_b16 v[76:77], v5 offset:46080
    ds_read_b64_tr_b16 v[78:79], v5 offset:48640
    s_waitcnt lgkmcnt(8)
    v_mfma_f32_16x16x32_bf16 v[60:63], v[48:51], v[80:83], v[60:63]
    ds_read_b64_tr_b16 v[80:81], v5 offset:46112
    ds_read_b64_tr_b16 v[82:83], v5 offset:48672
    s_waitcnt lgkmcnt(8)
    v_mfma_f32_16x16x32_bf16 v[64:67], v[48:51], v[84:87], v[64:67]
    ds_read_b64_tr_b16 v[84:85], v5 offset:46144
    ds_read_b64_tr_b16 v[86:87], v5 offset:48704
    s_waitcnt lgkmcnt(8)
    v_mfma_f32_16x16x32_bf16 v[68:71], v[48:51], v[88:91], v[68:71]
    ds_read_b64_tr_b16 v[88:89], v5 offset:46176
    ds_read_b64_tr_b16 v[90:91], v5 offset:48736
    s_waitcnt lgkmcnt(8)
    v_mfma_f32_16x16x32_bf16 v[72:75], v[48:51], v[92:95], v[72:75]
    ds_read_b64_tr_b16 v[92:93], v5 offset:46208
    ds_read_b64_tr_b16 v[94:95], v5 offset:48768
    s_waitcnt vmcnt(0) lgkmcnt(8)
    v_mfma_f32_16x16x32_bf16 v[56:59], v[52:55], v[76:79], v[56:59]
    s_waitcnt lgkmcnt(6)
    v_mfma_f32_16x16x32_bf16 v[60:63], v[52:55], v[80:83], v[60:63]
    s_waitcnt lgkmcnt(4)
    v_mfma_f32_16x16x32_bf16 v[64:67], v[52:55], v[84:87], v[64:67]
    s_waitcnt lgkmcnt(2)
    v_mfma_f32_16x16x32_bf16 v[68:71], v[52:55], v[88:91], v[68:71]
    s_waitcnt lgkmcnt(0)
    v_mfma_f32_16x16x32_bf16 v[72:75], v[52:55], v[92:95], v[72:75]
    s_barrier
    s_cmp_ge_u32 s3, 4
    s_nop 4
    s_cbranch_scc1 L_a2_k1
    ds_write_b128 v2, v[68:71] offset:3072
    ds_write_b128 v2, v[72:75] offset:4096
    s_waitcnt lgkmcnt(0)
    s_barrier
    ds_read_b128 v[16:19], v2 offset:0
    ds_read_b128 v[20:23], v2 offset:1024
    ds_read_b128 v[24:27], v2 offset:2048
    v_lshlrev_b32 v28, 16, v10
    v_and_b32 v29, 0xffff0000, v10
    v_lshlrev_b32 v30, 16, v11
    v_and_b32 v31, 0xffff0000, v11
    v_lshlrev_b32 v32, 16, v12
    v_and_b32 v33, 0xffff0000, v12
    v_lshlrev_b32 v34, 16, v13
    v_and_b32 v35, 0xffff0000, v13
    v_lshlrev_b32 v36, 16, v14
    v_and_b32 v37, 0xffff0000, v14
    v_lshlrev_b32 v38, 16, v15
    v_and_b32 v39, 0xffff0000, v15
    s_waitcnt lgkmcnt(0)
    v_add_f32 v16, v16, v56
    v_add_f32 v17, v17, v57
    v_add_f32 v18, v18, v58
    v_add_f32 v19, v19, v59
    v_add_f32 v20, v20, v60
    v_add_f32 v21, v21, v61
    v_add_f32 v22, v22, v62
    v_add_f32 v23, v23, v63
    v_add_f32 v24, v24, v64
    v_add_f32 v25, v25, v65
    v_add_f32 v26, v26, v66
    v_add_f32 v27, v27, v67
    v_cvt_pk_bf16_f32 v40, v16, v17
    v_cvt_pk_bf16_f32 v41, v18, v19
    v_cvt_pk_bf16_f32 v42, v20, v21
    v_cvt_pk_bf16_f32 v43, v22, v23
    v_cvt_pk_bf16_f32 v44, v24, v25
    v_cvt_pk_bf16_f32 v45, v26, v27
    v_lshlrev_b32 v16, 16, v40
    v_and_b32 v17, 0xffff0000, v40
    v_lshlrev_b32 v18, 16, v41
    v_and_b32 v19, 0xffff0000, v41
    v_lshlrev_b32 v20, 16, v42
    v_and_b32 v21, 0xffff0000, v42
    v_lshlrev_b32 v22, 16, v43
    v_and_b32 v23, 0xffff0000, v43
    v_lshlrev_b32 v24, 16, v44
    v_and_b32 v25, 0xffff0000, v44
    v_lshlrev_b32 v26, 16, v45
    v_and_b32 v27, 0xffff0000, v45
    v_add_f32 v28, v28, v16
    v_add_f32 v29, v29, v17
    v_add_f32 v30, v30, v18
    v_add_f32 v31, v31, v19
    v_add_f32 v32, v32, v20
    v_add_f32 v33, v33, v21
    v_add_f32 v34, v34, v22
    v_add_f32 v35, v35, v23
    v_add_f32 v36, v36, v24
    v_add_f32 v37, v37, v25
    v_add_f32 v38, v38, v26
    v_add_f32 v39, v39, v27
    v_cvt_pk_bf16_f32 v40, v28, v29
    v_cvt_pk_bf16_f32 v41, v30, v31
    v_cvt_pk_bf16_f32 v42, v32, v33
    v_cvt_pk_bf16_f32 v43, v34, v35
    v_cvt_pk_bf16_f32 v44, v36, v37
    v_cvt_pk_bf16_f32 v45, v38, v39
    v_lshlrev_b32 v28, 16, v40
    v_and_b32 v29, 0xffff0000, v40
    v_lshlrev_b32 v30, 16, v41
    v_and_b32 v31, 0xffff0000, v41
    v_lshlrev_b32 v32, 16, v42
    v_and_b32 v33, 0xffff0000, v42
    v_lshlrev_b32 v34, 16, v43
    v_and_b32 v35, 0xffff0000, v43
    v_lshlrev_b32 v36, 16, v44
    v_and_b32 v37, 0xffff0000, v44
    v_lshlrev_b32 v38, 16, v45
    v_and_b32 v39, 0xffff0000, v45
    v_add_f32 v56, v28, v32
    v_mul_f32 v60, v28, v28
    v_add_f32 v57, v29, v33
    v_mul_f32 v61, v29, v29
    v_add_f32 v58, v30, v34
    v_mul_f32 v62, v30, v30
    v_add_f32 v59, v31, v35
    v_mul_f32 v63, v31, v31
    v_fmac_f32 v60, v32, v32
    v_fmac_f32 v61, v33, v33
    v_fmac_f32 v62, v34, v34
    v_fmac_f32 v63, v35, v35
    v_add_f32 v56, v56, v36
    v_fmac_f32 v60, v36, v36
    v_add_f32 v57, v57, v37
    v_fmac_f32 v61, v37, v37
    v_add_f32 v58, v58, v38
    v_fmac_f32 v62, v38, v38
    v_add_f32 v59, v59, v39
    v_fmac_f32 v63, v39, v39
    v_cndmask_b32 v64, v57, v56, s[46:47]
    v_cndmask_b32 v68, v56, v57, s[46:47]
    v_cndmask_b32 v65, v61, v60, s[46:47]
    v_cndmask_b32 v69, v60, v61, s[46:47]
    v_cndmask_b32 v66, v59, v58, s[46:47]
    v_cndmask_b32 v70, v58, v59, s[46:47]
    v_cndmask_b32 v67, v63, v62, s[46:47]
    v_cndmask_b32 v71, v62, v63, s[46:47]
    v_add_f32_dpp v64, v68, v64 quad_perm:[1,0,3,2] row_mask:0xf bank_mask:0xf
    v_add_f32_dpp v65, v69, v65 quad_perm:[1,0,3,2] row_mask:0xf bank_mask:0xf
    v_add_f32_dpp v66, v70, v66 quad_perm:[1,0,3,2] row_mask:0xf bank_mask:0xf
    v_add_f32_dpp v67, v71, v67 quad_perm:[1,0,3,2] row_mask:0xf bank_mask:0xf
    v_cndmask_b32 v68, v64, v66, s[48:49]
    v_cndmask_b32 v64, v66, v64, s[48:49]
    v_cndmask_b32 v69, v65, v67, s[48:49]
    v_cndmask_b32 v65, v67, v65, s[48:49]
    v_add_f32_dpp v64, v68, v64 quad_perm:[2,3,0,1] row_mask:0xf bank_mask:0xf
    s_nop 0
    v_add_f32_dpp v65, v69, v65 quad_perm:[2,3,0,1] row_mask:0xf bank_mask:0xf
    v_add_f32_dpp v64, v64, v64 row_ror:4 row_mask:0xf bank_mask:0xf
    s_nop 0
    v_add_f32_dpp v65, v65, v65 row_ror:4 row_mask:0xf bank_mask:0xf
    v_add_f32_dpp v64, v64, v64 row_ror:8 row_mask:0xf bank_mask:0xf
    s_nop 0
    v_add_f32_dpp v65, v65, v65 row_ror:8 row_mask:0xf bank_mask:0xf
    v_or_b32 v65, 0x80000000, v65
    s_mov_b32 exec_lo, 0x000f000f
    s_mov_b32 exec_hi, 0x000f000f
    global_store_dwordx2 v9, v[64:65], s[32:33] sc1
    s_mov_b64 exec, -1
    global_store_dwordx2 v3, v[40:41], s[32:33] sc1
    v_add_u32 v6, 65536, v3
    global_store_dwordx2 v6, v[42:43], s[32:33] sc1
    v_add_u32 v7, 131072, v3
    global_store_dwordx2 v7, v[44:45], s[32:33] sc1
    s_mov_b32 s57, 0
L_st9:
    global_load_dwordx4 v[56:59], v4, s[32:33] sc1
    global_load_dwordx4 v[60:63], v4, s[32:33] offset:16 sc1
    s_add_u32 s57, s57, 1
    s_waitcnt vmcnt(0)
    v_and_b32 v64, v57, v59
    v_and_b32 v65, v61, v63
    v_and_b32 v64, v64, v65
    v_cmp_le_i32 vcc, 0, v64
    s_cmp_gt_u32 s57, 200000
    s_nop 2
    s_cbranch_scc1 L_end
    s_cbranch_vccnz L_st9
    v_cndmask_b32 v64, v58, v56, s[46:47]
    v_cndmask_b32 v68, v56, v58, s[46:47]
    v_cndmask_b32 v65, v59, v57, s[46:47]
    v_cndmask_b32 v69, v57, v59, s[46:47]
    v_cndmask_b32 v66, v62, v60, s[46:47]
    v_cndmask_b32 v70, v60, v62, s[46:47]
    v_cndmask_b32 v67, v63, v61, s[46:47]
    v_cndmask_b32 v71, v61, v63, s[46:47]
    v_add_f32_dpp v64, v68, v64 quad_perm:[1,0,3,2] row_mask:0xf bank_mask:0xf
    v_add_f32_dpp v65, v69, v65 quad_perm:[1,0,3,2] row_mask:0xf bank_mask:0xf
    v_add_f32_dpp v66, v70, v66 quad_perm:[1,0,3,2] row_mask:0xf bank_mask:0xf
    v_add_f32_dpp v67, v71, v67 quad_perm:[1,0,3,2] row_mask:0xf bank_mask:0xf
    v_cndmask_b32 v68, v64, v66, s[48:49]
    v_cndmask_b32 v64, v66, v64, s[48:49]
    v_cndmask_b32 v69, v65, v67, s[48:49]
    v_cndmask_b32 v65, v67, v65, s[48:49]
    v_add_f32_dpp v64, v68, v64 quad_perm:[2,3,0,1] row_mask:0xf bank_mask:0xf
    s_nop 0
    v_add_f32_dpp v65, v69, v65 quad_perm:[2,3,0,1] row_mask:0xf bank_mask:0xf
    v_add_f32_dpp v64, v64, v64 row_ror:4 row_mask:0xf bank_mask:0xf
    s_nop 0
    v_add_f32_dpp v65, v65, v65 row_ror:4 row_mask:0xf bank_mask:0xf
    v_add_f32_dpp v64, v64, v64 row_ror:8 row_mask:0xf bank_mask:0xf
    s_nop 0
    v_add_f32_dpp v65, v65, v65 row_ror:8 row_mask:0xf bank_mask:0xf
    v_mul_f32 v64, 0x3acccccd, v64
    v_mul_f32 v65, 0xbacccccd, v65
    v_fma_f32 v65, -v64, v64, v65
    v_max_f32 v65, 0, v65
    v_cvt_pk_bf16_f32 v64, v64, v65
    v_and_b32 v65, 0xffff0000, v64
    v_lshlrev_b32 v64, 16, v64
    v_add_f32 v65, 0x3727c5ac, v65
    v_cvt_pk_bf16_f32 v65, v65, v65
    v_lshlrev_b32 v65, 16, v65
    v_sqrt_f32 v65, v65
    s_nop 0
    v_cvt_pk_bf16_f32 v65, v65, v65
    v_lshlrev_b32 v65, 16, v65
    v_rcp_f32 v65, v65
    v_mov_b32_dpp v56, v64 quad_perm:[0,0,0,0] row_mask:0xf bank_mask:0xf
    v_mov_b32_dpp v57, v64 quad_perm:[1,1,1,1] row_mask:0xf bank_mask:0xf
    v_mov_b32_dpp v58, v64 quad_perm:[2,2,2,2] row_mask:0xf bank_mask:0xf
    v_mov_b32_dpp v59, v64 quad_perm:[3,3,3,3] row_mask:0xf bank_mask:0xf
    v_mov_b32_dpp v60, v65 quad_perm:[0,0,0,0] row_mask:0xf bank_mask:0xf
    v_mov_b32_dpp v61, v65 quad_perm:[1,1,1,1] row_mask:0xf bank_mask:0xf
    v_mov_b32_dpp v62, v65 quad_perm:[2,2,2,2] row_mask:0xf bank_mask:0xf
    v_mov_b32_dpp v63, v65 quad_perm:[3,3,3,3] row_mask:0xf bank_mask:0xf
    v_sub_f32 v28, v28, v56
    v_sub_f32 v29, v29, v57
    v_sub_f32 v30, v30, v58
    v_sub_f32 v31, v31, v59
    v_sub_f32 v32, v32, v56
    v_sub_f32 v33, v33, v57
    v_sub_f32 v34, v34, v58
    v_sub_f32 v35, v35, v59
    v_sub_f32 v36, v36, v56
    v_sub_f32 v37, v37, v57
    v_sub_f32 v38, v38, v58
    v_sub_f32 v39, v39, v59
    v_cvt_pk_bf16_f32 v40, v28, v29
    v_cvt_pk_bf16_f32 v41, v30, v31
    v_cvt_pk_bf16_f32 v42, v32, v33
    v_cvt_pk_bf16_f32 v43, v34, v35
    v_cvt_pk_bf16_f32 v44, v36, v37
    v_cvt_pk_bf16_f32 v45, v38, v39
    v_lshlrev_b32 v28, 16, v40
    v_and_b32 v29, 0xffff0000, v40
    v_lshlrev_b32 v30, 16, v41
    v_and_b32 v31, 0xffff0000, v41
    v_lshlrev_b32 v32, 16, v42
    v_and_b32 v33, 0xffff0000, v42
    v_lshlrev_b32 v34, 16, v43
    v_and_b32 v35, 0xffff0000, v43
    v_lshlrev_b32 v36, 16, v44
    v_and_b32 v37, 0xffff0000, v44
    v_lshlrev_b32 v38, 16, v45
    v_and_b32 v39, 0xffff0000, v45
    v_mul_f32 v28, v28, v60
    v_mul_f32 v29, v29, v61
    v_mul_f32 v30, v30, v62
    v_mul_f32 v31, v31, v63
    v_mul_f32 v32, v32, v60
    v_mul_f32 v33, v33, v61
    v_mul_f32 v34, v34, v62
    v_mul_f32 v35, v35, v63
    v_mul_f32 v36, v36, v60
    v_mul_f32 v37, v37, v61
    v_mul_f32 v38, v38, v62
    v_mul_f32 v39, v39, v63
    v_cvt_pk_bf16_f32 v40, v28, v29
    v_cvt_pk_bf16_f32 v41, v30, v31
    v_cvt_pk_bf16_f32 v42, v32, v33
    v_cvt_pk_bf16_f32 v43, v34, v35
    v_cvt_pk_bf16_f32 v44, v36, v37
    v_cvt_pk_bf16_f32 v45, v38, v39
    v_lshlrev_b32 v28, 16, v40
    v_and_b32 v29, 0xffff0000, v40
    v_lshlrev_b32 v30, 16, v41
    v_and_b32 v31, 0xffff0000, v41
    v_lshlrev_b32 v32, 16, v42
    v_and_b32 v33, 0xffff0000, v42
    v_lshlrev_b32 v34, 16, v43
    v_and_b32 v35, 0xffff0000, v43
    v_lshlrev_b32 v36, 16, v44
    v_and_b32 v37, 0xffff0000, v44
    v_lshlrev_b32 v38, 16, v45
    v_and_b32 v39, 0xffff0000, v45
    s_add_u32 s50, s32, 5242880
    s_addc_u32 s51, s33, 0
    v_cvt_pk_f16_f32 v40, v28, v29
    v_cvt_pk_f16_f32 v41, v30, v31
    global_store_dwordx2 v3, v[40:41], s[50:51] sc1
    v_cvt_pk_f16_f32 v42, v32, v33
    v_cvt_pk_f16_f32 v43, v34, v35
    global_store_dwordx2 v6, v[42:43], s[50:51] sc1
    v_cvt_pk_f16_f32 v44, v36, v37
    v_cvt_pk_f16_f32 v45, v38, v39
    global_store_dwordx2 v7, v[44:45], s[50:51] sc1
    s_branch L_a2_done
L_a2_k1:
    ds_write_b128 v2, v[56:59] offset:0
    ds_write_b128 v2, v[60:63] offset:1024
    ds_write_b128 v2, v[64:67] offset:2048
    s_waitcnt lgkmcnt(0)
    s_barrier
    ds_read_b128 v[16:19], v2 offset:3072
    ds_read_b128 v[20:23], v2 offset:4096
    v_lshlrev_b32 v28, 16, v10
    v_and_b32 v29, 0xffff0000, v10
    v_lshlrev_b32 v30, 16, v11
    v_and_b32 v31, 0xffff0000, v11
    v_lshlrev_b32 v32, 16, v12
    v_and_b32 v33, 0xffff0000, v12
    v_lshlrev_b32 v34, 16, v13
    v_and_b32 v35, 0xffff0000, v13
    s_waitcnt lgkmcnt(0)
    v_add_f32 v16, v16, v68
    v_add_f32 v17, v17, v69
    v_add_f32 v18, v18, v70
    v_add_f32 v19, v19, v71
    v_add_f32 v20, v20, v72
    v_add_f32 v21, v21, v73
    v_add_f32 v22, v22, v74
    v_add_f32 v23, v23, v75
    v_cvt_pk_bf16_f32 v40, v16, v17
    v_cvt_pk_bf16_f32 v41, v18, v19
    v_cvt_pk_bf16_f32 v42, v20, v21
    v_cvt_pk_bf16_f32 v43, v22, v23
    v_lshlrev_b32 v16, 16, v40
    v_and_b32 v17, 0xffff0000, v40
    v_lshlrev_b32 v18, 16, v41
    v_and_b32 v19, 0xffff0000, v41
    v_lshlrev_b32 v20, 16, v42
    v_and_b32 v21, 0xffff0000, v42
    v_lshlrev_b32 v22, 16, v43
    v_and_b32 v23, 0xffff0000, v43
    v_add_f32 v28, v28, v16
    v_add_f32 v29, v29, v17
    v_add_f32 v30, v30, v18
    v_add_f32 v31, v31, v19
    v_add_f32 v32, v32, v20
    v_add_f32 v33, v33, v21
    v_add_f32 v34, v34, v22
    v_add_f32 v35, v35, v23
    v_cvt_pk_bf16_f32 v40, v28, v29
    v_cvt_pk_bf16_f32 v41, v30, v31
    v_cvt_pk_bf16_f32 v42, v32, v33
    v_cvt_pk_bf16_f32 v43, v34, v35
    v_lshlrev_b32 v28, 16, v40
    v_and_b32 v29, 0xffff0000, v40
    v_lshlrev_b32 v30, 16, v41
    v_and_b32 v31, 0xffff0000, v41
    v_lshlrev_b32 v32, 16, v42
    v_and_b32 v33, 0xffff0000, v42
    v_lshlrev_b32 v34, 16, v43
    v_and_b32 v35, 0xffff0000, v43
    v_add_f32 v56, v28, v32
    v_mul_f32 v60, v28, v28
    v_add_f32 v57, v29, v33
    v_mul_f32 v61, v29, v29
    v_add_f32 v58, v30, v34
    v_mul_f32 v62, v30, v30
    v_add_f32 v59, v31, v35
    v_mul_f32 v63, v31, v31
    v_fmac_f32 v60, v32, v32
    v_fmac_f32 v61, v33, v33
    v_fmac_f32 v62, v34, v34
    v_fmac_f32 v63, v35, v35
    v_cndmask_b32 v64, v57, v56, s[46:47]
    v_cndmask_b32 v68, v56, v57, s[46:47]
    v_cndmask_b32 v65, v61, v60, s[46:47]
    v_cndmask_b32 v69, v60, v61, s[46:47]
    v_cndmask_b32 v66, v59, v58, s[46:47]
    v_cndmask_b32 v70, v58, v59, s[46:47]
    v_cndmask_b32 v67, v63, v62, s[46:47]
    v_cndmask_b32 v71, v62, v63, s[46:47]
    v_add_f32_dpp v64, v68, v64 quad_perm:[1,0,3,2] row_mask:0xf bank_mask:0xf
    v_add_f32_dpp v65, v69, v65 quad_perm:[1,0,3,2] row_mask:0xf bank_mask:0xf
    v_add_f32_dpp v66, v70, v66 quad_perm:[1,0,3,2] row_mask:0xf bank_mask:0xf
    v_add_f32_dpp v67, v71, v67 quad_perm:[1,0,3,2] row_mask:0xf bank_mask:0xf
    v_cndmask_b32 v68, v64, v66, s[48:49]
    v_cndmask_b32 v64, v66, v64, s[48:49]
    v_cndmask_b32 v69, v65, v67, s[48:49]
    v_cndmask_b32 v65, v67, v65, s[48:49]
    v_add_f32_dpp v64, v68, v64 quad_perm:[2,3,0,1] row_mask:0xf bank_mask:0xf
    s_nop 0
    v_add_f32_dpp v65, v69, v65 quad_perm:[2,3,0,1] row_mask:0xf bank_mask:0xf
    v_add_f32_dpp v64, v64, v64 row_ror:4 row_mask:0xf bank_mask:0xf
    s_nop 0
    v_add_f32_dpp v65, v65, v65 row_ror:4 row_mask:0xf bank_mask:0xf
    v_add_f32_dpp v64, v64, v64 row_ror:8 row_mask:0xf bank_mask:0xf
    s_nop 0
    v_add_f32_dpp v65, v65, v65 row_ror:8 row_mask:0xf bank_mask:0xf
    v_or_b32 v65, 0x80000000, v65
    s_mov_b32 exec_lo, 0x000f000f
    s_mov_b32 exec_hi, 0x000f000f
    global_store_dwordx2 v9, v[64:65], s[32:33] sc1
    s_mov_b64 exec, -1
    global_store_dwordx2 v3, v[40:41], s[32:33] sc1
    v_add_u32 v6, 65536, v3
    global_store_dwordx2 v6, v[42:43], s[32:33] sc1
    s_mov_b32 s57, 0
L_st10:
    global_load_dwordx4 v[56:59], v4, s[32:33] sc1
    global_load_dwordx4 v[60:63], v4, s[32:33] offset:16 sc1
    s_add_u32 s57, s57, 1
    s_waitcnt vmcnt(0)
    v_and_b32 v64, v57, v59
    v_and_b32 v65, v61, v63
    v_and_b32 v64, v64, v65
    v_cmp_le_i32 vcc, 0, v64
    s_cmp_gt_u32 s57, 200000
    s_nop 2
    s_cbranch_scc1 L_end
    s_cbranch_vccnz L_st10
    v_cndmask_b32 v64, v58, v56, s[46:47]
    v_cndmask_b32 v68, v56, v58, s[46:47]
    v_cndmask_b32 v65, v59, v57, s[46:47]
    v_cndmask_b32 v69, v57, v59, s[46:47]
    v_cndmask_b32 v66, v62, v60, s[46:47]
    v_cndmask_b32 v70, v60, v62, s[46:47]
    v_cndmask_b32 v67, v63, v61, s[46:47]
    v_cndmask_b32 v71, v61, v63, s[46:47]
    v_add_f32_dpp v64, v68, v64 quad_perm:[1,0,3,2] row_mask:0xf bank_mask:0xf
    v_add_f32_dpp v65, v69, v65 quad_perm:[1,0,3,2] row_mask:0xf bank_mask:0xf
    v_add_f32_dpp v66, v70, v66 quad_perm:[1,0,3,2] row_mask:0xf bank_mask:0xf
    v_add_f32_dpp v67, v71, v67 quad_perm:[1,0,3,2] row_mask:0xf bank_mask:0xf
    v_cndmask_b32 v68, v64, v66, s[48:49]
    v_cndmask_b32 v64, v66, v64, s[48:49]
    v_cndmask_b32 v69, v65, v67, s[48:49]
    v_cndmask_b32 v65, v67, v65, s[48:49]
    v_add_f32_dpp v64, v68, v64 quad_perm:[2,3,0,1] row_mask:0xf bank_mask:0xf
    s_nop 0
    v_add_f32_dpp v65, v69, v65 quad_perm:[2,3,0,1] row_mask:0xf bank_mask:0xf
    v_add_f32_dpp v64, v64, v64 row_ror:4 row_mask:0xf bank_mask:0xf
    s_nop 0
    v_add_f32_dpp v65, v65, v65 row_ror:4 row_mask:0xf bank_mask:0xf
    v_add_f32_dpp v64, v64, v64 row_ror:8 row_mask:0xf bank_mask:0xf
    s_nop 0
    v_add_f32_dpp v65, v65, v65 row_ror:8 row_mask:0xf bank_mask:0xf
    v_mul_f32 v64, 0x3acccccd, v64
    v_mul_f32 v65, 0xbacccccd, v65
    v_fma_f32 v65, -v64, v64, v65
    v_max_f32 v65, 0, v65
    v_cvt_pk_bf16_f32 v64, v64, v65
    v_and_b32 v65, 0xffff0000, v64
    v_lshlrev_b32 v64, 16, v64
    v_add_f32 v65, 0x3727c5ac, v65
    v_cvt_pk_bf16_f32 v65, v65, v65
    v_lshlrev_b32 v65, 16, v65
    v_sqrt_f32 v65, v65
    s_nop 0
    v_cvt_pk_bf16_f32 v65, v65, v65
    v_lshlrev_b32 v65, 16, v65
    v_rcp_f32 v65, v65
    v_mov_b32_dpp v56, v64 quad_perm:[0,0,0,0] row_mask:0xf bank_mask:0xf
    v_mov_b32_dpp v57, v64 quad_perm:[1,1,1,1] row_mask:0xf bank_mask:0xf
    v_mov_b32_dpp v58, v64 quad_perm:[2,2,2,2] row_mask:0xf bank_mask:0xf
    v_mov_b32_dpp v59, v64 quad_perm:[3,3,3,3] row_mask:0xf bank_mask:0xf
    v_mov_b32_dpp v60, v65 quad_perm:[0,0,0,0] row_mask:0xf bank_mask:0xf
    v_mov_b32_dpp v61, v65 quad_perm:[1,1,1,1] row_mask:0xf bank_mask:0xf
    v_mov_b32_dpp v62, v65 quad_perm:[2,2,2,2] row_mask:0xf bank_mask:0xf
    v_mov_b32_dpp v63, v65 quad_perm:[3,3,3,3] row_mask:0xf bank_mask:0xf
    v_sub_f32 v28, v28, v56
    v_sub_f32 v29, v29, v57
    v_sub_f32 v30, v30, v58
    v_sub_f32 v31, v31, v59
    v_sub_f32 v32, v32, v56
    v_sub_f32 v33, v33, v57
    v_sub_f32 v34, v34, v58
    v_sub_f32 v35, v35, v59
    v_cvt_pk_bf16_f32 v40, v28, v29
    v_cvt_pk_bf16_f32 v41, v30, v31
    v_cvt_pk_bf16_f32 v42, v32, v33
    v_cvt_pk_bf16_f32 v43, v34, v35
    v_lshlrev_b32 v28, 16, v40
    v_and_b32 v29, 0xffff0000, v40
    v_lshlrev_b32 v30, 16, v41
    v_and_b32 v31, 0xffff0000, v41
    v_lshlrev_b32 v32, 16, v42
    v_and_b32 v33, 0xffff0000, v42
    v_lshlrev_b32 v34, 16, v43
    v_and_b32 v35, 0xffff0000, v43
    v_mul_f32 v28, v28, v60
    v_mul_f32 v29, v29, v61
    v_mul_f32 v30, v30, v62
    v_mul_f32 v31, v31, v63
    v_mul_f32 v32, v32, v60
    v_mul_f32 v33, v33, v61
    v_mul_f32 v34, v34, v62
    v_mul_f32 v35, v35, v63
    v_cvt_pk_bf16_f32 v40, v28, v29
    v_cvt_pk_bf16_f32 v41, v30, v31
    v_cvt_pk_bf16_f32 v42, v32, v33
    v_cvt_pk_bf16_f32 v43, v34, v35
    v_lshlrev_b32 v28, 16, v40
    v_and_b32 v29, 0xffff0000, v40
    v_lshlrev_b32 v30, 16, v41
    v_and_b32 v31, 0xffff0000, v41
    v_lshlrev_b32 v32, 16, v42
    v_and_b32 v33, 0xffff0000, v42
    v_lshlrev_b32 v34, 16, v43
    v_and_b32 v35, 0xffff0000, v43
    s_add_u32 s50, s32, 5242880
    s_addc_u32 s51, s33, 0
    v_cvt_pk_f16_f32 v40, v28, v29
    v_cvt_pk_f16_f32 v41, v30, v31
    global_store_dwordx2 v3, v[40:41], s[50:51] sc1
    v_cvt_pk_f16_f32 v42, v32, v33
    v_cvt_pk_f16_f32 v43, v34, v35
    global_store_dwordx2 v6, v[42:43], s[50:51] sc1
L_a2_done:
    s_cmp_eq_u32 s7, 0
    s_cbranch_scc0 L_u_nt
    s_getpc_b64 s[50:51]
L_tbref:
    s_add_u32 s50, s50, L_tab1-L_tbref
    s_addc_u32 s51, s51, 0
    v_lshlrev_b32 v70, 1, v0
    v_lshlrev_b32 v71, 2, v0
    v_and_b32 v72, 0x7e, v70
    global_load_ushort v80, v70, s[50:51]
    global_load_ushort v81, v70, s[50:51] offset:1024
    global_load_ushort v82, v72, s[50:51] offset:2048
    global_load_dword v83, v71, s[50:51] offset:2176
    v_add_u32 v71, 2048, v71
    global_load_dword v84, v71, s[50:51] offset:2176
L_u_nt:
    s_waitcnt vmcnt(0)
    s_barrier
    s_cmp_eq_u32 s3, 0
    s_cbranch_scc0 L_u_np
    s_lshl_b32 s42, s4, 5
    s_add_u32 s42, s42, s5
    s_lshl_b32 s42, s42, 7
    s_add_u32 s42, s42, s40
    s_add_u32 s42, s42, 69632
    v_mov_b32 v2, s42
    v_mov_b32 v4, s34
    v_mov_b32 v5, s35
    s_mov_b64 exec, 1
    global_store_dwordx2 v2, v[4:5], s[32:33] sc1
    s_mov_b64 exec, -1
L_u_np:
    s_cmp_eq_u32 s7, 0
    s_cbranch_scc0 L_u_nb
    ds_read_b32 v16, v80 offset:0
    ds_read_b32 v17, v80 offset:4608
    ds_read_b32 v18, v80 offset:9216
    ds_read_b32 v19, v80 offset:13824
    ds_read_b32 v20, v80 offset:18432
    ds_read_b32 v21, v80 offset:23040
    ds_read_b32 v22, v80 offset:27648
    ds_read_b32 v23, v80 offset:32256
    ds_read_b32 v24, v80 offset:36864
    s_waitcnt lgkmcnt(6)
    ds_read_b32 v25, v81 offset:0
    ds_read_b32 v26, v81 offset:4608
    ds_read_b32 v27, v81 offset:9216
    ds_read_b32 v28, v81 offset:13824
    ds_read_b32 v29, v81 offset:18432
    ds_read_b32 v30, v81 offset:23040
    ds_read_b32 v31, v81 offset:27648
    ds_read_b32 v32, v81 offset:32256
    ds_read_b32 v33, v81 offset:36864
    s_waitcnt lgkmcnt(6)
    ds_read_b32 v34, v82 offset:0
    ds_read_b32 v35, v82 offset:4608
    ds_read_b32 v36, v82 offset:9216
    ds_read_b32 v37, v82 offset:13824
    ds_read_b32 v38, v82 offset:18432
    ds_read_b32 v39, v82 offset:23040
    ds_read_b32 v40, v82 offset:27648
    ds_read_b32 v41, v82 offset:32256
    ds_read_b32 v42, v82 offset:36864
    v_lshlrev_b32 v70, 1, v0
    v_and_b32 v72, 0x7e, v70
    v_add_u32 v70, 61440, v70
    v_add_u32 v72, 63488, v72
    v_mov_b32 v73, 46976
    s_waitcnt lgkmcnt(0)
    v_add_f32 v16, v16, v17
    v_add_f32 v19, v19, v20
    v_add_f32 v22, v22, v23
    v_add_f32 v25, v25, v26
    v_add_f32 v28, v28, v29
    v_add_f32 v31, v31, v32
    v_add_f32 v34, v34, v35
    v_add_f32 v37, v37, v38
    v_add_f32 v40, v40, v41
    v_add_f32 v16, v16, v18
    v_add_f32 v19, v19, v21
    v_add_f32 v22, v22, v24
    v_add_f32 v25, v25, v27
    v_add_f32 v28, v28, v30
    v_add_f32 v31, v31, v33
    v_add_f32 v34, v34, v36
    v_add_f32 v37, v37, v39
    v_add_f32 v40, v40, v42
    v_max3_f32 v48, abs(v16), abs(v25), abs(v34)
    v_max3_f32 v49, abs(v19), abs(v28), abs(v37)
    v_max3_f32 v50, abs(v22), abs(v31), abs(v40)
    v_max_f32_dpp v48, v48, v48 row_ror:1 row_mask:0xf bank_mask:0xf
    v_max_f32_dpp v49, v49, v49 row_ror:1 row_mask:0xf bank_mask:0xf
    v_max_f32_dpp v50, v50, v50 row_ror:1 row_mask:0xf bank_mask:0xf
    v_max_f32_dpp v48, v48, v48 row_ror:2 row_mask:0xf bank_mask:0xf
    v_max_f32_dpp v49, v49, v49 row_ror:2 row_mask:0xf bank_mask:0xf
    v_max_f32_dpp v50, v50, v50 row_ror:2 row_mask:0xf bank_mask:0xf
    v_max_f32_dpp v48, v48, v48 row_ror:4 row_mask:0xf bank_mask:0xf
    v_max_f32_dpp v49, v49, v49 row_ror:4 row_mask:0xf bank_mask:0xf
    v_max_f32_dpp v50, v50, v50 row_ror:4 row_mask:0xf bank_mask:0xf
    v_max_f32_dpp v48, v48, v48 row_ror:8 row_mask:0xf bank_mask:0xf
    v_max_f32_dpp v49, v49, v49 row_ror:8 row_mask:0xf bank_mask:0xf
    v_max_f32_dpp v50, v50, v50 row_ror:8 row_mask:0xf bank_mask:0xf
    s_mov_b32 exec_lo, 0x00010001
    s_mov_b32 exec_hi, 0x00010001
    ds_max_f32 v73, v48 offset:0
    ds_max_f32 v73, v49 offset:4
    ds_max_f32 v73, v50 offset:8
    s_mov_b64 exec, -1
    s_waitcnt lgkmcnt(0)
    s_barrier
    ds_read_b128 v[52:55], v73
    v_and_b32 v74, 0xffff, v83
    v_lshrrev_b32 v75, 16, v83
    v_and_b32 v76, 0xffff, v84
    v_lshrrev_b32 v77, 16, v84
    v_add_u32 v74, 61440, v74
    v_add_u32 v76, 61440, v76
    s_waitcnt lgkmcnt(0)
    v_frexp_exp_i32_f32 v52, v52
    v_frexp_exp_i32_f32 v53, v53
    v_frexp_exp_i32_f32 v54, v54
    v_sub_u32 v48, 14, v52
    v_subrev_u32 v52, 22, v52
    v_sub_u32 v49, 14, v53
    v_subrev_u32 v53, 22, v53
    v_sub_u32 v50, 14, v54
    v_subrev_u32 v54, 22, v54
    v_ldexp_f32 v52, 1.0, v52
    v_ldexp_f32 v53, 1.0, v53
    v_ldexp_f32 v54, 1.0, v54
    v_ldexp_f32 v16, v16, v48
    v_ldexp_f32 v19, v19, v49
    v_ldexp_f32 v22, v22, v50
    v_ldexp_f32 v25, v25, v48
    v_ldexp_f32 v28, v28, v49
    v_ldexp_f32 v31, v31, v50
    v_ldexp_f32 v34, v34, v48
    v_ldexp_f32 v37, v37, v49
    v_ldexp_f32 v40, v40, v50
    v_cvt_f16_f32 v16, v16
    v_cvt_f16_f32 v19, v19
    v_cvt_f16_f32 v22, v22
    v_cvt_f16_f32 v25, v25
    v_cvt_f16_f32 v28, v28
    v_cvt_f16_f32 v31, v31
    v_cvt_f16_f32 v34, v34
    v_cvt_f16_f32 v37, v37
    v_cvt_f16_f32 v40, v40
    ds_write_b128 v73, v[52:55] offset:16
    ds_write_b16 v70, v16 offset:0
    ds_write_b16 v70, v16 offset:2306
    ds_write_b16 v70, v19 offset:4608
    ds_write_b16 v70, v19 offset:6914
    ds_write_b16 v70, v22 offset:9216
    ds_write_b16 v70, v22 offset:11522
    ds_write_b16 v70, v25 offset:1024
    ds_write_b16 v70, v25 offset:3330
    ds_write_b16 v70, v28 offset:5632
    ds_write_b16 v70, v28 offset:7938
    ds_write_b16 v70, v31 offset:10240
    ds_write_b16 v70, v31 offset:12546
    ds_write_b16 v72, v34 offset:0
    ds_write_b16 v72, v34 offset:2306
    ds_write_b16 v72, v37 offset:4608
    ds_write_b16 v72, v37 offset:6914
    ds_write_b16 v72, v40 offset:9216
    ds_write_b16 v72, v40 offset:11522
    v_add_u32 v58, 4608, v74
    v_add_u32 v59, 4608, v76
    v_add_u32 v60, 9216, v74
    v_add_u32 v61, 9216, v76
    s_waitcnt lgkmcnt(0)
    s_barrier
    ds_read2_b32 v[16:17], v74 offset0:0 offset1:1
    ds_read2_b32 v[18:19], v74 offset0:2 offset1:3
    ds_read2_b32 v[20:21], v76 offset0:0 offset1:1
    ds_read2_b32 v[22:23], v76 offset0:2 offset1:3
    ds_read2_b32 v[24:25], v58 offset0:0 offset1:1
    ds_read2_b32 v[26:27], v58 offset0:2 offset1:3
    ds_read2_b32 v[28:29], v59 offset0:0 offset1:1
    ds_read2_b32 v[30:31], v59 offset0:2 offset1:3
    ds_read2_b32 v[32:33], v60 offset0:0 offset1:1
    ds_read2_b32 v[34:35], v60 offset0:2 offset1:3
    ds_read2_b32 v[36:37], v61 offset0:0 offset1:1
    ds_read2_b32 v[38:39], v61 offset0:2 offset1:3
    s_waitcnt lgkmcnt(8)
    ds_write_b128 v75, v[16:19] offset:0
    ds_write_b128 v77, v[20:23] offset:0
    s_waitcnt lgkmcnt(4)
    ds_write_b128 v75, v[24:27] offset:15104
    ds_write_b128 v77, v[28:31] offset:15104
    s_waitcnt lgkmcnt(0)
    ds_write_b128 v75, v[32:35] offset:30208
    ds_write_b128 v77, v[36:39] offset:30208
    s_waitcnt lgkmcnt(0)
    s_barrier
L_u_nb:
    s_and_b32 s44, s3, 3
    s_lshr_b32 s45, s3, 2
    s_cmp_eq_u32 s44, 3
    s_cselect_b32 s42, s45, s44
    s_add_u32 s43, s45, 1
    s_cmp_eq_u32 s44, 3
    s_cselect_b32 s43, 3, s43
    s_cmp_eq_u32 s44, 2
    s_cbranch_scc0 L_b_role
    s_add_u32 s43, s43, s36
    s_cmp_eq_u32 s43, 2
    s_cselect_b32 s46, 1, 0
    s_andn2_b32 s46, s46, s36
    s_cmp_eq_u32 s46, 1
    s_cselect_b32 s43, 0, s43
L_b_role:
    s_cmp_eq_u32 s42, 1
    s_cselect_b32 s44, s38, s37
    s_cmp_eq_u32 s42, 2
    s_cselect_b32 s44, s39, s44
    s_mul_i32 s45, s42, 15104
    s_mul_i32 s46, s42, 14976
    s_add_u32 s46, s46, 61440
    v_and_b32 v14, 15, v1
    v_lshrrev_b32 v15, 4, v1
    v_and_b32 v16, 7, v1
    v_mul_u32_u24 v16, 100, v16
    v_bfe_u32 v17, v1, 3, 1
    v_sub_u32 v16, v16, v17
    v_add3_u32 v3, v16, v15, 1
    v_lshl_add_u32 v3, v3, 4, s45
    v_and_b32 v17, 1, v15
    v_add3_u32 v16, v16, v17, 3
    v_and_b32 v18, 2, v15
    v_sub_u32 v16, v16, v18
    v_lshl_add_u32 v2, v16, 4, s45
    v_and_b32 v16, 3, v1
    v_mul_u32_u24 v16, 36, v16
    v_lshrrev_b32 v19, 2, v14
    v_sub_u32 v16, v16, v19
    v_add3_u32 v16, v16, v15, 3
    s_add_u32 s47, s45, 12800
    v_lshl_add_u32 v4, v16, 4, s47
    v_lshlrev_b32 v16, 5, v14
    v_lshl_add_u32 v5, v17, 4, v16
    v_lshlrev_b32 v18, 4, v18
    v_sub_u32 v5, v5, v18
    s_add_u32 s47, s46, 64
    v_add_u32 v5, s47, v5
    v_and_b32 v17, 3, v1
    v_lshl_add_u32 v17, v17, 3, s46
    v_lshl_add_u32 v6, v15, 7, v17
    v_lshl_add_u32 v6, v19, 4, v6
    v_lshl_add_u32 v7, v15, 8, v17
    v_lshl_add_u32 v7, v19, 5, v7
    v_lshl_add_u32 v16, v15, 3, v16
    s_add_u32 s47, s46, 512
    v_add_u32 v8, s47, v16
    s_lshl_b32 s47, s44, 12
    s_add_u32 s47, s47, s41
    s_add_u32 s47, s47, 9437184
    v_add_u32 v9, s47, v16
    v_lshlrev_b32 v13, 2, v14
    v_add_u32 v13, v13, v15
    v_mul_u32_u24 v13, 5120, v13
    s_lshl_b32 s47, s44, 1
    v_add_u32 v13, s47, v13
    v_mov_b32 v12, s47
    global_load_ushort v11, v12, s[26:27]
    s_lshl_b32 s47, s42, 2
    s_add_u32 s47, s47, 46992
    v_mov_b32 v12, s47
    ds_read_b32 v10, v12
    v_and_b32 v16, 255, v0
    v_lshlrev_b32 v17, 4, v16
    v_max_u32 v18, 1, v16
    v_lshlrev_b32 v18, 4, v18
    v_subrev_u32 v18, 16, v18
    s_cmp_ge_u32 s3, 4
    s_cselect_b32 s47, s38, s37
    s_cselect_b32 s48, 14976, 0
    s_add_u32 s48, s48, 61440
    s_lshl_b32 s47, s47, 12
    s_add_u32 s49, s41, 14680064
    s_add_u32 s47, s47, s49
    v_add_u32 v20, s47, v17
    v_add_u32 v21, s47, v18
    s_lshl_b32 s47, s39, 12
    s_add_u32 s47, s47, s49
    v_add_u32 v22, s47, v17
    v_add_u32 v23, s47, v18
    v_add_u32 v24, s48, v17
    v_add_u32 v25, 91392, v17
    v_cmp_eq_u32 s[52:53], 0, v16
    s_cmp_ge_u32 s3, 3
    s_nop 2
    s_cbranch_scc1 L_b_nz
    v_mov_b32 v28, 0
    v_mov_b32 v29, 0
    v_mov_b32 v30, 0
    v_mov_b32 v31, 0
    s_mul_i32 s47, s3, 14976
    s_add_u32 s47, s47, 61440
    v_and_b32 v16, 31, v1
    v_lshl_add_u32 v16, v16, 4, s47
    ds_write_b128 v16, v[28:31] offset:0
    v_bfe_u32 v16, v1, 1, 2
    v_mul_u32_u24 v17, 3104, v16
    v_cmp_eq_u32 vcc, 3, v16
    v_subrev_u32 v18, 1024, v17
    s_nop 0
    v_cndmask_b32 v17, v17, v18, vcc
    v_and_b32 v16, 1, v1
    v_lshl_add_u32 v17, v16, 4, v17
    v_add_u32 v17, s47, v17
    ds_write_b128 v17, v[28:31] offset:4608
L_b_nz:
    s_cmp_eq_u32 s3, 0
    s_cbranch_scc0 L_b_np
    s_and_b32 s47, s2, 7
    s_lshl_b32 s47, s47, 12
    s_add_u32 s47, s47, s40
    s_add_u32 s47, s47, 69632
    v_and_b32 v16, 31, v1
    v_lshl_add_u32 v16, v16, 7, s47
    s_mov_b32 s57, 0
L_poll11:
    global_load_dwordx2 v[18:19], v16, s[32:33] sc1
    s_add_u32 s57, s57, 1
    s_waitcnt vmcnt(0)
    v_cmp_ne_u64 vcc, s[34:35], v[18:19]
    s_cmp_gt_u32 s57, 200000
    s_nop 2
    s_cbranch_scc1 L_end
    s_cbranch_vccnz L_poll11
L_b_np:
    s_waitcnt vmcnt(0) lgkmcnt(0)
    v_lshlrev_b32 v11, 16, v11
    s_barrier
    global_load_dwordx4 v[76:79], v21, s[32:33] sc1
    global_load_dwordx4 v[80:83], v20, s[32:33] sc1
    s_cmp_ge_u32 s3, 4
    s_cbranch_scc1 L_b_l1
    global_load_dwordx4 v[84:87], v23, s[32:33] sc1
    global_load_dwordx4 v[88:91], v22, s[32:33] sc1
L_b_l1:
    s_max_u32 s47, s43, 1
    s_lshl_b32 s47, s47, 10
    s_cmp_gt_u32 s47, 1024
    s_cselect_b32 s47, s47, 0
    v_add_u32 v12, s47, v9
    global_load_dwordx2 v[32:33], v12, s[32:33] sc1
    global_load_dwordx2 v[34:35], v12, s[32:33] offset:512 sc1
    s_cbranch_scc1 L_b_l2
    global_load_dwordx2 v[36:37], v12, s[32:33] offset:1024 sc1
    global_load_dwordx2 v[38:39], v12, s[32:33] offset:1536 sc1
L_b_l2:
    s_waitcnt vmcnt(0)
    v_cndmask_b32 v76, v76, 0, s[52:53]
    v_cndmask_b32 v77, v77, 0, s[52:53]
    v_cndmask_b32 v78, v78, 0, s[52:53]
    v_cndmask_b32 v79, v79, 0, s[52:53]
    ds_write_b128 v24, v[80:83] offset:512
    s_and_b32 s50, s3, 3
    s_cmp_eq_u32 s50, 3
    s_cbranch_scc1 L_bx12
    v_alignbyte_b32 v48, v77, v76, 2
    v_alignbyte_b32 v49, v78, v77, 2
    v_alignbyte_b32 v50, v79, v78, 2
    v_alignbyte_b32 v51, v80, v79, 2
    v_alignbyte_b32 v52, v81, v80, 2
    v_alignbyte_b32 v53, v82, v81, 2
    v_alignbyte_b32 v54, v83, v82, 2
    v_pk_add_f16 v72, v49, v50
    v_pk_add_f16 v60, v77, v79
    v_pk_add_f16 v73, v50, v51
    v_pk_add_f16 v61, v78, v80
    v_pk_add_f16 v74, v51, v52
    v_pk_add_f16 v62, v79, v81
    v_pk_add_f16 v75, v52, v53
    v_pk_add_f16 v63, v80, v82
    v_pk_add_f16 v56, v78, v72
    v_pk_add_f16 v57, v79, v73
    v_pk_add_f16 v58, v80, v74
    v_pk_add_f16 v59, v81, v75
    v_pk_add_f16 v60, v60, v56
    v_pk_add_f16 v61, v61, v57
    v_pk_add_f16 v62, v62, v58
    v_pk_add_f16 v63, v63, v59
    ds_write_b128 v24, v[56:59] offset:7744
    ds_write_b128 v24, v[60:63] offset:4640
    s_cmp_ge_u32 s50, 2
    s_cbranch_scc1 L_bx12
    v_pk_add_f16 v64, v48, v51
    v_pk_add_f16 v68, v76, v80
    v_pk_add_f16 v65, v49, v52
    v_pk_add_f16 v69, v77, v81
    v_pk_add_f16 v66, v50, v53
    v_pk_add_f16 v70, v78, v82
    v_pk_add_f16 v67, v51, v54
    v_pk_add_f16 v71, v79, v83
    v_pk_add_f16 v64, v64, v60
    v_pk_add_f16 v65, v65, v61
    v_pk_add_f16 v66, v66, v62
    v_pk_add_f16 v67, v67, v63
    v_pk_add_f16 v68, v68, v64
    v_pk_add_f16 v69, v69, v65
    v_pk_add_f16 v70, v70, v66
    v_pk_add_f16 v71, v71, v67
    ds_write_b128 v24, v[64:67] offset:12928
    ds_write_b128 v24, v[68:71] offset:10848
L_bx12:
    s_cmp_ge_u32 s3, 4
    s_cbranch_scc1 L_b_go
    v_cndmask_b32 v84, v84, 0, s[52:53]
    v_cndmask_b32 v85, v85, 0, s[52:53]
    v_cndmask_b32 v86, v86, 0, s[52:53]
    v_cndmask_b32 v87, v87, 0, s[52:53]
    ds_write_b128 v25, v[88:91] offset:512
    s_and_b32 s50, s3, 3
    s_cmp_eq_u32 s50, 3
    s_cbranch_scc1 L_bx13
    v_alignbyte_b32 v48, v85, v84, 2
    v_alignbyte_b32 v49, v86, v85, 2
    v_alignbyte_b32 v50, v87, v86, 2
    v_alignbyte_b32 v51, v88, v87, 2
    v_alignbyte_b32 v52, v89, v88, 2
    v_alignbyte_b32 v53, v90, v89, 2
    v_alignbyte_b32 v54, v91, v90, 2
    v_pk_add_f16 v72, v49, v50
    v_pk_add_f16 v60, v85, v87
    v_pk_add_f16 v73, v50, v51
    v_pk_add_f16 v61, v86, v88
    v_pk_add_f16 v74, v51, v52
    v_pk_add_f16 v62, v87, v89
    v_pk_add_f16 v75, v52, v53
    v_pk_add_f16 v63, v88, v90
    v_pk_add_f16 v56, v86, v72
    v_pk_add_f16 v57, v87, v73
    v_pk_add_f16 v58, v88, v74
    v_pk_add_f16 v59, v89, v75
    v_pk_add_f16 v60, v60, v56
    v_pk_add_f16 v61, v61, v57
    v_pk_add_f16 v62, v62, v58
    v_pk_add_f16 v63, v63, v59
    ds_write_b128 v25, v[56:59] offset:7744
    ds_write_b128 v25, v[60:63] offset:4640
    s_cmp_ge_u32 s50, 2
    s_cbranch_scc1 L_bx13
    v_pk_add_f16 v64, v48, v51
    v_pk_add_f16 v68, v84, v88
    v_pk_add_f16 v65, v49, v52
    v_pk_add_f16 v69, v85, v89
    v_pk_add_f16 v66, v50, v53
    v_pk_add_f16 v70, v86, v90
    v_pk_add_f16 v67, v51, v54
    v_pk_add_f16 v71, v87, v91
    v_pk_add_f16 v64, v64, v60
    v_pk_add_f16 v65, v65, v61
    v_pk_add_f16 v66, v66, v62
    v_pk_add_f16 v67, v67, v63
    v_pk_add_f16 v68, v68, v64
    v_pk_add_f16 v69, v69, v65
    v_pk_add_f16 v70, v70, v66
    v_pk_add_f16 v71, v71, v67
    ds_write_b128 v25, v[64:67] offset:12928
    ds_write_b128 v25, v[68:71] offset:10848
L_bx13:
L_b_go:
    s_waitcnt lgkmcnt(0)
    s_barrier
    s_cmp_eq_u32 s43, 0
    s_cbranch_scc1 L_b_done
    s_cmp_eq_u32 s43, 2
    s_cbranch_scc1 L_b_p2
    s_cmp_eq_u32 s43, 3
    s_cbranch_scc1 L_b_p3
    ds_read_b128 v[40:43], v2 offset:1088
    ds_read_b128 v[44:47], v5 offset:448
    ds_read_b128 v[48:51], v5 offset:960
    ds_read_b128 v[52:55], v5 offset:1472
    ds_read_b128 v[56:59], v5 offset:1984
    ds_read_b128 v[60:63], v2 offset:1024
    ds_read_b128 v[64:67], v5 offset:384
    ds_read_b128 v[68:71], v5 offset:896
    ds_read_b128 v[72:75], v5 offset:1408
    ds_read_b128 v[76:79], v5 offset:1920
    s_waitcnt lgkmcnt(8)
    v_mfma_f32_16x16x32_f16 v[16:19], v[40:43], v[44:47], 0
    ds_read_b128 v[80:83], v2 offset:960
    s_waitcnt lgkmcnt(8)
    v_mfma_f32_16x16x32_f16 v[20:23], v[40:43], v[48:51], 0
    ds_read_b128 v[84:87], v5 offset:320
    s_waitcnt lgkmcnt(8)
    v_mfma_f32_16x16x32_f16 v[24:27], v[40:43], v[52:55], 0
    s_waitcnt lgkmcnt(7)
    v_mfma_f32_16x16x32_f16 v[28:31], v[40:43], v[56:59], 0
    ds_read_b128 v[40:43], v5 offset:832
    ds_read_b128 v[44:47], v5 offset:1344
    ds_read_b128 v[48:51], v5 offset:1856
    s_waitcnt lgkmcnt(8)
    v_mfma_f32_16x16x32_f16 v[16:19], v[60:63], v[64:67], v[16:19]
    ds_read_b128 v[52:55], v2 offset:896
    s_waitcnt lgkmcnt(8)
    v_mfma_f32_16x16x32_f16 v[20:23], v[60:63], v[68:71], v[20:23]
    ds_read_b128 v[56:59], v5 offset:256
    s_waitcnt lgkmcnt(8)
    v_mfma_f32_16x16x32_f16 v[24:27], v[60:63], v[72:75], v[24:27]
    s_waitcnt lgkmcnt(7)
    v_mfma_f32_16x16x32_f16 v[28:31], v[60:63], v[76:79], v[28:31]
    ds_read_b128 v[60:63], v5 offset:768
    ds_read_b128 v[64:67], v5 offset:1280
    ds_read_b128 v[68:71], v5 offset:1792
    s_waitcnt lgkmcnt(8)
    v_mfma_f32_16x16x32_f16 v[16:19], v[80:83], v[84:87], v[16:19]
    ds_read_b128 v[72:75], v2 offset:832
    s_waitcnt lgkmcnt(8)
    v_mfma_f32_16x16x32_f16 v[20:23], v[80:83], v[40:43], v[20:23]
    ds_read_b128 v[76:79], v5 offset:192
    s_waitcnt lgkmcnt(8)
    v_mfma_f32_16x16x32_f16 v[24:27], v[80:83], v[44:47], v[24:27]
    s_waitcnt lgkmcnt(7)
    v_mfma_f32_16x16x32_f16 v[28:31], v[80:83], v[48:51], v[28:31]
    ds_read_b128 v[80:83], v5 offset:704
    ds_read_b128 v[84:87], v5 offset:1216
    ds_read_b128 v[40:43], v5 offset:1728
    s_waitcnt lgkmcnt(8)
    v_mfma_f32_16x16x32_f16 v[16:19], v[52:55], v[56:59], v[16:19]
    ds_read_b128 v[44:47], v2 offset:768
    s_waitcnt lgkmcnt(8)
    v_mfma_f32_16x16x32_f16 v[20:23], v[52:55], v[60:63], v[20:23]
    ds_read_b128 v[48:51], v5 offset:128
    s_waitcnt lgkmcnt(8)
    v_mfma_f32_16x16x32_f16 v[24:27], v[52:55], v[64:67], v[24:27]
    s_waitcnt lgkmcnt(7)
    v_mfma_f32_16x16x32_f16 v[28:31], v[52:55], v[68:71], v[28:31]
    ds_read_b128 v[52:55], v5 offset:640
    ds_read_b128 v[56:59], v5 offset:1152
    ds_read_b128 v[60:63], v5 offset:1664
    s_waitcnt lgkmcnt(8)
    v_mfma_f32_16x16x32_f16 v[16:19], v[72:75], v[76:79], v[16:19]
    ds_read_b128 v[64:67], v2 offset:704
    s_waitcnt lgkmcnt(8)
    v_mfma_f32_16x16x32_f16 v[20:23], v[72:75], v[80:83], v[20:23]
    ds_read_b128 v[68:71], v5 offset:64
    s_waitcnt lgkmcnt(8)
    v_mfma_f32_16x16x32_f16 v[24:27], v[72:75], v[84:87], v[24:27]
    s_waitcnt lgkmcnt(7)
    v_mfma_f32_16x16x32_f16 v[28:31], v[72:75], v[40:43], v[28:31]
    ds_read_b128 v[72:75], v5 offset:576
    ds_read_b128 v[76:79], v5 offset:1088
    ds_read_b128 v[80:83], v5 offset:1600
    s_waitcnt lgkmcnt(8)
    v_mfma_f32_16x16x32_f16 v[16:19], v[44:47], v[48:51], v[16:19]
    ds_read_b128 v[84:87], v2 offset:640
    s_waitcnt lgkmcnt(8)
    v_mfma_f32_16x16x32_f16 v[20:23], v[44:47], v[52:55], v[20:23]
    ds_read_b128 v[40:43], v5 offset:0
    s_waitcnt lgkmcnt(8)
    v_mfma_f32_16x16x32_f16 v[24:27], v[44:47], v[56:59], v[24:27]
    s_waitcnt lgkmcnt(7)
    v_mfma_f32_16x16x32_f16 v[28:31], v[44:47], v[60:63], v[28:31]
    ds_read_b128 v[44:47], v5 offset:512
    ds_read_b128 v[48:51], v5 offset:1024
    ds_read_b128 v[52:55], v5 offset:1536
    s_waitcnt lgkmcnt(8)
    v_mfma_f32_16x16x32_f16 v[16:19], v[64:67], v[68:71], v[16:19]
    ds_read_b128 v[56:59], v2 offset:576
    s_waitcnt lgkmcnt(8)
    v_mfma_f32_16x16x32_f16 v[20:23], v[64:67], v[72:75], v[20:23]
    ds_read_b128 v[60:63], v5 offset:448
    s_waitcnt lgkmcnt(8)
    v_mfma_f32_16x16x32_f16 v[24:27], v[64:67], v[76:79], v[24:27]
    s_waitcnt lgkmcnt(7)
    v_mfma_f32_16x16x32_f16 v[28:31], v[64:67], v[80:83], v[28:31]
    ds_read_b128 v[64:67], v5 offset:960
    ds_read_b128 v[68:71], v5 offset:1472
    ds_read_b128 v[72:75], v2 offset:512
    s_waitcnt lgkmcnt(8)
    v_mfma_f32_16x16x32_f16 v[16:19], v[84:87], v[40:43], v[16:19]
    ds_read_b128 v[76:79], v5 offset:384
    s_waitcnt lgkmcnt(8)
    v_mfma_f32_16x16x32_f16 v[20:23], v[84:87], v[44:47], v[20:23]
    ds_read_b128 v[80:83], v5 offset:896
    s_waitcnt lgkmcnt(8)
    v_mfma_f32_16x16x32_f16 v[24:27], v[84:87], v[48:51], v[24:27]
    s_waitcnt lgkmcnt(7)
    v_mfma_f32_16x16x32_f16 v[28:31], v[84:87], v[52:55], v[28:31]
    ds_read_b128 v[84:87], v5 offset:1408
    ds_read_b128 v[40:43], v2 offset:448
    ds_read_b128 v[44:47], v5 offset:320
    s_waitcnt lgkmcnt(8)
    v_mfma_f32_16x16x32_f16 v[20:23], v[56:59], v[60:63], v[20:23]
    ds_read_b128 v[48:51], v5 offset:832
    s_waitcnt lgkmcnt(8)
    v_mfma_f32_16x16x32_f16 v[24:27], v[56:59], v[64:67], v[24:27]
    ds_read_b128 v[52:55], v5 offset:1344
    s_waitcnt lgkmcnt(8)
    v_mfma_f32_16x16x32_f16 v[28:31], v[56:59], v[68:71], v[28:31]
    ds_read_b128 v[56:59], v2 offset:384
    ds_read_b128 v[60:63], v5 offset:256
    s_waitcnt lgkmcnt(8)
    v_mfma_f32_16x16x32_f16 v[20:23], v[72:75], v[76:79], v[20:23]
    ds_read_b128 v[64:67], v5 offset:768
    s_waitcnt lgkmcnt(8)
    v_mfma_f32_16x16x32_f16 v[24:27], v[72:75], v[80:83], v[24:27]
    ds_read_b128 v[68:71], v5 offset:1280
    s_waitcnt lgkmcnt(8)
    v_mfma_f32_16x16x32_f16 v[28:31], v[72:75], v[84:87], v[28:31]
    ds_read_b128 v[72:75], v2 offset:320
    ds_read_b128 v[76:79], v5 offset:192
    s_waitcnt lgkmcnt(8)
    v_mfma_f32_16x16x32_f16 v[20:23], v[40:43], v[44:47], v[20:23]
    ds_read_b128 v[80:83], v5 offset:704
    s_waitcnt lgkmcnt(8)
    v_mfma_f32_16x16x32_f16 v[24:27], v[40:43], v[48:51], v[24:27]
    ds_read_b128 v[84:87], v5 offset:1216
    s_waitcnt lgkmcnt(8)
    v_mfma_f32_16x16x32_f16 v[28:31], v[40:43], v[52:55], v[28:31]
    ds_read_b128 v[40:43], v2 offset:256
    ds_read_b128 v[44:47], v5 offset:128
    s_waitcnt lgkmcnt(8)
    v_mfma_f32_16x16x32_f16 v[20:23], v[56:59], v[60:63], v[20:23]
    ds_read_b128 v[48:51], v5 offset:640
    s_waitcnt lgkmcnt(8)
    v_mfma_f32_16x16x32_f16 v[24:27], v[56:59], v[64:67], v[24:27]
    ds_read_b128 v[52:55], v5 offset:1152
    s_waitcnt lgkmcnt(8)
    v_mfma_f32_16x16x32_f16 v[28:31], v[56:59], v[68:71], v[28:31]
    ds_read_b128 v[56:59], v2 offset:192
    ds_read_b128 v[60:63], v5 offset:64
    s_waitcnt lgkmcnt(8)
    v_mfma_f32_16x16x32_f16 v[20:23], v[72:75], v[76:79], v[20:23]
    ds_read_b128 v[64:67], v5 offset:576
    s_waitcnt lgkmcnt(8)
    v_mfma_f32_16x16x32_f16 v[24:27], v[72:75], v[80:83], v[24:27]
    ds_read_b128 v[68:71], v5 offset:1088
    s_waitcnt lgkmcnt(8)
    v_mfma_f32_16x16x32_f16 v[28:31], v[72:75], v[84:87], v[28:31]
    ds_read_b128 v[72:75], v2 offset:128
    ds_read_b128 v[76:79], v5 offset:0
    s_waitcnt lgkmcnt(8)
    v_mfma_f32_16x16x32_f16 v[20:23], v[40:43], v[44:47], v[20:23]
    ds_read_b128 v[80:83], v5 offset:512
    s_waitcnt lgkmcnt(8)
    v_mfma_f32_16x16x32_f16 v[24:27], v[40:43], v[48:51], v[24:27]
    ds_read_b128 v[84:87], v5 offset:1024
    s_waitcnt lgkmcnt(8)
    v_mfma_f32_16x16x32_f16 v[28:31], v[40:43], v[52:55], v[28:31]
    ds_read_b128 v[40:43], v2 offset:64
    ds_read_b128 v[44:47], v5 offset:448
    s_waitcnt lgkmcnt(8)
    v_mfma_f32_16x16x32_f16 v[20:23], v[56:59], v[60:63], v[20:23]
    ds_read_b128 v[48:51], v5 offset:960
    s_waitcnt lgkmcnt(8)
    v_mfma_f32_16x16x32_f16 v[24:27], v[56:59], v[64:67], v[24:27]
    ds_read_b128 v[52:55], v4 offset:128
    s_waitcnt lgkmcnt(8)
    v_mfma_f32_16x16x32_f16 v[28:31], v[56:59], v[68:71], v[28:31]
    ds_read_b64_tr_b16 v[56:57], v6 offset:4616
    ds_read_b64_tr_b16 v[58:59], v6 offset:4680
    ds_read_b64_tr_b16 v[60:61], v6 offset:5128
    ds_read_b64_tr_b16 v[62:63], v6 offset:5192
    s_waitcnt lgkmcnt(10)
    v_mfma_f32_16x16x32_f16 v[20:23], v[72:75], v[76:79], v[20:23]
    ds_read_b128 v[64:67], v4 offset:64
    s_waitcnt lgkmcnt(10)
    v_mfma_f32_16x16x32_f16 v[24:27], v[72:75], v[80:83], v[24:27]
    ds_read_b64_tr_b16 v[68:69], v6 offset:4616
    ds_read_b64_tr_b16 v[70:71], v6 offset:4680
    s_waitcnt lgkmcnt(11)
    v_mfma_f32_16x16x32_f16 v[28:31], v[72:75], v[84:87], v[28:31]
    ds_read_b128 v[72:75], v4 offset:368
    ds_read_b64_tr_b16 v[76:77], v6 offset:7728
    ds_read_b64_tr_b16 v[78:79], v6 offset:7792
    s_waitcnt lgkmcnt(12)
    v_mfma_f32_16x16x32_f16 v[24:27], v[40:43], v[44:47], v[24:27]
    s_waitcnt lgkmcnt(11)
    v_mfma_f32_16x16x32_f16 v[28:31], v[40:43], v[48:51], v[28:31]
    ds_read_b64_tr_b16 v[80:81], v6 offset:8240
    ds_read_b64_tr_b16 v[82:83], v6 offset:8304
    ds_read_b128 v[84:87], v4 offset:304
    s_waitcnt lgkmcnt(11)
    v_mfma_f32_16x16x32_f16 v[24:27], v[56:59], v[52:55], v[24:27]
    ds_read_b64_tr_b16 v[40:41], v6 offset:7728
    ds_read_b64_tr_b16 v[42:43], v6 offset:7792
    s_waitcnt lgkmcnt(11)
    v_mfma_f32_16x16x32_f16 v[28:31], v[60:63], v[52:55], v[28:31]
    s_waitcnt lgkmcnt(8)
    v_mfma_f32_16x16x32_f16 v[28:31], v[68:71], v[64:67], v[28:31]
    s_waitcnt lgkmcnt(5)
    v_mfma_f32_16x16x32_f16 v[24:27], v[76:79], v[72:75], v[24:27]
    s_waitcnt lgkmcnt(3)
    v_mfma_f32_16x16x32_f16 v[28:31], v[80:83], v[72:75], v[28:31]
    s_waitcnt lgkmcnt(0)
    v_mfma_f32_16x16x32_f16 v[28:31], v[40:43], v[84:87], v[28:31]
    ds_read_b64 v[88:89], v8 offset:0
    ds_read_b64 v[90:91], v8 offset:512
    ds_read_b64 v[92:93], v8 offset:1024
    ds_read_b64 v[94:95], v8 offset:1536
    v_mul_f32 v40, v16, v10
    v_mul_f32 v41, v17, v10
    v_mul_f32 v42, v18, v10
    v_mul_f32 v43, v19, v10
    v_mul_f32 v44, v20, v10
    v_mul_f32 v45, v21, v10
    v_mul_f32 v46, v22, v10
    v_mul_f32 v47, v23, v10
    v_mul_f32 v48, v24, v10
    v_mul_f32 v49, v25, v10
    v_mul_f32 v50, v26, v10
    v_mul_f32 v51, v27, v10
    v_mul_f32 v52, v28, v10
    v_mul_f32 v53, v29, v10
    v_mul_f32 v54, v30, v10
    v_mul_f32 v55, v31, v10
    v_cvt_pk_bf16_f32 v72, v40, v41
    v_cvt_pk_bf16_f32 v73, v42, v43
    v_cvt_pk_bf16_f32 v74, v44, v45
    v_cvt_pk_bf16_f32 v75, v46, v47
    v_cvt_pk_bf16_f32 v76, v48, v49
    v_cvt_pk_bf16_f32 v77, v50, v51
    v_cvt_pk_bf16_f32 v78, v52, v53
    v_cvt_pk_bf16_f32 v79, v54, v55
    v_lshlrev_b32 v40, 16, v72
    v_and_b32 v41, 0xffff0000, v72
    v_lshlrev_b32 v42, 16, v73
    v_and_b32 v43, 0xffff0000, v73
    v_lshlrev_b32 v44, 16, v74
    v_and_b32 v45, 0xffff0000, v74
    v_lshlrev_b32 v46, 16, v75
    v_and_b32 v47, 0xffff0000, v75
    v_lshlrev_b32 v48, 16, v76
    v_and_b32 v49, 0xffff0000, v76
    v_lshlrev_b32 v50, 16, v77
    v_and_b32 v51, 0xffff0000, v77
    v_lshlrev_b32 v52, 16, v78
    v_and_b32 v53, 0xffff0000, v78
    v_lshlrev_b32 v54, 16, v79
    v_and_b32 v55, 0xffff0000, v79
    s_waitcnt vmcnt(0) lgkmcnt(0)
    v_fma_mix_f32 v56, v88, v11, 0 op_sel:[0,0,0] op_sel_hi:[1,0,0]
    v_fma_mix_f32 v57, v88, v11, 0 op_sel:[1,0,0] op_sel_hi:[1,0,0]
    v_fma_mix_f32 v58, v89, v11, 0 op_sel:[0,0,0] op_sel_hi:[1,0,0]
    v_fma_mix_f32 v59, v89, v11, 0 op_sel:[1,0,0] op_sel_hi:[1,0,0]
    v_fma_mix_f32 v60, v90, v11, 0 op_sel:[0,0,0] op_sel_hi:[1,0,0]
    v_fma_mix_f32 v61, v90, v11, 0 op_sel:[1,0,0] op_sel_hi:[1,0,0]
    v_fma_mix_f32 v62, v91, v11, 0 op_sel:[0,0,0] op_sel_hi:[1,0,0]
    v_fma_mix_f32 v63, v91, v11, 0 op_sel:[1,0,0] op_sel_hi:[1,0,0]
    v_fma_mix_f32 v64, v92, v11, 0 op_sel:[0,0,0] op_sel_hi:[1,0,0]
    v_fma_mix_f32 v65, v92, v11, 0 op_sel:[1,0,0] op_sel_hi:[1,0,0]
    v_fma_mix_f32 v66, v93, v11, 0 op_sel:[0,0,0] op_sel_hi:[1,0,0]
    v_fma_mix_f32 v67, v93, v11, 0 op_sel:[1,0,0] op_sel_hi:[1,0,0]
    v_fma_mix_f32 v68, v94, v11, 0 op_sel:[0,0,0] op_sel_hi:[1,0,0]
    v_fma_mix_f32 v69, v94, v11, 0 op_sel:[1,0,0] op_sel_hi:[1,0,0]
    v_fma_mix_f32 v70, v95, v11, 0 op_sel:[0,0,0] op_sel_hi:[1,0,0]
    v_fma_mix_f32 v71, v95, v11, 0 op_sel:[1,0,0] op_sel_hi:[1,0,0]
    v_cvt_pk_bf16_f32 v72, v56, v57
    v_cvt_pk_bf16_f32 v73, v58, v59
    v_cvt_pk_bf16_f32 v74, v60, v61
    v_cvt_pk_bf16_f32 v75, v62, v63
    v_cvt_pk_bf16_f32 v76, v64, v65
    v_cvt_pk_bf16_f32 v77, v66, v67
    v_cvt_pk_bf16_f32 v78, v68, v69
    v_cvt_pk_bf16_f32 v79, v70, v71
    v_lshlrev_b32 v56, 16, v72
    v_and_b32 v57, 0xffff0000, v72
    v_lshlrev_b32 v58, 16, v73
    v_and_b32 v59, 0xffff0000, v73
    v_lshlrev_b32 v60, 16, v74
    v_and_b32 v61, 0xffff0000, v74
    v_lshlrev_b32 v62, 16, v75
    v_and_b32 v63, 0xffff0000, v75
    v_lshlrev_b32 v64, 16, v76
    v_and_b32 v65, 0xffff0000, v76
    v_lshlrev_b32 v66, 16, v77
    v_and_b32 v67, 0xffff0000, v77
    v_lshlrev_b32 v68, 16, v78
    v_and_b32 v69, 0xffff0000, v78
    v_lshlrev_b32 v70, 16, v79
    v_and_b32 v71, 0xffff0000, v79
    v_add_f32 v40, v40, v56
    v_add_f32 v41, v41, v57
    v_add_f32 v42, v42, v58
    v_add_f32 v43, v43, v59
    v_add_f32 v44, v44, v60
    v_add_f32 v45, v45, v61
    v_add_f32 v46, v46, v62
    v_add_f32 v47, v47, v63
    v_add_f32 v48, v48, v64
    v_add_f32 v49, v49, v65
    v_add_f32 v50, v50, v66
    v_add_f32 v51, v51, v67
    v_add_f32 v52, v52, v68
    v_add_f32 v53, v53, v69
    v_add_f32 v54, v54, v70
    v_add_f32 v55, v55, v71
    v_cvt_pk_bf16_f32 v72, v40, v41
    v_cvt_pk_bf16_f32 v73, v42, v43
    v_cvt_pk_bf16_f32 v74, v44, v45
    v_cvt_pk_bf16_f32 v75, v46, v47
    v_cvt_pk_bf16_f32 v76, v48, v49
    v_cvt_pk_bf16_f32 v77, v50, v51
    v_cvt_pk_bf16_f32 v78, v52, v53
    v_cvt_pk_bf16_f32 v79, v54, v55
    v_lshlrev_b32 v40, 16, v72
    v_and_b32 v41, 0xffff0000, v72
    v_lshlrev_b32 v42, 16, v73
    v_and_b32 v43, 0xffff0000, v73
    v_lshlrev_b32 v56, 16, v32
    v_and_b32 v57, 0xffff0000, v32
    v_lshlrev_b32 v58, 16, v33
    v_and_b32 v59, 0xffff0000, v33
    v_lshlrev_b32 v44, 16, v74
    v_and_b32 v45, 0xffff0000, v74
    v_lshlrev_b32 v46, 16, v75
    v_and_b32 v47, 0xffff0000, v75
    v_lshlrev_b32 v60, 16, v34
    v_and_b32 v61, 0xffff0000, v34
    v_lshlrev_b32 v62, 16, v35
    v_and_b32 v63, 0xffff0000, v35
    v_lshlrev_b32 v48, 16, v76
    v_and_b32 v49, 0xffff0000, v76
    v_lshlrev_b32 v50, 16, v77
    v_and_b32 v51, 0xffff0000, v77
    v_lshlrev_b32 v64, 16, v36
    v_and_b32 v65, 0xffff0000, v36
    v_lshlrev_b32 v66, 16, v37
    v_and_b32 v67, 0xffff0000, v37
    v_lshlrev_b32 v52, 16, v78
    v_and_b32 v53, 0xffff0000, v78
    v_lshlrev_b32 v54, 16, v79
    v_and_b32 v55, 0xffff0000, v79
    v_lshlrev_b32 v68, 16, v38
    v_and_b32 v69, 0xffff0000, v38
    v_lshlrev_b32 v70, 16, v39
    v_and_b32 v71, 0xffff0000, v39
    v_add_f32 v40, v40, v56
    v_add_f32 v41, v41, v57
    v_add_f32 v42, v42, v58
    v_add_f32 v43, v43, v59
    v_add_f32 v44, v44, v60
    v_add_f32 v45, v45, v61
    v_add_f32 v46, v46, v62
    v_add_f32 v47, v47, v63
    v_add_f32 v48, v48, v64
    v_add_f32 v49, v49, v65
    v_add_f32 v50, v50, v66
    v_add_f32 v51, v51, v67
    v_add_f32 v52, v52, v68
    v_add_f32 v53, v53, v69
    v_add_f32 v54, v54, v70
    v_add_f32 v55, v55, v71
    v_cvt_pk_bf16_f32 v72, v40, v41
    v_cvt_pk_bf16_f32 v73, v42, v43
    v_cvt_pk_bf16_f32 v74, v44, v45
    v_cvt_pk_bf16_f32 v75, v46, v47
    v_cvt_pk_bf16_f32 v76, v48, v49
    v_cvt_pk_bf16_f32 v77, v50, v51
    v_cvt_pk_bf16_f32 v78, v52, v53
    v_cvt_pk_bf16_f32 v79, v54, v55
    s_cmp_eq_u32 s7, 1
    s_cbranch_scc1 L_fin14
    s_add_u32 s50, s32, 10485760
    s_addc_u32 s51, s33, 0
    global_store_dwordx2 v9, v[72:73], s[50:51] offset:0 sc1
    global_store_dwordx2 v9, v[74:75], s[50:51] offset:512 sc1
    global_store_dwordx2 v9, v[76:77], s[50:51] offset:1024 sc1
    global_store_dwordx2 v9, v[78:79], s[50:51] offset:1536 sc1
    s_branch L_b_done
L_fin14:
    v_add_u32 v12, 0, v13
    global_store_short v12, v72, s[28:29] offset:0
    global_store_short_d16_hi v12, v72, s[28:29] offset:1280
    global_store_short v12, v73, s[28:29] offset:2560
    global_store_short_d16_hi v12, v73, s[28:29] offset:3840
    v_add_u32 v12, 327680, v13
    global_store_short v12, v74, s[28:29] offset:0
    global_store_short_d16_hi v12, v74, s[28:29] offset:1280
    global_store_short v12, v75, s[28:29] offset:2560
    global_store_short_d16_hi v12, v75, s[28:29] offset:3840
    v_add_u32 v12, 655360, v13
    global_store_short v12, v76, s[28:29] offset:0
    global_store_short_d16_hi v12, v76, s[28:29] offset:1280
    global_store_short v12, v77, s[28:29] offset:2560
    global_store_short_d16_hi v12, v77, s[28:29] offset:3840
    v_add_u32 v12, 983040, v13
    global_store_short v12, v78, s[28:29] offset:0
    global_store_short_d16_hi v12, v78, s[28:29] offset:1280
    global_store_short v12, v79, s[28:29] offset:2560
    global_store_short_d16_hi v12, v79, s[28:29] offset:3840
    s_branch L_b_done
L_b_p2:
    ds_read_b128 v[40:43], v2 offset:1088
    ds_read_b128 v[44:47], v5 offset:2496
    ds_read_b128 v[48:51], v5 offset:3008
    ds_read_b128 v[52:55], v2 offset:1024
    ds_read_b128 v[56:59], v5 offset:2432
    ds_read_b128 v[60:63], v5 offset:2944
    ds_read_b128 v[64:67], v2 offset:960
    ds_read_b128 v[68:71], v5 offset:2368
    ds_read_b128 v[72:75], v5 offset:2880
    ds_read_b128 v[76:79], v2 offset:896
    s_waitcnt lgkmcnt(8)
    v_mfma_f32_16x16x32_f16 v[16:19], v[40:43], v[44:47], 0
    ds_read_b128 v[80:83], v5 offset:2304
    s_waitcnt lgkmcnt(8)
    v_mfma_f32_16x16x32_f16 v[20:23], v[40:43], v[48:51], 0
    ds_read_b128 v[84:87], v5 offset:2816
    ds_read_b128 v[40:43], v2 offset:832
    s_waitcnt lgkmcnt(8)
    v_mfma_f32_16x16x32_f16 v[16:19], v[52:55], v[56:59], v[16:19]
    ds_read_b128 v[44:47], v5 offset:2240
    s_waitcnt lgkmcnt(8)
    v_mfma_f32_16x16x32_f16 v[20:23], v[52:55], v[60:63], v[20:23]
    ds_read_b128 v[48:51], v5 offset:2752
    ds_read_b128 v[52:55], v2 offset:768
    s_waitcnt lgkmcnt(8)
    v_mfma_f32_16x16x32_f16 v[16:19], v[64:67], v[68:71], v[16:19]
    ds_read_b128 v[56:59], v5 offset:2176
    s_waitcnt lgkmcnt(8)
    v_mfma_f32_16x16x32_f16 v[20:23], v[64:67], v[72:75], v[20:23]
    ds_read_b128 v[60:63], v5 offset:2688
    ds_read_b128 v[64:67], v2 offset:704
    s_waitcnt lgkmcnt(8)
    v_mfma_f32_16x16x32_f16 v[16:19], v[76:79], v[80:83], v[16:19]
    ds_read_b128 v[68:71], v5 offset:2112
    s_waitcnt lgkmcnt(8)
    v_mfma_f32_16x16x32_f16 v[20:23], v[76:79], v[84:87], v[20:23]
    ds_read_b128 v[72:75], v5 offset:2624
    ds_read_b128 v[76:79], v2 offset:640
    s_waitcnt lgkmcnt(8)
    v_mfma_f32_16x16x32_f16 v[16:19], v[40:43], v[44:47], v[16:19]
    ds_read_b128 v[80:83], v5 offset:2048
    s_waitcnt lgkmcnt(8)
    v_mfma_f32_16x16x32_f16 v[20:23], v[40:43], v[48:51], v[20:23]
    ds_read_b128 v[84:87], v5 offset:2560
    ds_read_b128 v[40:43], v2 offset:576
    s_waitcnt lgkmcnt(8)
    v_mfma_f32_16x16x32_f16 v[16:19], v[52:55], v[56:59], v[16:19]
    ds_read_b128 v[44:47], v5 offset:1984
    s_waitcnt lgkmcnt(8)
    v_mfma_f32_16x16x32_f16 v[20:23], v[52:55], v[60:63], v[20:23]
    ds_read_b128 v[48:51], v5 offset:2496
    ds_read_b128 v[52:55], v2 offset:512
    s_waitcnt lgkmcnt(8)
    v_mfma_f32_16x16x32_f16 v[16:19], v[64:67], v[68:71], v[16:19]
    ds_read_b128 v[56:59], v5 offset:1920
    s_waitcnt lgkmcnt(8)
    v_mfma_f32_16x16x32_f16 v[20:23], v[64:67], v[72:75], v[20:23]
    ds_read_b128 v[60:63], v5 offset:2432
    ds_read_b128 v[64:67], v2 offset:448
    s_waitcnt lgkmcnt(8)
    v_mfma_f32_16x16x32_f16 v[16:19], v[76:79], v[80:83], v[16:19]
    ds_read_b128 v[68:71], v5 offset:1856
    s_waitcnt lgkmcnt(8)
    v_mfma_f32_16x16x32_f16 v[20:23], v[76:79], v[84:87], v[20:23]
    ds_read_b128 v[72:75], v5 offset:2368
    ds_read_b128 v[76:79], v2 offset:384
    s_waitcnt lgkmcnt(8)
    v_mfma_f32_16x16x32_f16 v[16:19], v[40:43], v[44:47], v[16:19]
    ds_read_b128 v[80:83], v5 offset:1792
    s_waitcnt lgkmcnt(8)
    v_mfma_f32_16x16x32_f16 v[20:23], v[40:43], v[48:51], v[20:23]
    ds_read_b128 v[84:87], v5 offset:2304
    ds_read_b128 v[40:43], v2 offset:320
    s_waitcnt lgkmcnt(8)
    v_mfma_f32_16x16x32_f16 v[16:19], v[52:55], v[56:59], v[16:19]
    ds_read_b128 v[44:47], v5 offset:1728
    s_waitcnt lgkmcnt(8)
    v_mfma_f32_16x16x32_f16 v[20:23], v[52:55], v[60:63], v[20:23]
    ds_read_b128 v[48:51], v5 offset:2240
    ds_read_b128 v[52:55], v2 offset:256
    s_waitcnt lgkmcnt(8)
    v_mfma_f32_16x16x32_f16 v[16:19], v[64:67], v[68:71], v[16:19]
    ds_read_b128 v[56:59], v5 offset:1664
    s_waitcnt lgkmcnt(8)
    v_mfma_f32_16x16x32_f16 v[20:23], v[64:67], v[72:75], v[20:23]
    ds_read_b128 v[60:63], v5 offset:2176
    ds_read_b128 v[64:67], v2 offset:192
    s_waitcnt lgkmcnt(8)
    v_mfma_f32_16x16x32_f16 v[16:19], v[76:79], v[80:83], v[16:19]
    ds_read_b128 v[68:71], v5 offset:1600
    s_waitcnt lgkmcnt(8)
    v_mfma_f32_16x16x32_f16 v[20:23], v[76:79], v[84:87], v[20:23]
    ds_read_b128 v[72:75], v5 offset:2112
    ds_read_b128 v[76:79], v2 offset:128
    s_waitcnt lgkmcnt(8)
    v_mfma_f32_16x16x32_f16 v[16:19], v[40:43], v[44:47], v[16:19]
    ds_read_b128 v[80:83], v5 offset:1536
    s_waitcnt lgkmcnt(8)
    v_mfma_f32_16x16x32_f16 v[20:23], v[40:43], v[48:51], v[20:23]
    ds_read_b128 v[84:87], v5 offset:2048
    ds_read_b128 v[40:43], v2 offset:64
    s_waitcnt lgkmcnt(8)
    v_mfma_f32_16x16x32_f16 v[16:19], v[52:55], v[56:59], v[16:19]
    ds_read_b128 v[44:47], v5 offset:1472
    s_waitcnt lgkmcnt(8)
    v_mfma_f32_16x16x32_f16 v[20:23], v[52:55], v[60:63], v[20:23]
    ds_read_b128 v[48:51], v5 offset:1984
    ds_read_b128 v[52:55], v2 offset:0
    s_waitcnt lgkmcnt(8)
    v_mfma_f32_16x16x32_f16 v[16:19], v[64:67], v[68:71], v[16:19]
    ds_read_b128 v[56:59], v5 offset:448
    s_waitcnt lgkmcnt(8)
    v_mfma_f32_16x16x32_f16 v[20:23], v[64:67], v[72:75], v[20:23]
    ds_read_b128 v[60:63], v5 offset:960
    ds_read_b128 v[64:67], v4 offset:128
    s_waitcnt lgkmcnt(8)
    v_mfma_f32_16x16x32_f16 v[16:19], v[76:79], v[80:83], v[16:19]
    ds_read_b64_tr_b16 v[68:69], v6 offset:5640
    ds_read_b64_tr_b16 v[70:71], v6 offset:5704
    s_waitcnt lgkmcnt(9)
    v_mfma_f32_16x16x32_f16 v[20:23], v[76:79], v[84:87], v[20:23]
    ds_read_b64_tr_b16 v[72:73], v6 offset:6152
    ds_read_b64_tr_b16 v[74:75], v6 offset:6216
    ds_read_b128 v[76:79], v4 offset:64
    s_waitcnt lgkmcnt(10)
    v_mfma_f32_16x16x32_f16 v[16:19], v[40:43], v[44:47], v[16:19]
    ds_read_b64_tr_b16 v[80:81], v6 offset:5128
    ds_read_b64_tr_b16 v[82:83], v6 offset:5192
    s_waitcnt lgkmcnt(11)
    v_mfma_f32_16x16x32_f16 v[20:23], v[40:43], v[48:51], v[20:23]
    ds_read_b64_tr_b16 v[84:85], v6 offset:5640
    ds_read_b64_tr_b16 v[86:87], v6 offset:5704
    ds_read_b128 v[40:43], v4 offset:0
    s_waitcnt lgkmcnt(12)
    v_mfma_f32_16x16x32_f16 v[16:19], v[52:55], v[56:59], v[16:19]
    s_waitcnt lgkmcnt(11)
    v_mfma_f32_16x16x32_f16 v[20:23], v[52:55], v[60:63], v[20:23]
    ds_read_b64_tr_b16 v[44:45], v6 offset:4616
    ds_read_b64_tr_b16 v[46:47], v6 offset:4680
    ds_read_b64_tr_b16 v[48:49], v6 offset:5128
    ds_read_b64_tr_b16 v[50:51], v6 offset:5192
    s_waitcnt lgkmcnt(12)
    v_mfma_f32_16x16x32_f16 v[16:19], v[68:71], v[64:67], v[16:19]
    ds_read_b128 v[52:55], v4 offset:368
    s_waitcnt lgkmcnt(11)
    v_mfma_f32_16x16x32_f16 v[20:23], v[72:75], v[64:67], v[20:23]
    ds_read_b64_tr_b16 v[56:57], v6 offset:8752
    ds_read_b64_tr_b16 v[58:59], v6 offset:8816
    ds_read_b64_tr_b16 v[60:61], v6 offset:9264
    ds_read_b64_tr_b16 v[62:63], v6 offset:9328
    s_waitcnt lgkmcnt(12)
    v_mfma_f32_16x16x32_f16 v[16:19], v[80:83], v[76:79], v[16:19]
    ds_read_b128 v[64:67], v4 offset:304
    s_waitcnt lgkmcnt(11)
    v_mfma_f32_16x16x32_f16 v[20:23], v[84:87], v[76:79], v[20:23]
    ds_read_b64_tr_b16 v[68:69], v6 offset:8240
    ds_read_b64_tr_b16 v[70:71], v6 offset:8304
    ds_read_b64_tr_b16 v[72:73], v6 offset:8752
    ds_read_b64_tr_b16 v[74:75], v6 offset:8816
    s_waitcnt lgkmcnt(12)
    v_mfma_f32_16x16x32_f16 v[16:19], v[44:47], v[40:43], v[16:19]
    ds_read_b128 v[76:79], v4 offset:240
    s_waitcnt lgkmcnt(11)
    v_mfma_f32_16x16x32_f16 v[20:23], v[48:51], v[40:43], v[20:23]
    ds_read_b64_tr_b16 v[80:81], v6 offset:7728
    ds_read_b64_tr_b16 v[82:83], v6 offset:7792
    ds_read_b64_tr_b16 v[84:85], v6 offset:8240
    ds_read_b64_tr_b16 v[86:87], v6 offset:8304
    s_waitcnt lgkmcnt(12)
    v_mfma_f32_16x16x32_f16 v[16:19], v[56:59], v[52:55], v[16:19]
    ds_read_b128 v[40:43], v3 offset:1264
    s_waitcnt lgkmcnt(11)
    v_mfma_f32_16x16x32_f16 v[20:23], v[60:63], v[52:55], v[20:23]
    ds_read_b64_tr_b16 v[44:45], v7 offset:10824
    ds_read_b64_tr_b16 v[46:47], v7 offset:10952
    ds_read_b128 v[48:51], v3 offset:1232
    s_waitcnt lgkmcnt(11)
    v_mfma_f32_16x16x32_f16 v[16:19], v[68:71], v[64:67], v[16:19]
    ds_read_b64_tr_b16 v[52:53], v7 offset:10824
    ds_read_b64_tr_b16 v[54:55], v7 offset:10952
    ds_read_b128 v[56:59], v3 offset:1440
    s_waitcnt lgkmcnt(12)
    v_mfma_f32_16x16x32_f16 v[20:23], v[72:75], v[64:67], v[20:23]
    ds_read_b64_tr_b16 v[60:61], v7 offset:12920
    ds_read_b64_tr_b16 v[62:63], v7 offset:13048
    ds_read_b128 v[64:67], v3 offset:1408
    s_waitcnt lgkmcnt(12)
    v_mfma_f32_16x16x32_f16 v[16:19], v[80:83], v[76:79], v[16:19]
    ds_read_b64_tr_b16 v[68:69], v7 offset:12920
    ds_read_b64_tr_b16 v[70:71], v7 offset:13048
    s_waitcnt lgkmcnt(12)
    v_mfma_f32_16x16x32_f16 v[20:23], v[84:87], v[76:79], v[20:23]
    s_waitcnt lgkmcnt(9)
    v_mfma_f32_16x16x32_f16 v[16:19], v[44:47], v[40:43], v[16:19]
    s_waitcnt lgkmcnt(6)
    v_mfma_f32_16x16x32_f16 v[20:23], v[52:55], v[48:51], v[20:23]
    s_waitcnt lgkmcnt(3)
    v_mfma_f32_16x16x32_f16 v[16:19], v[60:63], v[56:59], v[16:19]
    s_waitcnt lgkmcnt(0)
    v_mfma_f32_16x16x32_f16 v[20:23], v[68:71], v[64:67], v[20:23]
    ds_read_b64 v[88:89], v8 offset:2048
    ds_read_b64 v[90:91], v8 offset:2560
    s_nop 3
    v_mul_f32 v40, v16, v10
    v_mul_f32 v41, v17, v10
    v_mul_f32 v42, v18, v10
    v_mul_f32 v43, v19, v10
    v_mul_f32 v44, v20, v10
    v_mul_f32 v45, v21, v10
    v_mul_f32 v46, v22, v10
    v_mul_f32 v47, v23, v10
    v_cvt_pk_bf16_f32 v72, v40, v41
    v_cvt_pk_bf16_f32 v73, v42, v43
    v_cvt_pk_bf16_f32 v74, v44, v45
    v_cvt_pk_bf16_f32 v75, v46, v47
    v_lshlrev_b32 v40, 16, v72
    v_and_b32 v41, 0xffff0000, v72
    v_lshlrev_b32 v42, 16, v73
    v_and_b32 v43, 0xffff0000, v73
    v_lshlrev_b32 v44, 16, v74
    v_and_b32 v45, 0xffff0000, v74
    v_lshlrev_b32 v46, 16, v75
    v_and_b32 v47, 0xffff0000, v75
    s_waitcnt vmcnt(0) lgkmcnt(0)
    v_fma_mix_f32 v56, v88, v11, 0 op_sel:[0,0,0] op_sel_hi:[1,0,0]
    v_fma_mix_f32 v57, v88, v11, 0 op_sel:[1,0,0] op_sel_hi:[1,0,0]
    v_fma_mix_f32 v58, v89, v11, 0 op_sel:[0,0,0] op_sel_hi:[1,0,0]
    v_fma_mix_f32 v59, v89, v11, 0 op_sel:[1,0,0] op_sel_hi:[1,0,0]
    v_fma_mix_f32 v60, v90, v11, 0 op_sel:[0,0,0] op_sel_hi:[1,0,0]
    v_fma_mix_f32 v61, v90, v11, 0 op_sel:[1,0,0] op_sel_hi:[1,0,0]
    v_fma_mix_f32 v62, v91, v11, 0 op_sel:[0,0,0] op_sel_hi:[1,0,0]
    v_fma_mix_f32 v63, v91, v11, 0 op_sel:[1,0,0] op_sel_hi:[1,0,0]
    v_cvt_pk_bf16_f32 v72, v56, v57
    v_cvt_pk_bf16_f32 v73, v58, v59
    v_cvt_pk_bf16_f32 v74, v60, v61
    v_cvt_pk_bf16_f32 v75, v62, v63
    v_lshlrev_b32 v56, 16, v72
    v_and_b32 v57, 0xffff0000, v72
    v_lshlrev_b32 v58, 16, v73
    v_and_b32 v59, 0xffff0000, v73
    v_lshlrev_b32 v60, 16, v74
    v_and_b32 v61, 0xffff0000, v74
    v_lshlrev_b32 v62, 16, v75
    v_and_b32 v63, 0xffff0000, v75
    v_add_f32 v40, v40, v56
    v_add_f32 v41, v41, v57
    v_add_f32 v42, v42, v58
    v_add_f32 v43, v43, v59
    v_add_f32 v44, v44, v60
    v_add_f32 v45, v45, v61
    v_add_f32 v46, v46, v62
    v_add_f32 v47, v47, v63
    v_cvt_pk_bf16_f32 v72, v40, v41
    v_cvt_pk_bf16_f32 v73, v42, v43
    v_cvt_pk_bf16_f32 v74, v44, v45
    v_cvt_pk_bf16_f32 v75, v46, v47
    v_lshlrev_b32 v40, 16, v72
    v_and_b32 v41, 0xffff0000, v72
    v_lshlrev_b32 v42, 16, v73
    v_and_b32 v43, 0xffff0000, v73
    v_lshlrev_b32 v56, 16, v32
    v_and_b32 v57, 0xffff0000, v32
    v_lshlrev_b32 v58, 16, v33
    v_and_b32 v59, 0xffff0000, v33
    v_lshlrev_b32 v44, 16, v74
    v_and_b32 v45, 0xffff0000, v74
    v_lshlrev_b32 v46, 16, v75
    v_and_b32 v47, 0xffff0000, v75
    v_lshlrev_b32 v60, 16, v34
    v_and_b32 v61, 0xffff0000, v34
    v_lshlrev_b32 v62, 16, v35
    v_and_b32 v63, 0xffff0000, v35
    v_add_f32 v40, v40, v56
    v_add_f32 v41, v41, v57
    v_add_f32 v42, v42, v58
    v_add_f32 v43, v43, v59
    v_add_f32 v44, v44, v60
    v_add_f32 v45, v45, v61
    v_add_f32 v46, v46, v62
    v_add_f32 v47, v47, v63
    v_cvt_pk_bf16_f32 v72, v40, v41
    v_cvt_pk_bf16_f32 v73, v42, v43
    v_cvt_pk_bf16_f32 v74, v44, v45
    v_cvt_pk_bf16_f32 v75, v46, v47
    s_cmp_eq_u32 s7, 1
    s_cbranch_scc1 L_fin15
    s_add_u32 s50, s32, 10485760
    s_addc_u32 s51, s33, 0
    global_store_dwordx2 v9, v[72:73], s[50:51] offset:2048 sc1
    global_store_dwordx2 v9, v[74:75], s[50:51] offset:2560 sc1
    s_branch L_b_done
L_fin15:
    v_add_u32 v12, 1310720, v13
    global_store_short v12, v72, s[28:29] offset:0
    global_store_short_d16_hi v12, v72, s[28:29] offset:1280
    global_store_short v12, v73, s[28:29] offset:2560
    global_store_short_d16_hi v12, v73, s[28:29] offset:3840
    v_add_u32 v12, 1638400, v13
    global_store_short v12, v74, s[28:29] offset:0
    global_store_short_d16_hi v12, v74, s[28:29] offset:1280
    global_store_short v12, v75, s[28:29] offset:2560
    global_store_short_d16_hi v12, v75, s[28:29] offset:3840
    s_branch L_b_done
L_b_p3:
    ds_read_b128 v[40:43], v2 offset:1088
    ds_read_b128 v[44:47], v5 offset:3520
    ds_read_b128 v[48:51], v5 offset:4032
    ds_read_b128 v[52:55], v2 offset:1024
    ds_read_b128 v[56:59], v5 offset:3456
    ds_read_b128 v[60:63], v5 offset:3968
    ds_read_b128 v[64:67], v2 offset:960
    ds_read_b128 v[68:71], v5 offset:3392
    ds_read_b128 v[72:75], v5 offset:3904
    ds_read_b128 v[76:79], v2 offset:896
    s_waitcnt lgkmcnt(8)
    v_mfma_f32_16x16x32_f16 v[16:19], v[40:43], v[44:47], 0
    ds_read_b128 v[80:83], v5 offset:3328
    s_waitcnt lgkmcnt(8)
    v_mfma_f32_16x16x32_f16 v[20:23], v[40:43], v[48:51], 0
    ds_read_b128 v[84:87], v5 offset:3840
    ds_read_b128 v[40:43], v2 offset:832
    s_waitcnt lgkmcnt(8)
    v_mfma_f32_16x16x32_f16 v[16:19], v[52:55], v[56:59], v[16:19]
    ds_read_b128 v[44:47], v5 offset:3264
    s_waitcnt lgkmcnt(8)
    v_mfma_f32_16x16x32_f16 v[20:23], v[52:55], v[60:63], v[20:23]
    ds_read_b128 v[48:51], v5 offset:3776
    ds_read_b128 v[52:55], v2 offset:768
    s_waitcnt lgkmcnt(8)
    v_mfma_f32_16x16x32_f16 v[16:19], v[64:67], v[68:71], v[16:19]
    ds_read_b128 v[56:59], v5 offset:3200
    s_waitcnt lgkmcnt(8)
    v_mfma_f32_16x16x32_f16 v[20:23], v[64:67], v[72:75], v[20:23]
    ds_read_b128 v[60:63], v5 offset:3712
    ds_read_b128 v[64:67], v2 offset:704
    s_waitcnt lgkmcnt(8)
    v_mfma_f32_16x16x32_f16 v[16:19], v[76:79], v[80:83], v[16:19]
    ds_read_b128 v[68:71], v5 offset:3136
    s_waitcnt lgkmcnt(8)
    v_mfma_f32_16x16x32_f16 v[20:23], v[76:79], v[84:87], v[20:23]
    ds_read_b128 v[72:75], v5 offset:3648
    ds_read_b128 v[76:79], v2 offset:640
    s_waitcnt lgkmcnt(8)
    v_mfma_f32_16x16x32_f16 v[16:19], v[40:43], v[44:47], v[16:19]
    ds_read_b128 v[80:83], v5 offset:3072
    s_waitcnt lgkmcnt(8)
    v_mfma_f32_16x16x32_f16 v[20:23], v[40:43], v[48:51], v[20:23]
    ds_read_b128 v[84:87], v5 offset:3584
    ds_read_b128 v[40:43], v2 offset:576
    s_waitcnt lgkmcnt(8)
    v_mfma_f32_16x16x32_f16 v[16:19], v[52:55], v[56:59], v[16:19]
    ds_read_b128 v[44:47], v5 offset:3008
    s_waitcnt lgkmcnt(8)
    v_mfma_f32_16x16x32_f16 v[20:23], v[52:55], v[60:63], v[20:23]
    ds_read_b128 v[48:51], v5 offset:3520
    ds_read_b128 v[52:55], v2 offset:512
    s_waitcnt lgkmcnt(8)
    v_mfma_f32_16x16x32_f16 v[16:19], v[64:67], v[68:71], v[16:19]
    ds_read_b128 v[56:59], v5 offset:2944
    s_waitcnt lgkmcnt(8)
    v_mfma_f32_16x16x32_f16 v[20:23], v[64:67], v[72:75], v[20:23]
    ds_read_b128 v[60:63], v5 offset:3456
    ds_read_b128 v[64:67], v2 offset:448
    s_waitcnt lgkmcnt(8)
    v_mfma_f32_16x16x32_f16 v[16:19], v[76:79], v[80:83], v[16:19]
    ds_read_b128 v[68:71], v5 offset:2880
    s_waitcnt lgkmcnt(8)
    v_mfma_f32_16x16x32_f16 v[20:23], v[76:79], v[84:87], v[20:23]
    ds_read_b128 v[72:75], v5 offset:3392
    ds_read_b128 v[76:79], v2 offset:384
    s_waitcnt lgkmcnt(8)
    v_mfma_f32_16x16x32_f16 v[16:19], v[40:43], v[44:47], v[16:19]
    ds_read_b128 v[80:83], v5 offset:2816
    s_waitcnt lgkmcnt(8)
    v_mfma_f32_16x16x32_f16 v[20:23], v[40:43], v[48:51], v[20:23]
    ds_read_b128 v[84:87], v5 offset:3328
    ds_read_b128 v[40:43], v2 offset:320
    s_waitcnt lgkmcnt(8)
    v_mfma_f32_16x16x32_f16 v[16:19], v[52:55], v[56:59], v[16:19]
    ds_read_b128 v[44:47], v5 offset:2752
    s_waitcnt lgkmcnt(8)
    v_mfma_f32_16x16x32_f16 v[20:23], v[52:55], v[60:63], v[20:23]
    ds_read_b128 v[48:51], v5 offset:3264
    ds_read_b128 v[52:55], v2 offset:256
    s_waitcnt lgkmcnt(8)
    v_mfma_f32_16x16x32_f16 v[16:19], v[64:67], v[68:71], v[16:19]
    ds_read_b128 v[56:59], v5 offset:2688
    s_waitcnt lgkmcnt(8)
    v_mfma_f32_16x16x32_f16 v[20:23], v[64:67], v[72:75], v[20:23]
    ds_read_b128 v[60:63], v5 offset:3200
    ds_read_b128 v[64:67], v2 offset:192
    s_waitcnt lgkmcnt(8)
    v_mfma_f32_16x16x32_f16 v[16:19], v[76:79], v[80:83], v[16:19]
    ds_read_b128 v[68:71], v5 offset:2624
    s_waitcnt lgkmcnt(8)
    v_mfma_f32_16x16x32_f16 v[20:23], v[76:79], v[84:87], v[20:23]
    ds_read_b128 v[72:75], v5 offset:3136
    ds_read_b128 v[76:79], v2 offset:128
    s_waitcnt lgkmcnt(8)
    v_mfma_f32_16x16x32_f16 v[16:19], v[40:43], v[44:47], v[16:19]
    ds_read_b128 v[80:83], v5 offset:2560
    s_waitcnt lgkmcnt(8)
    v_mfma_f32_16x16x32_f16 v[20:23], v[40:43], v[48:51], v[20:23]
    ds_read_b128 v[84:87], v5 offset:3072
    ds_read_b128 v[40:43], v2 offset:64
    s_waitcnt lgkmcnt(8)
    v_mfma_f32_16x16x32_f16 v[16:19], v[52:55], v[56:59], v[16:19]
    ds_read_b128 v[44:47], v5 offset:2496
    s_waitcnt lgkmcnt(8)
    v_mfma_f32_16x16x32_f16 v[20:23], v[52:55], v[60:63], v[20:23]
    ds_read_b128 v[48:51], v5 offset:3008
    ds_read_b128 v[52:55], v2 offset:0
    s_waitcnt lgkmcnt(8)
    v_mfma_f32_16x16x32_f16 v[16:19], v[64:67], v[68:71], v[16:19]
    ds_read_b128 v[56:59], v5 offset:1472
    s_waitcnt lgkmcnt(8)
    v_mfma_f32_16x16x32_f16 v[20:23], v[64:67], v[72:75], v[20:23]
    ds_read_b128 v[60:63], v5 offset:1984
    ds_read_b128 v[64:67], v4 offset:128
    s_waitcnt lgkmcnt(8)
    v_mfma_f32_16x16x32_f16 v[16:19], v[76:79], v[80:83], v[16:19]
    ds_read_b64_tr_b16 v[68:69], v6 offset:6664
    ds_read_b64_tr_b16 v[70:71], v6 offset:6728
    s_waitcnt lgkmcnt(9)
    v_mfma_f32_16x16x32_f16 v[20:23], v[76:79], v[84:87], v[20:23]
    ds_read_b64_tr_b16 v[72:73], v6 offset:7176
    ds_read_b64_tr_b16 v[74:75], v6 offset:7240
    ds_read_b128 v[76:79], v4 offset:64
    s_waitcnt lgkmcnt(10)
    v_mfma_f32_16x16x32_f16 v[16:19], v[40:43], v[44:47], v[16:19]
    ds_read_b64_tr_b16 v[80:81], v6 offset:6152
    ds_read_b64_tr_b16 v[82:83], v6 offset:6216
    s_waitcnt lgkmcnt(11)
    v_mfma_f32_16x16x32_f16 v[20:23], v[40:43], v[48:51], v[20:23]
    ds_read_b64_tr_b16 v[84:85], v6 offset:6664
    ds_read_b64_tr_b16 v[86:87], v6 offset:6728
    ds_read_b128 v[40:43], v4 offset:0
    s_waitcnt lgkmcnt(12)
    v_mfma_f32_16x16x32_f16 v[16:19], v[52:55], v[56:59], v[16:19]
    s_waitcnt lgkmcnt(11)
    v_mfma_f32_16x16x32_f16 v[20:23], v[52:55], v[60:63], v[20:23]
    ds_read_b64_tr_b16 v[44:45], v6 offset:5640
    ds_read_b64_tr_b16 v[46:47], v6 offset:5704
    ds_read_b64_tr_b16 v[48:49], v6 offset:6152
    ds_read_b64_tr_b16 v[50:51], v6 offset:6216
    s_waitcnt lgkmcnt(12)
    v_mfma_f32_16x16x32_f16 v[16:19], v[68:71], v[64:67], v[16:19]
    ds_read_b128 v[52:55], v4 offset:368
    s_waitcnt lgkmcnt(11)
    v_mfma_f32_16x16x32_f16 v[20:23], v[72:75], v[64:67], v[20:23]
    ds_read_b64_tr_b16 v[56:57], v6 offset:9776
    ds_read_b64_tr_b16 v[58:59], v6 offset:9840
    ds_read_b64_tr_b16 v[60:61], v6 offset:10288
    ds_read_b64_tr_b16 v[62:63], v6 offset:10352
    s_waitcnt lgkmcnt(12)
    v_mfma_f32_16x16x32_f16 v[16:19], v[80:83], v[76:79], v[16:19]
    ds_read_b128 v[64:67], v4 offset:304
    s_waitcnt lgkmcnt(11)
    v_mfma_f32_16x16x32_f16 v[20:23], v[84:87], v[76:79], v[20:23]
    ds_read_b64_tr_b16 v[68:69], v6 offset:9264
    ds_read_b64_tr_b16 v[70:71], v6 offset:9328
    ds_read_b64_tr_b16 v[72:73], v6 offset:9776
    ds_read_b64_tr_b16 v[74:75], v6 offset:9840
    s_waitcnt lgkmcnt(12)
    v_mfma_f32_16x16x32_f16 v[16:19], v[44:47], v[40:43], v[16:19]
    ds_read_b128 v[76:79], v4 offset:240
    s_waitcnt lgkmcnt(11)
    v_mfma_f32_16x16x32_f16 v[20:23], v[48:51], v[40:43], v[20:23]
    ds_read_b64_tr_b16 v[80:81], v6 offset:8752
    ds_read_b64_tr_b16 v[82:83], v6 offset:8816
    ds_read_b64_tr_b16 v[84:85], v6 offset:9264
    ds_read_b64_tr_b16 v[86:87], v6 offset:9328
    s_waitcnt lgkmcnt(12)
    v_mfma_f32_16x16x32_f16 v[16:19], v[56:59], v[52:55], v[16:19]
    ds_read_b128 v[40:43], v3 offset:1264
    s_waitcnt lgkmcnt(11)
    v_mfma_f32_16x16x32_f16 v[20:23], v[60:63], v[52:55], v[20:23]
    ds_read_b64_tr_b16 v[44:45], v7 offset:11848
    ds_read_b64_tr_b16 v[46:47], v7 offset:11976
    ds_read_b128 v[48:51], v3 offset:1232
    s_waitcnt lgkmcnt(11)
    v_mfma_f32_16x16x32_f16 v[16:19], v[68:71], v[64:67], v[16:19]
    ds_read_b64_tr_b16 v[52:53], v7 offset:11848
    ds_read_b64_tr_b16 v[54:55], v7 offset:11976
    ds_read_b128 v[56:59], v3 offset:1200
    s_waitcnt lgkmcnt(12)
    v_mfma_f32_16x16x32_f16 v[20:23], v[72:75], v[64:67], v[20:23]
    ds_read_b64_tr_b16 v[60:61], v7 offset:10824
    ds_read_b64_tr_b16 v[62:63], v7 offset:10952
    ds_read_b128 v[64:67], v3 offset:1168
    s_waitcnt lgkmcnt(12)
    v_mfma_f32_16x16x32_f16 v[16:19], v[80:83], v[76:79], v[16:19]
    ds_read_b64_tr_b16 v[68:69], v7 offset:10824
    ds_read_b64_tr_b16 v[70:71], v7 offset:10952
    s_waitcnt lgkmcnt(12)
    v_mfma_f32_16x16x32_f16 v[20:23], v[84:87], v[76:79], v[20:23]
    ds_read_b128 v[72:75], v3 offset:1440
    ds_read_b64_tr_b16 v[76:77], v7 offset:13944
    ds_read_b64_tr_b16 v[78:79], v7 offset:14072
    s_waitcnt lgkmcnt(12)
    v_mfma_f32_16x16x32_f16 v[16:19], v[44:47], v[40:43], v[16:19]
    ds_read_b128 v[80:83], v3 offset:1408
    ds_read_b64_tr_b16 v[84:85], v7 offset:13944
    ds_read_b64_tr_b16 v[86:87], v7 offset:14072
    s_waitcnt lgkmcnt(12)
    v_mfma_f32_16x16x32_f16 v[20:23], v[52:55], v[48:51], v[20:23]
    ds_read_b128 v[40:43], v3 offset:1376
    ds_read_b64_tr_b16 v[44:45], v7 offset:12920
    ds_read_b64_tr_b16 v[46:47], v7 offset:13048
    s_waitcnt lgkmcnt(12)
    v_mfma_f32_16x16x32_f16 v[16:19], v[60:63], v[56:59], v[16:19]
    ds_read_b128 v[48:51], v3 offset:1344
    ds_read_b64_tr_b16 v[52:53], v7 offset:12920
    ds_read_b64_tr_b16 v[54:55], v7 offset:13048
    s_waitcnt lgkmcnt(12)
    v_mfma_f32_16x16x32_f16 v[20:23], v[68:71], v[64:67], v[20:23]
    s_waitcnt lgkmcnt(9)
    v_mfma_f32_16x16x32_f16 v[16:19], v[76:79], v[72:75], v[16:19]
    s_waitcnt lgkmcnt(6)
    v_mfma_f32_16x16x32_f16 v[20:23], v[84:87], v[80:83], v[20:23]
    s_waitcnt lgkmcnt(3)
    v_mfma_f32_16x16x32_f16 v[16:19], v[44:47], v[40:43], v[16:19]
    s_waitcnt lgkmcnt(0)
    v_mfma_f32_16x16x32_f16 v[20:23], v[52:55], v[48:51], v[20:23]
    ds_read_b64 v[88:89], v8 offset:3072
    ds_read_b64 v[90:91], v8 offset:3584
    s_nop 3
    v_mul_f32 v40, v16, v10
    v_mul_f32 v41, v17, v10
    v_mul_f32 v42, v18, v10
    v_mul_f32 v43, v19, v10
    v_mul_f32 v44, v20, v10
    v_mul_f32 v45, v21, v10
    v_mul_f32 v46, v22, v10
    v_mul_f32 v47, v23, v10
    v_cvt_pk_bf16_f32 v72, v40, v41
    v_cvt_pk_bf16_f32 v73, v42, v43
    v_cvt_pk_bf16_f32 v74, v44, v45
    v_cvt_pk_bf16_f32 v75, v46, v47
    v_lshlrev_b32 v40, 16, v72
    v_and_b32 v41, 0xffff0000, v72
    v_lshlrev_b32 v42, 16, v73
    v_and_b32 v43, 0xffff0000, v73
    v_lshlrev_b32 v44, 16, v74
    v_and_b32 v45, 0xffff0000, v74
    v_lshlrev_b32 v46, 16, v75
    v_and_b32 v47, 0xffff0000, v75
    s_waitcnt vmcnt(0) lgkmcnt(0)
    v_fma_mix_f32 v56, v88, v11, 0 op_sel:[0,0,0] op_sel_hi:[1,0,0]
    v_fma_mix_f32 v57, v88, v11, 0 op_sel:[1,0,0] op_sel_hi:[1,0,0]
    v_fma_mix_f32 v58, v89, v11, 0 op_sel:[0,0,0] op_sel_hi:[1,0,0]
    v_fma_mix_f32 v59, v89, v11, 0 op_sel:[1,0,0] op_sel_hi:[1,0,0]
    v_fma_mix_f32 v60, v90, v11, 0 op_sel:[0,0,0] op_sel_hi:[1,0,0]
    v_fma_mix_f32 v61, v90, v11, 0 op_sel:[1,0,0] op_sel_hi:[1,0,0]
    v_fma_mix_f32 v62, v91, v11, 0 op_sel:[0,0,0] op_sel_hi:[1,0,0]
    v_fma_mix_f32 v63, v91, v11, 0 op_sel:[1,0,0] op_sel_hi:[1,0,0]
    v_cvt_pk_bf16_f32 v72, v56, v57
    v_cvt_pk_bf16_f32 v73, v58, v59
    v_cvt_pk_bf16_f32 v74, v60, v61
    v_cvt_pk_bf16_f32 v75, v62, v63
    v_lshlrev_b32 v56, 16, v72
    v_and_b32 v57, 0xffff0000, v72
    v_lshlrev_b32 v58, 16, v73
    v_and_b32 v59, 0xffff0000, v73
    v_lshlrev_b32 v60, 16, v74
    v_and_b32 v61, 0xffff0000, v74
    v_lshlrev_b32 v62, 16, v75
    v_and_b32 v63, 0xffff0000, v75
    v_add_f32 v40, v40, v56
    v_add_f32 v41, v41, v57
    v_add_f32 v42, v42, v58
    v_add_f32 v43, v43, v59
    v_add_f32 v44, v44, v60
    v_add_f32 v45, v45, v61
    v_add_f32 v46, v46, v62
    v_add_f32 v47, v47, v63
    v_cvt_pk_bf16_f32 v72, v40, v41
    v_cvt_pk_bf16_f32 v73, v42, v43
    v_cvt_pk_bf16_f32 v74, v44, v45
    v_cvt_pk_bf16_f32 v75, v46, v47
    v_lshlrev_b32 v40, 16, v72
    v_and_b32 v41, 0xffff0000, v72
    v_lshlrev_b32 v42, 16, v73
    v_and_b32 v43, 0xffff0000, v73
    v_lshlrev_b32 v56, 16, v32
    v_and_b32 v57, 0xffff0000, v32
    v_lshlrev_b32 v58, 16, v33
    v_and_b32 v59, 0xffff0000, v33
    v_lshlrev_b32 v44, 16, v74
    v_and_b32 v45, 0xffff0000, v74
    v_lshlrev_b32 v46, 16, v75
    v_and_b32 v47, 0xffff0000, v75
    v_lshlrev_b32 v60, 16, v34
    v_and_b32 v61, 0xffff0000, v34
    v_lshlrev_b32 v62, 16, v35
    v_and_b32 v63, 0xffff0000, v35
    v_add_f32 v40, v40, v56
    v_add_f32 v41, v41, v57
    v_add_f32 v42, v42, v58
    v_add_f32 v43, v43, v59
    v_add_f32 v44, v44, v60
    v_add_f32 v45, v45, v61
    v_add_f32 v46, v46, v62
    v_add_f32 v47, v47, v63
    v_cvt_pk_bf16_f32 v72, v40, v41
    v_cvt_pk_bf16_f32 v73, v42, v43
    v_cvt_pk_bf16_f32 v74, v44, v45
    v_cvt_pk_bf16_f32 v75, v46, v47
    s_cmp_eq_u32 s7, 1
    s_cbranch_scc1 L_fin16
    s_add_u32 s50, s32, 10485760
    s_addc_u32 s51, s33, 0
    global_store_dwordx2 v9, v[72:73], s[50:51] offset:3072 sc1
    global_store_dwordx2 v9, v[74:75], s[50:51] offset:3584 sc1
    s_branch L_b_done
L_fin16:
    v_add_u32 v12, 1966080, v13
    global_store_short v12, v72, s[28:29] offset:0
    global_store_short_d16_hi v12, v72, s[28:29] offset:1280
    global_store_short v12, v73, s[28:29] offset:2560
    global_store_short_d16_hi v12, v73, s[28:29] offset:3840
    v_add_u32 v12, 2293760, v13
    global_store_short v12, v74, s[28:29] offset:0
    global_store_short_d16_hi v12, v74, s[28:29] offset:1280
    global_store_short v12, v75, s[28:29] offset:2560
    global_store_short_d16_hi v12, v75, s[28:29] offset:3840
    s_branch L_b_done
L_b_done:
    s_cmp_eq_u32 s7, 1
    s_cbranch_scc1 L_fin
    s_waitcnt vmcnt(0)
    s_barrier
    s_cmp_eq_u32 s3, 0
    s_cbranch_scc0 L_x_np
    s_lshl_b32 s42, s2, 7
    s_add_u32 s42, s42, 102400
    v_mov_b32 v2, s42
    v_mov_b32 v4, s34
    v_mov_b32 v5, s35
    s_mov_b64 exec, 1
    global_store_dwordx2 v2, v[4:5], s[32:33] sc1
    s_mov_b64 exec, -1
L_x_np:
    s_mov_b32 s7, 1
    s_mov_b32 s40, 98304
    s_mov_b32 s41, 2621440
    v_and_b32 v16, 15, v1
    v_lshrrev_b32 v17, 4, v1
    v_lshrrev_b32 v18, 2, v16
    v_and_b32 v19, 3, v1
    s_and_b32 s42, s3, 3
    s_lshr_b32 s43, s3, 2
    s_mul_i32 s43, s43, 48
    s_mul_i32 s44, s4, 80
    s_add_u32 s43, s43, s44
    v_mov_b32 v10, 0x3f803f80
    v_mov_b32 v11, 0x3f803f80
    v_mov_b32 v12, 0x3f803f80
    v_mov_b32 v13, 0x3f803f80
    v_lshl_add_u32 v20, v17, 2, v18
    v_mul_u32_u24 v20, 160, v20
    v_add_u32 v20, 61440, v20
    v_lshl_add_u32 v2, v19, 3, v20
    v_add_u32 v3, 61440, v2
    s_lshl_b32 s44, s42, 5
    s_add_u32 s44, s44, 61472
    v_lshl_add_u32 v20, v17, 3, s44
    s_lshl_b32 s44, s6, 5
    v_add_u32 v21, 0, v16
    v_add_u32 v21, s43, v21
    v_min_u32 v21, 639, v21
    v_xor_b32 v21, s44, v21
    v_and_b32 v22, 0x3e3, v21
    v_bfe_u32 v23, v21, 3, 2
    v_lshl_or_b32 v22, v23, 2, v22
    v_and_b32 v22, 0x3ef, v22
    v_bfe_u32 v23, v21, 2, 1
    v_lshl_or_b32 v22, v23, 4, v22
    v_mul_u32_u24 v22, 160, v22
    v_add_u32 v7, v22, v20
    v_add_u32 v21, 16, v16
    v_add_u32 v21, s43, v21
    v_min_u32 v21, 639, v21
    v_xor_b32 v21, s44, v21
    v_and_b32 v22, 0x3e3, v21
    v_bfe_u32 v23, v21, 3, 2
    v_lshl_or_b32 v22, v23, 2, v22
    v_and_b32 v22, 0x3ef, v22
    v_bfe_u32 v23, v21, 2, 1
    v_lshl_or_b32 v22, v23, 4, v22
    v_mul_u32_u24 v22, 160, v22
    v_add_u32 v8, v22, v20
    v_add_u32 v21, 32, v16
    v_add_u32 v21, s43, v21
    v_min_u32 v21, 639, v21
    v_xor_b32 v21, s44, v21
    v_and_b32 v22, 0x3e3, v21
    v_bfe_u32 v23, v21, 3, 2
    v_lshl_or_b32 v22, v23, 2, v22
    v_and_b32 v22, 0x3ef, v22
    v_bfe_u32 v23, v21, 2, 1
    v_lshl_or_b32 v22, v23, 4, v22
    v_mul_u32_u24 v22, 160, v22
    v_add_u32 v9, v22, v20
    v_add_u32 v24, 0, v1
    v_mul_u32_u24 v29, 205, v24
    v_lshrrev_b32 v29, 11, v29
    v_mul_u32_u24 v30, 10, v29
    v_sub_u32 v24, v24, v30
    v_and_b32 v30, 3, v29
    v_bfe_u32 v31, v29, 2, 2
    v_lshl_or_b32 v30, v31, 3, v30
    v_lshrrev_b32 v31, 4, v29
    v_lshl_or_b32 v30, v31, 2, v30
    v_mul_u32_u24 v30, 4096, v30
    v_lshl_add_u32 v24, v24, 4, v30
    v_add_u32 v25, 64, v1
    v_mul_u32_u24 v29, 205, v25
    v_lshrrev_b32 v29, 11, v29
    v_mul_u32_u24 v30, 10, v29
    v_sub_u32 v25, v25, v30
    v_and_b32 v30, 3, v29
    v_bfe_u32 v31, v29, 2, 2
    v_lshl_or_b32 v30, v31, 3, v30
    v_lshrrev_b32 v31, 4, v29
    v_lshl_or_b32 v30, v31, 2, v30
    v_mul_u32_u24 v30, 4096, v30
    v_lshl_add_u32 v25, v25, 4, v30
    v_add_u32 v26, 128, v1
    v_mul_u32_u24 v29, 205, v26
    v_lshrrev_b32 v29, 11, v29
    v_mul_u32_u24 v30, 10, v29
    v_sub_u32 v26, v26, v30
    v_and_b32 v30, 3, v29
    v_bfe_u32 v31, v29, 2, 2
    v_lshl_or_b32 v30, v31, 3, v30
    v_lshrrev_b32 v31, 4, v29
    v_lshl_or_b32 v30, v31, 2, v30
    v_mul_u32_u24 v30, 4096, v30
    v_lshl_add_u32 v26, v26, 4, v30
    v_add_u32 v27, 192, v1
    v_mul_u32_u24 v29, 205, v27
    v_lshrrev_b32 v29, 11, v29
    v_mul_u32_u24 v30, 10, v29
    v_sub_u32 v27, v27, v30
    v_and_b32 v30, 3, v29
    v_bfe_u32 v31, v29, 2, 2
    v_lshl_or_b32 v30, v31, 3, v30
    v_lshrrev_b32 v31, 4, v29
    v_lshl_or_b32 v30, v31, 2, v30
    v_mul_u32_u24 v30, 4096, v30
    v_lshl_add_u32 v27, v27, 4, v30
    v_add_u32 v28, 256, v1
    v_mul_u32_u24 v29, 205, v28
    v_lshrrev_b32 v29, 11, v29
    v_mul_u32_u24 v30, 10, v29
    v_sub_u32 v28, v28, v30
    v_and_b32 v30, 3, v29
    v_bfe_u32 v31, v29, 2, 2
    v_lshl_or_b32 v30, v31, 3, v30
    v_lshrrev_b32 v31, 4, v29
    v_lshl_or_b32 v30, v31, 2, v30
    v_mul_u32_u24 v30, 4096, v30
    v_lshl_add_u32 v28, v28, 4, v30
    s_cmp_eq_u32 s3, 0
    s_cbranch_scc0 L_x_go
    v_lshlrev_b32 v32, 7, v1
    v_add_u32 v32, 102400, v32
    v_add_u32 v33, 8192, v32
    v_add_u32 v34, 16384, v32
    v_add_u32 v35, 24576, v32
    s_mov_b32 s57, 0
L_poll17:
    global_load_dwordx2 v[36:37], v32, s[32:33] sc1
    global_load_dwordx2 v[38:39], v33, s[32:33] sc1
    global_load_dwordx2 v[40:41], v34, s[32:33] sc1
    global_load_dwordx2 v[42:43], v35, s[32:33] sc1
    s_add_u32 s57, s57, 1
    s_waitcnt vmcnt(0)
    v_cmp_ne_u64 vcc, s[34:35], v[36:37]
    v_cmp_ne_u64 s[54:55], s[34:35], v[38:39]
    s_nop 1
    s_or_b64 vcc, vcc, s[54:55]
    v_cmp_ne_u64 s[54:55], s[34:35], v[40:41]
    s_nop 1
    s_or_b64 vcc, vcc, s[54:55]
    v_cmp_ne_u64 s[54:55], s[34:35], v[42:43]
    s_nop 1
    s_or_b64 vcc, vcc, s[54:55]
    s_cmp_gt_u32 s57, 200000
    s_cbranch_scc1 L_end
    s_cbranch_vccnz L_poll17
L_x_go:
    s_barrier
    s_lshl_b32 s42, s5, 7
    s_add_u32 s42, s42, 19922912
    s_cmp_eq_u32 s3, 1
    s_cbranch_scc1 L_x2d1
    s_cmp_eq_u32 s3, 2
    s_cbranch_scc1 L_x2d2
    s_cmp_eq_u32 s3, 3
    s_cbranch_scc1 L_x2d3
    s_cmp_eq_u32 s3, 4
    s_cbranch_scc1 L_x2d4
    s_cmp_eq_u32 s3, 5
    s_cbranch_scc1 L_x2d5
    s_cmp_eq_u32 s3, 6
    s_cbranch_scc1 L_x2d6
    s_cmp_eq_u32 s3, 7
    s_cbranch_scc1 L_x2d7
    s_xor_b32 s43, s6, 0
    s_mov_b32 m0, 61440
    s_lshl_b32 s43, s43, 17
    s_add_u32 s43, s43, s42
    s_add_u32 s44, s32, s43
    s_addc_u32 s45, s33, 0
    global_load_lds_dwordx4 v24, s[44:45] sc1
    s_xor_b32 s43, s6, 1
    s_mov_b32 m0, 69632
    s_lshl_b32 s43, s43, 17
    s_add_u32 s43, s43, s42
    s_add_u32 s44, s32, s43
    s_addc_u32 s45, s33, 0
    global_load_lds_dwordx4 v27, s[44:45] sc1
    s_xor_b32 s43, s6, 3
    s_mov_b32 m0, 77824
    s_lshl_b32 s43, s43, 17
    s_add_u32 s43, s43, s42
    s_add_u32 s44, s32, s43
    s_addc_u32 s45, s33, 0
    global_load_lds_dwordx4 v25, s[44:45] sc1
    s_xor_b32 s43, s6, 4
    s_mov_b32 m0, 86016
    s_lshl_b32 s43, s43, 17
    s_add_u32 s43, s43, s42
    s_add_u32 s44, s32, s43
    s_addc_u32 s45, s33, 0
    global_load_lds_dwordx4 v28, s[44:45] sc1
    s_xor_b32 s43, s6, 6
    s_mov_b32 m0, 94208
    s_lshl_b32 s43, s43, 17
    s_add_u32 s43, s43, s42
    s_add_u32 s44, s32, s43
    s_addc_u32 s45, s33, 0
    global_load_lds_dwordx4 v26, s[44:45] sc1
    s_xor_b32 s43, s6, 8
    s_mov_b32 m0, 102400
    s_lshl_b32 s43, s43, 17
    s_add_u32 s43, s43, s42
    s_add_u32 s44, s32, s43
    s_addc_u32 s45, s33, 0
    global_load_lds_dwordx4 v24, s[44:45] sc1
    s_xor_b32 s43, s6, 9
    s_mov_b32 m0, 110592
    s_lshl_b32 s43, s43, 17
    s_add_u32 s43, s43, s42
    s_add_u32 s44, s32, s43
    s_addc_u32 s45, s33, 0
    global_load_lds_dwordx4 v27, s[44:45] sc1
    s_xor_b32 s43, s6, 11
    s_mov_b32 m0, 118784
    s_lshl_b32 s43, s43, 17
    s_add_u32 s43, s43, s42
    s_add_u32 s44, s32, s43
    s_addc_u32 s45, s33, 0
    global_load_lds_dwordx4 v25, s[44:45] sc1
    s_xor_b32 s43, s6, 12
    s_mov_b32 m0, 126976
    s_lshl_b32 s43, s43, 17
    s_add_u32 s43, s43, s42
    s_add_u32 s44, s32, s43
    s_addc_u32 s45, s33, 0
    global_load_lds_dwordx4 v28, s[44:45] sc1
    s_xor_b32 s43, s6, 14
    s_mov_b32 m0, 135168
    s_lshl_b32 s43, s43, 17
    s_add_u32 s43, s43, s42
    s_add_u32 s44, s32, s43
    s_addc_u32 s45, s33, 0
    global_load_lds_dwordx4 v26, s[44:45] sc1
    s_xor_b32 s43, s6, 16
    s_mov_b32 m0, 143360
    s_lshl_b32 s43, s43, 17
    s_add_u32 s43, s43, s42
    s_add_u32 s44, s32, s43
    s_addc_u32 s45, s33, 0
    global_load_lds_dwordx4 v24, s[44:45] sc1
    s_xor_b32 s43, s6, 17
    s_mov_b32 m0, 151552
    s_lshl_b32 s43, s43, 17
    s_add_u32 s43, s43, s42
    s_add_u32 s44, s32, s43
    s_addc_u32 s45, s33, 0
    global_load_lds_dwordx4 v27, s[44:45] sc1
    s_xor_b32 s43, s6, 19
    s_mov_b32 m0, 159744
    s_lshl_b32 s43, s43, 17
    s_add_u32 s43, s43, s42
    s_add_u32 s44, s32, s43
    s_addc_u32 s45, s33, 0
    global_load_lds_dwordx4 v25, s[44:45] sc1
    s_branch L_x2d_done
L_x2d1:
    s_xor_b32 s43, s6, 0
    s_mov_b32 m0, 62464
    s_lshl_b32 s43, s43, 17
    s_add_u32 s43, s43, s42
    s_add_u32 s44, s32, s43
    s_addc_u32 s45, s33, 0
    global_load_lds_dwordx4 v25, s[44:45] sc1
    s_xor_b32 s43, s6, 1
    s_mov_b32 m0, 70656
    s_lshl_b32 s43, s43, 17
    s_add_u32 s43, s43, s42
    s_add_u32 s44, s32, s43
    s_addc_u32 s45, s33, 0
    global_load_lds_dwordx4 v28, s[44:45] sc1
    s_xor_b32 s43, s6, 3
    s_mov_b32 m0, 78848
    s_lshl_b32 s43, s43, 17
    s_add_u32 s43, s43, s42
    s_add_u32 s44, s32, s43
    s_addc_u32 s45, s33, 0
    global_load_lds_dwordx4 v26, s[44:45] sc1
    s_xor_b32 s43, s6, 5
    s_mov_b32 m0, 87040
    s_lshl_b32 s43, s43, 17
    s_add_u32 s43, s43, s42
    s_add_u32 s44, s32, s43
    s_addc_u32 s45, s33, 0
    global_load_lds_dwordx4 v24, s[44:45] sc1
    s_xor_b32 s43, s6, 6
    s_mov_b32 m0, 95232
    s_lshl_b32 s43, s43, 17
    s_add_u32 s43, s43, s42
    s_add_u32 s44, s32, s43
    s_addc_u32 s45, s33, 0
    global_load_lds_dwordx4 v27, s[44:45] sc1
    s_xor_b32 s43, s6, 8
    s_mov_b32 m0, 103424
    s_lshl_b32 s43, s43, 17
    s_add_u32 s43, s43, s42
    s_add_u32 s44, s32, s43
    s_addc_u32 s45, s33, 0
    global_load_lds_dwordx4 v25, s[44:45] sc1
    s_xor_b32 s43, s6, 9
    s_mov_b32 m0, 111616
    s_lshl_b32 s43, s43, 17
    s_add_u32 s43, s43, s42
    s_add_u32 s44, s32, s43
    s_addc_u32 s45, s33, 0
    global_load_lds_dwordx4 v28, s[44:45] sc1
    s_xor_b32 s43, s6, 11
    s_mov_b32 m0, 119808
    s_lshl_b32 s43, s43, 17
    s_add_u32 s43, s43, s42
    s_add_u32 s44, s32, s43
    s_addc_u32 s45, s33, 0
    global_load_lds_dwordx4 v26, s[44:45] sc1
    s_xor_b32 s43, s6, 13
    s_mov_b32 m0, 128000
    s_lshl_b32 s43, s43, 17
    s_add_u32 s43, s43, s42
    s_add_u32 s44, s32, s43
    s_addc_u32 s45, s33, 0
    global_load_lds_dwordx4 v24, s[44:45] sc1
    s_xor_b32 s43, s6, 14
    s_mov_b32 m0, 136192
    s_lshl_b32 s43, s43, 17
    s_add_u32 s43, s43, s42
    s_add_u32 s44, s32, s43
    s_addc_u32 s45, s33, 0
    global_load_lds_dwordx4 v27, s[44:45] sc1
    s_xor_b32 s43, s6, 16
    s_mov_b32 m0, 144384
    s_lshl_b32 s43, s43, 17
    s_add_u32 s43, s43, s42
    s_add_u32 s44, s32, s43
    s_addc_u32 s45, s33, 0
    global_load_lds_dwordx4 v25, s[44:45] sc1
    s_xor_b32 s43, s6, 17
    s_mov_b32 m0, 152576
    s_lshl_b32 s43, s43, 17
    s_add_u32 s43, s43, s42
    s_add_u32 s44, s32, s43
    s_addc_u32 s45, s33, 0
    global_load_lds_dwordx4 v28, s[44:45] sc1
    s_xor_b32 s43, s6, 19
    s_mov_b32 m0, 160768
    s_lshl_b32 s43, s43, 17
    s_add_u32 s43, s43, s42
    s_add_u32 s44, s32, s43
    s_addc_u32 s45, s33, 0
    global_load_lds_dwordx4 v26, s[44:45] sc1
    s_branch L_x2d_done
L_x2d2:
    s_xor_b32 s43, s6, 0
    s_mov_b32 m0, 63488
    s_lshl_b32 s43, s43, 17
    s_add_u32 s43, s43, s42
    s_add_u32 s44, s32, s43
    s_addc_u32 s45, s33, 0
    global_load_lds_dwordx4 v26, s[44:45] sc1
    s_xor_b32 s43, s6, 2
    s_mov_b32 m0, 71680
    s_lshl_b32 s43, s43, 17
    s_add_u32 s43, s43, s42
    s_add_u32 s44, s32, s43
    s_addc_u32 s45, s33, 0
    global_load_lds_dwordx4 v24, s[44:45] sc1
    s_xor_b32 s43, s6, 3
    s_mov_b32 m0, 79872
    s_lshl_b32 s43, s43, 17
    s_add_u32 s43, s43, s42
    s_add_u32 s44, s32, s43
    s_addc_u32 s45, s33, 0
    global_load_lds_dwordx4 v27, s[44:45] sc1
    s_xor_b32 s43, s6, 5
    s_mov_b32 m0, 88064
    s_lshl_b32 s43, s43, 17
    s_add_u32 s43, s43, s42
    s_add_u32 s44, s32, s43
    s_addc_u32 s45, s33, 0
    global_load_lds_dwordx4 v25, s[44:45] sc1
    s_xor_b32 s43, s6, 6
    s_mov_b32 m0, 96256
    s_lshl_b32 s43, s43, 17
    s_add_u32 s43, s43, s42
    s_add_u32 s44, s32, s43
    s_addc_u32 s45, s33, 0
    global_load_lds_dwordx4 v28, s[44:45] sc1
    s_xor_b32 s43, s6, 8
    s_mov_b32 m0, 104448
    s_lshl_b32 s43, s43, 17
    s_add_u32 s43, s43, s42
    s_add_u32 s44, s32, s43
    s_addc_u32 s45, s33, 0
    global_load_lds_dwordx4 v26, s[44:45] sc1
    s_xor_b32 s43, s6, 10
    s_mov_b32 m0, 112640
    s_lshl_b32 s43, s43, 17
    s_add_u32 s43, s43, s42
    s_add_u32 s44, s32, s43
    s_addc_u32 s45, s33, 0
    global_load_lds_dwordx4 v24, s[44:45] sc1
    s_xor_b32 s43, s6, 11
    s_mov_b32 m0, 120832
    s_lshl_b32 s43, s43, 17
    s_add_u32 s43, s43, s42
    s_add_u32 s44, s32, s43
    s_addc_u32 s45, s33, 0
    global_load_lds_dwordx4 v27, s[44:45] sc1
    s_xor_b32 s43, s6, 13
    s_mov_b32 m0, 129024
    s_lshl_b32 s43, s43, 17
    s_add_u32 s43, s43, s42
    s_add_u32 s44, s32, s43
    s_addc_u32 s45, s33, 0
    global_load_lds_dwordx4 v25, s[44:45] sc1
    s_xor_b32 s43, s6, 14
    s_mov_b32 m0, 137216
    s_lshl_b32 s43, s43, 17
    s_add_u32 s43, s43, s42
    s_add_u32 s44, s32, s43
    s_addc_u32 s45, s33, 0
    global_load_lds_dwordx4 v28, s[44:45] sc1
    s_xor_b32 s43, s6, 16
    s_mov_b32 m0, 145408
    s_lshl_b32 s43, s43, 17
    s_add_u32 s43, s43, s42
    s_add_u32 s44, s32, s43
    s_addc_u32 s45, s33, 0
    global_load_lds_dwordx4 v26, s[44:45] sc1
    s_xor_b32 s43, s6, 18
    s_mov_b32 m0, 153600
    s_lshl_b32 s43, s43, 17
    s_add_u32 s43, s43, s42
    s_add_u32 s44, s32, s43
    s_addc_u32 s45, s33, 0
    global_load_lds_dwordx4 v24, s[44:45] sc1
    s_xor_b32 s43, s6, 19
    s_mov_b32 m0, 161792
    s_lshl_b32 s43, s43, 17
    s_add_u32 s43, s43, s42
    s_add_u32 s44, s32, s43
    s_addc_u32 s45, s33, 0
    global_load_lds_dwordx4 v27, s[44:45] sc1
    s_branch L_x2d_done
L_x2d3:
    s_xor_b32 s43, s6, 0
    s_mov_b32 m0, 64512
    s_lshl_b32 s43, s43, 17
    s_add_u32 s43, s43, s42
    s_add_u32 s44, s32, s43
    s_addc_u32 s45, s33, 0
    global_load_lds_dwordx4 v27, s[44:45] sc1
    s_xor_b32 s43, s6, 2
    s_mov_b32 m0, 72704
    s_lshl_b32 s43, s43, 17
    s_add_u32 s43, s43, s42
    s_add_u32 s44, s32, s43
    s_addc_u32 s45, s33, 0
    global_load_lds_dwordx4 v25, s[44:45] sc1
    s_xor_b32 s43, s6, 3
    s_mov_b32 m0, 80896
    s_lshl_b32 s43, s43, 17
    s_add_u32 s43, s43, s42
    s_add_u32 s44, s32, s43
    s_addc_u32 s45, s33, 0
    global_load_lds_dwordx4 v28, s[44:45] sc1
    s_xor_b32 s43, s6, 5
    s_mov_b32 m0, 89088
    s_lshl_b32 s43, s43, 17
    s_add_u32 s43, s43, s42
    s_add_u32 s44, s32, s43
    s_addc_u32 s45, s33, 0
    global_load_lds_dwordx4 v26, s[44:45] sc1
    s_xor_b32 s43, s6, 7
    s_mov_b32 m0, 97280
    s_lshl_b32 s43, s43, 17
    s_add_u32 s43, s43, s42
    s_add_u32 s44, s32, s43
    s_addc_u32 s45, s33, 0
    global_load_lds_dwordx4 v24, s[44:45] sc1
    s_xor_b32 s43, s6, 8
    s_mov_b32 m0, 105472
    s_lshl_b32 s43, s43, 17
    s_add_u32 s43, s43, s42
    s_add_u32 s44, s32, s43
    s_addc_u32 s45, s33, 0
    global_load_lds_dwordx4 v27, s[44:45] sc1
    s_xor_b32 s43, s6, 10
    s_mov_b32 m0, 113664
    s_lshl_b32 s43, s43, 17
    s_add_u32 s43, s43, s42
    s_add_u32 s44, s32, s43
    s_addc_u32 s45, s33, 0
    global_load_lds_dwordx4 v25, s[44:45] sc1
    s_xor_b32 s43, s6, 11
    s_mov_b32 m0, 121856
    s_lshl_b32 s43, s43, 17
    s_add_u32 s43, s43, s42
    s_add_u32 s44, s32, s43
    s_addc_u32 s45, s33, 0
    global_load_lds_dwordx4 v28, s[44:45] sc1
    s_xor_b32 s43, s6, 13
    s_mov_b32 m0, 130048
    s_lshl_b32 s43, s43, 17
    s_add_u32 s43, s43, s42
    s_add_u32 s44, s32, s43
    s_addc_u32 s45, s33, 0
    global_load_lds_dwordx4 v26, s[44:45] sc1
    s_xor_b32 s43, s6, 15
    s_mov_b32 m0, 138240
    s_lshl_b32 s43, s43, 17
    s_add_u32 s43, s43, s42
    s_add_u32 s44, s32, s43
    s_addc_u32 s45, s33, 0
    global_load_lds_dwordx4 v24, s[44:45] sc1
    s_xor_b32 s43, s6, 16
    s_mov_b32 m0, 146432
    s_lshl_b32 s43, s43, 17
    s_add_u32 s43, s43, s42
    s_add_u32 s44, s32, s43
    s_addc_u32 s45, s33, 0
    global_load_lds_dwordx4 v27, s[44:45] sc1
    s_xor_b32 s43, s6, 18
    s_mov_b32 m0, 154624
    s_lshl_b32 s43, s43, 17
    s_add_u32 s43, s43, s42
    s_add_u32 s44, s32, s43
    s_addc_u32 s45, s33, 0
    global_load_lds_dwordx4 v25, s[44:45] sc1
    s_xor_b32 s43, s6, 19
    s_mov_b32 m0, 162816
    s_lshl_b32 s43, s43, 17
    s_add_u32 s43, s43, s42
    s_add_u32 s44, s32, s43
    s_addc_u32 s45, s33, 0
    global_load_lds_dwordx4 v28, s[44:45] sc1
    s_branch L_x2d_done
L_x2d4:
    s_xor_b32 s43, s6, 0
    s_mov_b32 m0, 65536
    s_lshl_b32 s43, s43, 17
    s_add_u32 s43, s43, s42
    s_add_u32 s44, s32, s43
    s_addc_u32 s45, s33, 0
    global_load_lds_dwordx4 v28, s[44:45] sc1
    s_xor_b32 s43, s6, 2
    s_mov_b32 m0, 73728
    s_lshl_b32 s43, s43, 17
    s_add_u32 s43, s43, s42
    s_add_u32 s44, s32, s43
    s_addc_u32 s45, s33, 0
    global_load_lds_dwordx4 v26, s[44:45] sc1
    s_xor_b32 s43, s6, 4
    s_mov_b32 m0, 81920
    s_lshl_b32 s43, s43, 17
    s_add_u32 s43, s43, s42
    s_add_u32 s44, s32, s43
    s_addc_u32 s45, s33, 0
    global_load_lds_dwordx4 v24, s[44:45] sc1
    s_xor_b32 s43, s6, 5
    s_mov_b32 m0, 90112
    s_lshl_b32 s43, s43, 17
    s_add_u32 s43, s43, s42
    s_add_u32 s44, s32, s43
    s_addc_u32 s45, s33, 0
    global_load_lds_dwordx4 v27, s[44:45] sc1
    s_xor_b32 s43, s6, 7
    s_mov_b32 m0, 98304
    s_lshl_b32 s43, s43, 17
    s_add_u32 s43, s43, s42
    s_add_u32 s44, s32, s43
    s_addc_u32 s45, s33, 0
    global_load_lds_dwordx4 v25, s[44:45] sc1
    s_xor_b32 s43, s6, 8
    s_mov_b32 m0, 106496
    s_lshl_b32 s43, s43, 17
    s_add_u32 s43, s43, s42
    s_add_u32 s44, s32, s43
    s_addc_u32 s45, s33, 0
    global_load_lds_dwordx4 v28, s[44:45] sc1
    s_xor_b32 s43, s6, 10
    s_mov_b32 m0, 114688
    s_lshl_b32 s43, s43, 17
    s_add_u32 s43, s43, s42
    s_add_u32 s44, s32, s43
    s_addc_u32 s45, s33, 0
    global_load_lds_dwordx4 v26, s[44:45] sc1
    s_xor_b32 s43, s6, 12
    s_mov_b32 m0, 122880
    s_lshl_b32 s43, s43, 17
    s_add_u32 s43, s43, s42
    s_add_u32 s44, s32, s43
    s_addc_u32 s45, s33, 0
    global_load_lds_dwordx4 v24, s[44:45] sc1
    s_xor_b32 s43, s6, 13
    s_mov_b32 m0, 131072
    s_lshl_b32 s43, s43, 17
    s_add_u32 s43, s43, s42
    s_add_u32 s44, s32, s43
    s_addc_u32 s45, s33, 0
    global_load_lds_dwordx4 v27, s[44:45] sc1
    s_xor_b32 s43, s6, 15
    s_mov_b32 m0, 139264
    s_lshl_b32 s43, s43, 17
    s_add_u32 s43, s43, s42
    s_add_u32 s44, s32, s43
    s_addc_u32 s45, s33, 0
    global_load_lds_dwordx4 v25, s[44:45] sc1
    s_xor_b32 s43, s6, 16
    s_mov_b32 m0, 147456
    s_lshl_b32 s43, s43, 17
    s_add_u32 s43, s43, s42
    s_add_u32 s44, s32, s43
    s_addc_u32 s45, s33, 0
    global_load_lds_dwordx4 v28, s[44:45] sc1
    s_xor_b32 s43, s6, 18
    s_mov_b32 m0, 155648
    s_lshl_b32 s43, s43, 17
    s_add_u32 s43, s43, s42
    s_add_u32 s44, s32, s43
    s_addc_u32 s45, s33, 0
    global_load_lds_dwordx4 v26, s[44:45] sc1
    s_branch L_x2d_done
L_x2d5:
    s_xor_b32 s43, s6, 1
    s_mov_b32 m0, 66560
    s_lshl_b32 s43, s43, 17
    s_add_u32 s43, s43, s42
    s_add_u32 s44, s32, s43
    s_addc_u32 s45, s33, 0
    global_load_lds_dwordx4 v24, s[44:45] sc1
    s_xor_b32 s43, s6, 2
    s_mov_b32 m0, 74752
    s_lshl_b32 s43, s43, 17
    s_add_u32 s43, s43, s42
    s_add_u32 s44, s32, s43
    s_addc_u32 s45, s33, 0
    global_load_lds_dwordx4 v27, s[44:45] sc1
    s_xor_b32 s43, s6, 4
    s_mov_b32 m0, 82944
    s_lshl_b32 s43, s43, 17
    s_add_u32 s43, s43, s42
    s_add_u32 s44, s32, s43
    s_addc_u32 s45, s33, 0
    global_load_lds_dwordx4 v25, s[44:45] sc1
    s_xor_b32 s43, s6, 5
    s_mov_b32 m0, 91136
    s_lshl_b32 s43, s43, 17
    s_add_u32 s43, s43, s42
    s_add_u32 s44, s32, s43
    s_addc_u32 s45, s33, 0
    global_load_lds_dwordx4 v28, s[44:45] sc1
    s_xor_b32 s43, s6, 7
    s_mov_b32 m0, 99328
    s_lshl_b32 s43, s43, 17
    s_add_u32 s43, s43, s42
    s_add_u32 s44, s32, s43
    s_addc_u32 s45, s33, 0
    global_load_lds_dwordx4 v26, s[44:45] sc1
    s_xor_b32 s43, s6, 9
    s_mov_b32 m0, 107520
    s_lshl_b32 s43, s43, 17
    s_add_u32 s43, s43, s42
    s_add_u32 s44, s32, s43
    s_addc_u32 s45, s33, 0
    global_load_lds_dwordx4 v24, s[44:45] sc1
    s_xor_b32 s43, s6, 10
    s_mov_b32 m0, 115712
    s_lshl_b32 s43, s43, 17
    s_add_u32 s43, s43, s42
    s_add_u32 s44, s32, s43
    s_addc_u32 s45, s33, 0
    global_load_lds_dwordx4 v27, s[44:45] sc1
    s_xor_b32 s43, s6, 12
    s_mov_b32 m0, 123904
    s_lshl_b32 s43, s43, 17
    s_add_u32 s43, s43, s42
    s_add_u32 s44, s32, s43
    s_addc_u32 s45, s33, 0
    global_load_lds_dwordx4 v25, s[44:45] sc1
    s_xor_b32 s43, s6, 13
    s_mov_b32 m0, 132096
    s_lshl_b32 s43, s43, 17
    s_add_u32 s43, s43, s42
    s_add_u32 s44, s32, s43
    s_addc_u32 s45, s33, 0
    global_load_lds_dwordx4 v28, s[44:45] sc1
    s_xor_b32 s43, s6, 15
    s_mov_b32 m0, 140288
    s_lshl_b32 s43, s43, 17
    s_add_u32 s43, s43, s42
    s_add_u32 s44, s32, s43
    s_addc_u32 s45, s33, 0
    global_load_lds_dwordx4 v26, s[44:45] sc1
    s_xor_b32 s43, s6, 17
    s_mov_b32 m0, 148480
    s_lshl_b32 s43, s43, 17
    s_add_u32 s43, s43, s42
    s_add_u32 s44, s32, s43
    s_addc_u32 s45, s33, 0
    global_load_lds_dwordx4 v24, s[44:45] sc1
    s_xor_b32 s43, s6, 18
    s_mov_b32 m0, 156672
    s_lshl_b32 s43, s43, 17
    s_add_u32 s43, s43, s42
    s_add_u32 s44, s32, s43
    s_addc_u32 s45, s33, 0
    global_load_lds_dwordx4 v27, s[44:45] sc1
    s_branch L_x2d_done
L_x2d6:
    s_xor_b32 s43, s6, 1
    s_mov_b32 m0, 67584
    s_lshl_b32 s43, s43, 17
    s_add_u32 s43, s43, s42
    s_add_u32 s44, s32, s43
    s_addc_u32 s45, s33, 0
    global_load_lds_dwordx4 v25, s[44:45] sc1
    s_xor_b32 s43, s6, 2
    s_mov_b32 m0, 75776
    s_lshl_b32 s43, s43, 17
    s_add_u32 s43, s43, s42
    s_add_u32 s44, s32, s43
    s_addc_u32 s45, s33, 0
    global_load_lds_dwordx4 v28, s[44:45] sc1
    s_xor_b32 s43, s6, 4
    s_mov_b32 m0, 83968
    s_lshl_b32 s43, s43, 17
    s_add_u32 s43, s43, s42
    s_add_u32 s44, s32, s43
    s_addc_u32 s45, s33, 0
    global_load_lds_dwordx4 v26, s[44:45] sc1
    s_xor_b32 s43, s6, 6
    s_mov_b32 m0, 92160
    s_lshl_b32 s43, s43, 17
    s_add_u32 s43, s43, s42
    s_add_u32 s44, s32, s43
    s_addc_u32 s45, s33, 0
    global_load_lds_dwordx4 v24, s[44:45] sc1
    s_xor_b32 s43, s6, 7
    s_mov_b32 m0, 100352
    s_lshl_b32 s43, s43, 17
    s_add_u32 s43, s43, s42
    s_add_u32 s44, s32, s43
    s_addc_u32 s45, s33, 0
    global_load_lds_dwordx4 v27, s[44:45] sc1
    s_xor_b32 s43, s6, 9
    s_mov_b32 m0, 108544
    s_lshl_b32 s43, s43, 17
    s_add_u32 s43, s43, s42
    s_add_u32 s44, s32, s43
    s_addc_u32 s45, s33, 0
    global_load_lds_dwordx4 v25, s[44:45] sc1
    s_xor_b32 s43, s6, 10
    s_mov_b32 m0, 116736
    s_lshl_b32 s43, s43, 17
    s_add_u32 s43, s43, s42
    s_add_u32 s44, s32, s43
    s_addc_u32 s45, s33, 0
    global_load_lds_dwordx4 v28, s[44:45] sc1
    s_xor_b32 s43, s6, 12
    s_mov_b32 m0, 124928
    s_lshl_b32 s43, s43, 17
    s_add_u32 s43, s43, s42
    s_add_u32 s44, s32, s43
    s_addc_u32 s45, s33, 0
    global_load_lds_dwordx4 v26, s[44:45] sc1
    s_xor_b32 s43, s6, 14
    s_mov_b32 m0, 133120
    s_lshl_b32 s43, s43, 17
    s_add_u32 s43, s43, s42
    s_add_u32 s44, s32, s43
    s_addc_u32 s45, s33, 0
    global_load_lds_dwordx4 v24, s[44:45] sc1
    s_xor_b32 s43, s6, 15
    s_mov_b32 m0, 141312
    s_lshl_b32 s43, s43, 17
    s_add_u32 s43, s43, s42
    s_add_u32 s44, s32, s43
    s_addc_u32 s45, s33, 0
    global_load_lds_dwordx4 v27, s[44:45] sc1
    s_xor_b32 s43, s6, 17
    s_mov_b32 m0, 149504
    s_lshl_b32 s43, s43, 17
    s_add_u32 s43, s43, s42
    s_add_u32 s44, s32, s43
    s_addc_u32 s45, s33, 0
    global_load_lds_dwordx4 v25, s[44:45] sc1
    s_xor_b32 s43, s6, 18
    s_mov_b32 m0, 157696
    s_lshl_b32 s43, s43, 17
    s_add_u32 s43, s43, s42
    s_add_u32 s44, s32, s43
    s_addc_u32 s45, s33, 0
    global_load_lds_dwordx4 v28, s[44:45] sc1
    s_branch L_x2d_done
L_x2d7:
    s_xor_b32 s43, s6, 1
    s_mov_b32 m0, 68608
    s_lshl_b32 s43, s43, 17
    s_add_u32 s43, s43, s42
    s_add_u32 s44, s32, s43
    s_addc_u32 s45, s33, 0
    global_load_lds_dwordx4 v26, s[44:45] sc1
    s_xor_b32 s43, s6, 3
    s_mov_b32 m0, 76800
    s_lshl_b32 s43, s43, 17
    s_add_u32 s43, s43, s42
    s_add_u32 s44, s32, s43
    s_addc_u32 s45, s33, 0
    global_load_lds_dwordx4 v24, s[44:45] sc1
    s_xor_b32 s43, s6, 4
    s_mov_b32 m0, 84992
    s_lshl_b32 s43, s43, 17
    s_add_u32 s43, s43, s42
    s_add_u32 s44, s32, s43
    s_addc_u32 s45, s33, 0
    global_load_lds_dwordx4 v27, s[44:45] sc1
    s_xor_b32 s43, s6, 6
    s_mov_b32 m0, 93184
    s_lshl_b32 s43, s43, 17
    s_add_u32 s43, s43, s42
    s_add_u32 s44, s32, s43
    s_addc_u32 s45, s33, 0
    global_load_lds_dwordx4 v25, s[44:45] sc1
    s_xor_b32 s43, s6, 7
    s_mov_b32 m0, 101376
    s_lshl_b32 s43, s43, 17
    s_add_u32 s43, s43, s42
    s_add_u32 s44, s32, s43
    s_addc_u32 s45, s33, 0
    global_load_lds_dwordx4 v28, s[44:45] sc1
    s_xor_b32 s43, s6, 9
    s_mov_b32 m0, 109568
    s_lshl_b32 s43, s43, 17
    s_add_u32 s43, s43, s42
    s_add_u32 s44, s32, s43
    s_addc_u32 s45, s33, 0
    global_load_lds_dwordx4 v26, s[44:45] sc1
    s_xor_b32 s43, s6, 11
    s_mov_b32 m0, 117760
    s_lshl_b32 s43, s43, 17
    s_add_u32 s43, s43, s42
    s_add_u32 s44, s32, s43
    s_addc_u32 s45, s33, 0
    global_load_lds_dwordx4 v24, s[44:45] sc1
    s_xor_b32 s43, s6, 12
    s_mov_b32 m0, 125952
    s_lshl_b32 s43, s43, 17
    s_add_u32 s43, s43, s42
    s_add_u32 s44, s32, s43
    s_addc_u32 s45, s33, 0
    global_load_lds_dwordx4 v27, s[44:45] sc1
    s_xor_b32 s43, s6, 14
    s_mov_b32 m0, 134144
    s_lshl_b32 s43, s43, 17
    s_add_u32 s43, s43, s42
    s_add_u32 s44, s32, s43
    s_addc_u32 s45, s33, 0
    global_load_lds_dwordx4 v25, s[44:45] sc1
    s_xor_b32 s43, s6, 15
    s_mov_b32 m0, 142336
    s_lshl_b32 s43, s43, 17
    s_add_u32 s43, s43, s42
    s_add_u32 s44, s32, s43
    s_addc_u32 s45, s33, 0
    global_load_lds_dwordx4 v28, s[44:45] sc1
    s_xor_b32 s43, s6, 17
    s_mov_b32 m0, 150528
    s_lshl_b32 s43, s43, 17
    s_add_u32 s43, s43, s42
    s_add_u32 s44, s32, s43
    s_addc_u32 s45, s33, 0
    global_load_lds_dwordx4 v26, s[44:45] sc1
    s_xor_b32 s43, s6, 19
    s_mov_b32 m0, 158720
    s_lshl_b32 s43, s43, 17
    s_add_u32 s43, s43, s42
    s_add_u32 s44, s32, s43
    s_addc_u32 s45, s33, 0
    global_load_lds_dwordx4 v24, s[44:45] sc1
L_x2d_done:
    s_cmp_eq_u32 s3, 0
    s_cbranch_scc1 L_g2A
    s_cmp_eq_u32 s3, 1
    s_cbranch_scc1 L_g2B
    s_cmp_eq_u32 s3, 3
    s_cbranch_scc1 L_g2D
    s_cmp_eq_u32 s3, 7
    s_cbranch_scc1 L_g2E
    s_waitcnt vmcnt(10)
    s_barrier
    ds_read_b64_tr_b16 v[16:17], v2 offset:0
    ds_read_b64_tr_b16 v[18:19], v2 offset:2560
    ds_read_b64_tr_b16 v[20:21], v2 offset:32
    ds_read_b64_tr_b16 v[22:23], v2 offset:2592
    ds_read_b64_tr_b16 v[24:25], v2 offset:64
    ds_read_b64_tr_b16 v[26:27], v2 offset:2624
    ds_read_b64_tr_b16 v[28:29], v2 offset:96
    ds_read_b64_tr_b16 v[30:31], v2 offset:2656
    ds_read_b64_tr_b16 v[32:33], v2 offset:128
    ds_read_b64_tr_b16 v[34:35], v2 offset:2688
    ds_read_b64_tr_b16 v[36:37], v2 offset:5120
    ds_read_b64_tr_b16 v[38:39], v2 offset:7680
    ds_read_b64_tr_b16 v[40:41], v2 offset:5152
    ds_read_b64_tr_b16 v[42:43], v2 offset:7712
    ds_read_b64_tr_b16 v[44:45], v2 offset:5184
    ds_read_b64_tr_b16 v[46:47], v2 offset:7744
    s_waitcnt lgkmcnt(14)
    v_mfma_f32_16x16x32_bf16 v[48:51], v[96:99], v[16:19], 0
    v_mfma_f32_16x16x32_bf16 v[52:55], v[176:179], v[16:19], 0
    ds_read_b64_tr_b16 v[16:17], v2 offset:5216
    ds_read_b64_tr_b16 v[18:19], v2 offset:7776
    s_waitcnt lgkmcnt(14)
    v_mfma_f32_16x16x32_bf16 v[56:59], v[96:99], v[20:23], 0
    v_mfma_f32_16x16x32_bf16 v[60:63], v[176:179], v[20:23], 0
    ds_read_b64_tr_b16 v[20:21], v2 offset:5248
    ds_read_b64_tr_b16 v[22:23], v2 offset:7808
    s_waitcnt lgkmcnt(14)
    v_mfma_f32_16x16x32_bf16 v[64:67], v[96:99], v[24:27], 0
    v_mfma_f32_16x16x32_bf16 v[68:71], v[176:179], v[24:27], 0
    ds_read_b64_tr_b16 v[24:25], v2 offset:10240
    ds_read_b64_tr_b16 v[26:27], v2 offset:12800
    s_waitcnt lgkmcnt(14)
    v_mfma_f32_16x16x32_bf16 v[72:75], v[96:99], v[28:31], 0
    v_mfma_f32_16x16x32_bf16 v[76:79], v[176:179], v[28:31], 0
    ds_read_b64_tr_b16 v[28:29], v2 offset:10272
    ds_read_b64_tr_b16 v[30:31], v2 offset:12832
    s_waitcnt lgkmcnt(14)
    v_mfma_f32_16x16x32_bf16 v[80:83], v[96:99], v[32:35], 0
    v_mfma_f32_16x16x32_bf16 v[84:87], v[176:179], v[32:35], 0
    ds_read_b64_tr_b16 v[32:33], v2 offset:10304
    ds_read_b64_tr_b16 v[34:35], v2 offset:12864
    s_waitcnt lgkmcnt(14)
    v_mfma_f32_16x16x32_bf16 v[48:51], v[100:103], v[36:39], v[48:51]
    v_mfma_f32_16x16x32_bf16 v[52:55], v[180:183], v[36:39], v[52:55]
    ds_read_b64_tr_b16 v[36:37], v2 offset:10336
    ds_read_b64_tr_b16 v[38:39], v2 offset:12896
    s_waitcnt lgkmcnt(14)
    v_mfma_f32_16x16x32_bf16 v[56:59], v[100:103], v[40:43], v[56:59]
    v_mfma_f32_16x16x32_bf16 v[60:63], v[180:183], v[40:43], v[60:63]
    ds_read_b64_tr_b16 v[40:41], v2 offset:10368
    ds_read_b64_tr_b16 v[42:43], v2 offset:12928
    s_waitcnt lgkmcnt(14)
    v_mfma_f32_16x16x32_bf16 v[64:67], v[100:103], v[44:47], v[64:67]
    v_mfma_f32_16x16x32_bf16 v[68:71], v[180:183], v[44:47], v[68:71]
    s_waitcnt vmcnt(7)
    s_barrier
    ds_read_b64_tr_b16 v[44:45], v2 offset:15360
    ds_read_b64_tr_b16 v[46:47], v2 offset:17920
    s_waitcnt lgkmcnt(14)
    v_mfma_f32_16x16x32_bf16 v[72:75], v[100:103], v[16:19], v[72:75]
    v_mfma_f32_16x16x32_bf16 v[76:79], v[180:183], v[16:19], v[76:79]
    ds_read_b64_tr_b16 v[16:17], v2 offset:15392
    ds_read_b64_tr_b16 v[18:19], v2 offset:17952
    s_waitcnt lgkmcnt(14)
    v_mfma_f32_16x16x32_bf16 v[80:83], v[100:103], v[20:23], v[80:83]
    v_mfma_f32_16x16x32_bf16 v[84:87], v[180:183], v[20:23], v[84:87]
    ds_read_b64_tr_b16 v[20:21], v2 offset:15424
    ds_read_b64_tr_b16 v[22:23], v2 offset:17984
    s_waitcnt lgkmcnt(14)
    v_mfma_f32_16x16x32_bf16 v[48:51], v[104:107], v[24:27], v[48:51]
    v_mfma_f32_16x16x32_bf16 v[52:55], v[184:187], v[24:27], v[52:55]
    ds_read_b64_tr_b16 v[24:25], v2 offset:15456
    ds_read_b64_tr_b16 v[26:27], v2 offset:18016
    s_waitcnt lgkmcnt(14)
    v_mfma_f32_16x16x32_bf16 v[56:59], v[104:107], v[28:31], v[56:59]
    v_mfma_f32_16x16x32_bf16 v[60:63], v[184:187], v[28:31], v[60:63]
    ds_read_b64_tr_b16 v[28:29], v2 offset:15488
    ds_read_b64_tr_b16 v[30:31], v2 offset:18048
    s_waitcnt lgkmcnt(14)
    v_mfma_f32_16x16x32_bf16 v[64:67], v[104:107], v[32:35], v[64:67]
    v_mfma_f32_16x16x32_bf16 v[68:71], v[184:187], v[32:35], v[68:71]
    ds_read_b64_tr_b16 v[32:33], v2 offset:20480
    ds_read_b64_tr_b16 v[34:35], v2 offset:23040
    s_waitcnt lgkmcnt(14)
    v_mfma_f32_16x16x32_bf16 v[72:75], v[104:107], v[36:39], v[72:75]
    v_mfma_f32_16x16x32_bf16 v[76:79], v[184:187], v[36:39], v[76:79]
    ds_read_b64_tr_b16 v[36:37], v2 offset:20512
    ds_read_b64_tr_b16 v[38:39], v2 offset:23072
    s_waitcnt lgkmcnt(14)
    v_mfma_f32_16x16x32_bf16 v[80:83], v[104:107], v[40:43], v[80:83]
    v_mfma_f32_16x16x32_bf16 v[84:87], v[184:187], v[40:43], v[84:87]
    ds_read_b64_tr_b16 v[40:41], v2 offset:20544
    ds_read_b64_tr_b16 v[42:43], v2 offset:23104
    s_waitcnt lgkmcnt(14)
    v_mfma_f32_16x16x32_bf16 v[48:51], v[108:111], v[44:47], v[48:51]
    v_mfma_f32_16x16x32_bf16 v[52:55], v[188:191], v[44:47], v[52:55]
    ds_read_b64_tr_b16 v[44:45], v2 offset:20576
    ds_read_b64_tr_b16 v[46:47], v2 offset:23136
    s_waitcnt lgkmcnt(14)
    v_mfma_f32_16x16x32_bf16 v[56:59], v[108:111], v[16:19], v[56:59]
    v_mfma_f32_16x16x32_bf16 v[60:63], v[188:191], v[16:19], v[60:63]
    ds_read_b64_tr_b16 v[16:17], v2 offset:20608
    ds_read_b64_tr_b16 v[18:19], v2 offset:23168
    s_waitcnt lgkmcnt(14)
    v_mfma_f32_16x16x32_bf16 v[64:67], v[108:111], v[20:23], v[64:67]
    v_mfma_f32_16x16x32_bf16 v[68:71], v[188:191], v[20:23], v[68:71]
    ds_read_b64_tr_b16 v[20:21], v2 offset:25600
    ds_read_b64_tr_b16 v[22:23], v2 offset:28160
    s_waitcnt lgkmcnt(14)
    v_mfma_f32_16x16x32_bf16 v[72:75], v[108:111], v[24:27], v[72:75]
    v_mfma_f32_16x16x32_bf16 v[76:79], v[188:191], v[24:27], v[76:79]
    ds_read_b64_tr_b16 v[24:25], v2 offset:25632
    ds_read_b64_tr_b16 v[26:27], v2 offset:28192
    s_waitcnt lgkmcnt(14)
    v_mfma_f32_16x16x32_bf16 v[80:83], v[108:111], v[28:31], v[80:83]
    v_mfma_f32_16x16x32_bf16 v[84:87], v[188:191], v[28:31], v[84:87]
    ds_read_b64_tr_b16 v[28:29], v2 offset:25664
    ds_read_b64_tr_b16 v[30:31], v2 offset:28224
    s_waitcnt lgkmcnt(14)
    v_mfma_f32_16x16x32_bf16 v[48:51], v[112:115], v[32:35], v[48:51]
    v_mfma_f32_16x16x32_bf16 v[52:55], v[192:195], v[32:35], v[52:55]
    ds_read_b64_tr_b16 v[32:33], v2 offset:25696
    ds_read_b64_tr_b16 v[34:35], v2 offset:28256
    s_waitcnt lgkmcnt(14)
    v_mfma_f32_16x16x32_bf16 v[56:59], v[112:115], v[36:39], v[56:59]
    v_mfma_f32_16x16x32_bf16 v[60:63], v[192:195], v[36:39], v[60:63]
    ds_read_b64_tr_b16 v[36:37], v2 offset:25728
    ds_read_b64_tr_b16 v[38:39], v2 offset:28288
    s_waitcnt lgkmcnt(14)
    v_mfma_f32_16x16x32_bf16 v[64:67], v[112:115], v[40:43], v[64:67]
    v_mfma_f32_16x16x32_bf16 v[68:71], v[192:195], v[40:43], v[68:71]
    ds_read_b64_tr_b16 v[40:41], v2 offset:30720
    ds_read_b64_tr_b16 v[42:43], v2 offset:33280
    s_waitcnt lgkmcnt(14)
    v_mfma_f32_16x16x32_bf16 v[72:75], v[112:115], v[44:47], v[72:75]
    v_mfma_f32_16x16x32_bf16 v[76:79], v[192:195], v[44:47], v[76:79]
    ds_read_b64_tr_b16 v[44:45], v2 offset:30752
    ds_read_b64_tr_b16 v[46:47], v2 offset:33312
    s_waitcnt lgkmcnt(14)
    v_mfma_f32_16x16x32_bf16 v[80:83], v[112:115], v[16:19], v[80:83]
    v_mfma_f32_16x16x32_bf16 v[84:87], v[192:195], v[16:19], v[84:87]
    ds_read_b64_tr_b16 v[16:17], v2 offset:30784
    ds_read_b64_tr_b16 v[18:19], v2 offset:33344
    s_waitcnt lgkmcnt(14)
    v_mfma_f32_16x16x32_bf16 v[48:51], v[116:119], v[20:23], v[48:51]
    v_mfma_f32_16x16x32_bf16 v[52:55], v[196:199], v[20:23], v[52:55]
    ds_read_b64_tr_b16 v[20:21], v2 offset:30816
    ds_read_b64_tr_b16 v[22:23], v2 offset:33376
    s_waitcnt lgkmcnt(14)
    v_mfma_f32_16x16x32_bf16 v[56:59], v[116:119], v[24:27], v[56:59]
    v_mfma_f32_16x16x32_bf16 v[60:63], v[196:199], v[24:27], v[60:63]
    ds_read_b64_tr_b16 v[24:25], v2 offset:30848
    ds_read_b64_tr_b16 v[26:27], v2 offset:33408
    s_waitcnt lgkmcnt(14)
    v_mfma_f32_16x16x32_bf16 v[64:67], v[116:119], v[28:31], v[64:67]
    v_mfma_f32_16x16x32_bf16 v[68:71], v[196:199], v[28:31], v[68:71]
    ds_read_b64_tr_b16 v[28:29], v2 offset:35840
    ds_read_b64_tr_b16 v[30:31], v2 offset:38400
    s_waitcnt lgkmcnt(14)
    v_mfma_f32_16x16x32_bf16 v[72:75], v[116:119], v[32:35], v[72:75]
    v_mfma_f32_16x16x32_bf16 v[76:79], v[196:199], v[32:35], v[76:79]
    ds_read_b64_tr_b16 v[32:33], v2 offset:35872
    ds_read_b64_tr_b16 v[34:35], v2 offset:38432
    s_waitcnt lgkmcnt(14)
    v_mfma_f32_16x16x32_bf16 v[80:83], v[116:119], v[36:39], v[80:83]
    v_mfma_f32_16x16x32_bf16 v[84:87], v[196:199], v[36:39], v[84:87]
    ds_read_b64_tr_b16 v[36:37], v2 offset:35904
    ds_read_b64_tr_b16 v[38:39], v2 offset:38464
    s_waitcnt lgkmcnt(14)
    v_mfma_f32_16x16x32_bf16 v[48:51], v[120:123], v[40:43], v[48:51]
    v_mfma_f32_16x16x32_bf16 v[52:55], v[200:203], v[40:43], v[52:55]
    ds_read_b64_tr_b16 v[40:41], v2 offset:35936
    ds_read_b64_tr_b16 v[42:43], v2 offset:38496
    s_waitcnt lgkmcnt(14)
    v_mfma_f32_16x16x32_bf16 v[56:59], v[120:123], v[44:47], v[56:59]
    v_mfma_f32_16x16x32_bf16 v[60:63], v[200:203], v[44:47], v[60:63]
    ds_read_b64_tr_b16 v[44:45], v2 offset:35968
    ds_read_b64_tr_b16 v[46:47], v2 offset:38528
    s_waitcnt lgkmcnt(14)
    v_mfma_f32_16x16x32_bf16 v[64:67], v[120:123], v[16:19], v[64:67]
    v_mfma_f32_16x16x32_bf16 v[68:71], v[200:203], v[16:19], v[68:71]
    s_waitcnt vmcnt(3)
    s_barrier
    ds_read_b64_tr_b16 v[16:17], v2 offset:40960
    ds_read_b64_tr_b16 v[18:19], v2 offset:43520
    s_waitcnt lgkmcnt(14)
    v_mfma_f32_16x16x32_bf16 v[72:75], v[120:123], v[20:23], v[72:75]
    v_mfma_f32_16x16x32_bf16 v[76:79], v[200:203], v[20:23], v[76:79]
    ds_read_b64_tr_b16 v[20:21], v2 offset:40992
    ds_read_b64_tr_b16 v[22:23], v2 offset:43552
    s_waitcnt lgkmcnt(14)
    v_mfma_f32_16x16x32_bf16 v[80:83], v[120:123], v[24:27], v[80:83]
    v_mfma_f32_16x16x32_bf16 v[84:87], v[200:203], v[24:27], v[84:87]
    ds_read_b64_tr_b16 v[24:25], v2 offset:41024
    ds_read_b64_tr_b16 v[26:27], v2 offset:43584
    s_waitcnt lgkmcnt(14)
    v_mfma_f32_16x16x32_bf16 v[48:51], v[124:127], v[28:31], v[48:51]
    v_mfma_f32_16x16x32_bf16 v[52:55], v[204:207], v[28:31], v[52:55]
    ds_read_b64_tr_b16 v[28:29], v2 offset:41056
    ds_read_b64_tr_b16 v[30:31], v2 offset:43616
    s_waitcnt lgkmcnt(14)
    v_mfma_f32_16x16x32_bf16 v[56:59], v[124:127], v[32:35], v[56:59]
    v_mfma_f32_16x16x32_bf16 v[60:63], v[204:207], v[32:35], v[60:63]
    ds_read_b64_tr_b16 v[32:33], v2 offset:41088
    ds_read_b64_tr_b16 v[34:35], v2 offset:43648
    s_waitcnt lgkmcnt(14)
    v_mfma_f32_16x16x32_bf16 v[64:67], v[124:127], v[36:39], v[64:67]
    v_mfma_f32_16x16x32_bf16 v[68:71], v[204:207], v[36:39], v[68:71]
    ds_read_b64_tr_b16 v[36:37], v2 offset:46080
    ds_read_b64_tr_b16 v[38:39], v2 offset:48640
    s_waitcnt lgkmcnt(14)
    v_mfma_f32_16x16x32_bf16 v[72:75], v[124:127], v[40:43], v[72:75]
    v_mfma_f32_16x16x32_bf16 v[76:79], v[204:207], v[40:43], v[76:79]
    ds_read_b64_tr_b16 v[40:41], v2 offset:46112
    ds_read_b64_tr_b16 v[42:43], v2 offset:48672
    s_waitcnt lgkmcnt(14)
    v_mfma_f32_16x16x32_bf16 v[80:83], v[124:127], v[44:47], v[80:83]
    v_mfma_f32_16x16x32_bf16 v[84:87], v[204:207], v[44:47], v[84:87]
    ds_read_b64_tr_b16 v[44:45], v2 offset:46144
    ds_read_b64_tr_b16 v[46:47], v2 offset:48704
    s_waitcnt lgkmcnt(14)
    v_mfma_f32_16x16x32_bf16 v[48:51], v[128:131], v[16:19], v[48:51]
    v_mfma_f32_16x16x32_bf16 v[52:55], v[208:211], v[16:19], v[52:55]
    ds_read_b64_tr_b16 v[16:17], v2 offset:46176
    ds_read_b64_tr_b16 v[18:19], v2 offset:48736
    s_waitcnt lgkmcnt(14)
    v_mfma_f32_16x16x32_bf16 v[56:59], v[128:131], v[20:23], v[56:59]
    v_mfma_f32_16x16x32_bf16 v[60:63], v[208:211], v[20:23], v[60:63]
    ds_read_b64_tr_b16 v[20:21], v2 offset:46208
    ds_read_b64_tr_b16 v[22:23], v2 offset:48768
    s_waitcnt lgkmcnt(14)
    v_mfma_f32_16x16x32_bf16 v[64:67], v[128:131], v[24:27], v[64:67]
    v_mfma_f32_16x16x32_bf16 v[68:71], v[208:211], v[24:27], v[68:71]
    ds_read_b64_tr_b16 v[24:25], v2 offset:51200
    ds_read_b64_tr_b16 v[26:27], v2 offset:53760
    s_waitcnt lgkmcnt(14)
    v_mfma_f32_16x16x32_bf16 v[72:75], v[128:131], v[28:31], v[72:75]
    v_mfma_f32_16x16x32_bf16 v[76:79], v[208:211], v[28:31], v[76:79]
    ds_read_b64_tr_b16 v[28:29], v2 offset:51232
    ds_read_b64_tr_b16 v[30:31], v2 offset:53792
    s_waitcnt lgkmcnt(14)
    v_mfma_f32_16x16x32_bf16 v[80:83], v[128:131], v[32:35], v[80:83]
    v_mfma_f32_16x16x32_bf16 v[84:87], v[208:211], v[32:35], v[84:87]
    ds_read_b64_tr_b16 v[32:33], v2 offset:51264
    ds_read_b64_tr_b16 v[34:35], v2 offset:53824
    s_waitcnt lgkmcnt(14)
    v_mfma_f32_16x16x32_bf16 v[48:51], v[132:135], v[36:39], v[48:51]
    v_mfma_f32_16x16x32_bf16 v[52:55], v[212:215], v[36:39], v[52:55]
    ds_read_b64_tr_b16 v[36:37], v2 offset:51296
    ds_read_b64_tr_b16 v[38:39], v2 offset:53856
    s_waitcnt lgkmcnt(14)
    v_mfma_f32_16x16x32_bf16 v[56:59], v[132:135], v[40:43], v[56:59]
    v_mfma_f32_16x16x32_bf16 v[60:63], v[212:215], v[40:43], v[60:63]
    ds_read_b64_tr_b16 v[40:41], v2 offset:51328
    ds_read_b64_tr_b16 v[42:43], v2 offset:53888
    s_waitcnt lgkmcnt(14)
    v_mfma_f32_16x16x32_bf16 v[64:67], v[132:135], v[44:47], v[64:67]
    v_mfma_f32_16x16x32_bf16 v[68:71], v[212:215], v[44:47], v[68:71]
    ds_read_b64_tr_b16 v[44:45], v2 offset:56320
    ds_read_b64_tr_b16 v[46:47], v2 offset:58880
    s_waitcnt lgkmcnt(14)
    v_mfma_f32_16x16x32_bf16 v[72:75], v[132:135], v[16:19], v[72:75]
    v_mfma_f32_16x16x32_bf16 v[76:79], v[212:215], v[16:19], v[76:79]
    ds_read_b64_tr_b16 v[16:17], v2 offset:56352
    ds_read_b64_tr_b16 v[18:19], v2 offset:58912
    s_waitcnt lgkmcnt(14)
    v_mfma_f32_16x16x32_bf16 v[80:83], v[132:135], v[20:23], v[80:83]
    v_mfma_f32_16x16x32_bf16 v[84:87], v[212:215], v[20:23], v[84:87]
    ds_read_b64_tr_b16 v[20:21], v2 offset:56384
    ds_read_b64_tr_b16 v[22:23], v2 offset:58944
    s_waitcnt lgkmcnt(14)
    v_mfma_f32_16x16x32_bf16 v[48:51], v[136:139], v[24:27], v[48:51]
    v_mfma_f32_16x16x32_bf16 v[52:55], v[216:219], v[24:27], v[52:55]
    ds_read_b64_tr_b16 v[24:25], v2 offset:56416
    ds_read_b64_tr_b16 v[26:27], v2 offset:58976
    s_waitcnt lgkmcnt(14)
    v_mfma_f32_16x16x32_bf16 v[56:59], v[136:139], v[28:31], v[56:59]
    v_mfma_f32_16x16x32_bf16 v[60:63], v[216:219], v[28:31], v[60:63]
    ds_read_b64_tr_b16 v[28:29], v2 offset:56448
    ds_read_b64_tr_b16 v[30:31], v2 offset:59008
    s_waitcnt lgkmcnt(14)
    v_mfma_f32_16x16x32_bf16 v[64:67], v[136:139], v[32:35], v[64:67]
    v_mfma_f32_16x16x32_bf16 v[68:71], v[216:219], v[32:35], v[68:71]
    ds_read_b64_tr_b16 v[32:33], v3 offset:0
    ds_read_b64_tr_b16 v[34:35], v3 offset:2560
    s_waitcnt lgkmcnt(14)
    v_mfma_f32_16x16x32_bf16 v[72:75], v[136:139], v[36:39], v[72:75]
    v_mfma_f32_16x16x32_bf16 v[76:79], v[216:219], v[36:39], v[76:79]
    ds_read_b64_tr_b16 v[36:37], v3 offset:32
    ds_read_b64_tr_b16 v[38:39], v3 offset:2592
    s_waitcnt lgkmcnt(14)
    v_mfma_f32_16x16x32_bf16 v[80:83], v[136:139], v[40:43], v[80:83]
    v_mfma_f32_16x16x32_bf16 v[84:87], v[216:219], v[40:43], v[84:87]
    ds_read_b64_tr_b16 v[40:41], v3 offset:64
    ds_read_b64_tr_b16 v[42:43], v3 offset:2624
    s_waitcnt lgkmcnt(14)
    v_mfma_f32_16x16x32_bf16 v[48:51], v[140:143], v[44:47], v[48:51]
    v_mfma_f32_16x16x32_bf16 v[52:55], v[220:223], v[44:47], v[52:55]
    ds_read_b64_tr_b16 v[44:45], v3 offset:96
    ds_read_b64_tr_b16 v[46:47], v3 offset:2656
    s_waitcnt lgkmcnt(14)
    v_mfma_f32_16x16x32_bf16 v[56:59], v[140:143], v[16:19], v[56:59]
    v_mfma_f32_16x16x32_bf16 v[60:63], v[220:223], v[16:19], v[60:63]
    ds_read_b64_tr_b16 v[16:17], v3 offset:128
    ds_read_b64_tr_b16 v[18:19], v3 offset:2688
    s_waitcnt lgkmcnt(14)
    v_mfma_f32_16x16x32_bf16 v[64:67], v[140:143], v[20:23], v[64:67]
    v_mfma_f32_16x16x32_bf16 v[68:71], v[220:223], v[20:23], v[68:71]
    ds_read_b64_tr_b16 v[20:21], v3 offset:5120
    ds_read_b64_tr_b16 v[22:23], v3 offset:7680
    s_waitcnt lgkmcnt(14)
    v_mfma_f32_16x16x32_bf16 v[72:75], v[140:143], v[24:27], v[72:75]
    v_mfma_f32_16x16x32_bf16 v[76:79], v[220:223], v[24:27], v[76:79]
    ds_read_b64_tr_b16 v[24:25], v3 offset:5152
    ds_read_b64_tr_b16 v[26:27], v3 offset:7712
    s_waitcnt lgkmcnt(14)
    v_mfma_f32_16x16x32_bf16 v[80:83], v[140:143], v[28:31], v[80:83]
    v_mfma_f32_16x16x32_bf16 v[84:87], v[220:223], v[28:31], v[84:87]
    ds_read_b64_tr_b16 v[28:29], v3 offset:5184
    ds_read_b64_tr_b16 v[30:31], v3 offset:7744
    s_waitcnt lgkmcnt(14)
    v_mfma_f32_16x16x32_bf16 v[48:51], v[144:147], v[32:35], v[48:51]
    v_mfma_f32_16x16x32_bf16 v[52:55], v[224:227], v[32:35], v[52:55]
    ds_read_b64_tr_b16 v[32:33], v3 offset:5216
    ds_read_b64_tr_b16 v[34:35], v3 offset:7776
    s_waitcnt lgkmcnt(14)
    v_mfma_f32_16x16x32_bf16 v[56:59], v[144:147], v[36:39], v[56:59]
    v_mfma_f32_16x16x32_bf16 v[60:63], v[224:227], v[36:39], v[60:63]
    ds_read_b64_tr_b16 v[36:37], v3 offset:5248
    ds_read_b64_tr_b16 v[38:39], v3 offset:7808
    s_waitcnt lgkmcnt(14)
    v_mfma_f32_16x16x32_bf16 v[64:67], v[144:147], v[40:43], v[64:67]
    v_mfma_f32_16x16x32_bf16 v[68:71], v[224:227], v[40:43], v[68:71]
    s_waitcnt vmcnt(0)
    s_barrier
    ds_read_b64_tr_b16 v[40:41], v3 offset:10240
    ds_read_b64_tr_b16 v[42:43], v3 offset:12800
    s_waitcnt lgkmcnt(14)
    v_mfma_f32_16x16x32_bf16 v[72:75], v[144:147], v[44:47], v[72:75]
    v_mfma_f32_16x16x32_bf16 v[76:79], v[224:227], v[44:47], v[76:79]
    ds_read_b64_tr_b16 v[44:45], v3 offset:10272
    ds_read_b64_tr_b16 v[46:47], v3 offset:12832
    s_waitcnt lgkmcnt(14)
    v_mfma_f32_16x16x32_bf16 v[80:83], v[144:147], v[16:19], v[80:83]
    v_mfma_f32_16x16x32_bf16 v[84:87], v[224:227], v[16:19], v[84:87]
    ds_read_b64_tr_b16 v[16:17], v3 offset:10304
    ds_read_b64_tr_b16 v[18:19], v3 offset:12864
    s_waitcnt lgkmcnt(14)
    v_mfma_f32_16x16x32_bf16 v[48:51], v[148:151], v[20:23], v[48:51]
    v_mfma_f32_16x16x32_bf16 v[52:55], v[228:231], v[20:23], v[52:55]
    ds_read_b64_tr_b16 v[20:21], v3 offset:10336
    ds_read_b64_tr_b16 v[22:23], v3 offset:12896
    s_waitcnt lgkmcnt(14)
    v_mfma_f32_16x16x32_bf16 v[56:59], v[148:151], v[24:27], v[56:59]
    v_mfma_f32_16x16x32_bf16 v[60:63], v[228:231], v[24:27], v[60:63]
    ds_read_b64_tr_b16 v[24:25], v3 offset:10368
    ds_read_b64_tr_b16 v[26:27], v3 offset:12928
    s_waitcnt lgkmcnt(14)
    v_mfma_f32_16x16x32_bf16 v[64:67], v[148:151], v[28:31], v[64:67]
    v_mfma_f32_16x16x32_bf16 v[68:71], v[228:231], v[28:31], v[68:71]
    ds_read_b64_tr_b16 v[28:29], v3 offset:15360
    ds_read_b64_tr_b16 v[30:31], v3 offset:17920
    s_waitcnt lgkmcnt(14)
    v_mfma_f32_16x16x32_bf16 v[72:75], v[148:151], v[32:35], v[72:75]
    v_mfma_f32_16x16x32_bf16 v[76:79], v[228:231], v[32:35], v[76:79]
    ds_read_b64_tr_b16 v[32:33], v3 offset:15392
    ds_read_b64_tr_b16 v[34:35], v3 offset:17952
    s_waitcnt lgkmcnt(14)
    v_mfma_f32_16x16x32_bf16 v[80:83], v[148:151], v[36:39], v[80:83]
    v_mfma_f32_16x16x32_bf16 v[84:87], v[228:231], v[36:39], v[84:87]
    ds_read_b64_tr_b16 v[36:37], v3 offset:15424
    ds_read_b64_tr_b16 v[38:39], v3 offset:17984
    s_waitcnt lgkmcnt(14)
    v_mfma_f32_16x16x32_bf16 v[48:51], v[152:155], v[40:43], v[48:51]
    v_mfma_f32_16x16x32_bf16 v[52:55], v[232:235], v[40:43], v[52:55]
    ds_read_b64_tr_b16 v[40:41], v3 offset:15456
    ds_read_b64_tr_b16 v[42:43], v3 offset:18016
    s_waitcnt lgkmcnt(14)
    v_mfma_f32_16x16x32_bf16 v[56:59], v[152:155], v[44:47], v[56:59]
    v_mfma_f32_16x16x32_bf16 v[60:63], v[232:235], v[44:47], v[60:63]
    ds_read_b64_tr_b16 v[44:45], v3 offset:15488
    ds_read_b64_tr_b16 v[46:47], v3 offset:18048
    s_waitcnt lgkmcnt(14)
    v_mfma_f32_16x16x32_bf16 v[64:67], v[152:155], v[16:19], v[64:67]
    v_mfma_f32_16x16x32_bf16 v[68:71], v[232:235], v[16:19], v[68:71]
    ds_read_b64_tr_b16 v[16:17], v3 offset:20480
    ds_read_b64_tr_b16 v[18:19], v3 offset:23040
    s_waitcnt lgkmcnt(14)
    v_mfma_f32_16x16x32_bf16 v[72:75], v[152:155], v[20:23], v[72:75]
    v_mfma_f32_16x16x32_bf16 v[76:79], v[232:235], v[20:23], v[76:79]
    ds_read_b64_tr_b16 v[20:21], v3 offset:20512
    ds_read_b64_tr_b16 v[22:23], v3 offset:23072
    s_waitcnt lgkmcnt(14)
    v_mfma_f32_16x16x32_bf16 v[80:83], v[152:155], v[24:27], v[80:83]
    v_mfma_f32_16x16x32_bf16 v[84:87], v[232:235], v[24:27], v[84:87]
    ds_read_b64_tr_b16 v[24:25], v3 offset:20544
    ds_read_b64_tr_b16 v[26:27], v3 offset:23104
    s_waitcnt lgkmcnt(14)
    v_mfma_f32_16x16x32_bf16 v[48:51], v[156:159], v[28:31], v[48:51]
    v_mfma_f32_16x16x32_bf16 v[52:55], v[236:239], v[28:31], v[52:55]
    ds_read_b64_tr_b16 v[28:29], v3 offset:20576
    ds_read_b64_tr_b16 v[30:31], v3 offset:23136
    s_waitcnt lgkmcnt(14)
    v_mfma_f32_16x16x32_bf16 v[56:59], v[156:159], v[32:35], v[56:59]
    v_mfma_f32_16x16x32_bf16 v[60:63], v[236:239], v[32:35], v[60:63]
    ds_read_b64_tr_b16 v[32:33], v3 offset:20608
    ds_read_b64_tr_b16 v[34:35], v3 offset:23168
    s_waitcnt lgkmcnt(14)
    v_mfma_f32_16x16x32_bf16 v[64:67], v[156:159], v[36:39], v[64:67]
    v_mfma_f32_16x16x32_bf16 v[68:71], v[236:239], v[36:39], v[68:71]
    ds_read_b64_tr_b16 v[36:37], v3 offset:25600
    ds_read_b64_tr_b16 v[38:39], v3 offset:28160
    s_waitcnt lgkmcnt(14)
    v_mfma_f32_16x16x32_bf16 v[72:75], v[156:159], v[40:43], v[72:75]
    v_mfma_f32_16x16x32_bf16 v[76:79], v[236:239], v[40:43], v[76:79]
    ds_read_b64_tr_b16 v[40:41], v3 offset:25632
    ds_read_b64_tr_b16 v[42:43], v3 offset:28192
    s_waitcnt lgkmcnt(14)
    v_mfma_f32_16x16x32_bf16 v[80:83], v[156:159], v[44:47], v[80:83]
    v_mfma_f32_16x16x32_bf16 v[84:87], v[236:239], v[44:47], v[84:87]
    ds_read_b64_tr_b16 v[44:45], v3 offset:25664
    ds_read_b64_tr_b16 v[46:47], v3 offset:28224
    s_waitcnt lgkmcnt(14)
    v_mfma_f32_16x16x32_bf16 v[48:51], v[160:163], v[16:19], v[48:51]
    v_mfma_f32_16x16x32_bf16 v[52:55], v[240:243], v[16:19], v[52:55]
    ds_read_b64_tr_b16 v[16:17], v3 offset:25696
    ds_read_b64_tr_b16 v[18:19], v3 offset:28256
    s_waitcnt lgkmcnt(14)
    v_mfma_f32_16x16x32_bf16 v[56:59], v[160:163], v[20:23], v[56:59]
    v_mfma_f32_16x16x32_bf16 v[60:63], v[240:243], v[20:23], v[60:63]
    ds_read_b64_tr_b16 v[20:21], v3 offset:25728
    ds_read_b64_tr_b16 v[22:23], v3 offset:28288
    s_waitcnt lgkmcnt(14)
    v_mfma_f32_16x16x32_bf16 v[64:67], v[160:163], v[24:27], v[64:67]
    v_mfma_f32_16x16x32_bf16 v[68:71], v[240:243], v[24:27], v[68:71]
    ds_read_b64_tr_b16 v[24:25], v3 offset:30720
    ds_read_b64_tr_b16 v[26:27], v3 offset:33280
    s_waitcnt lgkmcnt(14)
    v_mfma_f32_16x16x32_bf16 v[72:75], v[160:163], v[28:31], v[72:75]
    v_mfma_f32_16x16x32_bf16 v[76:79], v[240:243], v[28:31], v[76:79]
    ds_read_b64_tr_b16 v[28:29], v3 offset:30752
    ds_read_b64_tr_b16 v[30:31], v3 offset:33312
    s_waitcnt lgkmcnt(14)
    v_mfma_f32_16x16x32_bf16 v[80:83], v[160:163], v[32:35], v[80:83]
    v_mfma_f32_16x16x32_bf16 v[84:87], v[240:243], v[32:35], v[84:87]
    ds_read_b64_tr_b16 v[32:33], v3 offset:30784
    ds_read_b64_tr_b16 v[34:35], v3 offset:33344
    s_waitcnt lgkmcnt(14)
    v_mfma_f32_16x16x32_bf16 v[48:51], v[164:167], v[36:39], v[48:51]
    v_mfma_f32_16x16x32_bf16 v[52:55], v[244:247], v[36:39], v[52:55]
    ds_read_b64_tr_b16 v[36:37], v3 offset:30816
    ds_read_b64_tr_b16 v[38:39], v3 offset:33376
    s_waitcnt lgkmcnt(14)
    v_mfma_f32_16x16x32_bf16 v[56:59], v[164:167], v[40:43], v[56:59]
    v_mfma_f32_16x16x32_bf16 v[60:63], v[244:247], v[40:43], v[60:63]
    ds_read_b64_tr_b16 v[40:41], v3 offset:30848
    ds_read_b64_tr_b16 v[42:43], v3 offset:33408
    s_waitcnt lgkmcnt(14)
    v_mfma_f32_16x16x32_bf16 v[64:67], v[164:167], v[44:47], v[64:67]
    v_mfma_f32_16x16x32_bf16 v[68:71], v[244:247], v[44:47], v[68:71]
    ds_read_b64_tr_b16 v[44:45], v3 offset:35840
    ds_read_b64_tr_b16 v[46:47], v3 offset:38400
    s_waitcnt lgkmcnt(14)
    v_mfma_f32_16x16x32_bf16 v[72:75], v[164:167], v[16:19], v[72:75]
    v_mfma_f32_16x16x32_bf16 v[76:79], v[244:247], v[16:19], v[76:79]
    ds_read_b64_tr_b16 v[16:17], v3 offset:35872
    ds_read_b64_tr_b16 v[18:19], v3 offset:38432
    s_waitcnt lgkmcnt(14)
    v_mfma_f32_16x16x32_bf16 v[80:83], v[164:167], v[20:23], v[80:83]
    v_mfma_f32_16x16x32_bf16 v[84:87], v[244:247], v[20:23], v[84:87]
    ds_read_b64_tr_b16 v[20:21], v3 offset:35904
    ds_read_b64_tr_b16 v[22:23], v3 offset:38464
    s_waitcnt lgkmcnt(14)
    v_mfma_f32_16x16x32_bf16 v[48:51], v[168:171], v[24:27], v[48:51]
    v_mfma_f32_16x16x32_bf16 v[52:55], v[248:251], v[24:27], v[52:55]
    ds_read_b64_tr_b16 v[24:25], v3 offset:35936
    ds_read_b64_tr_b16 v[26:27], v3 offset:38496
    s_waitcnt lgkmcnt(14)
    v_mfma_f32_16x16x32_bf16 v[56:59], v[168:171], v[28:31], v[56:59]
    v_mfma_f32_16x16x32_bf16 v[60:63], v[248:251], v[28:31], v[60:63]
    ds_read_b64_tr_b16 v[28:29], v3 offset:35968
    ds_read_b64_tr_b16 v[30:31], v3 offset:38528
    s_waitcnt lgkmcnt(14)
    v_mfma_f32_16x16x32_bf16 v[64:67], v[168:171], v[32:35], v[64:67]
    v_mfma_f32_16x16x32_bf16 v[68:71], v[248:251], v[32:35], v[68:71]
    s_waitcnt lgkmcnt(12)
    v_mfma_f32_16x16x32_bf16 v[72:75], v[168:171], v[36:39], v[72:75]
    v_mfma_f32_16x16x32_bf16 v[76:79], v[248:251], v[36:39], v[76:79]
    s_waitcnt lgkmcnt(10)
    v_mfma_f32_16x16x32_bf16 v[80:83], v[168:171], v[40:43], v[80:83]
    v_mfma_f32_16x16x32_bf16 v[84:87], v[248:251], v[40:43], v[84:87]
    s_waitcnt lgkmcnt(8)
    v_mfma_f32_16x16x32_bf16 v[48:51], v[172:175], v[44:47], v[48:51]
    v_mfma_f32_16x16x32_bf16 v[52:55], v[252:255], v[44:47], v[52:55]
    s_waitcnt lgkmcnt(6)
    v_mfma_f32_16x16x32_bf16 v[56:59], v[172:175], v[16:19], v[56:59]
    v_mfma_f32_16x16x32_bf16 v[60:63], v[252:255], v[16:19], v[60:63]
    s_waitcnt lgkmcnt(4)
    v_mfma_f32_16x16x32_bf16 v[64:67], v[172:175], v[20:23], v[64:67]
    v_mfma_f32_16x16x32_bf16 v[68:71], v[252:255], v[20:23], v[68:71]
    s_waitcnt lgkmcnt(2)
    v_mfma_f32_16x16x32_bf16 v[72:75], v[172:175], v[24:27], v[72:75]
    v_mfma_f32_16x16x32_bf16 v[76:79], v[252:255], v[24:27], v[76:79]
    s_waitcnt lgkmcnt(0)
    v_mfma_f32_16x16x32_bf16 v[80:83], v[172:175], v[28:31], v[80:83]
    v_mfma_f32_16x16x32_bf16 v[84:87], v[252:255], v[28:31], v[84:87]
    ds_read_b64 v[10:11], v7
    ds_read_b64 v[12:13], v8
    ds_read_b64 v[14:15], v9
    v_and_b32 v16, 15, v1
    v_lshrrev_b32 v17, 4, v1
    s_lshl_b32 s42, s3, 7
    s_add_u32 s42, s42, 46016
    v_lshl_add_u32 v19, v17, 4, s42
    s_lshl_b32 s42, s3, 6
    s_cmp_eq_u32 s3, 2
    s_cselect_b32 s42, 192, s42
    s_cmp_eq_u32 s3, 3
    s_cselect_b32 s42, 128, s42
    s_add_u32 s42, s42, 61440
    v_mul_u32_u24 v20, 496, v16
    v_lshl_add_u32 v20, v17, 4, v20
    v_add_u32 v20, s42, v20
    v_lshlrev_b32 v18, 3, v16
    v_add_u32 v18, 45376, v18
    s_waitcnt lgkmcnt(0)
    s_barrier
    ds_read_b64 v[24:25], v18 offset:0
    ds_read_b64 v[26:27], v18 offset:128
    ds_read_b64 v[28:29], v18 offset:256
    ds_read_b64 v[30:31], v18 offset:384
    ds_read_b64 v[32:33], v18 offset:512
    ds_read_b128 v[36:39], v19 offset:0
    ds_read_b128 v[40:43], v19 offset:64
    s_waitcnt lgkmcnt(0)
    v_fma_f32 v48, -v24, v36, v48
    v_fma_f32 v49, -v24, v37, v49
    v_fma_f32 v50, -v24, v38, v50
    v_fma_f32 v51, -v24, v39, v51
    v_fma_f32 v52, -v24, v40, v52
    v_fma_f32 v53, -v24, v41, v53
    v_fma_f32 v54, -v24, v42, v54
    v_fma_f32 v55, -v24, v43, v55
    v_fma_f32 v56, -v26, v36, v56
    v_fma_f32 v57, -v26, v37, v57
    v_fma_f32 v58, -v26, v38, v58
    v_fma_f32 v59, -v26, v39, v59
    v_fma_f32 v60, -v26, v40, v60
    v_fma_f32 v61, -v26, v41, v61
    v_fma_f32 v62, -v26, v42, v62
    v_fma_f32 v63, -v26, v43, v63
    v_fma_f32 v64, -v28, v36, v64
    v_fma_f32 v65, -v28, v37, v65
    v_fma_f32 v66, -v28, v38, v66
    v_fma_f32 v67, -v28, v39, v67
    v_fma_f32 v68, -v28, v40, v68
    v_fma_f32 v69, -v28, v41, v69
    v_fma_f32 v70, -v28, v42, v70
    v_fma_f32 v71, -v28, v43, v71
    v_fma_f32 v72, -v30, v36, v72
    v_fma_f32 v73, -v30, v37, v73
    v_fma_f32 v74, -v30, v38, v74
    v_fma_f32 v75, -v30, v39, v75
    v_fma_f32 v76, -v30, v40, v76
    v_fma_f32 v77, -v30, v41, v77
    v_fma_f32 v78, -v30, v42, v78
    v_fma_f32 v79, -v30, v43, v79
    v_fma_f32 v80, -v32, v36, v80
    v_fma_f32 v81, -v32, v37, v81
    v_fma_f32 v82, -v32, v38, v82
    v_fma_f32 v83, -v32, v39, v83
    v_fma_f32 v84, -v32, v40, v84
    v_fma_f32 v85, -v32, v41, v85
    v_fma_f32 v86, -v32, v42, v86
    v_fma_f32 v87, -v32, v43, v87
    v_mul_f32 v48, v48, v25
    v_mul_f32 v49, v49, v25
    v_mul_f32 v50, v50, v25
    v_mul_f32 v51, v51, v25
    v_mul_f32 v52, v52, v25
    v_mul_f32 v53, v53, v25
    v_mul_f32 v54, v54, v25
    v_mul_f32 v55, v55, v25
    v_mul_f32 v56, v56, v27
    v_mul_f32 v57, v57, v27
    v_mul_f32 v58, v58, v27
    v_mul_f32 v59, v59, v27
    v_mul_f32 v60, v60, v27
    v_mul_f32 v61, v61, v27
    v_mul_f32 v62, v62, v27
    v_mul_f32 v63, v63, v27
    v_mul_f32 v64, v64, v29
    v_mul_f32 v65, v65, v29
    v_mul_f32 v66, v66, v29
    v_mul_f32 v67, v67, v29
    v_mul_f32 v68, v68, v29
    v_mul_f32 v69, v69, v29
    v_mul_f32 v70, v70, v29
    v_mul_f32 v71, v71, v29
    v_mul_f32 v72, v72, v31
    v_mul_f32 v73, v73, v31
    v_mul_f32 v74, v74, v31
    v_mul_f32 v75, v75, v31
    v_mul_f32 v76, v76, v31
    v_mul_f32 v77, v77, v31
    v_mul_f32 v78, v78, v31
    v_mul_f32 v79, v79, v31
    v_mul_f32 v80, v80, v33
    v_mul_f32 v81, v81, v33
    v_mul_f32 v82, v82, v33
    v_mul_f32 v83, v83, v33
    v_mul_f32 v84, v84, v33
    v_mul_f32 v85, v85, v33
    v_mul_f32 v86, v86, v33
    v_mul_f32 v87, v87, v33
    v_cvt_pk_bf16_f32 v48, v48, v52
    v_cvt_pk_bf16_f32 v49, v49, v53
    v_cvt_pk_bf16_f32 v50, v50, v54
    v_cvt_pk_bf16_f32 v51, v51, v55
    ds_write_b128 v20, v[48:51] offset:0
    v_cvt_pk_bf16_f32 v56, v56, v60
    v_cvt_pk_bf16_f32 v57, v57, v61
    v_cvt_pk_bf16_f32 v58, v58, v62
    v_cvt_pk_bf16_f32 v59, v59, v63
    ds_write_b128 v20, v[56:59] offset:7936
    v_cvt_pk_bf16_f32 v64, v64, v68
    v_cvt_pk_bf16_f32 v65, v65, v69
    v_cvt_pk_bf16_f32 v66, v66, v70
    v_cvt_pk_bf16_f32 v67, v67, v71
    ds_write_b128 v20, v[64:67] offset:15872
    v_cvt_pk_bf16_f32 v72, v72, v76
    v_cvt_pk_bf16_f32 v73, v73, v77
    v_cvt_pk_bf16_f32 v74, v74, v78
    v_cvt_pk_bf16_f32 v75, v75, v79
    ds_write_b128 v20, v[72:75] offset:23808
    v_cvt_pk_bf16_f32 v80, v80, v84
    v_cvt_pk_bf16_f32 v81, v81, v85
    v_cvt_pk_bf16_f32 v82, v82, v86
    v_cvt_pk_bf16_f32 v83, v83, v87
    ds_write_b128 v20, v[80:83] offset:31744
    s_branch L_a1_post
L_g2A:
    s_waitcnt vmcnt(10)
    s_barrier
    ds_read_b64_tr_b16 v[16:17], v2 offset:32
    ds_read_b64_tr_b16 v[18:19], v2 offset:2592
    ds_read_b64_tr_b16 v[20:21], v2 offset:64
    ds_read_b64_tr_b16 v[22:23], v2 offset:2624
    ds_read_b64_tr_b16 v[24:25], v2 offset:96
    ds_read_b64_tr_b16 v[26:27], v2 offset:2656
    ds_read_b64_tr_b16 v[28:29], v2 offset:128
    ds_read_b64_tr_b16 v[30:31], v2 offset:2688
    ds_read_b64_tr_b16 v[32:33], v2 offset:5152
    ds_read_b64_tr_b16 v[34:35], v2 offset:7712
    ds_read_b64_tr_b16 v[36:37], v2 offset:5184
    ds_read_b64_tr_b16 v[38:39], v2 offset:7744
    ds_read_b64_tr_b16 v[40:41], v2 offset:5216
    ds_read_b64_tr_b16 v[42:43], v2 offset:7776
    ds_read_b64_tr_b16 v[44:45], v2 offset:5248
    ds_read_b64_tr_b16 v[46:47], v2 offset:7808
    s_waitcnt lgkmcnt(14)
    v_mfma_f32_16x16x32_bf16 v[48:51], v[96:99], v[16:19], 0
    v_mfma_f32_16x16x32_bf16 v[52:55], v[176:179], v[16:19], 0
    v_mfma_f32_16x16x32_bf16 v[56:59], v[16:19], v[16:19], 0
    v_mfma_f32_16x16x32_bf16 v[60:63], v[10:13], v[16:19], 0
    ds_read_b64_tr_b16 v[16:17], v2 offset:10272
    ds_read_b64_tr_b16 v[18:19], v2 offset:12832
    s_waitcnt lgkmcnt(14)
    v_mfma_f32_16x16x32_bf16 v[64:67], v[96:99], v[20:23], 0
    v_mfma_f32_16x16x32_bf16 v[68:71], v[176:179], v[20:23], 0
    ds_read_b64_tr_b16 v[20:21], v2 offset:10304
    ds_read_b64_tr_b16 v[22:23], v2 offset:12864
    s_waitcnt lgkmcnt(14)
    v_mfma_f32_16x16x32_bf16 v[72:75], v[96:99], v[24:27], 0
    v_mfma_f32_16x16x32_bf16 v[76:79], v[176:179], v[24:27], 0
    ds_read_b64_tr_b16 v[24:25], v2 offset:10336
    ds_read_b64_tr_b16 v[26:27], v2 offset:12896
    s_waitcnt lgkmcnt(14)
    v_mfma_f32_16x16x32_bf16 v[80:83], v[96:99], v[28:31], 0
    v_mfma_f32_16x16x32_bf16 v[84:87], v[176:179], v[28:31], 0
    ds_read_b64_tr_b16 v[28:29], v2 offset:10368
    ds_read_b64_tr_b16 v[30:31], v2 offset:12928
    s_waitcnt lgkmcnt(14)
    v_mfma_f32_16x16x32_bf16 v[48:51], v[100:103], v[32:35], v[48:51]
    v_mfma_f32_16x16x32_bf16 v[52:55], v[180:183], v[32:35], v[52:55]
    v_mfma_f32_16x16x32_bf16 v[56:59], v[32:35], v[32:35], v[56:59]
    v_mfma_f32_16x16x32_bf16 v[60:63], v[10:13], v[32:35], v[60:63]
    s_waitcnt vmcnt(7)
    s_barrier
    ds_read_b64_tr_b16 v[32:33], v2 offset:15392
    ds_read_b64_tr_b16 v[34:35], v2 offset:17952
    s_waitcnt lgkmcnt(14)
    v_mfma_f32_16x16x32_bf16 v[64:67], v[100:103], v[36:39], v[64:67]
    v_mfma_f32_16x16x32_bf16 v[68:71], v[180:183], v[36:39], v[68:71]
    ds_read_b64_tr_b16 v[36:37], v2 offset:15424
    ds_read_b64_tr_b16 v[38:39], v2 offset:17984
    s_waitcnt lgkmcnt(14)
    v_mfma_f32_16x16x32_bf16 v[72:75], v[100:103], v[40:43], v[72:75]
    v_mfma_f32_16x16x32_bf16 v[76:79], v[180:183], v[40:43], v[76:79]
    ds_read_b64_tr_b16 v[40:41], v2 offset:15456
    ds_read_b64_tr_b16 v[42:43], v2 offset:18016
    s_waitcnt lgkmcnt(14)
    v_mfma_f32_16x16x32_bf16 v[80:83], v[100:103], v[44:47], v[80:83]
    v_mfma_f32_16x16x32_bf16 v[84:87], v[180:183], v[44:47], v[84:87]
    ds_read_b64_tr_b16 v[44:45], v2 offset:15488
    ds_read_b64_tr_b16 v[46:47], v2 offset:18048
    s_waitcnt lgkmcnt(14)
    v_mfma_f32_16x16x32_bf16 v[48:51], v[104:107], v[16:19], v[48:51]
    v_mfma_f32_16x16x32_bf16 v[52:55], v[184:187], v[16:19], v[52:55]
    v_mfma_f32_16x16x32_bf16 v[56:59], v[16:19], v[16:19], v[56:59]
    v_mfma_f32_16x16x32_bf16 v[60:63], v[10:13], v[16:19], v[60:63]
    ds_read_b64_tr_b16 v[16:17], v2 offset:20512
    ds_read_b64_tr_b16 v[18:19], v2 offset:23072
    s_waitcnt lgkmcnt(14)
    v_mfma_f32_16x16x32_bf16 v[64:67], v[104:107], v[20:23], v[64:67]
    v_mfma_f32_16x16x32_bf16 v[68:71], v[184:187], v[20:23], v[68:71]
    ds_read_b64_tr_b16 v[20:21], v2 offset:20544
    ds_read_b64_tr_b16 v[22:23], v2 offset:23104
    s_waitcnt lgkmcnt(14)
    v_mfma_f32_16x16x32_bf16 v[72:75], v[104:107], v[24:27], v[72:75]
    v_mfma_f32_16x16x32_bf16 v[76:79], v[184:187], v[24:27], v[76:79]
    ds_read_b64_tr_b16 v[24:25], v2 offset:20576
    ds_read_b64_tr_b16 v[26:27], v2 offset:23136
    s_waitcnt lgkmcnt(14)
    v_mfma_f32_16x16x32_bf16 v[80:83], v[104:107], v[28:31], v[80:83]
    v_mfma_f32_16x16x32_bf16 v[84:87], v[184:187], v[28:31], v[84:87]
    ds_read_b64_tr_b16 v[28:29], v2 offset:20608
    ds_read_b64_tr_b16 v[30:31], v2 offset:23168
    s_waitcnt lgkmcnt(14)
    v_mfma_f32_16x16x32_bf16 v[48:51], v[108:111], v[32:35], v[48:51]
    v_mfma_f32_16x16x32_bf16 v[52:55], v[188:191], v[32:35], v[52:55]
    v_mfma_f32_16x16x32_bf16 v[56:59], v[32:35], v[32:35], v[56:59]
    v_mfma_f32_16x16x32_bf16 v[60:63], v[10:13], v[32:35], v[60:63]
    ds_read_b64_tr_b16 v[32:33], v2 offset:25632
    ds_read_b64_tr_b16 v[34:35], v2 offset:28192
    s_waitcnt lgkmcnt(14)
    v_mfma_f32_16x16x32_bf16 v[64:67], v[108:111], v[36:39], v[64:67]
    v_mfma_f32_16x16x32_bf16 v[68:71], v[188:191], v[36:39], v[68:71]
    ds_read_b64_tr_b16 v[36:37], v2 offset:25664
    ds_read_b64_tr_b16 v[38:39], v2 offset:28224
    s_waitcnt lgkmcnt(14)
    v_mfma_f32_16x16x32_bf16 v[72:75], v[108:111], v[40:43], v[72:75]
    v_mfma_f32_16x16x32_bf16 v[76:79], v[188:191], v[40:43], v[76:79]
    ds_read_b64_tr_b16 v[40:41], v2 offset:25696
    ds_read_b64_tr_b16 v[42:43], v2 offset:28256
    s_waitcnt lgkmcnt(14)
    v_mfma_f32_16x16x32_bf16 v[80:83], v[108:111], v[44:47], v[80:83]
    v_mfma_f32_16x16x32_bf16 v[84:87], v[188:191], v[44:47], v[84:87]
    ds_read_b64_tr_b16 v[44:45], v2 offset:25728
    ds_read_b64_tr_b16 v[46:47], v2 offset:28288
    s_waitcnt lgkmcnt(14)
    v_mfma_f32_16x16x32_bf16 v[48:51], v[112:115], v[16:19], v[48:51]
    v_mfma_f32_16x16x32_bf16 v[52:55], v[192:195], v[16:19], v[52:55]
    v_mfma_f32_16x16x32_bf16 v[56:59], v[16:19], v[16:19], v[56:59]
    v_mfma_f32_16x16x32_bf16 v[60:63], v[10:13], v[16:19], v[60:63]
    ds_read_b64_tr_b16 v[16:17], v2 offset:30752
    ds_read_b64_tr_b16 v[18:19], v2 offset:33312
    s_waitcnt lgkmcnt(14)
    v_mfma_f32_16x16x32_bf16 v[64:67], v[112:115], v[20:23], v[64:67]
    v_mfma_f32_16x16x32_bf16 v[68:71], v[192:195], v[20:23], v[68:71]
    ds_read_b64_tr_b16 v[20:21], v2 offset:30784
    ds_read_b64_tr_b16 v[22:23], v2 offset:33344
    s_waitcnt lgkmcnt(14)
    v_mfma_f32_16x16x32_bf16 v[72:75], v[112:115], v[24:27], v[72:75]
    v_mfma_f32_16x16x32_bf16 v[76:79], v[192:195], v[24:27], v[76:79]
    ds_read_b64_tr_b16 v[24:25], v2 offset:30816
    ds_read_b64_tr_b16 v[26:27], v2 offset:33376
    s_waitcnt lgkmcnt(14)
    v_mfma_f32_16x16x32_bf16 v[80:83], v[112:115], v[28:31], v[80:83]
    v_mfma_f32_16x16x32_bf16 v[84:87], v[192:195], v[28:31], v[84:87]
    ds_read_b64_tr_b16 v[28:29], v2 offset:30848
    ds_read_b64_tr_b16 v[30:31], v2 offset:33408
    s_waitcnt lgkmcnt(14)
    v_mfma_f32_16x16x32_bf16 v[48:51], v[116:119], v[32:35], v[48:51]
    v_mfma_f32_16x16x32_bf16 v[52:55], v[196:199], v[32:35], v[52:55]
    v_mfma_f32_16x16x32_bf16 v[56:59], v[32:35], v[32:35], v[56:59]
    v_mfma_f32_16x16x32_bf16 v[60:63], v[10:13], v[32:35], v[60:63]
    ds_read_b64_tr_b16 v[32:33], v2 offset:35872
    ds_read_b64_tr_b16 v[34:35], v2 offset:38432
    s_waitcnt lgkmcnt(14)
    v_mfma_f32_16x16x32_bf16 v[64:67], v[116:119], v[36:39], v[64:67]
    v_mfma_f32_16x16x32_bf16 v[68:71], v[196:199], v[36:39], v[68:71]
    ds_read_b64_tr_b16 v[36:37], v2 offset:35904
    ds_read_b64_tr_b16 v[38:39], v2 offset:38464
    s_waitcnt lgkmcnt(14)
    v_mfma_f32_16x16x32_bf16 v[72:75], v[116:119], v[40:43], v[72:75]
    v_mfma_f32_16x16x32_bf16 v[76:79], v[196:199], v[40:43], v[76:79]
    ds_read_b64_tr_b16 v[40:41], v2 offset:35936
    ds_read_b64_tr_b16 v[42:43], v2 offset:38496
    s_waitcnt lgkmcnt(14)
    v_mfma_f32_16x16x32_bf16 v[80:83], v[116:119], v[44:47], v[80:83]
    v_mfma_f32_16x16x32_bf16 v[84:87], v[196:199], v[44:47], v[84:87]
    ds_read_b64_tr_b16 v[44:45], v2 offset:35968
    ds_read_b64_tr_b16 v[46:47], v2 offset:38528
    s_waitcnt lgkmcnt(14)
    v_mfma_f32_16x16x32_bf16 v[48:51], v[120:123], v[16:19], v[48:51]
    v_mfma_f32_16x16x32_bf16 v[52:55], v[200:203], v[16:19], v[52:55]
    v_mfma_f32_16x16x32_bf16 v[56:59], v[16:19], v[16:19], v[56:59]
    v_mfma_f32_16x16x32_bf16 v[60:63], v[10:13], v[16:19], v[60:63]
    s_waitcnt vmcnt(3)
    s_barrier
    ds_read_b64_tr_b16 v[16:17], v2 offset:40992
    ds_read_b64_tr_b16 v[18:19], v2 offset:43552
    s_waitcnt lgkmcnt(14)
    v_mfma_f32_16x16x32_bf16 v[64:67], v[120:123], v[20:23], v[64:67]
    v_mfma_f32_16x16x32_bf16 v[68:71], v[200:203], v[20:23], v[68:71]
    ds_read_b64_tr_b16 v[20:21], v2 offset:41024
    ds_read_b64_tr_b16 v[22:23], v2 offset:43584
    s_waitcnt lgkmcnt(14)
    v_mfma_f32_16x16x32_bf16 v[72:75], v[120:123], v[24:27], v[72:75]
    v_mfma_f32_16x16x32_bf16 v[76:79], v[200:203], v[24:27], v[76:79]
    ds_read_b64_tr_b16 v[24:25], v2 offset:41056
    ds_read_b64_tr_b16 v[26:27], v2 offset:43616
    s_waitcnt lgkmcnt(14)
    v_mfma_f32_16x16x32_bf16 v[80:83], v[120:123], v[28:31], v[80:83]
    v_mfma_f32_16x16x32_bf16 v[84:87], v[200:203], v[28:31], v[84:87]
    ds_read_b64_tr_b16 v[28:29], v2 offset:41088
    ds_read_b64_tr_b16 v[30:31], v2 offset:43648
    s_waitcnt lgkmcnt(14)
    v_mfma_f32_16x16x32_bf16 v[48:51], v[124:127], v[32:35], v[48:51]
    v_mfma_f32_16x16x32_bf16 v[52:55], v[204:207], v[32:35], v[52:55]
    v_mfma_f32_16x16x32_bf16 v[56:59], v[32:35], v[32:35], v[56:59]
    v_mfma_f32_16x16x32_bf16 v[60:63], v[10:13], v[32:35], v[60:63]
    ds_read_b64_tr_b16 v[32:33], v2 offset:46112
    ds_read_b64_tr_b16 v[34:35], v2 offset:48672
    s_waitcnt lgkmcnt(14)
    v_mfma_f32_16x16x32_bf16 v[64:67], v[124:127], v[36:39], v[64:67]
    v_mfma_f32_16x16x32_bf16 v[68:71], v[204:207], v[36:39], v[68:71]
    ds_read_b64_tr_b16 v[36:37], v2 offset:46144
    ds_read_b64_tr_b16 v[38:39], v2 offset:48704
    s_waitcnt lgkmcnt(14)
    v_mfma_f32_16x16x32_bf16 v[72:75], v[124:127], v[40:43], v[72:75]
    v_mfma_f32_16x16x32_bf16 v[76:79], v[204:207], v[40:43], v[76:79]
    ds_read_b64_tr_b16 v[40:41], v2 offset:46176
    ds_read_b64_tr_b16 v[42:43], v2 offset:48736
    s_waitcnt lgkmcnt(14)
    v_mfma_f32_16x16x32_bf16 v[80:83], v[124:127], v[44:47], v[80:83]
    v_mfma_f32_16x16x32_bf16 v[84:87], v[204:207], v[44:47], v[84:87]
    ds_read_b64_tr_b16 v[44:45], v2 offset:46208
    ds_read_b64_tr_b16 v[46:47], v2 offset:48768
    s_waitcnt lgkmcnt(14)
    v_mfma_f32_16x16x32_bf16 v[48:51], v[128:131], v[16:19], v[48:51]
    v_mfma_f32_16x16x32_bf16 v[52:55], v[208:211], v[16:19], v[52:55]
    v_mfma_f32_16x16x32_bf16 v[56:59], v[16:19], v[16:19], v[56:59]
    v_mfma_f32_16x16x32_bf16 v[60:63], v[10:13], v[16:19], v[60:63]
    ds_read_b64_tr_b16 v[16:17], v2 offset:51232
    ds_read_b64_tr_b16 v[18:19], v2 offset:53792
    s_waitcnt lgkmcnt(14)
    v_mfma_f32_16x16x32_bf16 v[64:67], v[128:131], v[20:23], v[64:67]
    v_mfma_f32_16x16x32_bf16 v[68:71], v[208:211], v[20:23], v[68:71]
    ds_read_b64_tr_b16 v[20:21], v2 offset:51264
    ds_read_b64_tr_b16 v[22:23], v2 offset:53824
    s_waitcnt lgkmcnt(14)
    v_mfma_f32_16x16x32_bf16 v[72:75], v[128:131], v[24:27], v[72:75]
    v_mfma_f32_16x16x32_bf16 v[76:79], v[208:211], v[24:27], v[76:79]
    ds_read_b64_tr_b16 v[24:25], v2 offset:51296
    ds_read_b64_tr_b16 v[26:27], v2 offset:53856
    s_waitcnt lgkmcnt(14)
    v_mfma_f32_16x16x32_bf16 v[80:83], v[128:131], v[28:31], v[80:83]
    v_mfma_f32_16x16x32_bf16 v[84:87], v[208:211], v[28:31], v[84:87]
    ds_read_b64_tr_b16 v[28:29], v2 offset:51328
    ds_read_b64_tr_b16 v[30:31], v2 offset:53888
    s_waitcnt lgkmcnt(14)
    v_mfma_f32_16x16x32_bf16 v[48:51], v[132:135], v[32:35], v[48:51]
    v_mfma_f32_16x16x32_bf16 v[52:55], v[212:215], v[32:35], v[52:55]
    v_mfma_f32_16x16x32_bf16 v[56:59], v[32:35], v[32:35], v[56:59]
    v_mfma_f32_16x16x32_bf16 v[60:63], v[10:13], v[32:35], v[60:63]
    ds_read_b64_tr_b16 v[32:33], v2 offset:56352
    ds_read_b64_tr_b16 v[34:35], v2 offset:58912
    s_waitcnt lgkmcnt(14)
    v_mfma_f32_16x16x32_bf16 v[64:67], v[132:135], v[36:39], v[64:67]
    v_mfma_f32_16x16x32_bf16 v[68:71], v[212:215], v[36:39], v[68:71]
    ds_read_b64_tr_b16 v[36:37], v2 offset:56384
    ds_read_b64_tr_b16 v[38:39], v2 offset:58944
    s_waitcnt lgkmcnt(14)
    v_mfma_f32_16x16x32_bf16 v[72:75], v[132:135], v[40:43], v[72:75]
    v_mfma_f32_16x16x32_bf16 v[76:79], v[212:215], v[40:43], v[76:79]
    ds_read_b64_tr_b16 v[40:41], v2 offset:56416
    ds_read_b64_tr_b16 v[42:43], v2 offset:58976
    s_waitcnt lgkmcnt(14)
    v_mfma_f32_16x16x32_bf16 v[80:83], v[132:135], v[44:47], v[80:83]
    v_mfma_f32_16x16x32_bf16 v[84:87], v[212:215], v[44:47], v[84:87]
    ds_read_b64_tr_b16 v[44:45], v2 offset:56448
    ds_read_b64_tr_b16 v[46:47], v2 offset:59008
    s_waitcnt lgkmcnt(14)
    v_mfma_f32_16x16x32_bf16 v[48:51], v[136:139], v[16:19], v[48:51]
    v_mfma_f32_16x16x32_bf16 v[52:55], v[216:219], v[16:19], v[52:55]
    v_mfma_f32_16x16x32_bf16 v[56:59], v[16:19], v[16:19], v[56:59]
    v_mfma_f32_16x16x32_bf16 v[60:63], v[10:13], v[16:19], v[60:63]
    ds_read_b64_tr_b16 v[16:17], v3 offset:32
    ds_read_b64_tr_b16 v[18:19], v3 offset:2592
    s_waitcnt lgkmcnt(14)
    v_mfma_f32_16x16x32_bf16 v[64:67], v[136:139], v[20:23], v[64:67]
    v_mfma_f32_16x16x32_bf16 v[68:71], v[216:219], v[20:23], v[68:71]
    ds_read_b64_tr_b16 v[20:21], v3 offset:64
    ds_read_b64_tr_b16 v[22:23], v3 offset:2624
    s_waitcnt lgkmcnt(14)
    v_mfma_f32_16x16x32_bf16 v[72:75], v[136:139], v[24:27], v[72:75]
    v_mfma_f32_16x16x32_bf16 v[76:79], v[216:219], v[24:27], v[76:79]
    ds_read_b64_tr_b16 v[24:25], v3 offset:96
    ds_read_b64_tr_b16 v[26:27], v3 offset:2656
    s_waitcnt lgkmcnt(14)
    v_mfma_f32_16x16x32_bf16 v[80:83], v[136:139], v[28:31], v[80:83]
    v_mfma_f32_16x16x32_bf16 v[84:87], v[216:219], v[28:31], v[84:87]
    ds_read_b64_tr_b16 v[28:29], v3 offset:128
    ds_read_b64_tr_b16 v[30:31], v3 offset:2688
    s_waitcnt lgkmcnt(14)
    v_mfma_f32_16x16x32_bf16 v[48:51], v[140:143], v[32:35], v[48:51]
    v_mfma_f32_16x16x32_bf16 v[52:55], v[220:223], v[32:35], v[52:55]
    v_mfma_f32_16x16x32_bf16 v[56:59], v[32:35], v[32:35], v[56:59]
    v_mfma_f32_16x16x32_bf16 v[60:63], v[10:13], v[32:35], v[60:63]
    ds_read_b64_tr_b16 v[32:33], v3 offset:5152
    ds_read_b64_tr_b16 v[34:35], v3 offset:7712
    s_waitcnt lgkmcnt(14)
    v_mfma_f32_16x16x32_bf16 v[64:67], v[140:143], v[36:39], v[64:67]
    v_mfma_f32_16x16x32_bf16 v[68:71], v[220:223], v[36:39], v[68:71]
    ds_read_b64_tr_b16 v[36:37], v3 offset:5184
    ds_read_b64_tr_b16 v[38:39], v3 offset:7744
    s_waitcnt lgkmcnt(14)
    v_mfma_f32_16x16x32_bf16 v[72:75], v[140:143], v[40:43], v[72:75]
    v_mfma_f32_16x16x32_bf16 v[76:79], v[220:223], v[40:43], v[76:79]
    ds_read_b64_tr_b16 v[40:41], v3 offset:5216
    ds_read_b64_tr_b16 v[42:43], v3 offset:7776
    s_waitcnt lgkmcnt(14)
    v_mfma_f32_16x16x32_bf16 v[80:83], v[140:143], v[44:47], v[80:83]
    v_mfma_f32_16x16x32_bf16 v[84:87], v[220:223], v[44:47], v[84:87]
    ds_read_b64_tr_b16 v[44:45], v3 offset:5248
    ds_read_b64_tr_b16 v[46:47], v3 offset:7808
    s_waitcnt lgkmcnt(14)
    v_mfma_f32_16x16x32_bf16 v[48:51], v[144:147], v[16:19], v[48:51]
    v_mfma_f32_16x16x32_bf16 v[52:55], v[224:227], v[16:19], v[52:55]
    v_mfma_f32_16x16x32_bf16 v[56:59], v[16:19], v[16:19], v[56:59]
    v_mfma_f32_16x16x32_bf16 v[60:63], v[10:13], v[16:19], v[60:63]
    s_waitcnt vmcnt(0)
    s_barrier
    ds_read_b64_tr_b16 v[16:17], v3 offset:10272
    ds_read_b64_tr_b16 v[18:19], v3 offset:12832
    s_waitcnt lgkmcnt(14)
    v_mfma_f32_16x16x32_bf16 v[64:67], v[144:147], v[20:23], v[64:67]
    v_mfma_f32_16x16x32_bf16 v[68:71], v[224:227], v[20:23], v[68:71]
    ds_read_b64_tr_b16 v[20:21], v3 offset:10304
    ds_read_b64_tr_b16 v[22:23], v3 offset:12864
    s_waitcnt lgkmcnt(14)
    v_mfma_f32_16x16x32_bf16 v[72:75], v[144:147], v[24:27], v[72:75]
    v_mfma_f32_16x16x32_bf16 v[76:79], v[224:227], v[24:27], v[76:79]
    ds_read_b64_tr_b16 v[24:25], v3 offset:10336
    ds_read_b64_tr_b16 v[26:27], v3 offset:12896
    s_waitcnt lgkmcnt(14)
    v_mfma_f32_16x16x32_bf16 v[80:83], v[144:147], v[28:31], v[80:83]
    v_mfma_f32_16x16x32_bf16 v[84:87], v[224:227], v[28:31], v[84:87]
    ds_read_b64_tr_b16 v[28:29], v3 offset:10368
    ds_read_b64_tr_b16 v[30:31], v3 offset:12928
    s_waitcnt lgkmcnt(14)
    v_mfma_f32_16x16x32_bf16 v[48:51], v[148:151], v[32:35], v[48:51]
    v_mfma_f32_16x16x32_bf16 v[52:55], v[228:231], v[32:35], v[52:55]
    v_mfma_f32_16x16x32_bf16 v[56:59], v[32:35], v[32:35], v[56:59]
    v_mfma_f32_16x16x32_bf16 v[60:63], v[10:13], v[32:35], v[60:63]
    ds_read_b64_tr_b16 v[32:33], v3 offset:15392
    ds_read_b64_tr_b16 v[34:35], v3 offset:17952
    s_waitcnt lgkmcnt(14)
    v_mfma_f32_16x16x32_bf16 v[64:67], v[148:151], v[36:39], v[64:67]
    v_mfma_f32_16x16x32_bf16 v[68:71], v[228:231], v[36:39], v[68:71]
    ds_read_b64_tr_b16 v[36:37], v3 offset:15424
    ds_read_b64_tr_b16 v[38:39], v3 offset:17984
    s_waitcnt lgkmcnt(14)
    v_mfma_f32_16x16x32_bf16 v[72:75], v[148:151], v[40:43], v[72:75]
    v_mfma_f32_16x16x32_bf16 v[76:79], v[228:231], v[40:43], v[76:79]
    ds_read_b64_tr_b16 v[40:41], v3 offset:15456
    ds_read_b64_tr_b16 v[42:43], v3 offset:18016
    s_waitcnt lgkmcnt(14)
    v_mfma_f32_16x16x32_bf16 v[80:83], v[148:151], v[44:47], v[80:83]
    v_mfma_f32_16x16x32_bf16 v[84:87], v[228:231], v[44:47], v[84:87]
    ds_read_b64_tr_b16 v[44:45], v3 offset:15488
    ds_read_b64_tr_b16 v[46:47], v3 offset:18048
    s_waitcnt lgkmcnt(14)
    v_mfma_f32_16x16x32_bf16 v[48:51], v[152:155], v[16:19], v[48:51]
    v_mfma_f32_16x16x32_bf16 v[52:55], v[232:235], v[16:19], v[52:55]
    v_mfma_f32_16x16x32_bf16 v[56:59], v[16:19], v[16:19], v[56:59]
    v_mfma_f32_16x16x32_bf16 v[60:63], v[10:13], v[16:19], v[60:63]
    ds_read_b64_tr_b16 v[16:17], v3 offset:20512
    ds_read_b64_tr_b16 v[18:19], v3 offset:23072
    s_waitcnt lgkmcnt(14)
    v_mfma_f32_16x16x32_bf16 v[64:67], v[152:155], v[20:23], v[64:67]
    v_mfma_f32_16x16x32_bf16 v[68:71], v[232:235], v[20:23], v[68:71]
    ds_read_b64_tr_b16 v[20:21], v3 offset:20544
    ds_read_b64_tr_b16 v[22:23], v3 offset:23104
    s_waitcnt lgkmcnt(14)
    v_mfma_f32_16x16x32_bf16 v[72:75], v[152:155], v[24:27], v[72:75]
    v_mfma_f32_16x16x32_bf16 v[76:79], v[232:235], v[24:27], v[76:79]
    ds_read_b64_tr_b16 v[24:25], v3 offset:20576
    ds_read_b64_tr_b16 v[26:27], v3 offset:23136
    s_waitcnt lgkmcnt(14)
    v_mfma_f32_16x16x32_bf16 v[80:83], v[152:155], v[28:31], v[80:83]
    v_mfma_f32_16x16x32_bf16 v[84:87], v[232:235], v[28:31], v[84:87]
    ds_read_b64_tr_b16 v[28:29], v3 offset:20608
    ds_read_b64_tr_b16 v[30:31], v3 offset:23168
    s_waitcnt lgkmcnt(14)
    v_mfma_f32_16x16x32_bf16 v[48:51], v[156:159], v[32:35], v[48:51]
    v_mfma_f32_16x16x32_bf16 v[52:55], v[236:239], v[32:35], v[52:55]
    v_mfma_f32_16x16x32_bf16 v[56:59], v[32:35], v[32:35], v[56:59]
    v_mfma_f32_16x16x32_bf16 v[60:63], v[10:13], v[32:35], v[60:63]
    ds_read_b64_tr_b16 v[32:33], v3 offset:25632
    ds_read_b64_tr_b16 v[34:35], v3 offset:28192
    s_waitcnt lgkmcnt(14)
    v_mfma_f32_16x16x32_bf16 v[64:67], v[156:159], v[36:39], v[64:67]
    v_mfma_f32_16x16x32_bf16 v[68:71], v[236:239], v[36:39], v[68:71]
    ds_read_b64_tr_b16 v[36:37], v3 offset:25664
    ds_read_b64_tr_b16 v[38:39], v3 offset:28224
    s_waitcnt lgkmcnt(14)
    v_mfma_f32_16x16x32_bf16 v[72:75], v[156:159], v[40:43], v[72:75]
    v_mfma_f32_16x16x32_bf16 v[76:79], v[236:239], v[40:43], v[76:79]
    ds_read_b64_tr_b16 v[40:41], v3 offset:25696
    ds_read_b64_tr_b16 v[42:43], v3 offset:28256
    s_waitcnt lgkmcnt(14)
    v_mfma_f32_16x16x32_bf16 v[80:83], v[156:159], v[44:47], v[80:83]
    v_mfma_f32_16x16x32_bf16 v[84:87], v[236:239], v[44:47], v[84:87]
    ds_read_b64_tr_b16 v[44:45], v3 offset:25728
    ds_read_b64_tr_b16 v[46:47], v3 offset:28288
    s_waitcnt lgkmcnt(14)
    v_mfma_f32_16x16x32_bf16 v[48:51], v[160:163], v[16:19], v[48:51]
    v_mfma_f32_16x16x32_bf16 v[52:55], v[240:243], v[16:19], v[52:55]
    v_mfma_f32_16x16x32_bf16 v[56:59], v[16:19], v[16:19], v[56:59]
    v_mfma_f32_16x16x32_bf16 v[60:63], v[10:13], v[16:19], v[60:63]
    ds_read_b64_tr_b16 v[16:17], v3 offset:30752
    ds_read_b64_tr_b16 v[18:19], v3 offset:33312
    s_waitcnt lgkmcnt(14)
    v_mfma_f32_16x16x32_bf16 v[64:67], v[160:163], v[20:23], v[64:67]
    v_mfma_f32_16x16x32_bf16 v[68:71], v[240:243], v[20:23], v[68:71]
    ds_read_b64_tr_b16 v[20:21], v3 offset:30784
    ds_read_b64_tr_b16 v[22:23], v3 offset:33344
    s_waitcnt lgkmcnt(14)
    v_mfma_f32_16x16x32_bf16 v[72:75], v[160:163], v[24:27], v[72:75]
    v_mfma_f32_16x16x32_bf16 v[76:79], v[240:243], v[24:27], v[76:79]
    ds_read_b64_tr_b16 v[24:25], v3 offset:30816
    ds_read_b64_tr_b16 v[26:27], v3 offset:33376
    s_waitcnt lgkmcnt(14)
    v_mfma_f32_16x16x32_bf16 v[80:83], v[160:163], v[28:31], v[80:83]
    v_mfma_f32_16x16x32_bf16 v[84:87], v[240:243], v[28:31], v[84:87]
    ds_read_b64_tr_b16 v[28:29], v3 offset:30848
    ds_read_b64_tr_b16 v[30:31], v3 offset:33408
    s_waitcnt lgkmcnt(14)
    v_mfma_f32_16x16x32_bf16 v[48:51], v[164:167], v[32:35], v[48:51]
    v_mfma_f32_16x16x32_bf16 v[52:55], v[244:247], v[32:35], v[52:55]
    v_mfma_f32_16x16x32_bf16 v[56:59], v[32:35], v[32:35], v[56:59]
    v_mfma_f32_16x16x32_bf16 v[60:63], v[10:13], v[32:35], v[60:63]
    ds_read_b64_tr_b16 v[32:33], v3 offset:35872
    ds_read_b64_tr_b16 v[34:35], v3 offset:38432
    s_waitcnt lgkmcnt(14)
    v_mfma_f32_16x16x32_bf16 v[64:67], v[164:167], v[36:39], v[64:67]
    v_mfma_f32_16x16x32_bf16 v[68:71], v[244:247], v[36:39], v[68:71]
    ds_read_b64_tr_b16 v[36:37], v3 offset:35904
    ds_read_b64_tr_b16 v[38:39], v3 offset:38464
    s_waitcnt lgkmcnt(14)
    v_mfma_f32_16x16x32_bf16 v[72:75], v[164:167], v[40:43], v[72:75]
    v_mfma_f32_16x16x32_bf16 v[76:79], v[244:247], v[40:43], v[76:79]
    ds_read_b64_tr_b16 v[40:41], v3 offset:35936
    ds_read_b64_tr_b16 v[42:43], v3 offset:38496
    s_waitcnt lgkmcnt(14)
    v_mfma_f32_16x16x32_bf16 v[80:83], v[164:167], v[44:47], v[80:83]
    v_mfma_f32_16x16x32_bf16 v[84:87], v[244:247], v[44:47], v[84:87]
    ds_read_b64_tr_b16 v[44:45], v3 offset:35968
    ds_read_b64_tr_b16 v[46:47], v3 offset:38528
    s_waitcnt lgkmcnt(14)
    v_mfma_f32_16x16x32_bf16 v[48:51], v[168:171], v[16:19], v[48:51]
    v_mfma_f32_16x16x32_bf16 v[52:55], v[248:251], v[16:19], v[52:55]
    v_mfma_f32_16x16x32_bf16 v[56:59], v[16:19], v[16:19], v[56:59]
    v_mfma_f32_16x16x32_bf16 v[60:63], v[10:13], v[16:19], v[60:63]
    s_waitcnt lgkmcnt(12)
    v_mfma_f32_16x16x32_bf16 v[64:67], v[168:171], v[20:23], v[64:67]
    v_mfma_f32_16x16x32_bf16 v[68:71], v[248:251], v[20:23], v[68:71]
    s_waitcnt lgkmcnt(10)
    v_mfma_f32_16x16x32_bf16 v[72:75], v[168:171], v[24:27], v[72:75]
    v_mfma_f32_16x16x32_bf16 v[76:79], v[248:251], v[24:27], v[76:79]
    s_waitcnt lgkmcnt(8)
    v_mfma_f32_16x16x32_bf16 v[80:83], v[168:171], v[28:31], v[80:83]
    v_mfma_f32_16x16x32_bf16 v[84:87], v[248:251], v[28:31], v[84:87]
    s_waitcnt lgkmcnt(6)
    v_mfma_f32_16x16x32_bf16 v[48:51], v[172:175], v[32:35], v[48:51]
    v_mfma_f32_16x16x32_bf16 v[52:55], v[252:255], v[32:35], v[52:55]
    v_mfma_f32_16x16x32_bf16 v[56:59], v[32:35], v[32:35], v[56:59]
    v_mfma_f32_16x16x32_bf16 v[60:63], v[10:13], v[32:35], v[60:63]
    s_waitcnt lgkmcnt(4)
    v_mfma_f32_16x16x32_bf16 v[64:67], v[172:175], v[36:39], v[64:67]
    v_mfma_f32_16x16x32_bf16 v[68:71], v[252:255], v[36:39], v[68:71]
    s_waitcnt lgkmcnt(2)
    v_mfma_f32_16x16x32_bf16 v[72:75], v[172:175], v[40:43], v[72:75]
    v_mfma_f32_16x16x32_bf16 v[76:79], v[252:255], v[40:43], v[76:79]
    s_waitcnt lgkmcnt(0)
    v_mfma_f32_16x16x32_bf16 v[80:83], v[172:175], v[44:47], v[80:83]
    v_mfma_f32_16x16x32_bf16 v[84:87], v[252:255], v[44:47], v[84:87]
    ds_read_b64 v[10:11], v7
    ds_read_b64 v[12:13], v8
    ds_read_b64 v[14:15], v9
    v_and_b32 v16, 15, v1
    v_lshrrev_b32 v17, 4, v1
    v_and_b32 v18, 3, v1
    v_lshrrev_b32 v19, 2, v16
    v_cmp_eq_u32 s[42:43], 1, v18
    v_cmp_eq_u32 s[44:45], 2, v18
    v_cmp_eq_u32 s[46:47], 3, v18
    v_cmp_eq_u32 s[48:49], v19, v17
    v_lshlrev_b32 v18, 3, v16
    v_add_u32 v18, 45376, v18
    v_cndmask_b32 v56, v56, v57, s[42:43]
    v_cndmask_b32 v56, v56, v58, s[44:45]
    v_cndmask_b32 v56, v56, v59, s[46:47]
    v_mul_f32 v60, 0x3acccccd, v60
    v_mul_f32 v56, 0x3acccccd, v56
    v_fma_f32 v56, -v60, v60, v56
    v_max_f32 v56, 0, v56
    v_cvt_pk_bf16_f32 v60, v60, v56
    v_and_b32 v56, 0xffff0000, v60
    v_lshlrev_b32 v60, 16, v60
    v_add_f32 v56, 0x3727c5ac, v56
    v_cvt_pk_bf16_f32 v56, v56, v56
    v_lshlrev_b32 v56, 16, v56
    v_sqrt_f32 v56, v56
    s_nop 0
    v_cvt_pk_bf16_f32 v56, v56, v56
    v_lshlrev_b32 v56, 16, v56
    v_rcp_f32 v61, v56
    s_mov_b64 exec, s[48:49]
    ds_write_b64 v18, v[60:61] offset:128
    s_mov_b64 exec, -1
    s_lshl_b32 s42, s3, 7
    s_add_u32 s42, s42, 46016
    v_lshl_add_u32 v19, v17, 4, s42
    s_lshl_b32 s42, s3, 6
    s_cmp_eq_u32 s3, 2
    s_cselect_b32 s42, 192, s42
    s_cmp_eq_u32 s3, 3
    s_cselect_b32 s42, 128, s42
    s_add_u32 s42, s42, 61440
    v_mul_u32_u24 v20, 496, v16
    v_lshl_add_u32 v20, v17, 4, v20
    v_add_u32 v20, s42, v20
    v_lshlrev_b32 v18, 3, v16
    v_add_u32 v18, 45376, v18
    s_waitcnt lgkmcnt(0)
    s_barrier
    ds_read_b64 v[26:27], v18 offset:128
    ds_read_b64 v[28:29], v18 offset:256
    ds_read_b64 v[30:31], v18 offset:384
    ds_read_b64 v[32:33], v18 offset:512
    ds_read_b128 v[36:39], v19 offset:0
    ds_read_b128 v[40:43], v19 offset:64
    s_waitcnt lgkmcnt(0)
    v_fma_f32 v48, -v26, v36, v48
    v_fma_f32 v49, -v26, v37, v49
    v_fma_f32 v50, -v26, v38, v50
    v_fma_f32 v51, -v26, v39, v51
    v_fma_f32 v52, -v26, v40, v52
    v_fma_f32 v53, -v26, v41, v53
    v_fma_f32 v54, -v26, v42, v54
    v_fma_f32 v55, -v26, v43, v55
    v_fma_f32 v64, -v28, v36, v64
    v_fma_f32 v65, -v28, v37, v65
    v_fma_f32 v66, -v28, v38, v66
    v_fma_f32 v67, -v28, v39, v67
    v_fma_f32 v68, -v28, v40, v68
    v_fma_f32 v69, -v28, v41, v69
    v_fma_f32 v70, -v28, v42, v70
    v_fma_f32 v71, -v28, v43, v71
    v_fma_f32 v72, -v30, v36, v72
    v_fma_f32 v73, -v30, v37, v73
    v_fma_f32 v74, -v30, v38, v74
    v_fma_f32 v75, -v30, v39, v75
    v_fma_f32 v76, -v30, v40, v76
    v_fma_f32 v77, -v30, v41, v77
    v_fma_f32 v78, -v30, v42, v78
    v_fma_f32 v79, -v30, v43, v79
    v_fma_f32 v80, -v32, v36, v80
    v_fma_f32 v81, -v32, v37, v81
    v_fma_f32 v82, -v32, v38, v82
    v_fma_f32 v83, -v32, v39, v83
    v_fma_f32 v84, -v32, v40, v84
    v_fma_f32 v85, -v32, v41, v85
    v_fma_f32 v86, -v32, v42, v86
    v_fma_f32 v87, -v32, v43, v87
    v_mul_f32 v48, v48, v27
    v_mul_f32 v49, v49, v27
    v_mul_f32 v50, v50, v27
    v_mul_f32 v51, v51, v27
    v_mul_f32 v52, v52, v27
    v_mul_f32 v53, v53, v27
    v_mul_f32 v54, v54, v27
    v_mul_f32 v55, v55, v27
    v_mul_f32 v64, v64, v29
    v_mul_f32 v65, v65, v29
    v_mul_f32 v66, v66, v29
    v_mul_f32 v67, v67, v29
    v_mul_f32 v68, v68, v29
    v_mul_f32 v69, v69, v29
    v_mul_f32 v70, v70, v29
    v_mul_f32 v71, v71, v29
    v_mul_f32 v72, v72, v31
    v_mul_f32 v73, v73, v31
    v_mul_f32 v74, v74, v31
    v_mul_f32 v75, v75, v31
    v_mul_f32 v76, v76, v31
    v_mul_f32 v77, v77, v31
    v_mul_f32 v78, v78, v31
    v_mul_f32 v79, v79, v31
    v_mul_f32 v80, v80, v33
    v_mul_f32 v81, v81, v33
    v_mul_f32 v82, v82, v33
    v_mul_f32 v83, v83, v33
    v_mul_f32 v84, v84, v33
    v_mul_f32 v85, v85, v33
    v_mul_f32 v86, v86, v33
    v_mul_f32 v87, v87, v33
    v_cvt_pk_bf16_f32 v48, v48, v52
    v_cvt_pk_bf16_f32 v49, v49, v53
    v_cvt_pk_bf16_f32 v50, v50, v54
    v_cvt_pk_bf16_f32 v51, v51, v55
    ds_write_b128 v20, v[48:51] offset:7936
    v_cvt_pk_bf16_f32 v64, v64, v68
    v_cvt_pk_bf16_f32 v65, v65, v69
    v_cvt_pk_bf16_f32 v66, v66, v70
    v_cvt_pk_bf16_f32 v67, v67, v71
    ds_write_b128 v20, v[64:67] offset:15872
    v_cvt_pk_bf16_f32 v72, v72, v76
    v_cvt_pk_bf16_f32 v73, v73, v77
    v_cvt_pk_bf16_f32 v74, v74, v78
    v_cvt_pk_bf16_f32 v75, v75, v79
    ds_write_b128 v20, v[72:75] offset:23808
    v_cvt_pk_bf16_f32 v80, v80, v84
    v_cvt_pk_bf16_f32 v81, v81, v85
    v_cvt_pk_bf16_f32 v82, v82, v86
    v_cvt_pk_bf16_f32 v83, v83, v87
    ds_write_b128 v20, v[80:83] offset:31744
    s_branch L_a1_post
L_g2B:
    s_waitcnt vmcnt(10)
    s_barrier
    ds_read_b64_tr_b16 v[16:17], v2 offset:32
    ds_read_b64_tr_b16 v[18:19], v2 offset:2592
    ds_read_b64_tr_b16 v[20:21], v2 offset:64
    ds_read_b64_tr_b16 v[22:23], v2 offset:2624
    ds_read_b64_tr_b16 v[24:25], v2 offset:96
    ds_read_b64_tr_b16 v[26:27], v2 offset:2656
    ds_read_b64_tr_b16 v[28:29], v2 offset:128
    ds_read_b64_tr_b16 v[30:31], v2 offset:2688
    ds_read_b64_tr_b16 v[32:33], v2 offset:5152
    ds_read_b64_tr_b16 v[34:35], v2 offset:7712
    ds_read_b64_tr_b16 v[36:37], v2 offset:5184
    ds_read_b64_tr_b16 v[38:39], v2 offset:7744
    ds_read_b64_tr_b16 v[40:41], v2 offset:5216
    ds_read_b64_tr_b16 v[42:43], v2 offset:7776
    ds_read_b64_tr_b16 v[44:45], v2 offset:5248
    ds_read_b64_tr_b16 v[46:47], v2 offset:7808
    s_waitcnt lgkmcnt(14)
    v_mfma_f32_16x16x32_bf16 v[48:51], v[96:99], v[16:19], 0
    v_mfma_f32_16x16x32_bf16 v[52:55], v[176:179], v[16:19], 0
    ds_read_b64_tr_b16 v[16:17], v2 offset:10272
    ds_read_b64_tr_b16 v[18:19], v2 offset:12832
    s_waitcnt lgkmcnt(14)
    v_mfma_f32_16x16x32_bf16 v[56:59], v[96:99], v[20:23], 0
    v_mfma_f32_16x16x32_bf16 v[60:63], v[176:179], v[20:23], 0
    v_mfma_f32_16x16x32_bf16 v[64:67], v[20:23], v[20:23], 0
    v_mfma_f32_16x16x32_bf16 v[68:71], v[10:13], v[20:23], 0
    ds_read_b64_tr_b16 v[20:21], v2 offset:10304
    ds_read_b64_tr_b16 v[22:23], v2 offset:12864
    s_waitcnt lgkmcnt(14)
    v_mfma_f32_16x16x32_bf16 v[72:75], v[96:99], v[24:27], 0
    v_mfma_f32_16x16x32_bf16 v[76:79], v[176:179], v[24:27], 0
    ds_read_b64_tr_b16 v[24:25], v2 offset:10336
    ds_read_b64_tr_b16 v[26:27], v2 offset:12896
    s_waitcnt lgkmcnt(14)
    v_mfma_f32_16x16x32_bf16 v[80:83], v[96:99], v[28:31], 0
    v_mfma_f32_16x16x32_bf16 v[84:87], v[176:179], v[28:31], 0
    ds_read_b64_tr_b16 v[28:29], v2 offset:10368
    ds_read_b64_tr_b16 v[30:31], v2 offset:12928
    s_waitcnt lgkmcnt(14)
    v_mfma_f32_16x16x32_bf16 v[48:51], v[100:103], v[32:35], v[48:51]
    v_mfma_f32_16x16x32_bf16 v[52:55], v[180:183], v[32:35], v[52:55]
    s_waitcnt vmcnt(7)
    s_barrier
    ds_read_b64_tr_b16 v[32:33], v2 offset:15392
    ds_read_b64_tr_b16 v[34:35], v2 offset:17952
    s_waitcnt lgkmcnt(14)
    v_mfma_f32_16x16x32_bf16 v[56:59], v[100:103], v[36:39], v[56:59]
    v_mfma_f32_16x16x32_bf16 v[60:63], v[180:183], v[36:39], v[60:63]
    v_mfma_f32_16x16x32_bf16 v[64:67], v[36:39], v[36:39], v[64:67]
    v_mfma_f32_16x16x32_bf16 v[68:71], v[10:13], v[36:39], v[68:71]
    ds_read_b64_tr_b16 v[36:37], v2 offset:15424
    ds_read_b64_tr_b16 v[38:39], v2 offset:17984
    s_waitcnt lgkmcnt(14)
    v_mfma_f32_16x16x32_bf16 v[72:75], v[100:103], v[40:43], v[72:75]
    v_mfma_f32_16x16x32_bf16 v[76:79], v[180:183], v[40:43], v[76:79]
    ds_read_b64_tr_b16 v[40:41], v2 offset:15456
    ds_read_b64_tr_b16 v[42:43], v2 offset:18016
    s_waitcnt lgkmcnt(14)
    v_mfma_f32_16x16x32_bf16 v[80:83], v[100:103], v[44:47], v[80:83]
    v_mfma_f32_16x16x32_bf16 v[84:87], v[180:183], v[44:47], v[84:87]
    ds_read_b64_tr_b16 v[44:45], v2 offset:15488
    ds_read_b64_tr_b16 v[46:47], v2 offset:18048
    s_waitcnt lgkmcnt(14)
    v_mfma_f32_16x16x32_bf16 v[48:51], v[104:107], v[16:19], v[48:51]
    v_mfma_f32_16x16x32_bf16 v[52:55], v[184:187], v[16:19], v[52:55]
    ds_read_b64_tr_b16 v[16:17], v2 offset:20512
    ds_read_b64_tr_b16 v[18:19], v2 offset:23072
    s_waitcnt lgkmcnt(14)
    v_mfma_f32_16x16x32_bf16 v[56:59], v[104:107], v[20:23], v[56:59]
    v_mfma_f32_16x16x32_bf16 v[60:63], v[184:187], v[20:23], v[60:63]
    v_mfma_f32_16x16x32_bf16 v[64:67], v[20:23], v[20:23], v[64:67]
    v_mfma_f32_16x16x32_bf16 v[68:71], v[10:13], v[20:23], v[68:71]
    ds_read_b64_tr_b16 v[20:21], v2 offset:20544
    ds_read_b64_tr_b16 v[22:23], v2 offset:23104
    s_waitcnt lgkmcnt(14)
    v_mfma_f32_16x16x32_bf16 v[72:75], v[104:107], v[24:27], v[72:75]
    v_mfma_f32_16x16x32_bf16 v[76:79], v[184:187], v[24:27], v[76:79]
    ds_read_b64_tr_b16 v[24:25], v2 offset:20576
    ds_read_b64_tr_b16 v[26:27], v2 offset:23136
    s_waitcnt lgkmcnt(14)
    v_mfma_f32_16x16x32_bf16 v[80:83], v[104:107], v[28:31], v[80:83]
    v_mfma_f32_16x16x32_bf16 v[84:87], v[184:187], v[28:31], v[84:87]
    ds_read_b64_tr_b16 v[28:29], v2 offset:20608
    ds_read_b64_tr_b16 v[30:31], v2 offset:23168
    s_waitcnt lgkmcnt(14)
    v_mfma_f32_16x16x32_bf16 v[48:51], v[108:111], v[32:35], v[48:51]
    v_mfma_f32_16x16x32_bf16 v[52:55], v[188:191], v[32:35], v[52:55]
    ds_read_b64_tr_b16 v[32:33], v2 offset:25632
    ds_read_b64_tr_b16 v[34:35], v2 offset:28192
    s_waitcnt lgkmcnt(14)
    v_mfma_f32_16x16x32_bf16 v[56:59], v[108:111], v[36:39], v[56:59]
    v_mfma_f32_16x16x32_bf16 v[60:63], v[188:191], v[36:39], v[60:63]
    v_mfma_f32_16x16x32_bf16 v[64:67], v[36:39], v[36:39], v[64:67]
    v_mfma_f32_16x16x32_bf16 v[68:71], v[10:13], v[36:39], v[68:71]
    ds_read_b64_tr_b16 v[36:37], v2 offset:25664
    ds_read_b64_tr_b16 v[38:39], v2 offset:28224
    s_waitcnt lgkmcnt(14)
    v_mfma_f32_16x16x32_bf16 v[72:75], v[108:111], v[40:43], v[72:75]
    v_mfma_f32_16x16x32_bf16 v[76:79], v[188:191], v[40:43], v[76:79]
    ds_read_b64_tr_b16 v[40:41], v2 offset:25696
    ds_read_b64_tr_b16 v[42:43], v2 offset:28256
    s_waitcnt lgkmcnt(14)
    v_mfma_f32_16x16x32_bf16 v[80:83], v[108:111], v[44:47], v[80:83]
    v_mfma_f32_16x16x32_bf16 v[84:87], v[188:191], v[44:47], v[84:87]
    ds_read_b64_tr_b16 v[44:45], v2 offset:25728
    ds_read_b64_tr_b16 v[46:47], v2 offset:28288
    s_waitcnt lgkmcnt(14)
    v_mfma_f32_16x16x32_bf16 v[48:51], v[112:115], v[16:19], v[48:51]
    v_mfma_f32_16x16x32_bf16 v[52:55], v[192:195], v[16:19], v[52:55]
    ds_read_b64_tr_b16 v[16:17], v2 offset:30752
    ds_read_b64_tr_b16 v[18:19], v2 offset:33312
    s_waitcnt lgkmcnt(14)
    v_mfma_f32_16x16x32_bf16 v[56:59], v[112:115], v[20:23], v[56:59]
    v_mfma_f32_16x16x32_bf16 v[60:63], v[192:195], v[20:23], v[60:63]
    v_mfma_f32_16x16x32_bf16 v[64:67], v[20:23], v[20:23], v[64:67]
    v_mfma_f32_16x16x32_bf16 v[68:71], v[10:13], v[20:23], v[68:71]
    ds_read_b64_tr_b16 v[20:21], v2 offset:30784
    ds_read_b64_tr_b16 v[22:23], v2 offset:33344
    s_waitcnt lgkmcnt(14)
    v_mfma_f32_16x16x32_bf16 v[72:75], v[112:115], v[24:27], v[72:75]
    v_mfma_f32_16x16x32_bf16 v[76:79], v[192:195], v[24:27], v[76:79]
    ds_read_b64_tr_b16 v[24:25], v2 offset:30816
    ds_read_b64_tr_b16 v[26:27], v2 offset:33376
    s_waitcnt lgkmcnt(14)
    v_mfma_f32_16x16x32_bf16 v[80:83], v[112:115], v[28:31], v[80:83]
    v_mfma_f32_16x16x32_bf16 v[84:87], v[192:195], v[28:31], v[84:87]
    ds_read_b64_tr_b16 v[28:29], v2 offset:30848
    ds_read_b64_tr_b16 v[30:31], v2 offset:33408
    s_waitcnt lgkmcnt(14)
    v_mfma_f32_16x16x32_bf16 v[48:51], v[116:119], v[32:35], v[48:51]
    v_mfma_f32_16x16x32_bf16 v[52:55], v[196:199], v[32:35], v[52:55]
    ds_read_b64_tr_b16 v[32:33], v2 offset:35872
    ds_read_b64_tr_b16 v[34:35], v2 offset:38432
    s_waitcnt lgkmcnt(14)
    v_mfma_f32_16x16x32_bf16 v[56:59], v[116:119], v[36:39], v[56:59]
    v_mfma_f32_16x16x32_bf16 v[60:63], v[196:199], v[36:39], v[60:63]
    v_mfma_f32_16x16x32_bf16 v[64:67], v[36:39], v[36:39], v[64:67]
    v_mfma_f32_16x16x32_bf16 v[68:71], v[10:13], v[36:39], v[68:71]
    ds_read_b64_tr_b16 v[36:37], v2 offset:35904
    ds_read_b64_tr_b16 v[38:39], v2 offset:38464
    s_waitcnt lgkmcnt(14)
    v_mfma_f32_16x16x32_bf16 v[72:75], v[116:119], v[40:43], v[72:75]
    v_mfma_f32_16x16x32_bf16 v[76:79], v[196:199], v[40:43], v[76:79]
    ds_read_b64_tr_b16 v[40:41], v2 offset:35936
    ds_read_b64_tr_b16 v[42:43], v2 offset:38496
    s_waitcnt lgkmcnt(14)
    v_mfma_f32_16x16x32_bf16 v[80:83], v[116:119], v[44:47], v[80:83]
    v_mfma_f32_16x16x32_bf16 v[84:87], v[196:199], v[44:47], v[84:87]
    ds_read_b64_tr_b16 v[44:45], v2 offset:35968
    ds_read_b64_tr_b16 v[46:47], v2 offset:38528
    s_waitcnt lgkmcnt(14)
    v_mfma_f32_16x16x32_bf16 v[48:51], v[120:123], v[16:19], v[48:51]
    v_mfma_f32_16x16x32_bf16 v[52:55], v[200:203], v[16:19], v[52:55]
    s_waitcnt vmcnt(3)
    s_barrier
    ds_read_b64_tr_b16 v[16:17], v2 offset:40992
    ds_read_b64_tr_b16 v[18:19], v2 offset:43552
    s_waitcnt lgkmcnt(14)
    v_mfma_f32_16x16x32_bf16 v[56:59], v[120:123], v[20:23], v[56:59]
    v_mfma_f32_16x16x32_bf16 v[60:63], v[200:203], v[20:23], v[60:63]
    v_mfma_f32_16x16x32_bf16 v[64:67], v[20:23], v[20:23], v[64:67]
    v_mfma_f32_16x16x32_bf16 v[68:71], v[10:13], v[20:23], v[68:71]
    ds_read_b64_tr_b16 v[20:21], v2 offset:41024
    ds_read_b64_tr_b16 v[22:23], v2 offset:43584
    s_waitcnt lgkmcnt(14)
    v_mfma_f32_16x16x32_bf16 v[72:75], v[120:123], v[24:27], v[72:75]
    v_mfma_f32_16x16x32_bf16 v[76:79], v[200:203], v[24:27], v[76:79]
    ds_read_b64_tr_b16 v[24:25], v2 offset:41056
    ds_read_b64_tr_b16 v[26:27], v2 offset:43616
    s_waitcnt lgkmcnt(14)
    v_mfma_f32_16x16x32_bf16 v[80:83], v[120:123], v[28:31], v[80:83]
    v_mfma_f32_16x16x32_bf16 v[84:87], v[200:203], v[28:31], v[84:87]
    ds_read_b64_tr_b16 v[28:29], v2 offset:41088
    ds_read_b64_tr_b16 v[30:31], v2 offset:43648
    s_waitcnt lgkmcnt(14)
    v_mfma_f32_16x16x32_bf16 v[48:51], v[124:127], v[32:35], v[48:51]
    v_mfma_f32_16x16x32_bf16 v[52:55], v[204:207], v[32:35], v[52:55]
    ds_read_b64_tr_b16 v[32:33], v2 offset:46112
    ds_read_b64_tr_b16 v[34:35], v2 offset:48672
    s_waitcnt lgkmcnt(14)
    v_mfma_f32_16x16x32_bf16 v[56:59], v[124:127], v[36:39], v[56:59]
    v_mfma_f32_16x16x32_bf16 v[60:63], v[204:207], v[36:39], v[60:63]
    v_mfma_f32_16x16x32_bf16 v[64:67], v[36:39], v[36:39], v[64:67]
    v_mfma_f32_16x16x32_bf16 v[68:71], v[10:13], v[36:39], v[68:71]
    ds_read_b64_tr_b16 v[36:37], v2 offset:46144
    ds_read_b64_tr_b16 v[38:39], v2 offset:48704
    s_waitcnt lgkmcnt(14)
    v_mfma_f32_16x16x32_bf16 v[72:75], v[124:127], v[40:43], v[72:75]
    v_mfma_f32_16x16x32_bf16 v[76:79], v[204:207], v[40:43], v[76:79]
    ds_read_b64_tr_b16 v[40:41], v2 offset:46176
    ds_read_b64_tr_b16 v[42:43], v2 offset:48736
    s_waitcnt lgkmcnt(14)
    v_mfma_f32_16x16x32_bf16 v[80:83], v[124:127], v[44:47], v[80:83]
    v_mfma_f32_16x16x32_bf16 v[84:87], v[204:207], v[44:47], v[84:87]
    ds_read_b64_tr_b16 v[44:45], v2 offset:46208
    ds_read_b64_tr_b16 v[46:47], v2 offset:48768
    s_waitcnt lgkmcnt(14)
    v_mfma_f32_16x16x32_bf16 v[48:51], v[128:131], v[16:19], v[48:51]
    v_mfma_f32_16x16x32_bf16 v[52:55], v[208:211], v[16:19], v[52:55]
    ds_read_b64_tr_b16 v[16:17], v2 offset:51232
    ds_read_b64_tr_b16 v[18:19], v2 offset:53792
    s_waitcnt lgkmcnt(14)
    v_mfma_f32_16x16x32_bf16 v[56:59], v[128:131], v[20:23], v[56:59]
    v_mfma_f32_16x16x32_bf16 v[60:63], v[208:211], v[20:23], v[60:63]
    v_mfma_f32_16x16x32_bf16 v[64:67], v[20:23], v[20:23], v[64:67]
    v_mfma_f32_16x16x32_bf16 v[68:71], v[10:13], v[20:23], v[68:71]
    ds_read_b64_tr_b16 v[20:21], v2 offset:51264
    ds_read_b64_tr_b16 v[22:23], v2 offset:53824
    s_waitcnt lgkmcnt(14)
    v_mfma_f32_16x16x32_bf16 v[72:75], v[128:131], v[24:27], v[72:75]
    v_mfma_f32_16x16x32_bf16 v[76:79], v[208:211], v[24:27], v[76:79]
    ds_read_b64_tr_b16 v[24:25], v2 offset:51296
    ds_read_b64_tr_b16 v[26:27], v2 offset:53856
    s_waitcnt lgkmcnt(14)
    v_mfma_f32_16x16x32_bf16 v[80:83], v[128:131], v[28:31], v[80:83]
    v_mfma_f32_16x16x32_bf16 v[84:87], v[208:211], v[28:31], v[84:87]
    ds_read_b64_tr_b16 v[28:29], v2 offset:51328
    ds_read_b64_tr_b16 v[30:31], v2 offset:53888
    s_waitcnt lgkmcnt(14)
    v_mfma_f32_16x16x32_bf16 v[48:51], v[132:135], v[32:35], v[48:51]
    v_mfma_f32_16x16x32_bf16 v[52:55], v[212:215], v[32:35], v[52:55]
    ds_read_b64_tr_b16 v[32:33], v2 offset:56352
    ds_read_b64_tr_b16 v[34:35], v2 offset:58912
    s_waitcnt lgkmcnt(14)
    v_mfma_f32_16x16x32_bf16 v[56:59], v[132:135], v[36:39], v[56:59]
    v_mfma_f32_16x16x32_bf16 v[60:63], v[212:215], v[36:39], v[60:63]
    v_mfma_f32_16x16x32_bf16 v[64:67], v[36:39], v[36:39], v[64:67]
    v_mfma_f32_16x16x32_bf16 v[68:71], v[10:13], v[36:39], v[68:71]
    ds_read_b64_tr_b16 v[36:37], v2 offset:56384
    ds_read_b64_tr_b16 v[38:39], v2 offset:58944
    s_waitcnt lgkmcnt(14)
    v_mfma_f32_16x16x32_bf16 v[72:75], v[132:135], v[40:43], v[72:75]
    v_mfma_f32_16x16x32_bf16 v[76:79], v[212:215], v[40:43], v[76:79]
    ds_read_b64_tr_b16 v[40:41], v2 offset:56416
    ds_read_b64_tr_b16 v[42:43], v2 offset:58976
    s_waitcnt lgkmcnt(14)
    v_mfma_f32_16x16x32_bf16 v[80:83], v[132:135], v[44:47], v[80:83]
    v_mfma_f32_16x16x32_bf16 v[84:87], v[212:215], v[44:47], v[84:87]
    ds_read_b64_tr_b16 v[44:45], v2 offset:56448
    ds_read_b64_tr_b16 v[46:47], v2 offset:59008
    s_waitcnt lgkmcnt(14)
    v_mfma_f32_16x16x32_bf16 v[48:51], v[136:139], v[16:19], v[48:51]
    v_mfma_f32_16x16x32_bf16 v[52:55], v[216:219], v[16:19], v[52:55]
    ds_read_b64_tr_b16 v[16:17], v3 offset:32
    ds_read_b64_tr_b16 v[18:19], v3 offset:2592
    s_waitcnt lgkmcnt(14)
    v_mfma_f32_16x16x32_bf16 v[56:59], v[136:139], v[20:23], v[56:59]
    v_mfma_f32_16x16x32_bf16 v[60:63], v[216:219], v[20:23], v[60:63]
    v_mfma_f32_16x16x32_bf16 v[64:67], v[20:23], v[20:23], v[64:67]
    v_mfma_f32_16x16x32_bf16 v[68:71], v[10:13], v[20:23], v[68:71]
    ds_read_b64_tr_b16 v[20:21], v3 offset:64
    ds_read_b64_tr_b16 v[22:23], v3 offset:2624
    s_waitcnt lgkmcnt(14)
    v_mfma_f32_16x16x32_bf16 v[72:75], v[136:139], v[24:27], v[72:75]
    v_mfma_f32_16x16x32_bf16 v[76:79], v[216:219], v[24:27], v[76:79]
    ds_read_b64_tr_b16 v[24:25], v3 offset:96
    ds_read_b64_tr_b16 v[26:27], v3 offset:2656
    s_waitcnt lgkmcnt(14)
    v_mfma_f32_16x16x32_bf16 v[80:83], v[136:139], v[28:31], v[80:83]
    v_mfma_f32_16x16x32_bf16 v[84:87], v[216:219], v[28:31], v[84:87]
    ds_read_b64_tr_b16 v[28:29], v3 offset:128
    ds_read_b64_tr_b16 v[30:31], v3 offset:2688
    s_waitcnt lgkmcnt(14)
    v_mfma_f32_16x16x32_bf16 v[48:51], v[140:143], v[32:35], v[48:51]
    v_mfma_f32_16x16x32_bf16 v[52:55], v[220:223], v[32:35], v[52:55]
    ds_read_b64_tr_b16 v[32:33], v3 offset:5152
    ds_read_b64_tr_b16 v[34:35], v3 offset:7712
    s_waitcnt lgkmcnt(14)
    v_mfma_f32_16x16x32_bf16 v[56:59], v[140:143], v[36:39], v[56:59]
    v_mfma_f32_16x16x32_bf16 v[60:63], v[220:223], v[36:39], v[60:63]
    v_mfma_f32_16x16x32_bf16 v[64:67], v[36:39], v[36:39], v[64:67]
    v_mfma_f32_16x16x32_bf16 v[68:71], v[10:13], v[36:39], v[68:71]
    ds_read_b64_tr_b16 v[36:37], v3 offset:5184
    ds_read_b64_tr_b16 v[38:39], v3 offset:7744
    s_waitcnt lgkmcnt(14)
    v_mfma_f32_16x16x32_bf16 v[72:75], v[140:143], v[40:43], v[72:75]
    v_mfma_f32_16x16x32_bf16 v[76:79], v[220:223], v[40:43], v[76:79]
    ds_read_b64_tr_b16 v[40:41], v3 offset:5216
    ds_read_b64_tr_b16 v[42:43], v3 offset:7776
    s_waitcnt lgkmcnt(14)
    v_mfma_f32_16x16x32_bf16 v[80:83], v[140:143], v[44:47], v[80:83]
    v_mfma_f32_16x16x32_bf16 v[84:87], v[220:223], v[44:47], v[84:87]
    ds_read_b64_tr_b16 v[44:45], v3 offset:5248
    ds_read_b64_tr_b16 v[46:47], v3 offset:7808
    s_waitcnt lgkmcnt(14)
    v_mfma_f32_16x16x32_bf16 v[48:51], v[144:147], v[16:19], v[48:51]
    v_mfma_f32_16x16x32_bf16 v[52:55], v[224:227], v[16:19], v[52:55]
    s_waitcnt vmcnt(0)
    s_barrier
    ds_read_b64_tr_b16 v[16:17], v3 offset:10272
    ds_read_b64_tr_b16 v[18:19], v3 offset:12832
    s_waitcnt lgkmcnt(14)
    v_mfma_f32_16x16x32_bf16 v[56:59], v[144:147], v[20:23], v[56:59]
    v_mfma_f32_16x16x32_bf16 v[60:63], v[224:227], v[20:23], v[60:63]
    v_mfma_f32_16x16x32_bf16 v[64:67], v[20:23], v[20:23], v[64:67]
    v_mfma_f32_16x16x32_bf16 v[68:71], v[10:13], v[20:23], v[68:71]
    ds_read_b64_tr_b16 v[20:21], v3 offset:10304
    ds_read_b64_tr_b16 v[22:23], v3 offset:12864
    s_waitcnt lgkmcnt(14)
    v_mfma_f32_16x16x32_bf16 v[72:75], v[144:147], v[24:27], v[72:75]
    v_mfma_f32_16x16x32_bf16 v[76:79], v[224:227], v[24:27], v[76:79]
    ds_read_b64_tr_b16 v[24:25], v3 offset:10336
    ds_read_b64_tr_b16 v[26:27], v3 offset:12896
    s_waitcnt lgkmcnt(14)
    v_mfma_f32_16x16x32_bf16 v[80:83], v[144:147], v[28:31], v[80:83]
    v_mfma_f32_16x16x32_bf16 v[84:87], v[224:227], v[28:31], v[84:87]
    ds_read_b64_tr_b16 v[28:29], v3 offset:10368
    ds_read_b64_tr_b16 v[30:31], v3 offset:12928
    s_waitcnt lgkmcnt(14)
    v_mfma_f32_16x16x32_bf16 v[48:51], v[148:151], v[32:35], v[48:51]
    v_mfma_f32_16x16x32_bf16 v[52:55], v[228:231], v[32:35], v[52:55]
    ds_read_b64_tr_b16 v[32:33], v3 offset:15392
    ds_read_b64_tr_b16 v[34:35], v3 offset:17952
    s_waitcnt lgkmcnt(14)
    v_mfma_f32_16x16x32_bf16 v[56:59], v[148:151], v[36:39], v[56:59]
    v_mfma_f32_16x16x32_bf16 v[60:63], v[228:231], v[36:39], v[60:63]
    v_mfma_f32_16x16x32_bf16 v[64:67], v[36:39], v[36:39], v[64:67]
    v_mfma_f32_16x16x32_bf16 v[68:71], v[10:13], v[36:39], v[68:71]
    ds_read_b64_tr_b16 v[36:37], v3 offset:15424
    ds_read_b64_tr_b16 v[38:39], v3 offset:17984
    s_waitcnt lgkmcnt(14)
    v_mfma_f32_16x16x32_bf16 v[72:75], v[148:151], v[40:43], v[72:75]
    v_mfma_f32_16x16x32_bf16 v[76:79], v[228:231], v[40:43], v[76:79]
    ds_read_b64_tr_b16 v[40:41], v3 offset:15456
    ds_read_b64_tr_b16 v[42:43], v3 offset:18016
    s_waitcnt lgkmcnt(14)
    v_mfma_f32_16x16x32_bf16 v[80:83], v[148:151], v[44:47], v[80:83]
    v_mfma_f32_16x16x32_bf16 v[84:87], v[228:231], v[44:47], v[84:87]
    ds_read_b64_tr_b16 v[44:45], v3 offset:15488
    ds_read_b64_tr_b16 v[46:47], v3 offset:18048
    s_waitcnt lgkmcnt(14)
    v_mfma_f32_16x16x32_bf16 v[48:51], v[152:155], v[16:19], v[48:51]
    v_mfma_f32_16x16x32_bf16 v[52:55], v[232:235], v[16:19], v[52:55]
    ds_read_b64_tr_b16 v[16:17], v3 offset:20512
    ds_read_b64_tr_b16 v[18:19], v3 offset:23072
    s_waitcnt lgkmcnt(14)
    v_mfma_f32_16x16x32_bf16 v[56:59], v[152:155], v[20:23], v[56:59]
    v_mfma_f32_16x16x32_bf16 v[60:63], v[232:235], v[20:23], v[60:63]
    v_mfma_f32_16x16x32_bf16 v[64:67], v[20:23], v[20:23], v[64:67]
    v_mfma_f32_16x16x32_bf16 v[68:71], v[10:13], v[20:23], v[68:71]
    ds_read_b64_tr_b16 v[20:21], v3 offset:20544
    ds_read_b64_tr_b16 v[22:23], v3 offset:23104
    s_waitcnt lgkmcnt(14)
    v_mfma_f32_16x16x32_bf16 v[72:75], v[152:155], v[24:27], v[72:75]
    v_mfma_f32_16x16x32_bf16 v[76:79], v[232:235], v[24:27], v[76:79]
    ds_read_b64_tr_b16 v[24:25], v3 offset:20576
    ds_read_b64_tr_b16 v[26:27], v3 offset:23136
    s_waitcnt lgkmcnt(14)
    v_mfma_f32_16x16x32_bf16 v[80:83], v[152:155], v[28:31], v[80:83]
    v_mfma_f32_16x16x32_bf16 v[84:87], v[232:235], v[28:31], v[84:87]
    ds_read_b64_tr_b16 v[28:29], v3 offset:20608
    ds_read_b64_tr_b16 v[30:31], v3 offset:23168
    s_waitcnt lgkmcnt(14)
    v_mfma_f32_16x16x32_bf16 v[48:51], v[156:159], v[32:35], v[48:51]
    v_mfma_f32_16x16x32_bf16 v[52:55], v[236:239], v[32:35], v[52:55]
    ds_read_b64_tr_b16 v[32:33], v3 offset:25632
    ds_read_b64_tr_b16 v[34:35], v3 offset:28192
    s_waitcnt lgkmcnt(14)
    v_mfma_f32_16x16x32_bf16 v[56:59], v[156:159], v[36:39], v[56:59]
    v_mfma_f32_16x16x32_bf16 v[60:63], v[236:239], v[36:39], v[60:63]
    v_mfma_f32_16x16x32_bf16 v[64:67], v[36:39], v[36:39], v[64:67]
    v_mfma_f32_16x16x32_bf16 v[68:71], v[10:13], v[36:39], v[68:71]
    ds_read_b64_tr_b16 v[36:37], v3 offset:25664
    ds_read_b64_tr_b16 v[38:39], v3 offset:28224
    s_waitcnt lgkmcnt(14)
    v_mfma_f32_16x16x32_bf16 v[72:75], v[156:159], v[40:43], v[72:75]
    v_mfma_f32_16x16x32_bf16 v[76:79], v[236:239], v[40:43], v[76:79]
    ds_read_b64_tr_b16 v[40:41], v3 offset:25696
    ds_read_b64_tr_b16 v[42:43], v3 offset:28256
    s_waitcnt lgkmcnt(14)
    v_mfma_f32_16x16x32_bf16 v[80:83], v[156:159], v[44:47], v[80:83]
    v_mfma_f32_16x16x32_bf16 v[84:87], v[236:239], v[44:47], v[84:87]
    ds_read_b64_tr_b16 v[44:45], v3 offset:25728
    ds_read_b64_tr_b16 v[46:47], v3 offset:28288
    s_waitcnt lgkmcnt(14)
    v_mfma_f32_16x16x32_bf16 v[48:51], v[160:163], v[16:19], v[48:51]
    v_mfma_f32_16x16x32_bf16 v[52:55], v[240:243], v[16:19], v[52:55]
    ds_read_b64_tr_b16 v[16:17], v3 offset:30752
    ds_read_b64_tr_b16 v[18:19], v3 offset:33312
    s_waitcnt lgkmcnt(14)
    v_mfma_f32_16x16x32_bf16 v[56:59], v[160:163], v[20:23], v[56:59]
    v_mfma_f32_16x16x32_bf16 v[60:63], v[240:243], v[20:23], v[60:63]
    v_mfma_f32_16x16x32_bf16 v[64:67], v[20:23], v[20:23], v[64:67]
    v_mfma_f32_16x16x32_bf16 v[68:71], v[10:13], v[20:23], v[68:71]
    ds_read_b64_tr_b16 v[20:21], v3 offset:30784
    ds_read_b64_tr_b16 v[22:23], v3 offset:33344
    s_waitcnt lgkmcnt(14)
    v_mfma_f32_16x16x32_bf16 v[72:75], v[160:163], v[24:27], v[72:75]
    v_mfma_f32_16x16x32_bf16 v[76:79], v[240:243], v[24:27], v[76:79]
    ds_read_b64_tr_b16 v[24:25], v3 offset:30816
    ds_read_b64_tr_b16 v[26:27], v3 offset:33376
    s_waitcnt lgkmcnt(14)
    v_mfma_f32_16x16x32_bf16 v[80:83], v[160:163], v[28:31], v[80:83]
    v_mfma_f32_16x16x32_bf16 v[84:87], v[240:243], v[28:31], v[84:87]
    ds_read_b64_tr_b16 v[28:29], v3 offset:30848
    ds_read_b64_tr_b16 v[30:31], v3 offset:33408
    s_waitcnt lgkmcnt(14)
    v_mfma_f32_16x16x32_bf16 v[48:51], v[164:167], v[32:35], v[48:51]
    v_mfma_f32_16x16x32_bf16 v[52:55], v[244:247], v[32:35], v[52:55]
    ds_read_b64_tr_b16 v[32:33], v3 offset:35872
    ds_read_b64_tr_b16 v[34:35], v3 offset:38432
    s_waitcnt lgkmcnt(14)
    v_mfma_f32_16x16x32_bf16 v[56:59], v[164:167], v[36:39], v[56:59]
    v_mfma_f32_16x16x32_bf16 v[60:63], v[244:247], v[36:39], v[60:63]
    v_mfma_f32_16x16x32_bf16 v[64:67], v[36:39], v[36:39], v[64:67]
    v_mfma_f32_16x16x32_bf16 v[68:71], v[10:13], v[36:39], v[68:71]
    ds_read_b64_tr_b16 v[36:37], v3 offset:35904
    ds_read_b64_tr_b16 v[38:39], v3 offset:38464
    s_waitcnt lgkmcnt(14)
    v_mfma_f32_16x16x32_bf16 v[72:75], v[164:167], v[40:43], v[72:75]
    v_mfma_f32_16x16x32_bf16 v[76:79], v[244:247], v[40:43], v[76:79]
    ds_read_b64_tr_b16 v[40:41], v3 offset:35936
    ds_read_b64_tr_b16 v[42:43], v3 offset:38496
    s_waitcnt lgkmcnt(14)
    v_mfma_f32_16x16x32_bf16 v[80:83], v[164:167], v[44:47], v[80:83]
    v_mfma_f32_16x16x32_bf16 v[84:87], v[244:247], v[44:47], v[84:87]
    ds_read_b64_tr_b16 v[44:45], v3 offset:35968
    ds_read_b64_tr_b16 v[46:47], v3 offset:38528
    s_waitcnt lgkmcnt(14)
    v_mfma_f32_16x16x32_bf16 v[48:51], v[168:171], v[16:19], v[48:51]
    v_mfma_f32_16x16x32_bf16 v[52:55], v[248:251], v[16:19], v[52:55]
    s_waitcnt lgkmcnt(12)
    v_mfma_f32_16x16x32_bf16 v[56:59], v[168:171], v[20:23], v[56:59]
    v_mfma_f32_16x16x32_bf16 v[60:63], v[248:251], v[20:23], v[60:63]
    v_mfma_f32_16x16x32_bf16 v[64:67], v[20:23], v[20:23], v[64:67]
    v_mfma_f32_16x16x32_bf16 v[68:71], v[10:13], v[20:23], v[68:71]
    s_waitcnt lgkmcnt(10)
    v_mfma_f32_16x16x32_bf16 v[72:75], v[168:171], v[24:27], v[72:75]
    v_mfma_f32_16x16x32_bf16 v[76:79], v[248:251], v[24:27], v[76:79]
    s_waitcnt lgkmcnt(8)
    v_mfma_f32_16x16x32_bf16 v[80:83], v[168:171], v[28:31], v[80:83]
    v_mfma_f32_16x16x32_bf16 v[84:87], v[248:251], v[28:31], v[84:87]
    s_waitcnt lgkmcnt(6)
    v_mfma_f32_16x16x32_bf16 v[48:51], v[172:175], v[32:35], v[48:51]
    v_mfma_f32_16x16x32_bf16 v[52:55], v[252:255], v[32:35], v[52:55]
    s_waitcnt lgkmcnt(4)
    v_mfma_f32_16x16x32_bf16 v[56:59], v[172:175], v[36:39], v[56:59]
    v_mfma_f32_16x16x32_bf16 v[60:63], v[252:255], v[36:39], v[60:63]
    v_mfma_f32_16x16x32_bf16 v[64:67], v[36:39], v[36:39], v[64:67]
    v_mfma_f32_16x16x32_bf16 v[68:71], v[10:13], v[36:39], v[68:71]
    s_waitcnt lgkmcnt(2)
    v_mfma_f32_16x16x32_bf16 v[72:75], v[172:175], v[40:43], v[72:75]
    v_mfma_f32_16x16x32_bf16 v[76:79], v[252:255], v[40:43], v[76:79]
    s_waitcnt lgkmcnt(0)
    v_mfma_f32_16x16x32_bf16 v[80:83], v[172:175], v[44:47], v[80:83]
    v_mfma_f32_16x16x32_bf16 v[84:87], v[252:255], v[44:47], v[84:87]
    ds_read_b64 v[10:11], v7
    ds_read_b64 v[12:13], v8
    ds_read_b64 v[14:15], v9
    v_and_b32 v16, 15, v1
    v_lshrrev_b32 v17, 4, v1
    v_and_b32 v18, 3, v1
    v_lshrrev_b32 v19, 2, v16
    v_cmp_eq_u32 s[42:43], 1, v18
    v_cmp_eq_u32 s[44:45], 2, v18
    v_cmp_eq_u32 s[46:47], 3, v18
    v_cmp_eq_u32 s[48:49], v19, v17
    v_lshlrev_b32 v18, 3, v16
    v_add_u32 v18, 45376, v18
    v_cndmask_b32 v64, v64, v65, s[42:43]
    v_cndmask_b32 v64, v64, v66, s[44:45]
    v_cndmask_b32 v64, v64, v67, s[46:47]
    v_mul_f32 v68, 0x3acccccd, v68
    v_mul_f32 v64, 0x3acccccd, v64
    v_fma_f32 v64, -v68, v68, v64
    v_max_f32 v64, 0, v64
    v_cvt_pk_bf16_f32 v68, v68, v64
    v_and_b32 v64, 0xffff0000, v68
    v_lshlrev_b32 v68, 16, v68
    v_add_f32 v64, 0x3727c5ac, v64
    v_cvt_pk_bf16_f32 v64, v64, v64
    v_lshlrev_b32 v64, 16, v64
    v_sqrt_f32 v64, v64
    s_nop 0
    v_cvt_pk_bf16_f32 v64, v64, v64
    v_lshlrev_b32 v64, 16, v64
    v_rcp_f32 v69, v64
    s_mov_b64 exec, s[48:49]
    ds_write_b64 v18, v[68:69] offset:256
    s_mov_b64 exec, -1
    s_lshl_b32 s42, s3, 7
    s_add_u32 s42, s42, 46016
    v_lshl_add_u32 v19, v17, 4, s42
    s_lshl_b32 s42, s3, 6
    s_cmp_eq_u32 s3, 2
    s_cselect_b32 s42, 192, s42
    s_cmp_eq_u32 s3, 3
    s_cselect_b32 s42, 128, s42
    s_add_u32 s42, s42, 61440
    v_mul_u32_u24 v20, 496, v16
    v_lshl_add_u32 v20, v17, 4, v20
    v_add_u32 v20, s42, v20
    v_lshlrev_b32 v18, 3, v16
    v_add_u32 v18, 45376, v18
    s_waitcnt lgkmcnt(0)
    s_barrier
    ds_read_b64 v[26:27], v18 offset:128
    ds_read_b64 v[28:29], v18 offset:256
    ds_read_b64 v[30:31], v18 offset:384
    ds_read_b64 v[32:33], v18 offset:512
    ds_read_b128 v[36:39], v19 offset:0
    ds_read_b128 v[40:43], v19 offset:64
    s_waitcnt lgkmcnt(0)
    v_fma_f32 v48, -v26, v36, v48
    v_fma_f32 v49, -v26, v37, v49
    v_fma_f32 v50, -v26, v38, v50
    v_fma_f32 v51, -v26, v39, v51
    v_fma_f32 v52, -v26, v40, v52
    v_fma_f32 v53, -v26, v41, v53
    v_fma_f32 v54, -v26, v42, v54
    v_fma_f32 v55, -v26, v43, v55
    v_fma_f32 v56, -v28, v36, v56
    v_fma_f32 v57, -v28, v37, v57
    v_fma_f32 v58, -v28, v38, v58
    v_fma_f32 v59, -v28, v39, v59
    v_fma_f32 v60, -v28, v40, v60
    v_fma_f32 v61, -v28, v41, v61
    v_fma_f32 v62, -v28, v42, v62
    v_fma_f32 v63, -v28, v43, v63
    v_fma_f32 v72, -v30, v36, v72
    v_fma_f32 v73, -v30, v37, v73
    v_fma_f32 v74, -v30, v38, v74
    v_fma_f32 v75, -v30, v39, v75
    v_fma_f32 v76, -v30, v40, v76
    v_fma_f32 v77, -v30, v41, v77
    v_fma_f32 v78, -v30, v42, v78
    v_fma_f32 v79, -v30, v43, v79
    v_fma_f32 v80, -v32, v36, v80
    v_fma_f32 v81, -v32, v37, v81
    v_fma_f32 v82, -v32, v38, v82
    v_fma_f32 v83, -v32, v39, v83
    v_fma_f32 v84, -v32, v40, v84
    v_fma_f32 v85, -v32, v41, v85
    v_fma_f32 v86, -v32, v42, v86
    v_fma_f32 v87, -v32, v43, v87
    v_mul_f32 v48, v48, v27
    v_mul_f32 v49, v49, v27
    v_mul_f32 v50, v50, v27
    v_mul_f32 v51, v51, v27
    v_mul_f32 v52, v52, v27
    v_mul_f32 v53, v53, v27
    v_mul_f32 v54, v54, v27
    v_mul_f32 v55, v55, v27
    v_mul_f32 v56, v56, v29
    v_mul_f32 v57, v57, v29
    v_mul_f32 v58, v58, v29
    v_mul_f32 v59, v59, v29
    v_mul_f32 v60, v60, v29
    v_mul_f32 v61, v61, v29
    v_mul_f32 v62, v62, v29
    v_mul_f32 v63, v63, v29
    v_mul_f32 v72, v72, v31
    v_mul_f32 v73, v73, v31
    v_mul_f32 v74, v74, v31
    v_mul_f32 v75, v75, v31
    v_mul_f32 v76, v76, v31
    v_mul_f32 v77, v77, v31
    v_mul_f32 v78, v78, v31
    v_mul_f32 v79, v79, v31
    v_mul_f32 v80, v80, v33
    v_mul_f32 v81, v81, v33
    v_mul_f32 v82, v82, v33
    v_mul_f32 v83, v83, v33
    v_mul_f32 v84, v84, v33
    v_mul_f32 v85, v85, v33
    v_mul_f32 v86, v86, v33
    v_mul_f32 v87, v87, v33
    v_cvt_pk_bf16_f32 v48, v48, v52
    v_cvt_pk_bf16_f32 v49, v49, v53
    v_cvt_pk_bf16_f32 v50, v50, v54
    v_cvt_pk_bf16_f32 v51, v51, v55
    ds_write_b128 v20, v[48:51] offset:7936
    v_cvt_pk_bf16_f32 v56, v56, v60
    v_cvt_pk_bf16_f32 v57, v57, v61
    v_cvt_pk_bf16_f32 v58, v58, v62
    v_cvt_pk_bf16_f32 v59, v59, v63
    ds_write_b128 v20, v[56:59] offset:15872
    v_cvt_pk_bf16_f32 v72, v72, v76
    v_cvt_pk_bf16_f32 v73, v73, v77
    v_cvt_pk_bf16_f32 v74, v74, v78
    v_cvt_pk_bf16_f32 v75, v75, v79
    ds_write_b128 v20, v[72:75] offset:23808
    v_cvt_pk_bf16_f32 v80, v80, v84
    v_cvt_pk_bf16_f32 v81, v81, v85
    v_cvt_pk_bf16_f32 v82, v82, v86
    v_cvt_pk_bf16_f32 v83, v83, v87
    ds_write_b128 v20, v[80:83] offset:31744
    s_branch L_a1_post
L_g2D:
    s_waitcnt vmcnt(10)
    s_barrier
    ds_read_b64_tr_b16 v[16:17], v2 offset:0
    ds_read_b64_tr_b16 v[18:19], v2 offset:2560
    ds_read_b64_tr_b16 v[20:21], v2 offset:32
    ds_read_b64_tr_b16 v[22:23], v2 offset:2592
    ds_read_b64_tr_b16 v[24:25], v2 offset:64
    ds_read_b64_tr_b16 v[26:27], v2 offset:2624
    ds_read_b64_tr_b16 v[28:29], v2 offset:96
    ds_read_b64_tr_b16 v[30:31], v2 offset:2656
    ds_read_b64_tr_b16 v[32:33], v2 offset:128
    ds_read_b64_tr_b16 v[34:35], v2 offset:2688
    ds_read_b64_tr_b16 v[36:37], v2 offset:5120
    ds_read_b64_tr_b16 v[38:39], v2 offset:7680
    ds_read_b64_tr_b16 v[40:41], v2 offset:5152
    ds_read_b64_tr_b16 v[42:43], v2 offset:7712
    ds_read_b64_tr_b16 v[44:45], v2 offset:5184
    ds_read_b64_tr_b16 v[46:47], v2 offset:7744
    s_waitcnt lgkmcnt(14)
    v_mfma_f32_16x16x32_bf16 v[48:51], v[176:179], v[16:19], 0
    v_mfma_f32_16x16x32_bf16 v[52:55], v[16:19], v[16:19], 0
    v_mfma_f32_16x16x32_bf16 v[56:59], v[10:13], v[16:19], 0
    ds_read_b64_tr_b16 v[16:17], v2 offset:5216
    ds_read_b64_tr_b16 v[18:19], v2 offset:7776
    s_waitcnt lgkmcnt(14)
    v_mfma_f32_16x16x32_bf16 v[60:63], v[96:99], v[20:23], 0
    v_mfma_f32_16x16x32_bf16 v[64:67], v[176:179], v[20:23], 0
    ds_read_b64_tr_b16 v[20:21], v2 offset:5248
    ds_read_b64_tr_b16 v[22:23], v2 offset:7808
    s_waitcnt lgkmcnt(14)
    v_mfma_f32_16x16x32_bf16 v[68:71], v[96:99], v[24:27], 0
    v_mfma_f32_16x16x32_bf16 v[72:75], v[176:179], v[24:27], 0
    ds_read_b64_tr_b16 v[24:25], v2 offset:10240
    ds_read_b64_tr_b16 v[26:27], v2 offset:12800
    s_waitcnt lgkmcnt(14)
    v_mfma_f32_16x16x32_bf16 v[76:79], v[96:99], v[28:31], 0
    v_mfma_f32_16x16x32_bf16 v[80:83], v[176:179], v[28:31], 0
    ds_read_b64_tr_b16 v[28:29], v2 offset:10272
    ds_read_b64_tr_b16 v[30:31], v2 offset:12832
    s_waitcnt lgkmcnt(14)
    v_mfma_f32_16x16x32_bf16 v[84:87], v[96:99], v[32:35], 0
    v_mfma_f32_16x16x32_bf16 v[88:91], v[176:179], v[32:35], 0
    ds_read_b64_tr_b16 v[32:33], v2 offset:10304
    ds_read_b64_tr_b16 v[34:35], v2 offset:12864
    s_waitcnt lgkmcnt(14)
    v_mfma_f32_16x16x32_bf16 v[48:51], v[180:183], v[36:39], v[48:51]
    v_mfma_f32_16x16x32_bf16 v[52:55], v[36:39], v[36:39], v[52:55]
    v_mfma_f32_16x16x32_bf16 v[56:59], v[10:13], v[36:39], v[56:59]
    ds_read_b64_tr_b16 v[36:37], v2 offset:10336
    ds_read_b64_tr_b16 v[38:39], v2 offset:12896
    s_waitcnt lgkmcnt(14)
    v_mfma_f32_16x16x32_bf16 v[60:63], v[100:103], v[40:43], v[60:63]
    v_mfma_f32_16x16x32_bf16 v[64:67], v[180:183], v[40:43], v[64:67]
    ds_read_b64_tr_b16 v[40:41], v2 offset:10368
    ds_read_b64_tr_b16 v[42:43], v2 offset:12928
    s_waitcnt lgkmcnt(14)
    v_mfma_f32_16x16x32_bf16 v[68:71], v[100:103], v[44:47], v[68:71]
    v_mfma_f32_16x16x32_bf16 v[72:75], v[180:183], v[44:47], v[72:75]
    s_waitcnt vmcnt(7)
    s_barrier
    ds_read_b64_tr_b16 v[44:45], v2 offset:15360
    ds_read_b64_tr_b16 v[46:47], v2 offset:17920
    s_waitcnt lgkmcnt(14)
    v_mfma_f32_16x16x32_bf16 v[76:79], v[100:103], v[16:19], v[76:79]
    v_mfma_f32_16x16x32_bf16 v[80:83], v[180:183], v[16:19], v[80:83]
    ds_read_b64_tr_b16 v[16:17], v2 offset:15392
    ds_read_b64_tr_b16 v[18:19], v2 offset:17952
    s_waitcnt lgkmcnt(14)
    v_mfma_f32_16x16x32_bf16 v[84:87], v[100:103], v[20:23], v[84:87]
    v_mfma_f32_16x16x32_bf16 v[88:91], v[180:183], v[20:23], v[88:91]
    ds_read_b64_tr_b16 v[20:21], v2 offset:15424
    ds_read_b64_tr_b16 v[22:23], v2 offset:17984
    s_waitcnt lgkmcnt(14)
    v_mfma_f32_16x16x32_bf16 v[48:51], v[184:187], v[24:27], v[48:51]
    v_mfma_f32_16x16x32_bf16 v[52:55], v[24:27], v[24:27], v[52:55]
    v_mfma_f32_16x16x32_bf16 v[56:59], v[10:13], v[24:27], v[56:59]
    ds_read_b64_tr_b16 v[24:25], v2 offset:15456
    ds_read_b64_tr_b16 v[26:27], v2 offset:18016
    s_waitcnt lgkmcnt(14)
    v_mfma_f32_16x16x32_bf16 v[60:63], v[104:107], v[28:31], v[60:63]
    v_mfma_f32_16x16x32_bf16 v[64:67], v[184:187], v[28:31], v[64:67]
    ds_read_b64_tr_b16 v[28:29], v2 offset:15488
    ds_read_b64_tr_b16 v[30:31], v2 offset:18048
    s_waitcnt lgkmcnt(14)
    v_mfma_f32_16x16x32_bf16 v[68:71], v[104:107], v[32:35], v[68:71]
    v_mfma_f32_16x16x32_bf16 v[72:75], v[184:187], v[32:35], v[72:75]
    ds_read_b64_tr_b16 v[32:33], v2 offset:20480
    ds_read_b64_tr_b16 v[34:35], v2 offset:23040
    s_waitcnt lgkmcnt(14)
    v_mfma_f32_16x16x32_bf16 v[76:79], v[104:107], v[36:39], v[76:79]
    v_mfma_f32_16x16x32_bf16 v[80:83], v[184:187], v[36:39], v[80:83]
    ds_read_b64_tr_b16 v[36:37], v2 offset:20512
    ds_read_b64_tr_b16 v[38:39], v2 offset:23072
    s_waitcnt lgkmcnt(14)
    v_mfma_f32_16x16x32_bf16 v[84:87], v[104:107], v[40:43], v[84:87]
    v_mfma_f32_16x16x32_bf16 v[88:91], v[184:187], v[40:43], v[88:91]
    ds_read_b64_tr_b16 v[40:41], v2 offset:20544
    ds_read_b64_tr_b16 v[42:43], v2 offset:23104
    s_waitcnt lgkmcnt(14)
    v_mfma_f32_16x16x32_bf16 v[48:51], v[188:191], v[44:47], v[48:51]
    v_mfma_f32_16x16x32_bf16 v[52:55], v[44:47], v[44:47], v[52:55]
    v_mfma_f32_16x16x32_bf16 v[56:59], v[10:13], v[44:47], v[56:59]
    ds_read_b64_tr_b16 v[44:45], v2 offset:20576
    ds_read_b64_tr_b16 v[46:47], v2 offset:23136
    s_waitcnt lgkmcnt(14)
    v_mfma_f32_16x16x32_bf16 v[60:63], v[108:111], v[16:19], v[60:63]
    v_mfma_f32_16x16x32_bf16 v[64:67], v[188:191], v[16:19], v[64:67]
    ds_read_b64_tr_b16 v[16:17], v2 offset:20608
    ds_read_b64_tr_b16 v[18:19], v2 offset:23168
    s_waitcnt lgkmcnt(14)
    v_mfma_f32_16x16x32_bf16 v[68:71], v[108:111], v[20:23], v[68:71]
    v_mfma_f32_16x16x32_bf16 v[72:75], v[188:191], v[20:23], v[72:75]
    ds_read_b64_tr_b16 v[20:21], v2 offset:25600
    ds_read_b64_tr_b16 v[22:23], v2 offset:28160
    s_waitcnt lgkmcnt(14)
    v_mfma_f32_16x16x32_bf16 v[76:79], v[108:111], v[24:27], v[76:79]
    v_mfma_f32_16x16x32_bf16 v[80:83], v[188:191], v[24:27], v[80:83]
    ds_read_b64_tr_b16 v[24:25], v2 offset:25632
    ds_read_b64_tr_b16 v[26:27], v2 offset:28192
    s_waitcnt lgkmcnt(14)
    v_mfma_f32_16x16x32_bf16 v[84:87], v[108:111], v[28:31], v[84:87]
    v_mfma_f32_16x16x32_bf16 v[88:91], v[188:191], v[28:31], v[88:91]
    ds_read_b64_tr_b16 v[28:29], v2 offset:25664
    ds_read_b64_tr_b16 v[30:31], v2 offset:28224
    s_waitcnt lgkmcnt(14)
    v_mfma_f32_16x16x32_bf16 v[48:51], v[192:195], v[32:35], v[48:51]
    v_mfma_f32_16x16x32_bf16 v[52:55], v[32:35], v[32:35], v[52:55]
    v_mfma_f32_16x16x32_bf16 v[56:59], v[10:13], v[32:35], v[56:59]
    ds_read_b64_tr_b16 v[32:33], v2 offset:25696
    ds_read_b64_tr_b16 v[34:35], v2 offset:28256
    s_waitcnt lgkmcnt(14)
    v_mfma_f32_16x16x32_bf16 v[60:63], v[112:115], v[36:39], v[60:63]
    v_mfma_f32_16x16x32_bf16 v[64:67], v[192:195], v[36:39], v[64:67]
    ds_read_b64_tr_b16 v[36:37], v2 offset:25728
    ds_read_b64_tr_b16 v[38:39], v2 offset:28288
    s_waitcnt lgkmcnt(14)
    v_mfma_f32_16x16x32_bf16 v[68:71], v[112:115], v[40:43], v[68:71]
    v_mfma_f32_16x16x32_bf16 v[72:75], v[192:195], v[40:43], v[72:75]
    ds_read_b64_tr_b16 v[40:41], v2 offset:30720
    ds_read_b64_tr_b16 v[42:43], v2 offset:33280
    s_waitcnt lgkmcnt(14)
    v_mfma_f32_16x16x32_bf16 v[76:79], v[112:115], v[44:47], v[76:79]
    v_mfma_f32_16x16x32_bf16 v[80:83], v[192:195], v[44:47], v[80:83]
    ds_read_b64_tr_b16 v[44:45], v2 offset:30752
    ds_read_b64_tr_b16 v[46:47], v2 offset:33312
    s_waitcnt lgkmcnt(14)
    v_mfma_f32_16x16x32_bf16 v[84:87], v[112:115], v[16:19], v[84:87]
    v_mfma_f32_16x16x32_bf16 v[88:91], v[192:195], v[16:19], v[88:91]
    ds_read_b64_tr_b16 v[16:17], v2 offset:30784
    ds_read_b64_tr_b16 v[18:19], v2 offset:33344
    s_waitcnt lgkmcnt(14)
    v_mfma_f32_16x16x32_bf16 v[48:51], v[196:199], v[20:23], v[48:51]
    v_mfma_f32_16x16x32_bf16 v[52:55], v[20:23], v[20:23], v[52:55]
    v_mfma_f32_16x16x32_bf16 v[56:59], v[10:13], v[20:23], v[56:59]
    ds_read_b64_tr_b16 v[20:21], v2 offset:30816
    ds_read_b64_tr_b16 v[22:23], v2 offset:33376
    s_waitcnt lgkmcnt(14)
    v_mfma_f32_16x16x32_bf16 v[60:63], v[116:119], v[24:27], v[60:63]
    v_mfma_f32_16x16x32_bf16 v[64:67], v[196:199], v[24:27], v[64:67]
    ds_read_b64_tr_b16 v[24:25], v2 offset:30848
    ds_read_b64_tr_b16 v[26:27], v2 offset:33408
    s_waitcnt lgkmcnt(14)
    v_mfma_f32_16x16x32_bf16 v[68:71], v[116:119], v[28:31], v[68:71]
    v_mfma_f32_16x16x32_bf16 v[72:75], v[196:199], v[28:31], v[72:75]
    ds_read_b64_tr_b16 v[28:29], v2 offset:35840
    ds_read_b64_tr_b16 v[30:31], v2 offset:38400
    s_waitcnt lgkmcnt(14)
    v_mfma_f32_16x16x32_bf16 v[76:79], v[116:119], v[32:35], v[76:79]
    v_mfma_f32_16x16x32_bf16 v[80:83], v[196:199], v[32:35], v[80:83]
    ds_read_b64_tr_b16 v[32:33], v2 offset:35872
    ds_read_b64_tr_b16 v[34:35], v2 offset:38432
    s_waitcnt lgkmcnt(14)
    v_mfma_f32_16x16x32_bf16 v[84:87], v[116:119], v[36:39], v[84:87]
    v_mfma_f32_16x16x32_bf16 v[88:91], v[196:199], v[36:39], v[88:91]
    ds_read_b64_tr_b16 v[36:37], v2 offset:35904
    ds_read_b64_tr_b16 v[38:39], v2 offset:38464
    s_waitcnt lgkmcnt(14)
    v_mfma_f32_16x16x32_bf16 v[48:51], v[200:203], v[40:43], v[48:51]
    v_mfma_f32_16x16x32_bf16 v[52:55], v[40:43], v[40:43], v[52:55]
    v_mfma_f32_16x16x32_bf16 v[56:59], v[10:13], v[40:43], v[56:59]
    ds_read_b64_tr_b16 v[40:41], v2 offset:35936
    ds_read_b64_tr_b16 v[42:43], v2 offset:38496
    s_waitcnt lgkmcnt(14)
    v_mfma_f32_16x16x32_bf16 v[60:63], v[120:123], v[44:47], v[60:63]
    v_mfma_f32_16x16x32_bf16 v[64:67], v[200:203], v[44:47], v[64:67]
    ds_read_b64_tr_b16 v[44:45], v2 offset:35968
    ds_read_b64_tr_b16 v[46:47], v2 offset:38528
    s_waitcnt lgkmcnt(14)
    v_mfma_f32_16x16x32_bf16 v[68:71], v[120:123], v[16:19], v[68:71]
    v_mfma_f32_16x16x32_bf16 v[72:75], v[200:203], v[16:19], v[72:75]
    s_waitcnt vmcnt(3)
    s_barrier
    ds_read_b64_tr_b16 v[16:17], v2 offset:40960
    ds_read_b64_tr_b16 v[18:19], v2 offset:43520
    s_waitcnt lgkmcnt(14)
    v_mfma_f32_16x16x32_bf16 v[76:79], v[120:123], v[20:23], v[76:79]
    v_mfma_f32_16x16x32_bf16 v[80:83], v[200:203], v[20:23], v[80:83]
    ds_read_b64_tr_b16 v[20:21], v2 offset:40992
    ds_read_b64_tr_b16 v[22:23], v2 offset:43552
    s_waitcnt lgkmcnt(14)
    v_mfma_f32_16x16x32_bf16 v[84:87], v[120:123], v[24:27], v[84:87]
    v_mfma_f32_16x16x32_bf16 v[88:91], v[200:203], v[24:27], v[88:91]
    ds_read_b64_tr_b16 v[24:25], v2 offset:41024
    ds_read_b64_tr_b16 v[26:27], v2 offset:43584
    s_waitcnt lgkmcnt(14)
    v_mfma_f32_16x16x32_bf16 v[48:51], v[204:207], v[28:31], v[48:51]
    v_mfma_f32_16x16x32_bf16 v[52:55], v[28:31], v[28:31], v[52:55]
    v_mfma_f32_16x16x32_bf16 v[56:59], v[10:13], v[28:31], v[56:59]
    ds_read_b64_tr_b16 v[28:29], v2 offset:41056
    ds_read_b64_tr_b16 v[30:31], v2 offset:43616
    s_waitcnt lgkmcnt(14)
    v_mfma_f32_16x16x32_bf16 v[60:63], v[124:127], v[32:35], v[60:63]
    v_mfma_f32_16x16x32_bf16 v[64:67], v[204:207], v[32:35], v[64:67]
    ds_read_b64_tr_b16 v[32:33], v2 offset:41088
    ds_read_b64_tr_b16 v[34:35], v2 offset:43648
    s_waitcnt lgkmcnt(14)
    v_mfma_f32_16x16x32_bf16 v[68:71], v[124:127], v[36:39], v[68:71]
    v_mfma_f32_16x16x32_bf16 v[72:75], v[204:207], v[36:39], v[72:75]
    ds_read_b64_tr_b16 v[36:37], v2 offset:46080
    ds_read_b64_tr_b16 v[38:39], v2 offset:48640
    s_waitcnt lgkmcnt(14)
    v_mfma_f32_16x16x32_bf16 v[76:79], v[124:127], v[40:43], v[76:79]
    v_mfma_f32_16x16x32_bf16 v[80:83], v[204:207], v[40:43], v[80:83]
    ds_read_b64_tr_b16 v[40:41], v2 offset:46112
    ds_read_b64_tr_b16 v[42:43], v2 offset:48672
    s_waitcnt lgkmcnt(14)
    v_mfma_f32_16x16x32_bf16 v[84:87], v[124:127], v[44:47], v[84:87]
    v_mfma_f32_16x16x32_bf16 v[88:91], v[204:207], v[44:47], v[88:91]
    ds_read_b64_tr_b16 v[44:45], v2 offset:46144
    ds_read_b64_tr_b16 v[46:47], v2 offset:48704
    s_waitcnt lgkmcnt(14)
    v_mfma_f32_16x16x32_bf16 v[48:51], v[208:211], v[16:19], v[48:51]
    v_mfma_f32_16x16x32_bf16 v[52:55], v[16:19], v[16:19], v[52:55]
    v_mfma_f32_16x16x32_bf16 v[56:59], v[10:13], v[16:19], v[56:59]
    ds_read_b64_tr_b16 v[16:17], v2 offset:46176
    ds_read_b64_tr_b16 v[18:19], v2 offset:48736
    s_waitcnt lgkmcnt(14)
    v_mfma_f32_16x16x32_bf16 v[60:63], v[128:131], v[20:23], v[60:63]
    v_mfma_f32_16x16x32_bf16 v[64:67], v[208:211], v[20:23], v[64:67]
    ds_read_b64_tr_b16 v[20:21], v2 offset:46208
    ds_read_b64_tr_b16 v[22:23], v2 offset:48768
    s_waitcnt lgkmcnt(14)
    v_mfma_f32_16x16x32_bf16 v[68:71], v[128:131], v[24:27], v[68:71]
    v_mfma_f32_16x16x32_bf16 v[72:75], v[208:211], v[24:27], v[72:75]
    ds_read_b64_tr_b16 v[24:25], v2 offset:51200
    ds_read_b64_tr_b16 v[26:27], v2 offset:53760
    s_waitcnt lgkmcnt(14)
    v_mfma_f32_16x16x32_bf16 v[76:79], v[128:131], v[28:31], v[76:79]
    v_mfma_f32_16x16x32_bf16 v[80:83], v[208:211], v[28:31], v[80:83]
    ds_read_b64_tr_b16 v[28:29], v2 offset:51232
    ds_read_b64_tr_b16 v[30:31], v2 offset:53792
    s_waitcnt lgkmcnt(14)
    v_mfma_f32_16x16x32_bf16 v[84:87], v[128:131], v[32:35], v[84:87]
    v_mfma_f32_16x16x32_bf16 v[88:91], v[208:211], v[32:35], v[88:91]
    ds_read_b64_tr_b16 v[32:33], v2 offset:51264
    ds_read_b64_tr_b16 v[34:35], v2 offset:53824
    s_waitcnt lgkmcnt(14)
    v_mfma_f32_16x16x32_bf16 v[48:51], v[212:215], v[36:39], v[48:51]
    v_mfma_f32_16x16x32_bf16 v[52:55], v[36:39], v[36:39], v[52:55]
    v_mfma_f32_16x16x32_bf16 v[56:59], v[10:13], v[36:39], v[56:59]
    ds_read_b64_tr_b16 v[36:37], v2 offset:51296
    ds_read_b64_tr_b16 v[38:39], v2 offset:53856
    s_waitcnt lgkmcnt(14)
    v_mfma_f32_16x16x32_bf16 v[60:63], v[132:135], v[40:43], v[60:63]
    v_mfma_f32_16x16x32_bf16 v[64:67], v[212:215], v[40:43], v[64:67]
    ds_read_b64_tr_b16 v[40:41], v2 offset:51328
    ds_read_b64_tr_b16 v[42:43], v2 offset:53888
    s_waitcnt lgkmcnt(14)
    v_mfma_f32_16x16x32_bf16 v[68:71], v[132:135], v[44:47], v[68:71]
    v_mfma_f32_16x16x32_bf16 v[72:75], v[212:215], v[44:47], v[72:75]
    ds_read_b64_tr_b16 v[44:45], v2 offset:56320
    ds_read_b64_tr_b16 v[46:47], v2 offset:58880
    s_waitcnt lgkmcnt(14)
    v_mfma_f32_16x16x32_bf16 v[76:79], v[132:135], v[16:19], v[76:79]
    v_mfma_f32_16x16x32_bf16 v[80:83], v[212:215], v[16:19], v[80:83]
    ds_read_b64_tr_b16 v[16:17], v2 offset:56352
    ds_read_b64_tr_b16 v[18:19], v2 offset:58912
    s_waitcnt lgkmcnt(14)
    v_mfma_f32_16x16x32_bf16 v[84:87], v[132:135], v[20:23], v[84:87]
    v_mfma_f32_16x16x32_bf16 v[88:91], v[212:215], v[20:23], v[88:91]
    ds_read_b64_tr_b16 v[20:21], v2 offset:56384
    ds_read_b64_tr_b16 v[22:23], v2 offset:58944
    s_waitcnt lgkmcnt(14)
    v_mfma_f32_16x16x32_bf16 v[48:51], v[216:219], v[24:27], v[48:51]
    v_mfma_f32_16x16x32_bf16 v[52:55], v[24:27], v[24:27], v[52:55]
    v_mfma_f32_16x16x32_bf16 v[56:59], v[10:13], v[24:27], v[56:59]
    ds_read_b64_tr_b16 v[24:25], v2 offset:56416
    ds_read_b64_tr_b16 v[26:27], v2 offset:58976
    s_waitcnt lgkmcnt(14)
    v_mfma_f32_16x16x32_bf16 v[60:63], v[136:139], v[28:31], v[60:63]
    v_mfma_f32_16x16x32_bf16 v[64:67], v[216:219], v[28:31], v[64:67]
    ds_read_b64_tr_b16 v[28:29], v2 offset:56448
    ds_read_b64_tr_b16 v[30:31], v2 offset:59008
    s_waitcnt lgkmcnt(14)
    v_mfma_f32_16x16x32_bf16 v[68:71], v[136:139], v[32:35], v[68:71]
    v_mfma_f32_16x16x32_bf16 v[72:75], v[216:219], v[32:35], v[72:75]
    ds_read_b64_tr_b16 v[32:33], v3 offset:0
    ds_read_b64_tr_b16 v[34:35], v3 offset:2560
    s_waitcnt lgkmcnt(14)
    v_mfma_f32_16x16x32_bf16 v[76:79], v[136:139], v[36:39], v[76:79]
    v_mfma_f32_16x16x32_bf16 v[80:83], v[216:219], v[36:39], v[80:83]
    ds_read_b64_tr_b16 v[36:37], v3 offset:32
    ds_read_b64_tr_b16 v[38:39], v3 offset:2592
    s_waitcnt lgkmcnt(14)
    v_mfma_f32_16x16x32_bf16 v[84:87], v[136:139], v[40:43], v[84:87]
    v_mfma_f32_16x16x32_bf16 v[88:91], v[216:219], v[40:43], v[88:91]
    ds_read_b64_tr_b16 v[40:41], v3 offset:64
    ds_read_b64_tr_b16 v[42:43], v3 offset:2624
    s_waitcnt lgkmcnt(14)
    v_mfma_f32_16x16x32_bf16 v[48:51], v[220:223], v[44:47], v[48:51]
    v_mfma_f32_16x16x32_bf16 v[52:55], v[44:47], v[44:47], v[52:55]
    v_mfma_f32_16x16x32_bf16 v[56:59], v[10:13], v[44:47], v[56:59]
    ds_read_b64_tr_b16 v[44:45], v3 offset:96
    ds_read_b64_tr_b16 v[46:47], v3 offset:2656
    s_waitcnt lgkmcnt(14)
    v_mfma_f32_16x16x32_bf16 v[60:63], v[140:143], v[16:19], v[60:63]
    v_mfma_f32_16x16x32_bf16 v[64:67], v[220:223], v[16:19], v[64:67]
    ds_read_b64_tr_b16 v[16:17], v3 offset:128
    ds_read_b64_tr_b16 v[18:19], v3 offset:2688
    s_waitcnt lgkmcnt(14)
    v_mfma_f32_16x16x32_bf16 v[68:71], v[140:143], v[20:23], v[68:71]
    v_mfma_f32_16x16x32_bf16 v[72:75], v[220:223], v[20:23], v[72:75]
    ds_read_b64_tr_b16 v[20:21], v3 offset:5120
    ds_read_b64_tr_b16 v[22:23], v3 offset:7680
    s_waitcnt lgkmcnt(14)
    v_mfma_f32_16x16x32_bf16 v[76:79], v[140:143], v[24:27], v[76:79]
    v_mfma_f32_16x16x32_bf16 v[80:83], v[220:223], v[24:27], v[80:83]
    ds_read_b64_tr_b16 v[24:25], v3 offset:5152
    ds_read_b64_tr_b16 v[26:27], v3 offset:7712
    s_waitcnt lgkmcnt(14)
    v_mfma_f32_16x16x32_bf16 v[84:87], v[140:143], v[28:31], v[84:87]
    v_mfma_f32_16x16x32_bf16 v[88:91], v[220:223], v[28:31], v[88:91]
    ds_read_b64_tr_b16 v[28:29], v3 offset:5184
    ds_read_b64_tr_b16 v[30:31], v3 offset:7744
    s_waitcnt lgkmcnt(14)
    v_mfma_f32_16x16x32_bf16 v[48:51], v[224:227], v[32:35], v[48:51]
    v_mfma_f32_16x16x32_bf16 v[52:55], v[32:35], v[32:35], v[52:55]
    v_mfma_f32_16x16x32_bf16 v[56:59], v[10:13], v[32:35], v[56:59]
    ds_read_b64_tr_b16 v[32:33], v3 offset:5216
    ds_read_b64_tr_b16 v[34:35], v3 offset:7776
    s_waitcnt lgkmcnt(14)
    v_mfma_f32_16x16x32_bf16 v[60:63], v[144:147], v[36:39], v[60:63]
    v_mfma_f32_16x16x32_bf16 v[64:67], v[224:227], v[36:39], v[64:67]
    ds_read_b64_tr_b16 v[36:37], v3 offset:5248
    ds_read_b64_tr_b16 v[38:39], v3 offset:7808
    s_waitcnt lgkmcnt(14)
    v_mfma_f32_16x16x32_bf16 v[68:71], v[144:147], v[40:43], v[68:71]
    v_mfma_f32_16x16x32_bf16 v[72:75], v[224:227], v[40:43], v[72:75]
    s_waitcnt vmcnt(0)
    s_barrier
    ds_read_b64_tr_b16 v[40:41], v3 offset:10240
    ds_read_b64_tr_b16 v[42:43], v3 offset:12800
    s_waitcnt lgkmcnt(14)
    v_mfma_f32_16x16x32_bf16 v[76:79], v[144:147], v[44:47], v[76:79]
    v_mfma_f32_16x16x32_bf16 v[80:83], v[224:227], v[44:47], v[80:83]
    ds_read_b64_tr_b16 v[44:45], v3 offset:10272
    ds_read_b64_tr_b16 v[46:47], v3 offset:12832
    s_waitcnt lgkmcnt(14)
    v_mfma_f32_16x16x32_bf16 v[84:87], v[144:147], v[16:19], v[84:87]
    v_mfma_f32_16x16x32_bf16 v[88:91], v[224:227], v[16:19], v[88:91]
    ds_read_b64_tr_b16 v[16:17], v3 offset:10304
    ds_read_b64_tr_b16 v[18:19], v3 offset:12864
    s_waitcnt lgkmcnt(14)
    v_mfma_f32_16x16x32_bf16 v[48:51], v[228:231], v[20:23], v[48:51]
    v_mfma_f32_16x16x32_bf16 v[52:55], v[20:23], v[20:23], v[52:55]
    v_mfma_f32_16x16x32_bf16 v[56:59], v[10:13], v[20:23], v[56:59]
    ds_read_b64_tr_b16 v[20:21], v3 offset:10336
    ds_read_b64_tr_b16 v[22:23], v3 offset:12896
    s_waitcnt lgkmcnt(14)
    v_mfma_f32_16x16x32_bf16 v[60:63], v[148:151], v[24:27], v[60:63]
    v_mfma_f32_16x16x32_bf16 v[64:67], v[228:231], v[24:27], v[64:67]
    ds_read_b64_tr_b16 v[24:25], v3 offset:10368
    ds_read_b64_tr_b16 v[26:27], v3 offset:12928
    s_waitcnt lgkmcnt(14)
    v_mfma_f32_16x16x32_bf16 v[68:71], v[148:151], v[28:31], v[68:71]
    v_mfma_f32_16x16x32_bf16 v[72:75], v[228:231], v[28:31], v[72:75]
    ds_read_b64_tr_b16 v[28:29], v3 offset:15360
    ds_read_b64_tr_b16 v[30:31], v3 offset:17920
    s_waitcnt lgkmcnt(14)
    v_mfma_f32_16x16x32_bf16 v[76:79], v[148:151], v[32:35], v[76:79]
    v_mfma_f32_16x16x32_bf16 v[80:83], v[228:231], v[32:35], v[80:83]
    ds_read_b64_tr_b16 v[32:33], v3 offset:15392
    ds_read_b64_tr_b16 v[34:35], v3 offset:17952
    s_waitcnt lgkmcnt(14)
    v_mfma_f32_16x16x32_bf16 v[84:87], v[148:151], v[36:39], v[84:87]
    v_mfma_f32_16x16x32_bf16 v[88:91], v[228:231], v[36:39], v[88:91]
    ds_read_b64_tr_b16 v[36:37], v3 offset:15424
    ds_read_b64_tr_b16 v[38:39], v3 offset:17984
    s_waitcnt lgkmcnt(14)
    v_mfma_f32_16x16x32_bf16 v[48:51], v[232:235], v[40:43], v[48:51]
    v_mfma_f32_16x16x32_bf16 v[52:55], v[40:43], v[40:43], v[52:55]
    v_mfma_f32_16x16x32_bf16 v[56:59], v[10:13], v[40:43], v[56:59]
    ds_read_b64_tr_b16 v[40:41], v3 offset:15456
    ds_read_b64_tr_b16 v[42:43], v3 offset:18016
    s_waitcnt lgkmcnt(14)
    v_mfma_f32_16x16x32_bf16 v[60:63], v[152:155], v[44:47], v[60:63]
    v_mfma_f32_16x16x32_bf16 v[64:67], v[232:235], v[44:47], v[64:67]
    ds_read_b64_tr_b16 v[44:45], v3 offset:15488
    ds_read_b64_tr_b16 v[46:47], v3 offset:18048
    s_waitcnt lgkmcnt(14)
    v_mfma_f32_16x16x32_bf16 v[68:71], v[152:155], v[16:19], v[68:71]
    v_mfma_f32_16x16x32_bf16 v[72:75], v[232:235], v[16:19], v[72:75]
    ds_read_b64_tr_b16 v[16:17], v3 offset:20480
    ds_read_b64_tr_b16 v[18:19], v3 offset:23040
    s_waitcnt lgkmcnt(14)
    v_mfma_f32_16x16x32_bf16 v[76:79], v[152:155], v[20:23], v[76:79]
    v_mfma_f32_16x16x32_bf16 v[80:83], v[232:235], v[20:23], v[80:83]
    ds_read_b64_tr_b16 v[20:21], v3 offset:20512
    ds_read_b64_tr_b16 v[22:23], v3 offset:23072
    s_waitcnt lgkmcnt(14)
    v_mfma_f32_16x16x32_bf16 v[84:87], v[152:155], v[24:27], v[84:87]
    v_mfma_f32_16x16x32_bf16 v[88:91], v[232:235], v[24:27], v[88:91]
    ds_read_b64_tr_b16 v[24:25], v3 offset:20544
    ds_read_b64_tr_b16 v[26:27], v3 offset:23104
    s_waitcnt lgkmcnt(14)
    v_mfma_f32_16x16x32_bf16 v[48:51], v[236:239], v[28:31], v[48:51]
    v_mfma_f32_16x16x32_bf16 v[52:55], v[28:31], v[28:31], v[52:55]
    v_mfma_f32_16x16x32_bf16 v[56:59], v[10:13], v[28:31], v[56:59]
    ds_read_b64_tr_b16 v[28:29], v3 offset:20576
    ds_read_b64_tr_b16 v[30:31], v3 offset:23136
    s_waitcnt lgkmcnt(14)
    v_mfma_f32_16x16x32_bf16 v[60:63], v[156:159], v[32:35], v[60:63]
    v_mfma_f32_16x16x32_bf16 v[64:67], v[236:239], v[32:35], v[64:67]
    ds_read_b64_tr_b16 v[32:33], v3 offset:20608
    ds_read_b64_tr_b16 v[34:35], v3 offset:23168
    s_waitcnt lgkmcnt(14)
    v_mfma_f32_16x16x32_bf16 v[68:71], v[156:159], v[36:39], v[68:71]
    v_mfma_f32_16x16x32_bf16 v[72:75], v[236:239], v[36:39], v[72:75]
    ds_read_b64_tr_b16 v[36:37], v3 offset:25600
    ds_read_b64_tr_b16 v[38:39], v3 offset:28160
    s_waitcnt lgkmcnt(14)
    v_mfma_f32_16x16x32_bf16 v[76:79], v[156:159], v[40:43], v[76:79]
    v_mfma_f32_16x16x32_bf16 v[80:83], v[236:239], v[40:43], v[80:83]
    ds_read_b64_tr_b16 v[40:41], v3 offset:25632
    ds_read_b64_tr_b16 v[42:43], v3 offset:28192
    s_waitcnt lgkmcnt(14)
    v_mfma_f32_16x16x32_bf16 v[84:87], v[156:159], v[44:47], v[84:87]
    v_mfma_f32_16x16x32_bf16 v[88:91], v[236:239], v[44:47], v[88:91]
    ds_read_b64_tr_b16 v[44:45], v3 offset:25664
    ds_read_b64_tr_b16 v[46:47], v3 offset:28224
    s_waitcnt lgkmcnt(14)
    v_mfma_f32_16x16x32_bf16 v[48:51], v[240:243], v[16:19], v[48:51]
    v_mfma_f32_16x16x32_bf16 v[52:55], v[16:19], v[16:19], v[52:55]
    v_mfma_f32_16x16x32_bf16 v[56:59], v[10:13], v[16:19], v[56:59]
    ds_read_b64_tr_b16 v[16:17], v3 offset:25696
    ds_read_b64_tr_b16 v[18:19], v3 offset:28256
    s_waitcnt lgkmcnt(14)
    v_mfma_f32_16x16x32_bf16 v[60:63], v[160:163], v[20:23], v[60:63]
    v_mfma_f32_16x16x32_bf16 v[64:67], v[240:243], v[20:23], v[64:67]
    ds_read_b64_tr_b16 v[20:21], v3 offset:25728
    ds_read_b64_tr_b16 v[22:23], v3 offset:28288
    s_waitcnt lgkmcnt(14)
    v_mfma_f32_16x16x32_bf16 v[68:71], v[160:163], v[24:27], v[68:71]
    v_mfma_f32_16x16x32_bf16 v[72:75], v[240:243], v[24:27], v[72:75]
    ds_read_b64_tr_b16 v[24:25], v3 offset:30720
    ds_read_b64_tr_b16 v[26:27], v3 offset:33280
    s_waitcnt lgkmcnt(14)
    v_mfma_f32_16x16x32_bf16 v[76:79], v[160:163], v[28:31], v[76:79]
    v_mfma_f32_16x16x32_bf16 v[80:83], v[240:243], v[28:31], v[80:83]
    ds_read_b64_tr_b16 v[28:29], v3 offset:30752
    ds_read_b64_tr_b16 v[30:31], v3 offset:33312
    s_waitcnt lgkmcnt(14)
    v_mfma_f32_16x16x32_bf16 v[84:87], v[160:163], v[32:35], v[84:87]
    v_mfma_f32_16x16x32_bf16 v[88:91], v[240:243], v[32:35], v[88:91]
    ds_read_b64_tr_b16 v[32:33], v3 offset:30784
    ds_read_b64_tr_b16 v[34:35], v3 offset:33344
    s_waitcnt lgkmcnt(14)
    v_mfma_f32_16x16x32_bf16 v[48:51], v[244:247], v[36:39], v[48:51]
    v_mfma_f32_16x16x32_bf16 v[52:55], v[36:39], v[36:39], v[52:55]
    v_mfma_f32_16x16x32_bf16 v[56:59], v[10:13], v[36:39], v[56:59]
    ds_read_b64_tr_b16 v[36:37], v3 offset:30816
    ds_read_b64_tr_b16 v[38:39], v3 offset:33376
    s_waitcnt lgkmcnt(14)
    v_mfma_f32_16x16x32_bf16 v[60:63], v[164:167], v[40:43], v[60:63]
    v_mfma_f32_16x16x32_bf16 v[64:67], v[244:247], v[40:43], v[64:67]
    ds_read_b64_tr_b16 v[40:41], v3 offset:30848
    ds_read_b64_tr_b16 v[42:43], v3 offset:33408
    s_waitcnt lgkmcnt(14)
    v_mfma_f32_16x16x32_bf16 v[68:71], v[164:167], v[44:47], v[68:71]
    v_mfma_f32_16x16x32_bf16 v[72:75], v[244:247], v[44:47], v[72:75]
    ds_read_b64_tr_b16 v[44:45], v3 offset:35840
    ds_read_b64_tr_b16 v[46:47], v3 offset:38400
    s_waitcnt lgkmcnt(14)
    v_mfma_f32_16x16x32_bf16 v[76:79], v[164:167], v[16:19], v[76:79]
    v_mfma_f32_16x16x32_bf16 v[80:83], v[244:247], v[16:19], v[80:83]
    ds_read_b64_tr_b16 v[16:17], v3 offset:35872
    ds_read_b64_tr_b16 v[18:19], v3 offset:38432
    s_waitcnt lgkmcnt(14)
    v_mfma_f32_16x16x32_bf16 v[84:87], v[164:167], v[20:23], v[84:87]
    v_mfma_f32_16x16x32_bf16 v[88:91], v[244:247], v[20:23], v[88:91]
    ds_read_b64_tr_b16 v[20:21], v3 offset:35904
    ds_read_b64_tr_b16 v[22:23], v3 offset:38464
    s_waitcnt lgkmcnt(14)
    v_mfma_f32_16x16x32_bf16 v[48:51], v[248:251], v[24:27], v[48:51]
    v_mfma_f32_16x16x32_bf16 v[52:55], v[24:27], v[24:27], v[52:55]
    v_mfma_f32_16x16x32_bf16 v[56:59], v[10:13], v[24:27], v[56:59]
    ds_read_b64_tr_b16 v[24:25], v3 offset:35936
    ds_read_b64_tr_b16 v[26:27], v3 offset:38496
    s_waitcnt lgkmcnt(14)
    v_mfma_f32_16x16x32_bf16 v[60:63], v[168:171], v[28:31], v[60:63]
    v_mfma_f32_16x16x32_bf16 v[64:67], v[248:251], v[28:31], v[64:67]
    ds_read_b64_tr_b16 v[28:29], v3 offset:35968
    ds_read_b64_tr_b16 v[30:31], v3 offset:38528
    s_waitcnt lgkmcnt(14)
    v_mfma_f32_16x16x32_bf16 v[68:71], v[168:171], v[32:35], v[68:71]
    v_mfma_f32_16x16x32_bf16 v[72:75], v[248:251], v[32:35], v[72:75]
    s_waitcnt lgkmcnt(12)
    v_mfma_f32_16x16x32_bf16 v[76:79], v[168:171], v[36:39], v[76:79]
    v_mfma_f32_16x16x32_bf16 v[80:83], v[248:251], v[36:39], v[80:83]
    s_waitcnt lgkmcnt(10)
    v_mfma_f32_16x16x32_bf16 v[84:87], v[168:171], v[40:43], v[84:87]
    v_mfma_f32_16x16x32_bf16 v[88:91], v[248:251], v[40:43], v[88:91]
    s_waitcnt lgkmcnt(8)
    v_mfma_f32_16x16x32_bf16 v[48:51], v[252:255], v[44:47], v[48:51]
    v_mfma_f32_16x16x32_bf16 v[52:55], v[44:47], v[44:47], v[52:55]
    v_mfma_f32_16x16x32_bf16 v[56:59], v[10:13], v[44:47], v[56:59]
    s_waitcnt lgkmcnt(6)
    v_mfma_f32_16x16x32_bf16 v[60:63], v[172:175], v[16:19], v[60:63]
    v_mfma_f32_16x16x32_bf16 v[64:67], v[252:255], v[16:19], v[64:67]
    s_waitcnt lgkmcnt(4)
    v_mfma_f32_16x16x32_bf16 v[68:71], v[172:175], v[20:23], v[68:71]
    v_mfma_f32_16x16x32_bf16 v[72:75], v[252:255], v[20:23], v[72:75]
    s_waitcnt lgkmcnt(2)
    v_mfma_f32_16x16x32_bf16 v[76:79], v[172:175], v[24:27], v[76:79]
    v_mfma_f32_16x16x32_bf16 v[80:83], v[252:255], v[24:27], v[80:83]
    s_waitcnt lgkmcnt(0)
    v_mfma_f32_16x16x32_bf16 v[84:87], v[172:175], v[28:31], v[84:87]
    v_mfma_f32_16x16x32_bf16 v[88:91], v[252:255], v[28:31], v[88:91]
    ds_read_b64 v[10:11], v7
    ds_read_b64 v[12:13], v8
    ds_read_b64 v[14:15], v9
    v_and_b32 v16, 15, v1
    v_lshrrev_b32 v17, 4, v1
    v_and_b32 v18, 3, v1
    v_lshrrev_b32 v19, 2, v16
    v_cmp_eq_u32 s[42:43], 1, v18
    v_cmp_eq_u32 s[44:45], 2, v18
    v_cmp_eq_u32 s[46:47], 3, v18
    v_cmp_eq_u32 s[48:49], v19, v17
    v_lshlrev_b32 v18, 3, v16
    v_add_u32 v18, 45376, v18
    v_cndmask_b32 v52, v52, v53, s[42:43]
    v_cndmask_b32 v52, v52, v54, s[44:45]
    v_cndmask_b32 v52, v52, v55, s[46:47]
    v_mul_f32 v56, 0x3acccccd, v56
    v_mul_f32 v52, 0x3acccccd, v52
    v_fma_f32 v52, -v56, v56, v52
    v_max_f32 v52, 0, v52
    v_cvt_pk_bf16_f32 v56, v56, v52
    v_and_b32 v52, 0xffff0000, v56
    v_lshlrev_b32 v56, 16, v56
    v_add_f32 v52, 0x3727c5ac, v52
    v_cvt_pk_bf16_f32 v52, v52, v52
    v_lshlrev_b32 v52, 16, v52
    v_sqrt_f32 v52, v52
    s_nop 0
    v_cvt_pk_bf16_f32 v52, v52, v52
    v_lshlrev_b32 v52, 16, v52
    v_rcp_f32 v57, v52
    s_mov_b64 exec, s[48:49]
    ds_write_b64 v18, v[56:57] offset:0
    s_mov_b64 exec, -1
    s_lshl_b32 s42, s3, 7
    s_add_u32 s42, s42, 46016
    v_lshl_add_u32 v19, v17, 4, s42
    s_lshl_b32 s42, s3, 6
    s_cmp_eq_u32 s3, 2
    s_cselect_b32 s42, 192, s42
    s_cmp_eq_u32 s3, 3
    s_cselect_b32 s42, 128, s42
    s_add_u32 s42, s42, 61440
    v_mul_u32_u24 v20, 496, v16
    v_lshl_add_u32 v20, v17, 3, v20
    v_add_u32 v20, s42, v20
    v_lshlrev_b32 v18, 3, v16
    v_add_u32 v18, 45376, v18
    s_waitcnt lgkmcnt(0)
    s_barrier
    ds_read_b64 v[24:25], v18 offset:0
    ds_read_b64 v[26:27], v18 offset:128
    ds_read_b64 v[28:29], v18 offset:256
    ds_read_b64 v[30:31], v18 offset:384
    ds_read_b64 v[32:33], v18 offset:512
    ds_read_b128 v[36:39], v19 offset:0
    ds_read_b128 v[40:43], v19 offset:64
    s_waitcnt lgkmcnt(0)
    v_fma_f32 v48, -v24, v40, v48
    v_fma_f32 v49, -v24, v41, v49
    v_fma_f32 v50, -v24, v42, v50
    v_fma_f32 v51, -v24, v43, v51
    v_fma_f32 v60, -v26, v36, v60
    v_fma_f32 v61, -v26, v37, v61
    v_fma_f32 v62, -v26, v38, v62
    v_fma_f32 v63, -v26, v39, v63
    v_fma_f32 v64, -v26, v40, v64
    v_fma_f32 v65, -v26, v41, v65
    v_fma_f32 v66, -v26, v42, v66
    v_fma_f32 v67, -v26, v43, v67
    v_fma_f32 v68, -v28, v36, v68
    v_fma_f32 v69, -v28, v37, v69
    v_fma_f32 v70, -v28, v38, v70
    v_fma_f32 v71, -v28, v39, v71
    v_fma_f32 v72, -v28, v40, v72
    v_fma_f32 v73, -v28, v41, v73
    v_fma_f32 v74, -v28, v42, v74
    v_fma_f32 v75, -v28, v43, v75
    v_fma_f32 v76, -v30, v36, v76
    v_fma_f32 v77, -v30, v37, v77
    v_fma_f32 v78, -v30, v38, v78
    v_fma_f32 v79, -v30, v39, v79
    v_fma_f32 v80, -v30, v40, v80
    v_fma_f32 v81, -v30, v41, v81
    v_fma_f32 v82, -v30, v42, v82
    v_fma_f32 v83, -v30, v43, v83
    v_fma_f32 v84, -v32, v36, v84
    v_fma_f32 v85, -v32, v37, v85
    v_fma_f32 v86, -v32, v38, v86
    v_fma_f32 v87, -v32, v39, v87
    v_fma_f32 v88, -v32, v40, v88
    v_fma_f32 v89, -v32, v41, v89
    v_fma_f32 v90, -v32, v42, v90
    v_fma_f32 v91, -v32, v43, v91
    v_mul_f32 v48, v48, v25
    v_mul_f32 v49, v49, v25
    v_mul_f32 v50, v50, v25
    v_mul_f32 v51, v51, v25
    v_mul_f32 v60, v60, v27
    v_mul_f32 v61, v61, v27
    v_mul_f32 v62, v62, v27
    v_mul_f32 v63, v63, v27
    v_mul_f32 v64, v64, v27
    v_mul_f32 v65, v65, v27
    v_mul_f32 v66, v66, v27
    v_mul_f32 v67, v67, v27
    v_mul_f32 v68, v68, v29
    v_mul_f32 v69, v69, v29
    v_mul_f32 v70, v70, v29
    v_mul_f32 v71, v71, v29
    v_mul_f32 v72, v72, v29
    v_mul_f32 v73, v73, v29
    v_mul_f32 v74, v74, v29
    v_mul_f32 v75, v75, v29
    v_mul_f32 v76, v76, v31
    v_mul_f32 v77, v77, v31
    v_mul_f32 v78, v78, v31
    v_mul_f32 v79, v79, v31
    v_mul_f32 v80, v80, v31
    v_mul_f32 v81, v81, v31
    v_mul_f32 v82, v82, v31
    v_mul_f32 v83, v83, v31
    v_mul_f32 v84, v84, v33
    v_mul_f32 v85, v85, v33
    v_mul_f32 v86, v86, v33
    v_mul_f32 v87, v87, v33
    v_mul_f32 v88, v88, v33
    v_mul_f32 v89, v89, v33
    v_mul_f32 v90, v90, v33
    v_mul_f32 v91, v91, v33
    v_cvt_pk_bf16_f32 v48, v48, v49
    v_cvt_pk_bf16_f32 v49, v50, v51
    ds_write_b64 v20, v[48:49] offset:32
    v_cvt_pk_bf16_f32 v60, v60, v61
    v_cvt_pk_bf16_f32 v61, v62, v63
    ds_write_b64 v20, v[60:61] offset:7936
    v_cvt_pk_bf16_f32 v64, v64, v65
    v_cvt_pk_bf16_f32 v65, v66, v67
    ds_write_b64 v20, v[64:65] offset:7968
    v_cvt_pk_bf16_f32 v68, v68, v69
    v_cvt_pk_bf16_f32 v69, v70, v71
    ds_write_b64 v20, v[68:69] offset:15872
    v_cvt_pk_bf16_f32 v72, v72, v73
    v_cvt_pk_bf16_f32 v73, v74, v75
    ds_write_b64 v20, v[72:73] offset:15904
    v_cvt_pk_bf16_f32 v76, v76, v77
    v_cvt_pk_bf16_f32 v77, v78, v79
    ds_write_b64 v20, v[76:77] offset:23808
    v_cvt_pk_bf16_f32 v80, v80, v81
    v_cvt_pk_bf16_f32 v81, v82, v83
    ds_write_b64 v20, v[80:81] offset:23840
    v_cvt_pk_bf16_f32 v84, v84, v85
    v_cvt_pk_bf16_f32 v85, v86, v87
    ds_write_b64 v20, v[84:85] offset:31744
    v_cvt_pk_bf16_f32 v88, v88, v89
    v_cvt_pk_bf16_f32 v89, v90, v91
    ds_write_b64 v20, v[88:89] offset:31776
    s_branch L_a1_post
L_g2E:
    s_waitcnt vmcnt(10)
    s_barrier
    ds_read_b64_tr_b16 v[16:17], v2 offset:0
    ds_read_b64_tr_b16 v[18:19], v2 offset:2560
    ds_read_b64_tr_b16 v[20:21], v2 offset:32
    ds_read_b64_tr_b16 v[22:23], v2 offset:2592
    ds_read_b64_tr_b16 v[24:25], v2 offset:64
    ds_read_b64_tr_b16 v[26:27], v2 offset:2624
    ds_read_b64_tr_b16 v[28:29], v2 offset:96
    ds_read_b64_tr_b16 v[30:31], v2 offset:2656
    ds_read_b64_tr_b16 v[32:33], v2 offset:128
    ds_read_b64_tr_b16 v[34:35], v2 offset:2688
    ds_read_b64_tr_b16 v[36:37], v2 offset:5120
    ds_read_b64_tr_b16 v[38:39], v2 offset:7680
    ds_read_b64_tr_b16 v[40:41], v2 offset:5152
    ds_read_b64_tr_b16 v[42:43], v2 offset:7712
    ds_read_b64_tr_b16 v[44:45], v2 offset:5184
    ds_read_b64_tr_b16 v[46:47], v2 offset:7744
    s_waitcnt lgkmcnt(14)
    v_mfma_f32_16x16x32_bf16 v[48:51], v[96:99], v[16:19], 0
    ds_read_b64_tr_b16 v[16:17], v2 offset:5216
    ds_read_b64_tr_b16 v[18:19], v2 offset:7776
    s_waitcnt lgkmcnt(14)
    v_mfma_f32_16x16x32_bf16 v[52:55], v[96:99], v[20:23], 0
    ds_read_b64_tr_b16 v[20:21], v2 offset:5248
    ds_read_b64_tr_b16 v[22:23], v2 offset:7808
    s_waitcnt lgkmcnt(14)
    v_mfma_f32_16x16x32_bf16 v[56:59], v[96:99], v[24:27], 0
    ds_read_b64_tr_b16 v[24:25], v2 offset:10240
    ds_read_b64_tr_b16 v[26:27], v2 offset:12800
    s_waitcnt lgkmcnt(14)
    v_mfma_f32_16x16x32_bf16 v[60:63], v[96:99], v[28:31], 0
    v_mfma_f32_16x16x32_bf16 v[64:67], v[28:31], v[28:31], 0
    v_mfma_f32_16x16x32_bf16 v[68:71], v[10:13], v[28:31], 0
    ds_read_b64_tr_b16 v[28:29], v2 offset:10272
    ds_read_b64_tr_b16 v[30:31], v2 offset:12832
    s_waitcnt lgkmcnt(14)
    v_mfma_f32_16x16x32_bf16 v[72:75], v[96:99], v[32:35], 0
    v_mfma_f32_16x16x32_bf16 v[76:79], v[32:35], v[32:35], 0
    v_mfma_f32_16x16x32_bf16 v[80:83], v[10:13], v[32:35], 0
    ds_read_b64_tr_b16 v[32:33], v2 offset:10304
    ds_read_b64_tr_b16 v[34:35], v2 offset:12864
    s_waitcnt lgkmcnt(14)
    v_mfma_f32_16x16x32_bf16 v[48:51], v[100:103], v[36:39], v[48:51]
    ds_read_b64_tr_b16 v[36:37], v2 offset:10336
    ds_read_b64_tr_b16 v[38:39], v2 offset:12896
    s_waitcnt lgkmcnt(14)
    v_mfma_f32_16x16x32_bf16 v[52:55], v[100:103], v[40:43], v[52:55]
    ds_read_b64_tr_b16 v[40:41], v2 offset:10368
    ds_read_b64_tr_b16 v[42:43], v2 offset:12928
    s_waitcnt lgkmcnt(14)
    v_mfma_f32_16x16x32_bf16 v[56:59], v[100:103], v[44:47], v[56:59]
    s_waitcnt vmcnt(7)
    s_barrier
    ds_read_b64_tr_b16 v[44:45], v2 offset:15360
    ds_read_b64_tr_b16 v[46:47], v2 offset:17920
    s_waitcnt lgkmcnt(14)
    v_mfma_f32_16x16x32_bf16 v[60:63], v[100:103], v[16:19], v[60:63]
    v_mfma_f32_16x16x32_bf16 v[64:67], v[16:19], v[16:19], v[64:67]
    v_mfma_f32_16x16x32_bf16 v[68:71], v[10:13], v[16:19], v[68:71]
    ds_read_b64_tr_b16 v[16:17], v2 offset:15392
    ds_read_b64_tr_b16 v[18:19], v2 offset:17952
    s_waitcnt lgkmcnt(14)
    v_mfma_f32_16x16x32_bf16 v[72:75], v[100:103], v[20:23], v[72:75]
    v_mfma_f32_16x16x32_bf16 v[76:79], v[20:23], v[20:23], v[76:79]
    v_mfma_f32_16x16x32_bf16 v[80:83], v[10:13], v[20:23], v[80:83]
    ds_read_b64_tr_b16 v[20:21], v2 offset:15424
    ds_read_b64_tr_b16 v[22:23], v2 offset:17984
    s_waitcnt lgkmcnt(14)
    v_mfma_f32_16x16x32_bf16 v[48:51], v[104:107], v[24:27], v[48:51]
    ds_read_b64_tr_b16 v[24:25], v2 offset:15456
    ds_read_b64_tr_b16 v[26:27], v2 offset:18016
    s_waitcnt lgkmcnt(14)
    v_mfma_f32_16x16x32_bf16 v[52:55], v[104:107], v[28:31], v[52:55]
    ds_read_b64_tr_b16 v[28:29], v2 offset:15488
    ds_read_b64_tr_b16 v[30:31], v2 offset:18048
    s_waitcnt lgkmcnt(14)
    v_mfma_f32_16x16x32_bf16 v[56:59], v[104:107], v[32:35], v[56:59]
    ds_read_b64_tr_b16 v[32:33], v2 offset:20480
    ds_read_b64_tr_b16 v[34:35], v2 offset:23040
    s_waitcnt lgkmcnt(14)
    v_mfma_f32_16x16x32_bf16 v[60:63], v[104:107], v[36:39], v[60:63]
    v_mfma_f32_16x16x32_bf16 v[64:67], v[36:39], v[36:39], v[64:67]
    v_mfma_f32_16x16x32_bf16 v[68:71], v[10:13], v[36:39], v[68:71]
    ds_read_b64_tr_b16 v[36:37], v2 offset:20512
    ds_read_b64_tr_b16 v[38:39], v2 offset:23072
    s_waitcnt lgkmcnt(14)
    v_mfma_f32_16x16x32_bf16 v[72:75], v[104:107], v[40:43], v[72:75]
    v_mfma_f32_16x16x32_bf16 v[76:79], v[40:43], v[40:43], v[76:79]
    v_mfma_f32_16x16x32_bf16 v[80:83], v[10:13], v[40:43], v[80:83]
    ds_read_b64_tr_b16 v[40:41], v2 offset:20544
    ds_read_b64_tr_b16 v[42:43], v2 offset:23104
    s_waitcnt lgkmcnt(14)
    v_mfma_f32_16x16x32_bf16 v[48:51], v[108:111], v[44:47], v[48:51]
    ds_read_b64_tr_b16 v[44:45], v2 offset:20576
    ds_read_b64_tr_b16 v[46:47], v2 offset:23136
    s_waitcnt lgkmcnt(14)
    v_mfma_f32_16x16x32_bf16 v[52:55], v[108:111], v[16:19], v[52:55]
    ds_read_b64_tr_b16 v[16:17], v2 offset:20608
    ds_read_b64_tr_b16 v[18:19], v2 offset:23168
    s_waitcnt lgkmcnt(14)
    v_mfma_f32_16x16x32_bf16 v[56:59], v[108:111], v[20:23], v[56:59]
    ds_read_b64_tr_b16 v[20:21], v2 offset:25600
    ds_read_b64_tr_b16 v[22:23], v2 offset:28160
    s_waitcnt lgkmcnt(14)
    v_mfma_f32_16x16x32_bf16 v[60:63], v[108:111], v[24:27], v[60:63]
    v_mfma_f32_16x16x32_bf16 v[64:67], v[24:27], v[24:27], v[64:67]
    v_mfma_f32_16x16x32_bf16 v[68:71], v[10:13], v[24:27], v[68:71]
    ds_read_b64_tr_b16 v[24:25], v2 offset:25632
    ds_read_b64_tr_b16 v[26:27], v2 offset:28192
    s_waitcnt lgkmcnt(14)
    v_mfma_f32_16x16x32_bf16 v[72:75], v[108:111], v[28:31], v[72:75]
    v_mfma_f32_16x16x32_bf16 v[76:79], v[28:31], v[28:31], v[76:79]
    v_mfma_f32_16x16x32_bf16 v[80:83], v[10:13], v[28:31], v[80:83]
    ds_read_b64_tr_b16 v[28:29], v2 offset:25664
    ds_read_b64_tr_b16 v[30:31], v2 offset:28224
    s_waitcnt lgkmcnt(14)
    v_mfma_f32_16x16x32_bf16 v[48:51], v[112:115], v[32:35], v[48:51]
    ds_read_b64_tr_b16 v[32:33], v2 offset:25696
    ds_read_b64_tr_b16 v[34:35], v2 offset:28256
    s_waitcnt lgkmcnt(14)
    v_mfma_f32_16x16x32_bf16 v[52:55], v[112:115], v[36:39], v[52:55]
    ds_read_b64_tr_b16 v[36:37], v2 offset:25728
    ds_read_b64_tr_b16 v[38:39], v2 offset:28288
    s_waitcnt lgkmcnt(14)
    v_mfma_f32_16x16x32_bf16 v[56:59], v[112:115], v[40:43], v[56:59]
    ds_read_b64_tr_b16 v[40:41], v2 offset:30720
    ds_read_b64_tr_b16 v[42:43], v2 offset:33280
    s_waitcnt lgkmcnt(14)
    v_mfma_f32_16x16x32_bf16 v[60:63], v[112:115], v[44:47], v[60:63]
    v_mfma_f32_16x16x32_bf16 v[64:67], v[44:47], v[44:47], v[64:67]
    v_mfma_f32_16x16x32_bf16 v[68:71], v[10:13], v[44:47], v[68:71]
    ds_read_b64_tr_b16 v[44:45], v2 offset:30752
    ds_read_b64_tr_b16 v[46:47], v2 offset:33312
    s_waitcnt lgkmcnt(14)
    v_mfma_f32_16x16x32_bf16 v[72:75], v[112:115], v[16:19], v[72:75]
    v_mfma_f32_16x16x32_bf16 v[76:79], v[16:19], v[16:19], v[76:79]
    v_mfma_f32_16x16x32_bf16 v[80:83], v[10:13], v[16:19], v[80:83]
    ds_read_b64_tr_b16 v[16:17], v2 offset:30784
    ds_read_b64_tr_b16 v[18:19], v2 offset:33344
    s_waitcnt lgkmcnt(14)
    v_mfma_f32_16x16x32_bf16 v[48:51], v[116:119], v[20:23], v[48:51]
    ds_read_b64_tr_b16 v[20:21], v2 offset:30816
    ds_read_b64_tr_b16 v[22:23], v2 offset:33376
    s_waitcnt lgkmcnt(14)
    v_mfma_f32_16x16x32_bf16 v[52:55], v[116:119], v[24:27], v[52:55]
    ds_read_b64_tr_b16 v[24:25], v2 offset:30848
    ds_read_b64_tr_b16 v[26:27], v2 offset:33408
    s_waitcnt lgkmcnt(14)
    v_mfma_f32_16x16x32_bf16 v[56:59], v[116:119], v[28:31], v[56:59]
    ds_read_b64_tr_b16 v[28:29], v2 offset:35840
    ds_read_b64_tr_b16 v[30:31], v2 offset:38400
    s_waitcnt lgkmcnt(14)
    v_mfma_f32_16x16x32_bf16 v[60:63], v[116:119], v[32:35], v[60:63]
    v_mfma_f32_16x16x32_bf16 v[64:67], v[32:35], v[32:35], v[64:67]
    v_mfma_f32_16x16x32_bf16 v[68:71], v[10:13], v[32:35], v[68:71]
    ds_read_b64_tr_b16 v[32:33], v2 offset:35872
    ds_read_b64_tr_b16 v[34:35], v2 offset:38432
    s_waitcnt lgkmcnt(14)
    v_mfma_f32_16x16x32_bf16 v[72:75], v[116:119], v[36:39], v[72:75]
    v_mfma_f32_16x16x32_bf16 v[76:79], v[36:39], v[36:39], v[76:79]
    v_mfma_f32_16x16x32_bf16 v[80:83], v[10:13], v[36:39], v[80:83]
    ds_read_b64_tr_b16 v[36:37], v2 offset:35904
    ds_read_b64_tr_b16 v[38:39], v2 offset:38464
    s_waitcnt lgkmcnt(14)
    v_mfma_f32_16x16x32_bf16 v[48:51], v[120:123], v[40:43], v[48:51]
    ds_read_b64_tr_b16 v[40:41], v2 offset:35936
    ds_read_b64_tr_b16 v[42:43], v2 offset:38496
    s_waitcnt lgkmcnt(14)
    v_mfma_f32_16x16x32_bf16 v[52:55], v[120:123], v[44:47], v[52:55]
    ds_read_b64_tr_b16 v[44:45], v2 offset:35968
    ds_read_b64_tr_b16 v[46:47], v2 offset:38528
    s_waitcnt lgkmcnt(14)
    v_mfma_f32_16x16x32_bf16 v[56:59], v[120:123], v[16:19], v[56:59]
    s_waitcnt vmcnt(3)
    s_barrier
    ds_read_b64_tr_b16 v[16:17], v2 offset:40960
    ds_read_b64_tr_b16 v[18:19], v2 offset:43520
    s_waitcnt lgkmcnt(14)
    v_mfma_f32_16x16x32_bf16 v[60:63], v[120:123], v[20:23], v[60:63]
    v_mfma_f32_16x16x32_bf16 v[64:67], v[20:23], v[20:23], v[64:67]
    v_mfma_f32_16x16x32_bf16 v[68:71], v[10:13], v[20:23], v[68:71]
    ds_read_b64_tr_b16 v[20:21], v2 offset:40992
    ds_read_b64_tr_b16 v[22:23], v2 offset:43552
    s_waitcnt lgkmcnt(14)
    v_mfma_f32_16x16x32_bf16 v[72:75], v[120:123], v[24:27], v[72:75]
    v_mfma_f32_16x16x32_bf16 v[76:79], v[24:27], v[24:27], v[76:79]
    v_mfma_f32_16x16x32_bf16 v[80:83], v[10:13], v[24:27], v[80:83]
    ds_read_b64_tr_b16 v[24:25], v2 offset:41024
    ds_read_b64_tr_b16 v[26:27], v2 offset:43584
    s_waitcnt lgkmcnt(14)
    v_mfma_f32_16x16x32_bf16 v[48:51], v[124:127], v[28:31], v[48:51]
    ds_read_b64_tr_b16 v[28:29], v2 offset:41056
    ds_read_b64_tr_b16 v[30:31], v2 offset:43616
    s_waitcnt lgkmcnt(14)
    v_mfma_f32_16x16x32_bf16 v[52:55], v[124:127], v[32:35], v[52:55]
    ds_read_b64_tr_b16 v[32:33], v2 offset:41088
    ds_read_b64_tr_b16 v[34:35], v2 offset:43648
    s_waitcnt lgkmcnt(14)
    v_mfma_f32_16x16x32_bf16 v[56:59], v[124:127], v[36:39], v[56:59]
    ds_read_b64_tr_b16 v[36:37], v2 offset:46080
    ds_read_b64_tr_b16 v[38:39], v2 offset:48640
    s_waitcnt lgkmcnt(14)
    v_mfma_f32_16x16x32_bf16 v[60:63], v[124:127], v[40:43], v[60:63]
    v_mfma_f32_16x16x32_bf16 v[64:67], v[40:43], v[40:43], v[64:67]
    v_mfma_f32_16x16x32_bf16 v[68:71], v[10:13], v[40:43], v[68:71]
    ds_read_b64_tr_b16 v[40:41], v2 offset:46112
    ds_read_b64_tr_b16 v[42:43], v2 offset:48672
    s_waitcnt lgkmcnt(14)
    v_mfma_f32_16x16x32_bf16 v[72:75], v[124:127], v[44:47], v[72:75]
    v_mfma_f32_16x16x32_bf16 v[76:79], v[44:47], v[44:47], v[76:79]
    v_mfma_f32_16x16x32_bf16 v[80:83], v[10:13], v[44:47], v[80:83]
    ds_read_b64_tr_b16 v[44:45], v2 offset:46144
    ds_read_b64_tr_b16 v[46:47], v2 offset:48704
    s_waitcnt lgkmcnt(14)
    v_mfma_f32_16x16x32_bf16 v[48:51], v[128:131], v[16:19], v[48:51]
    ds_read_b64_tr_b16 v[16:17], v2 offset:46176
    ds_read_b64_tr_b16 v[18:19], v2 offset:48736
    s_waitcnt lgkmcnt(14)
    v_mfma_f32_16x16x32_bf16 v[52:55], v[128:131], v[20:23], v[52:55]
    ds_read_b64_tr_b16 v[20:21], v2 offset:46208
    ds_read_b64_tr_b16 v[22:23], v2 offset:48768
    s_waitcnt lgkmcnt(14)
    v_mfma_f32_16x16x32_bf16 v[56:59], v[128:131], v[24:27], v[56:59]
    ds_read_b64_tr_b16 v[24:25], v2 offset:51200
    ds_read_b64_tr_b16 v[26:27], v2 offset:53760
    s_waitcnt lgkmcnt(14)
    v_mfma_f32_16x16x32_bf16 v[60:63], v[128:131], v[28:31], v[60:63]
    v_mfma_f32_16x16x32_bf16 v[64:67], v[28:31], v[28:31], v[64:67]
    v_mfma_f32_16x16x32_bf16 v[68:71], v[10:13], v[28:31], v[68:71]
    ds_read_b64_tr_b16 v[28:29], v2 offset:51232
    ds_read_b64_tr_b16 v[30:31], v2 offset:53792
    s_waitcnt lgkmcnt(14)
    v_mfma_f32_16x16x32_bf16 v[72:75], v[128:131], v[32:35], v[72:75]
    v_mfma_f32_16x16x32_bf16 v[76:79], v[32:35], v[32:35], v[76:79]
    v_mfma_f32_16x16x32_bf16 v[80:83], v[10:13], v[32:35], v[80:83]
    ds_read_b64_tr_b16 v[32:33], v2 offset:51264
    ds_read_b64_tr_b16 v[34:35], v2 offset:53824
    s_waitcnt lgkmcnt(14)
    v_mfma_f32_16x16x32_bf16 v[48:51], v[132:135], v[36:39], v[48:51]
    ds_read_b64_tr_b16 v[36:37], v2 offset:51296
    ds_read_b64_tr_b16 v[38:39], v2 offset:53856
    s_waitcnt lgkmcnt(14)
    v_mfma_f32_16x16x32_bf16 v[52:55], v[132:135], v[40:43], v[52:55]
    ds_read_b64_tr_b16 v[40:41], v2 offset:51328
    ds_read_b64_tr_b16 v[42:43], v2 offset:53888
    s_waitcnt lgkmcnt(14)
    v_mfma_f32_16x16x32_bf16 v[56:59], v[132:135], v[44:47], v[56:59]
    ds_read_b64_tr_b16 v[44:45], v2 offset:56320
    ds_read_b64_tr_b16 v[46:47], v2 offset:58880
    s_waitcnt lgkmcnt(14)
    v_mfma_f32_16x16x32_bf16 v[60:63], v[132:135], v[16:19], v[60:63]
    v_mfma_f32_16x16x32_bf16 v[64:67], v[16:19], v[16:19], v[64:67]
    v_mfma_f32_16x16x32_bf16 v[68:71], v[10:13], v[16:19], v[68:71]
    ds_read_b64_tr_b16 v[16:17], v2 offset:56352
    ds_read_b64_tr_b16 v[18:19], v2 offset:58912
    s_waitcnt lgkmcnt(14)
    v_mfma_f32_16x16x32_bf16 v[72:75], v[132:135], v[20:23], v[72:75]
    v_mfma_f32_16x16x32_bf16 v[76:79], v[20:23], v[20:23], v[76:79]
    v_mfma_f32_16x16x32_bf16 v[80:83], v[10:13], v[20:23], v[80:83]
    ds_read_b64_tr_b16 v[20:21], v2 offset:56384
    ds_read_b64_tr_b16 v[22:23], v2 offset:58944
    s_waitcnt lgkmcnt(14)
    v_mfma_f32_16x16x32_bf16 v[48:51], v[136:139], v[24:27], v[48:51]
    ds_read_b64_tr_b16 v[24:25], v2 offset:56416
    ds_read_b64_tr_b16 v[26:27], v2 offset:58976
    s_waitcnt lgkmcnt(14)
    v_mfma_f32_16x16x32_bf16 v[52:55], v[136:139], v[28:31], v[52:55]
    ds_read_b64_tr_b16 v[28:29], v2 offset:56448
    ds_read_b64_tr_b16 v[30:31], v2 offset:59008
    s_waitcnt lgkmcnt(14)
    v_mfma_f32_16x16x32_bf16 v[56:59], v[136:139], v[32:35], v[56:59]
    ds_read_b64_tr_b16 v[32:33], v3 offset:0
    ds_read_b64_tr_b16 v[34:35], v3 offset:2560
    s_waitcnt lgkmcnt(14)
    v_mfma_f32_16x16x32_bf16 v[60:63], v[136:139], v[36:39], v[60:63]
    v_mfma_f32_16x16x32_bf16 v[64:67], v[36:39], v[36:39], v[64:67]
    v_mfma_f32_16x16x32_bf16 v[68:71], v[10:13], v[36:39], v[68:71]
    ds_read_b64_tr_b16 v[36:37], v3 offset:32
    ds_read_b64_tr_b16 v[38:39], v3 offset:2592
    s_waitcnt lgkmcnt(14)
    v_mfma_f32_16x16x32_bf16 v[72:75], v[136:139], v[40:43], v[72:75]
    v_mfma_f32_16x16x32_bf16 v[76:79], v[40:43], v[40:43], v[76:79]
    v_mfma_f32_16x16x32_bf16 v[80:83], v[10:13], v[40:43], v[80:83]
    ds_read_b64_tr_b16 v[40:41], v3 offset:64
    ds_read_b64_tr_b16 v[42:43], v3 offset:2624
    s_waitcnt lgkmcnt(14)
    v_mfma_f32_16x16x32_bf16 v[48:51], v[140:143], v[44:47], v[48:51]
    ds_read_b64_tr_b16 v[44:45], v3 offset:96
    ds_read_b64_tr_b16 v[46:47], v3 offset:2656
    s_waitcnt lgkmcnt(14)
    v_mfma_f32_16x16x32_bf16 v[52:55], v[140:143], v[16:19], v[52:55]
    ds_read_b64_tr_b16 v[16:17], v3 offset:128
    ds_read_b64_tr_b16 v[18:19], v3 offset:2688
    s_waitcnt lgkmcnt(14)
    v_mfma_f32_16x16x32_bf16 v[56:59], v[140:143], v[20:23], v[56:59]
    ds_read_b64_tr_b16 v[20:21], v3 offset:5120
    ds_read_b64_tr_b16 v[22:23], v3 offset:7680
    s_waitcnt lgkmcnt(14)
    v_mfma_f32_16x16x32_bf16 v[60:63], v[140:143], v[24:27], v[60:63]
    v_mfma_f32_16x16x32_bf16 v[64:67], v[24:27], v[24:27], v[64:67]
    v_mfma_f32_16x16x32_bf16 v[68:71], v[10:13], v[24:27], v[68:71]
    ds_read_b64_tr_b16 v[24:25], v3 offset:5152
    ds_read_b64_tr_b16 v[26:27], v3 offset:7712
    s_waitcnt lgkmcnt(14)
    v_mfma_f32_16x16x32_bf16 v[72:75], v[140:143], v[28:31], v[72:75]
    v_mfma_f32_16x16x32_bf16 v[76:79], v[28:31], v[28:31], v[76:79]
    v_mfma_f32_16x16x32_bf16 v[80:83], v[10:13], v[28:31], v[80:83]
    ds_read_b64_tr_b16 v[28:29], v3 offset:5184
    ds_read_b64_tr_b16 v[30:31], v3 offset:7744
    s_waitcnt lgkmcnt(14)
    v_mfma_f32_16x16x32_bf16 v[48:51], v[144:147], v[32:35], v[48:51]
    ds_read_b64_tr_b16 v[32:33], v3 offset:5216
    ds_read_b64_tr_b16 v[34:35], v3 offset:7776
    s_waitcnt lgkmcnt(14)
    v_mfma_f32_16x16x32_bf16 v[52:55], v[144:147], v[36:39], v[52:55]
    ds_read_b64_tr_b16 v[36:37], v3 offset:5248
    ds_read_b64_tr_b16 v[38:39], v3 offset:7808
    s_waitcnt lgkmcnt(14)
    v_mfma_f32_16x16x32_bf16 v[56:59], v[144:147], v[40:43], v[56:59]
    s_waitcnt vmcnt(0)
    s_barrier
    ds_read_b64_tr_b16 v[40:41], v3 offset:10240
    ds_read_b64_tr_b16 v[42:43], v3 offset:12800
    s_waitcnt lgkmcnt(14)
    v_mfma_f32_16x16x32_bf16 v[60:63], v[144:147], v[44:47], v[60:63]
    v_mfma_f32_16x16x32_bf16 v[64:67], v[44:47], v[44:47], v[64:67]
    v_mfma_f32_16x16x32_bf16 v[68:71], v[10:13], v[44:47], v[68:71]
    ds_read_b64_tr_b16 v[44:45], v3 offset:10272
    ds_read_b64_tr_b16 v[46:47], v3 offset:12832
    s_waitcnt lgkmcnt(14)
    v_mfma_f32_16x16x32_bf16 v[72:75], v[144:147], v[16:19], v[72:75]
    v_mfma_f32_16x16x32_bf16 v[76:79], v[16:19], v[16:19], v[76:79]
    v_mfma_f32_16x16x32_bf16 v[80:83], v[10:13], v[16:19], v[80:83]
    ds_read_b64_tr_b16 v[16:17], v3 offset:10304
    ds_read_b64_tr_b16 v[18:19], v3 offset:12864
    s_waitcnt lgkmcnt(14)
    v_mfma_f32_16x16x32_bf16 v[48:51], v[148:151], v[20:23], v[48:51]
    ds_read_b64_tr_b16 v[20:21], v3 offset:10336
    ds_read_b64_tr_b16 v[22:23], v3 offset:12896
    s_waitcnt lgkmcnt(14)
    v_mfma_f32_16x16x32_bf16 v[52:55], v[148:151], v[24:27], v[52:55]
    ds_read_b64_tr_b16 v[24:25], v3 offset:10368
    ds_read_b64_tr_b16 v[26:27], v3 offset:12928
    s_waitcnt lgkmcnt(14)
    v_mfma_f32_16x16x32_bf16 v[56:59], v[148:151], v[28:31], v[56:59]
    ds_read_b64_tr_b16 v[28:29], v3 offset:15360
    ds_read_b64_tr_b16 v[30:31], v3 offset:17920
    s_waitcnt lgkmcnt(14)
    v_mfma_f32_16x16x32_bf16 v[60:63], v[148:151], v[32:35], v[60:63]
    v_mfma_f32_16x16x32_bf16 v[64:67], v[32:35], v[32:35], v[64:67]
    v_mfma_f32_16x16x32_bf16 v[68:71], v[10:13], v[32:35], v[68:71]
    ds_read_b64_tr_b16 v[32:33], v3 offset:15392
    ds_read_b64_tr_b16 v[34:35], v3 offset:17952
    s_waitcnt lgkmcnt(14)
    v_mfma_f32_16x16x32_bf16 v[72:75], v[148:151], v[36:39], v[72:75]
    v_mfma_f32_16x16x32_bf16 v[76:79], v[36:39], v[36:39], v[76:79]
    v_mfma_f32_16x16x32_bf16 v[80:83], v[10:13], v[36:39], v[80:83]
    ds_read_b64_tr_b16 v[36:37], v3 offset:15424
    ds_read_b64_tr_b16 v[38:39], v3 offset:17984
    s_waitcnt lgkmcnt(14)
    v_mfma_f32_16x16x32_bf16 v[48:51], v[152:155], v[40:43], v[48:51]
    ds_read_b64_tr_b16 v[40:41], v3 offset:15456
    ds_read_b64_tr_b16 v[42:43], v3 offset:18016
    s_waitcnt lgkmcnt(14)
    v_mfma_f32_16x16x32_bf16 v[52:55], v[152:155], v[44:47], v[52:55]
    ds_read_b64_tr_b16 v[44:45], v3 offset:15488
    ds_read_b64_tr_b16 v[46:47], v3 offset:18048
    s_waitcnt lgkmcnt(14)
    v_mfma_f32_16x16x32_bf16 v[56:59], v[152:155], v[16:19], v[56:59]
    ds_read_b64_tr_b16 v[16:17], v3 offset:20480
    ds_read_b64_tr_b16 v[18:19], v3 offset:23040
    s_waitcnt lgkmcnt(14)
    v_mfma_f32_16x16x32_bf16 v[60:63], v[152:155], v[20:23], v[60:63]
    v_mfma_f32_16x16x32_bf16 v[64:67], v[20:23], v[20:23], v[64:67]
    v_mfma_f32_16x16x32_bf16 v[68:71], v[10:13], v[20:23], v[68:71]
    ds_read_b64_tr_b16 v[20:21], v3 offset:20512
    ds_read_b64_tr_b16 v[22:23], v3 offset:23072
    s_waitcnt lgkmcnt(14)
    v_mfma_f32_16x16x32_bf16 v[72:75], v[152:155], v[24:27], v[72:75]
    v_mfma_f32_16x16x32_bf16 v[76:79], v[24:27], v[24:27], v[76:79]
    v_mfma_f32_16x16x32_bf16 v[80:83], v[10:13], v[24:27], v[80:83]
    ds_read_b64_tr_b16 v[24:25], v3 offset:20544
    ds_read_b64_tr_b16 v[26:27], v3 offset:23104
    s_waitcnt lgkmcnt(14)
    v_mfma_f32_16x16x32_bf16 v[48:51], v[156:159], v[28:31], v[48:51]
    ds_read_b64_tr_b16 v[28:29], v3 offset:20576
    ds_read_b64_tr_b16 v[30:31], v3 offset:23136
    s_waitcnt lgkmcnt(14)
    v_mfma_f32_16x16x32_bf16 v[52:55], v[156:159], v[32:35], v[52:55]
    ds_read_b64_tr_b16 v[32:33], v3 offset:20608
    ds_read_b64_tr_b16 v[34:35], v3 offset:23168
    s_waitcnt lgkmcnt(14)
    v_mfma_f32_16x16x32_bf16 v[56:59], v[156:159], v[36:39], v[56:59]
    ds_read_b64_tr_b16 v[36:37], v3 offset:25600
    ds_read_b64_tr_b16 v[38:39], v3 offset:28160
    s_waitcnt lgkmcnt(14)
    v_mfma_f32_16x16x32_bf16 v[60:63], v[156:159], v[40:43], v[60:63]
    v_mfma_f32_16x16x32_bf16 v[64:67], v[40:43], v[40:43], v[64:67]
    v_mfma_f32_16x16x32_bf16 v[68:71], v[10:13], v[40:43], v[68:71]
    ds_read_b64_tr_b16 v[40:41], v3 offset:25632
    ds_read_b64_tr_b16 v[42:43], v3 offset:28192
    s_waitcnt lgkmcnt(14)
    v_mfma_f32_16x16x32_bf16 v[72:75], v[156:159], v[44:47], v[72:75]
    v_mfma_f32_16x16x32_bf16 v[76:79], v[44:47], v[44:47], v[76:79]
    v_mfma_f32_16x16x32_bf16 v[80:83], v[10:13], v[44:47], v[80:83]
    ds_read_b64_tr_b16 v[44:45], v3 offset:25664
    ds_read_b64_tr_b16 v[46:47], v3 offset:28224
    s_waitcnt lgkmcnt(14)
    v_mfma_f32_16x16x32_bf16 v[48:51], v[160:163], v[16:19], v[48:51]
    ds_read_b64_tr_b16 v[16:17], v3 offset:25696
    ds_read_b64_tr_b16 v[18:19], v3 offset:28256
    s_waitcnt lgkmcnt(14)
    v_mfma_f32_16x16x32_bf16 v[52:55], v[160:163], v[20:23], v[52:55]
    ds_read_b64_tr_b16 v[20:21], v3 offset:25728
    ds_read_b64_tr_b16 v[22:23], v3 offset:28288
    s_waitcnt lgkmcnt(14)
    v_mfma_f32_16x16x32_bf16 v[56:59], v[160:163], v[24:27], v[56:59]
    ds_read_b64_tr_b16 v[24:25], v3 offset:30720
    ds_read_b64_tr_b16 v[26:27], v3 offset:33280
    s_waitcnt lgkmcnt(14)
    v_mfma_f32_16x16x32_bf16 v[60:63], v[160:163], v[28:31], v[60:63]
    v_mfma_f32_16x16x32_bf16 v[64:67], v[28:31], v[28:31], v[64:67]
    v_mfma_f32_16x16x32_bf16 v[68:71], v[10:13], v[28:31], v[68:71]
    ds_read_b64_tr_b16 v[28:29], v3 offset:30752
    ds_read_b64_tr_b16 v[30:31], v3 offset:33312
    s_waitcnt lgkmcnt(14)
    v_mfma_f32_16x16x32_bf16 v[72:75], v[160:163], v[32:35], v[72:75]
    v_mfma_f32_16x16x32_bf16 v[76:79], v[32:35], v[32:35], v[76:79]
    v_mfma_f32_16x16x32_bf16 v[80:83], v[10:13], v[32:35], v[80:83]
    ds_read_b64_tr_b16 v[32:33], v3 offset:30784
    ds_read_b64_tr_b16 v[34:35], v3 offset:33344
    s_waitcnt lgkmcnt(14)
    v_mfma_f32_16x16x32_bf16 v[48:51], v[164:167], v[36:39], v[48:51]
    ds_read_b64_tr_b16 v[36:37], v3 offset:30816
    ds_read_b64_tr_b16 v[38:39], v3 offset:33376
    s_waitcnt lgkmcnt(14)
    v_mfma_f32_16x16x32_bf16 v[52:55], v[164:167], v[40:43], v[52:55]
    ds_read_b64_tr_b16 v[40:41], v3 offset:30848
    ds_read_b64_tr_b16 v[42:43], v3 offset:33408
    s_waitcnt lgkmcnt(14)
    v_mfma_f32_16x16x32_bf16 v[56:59], v[164:167], v[44:47], v[56:59]
    ds_read_b64_tr_b16 v[44:45], v3 offset:35840
    ds_read_b64_tr_b16 v[46:47], v3 offset:38400
    s_waitcnt lgkmcnt(14)
    v_mfma_f32_16x16x32_bf16 v[60:63], v[164:167], v[16:19], v[60:63]
    v_mfma_f32_16x16x32_bf16 v[64:67], v[16:19], v[16:19], v[64:67]
    v_mfma_f32_16x16x32_bf16 v[68:71], v[10:13], v[16:19], v[68:71]
    ds_read_b64_tr_b16 v[16:17], v3 offset:35872
    ds_read_b64_tr_b16 v[18:19], v3 offset:38432
    s_waitcnt lgkmcnt(14)
    v_mfma_f32_16x16x32_bf16 v[72:75], v[164:167], v[20:23], v[72:75]
    v_mfma_f32_16x16x32_bf16 v[76:79], v[20:23], v[20:23], v[76:79]
    v_mfma_f32_16x16x32_bf16 v[80:83], v[10:13], v[20:23], v[80:83]
    ds_read_b64_tr_b16 v[20:21], v3 offset:35904
    ds_read_b64_tr_b16 v[22:23], v3 offset:38464
    s_waitcnt lgkmcnt(14)
    v_mfma_f32_16x16x32_bf16 v[48:51], v[168:171], v[24:27], v[48:51]
    ds_read_b64_tr_b16 v[24:25], v3 offset:35936
    ds_read_b64_tr_b16 v[26:27], v3 offset:38496
    s_waitcnt lgkmcnt(14)
    v_mfma_f32_16x16x32_bf16 v[52:55], v[168:171], v[28:31], v[52:55]
    ds_read_b64_tr_b16 v[28:29], v3 offset:35968
    ds_read_b64_tr_b16 v[30:31], v3 offset:38528
    s_waitcnt lgkmcnt(14)
    v_mfma_f32_16x16x32_bf16 v[56:59], v[168:171], v[32:35], v[56:59]
    s_waitcnt lgkmcnt(12)
    v_mfma_f32_16x16x32_bf16 v[60:63], v[168:171], v[36:39], v[60:63]
    v_mfma_f32_16x16x32_bf16 v[64:67], v[36:39], v[36:39], v[64:67]
    v_mfma_f32_16x16x32_bf16 v[68:71], v[10:13], v[36:39], v[68:71]
    s_waitcnt lgkmcnt(10)
    v_mfma_f32_16x16x32_bf16 v[72:75], v[168:171], v[40:43], v[72:75]
    v_mfma_f32_16x16x32_bf16 v[76:79], v[40:43], v[40:43], v[76:79]
    v_mfma_f32_16x16x32_bf16 v[80:83], v[10:13], v[40:43], v[80:83]
    s_waitcnt lgkmcnt(8)
    v_mfma_f32_16x16x32_bf16 v[48:51], v[172:175], v[44:47], v[48:51]
    s_waitcnt lgkmcnt(6)
    v_mfma_f32_16x16x32_bf16 v[52:55], v[172:175], v[16:19], v[52:55]
    s_waitcnt lgkmcnt(4)
    v_mfma_f32_16x16x32_bf16 v[56:59], v[172:175], v[20:23], v[56:59]
    s_waitcnt lgkmcnt(2)
    v_mfma_f32_16x16x32_bf16 v[60:63], v[172:175], v[24:27], v[60:63]
    v_mfma_f32_16x16x32_bf16 v[64:67], v[24:27], v[24:27], v[64:67]
    v_mfma_f32_16x16x32_bf16 v[68:71], v[10:13], v[24:27], v[68:71]
    s_waitcnt lgkmcnt(0)
    v_mfma_f32_16x16x32_bf16 v[72:75], v[172:175], v[28:31], v[72:75]
    v_mfma_f32_16x16x32_bf16 v[76:79], v[28:31], v[28:31], v[76:79]
    v_mfma_f32_16x16x32_bf16 v[80:83], v[10:13], v[28:31], v[80:83]
    ds_read_b64 v[10:11], v7
    ds_read_b64 v[12:13], v8
    ds_read_b64 v[14:15], v9
    v_and_b32 v16, 15, v1
    v_lshrrev_b32 v17, 4, v1
    v_and_b32 v18, 3, v1
    v_lshrrev_b32 v19, 2, v16
    v_cmp_eq_u32 s[42:43], 1, v18
    v_cmp_eq_u32 s[44:45], 2, v18
    v_cmp_eq_u32 s[46:47], 3, v18
    v_cmp_eq_u32 s[48:49], v19, v17
    v_lshlrev_b32 v18, 3, v16
    v_add_u32 v18, 45376, v18
    v_cndmask_b32 v64, v64, v65, s[42:43]
    v_cndmask_b32 v76, v76, v77, s[42:43]
    v_cndmask_b32 v64, v64, v66, s[44:45]
    v_cndmask_b32 v76, v76, v78, s[44:45]
    v_cndmask_b32 v64, v64, v67, s[46:47]
    v_cndmask_b32 v76, v76, v79, s[46:47]
    v_mul_f32 v68, 0x3acccccd, v68
    v_mul_f32 v64, 0x3acccccd, v64
    v_mul_f32 v80, 0x3acccccd, v80
    v_mul_f32 v76, 0x3acccccd, v76
    v_fma_f32 v64, -v68, v68, v64
    v_fma_f32 v76, -v80, v80, v76
    v_max_f32 v64, 0, v64
    v_max_f32 v76, 0, v76
    v_cvt_pk_bf16_f32 v68, v68, v64
    v_cvt_pk_bf16_f32 v80, v80, v76
    v_and_b32 v64, 0xffff0000, v68
    v_lshlrev_b32 v68, 16, v68
    v_and_b32 v76, 0xffff0000, v80
    v_lshlrev_b32 v80, 16, v80
    v_add_f32 v64, 0x3727c5ac, v64
    v_add_f32 v76, 0x3727c5ac, v76
    v_cvt_pk_bf16_f32 v64, v64, v64
    v_cvt_pk_bf16_f32 v76, v76, v76
    v_lshlrev_b32 v64, 16, v64
    v_lshlrev_b32 v76, 16, v76
    v_sqrt_f32 v64, v64
    v_sqrt_f32 v76, v76
    v_cvt_pk_bf16_f32 v64, v64, v64
    v_cvt_pk_bf16_f32 v76, v76, v76
    v_lshlrev_b32 v64, 16, v64
    v_lshlrev_b32 v76, 16, v76
    v_rcp_f32 v69, v64
    v_rcp_f32 v81, v76
    s_mov_b64 exec, s[48:49]
    ds_write_b64 v18, v[68:69] offset:384
    ds_write_b64 v18, v[80:81] offset:512
    s_mov_b64 exec, -1
    s_lshl_b32 s42, s3, 7
    s_add_u32 s42, s42, 46016
    v_lshl_add_u32 v19, v17, 4, s42
    s_lshl_b32 s42, s3, 6
    s_cmp_eq_u32 s3, 2
    s_cselect_b32 s42, 192, s42
    s_cmp_eq_u32 s3, 3
    s_cselect_b32 s42, 128, s42
    s_add_u32 s42, s42, 61440
    v_mul_u32_u24 v20, 496, v16
    v_lshl_add_u32 v20, v17, 3, v20
    v_add_u32 v20, s42, v20
    v_lshlrev_b32 v18, 3, v16
    v_add_u32 v18, 45376, v18
    s_waitcnt lgkmcnt(0)
    s_barrier
    ds_read_b64 v[24:25], v18 offset:0
    ds_read_b64 v[26:27], v18 offset:128
    ds_read_b64 v[28:29], v18 offset:256
    ds_read_b64 v[30:31], v18 offset:384
    ds_read_b64 v[32:33], v18 offset:512
    ds_read_b128 v[36:39], v19 offset:0
    s_waitcnt lgkmcnt(0)
    v_fma_f32 v48, -v24, v36, v48
    v_fma_f32 v49, -v24, v37, v49
    v_fma_f32 v50, -v24, v38, v50
    v_fma_f32 v51, -v24, v39, v51
    v_fma_f32 v52, -v26, v36, v52
    v_fma_f32 v53, -v26, v37, v53
    v_fma_f32 v54, -v26, v38, v54
    v_fma_f32 v55, -v26, v39, v55
    v_fma_f32 v56, -v28, v36, v56
    v_fma_f32 v57, -v28, v37, v57
    v_fma_f32 v58, -v28, v38, v58
    v_fma_f32 v59, -v28, v39, v59
    v_fma_f32 v60, -v30, v36, v60
    v_fma_f32 v61, -v30, v37, v61
    v_fma_f32 v62, -v30, v38, v62
    v_fma_f32 v63, -v30, v39, v63
    v_fma_f32 v72, -v32, v36, v72
    v_fma_f32 v73, -v32, v37, v73
    v_fma_f32 v74, -v32, v38, v74
    v_fma_f32 v75, -v32, v39, v75
    v_mul_f32 v48, v48, v25
    v_mul_f32 v49, v49, v25
    v_mul_f32 v50, v50, v25
    v_mul_f32 v51, v51, v25
    v_mul_f32 v52, v52, v27
    v_mul_f32 v53, v53, v27
    v_mul_f32 v54, v54, v27
    v_mul_f32 v55, v55, v27
    v_mul_f32 v56, v56, v29
    v_mul_f32 v57, v57, v29
    v_mul_f32 v58, v58, v29
    v_mul_f32 v59, v59, v29
    v_mul_f32 v60, v60, v31
    v_mul_f32 v61, v61, v31
    v_mul_f32 v62, v62, v31
    v_mul_f32 v63, v63, v31
    v_mul_f32 v72, v72, v33
    v_mul_f32 v73, v73, v33
    v_mul_f32 v74, v74, v33
    v_mul_f32 v75, v75, v33
    v_cvt_pk_bf16_f32 v48, v48, v49
    v_cvt_pk_bf16_f32 v49, v50, v51
    ds_write_b64 v20, v[48:49] offset:0
    v_cvt_pk_bf16_f32 v52, v52, v53
    v_cvt_pk_bf16_f32 v53, v54, v55
    ds_write_b64 v20, v[52:53] offset:7936
    v_cvt_pk_bf16_f32 v56, v56, v57
    v_cvt_pk_bf16_f32 v57, v58, v59
    ds_write_b64 v20, v[56:57] offset:15872
    v_cvt_pk_bf16_f32 v60, v60, v61
    v_cvt_pk_bf16_f32 v61, v62, v63
    ds_write_b64 v20, v[60:61] offset:23808
    v_cvt_pk_bf16_f32 v72, v72, v73
    v_cvt_pk_bf16_f32 v73, v74, v75
    ds_write_b64 v20, v[72:73] offset:31744
    s_branch L_a1_post
L_fin:
    s_or_b32 s42, s2, s3
    s_cmp_eq_u32 s42, 0
    s_cbranch_scc0 L_fin2
    s_mov_b32 s42, 0
    v_mov_b32 v2, s42
    v_mov_b32 v4, s34
    v_mov_b32 v5, s35
    s_mov_b64 exec, 1
    global_store_dwordx2 v2, v[4:5], s[32:33] sc1
    s_mov_b64 exec, -1
L_fin2:
L_end:
    s_endpgm
.p2align 7
L_tab1:
.short 3072, 3072, 3072, 3072, 3072, 3072, 3072, 3072, 3072, 3072, 3072, 3072, 3072, 3072, 3072, 3072
.short 3072, 3072, 3072, 3072, 3072, 3072, 3072, 3072, 3072, 3072, 3072, 3072, 2048, 2048, 3072, 3072
.short 3072, 3072, 3072, 3072, 3072, 3072, 3072, 3072, 3072, 3072, 3072, 3072, 3072, 3072, 3072, 3072
.short 3072, 3072, 3072, 3072, 3072, 3072, 3072, 3072, 3072, 3072, 3072, 3072, 3072, 3072, 1536, 1536
.short 1536, 1536, 1532, 1528, 1528, 1528, 1524, 1520, 1520, 1520, 1516, 1512, 1512, 1512, 1508, 1504
.short 1504, 1504, 1500, 1496, 1496, 1496, 1492, 1488, 1488, 1488, 1484, 1480, 1480, 1480, 1476, 1472
.short 1472, 1472, 1468, 1464, 1464, 1464, 1460, 1456, 1456, 1456, 1452, 1448, 1448, 1448, 1444, 1440
.short 1440, 1440, 1436, 1432, 1432, 1432, 1428, 1424, 1424, 1424, 1420, 1416, 1416, 1416, 1412, 1408
.short 1408, 1408, 1404, 1400, 1400, 1400, 1396, 1392, 1392, 1392, 1388, 1384, 1384, 1384, 1380, 1376
.short 1376, 1376, 1372, 1368, 1368, 1368, 1364, 1360, 1360, 1360, 1356, 1352, 1352, 1352, 1348, 1344
.short 1344, 1344, 1340, 1336, 1336, 1336, 1332, 1328, 1328, 1328, 1324, 1320, 1320, 1320, 1316, 1312
.short 1312, 1312, 1308, 1304, 1304, 1304, 1300, 1296, 1296, 1296, 1292, 1288, 1288, 1288, 1284, 1280
.short 1280, 1280, 1276, 1272, 1272, 1272, 1268, 1264, 1264, 1264, 1260, 1256, 1256, 1256, 1252, 1248
.short 1248, 1248, 1244, 1240, 1240, 1240, 1236, 1232, 1232, 1232, 1228, 1224, 1224, 1224, 1220, 1216
.short 1216, 1216, 1212, 1208, 1208, 1208, 1204, 1200, 1200, 1200, 1196, 1192, 1192, 1192, 1188, 1184
.short 1184, 1184, 1180, 1176, 1176, 1176, 1172, 1168, 1168, 1168, 1164, 1160, 1160, 1160, 1156, 1152
.short 1152, 1152, 1148, 1144, 1144, 1144, 1140, 1136, 1136, 1136, 1132, 1128, 1128, 1128, 1124, 1120
.short 1120, 1120, 1116, 1112, 1112, 1112, 1108, 1104, 1104, 1104, 1100, 1096, 1096, 1096, 1092, 1088
.short 1088, 1088, 1084, 1080, 1080, 1080, 1076, 1072, 1072, 1072, 1068, 1064, 1064, 1064, 1060, 1056
.short 1056, 1056, 1052, 1048, 1048, 1048, 1044, 1040, 1040, 1040, 1036, 1032, 1032, 1032, 1028, 1024
.short 1024, 1020, 1016, 1012, 1008, 764, 760, 756, 752, 1004, 1000, 996, 992, 748, 744, 740
.short 736, 988, 984, 980, 976, 732, 728, 724, 720, 972, 968, 964, 960, 716, 712, 708
.short 704, 956, 952, 948, 944, 700, 696, 692, 688, 940, 936, 932, 928, 684, 680, 676
.short 672, 924, 920, 916, 912, 668, 664, 660, 656, 908, 904, 900, 896, 652, 648, 644
.short 640, 892, 888, 884, 880, 636, 632, 628, 624, 876, 872, 868, 864, 620, 616, 612
.short 608, 860, 856, 852, 848, 604, 600, 596, 592, 844, 840, 836, 832, 588, 584, 580
.short 576, 828, 824, 820, 816, 572, 568, 564, 560, 812, 808, 804, 800, 556, 552, 548
.short 544, 796, 792, 788, 784, 540, 536, 532, 528, 780, 776, 772, 768, 524, 520, 516
.short 512, 508, 504, 500, 496, 252, 248, 244, 240, 492, 488, 484, 480, 236, 232, 228
.short 224, 476, 472, 468, 464, 220, 216, 212, 208, 460, 456, 452, 448, 204, 200, 196
.short 192, 444, 440, 436, 432, 188, 184, 180, 176, 428, 424, 420, 416, 172, 168, 164
.short 160, 412, 408, 404, 400, 156, 152, 148, 144, 396, 392, 388, 384, 140, 136, 132
.short 128, 380, 376, 372, 368, 124, 120, 116, 112, 364, 360, 356, 352, 108, 104, 100
.short 96, 348, 344, 340, 336, 92, 88, 84, 80, 332, 328, 324, 320, 76, 72, 68
.short 64, 316, 312, 308, 304, 60, 56, 52, 48, 300, 296, 292, 288, 44, 40, 36
.short 32, 284, 280, 276, 272, 28, 24, 20, 16, 268, 264, 260, 256, 12, 8, 4
.short 0, 3072, 3072, 3072, 3072, 3072, 3072, 3072, 3072, 3072, 3072, 3072, 3072, 3072, 3072, 3072
.short 3072, 3072, 3072, 3072, 3072, 3072, 3072, 3072, 3072, 2560, 2540, 2508, 2476, 2444, 2412, 2380
.short 2348, 2316, 2536, 2504, 2472, 2440, 2408, 2376, 2344, 2312, 2532, 2500, 2468, 2436, 2404, 2372
.short 2340, 2308, 2528, 2496, 2464, 2432, 2400, 2368, 2336, 2304, 2284, 2252, 2220, 2188, 2156, 2124
.short 2092, 2060, 2280, 2248, 2216, 2184, 2152, 2120, 2088, 2056, 2276, 2244, 2212, 2180, 2148, 2116
.short 2084, 2052, 2272, 2240, 2208, 2176, 2144, 2112, 2080, 3072, 3072, 3072, 3072, 3072, 3072, 3072
.short 3072, 3072, 3072, 3072, 3072, 3072, 3072, 3072, 3072, 3072, 3072, 3072, 3072, 3072, 3072, 3072
.short 3072, 3072, 3072, 3072, 3072, 3072, 3072, 3072, 3072, 3072, 3072, 3072, 3072, 3072, 3072, 3072
.short 3072, 2556, 2524, 2492, 2460, 2428, 2396, 2364, 2332, 2552, 2520, 2488, 2456, 2424, 2392, 2360
.short 2328, 2548, 2516, 2484, 2452, 2420, 2388, 2356, 2324, 2544, 2512, 2480, 2448, 2416, 2384, 2352
.short 2320, 2300, 2268, 2236, 2204, 2172, 2140, 2108, 2076, 2296, 2264, 2232, 2200, 2168, 2136, 2104
.short 2072, 2292, 2260, 2228, 2196, 2164, 2132, 2100, 2068, 2288, 2256, 2224, 2192, 2160, 2128, 2096
.short 2064, 3072, 3072, 3072, 3072, 3072, 3072, 3072, 3072, 3072, 3072, 3072, 3072, 3072, 3072, 3072
.short 3072, 3072, 3072, 3072, 3072, 3072, 3072, 3072, 3072, 3072, 3072, 3072, 3072, 3072, 3072, 3072
.short 3072, 3072, 3072, 3072, 3072, 3072, 3072, 3072, 3072, 3072, 3072, 3072, 3072, 3072, 3072, 3072
.short 3072, 3072, 3072, 3072, 3072, 3072, 3072, 3072, 3072, 3072, 3072, 3072, 3072, 3072, 3072, 3072
.short 3072, 3072, 3072, 3072, 3072, 3072, 3072, 3072, 3072, 3072, 2048, 2040, 2024, 2008, 1992, 1976
.short 1960, 1944, 1928, 1912, 1896, 1880, 1864, 1848, 1832, 1816, 1800, 2032, 2016, 2000, 1984, 1968
.short 1952, 1936, 1920, 1904, 1888, 1872, 1856, 1840, 1824, 1808, 1792, 1784, 1768, 1752, 1736, 1720
.short 1704, 1688, 1672, 1656, 1640, 1624, 1608, 1592, 1576, 1560, 1544, 1776, 1760, 1744, 1728, 1712
.short 1696, 1680, 1664, 1648, 1632, 1616, 1600, 1584, 1568, 1552, 3072, 3072, 3072, 3072, 3072, 3072
.short 3072, 3072, 3072, 3072, 3072, 3072, 3072, 3072, 3072, 3072, 3072, 3072, 3072, 3072, 3072, 3072
.short 3072, 3072, 3072, 3072, 3072, 3072, 3072, 3072, 3072, 3072, 3072, 3072, 3072, 3072, 3072, 3072
.short 3072, 3072, 3072, 3072, 3072, 3072, 3072, 3072, 3072, 3072, 3072, 3072, 3072, 3072, 3072, 3072
.short 3072, 3072, 3072, 3072, 3072, 3072, 3072, 3072, 3072, 3072, 3072, 3072, 3072, 3072, 3072, 3072
.short 3072, 3072, 2044, 2028, 2012, 1996, 1980, 1964, 1948, 1932, 1916, 1900, 1884, 1868, 1852, 1836
.short 1820, 1804, 2036, 2020, 2004, 1988, 1972, 1956, 1940, 1924, 1908, 1892, 1876, 1860, 1844, 1828
.short 1812, 1796, 1788, 1772, 1756, 1740, 1724, 1708, 1692, 1676, 1660, 1644, 1628, 1612, 1596, 1580
.short 1564, 1548, 1780, 1764, 1748, 1732, 1716, 1700, 1684, 1668, 1652, 1636, 1620, 1604, 1588, 1572
.short 1556, 1540, 3072, 3072, 3072, 3072, 3072, 3072, 3072, 3072, 3072, 3072, 3072, 3072, 3072, 3072
.short 3072, 3072, 3072, 3072, 3072, 3072, 3072, 3072, 3072, 3072, 3072, 3072, 3072, 3072, 3072, 3072
.short 3072, 3072, 3072, 3072, 3072, 3072, 3072, 3072, 3072, 3072, 3072, 3072, 3072, 3072, 3072, 3072
L_tab2:
.long 16, 1048608, 2097200, 3145792, 4194384, 5242976, 6291568, 7340160
.long 8388752, 9437344, 10485936, 11534528, 12583120, 13631712, 14680304, 15728896
.long 16777488, 17826080, 18874672, 19923264, 20971856, 22020448, 23069040, 24117632
.long 25166224, 26214816, 27263408, 28312000, 29360592, 30409184, 31457776, 32506368
.long 33554960, 34603552, 35652144, 36700736, 37749328, 38797920, 39846512, 40895104
.long 41943696, 42992288, 44040880, 45089472, 46138064, 47186656, 48235248, 49283840
.long 50332432, 51381024, 52429616, 53478208, 54526800, 55575392, 56623984, 57672576
.long 58721168, 59769760, 60818352, 61866944, 62915536, 63964128, 65012720, 66061312
.long 67109904, 68158496, 69207088, 70255680, 71304272, 72352864, 73401456, 74450048
.long 75498640, 76547264, 88081808, 77595856, 89130400, 78644448, 90178992, 79693040
.long 91227584, 80741632, 92276176, 81790224, 93324768, 82838816, 94373360, 83887408
.long 95421952, 84936000, 96470544, 85984592, 97519136, 87033184, 98567728, 104859920
.long 105908512, 106957104, 108005696, 109054288, 110102880, 111151472, 112200064, 113248656
.long 114297248, 115345840, 116394432, 117443024, 118491616, 119540208, 120588800, 121637392
.long 122685984, 123734576, 124783168, 125831760, 126880352, 127928944, 128977536, 130026128
.long 131074720, 132123312, 133171904, 134220496, 135269088, 136317680, 137366272, 138414864
.long 139463456, 140512048, 141560640, 142609232, 143657824, 144706416, 145755008, 146803600
.long 147852192, 148900784, 149949376, 150997968, 152046560, 153095152, 154143744, 155192336
.long 156240928, 157289520, 158338112, 159386704, 160435296, 161483888, 162532480, 163581072
.long 164629664, 165678256, 166726848, 167775440, 168824032, 169872624, 170921216, 171969808
.long 173018400, 174066992, 175115584, 176164176, 177212768, 178261360, 179309952, 180358544
.long 181407168, 192941712, 182455760, 193990304, 183504352, 195038896, 184552944, 196087488
.long 185601536, 197136080, 186650128, 198184672, 187698720, 199233264, 188747312, 200281856
.long 189795904, 201330448, 190844496, 202379040, 191893088, 203427632, 209715212, 210763804
.long 211812396, 212860988, 213909580, 214958172, 216006764, 217055356, 218103948, 219152540
.long 220201132, 221249724, 222298316, 223346908, 224395500, 225444092, 226492684, 227541276
.long 228589868, 229638460, 230687052, 231735644, 232784236, 233832828, 234881420, 235930012
.long 236978604, 238027196, 239075788, 240124380, 241172972, 242221564, 243270156, 244318748
.long 245367340, 246415932, 247464524, 248513116, 249561708, 250610300, 251658892, 252707484
.long 253756076, 254804668, 255853260, 256901852, 257950444, 258999036, 260047628, 261096220
.long 262144812, 263193404, 264241996, 265290588, 266339180, 267387772, 268436364, 269484956
.long 270533548, 271582140, 272630732, 273679324, 274727916, 275776508, 276825100, 277873692
.long 278922284, 279970876, 281019468, 282068060, 283116652, 284165244, 285213836, 286262460
.long 297797004, 287311052, 298845596, 288359644, 299894188, 289408236, 300942780, 290456828
.long 301991372, 291505420, 303039964, 292554012, 304088556, 293602604, 305137148, 294651196
.long 306185740, 295699788, 307234332, 296748380, 308282924, 314575116, 315623708, 316672300
.long 317720892, 318769484, 319818076, 320866668, 321915260, 322963852, 324012444, 325061036
.long 326109628, 327158220, 328206812, 329255404, 330303996, 331352588, 332401180, 333449772
.long 334498364, 335546956, 336595548, 337644140, 338692732, 339741324, 340789916, 341838508
.long 342887100, 343935692, 344984284, 346032876, 347081468, 348130060, 349178652, 350227244
.long 351275836, 352324428, 353373020, 354421612, 355470204, 356518796, 357567388, 358615980
.long 359664572, 360713164, 361761756, 362810348, 363858940, 364907532, 365956124, 367004716
.long 368053308, 369101900, 370150492, 371199084, 372247676, 373296268, 374344860, 375393452
.long 376442044, 377490636, 378539228, 379587820, 380636412, 381685004, 382733596, 383782188
.long 384830780, 385879372, 386927964, 387976556, 389025148, 390073740, 391122364, 402656908
.long 392170956, 403705500, 393219548, 404754092, 394268140, 405802684, 395316732, 406851276
.long 396365324, 407899868, 397413916, 408948460, 398462508, 409997052, 399511100, 411045644
.long 400559692, 412094236, 401608284, 413142828, 419430408, 420479000, 421527592, 422576184
.long 423624776, 424673368, 425721960, 426770552, 427819144, 428867736, 429916328, 430964920
.long 432013512, 433062104, 434110696, 435159288, 436207880, 437256472, 438305064, 439353656
.long 440402248, 441450840, 442499432, 443548024, 444596616, 445645208, 446693800, 447742392
.long 448790984, 449839576, 450888168, 451936760, 452985352, 454033944, 455082536, 456131128
.long 457179720, 458228312, 459276904, 460325496, 461374088, 462422680, 463471272, 464519864
.long 465568456, 466617048, 467665640, 468714232, 469762824, 470811416, 471860008, 472908600
.long 473957192, 475005784, 476054376, 477102968, 478151560, 479200152, 480248744, 481297336
.long 482345928, 483394520, 484443112, 485491704, 486540296, 487588888, 488637480, 489686072
.long 490734664, 491783256, 492831848, 493880440, 494929032, 495977656, 507512200, 497026248
.long 508560792, 498074840, 509609384, 499123432, 510657976, 500172024, 511706568, 501220616
.long 512755160, 502269208, 513803752, 503317800, 514852344, 504366392, 515900936, 505414984
.long 516949528, 506463576, 517998120, 524290312, 525338904, 526387496, 527436088, 528484680
.long 529533272, 530581864, 531630456, 532679048, 533727640, 534776232, 535824824, 536873416
.long 537922008, 538970600, 540019192, 541067784, 542116376, 543164968, 544213560, 545262152
.long 546310744, 547359336, 548407928, 549456520, 550505112, 551553704, 552602296, 553650888
.long 554699480, 555748072, 556796664, 557845256, 558893848, 559942440, 560991032, 562039624
.long 563088216, 564136808, 565185400, 566233992, 567282584, 568331176, 569379768, 570428360
.long 571476952, 572525544, 573574136, 574622728, 575671320, 576719912, 577768504, 578817096
.long 579865688, 580914280, 581962872, 583011464, 584060056, 585108648, 586157240, 587205832
.long 588254424, 589303016, 590351608, 591400200, 592448792, 593497384, 594545976, 595594568
.long 596643160, 597691752, 598740344, 599788936, 600837560, 612372104, 601886152, 613420696
.long 602934744, 614469288, 603983336, 615517880, 605031928, 616566472, 606080520, 617615064
.long 607129112, 618663656, 608177704, 619712248, 609226296, 620760840, 610274888, 621809432
.long 611323480, 622858024, 629145604, 630194196, 631242788, 632291380, 633339972, 634388564
.long 635437156, 636485748, 637534340, 638582932, 639631524, 640680116, 641728708, 642777300
.long 643825892, 644874484, 645923076, 646971668, 648020260, 649068852, 650117444, 651166036
.long 652214628, 653263220, 654311812, 655360404, 656408996, 657457588, 658506180, 659554772
.long 660603364, 661651956, 662700548, 663749140, 664797732, 665846324, 666894916, 667943508
.long 668992100, 670040692, 671089284, 672137876, 673186468, 674235060, 675283652, 676332244
.long 677380836, 678429428, 679478020, 680526612, 681575204, 682623796, 683672388, 684720980
.long 685769572, 686818164, 687866756, 688915348, 689963940, 691012532, 692061124, 693109716
.long 694158308, 695206900, 696255492, 697304084, 698352676, 699401268, 700449860, 701498452
.long 702547044, 703595636, 704644228, 705692852, 717227396, 706741444, 718275988, 707790036
.long 719324580, 708838628, 720373172, 709887220, 721421764, 710935812, 722470356, 711984404
.long 723518948, 713032996, 724567540, 714081588, 725616132, 715130180, 726664724, 716178772
.long 727713316, 734005508, 735054100, 736102692, 737151284, 738199876, 739248468, 740297060
.long 741345652, 742394244, 743442836, 744491428, 745540020, 746588612, 747637204, 748685796
.long 749734388, 750782980, 751831572, 752880164, 753928756, 754977348, 756025940, 757074532
.long 758123124, 759171716, 760220308, 761268900, 762317492, 763366084, 764414676, 765463268
.long 766511860, 767560452, 768609044, 769657636, 770706228, 771754820, 772803412, 773852004
.long 774900596, 775949188, 776997780, 778046372, 779094964, 780143556, 781192148, 782240740
.long 783289332, 784337924, 785386516, 786435108, 787483700, 788532292, 789580884, 790629476
.long 791678068, 792726660, 793775252, 794823844, 795872436, 796921028, 797969620, 799018212
.long 800066804, 801115396, 802163988, 803212580, 804261172, 805309764, 806358356, 807406948
.long 808455540, 809504132, 810552756, 822087300, 811601348, 823135892, 812649940, 824184484
.long 813698532, 825233076, 814747124, 826281668, 815795716, 827330260, 816844308, 828378852
.long 817892900, 829427444, 818941492, 830476036, 819990084, 831524628, 821038676, 832573220
.long 838862432, 854591344, 839911024, 855639936, 840959616, 856688528, 842008208, 857737120
.long 843056800, 858785712, 844105392, 859834304, 845153984, 860882896, 846202576, 861931488
.long 847251168, 862980080, 848299760, 864028672, 849348352, 865077264, 850396944, 866125856
.long 851445536, 867174448, 852494128, 868223040, 853542720, 869271632, 876611164, 892340076
.long 877659756, 893388668, 878708348, 894437260, 879756940, 895485852, 880805532, 896534444
.long 881854124, 897583036, 882902716, 898631628, 883951308, 899680220, 884999900, 900728812
.long 886048492, 901777404, 887097084, 902825996, 888145676, 903874588, 889194268, 904923180
.long 890242860, 905971772, 891291452, 907020364, 914359896, 930088808, 915408488, 931137400
.long 916457080, 932185992, 917505672, 933234584, 918554264, 934283176, 919602856, 935331768
.long 920651448, 936380360, 921700040, 937428952, 922748632, 938477544, 923797224, 939526136
.long 924845816, 940574728, 925894408, 941623320, 926943000, 942671912, 927991592, 943720504
.long 929040184, 944769096, 952108628, 967837540, 953157220, 968886132, 954205812, 969934724
.long 955254404, 970983316, 956302996, 972031908, 957351588, 973080500, 958400180, 974129092
.long 959448772, 975177684, 960497364, 976226276, 961545956, 977274868, 962594548, 978323460
.long 963643140, 979372052, 964691732, 980420644, 965740324, 981469236, 966788916, 982517828
.long 982517828, 982517828, 982517828, 982517828, 982517828, 982517828, 982517828, 982517828
.long 982517828, 982517828, 982517828, 982517828, 982517828, 982517828, 982517828, 982517828
.long 982517828, 982517828, 982517828, 982517828, 982517828, 982517828, 982517828, 982517828
.long 982517828, 982517828, 982517828, 982517828, 982517828, 982517828, 982517828, 982517828
.long 982517828, 982517828, 982517828, 982517828, 982517828, 982517828, 982517828, 982517828
.long 982517828, 982517828, 982517828, 982517828, 982517828, 982517828, 982517828, 982517828
.long 982517828, 982517828, 982517828, 982517828, 982517828, 982517828, 982517828, 982517828
.long 982517828, 982517828, 982517828, 982517828, 982517828, 982517828, 982517828, 982517828
.long 982517828, 982517828, 982517828, 982517828, 982517828, 982517828, 982517828, 982517828
.long 982517828, 982517828, 982517828, 982517828, 982517828, 982517828, 982517828, 982517828
.long 982517828, 982517828, 982517828, 982517828, 982517828, 982517828, 982517828, 982517828
.long 982517828, 982517828, 982517828, 982517828, 982517828, 982517828, 982517828, 982517828
.long 982517828, 982517828, 982517828, 982517828, 982517828, 982517828, 982517828, 982517828
.long 982517828, 982517828, 982517828, 982517828, 982517828, 982517828, 982517828, 982517828
.long 982517828, 982517828, 982517828, 982517828, 982517828, 982517828, 982517828, 982517828
.long 982517828, 982517828, 982517828, 982517828, 982517828, 982517828, 982517828, 982517828
.long 982517828, 982517828, 982517828, 982517828, 982517828, 982517828, 982517828, 982517828
.long 982517828, 982517828, 982517828, 982517828, 982517828, 982517828, 982517828, 982517828
.fill 32, 4, 0
L_code_end:
.section .rodata,"a"
.p2align 6
.amdhsa_kernel interleave_layers__sliding_local_dilated__ssm_conv_s4d__prompt_kernel
  .amdhsa_next_free_vgpr 256
  .amdhsa_next_free_sgpr 102
  .amdhsa_accum_offset 256
  .amdhsa_group_segment_fixed_size 0
  .amdhsa_kernarg_size 104
  .amdhsa_user_sgpr_count 2
  .amdhsa_user_sgpr_kernarg_segment_ptr 1
  .amdhsa_system_sgpr_workgroup_id_x 1
.end_amdhsa_kernel
```

```asm
; @launch grid=(256,1,1) block=(512,1,1) lds=163840
.amdgcn_target "amdgcn-amd-amdhsa--gfx950"
.text
.globl interleave_layers__sliding_local_dilated__ssm_conv_s4d__prompt_kernel
.p2align 8
.type interleave_layers__sliding_local_dilated__ssm_conv_s4d__prompt_kernel,@function
interleave_layers__sliding_local_dilated__ssm_conv_s4d__prompt_kernel:
    s_cmp_ge_u32 s2, 256
    s_cbranch_scc1 L_end
    s_load_dwordx16 s[8:23], s[0:1], 0
    s_load_dwordx8 s[24:31], s[0:1], 64
    s_load_dwordx2 s[32:33], s[0:1], 96
    v_lshrrev_b32 v2, 6, v0
    v_and_b32 v1, 63, v0
    v_readfirstlane_b32 s3, v2
    s_getpc_b64 s[50:51]
L_pcref:
    s_lshr_b32 s47, s2, 3
    s_cmp_eq_u32 s3, 7
    s_nop 0
    s_cbranch_scc0 L_nopf
    v_and_b32 v2, 31, v1
    v_lshl_add_u32 v2, v2, 5, s47
    v_lshlrev_b32 v2, 7, v2
    v_min_u32 v2, L_code_end-L_pcref-4, v2
    global_load_dword v250, v2, s[50:51]
L_nopf:
    s_and_b32 s42, s2, 7
    s_lshr_b32 s43, s2, 3
    s_and_b32 s6, s43, 3
    s_lshr_b32 s5, s42, 1
    s_lshl_b32 s5, s5, 3
    s_and_b32 s4, s43, 7
    s_add_u32 s5, s5, s4
    s_and_b32 s4, s42, 1
    s_lshl_b32 s4, s4, 2
    s_lshr_b32 s44, s43, 3
    s_add_u32 s4, s4, s44
    s_and_b32 s36, s43, 1
    s_lshr_b32 s43, s43, 1
    s_lshl_b32 s42, s42, 4
    s_add_u32 s42, s42, s43
    s_mul_i32 s42, s42, 5
    s_mul_i32 s43, s36, 3
    s_add_u32 s37, s42, s43
    s_add_u32 s38, s37, 1
    s_add_u32 s39, s42, 2
    s_mov_b32 s7, 0
    s_mov_b32 s40, 0
    s_mov_b32 s41, 0
    s_mul_i32 s42, s3, 11
    s_lshr_b32 s42, s42, 5
    s_mul_i32 s43, s42, 3
    s_sub_u32 s43, s3, s43
    s_cmp_eq_u32 s42, 1
    s_cselect_b32 s44, s38, s37
    s_cmp_eq_u32 s42, 2
    s_cselect_b32 s44, s39, s44
    v_mov_b32 v16, 0
    v_mov_b32 v17, 0
    v_mov_b32 v18, 0
    v_mov_b32 v19, 0
    s_mul_i32 s54, s44, 384
    s_lshl_b32 s55, s43, 7
    s_add_u32 s54, s54, s55
    v_lshl_add_u32 v2, v1, 1, s54
    s_lshl_b32 s55, s44, 1
    v_mov_b32 v3, s55
    s_cmp_ge_u32 s3, 3
    s_cbranch_scc1 L_st_x
    s_min_u32 s45, s2, 239
    s_mul_i32 s45, s45, 6
    s_lshl_b32 s46, s3, 1
    s_add_u32 s45, s45, s46
    v_and_b32 v4, 15, v1
    v_lshrrev_b32 v5, 4, v1
    v_mul_u32_u24 v5, 30720, v5
    v_mov_b32 v246, 0
    v_mov_b32 v247, 0
    v_mov_b32 v248, 0
    v_mov_b32 v249, 0
    s_add_u32 s49, s45, 0
    s_mul_i32 s46, s49, 46604
    s_lshr_b32 s46, s46, 23
    s_mul_i32 s47, s46, 180
    s_sub_u32 s47, s49, s47
    s_mul_i32 s48, s47, 57
    s_lshr_b32 s48, s48, 9
    s_mul_i32 s49, s48, 9
    s_sub_u32 s49, s47, s49
    s_mov_b32 s54, 2499870976
    s_mov_b32 s55, 1420116314
    s_mul_i32 s47, s49, 7
    s_lshr_b64 s[54:55], s[54:55], s47
    s_and_b32 s47, s54, 127
    s_lshl_b32 s47, s47, 5
    s_mul_i32 s54, s46, 160
    s_add_u32 s47, s47, s54
    s_mul_i32 s54, s48, 122880
    s_add_u32 s50, s47, s54
    s_lshr_b32 s52, 0x10c, s49
    s_and_b32 s52, s52, 1
    s_cselect_b32 s47, 1, 2
    s_cselect_b32 s54, 14, 15
    v_and_b32 v24, s54, v4
    v_lshlrev_b32 v24, s47, v24
    v_add_u32 v24, v24, v5
    v_add_u32 v25, 7680, v24
    v_add_u32 v26, 15360, v24
    v_add_u32 v27, 23040, v24
    s_mov_b32 s54, 3397678624
    s_mov_b32 s55, 14
    s_lshl_b32 s47, s49, 2
    s_lshr_b64 s[54:55], s[54:55], s47
    s_and_b32 s47, s54, 15
    s_mul_i32 s54, s46, 15
    s_add_u32 s47, s47, s54
    s_mul_i32 s47, s47, 20
    s_add_u32 s47, s47, s48
    s_lshl_b32 s47, s47, 10
    s_add_u32 s47, s47, 1048576
    v_lshl_add_u32 v10, v1, 4, s47
    v_add_u32 v11, 20480, v10
    v_and_b32 v14, s52, v1
    v_mul_u32_u24 v14, 0x020202, v14
    v_lshl_or_b32 v14, v14, 8, v14
    v_add_u32 v14, 0x05040100, v14
    s_add_u32 s49, s45, 1
    s_mul_i32 s46, s49, 46604
    s_lshr_b32 s46, s46, 23
    s_mul_i32 s47, s46, 180
    s_sub_u32 s47, s49, s47
    s_mul_i32 s48, s47, 57
    s_lshr_b32 s48, s48, 9
    s_mul_i32 s49, s48, 9
    s_sub_u32 s49, s47, s49
    s_mov_b32 s54, 2499870976
    s_mov_b32 s55, 1420116314
    s_mul_i32 s47, s49, 7
    s_lshr_b64 s[54:55], s[54:55], s47
    s_and_b32 s47, s54, 127
    s_lshl_b32 s47, s47, 5
    s_mul_i32 s54, s46, 160
    s_add_u32 s47, s47, s54
    s_mul_i32 s54, s48, 122880
    s_add_u32 s51, s47, s54
    s_lshr_b32 s53, 0x10c, s49
    s_and_b32 s53, s53, 1
    s_cselect_b32 s47, 1, 2
    s_cselect_b32 s54, 14, 15
    v_and_b32 v28, s54, v4
    v_lshlrev_b32 v28, s47, v28
    v_add_u32 v28, v28, v5
    v_add_u32 v29, 7680, v28
    v_add_u32 v30, 15360, v28
    v_add_u32 v31, 23040, v28
    s_mov_b32 s54, 3397678624
    s_mov_b32 s55, 14
    s_lshl_b32 s47, s49, 2
    s_lshr_b64 s[54:55], s[54:55], s47
    s_and_b32 s47, s54, 15
    s_mul_i32 s54, s46, 15
    s_add_u32 s47, s47, s54
    s_mul_i32 s47, s47, 20
    s_add_u32 s47, s47, s48
    s_lshl_b32 s47, s47, 10
    s_add_u32 s47, s47, 1048576
    v_lshl_add_u32 v12, v1, 4, s47
    v_add_u32 v13, 20480, v12
    v_and_b32 v15, s53, v1
    v_mul_u32_u24 v15, 0x020202, v15
    v_lshl_or_b32 v15, v15, 8, v15
    v_add_u32 v15, 0x05040100, v15
    v_add_u32 v32, 0, v1
    v_mul_u32_u24 v37, 205, v32
    v_lshrrev_b32 v37, 11, v37
    v_mul_u32_u24 v38, 10, v37
    v_sub_u32 v32, v32, v38
    v_and_b32 v38, 3, v37
    v_bfe_u32 v39, v37, 2, 2
    v_lshl_or_b32 v38, v39, 3, v38
    v_lshrrev_b32 v39, 4, v37
    v_lshl_or_b32 v38, v39, 2, v38
    v_mul_u32_u24 v38, 1280, v38
    v_lshl_add_u32 v32, v32, 4, v38
    v_add_u32 v33, 64, v1
    v_mul_u32_u24 v37, 205, v33
    v_lshrrev_b32 v37, 11, v37
    v_mul_u32_u24 v38, 10, v37
    v_sub_u32 v33, v33, v38
    v_and_b32 v38, 3, v37
    v_bfe_u32 v39, v37, 2, 2
    v_lshl_or_b32 v38, v39, 3, v38
    v_lshrrev_b32 v39, 4, v37
    v_lshl_or_b32 v38, v39, 2, v38
    v_mul_u32_u24 v38, 1280, v38
    v_lshl_add_u32 v33, v33, 4, v38
    v_add_u32 v34, 128, v1
    v_mul_u32_u24 v37, 205, v34
    v_lshrrev_b32 v37, 11, v37
    v_mul_u32_u24 v38, 10, v37
    v_sub_u32 v34, v34, v38
    v_and_b32 v38, 3, v37
    v_bfe_u32 v39, v37, 2, 2
    v_lshl_or_b32 v38, v39, 3, v38
    v_lshrrev_b32 v39, 4, v37
    v_lshl_or_b32 v38, v39, 2, v38
    v_mul_u32_u24 v38, 1280, v38
    v_lshl_add_u32 v34, v34, 4, v38
    v_add_u32 v35, 192, v1
    v_mul_u32_u24 v37, 205, v35
    v_lshrrev_b32 v37, 11, v37
    v_mul_u32_u24 v38, 10, v37
    v_sub_u32 v35, v35, v38
    v_and_b32 v38, 3, v37
    v_bfe_u32 v39, v37, 2, 2
    v_lshl_or_b32 v38, v39, 3, v38
    v_lshrrev_b32 v39, 4, v37
    v_lshl_or_b32 v38, v39, 2, v38
    v_mul_u32_u24 v38, 1280, v38
    v_lshl_add_u32 v35, v35, 4, v38
    v_add_u32 v36, 256, v1
    v_mul_u32_u24 v37, 205, v36
    v_lshrrev_b32 v37, 11, v37
    v_mul_u32_u24 v38, 10, v37
    v_sub_u32 v36, v36, v38
    v_and_b32 v38, 3, v37
    v_bfe_u32 v39, v37, 2, 2
    v_lshl_or_b32 v38, v39, 3, v38
    v_lshrrev_b32 v39, 4, v37
    v_lshl_or_b32 v38, v39, 2, v38
    v_mul_u32_u24 v38, 1280, v38
    v_lshl_add_u32 v36, v36, 4, v38
    s_mul_i32 s46, s2, 2185
    s_lshr_b32 s46, s46, 16
    s_mul_i32 s47, s46, 30
    s_sub_u32 s47, s2, s47
    s_cmp_lt_u32 s47, 20
    s_cselect_b32 s42, 1, 0
    s_cmp_lt_u32 s2, 240
    s_cselect_b32 s42, s42, 0
    s_cmp_eq_u32 s3, 1
    s_cselect_b32 s42, s42, 0
    s_mul_i32 s43, s47, 40960
    s_mul_i32 s48, s46, 160
    s_add_u32 s43, s43, s48
    s_mul_i32 s46, s46, 102400
    s_mul_i32 s47, s47, 5120
    s_add_u32 s46, s46, s47
    s_add_u32 s46, s46, 14681088
    v_lshl_add_u32 v37, v1, 4, s46
    s_lshl_b32 s46, s5, 9
    s_add_u32 s46, s46, 262144
    v_and_b32 v6, 31, v1
    v_lshl_add_u32 v6, v6, 4, s46
    v_lshrrev_b32 v7, 5, v1
    v_lshl_add_u32 v6, v7, 14, v6
    v_and_b32 v8, 3, v1
    v_lshlrev_b32 v8, 4, v8
    v_add_u32 v8, 45312, v8
    v_mov_b32 v9, 46976
    ds_write_b128 v8, v[16:19]
    ds_write_b128 v9, v[16:19]
    s_waitcnt lgkmcnt(0)
    s_cmp_ge_u32 s2, 240
    s_cbranch_scc1 L_st_nopack
    s_add_u32 s54, s10, s50
    s_addc_u32 s55, s11, 0
    global_load_dword v192, v24, s[54:55] offset:0
    global_load_dword v193, v24, s[54:55] offset:3840
    global_load_dword v194, v25, s[54:55] offset:0
    global_load_dword v195, v25, s[54:55] offset:3840
    global_load_dword v196, v26, s[54:55] offset:0
    global_load_dword v197, v26, s[54:55] offset:3840
    global_load_dword v198, v27, s[54:55] offset:0
    global_load_dword v199, v27, s[54:55] offset:3840
    s_add_u32 s54, s10, s51
    s_addc_u32 s55, s11, 0
    global_load_dword v208, v28, s[54:55] offset:0
    global_load_dword v209, v28, s[54:55] offset:3840
    global_load_dword v210, v29, s[54:55] offset:0
    global_load_dword v211, v29, s[54:55] offset:3840
    global_load_dword v212, v30, s[54:55] offset:0
    global_load_dword v213, v30, s[54:55] offset:3840
    global_load_dword v214, v31, s[54:55] offset:0
    global_load_dword v215, v31, s[54:55] offset:3840
    s_cmp_eq_u32 s42, 0
    s_cbranch_scc1 L_st_nopack
    s_add_u32 s54, s12, s43
    s_addc_u32 s55, s13, 0
    global_load_dwordx4 v[160:163], v32, s[54:55]
    global_load_dwordx4 v[164:167], v33, s[54:55]
    global_load_dwordx4 v[168:171], v34, s[54:55]
    global_load_dwordx4 v[172:175], v35, s[54:55]
    global_load_dwordx4 v[176:179], v36, s[54:55]
L_st_nopack:
    global_load_ushort v240, v2, s[16:17]
    global_load_ushort v244, v3, s[24:25]
    global_load_ushort v241, v2, s[18:19]
    global_load_ushort v242, v2, s[20:21]
    global_load_ushort v243, v2, s[22:23]
    global_load_dwordx2 v[20:21], v16, s[32:33] sc1
    s_cmp_eq_u32 s3, 2
    s_cbranch_scc0 L_st_b0
    s_cmp_eq_u32 s4, 0
    s_cbranch_scc0 L_st_nz
    global_store_dwordx4 v6, v[16:19], s[32:33] sc1
L_st_nz:
    s_cmp_eq_u32 s2, 255
    s_cbranch_scc0 L_st_b0
    v_and_b32 v6, 1, v1
    v_lshlrev_b32 v6, 4, v6
    v_add_u32 v6, 19922912, v6
    s_mov_b64 exec, 3
    global_store_dwordx4 v6, v[16:19], s[32:33] sc1
    s_mov_b64 exec, -1
L_st_b0:
    s_barrier
    s_waitcnt vmcnt(0)
    s_cmp_ge_u32 s2, 240
    s_cbranch_scc1 L_st_unit
    s_mov_b32 s50, 0x07060302
    v_perm_b32 v200, v193, v192, v14
    v_perm_b32 v201, v195, v194, v14
    v_perm_b32 v202, v197, v196, v14
    v_perm_b32 v203, v199, v198, v14
    global_store_dwordx4 v10, v[200:203], s[32:33] sc1
    v_perm_b32 v216, v209, v208, v15
    v_perm_b32 v217, v211, v210, v15
    v_perm_b32 v218, v213, v212, v15
    v_perm_b32 v219, v215, v214, v15
    global_store_dwordx4 v12, v[216:219], s[32:33] sc1
    s_cmp_eq_u32 s52, 1
    s_cbranch_scc1 L_st_sg0
    v_perm_b32 v204, v193, v192, s50
    v_perm_b32 v205, v195, v194, s50
    v_perm_b32 v206, v197, v196, s50
    v_perm_b32 v207, v199, v198, s50
    global_store_dwordx4 v11, v[204:207], s[32:33] sc1
L_st_sg0:
    s_cmp_eq_u32 s53, 1
    s_cbranch_scc1 L_st_sg1
    v_perm_b32 v220, v209, v208, s50
    v_perm_b32 v221, v211, v210, s50
    v_perm_b32 v222, v213, v212, s50
    v_perm_b32 v223, v215, v214, s50
    global_store_dwordx4 v13, v[220:223], s[32:33] sc1
L_st_sg1:
    s_cmp_eq_u32 s42, 0
    s_cbranch_scc1 L_st_unit
    global_store_dwordx4 v37, v[160:163], s[32:33] offset:-1024 sc1
    global_store_dwordx4 v37, v[164:167], s[32:33] offset:0 sc1
    global_store_dwordx4 v37, v[168:171], s[32:33] offset:1024 sc1
    global_store_dwordx4 v37, v[172:175], s[32:33] offset:2048 sc1
    global_store_dwordx4 v37, v[176:179], s[32:33] offset:3072 sc1
    s_nop 0
    s_branch L_st_unit
L_st_x:
    s_lshl_b32 s46, s3, 6
    v_add_u32 v6, s46, v1
    v_subrev_u32 v6, 192, v6
    v_mul_u32_u24 v7, 205, v6
    v_lshrrev_b32 v7, 14, v7
    v_mul_u32_u24 v8, 80, v7
    v_sub_u32 v8, v6, v8
    v_xor_b32 v8, v8, v7
    v_lshlrev_b32 v8, 4, v8
    v_mul_u32_u24 v7, 1280, v7
    v_add_u32 v7, v7, v8
    s_lshl_b32 s46, s6, 6
    v_xor_b32 v246, s46, v7
    v_xor_b32 v247, 64, v246
    v_xor_b32 v248, 128, v246
    v_xor_b32 v249, 192, v246
    s_waitcnt lgkmcnt(0)
    global_load_ushort v240, v2, s[16:17]
    global_load_ushort v244, v3, s[24:25]
    global_load_ushort v241, v2, s[18:19]
    global_load_ushort v242, v2, s[20:21]
    global_load_ushort v243, v2, s[22:23]
    global_load_dwordx2 v[20:21], v16, s[32:33] sc1
    s_barrier
    s_sub_u32 s48, s3, 3
    s_lshl_b32 s48, s48, 10
    s_mul_i32 s49, s5, 81920
    s_max_u32 s47, s49, 20480
    s_and_b32 s52, s4, 3
    s_cmp_eq_u32 s52, 1
    s_cbranch_scc1 L_xd1_1
    s_cmp_eq_u32 s52, 2
    s_cbranch_scc1 L_xd1_2
    s_cmp_eq_u32 s52, 3
    s_cbranch_scc1 L_xd1_3
    s_add_u32 m0, s48, 61440
    s_add_u32 s52, s47, -20480
    s_add_u32 s50, s8, s52
    s_addc_u32 s51, s9, 0
    global_load_lds_dwordx4 v246, s[50:51]
    s_add_u32 m0, s48, 66560
    s_add_u32 s50, s50, 5120
    s_addc_u32 s51, s51, 0
    global_load_lds_dwordx4 v247, s[50:51]
    s_add_u32 m0, s48, 71680
    s_add_u32 s50, s50, 5120
    s_addc_u32 s51, s51, 0
    global_load_lds_dwordx4 v248, s[50:51]
    s_add_u32 m0, s48, 76800
    s_add_u32 s50, s50, 5120
    s_addc_u32 s51, s51, 0
    global_load_lds_dwordx4 v249, s[50:51]
    s_add_u32 m0, s48, 81920
    s_add_u32 s52, s49, 0
    s_add_u32 s50, s8, s52
    s_addc_u32 s51, s9, 0
    global_load_lds_dwordx4 v246, s[50:51]
    s_branch L_xd1
L_xd1_1:
    s_add_u32 m0, s48, 87040
    s_add_u32 s52, s49, 5120
    s_add_u32 s50, s8, s52
    s_addc_u32 s51, s9, 0
    global_load_lds_dwordx4 v247, s[50:51]
    s_add_u32 m0, s48, 92160
    s_add_u32 s50, s50, 5120
    s_addc_u32 s51, s51, 0
    global_load_lds_dwordx4 v248, s[50:51]
    s_add_u32 m0, s48, 97280
    s_add_u32 s50, s50, 5120
    s_addc_u32 s51, s51, 0
    global_load_lds_dwordx4 v249, s[50:51]
    s_add_u32 m0, s48, 102400
    s_add_u32 s50, s50, 5120
    s_addc_u32 s51, s51, 0
    global_load_lds_dwordx4 v246, s[50:51]
    s_add_u32 m0, s48, 107520
    s_add_u32 s50, s50, 5120
    s_addc_u32 s51, s51, 0
    global_load_lds_dwordx4 v247, s[50:51]
    s_branch L_xd1
L_xd1_2:
    s_add_u32 m0, s48, 112640
    s_add_u32 s52, s49, 30720
    s_add_u32 s50, s8, s52
    s_addc_u32 s51, s9, 0
    global_load_lds_dwordx4 v248, s[50:51]
    s_add_u32 m0, s48, 117760
    s_add_u32 s50, s50, 5120
    s_addc_u32 s51, s51, 0
    global_load_lds_dwordx4 v249, s[50:51]
    s_add_u32 m0, s48, 122880
    s_add_u32 s50, s50, 5120
    s_addc_u32 s51, s51, 0
    global_load_lds_dwordx4 v246, s[50:51]
    s_add_u32 m0, s48, 128000
    s_add_u32 s50, s50, 5120
    s_addc_u32 s51, s51, 0
    global_load_lds_dwordx4 v247, s[50:51]
    s_add_u32 m0, s48, 133120
    s_add_u32 s50, s50, 5120
    s_addc_u32 s51, s51, 0
    global_load_lds_dwordx4 v248, s[50:51]
    s_branch L_xd1
L_xd1_3:
    s_add_u32 m0, s48, 138240
    s_add_u32 s52, s49, 56320
    s_add_u32 s50, s8, s52
    s_addc_u32 s51, s9, 0
    global_load_lds_dwordx4 v249, s[50:51]
    s_add_u32 m0, s48, 143360
    s_add_u32 s50, s50, 5120
    s_addc_u32 s51, s51, 0
    global_load_lds_dwordx4 v246, s[50:51]
    s_add_u32 m0, s48, 148480
    s_add_u32 s50, s50, 5120
    s_addc_u32 s51, s51, 0
    global_load_lds_dwordx4 v247, s[50:51]
    s_add_u32 m0, s48, 153600
    s_add_u32 s50, s50, 5120
    s_addc_u32 s51, s51, 0
    global_load_lds_dwordx4 v248, s[50:51]
    s_add_u32 m0, s48, 158720
    s_add_u32 s50, s50, 5120
    s_addc_u32 s51, s51, 0
    global_load_lds_dwordx4 v249, s[50:51]
L_xd1:
    s_waitcnt vmcnt(5)
L_st_unit:
    s_and_b32 s14, s2, 7
    s_lshl_b32 s14, s14, 5
    s_lshr_b32 s15, s2, 3
    s_add_u32 s14, s14, s15
    v_readfirstlane_b32 s34, v20
    v_readfirstlane_b32 s35, v21
    s_nop 0
    s_add_u32 s34, s34, 1
    s_addc_u32 s35, s35, 0
    s_mul_i32 s46, s3, 4608
    s_add_u32 s46, s46, 0
    v_lshlrev_b32 v52, 16, v240
    v_lshlrev_b32 v56, 16, v244
    v_mul_f32 v52, 1069066811, v52
    v_mul_f32 v56, 1069066811, v56
    v_exp_f32 v52, v52
    v_exp_f32 v56, v56
    v_lshlrev_b32 v53, 16, v241
    v_lshlrev_b32 v54, 16, v242
    v_lshlrev_b32 v55, 16, v243
    v_cvt_pk_bf16_f32 v52, v52, v56
    v_and_b32 v3, 15, v1
    v_mul_u32_u24 v3, 288, v3
    v_and_b32 v2, 0x30, v1
    v_add3_u32 v3, v3, v2, s46
    s_mov_b32 m0, s46
    v_and_b32 v56, 0xffff0000, v52
    v_lshlrev_b32 v52, 16, v52
    v_mul_f32 v52, v52, v56
    v_mul_f32 v53, v53, v56
    v_mul_f32 v84, v54, v56
    v_mul_f32 v85, v55, v56
    v_mul_f32 v52, 3216550459, v52
    v_mul_f32 v53, 1042479491, v53
    v_mul_f32 v84, 0x44000000, v84
    v_mul_f32 v85, 0x44000000, v85
    v_mul_f32 v54, 1065353216, v52
    v_mul_f32 v60, 1065353216, v53
    v_mul_f32 v55, 1090519040, v52
    v_mul_f32 v61, 1090519040, v53
    v_mul_f32 v56, 1124073472, v52
    v_mul_f32 v62, 1124073472, v53
    v_mul_f32 v57, 1132462080, v52
    v_mul_f32 v63, 1132462080, v53
    v_mul_f32 v58, 1140850688, v52
    v_mul_f32 v64, 1140850688, v53
    v_mul_f32 v59, 1149239296, v52
    v_mul_f32 v65, 1149239296, v53
    v_exp_f32 v54, v54
    v_fract_f32 v60, v60
    v_exp_f32 v55, v55
    v_fract_f32 v61, v61
    v_exp_f32 v56, v56
    v_fract_f32 v62, v62
    v_exp_f32 v57, v57
    v_fract_f32 v63, v63
    v_exp_f32 v58, v58
    v_fract_f32 v64, v64
    v_exp_f32 v59, v59
    v_fract_f32 v65, v65
    v_cos_f32 v4, v60
    v_sin_f32 v5, v60
    v_cos_f32 v6, v61
    v_sin_f32 v7, v61
    v_cos_f32 v8, v62
    v_sin_f32 v9, v62
    v_cos_f32 v10, v63
    v_sin_f32 v11, v63
    v_cos_f32 v12, v64
    v_sin_f32 v13, v64
    v_cos_f32 v14, v65
    v_sin_f32 v15, v65
    v_mul_f32 v4, v4, v54
    v_mul_f32 v5, v5, v54
    v_mul_f32 v6, v6, v55
    v_mul_f32 v7, v7, v55
    v_mul_f32 v8, v8, v56
    v_mul_f32 v9, v9, v56
    v_mul_f32 v10, v10, v57
    v_mul_f32 v11, v11, v57
    v_mul_f32 v12, v12, v58
    v_mul_f32 v13, v13, v58
    v_mul_f32 v14, v14, v59
    v_mul_f32 v15, v15, v59
    s_cmp_lt_u32 s3, 3
    s_cbranch_scc1 L_xs2
    s_sub_u32 s48, s3, 3
    s_lshl_b32 s48, s48, 10
    s_mul_i32 s49, s5, 81920
    s_max_u32 s47, s49, 20480
    s_and_b32 s52, s4, 3
    s_cmp_eq_u32 s52, 1
    s_cbranch_scc1 L_xd3_1
    s_cmp_eq_u32 s52, 2
    s_cbranch_scc1 L_xd3_2
    s_cmp_eq_u32 s52, 3
    s_cbranch_scc1 L_xd3_3
    s_add_u32 m0, s48, 87040
    s_add_u32 s52, s49, 5120
    s_add_u32 s50, s8, s52
    s_addc_u32 s51, s9, 0
    global_load_lds_dwordx4 v247, s[50:51]
    s_add_u32 m0, s48, 92160
    s_add_u32 s50, s50, 5120
    s_addc_u32 s51, s51, 0
    global_load_lds_dwordx4 v248, s[50:51]
    s_add_u32 m0, s48, 97280
    s_add_u32 s50, s50, 5120
    s_addc_u32 s51, s51, 0
    global_load_lds_dwordx4 v249, s[50:51]
    s_add_u32 m0, s48, 102400
    s_add_u32 s50, s50, 5120
    s_addc_u32 s51, s51, 0
    global_load_lds_dwordx4 v246, s[50:51]
    s_add_u32 m0, s48, 107520
    s_add_u32 s50, s50, 5120
    s_addc_u32 s51, s51, 0
    global_load_lds_dwordx4 v247, s[50:51]
    s_add_u32 m0, s48, 112640
    s_add_u32 s50, s50, 5120
    s_addc_u32 s51, s51, 0
    global_load_lds_dwordx4 v248, s[50:51]
    s_add_u32 m0, s48, 117760
    s_add_u32 s50, s50, 5120
    s_addc_u32 s51, s51, 0
    global_load_lds_dwordx4 v249, s[50:51]
    s_branch L_xd3
L_xd3_1:
    s_add_u32 m0, s48, 112640
    s_add_u32 s52, s49, 30720
    s_add_u32 s50, s8, s52
    s_addc_u32 s51, s9, 0
    global_load_lds_dwordx4 v248, s[50:51]
    s_add_u32 m0, s48, 117760
    s_add_u32 s50, s50, 5120
    s_addc_u32 s51, s51, 0
    global_load_lds_dwordx4 v249, s[50:51]
    s_add_u32 m0, s48, 122880
    s_add_u32 s50, s50, 5120
    s_addc_u32 s51, s51, 0
    global_load_lds_dwordx4 v246, s[50:51]
    s_add_u32 m0, s48, 128000
    s_add_u32 s50, s50, 5120
    s_addc_u32 s51, s51, 0
    global_load_lds_dwordx4 v247, s[50:51]
    s_add_u32 m0, s48, 133120
    s_add_u32 s50, s50, 5120
    s_addc_u32 s51, s51, 0
    global_load_lds_dwordx4 v248, s[50:51]
    s_add_u32 m0, s48, 138240
    s_add_u32 s50, s50, 5120
    s_addc_u32 s51, s51, 0
    global_load_lds_dwordx4 v249, s[50:51]
    s_add_u32 m0, s48, 143360
    s_add_u32 s50, s50, 5120
    s_addc_u32 s51, s51, 0
    global_load_lds_dwordx4 v246, s[50:51]
    s_branch L_xd3
L_xd3_2:
    s_add_u32 m0, s48, 138240
    s_add_u32 s52, s49, 56320
    s_add_u32 s50, s8, s52
    s_addc_u32 s51, s9, 0
    global_load_lds_dwordx4 v249, s[50:51]
    s_add_u32 m0, s48, 143360
    s_add_u32 s50, s50, 5120
    s_addc_u32 s51, s51, 0
    global_load_lds_dwordx4 v246, s[50:51]
    s_add_u32 m0, s48, 148480
    s_add_u32 s50, s50, 5120
    s_addc_u32 s51, s51, 0
    global_load_lds_dwordx4 v247, s[50:51]
    s_add_u32 m0, s48, 153600
    s_add_u32 s50, s50, 5120
    s_addc_u32 s51, s51, 0
    global_load_lds_dwordx4 v248, s[50:51]
    s_add_u32 m0, s48, 158720
    s_add_u32 s50, s50, 5120
    s_addc_u32 s51, s51, 0
    global_load_lds_dwordx4 v249, s[50:51]
    s_add_u32 m0, s48, 61440
    s_add_u32 s52, s47, -20480
    s_add_u32 s50, s8, s52
    s_addc_u32 s51, s9, 0
    global_load_lds_dwordx4 v246, s[50:51]
    s_add_u32 m0, s48, 66560
    s_add_u32 s50, s50, 5120
    s_addc_u32 s51, s51, 0
    global_load_lds_dwordx4 v247, s[50:51]
    s_branch L_xd3
L_xd3_3:
    s_add_u32 m0, s48, 61440
    s_add_u32 s52, s47, -20480
    s_add_u32 s50, s8, s52
    s_addc_u32 s51, s9, 0
    global_load_lds_dwordx4 v246, s[50:51]
    s_add_u32 m0, s48, 66560
    s_add_u32 s50, s50, 5120
    s_addc_u32 s51, s51, 0
    global_load_lds_dwordx4 v247, s[50:51]
    s_add_u32 m0, s48, 71680
    s_add_u32 s50, s50, 5120
    s_addc_u32 s51, s51, 0
    global_load_lds_dwordx4 v248, s[50:51]
    s_add_u32 m0, s48, 76800
    s_add_u32 s50, s50, 5120
    s_addc_u32 s51, s51, 0
    global_load_lds_dwordx4 v249, s[50:51]
    s_add_u32 m0, s48, 81920
    s_add_u32 s52, s49, 0
    s_add_u32 s50, s8, s52
    s_addc_u32 s51, s9, 0
    global_load_lds_dwordx4 v246, s[50:51]
    s_add_u32 m0, s48, 87040
    s_add_u32 s50, s50, 5120
    s_addc_u32 s51, s51, 0
    global_load_lds_dwordx4 v247, s[50:51]
    s_add_u32 m0, s48, 92160
    s_add_u32 s50, s50, 5120
    s_addc_u32 s51, s51, 0
    global_load_lds_dwordx4 v248, s[50:51]
L_xd3:
L_xs2:
    s_mov_b32 m0, s46
    v_mov_b32 v16, 1.0
    v_mov_b32 v17, 0
    v_mov_b32 v18, v6
    v_mov_b32 v19, v7
    v_pk_mul_f32 v[20:21], v[6:7], v[6:7] op_sel:[0,0] op_sel_hi:[1,0]
    v_pk_mul_f32 v[48:49], v[4:5], v[4:5] op_sel:[0,0] op_sel_hi:[1,0]
    v_pk_fma_f32 v[20:21], v[6:7], v[6:7], v[20:21] op_sel:[1,1,0] op_sel_hi:[0,1,1] neg_lo:[1,0,0]
    v_pk_fma_f32 v[48:49], v[4:5], v[4:5], v[48:49] op_sel:[1,1,0] op_sel_hi:[0,1,1] neg_lo:[1,0,0]
    v_pk_mul_f32 v[22:23], v[20:21], v[6:7] op_sel:[0,0] op_sel_hi:[1,0]
    v_pk_mul_f32 v[24:25], v[20:21], v[20:21] op_sel:[0,0] op_sel_hi:[1,0]
    v_pk_mul_f32 v[50:51], v[48:49], v[48:49] op_sel:[0,0] op_sel_hi:[1,0]
    v_pk_fma_f32 v[22:23], v[20:21], v[6:7], v[22:23] op_sel:[1,1,0] op_sel_hi:[0,1,1] neg_lo:[1,0,0]
    v_pk_fma_f32 v[24:25], v[20:21], v[20:21], v[24:25] op_sel:[1,1,0] op_sel_hi:[0,1,1] neg_lo:[1,0,0]
    v_pk_fma_f32 v[50:51], v[48:49], v[48:49], v[50:51] op_sel:[1,1,0] op_sel_hi:[0,1,1] neg_lo:[1,0,0]
    v_pk_mul_f32 v[26:27], v[18:19], v[24:25] op_sel:[0,0] op_sel_hi:[1,0]
    v_pk_mul_f32 v[28:29], v[20:21], v[24:25] op_sel:[0,0] op_sel_hi:[1,0]
    v_pk_mul_f32 v[30:31], v[22:23], v[24:25] op_sel:[0,0] op_sel_hi:[1,0]
    v_pk_mul_f32 v[32:33], v[24:25], v[24:25] op_sel:[0,0] op_sel_hi:[1,0]
    v_pk_fma_f32 v[26:27], v[18:19], v[24:25], v[26:27] op_sel:[1,1,0] op_sel_hi:[0,1,1] neg_lo:[1,0,0]
    v_pk_fma_f32 v[28:29], v[20:21], v[24:25], v[28:29] op_sel:[1,1,0] op_sel_hi:[0,1,1] neg_lo:[1,0,0]
    v_pk_fma_f32 v[30:31], v[22:23], v[24:25], v[30:31] op_sel:[1,1,0] op_sel_hi:[0,1,1] neg_lo:[1,0,0]
    v_pk_fma_f32 v[32:33], v[24:25], v[24:25], v[32:33] op_sel:[1,1,0] op_sel_hi:[0,1,1] neg_lo:[1,0,0]
    v_pk_mul_f32 v[34:35], v[26:27], v[24:25] op_sel:[0,0] op_sel_hi:[1,0]
    v_pk_mul_f32 v[36:37], v[28:29], v[24:25] op_sel:[0,0] op_sel_hi:[1,0]
    v_pk_mul_f32 v[38:39], v[30:31], v[24:25] op_sel:[0,0] op_sel_hi:[1,0]
    v_pk_mul_f32 v[40:41], v[32:33], v[24:25] op_sel:[0,0] op_sel_hi:[1,0]
    v_pk_fma_f32 v[34:35], v[26:27], v[24:25], v[34:35] op_sel:[1,1,0] op_sel_hi:[0,1,1] neg_lo:[1,0,0]
    v_pk_fma_f32 v[36:37], v[28:29], v[24:25], v[36:37] op_sel:[1,1,0] op_sel_hi:[0,1,1] neg_lo:[1,0,0]
    v_pk_fma_f32 v[38:39], v[30:31], v[24:25], v[38:39] op_sel:[1,1,0] op_sel_hi:[0,1,1] neg_lo:[1,0,0]
    v_pk_fma_f32 v[40:41], v[32:33], v[24:25], v[40:41] op_sel:[1,1,0] op_sel_hi:[0,1,1] neg_lo:[1,0,0]
    v_pk_mul_f32 v[42:43], v[34:35], v[24:25] op_sel:[0,0] op_sel_hi:[1,0]
    v_pk_mul_f32 v[44:45], v[36:37], v[24:25] op_sel:[0,0] op_sel_hi:[1,0]
    v_pk_mul_f32 v[46:47], v[38:39], v[24:25] op_sel:[0,0] op_sel_hi:[1,0]
    v_pk_fma_f32 v[42:43], v[34:35], v[24:25], v[42:43] op_sel:[1,1,0] op_sel_hi:[0,1,1] neg_lo:[1,0,0]
    v_pk_fma_f32 v[44:45], v[36:37], v[24:25], v[44:45] op_sel:[1,1,0] op_sel_hi:[0,1,1] neg_lo:[1,0,0]
    v_pk_fma_f32 v[46:47], v[38:39], v[24:25], v[46:47] op_sel:[1,1,0] op_sel_hi:[0,1,1] neg_lo:[1,0,0]
    v_cvt_pk_f16_f32 v52, v16, -v17
    v_cvt_pk_f16_f32 v53, v18, -v19
    v_cvt_pk_f16_f32 v54, v20, -v21
    v_cvt_pk_f16_f32 v55, v22, -v23
    v_cvt_pk_f16_f32 v56, v24, -v25
    v_cvt_pk_f16_f32 v57, v26, -v27
    v_cvt_pk_f16_f32 v58, v28, -v29
    v_cvt_pk_f16_f32 v59, v30, -v31
    v_cvt_pk_f16_f32 v60, v32, -v33
    v_cvt_pk_f16_f32 v61, v34, -v35
    v_cvt_pk_f16_f32 v62, v36, -v37
    v_cvt_pk_f16_f32 v63, v38, -v39
    v_cvt_pk_f16_f32 v64, v40, -v41
    v_cvt_pk_f16_f32 v65, v42, -v43
    v_cvt_pk_f16_f32 v66, v44, -v45
    v_cvt_pk_f16_f32 v67, v46, -v47
    ds_write_addtid_b32 v52 offset:0
    ds_write_addtid_b32 v53 offset:288
    ds_write_addtid_b32 v54 offset:576
    ds_write_addtid_b32 v55 offset:864
    ds_write_addtid_b32 v56 offset:1152
    ds_write_addtid_b32 v57 offset:1440
    ds_write_addtid_b32 v58 offset:1728
    ds_write_addtid_b32 v59 offset:2016
    ds_write_addtid_b32 v60 offset:2304
    ds_write_addtid_b32 v61 offset:2592
    ds_write_addtid_b32 v62 offset:2880
    ds_write_addtid_b32 v63 offset:3168
    ds_write_addtid_b32 v64 offset:3456
    ds_write_addtid_b32 v65 offset:3744
    ds_write_addtid_b32 v66 offset:4032
    ds_write_addtid_b32 v67 offset:4320
    v_mov_b32 v16, v84
    v_mov_b32 v17, v85
    v_pk_mul_f32 v[18:19], v[16:17], v[4:5] op_sel:[0,0] op_sel_hi:[1,0]
    v_pk_mul_f32 v[20:21], v[16:17], v[48:49] op_sel:[0,0] op_sel_hi:[1,0]
    v_pk_mul_f32 v[24:25], v[16:17], v[50:51] op_sel:[0,0] op_sel_hi:[1,0]
    v_pk_mul_f32 v[32:33], v[16:17], v[8:9] op_sel:[0,0] op_sel_hi:[1,0]
    v_pk_fma_f32 v[18:19], v[16:17], v[4:5], v[18:19] op_sel:[1,1,0] op_sel_hi:[0,1,1] neg_lo:[1,0,0]
    v_pk_fma_f32 v[20:21], v[16:17], v[48:49], v[20:21] op_sel:[1,1,0] op_sel_hi:[0,1,1] neg_lo:[1,0,0]
    v_pk_fma_f32 v[24:25], v[16:17], v[50:51], v[24:25] op_sel:[1,1,0] op_sel_hi:[0,1,1] neg_lo:[1,0,0]
    v_pk_fma_f32 v[32:33], v[16:17], v[8:9], v[32:33] op_sel:[1,1,0] op_sel_hi:[0,1,1] neg_lo:[1,0,0]
    s_waitcnt lgkmcnt(0)
    ds_read_b128 v[68:71], v3 offset:0
    ds_read_b128 v[72:75], v3 offset:64
    ds_read_b128 v[76:79], v3 offset:128
    ds_read_b128 v[80:83], v3 offset:192
    v_pk_mul_f32 v[22:23], v[18:19], v[48:49] op_sel:[0,0] op_sel_hi:[1,0]
    v_pk_mul_f32 v[26:27], v[18:19], v[50:51] op_sel:[0,0] op_sel_hi:[1,0]
    v_pk_mul_f32 v[28:29], v[20:21], v[50:51] op_sel:[0,0] op_sel_hi:[1,0]
    v_pk_mul_f32 v[34:35], v[18:19], v[8:9] op_sel:[0,0] op_sel_hi:[1,0]
    v_pk_mul_f32 v[36:37], v[20:21], v[8:9] op_sel:[0,0] op_sel_hi:[1,0]
    v_pk_mul_f32 v[40:41], v[24:25], v[8:9] op_sel:[0,0] op_sel_hi:[1,0]
    v_pk_fma_f32 v[22:23], v[18:19], v[48:49], v[22:23] op_sel:[1,1,0] op_sel_hi:[0,1,1] neg_lo:[1,0,0]
    v_pk_fma_f32 v[26:27], v[18:19], v[50:51], v[26:27] op_sel:[1,1,0] op_sel_hi:[0,1,1] neg_lo:[1,0,0]
    v_pk_fma_f32 v[28:29], v[20:21], v[50:51], v[28:29] op_sel:[1,1,0] op_sel_hi:[0,1,1] neg_lo:[1,0,0]
    v_pk_fma_f32 v[34:35], v[18:19], v[8:9], v[34:35] op_sel:[1,1,0] op_sel_hi:[0,1,1] neg_lo:[1,0,0]
    v_pk_fma_f32 v[36:37], v[20:21], v[8:9], v[36:37] op_sel:[1,1,0] op_sel_hi:[0,1,1] neg_lo:[1,0,0]
    v_pk_fma_f32 v[40:41], v[24:25], v[8:9], v[40:41] op_sel:[1,1,0] op_sel_hi:[0,1,1] neg_lo:[1,0,0]
    v_pk_mul_f32 v[30:31], v[22:23], v[50:51] op_sel:[0,0] op_sel_hi:[1,0]
    v_pk_mul_f32 v[38:39], v[22:23], v[8:9] op_sel:[0,0] op_sel_hi:[1,0]
    v_pk_mul_f32 v[42:43], v[26:27], v[8:9] op_sel:[0,0] op_sel_hi:[1,0]
    v_pk_mul_f32 v[44:45], v[28:29], v[8:9] op_sel:[0,0] op_sel_hi:[1,0]
    v_pk_fma_f32 v[30:31], v[22:23], v[50:51], v[30:31] op_sel:[1,1,0] op_sel_hi:[0,1,1] neg_lo:[1,0,0]
    v_pk_fma_f32 v[38:39], v[22:23], v[8:9], v[38:39] op_sel:[1,1,0] op_sel_hi:[0,1,1] neg_lo:[1,0,0]
    v_pk_fma_f32 v[42:43], v[26:27], v[8:9], v[42:43] op_sel:[1,1,0] op_sel_hi:[0,1,1] neg_lo:[1,0,0]
    v_pk_fma_f32 v[44:45], v[28:29], v[8:9], v[44:45] op_sel:[1,1,0] op_sel_hi:[0,1,1] neg_lo:[1,0,0]
    v_pk_mul_f32 v[46:47], v[30:31], v[8:9] op_sel:[0,0] op_sel_hi:[1,0]
    v_pk_fma_f32 v[46:47], v[30:31], v[8:9], v[46:47] op_sel:[1,1,0] op_sel_hi:[0,1,1] neg_lo:[1,0,0]
    s_cmp_ge_u32 s3, 3
    s_cbranch_scc1 L_st_mid
    s_waitcnt vmcnt(0)
    v_mov_b32 v192, 45312
    v_mov_b32 v194, 1
    s_mov_b64 exec, 1
    ds_add_rtn_u32 v194, v192, v194
    s_waitcnt lgkmcnt(0)
    s_mov_b64 exec, -1
    v_readfirstlane_b32 s56, v194
    s_nop 1
    s_cmp_eq_u32 s56, 2
    s_nop 0
    s_cbranch_scc0 L_st_mid
    s_lshl_b32 s50, s2, 7
    s_add_u32 s50, s50, 4096
    v_lshl_add_u32 v192, v1, 4, s50
    v_mov_b32 v196, s34
    v_mov_b32 v197, s35
    v_mov_b32 v198, s34
    v_mov_b32 v199, s35
    s_mov_b64 exec, 0xff
    global_store_dwordx4 v192, v[196:199], s[32:33] sc1
    s_mov_b64 exec, -1
L_st_mid:
    s_mov_b32 m0, s46
    s_waitcnt lgkmcnt(0)
    v_cvt_pk_f16_f32 v52, v16, v17
    v_cvt_pk_f16_f32 v53, v18, v19
    v_cvt_pk_f16_f32 v54, v20, v21
    v_cvt_pk_f16_f32 v55, v22, v23
    v_cvt_pk_f16_f32 v56, v24, v25
    v_cvt_pk_f16_f32 v57, v26, v27
    v_cvt_pk_f16_f32 v58, v28, v29
    v_cvt_pk_f16_f32 v59, v30, v31
    v_cvt_pk_f16_f32 v60, v32, v33
    v_cvt_pk_f16_f32 v61, v34, v35
    v_cvt_pk_f16_f32 v62, v36, v37
    v_cvt_pk_f16_f32 v63, v38, v39
    v_cvt_pk_f16_f32 v64, v40, v41
    v_cvt_pk_f16_f32 v65, v42, v43
    v_cvt_pk_f16_f32 v66, v44, v45
    v_cvt_pk_f16_f32 v67, v46, v47
    ds_write_addtid_b32 v52 offset:0
    ds_write_addtid_b32 v53 offset:288
    ds_write_addtid_b32 v54 offset:576
    ds_write_addtid_b32 v55 offset:864
    ds_write_addtid_b32 v56 offset:1152
    ds_write_addtid_b32 v57 offset:1440
    ds_write_addtid_b32 v58 offset:1728
    ds_write_addtid_b32 v59 offset:2016
    ds_write_addtid_b32 v60 offset:2304
    ds_write_addtid_b32 v61 offset:2592
    ds_write_addtid_b32 v62 offset:2880
    ds_write_addtid_b32 v63 offset:3168
    ds_write_addtid_b32 v64 offset:3456
    ds_write_addtid_b32 v65 offset:3744
    ds_write_addtid_b32 v66 offset:4032
    ds_write_addtid_b32 v67 offset:4320
    v_pk_mul_f32 v[18:19], v[16:17], v[10:11] op_sel:[0,0] op_sel_hi:[1,0]
    v_pk_mul_f32 v[22:23], v[20:21], v[10:11] op_sel:[0,0] op_sel_hi:[1,0]
    v_pk_mul_f32 v[26:27], v[24:25], v[10:11] op_sel:[0,0] op_sel_hi:[1,0]
    v_pk_mul_f32 v[30:31], v[28:29], v[10:11] op_sel:[0,0] op_sel_hi:[1,0]
    v_pk_mul_f32 v[34:35], v[32:33], v[10:11] op_sel:[0,0] op_sel_hi:[1,0]
    v_pk_mul_f32 v[38:39], v[36:37], v[10:11] op_sel:[0,0] op_sel_hi:[1,0]
    v_pk_mul_f32 v[42:43], v[40:41], v[10:11] op_sel:[0,0] op_sel_hi:[1,0]
    v_pk_mul_f32 v[46:47], v[44:45], v[10:11] op_sel:[0,0] op_sel_hi:[1,0]
    v_pk_fma_f32 v[18:19], v[16:17], v[10:11], v[18:19] op_sel:[1,1,0] op_sel_hi:[0,1,1] neg_lo:[1,0,0]
    v_pk_fma_f32 v[22:23], v[20:21], v[10:11], v[22:23] op_sel:[1,1,0] op_sel_hi:[0,1,1] neg_lo:[1,0,0]
    v_pk_fma_f32 v[26:27], v[24:25], v[10:11], v[26:27] op_sel:[1,1,0] op_sel_hi:[0,1,1] neg_lo:[1,0,0]
    v_pk_fma_f32 v[30:31], v[28:29], v[10:11], v[30:31] op_sel:[1,1,0] op_sel_hi:[0,1,1] neg_lo:[1,0,0]
    v_pk_fma_f32 v[34:35], v[32:33], v[10:11], v[34:35] op_sel:[1,1,0] op_sel_hi:[0,1,1] neg_lo:[1,0,0]
    v_pk_fma_f32 v[38:39], v[36:37], v[10:11], v[38:39] op_sel:[1,1,0] op_sel_hi:[0,1,1] neg_lo:[1,0,0]
    v_pk_fma_f32 v[42:43], v[40:41], v[10:11], v[42:43] op_sel:[1,1,0] op_sel_hi:[0,1,1] neg_lo:[1,0,0]
    v_pk_fma_f32 v[46:47], v[44:45], v[10:11], v[46:47] op_sel:[1,1,0] op_sel_hi:[0,1,1] neg_lo:[1,0,0]
    s_waitcnt lgkmcnt(0)
    ds_read_b128 v[52:55], v3 offset:0
    ds_read_b128 v[56:59], v3 offset:64
    ds_read_b128 v[60:63], v3 offset:128
    ds_read_b128 v[64:67], v3 offset:192
    v_pk_mul_f32 v[20:21], v[16:17], v[12:13] op_sel:[0,0] op_sel_hi:[1,0]
    v_pk_mul_f32 v[28:29], v[24:25], v[12:13] op_sel:[0,0] op_sel_hi:[1,0]
    v_pk_mul_f32 v[36:37], v[32:33], v[12:13] op_sel:[0,0] op_sel_hi:[1,0]
    v_pk_mul_f32 v[44:45], v[40:41], v[12:13] op_sel:[0,0] op_sel_hi:[1,0]
    v_pk_fma_f32 v[20:21], v[16:17], v[12:13], v[20:21] op_sel:[1,1,0] op_sel_hi:[0,1,1] neg_lo:[1,0,0]
    v_pk_fma_f32 v[28:29], v[24:25], v[12:13], v[28:29] op_sel:[1,1,0] op_sel_hi:[0,1,1] neg_lo:[1,0,0]
    v_pk_fma_f32 v[36:37], v[32:33], v[12:13], v[36:37] op_sel:[1,1,0] op_sel_hi:[0,1,1] neg_lo:[1,0,0]
    v_pk_fma_f32 v[44:45], v[40:41], v[12:13], v[44:45] op_sel:[1,1,0] op_sel_hi:[0,1,1] neg_lo:[1,0,0]
    v_pk_mul_f32 v[24:25], v[20:21], v[10:11] op_sel:[0,0] op_sel_hi:[1,0]
    v_pk_mul_f32 v[40:41], v[28:29], v[10:11] op_sel:[0,0] op_sel_hi:[1,0]
    v_pk_mul_f32 v[48:49], v[36:37], v[10:11] op_sel:[0,0] op_sel_hi:[1,0]
    v_pk_mul_f32 v[50:51], v[44:45], v[10:11] op_sel:[0,0] op_sel_hi:[1,0]
    v_pk_fma_f32 v[24:25], v[20:21], v[10:11], v[24:25] op_sel:[1,1,0] op_sel_hi:[0,1,1] neg_lo:[1,0,0]
    v_pk_fma_f32 v[40:41], v[28:29], v[10:11], v[40:41] op_sel:[1,1,0] op_sel_hi:[0,1,1] neg_lo:[1,0,0]
    v_pk_fma_f32 v[48:49], v[36:37], v[10:11], v[48:49] op_sel:[1,1,0] op_sel_hi:[0,1,1] neg_lo:[1,0,0]
    v_pk_fma_f32 v[50:51], v[44:45], v[10:11], v[50:51] op_sel:[1,1,0] op_sel_hi:[0,1,1] neg_lo:[1,0,0]
    s_cmp_lt_u32 s3, 3
    s_cbranch_scc1 L_xs4
    s_sub_u32 s48, s3, 3
    s_lshl_b32 s48, s48, 10
    s_mul_i32 s49, s5, 81920
    s_max_u32 s47, s49, 20480
    s_and_b32 s52, s4, 3
    s_cmp_eq_u32 s52, 1
    s_cbranch_scc1 L_xd5_1
    s_cmp_eq_u32 s52, 2
    s_cbranch_scc1 L_xd5_2
    s_cmp_eq_u32 s52, 3
    s_cbranch_scc1 L_xd5_3
    s_add_u32 m0, s48, 122880
    s_add_u32 s52, s49, 40960
    s_add_u32 s50, s8, s52
    s_addc_u32 s51, s9, 0
    global_load_lds_dwordx4 v246, s[50:51]
    s_add_u32 m0, s48, 128000
    s_add_u32 s50, s50, 5120
    s_addc_u32 s51, s51, 0
    global_load_lds_dwordx4 v247, s[50:51]
    s_add_u32 m0, s48, 133120
    s_add_u32 s50, s50, 5120
    s_addc_u32 s51, s51, 0
    global_load_lds_dwordx4 v248, s[50:51]
    s_add_u32 m0, s48, 138240
    s_add_u32 s50, s50, 5120
    s_addc_u32 s51, s51, 0
    global_load_lds_dwordx4 v249, s[50:51]
    s_add_u32 m0, s48, 143360
    s_add_u32 s50, s50, 5120
    s_addc_u32 s51, s51, 0
    global_load_lds_dwordx4 v246, s[50:51]
    s_add_u32 m0, s48, 148480
    s_add_u32 s50, s50, 5120
    s_addc_u32 s51, s51, 0
    global_load_lds_dwordx4 v247, s[50:51]
    s_add_u32 m0, s48, 153600
    s_add_u32 s50, s50, 5120
    s_addc_u32 s51, s51, 0
    global_load_lds_dwordx4 v248, s[50:51]
    s_add_u32 m0, s48, 158720
    s_add_u32 s50, s50, 5120
    s_addc_u32 s51, s51, 0
    global_load_lds_dwordx4 v249, s[50:51]
    s_branch L_xd5
L_xd5_1:
    s_add_u32 m0, s48, 148480
    s_add_u32 s52, s49, 66560
    s_add_u32 s50, s8, s52
    s_addc_u32 s51, s9, 0
    global_load_lds_dwordx4 v247, s[50:51]
    s_add_u32 m0, s48, 153600
    s_add_u32 s50, s50, 5120
    s_addc_u32 s51, s51, 0
    global_load_lds_dwordx4 v248, s[50:51]
    s_add_u32 m0, s48, 158720
    s_add_u32 s50, s50, 5120
    s_addc_u32 s51, s51, 0
    global_load_lds_dwordx4 v249, s[50:51]
    s_add_u32 m0, s48, 61440
    s_add_u32 s52, s47, -20480
    s_add_u32 s50, s8, s52
    s_addc_u32 s51, s9, 0
    global_load_lds_dwordx4 v246, s[50:51]
    s_add_u32 m0, s48, 66560
    s_add_u32 s50, s50, 5120
    s_addc_u32 s51, s51, 0
    global_load_lds_dwordx4 v247, s[50:51]
    s_add_u32 m0, s48, 71680
    s_add_u32 s50, s50, 5120
    s_addc_u32 s51, s51, 0
    global_load_lds_dwordx4 v248, s[50:51]
    s_add_u32 m0, s48, 76800
    s_add_u32 s50, s50, 5120
    s_addc_u32 s51, s51, 0
    global_load_lds_dwordx4 v249, s[50:51]
    s_add_u32 m0, s48, 81920
    s_add_u32 s52, s49, 0
    s_add_u32 s50, s8, s52
    s_addc_u32 s51, s9, 0
    global_load_lds_dwordx4 v246, s[50:51]
    s_branch L_xd5
L_xd5_2:
    s_add_u32 m0, s48, 71680
    s_add_u32 s52, s47, -10240
    s_add_u32 s50, s8, s52
    s_addc_u32 s51, s9, 0
    global_load_lds_dwordx4 v248, s[50:51]
    s_add_u32 m0, s48, 76800
    s_add_u32 s50, s50, 5120
    s_addc_u32 s51, s51, 0
    global_load_lds_dwordx4 v249, s[50:51]
    s_add_u32 m0, s48, 81920
    s_add_u32 s52, s49, 0
    s_add_u32 s50, s8, s52
    s_addc_u32 s51, s9, 0
    global_load_lds_dwordx4 v246, s[50:51]
    s_add_u32 m0, s48, 87040
    s_add_u32 s50, s50, 5120
    s_addc_u32 s51, s51, 0
    global_load_lds_dwordx4 v247, s[50:51]
    s_add_u32 m0, s48, 92160
    s_add_u32 s50, s50, 5120
    s_addc_u32 s51, s51, 0
    global_load_lds_dwordx4 v248, s[50:51]
    s_add_u32 m0, s48, 97280
    s_add_u32 s50, s50, 5120
    s_addc_u32 s51, s51, 0
    global_load_lds_dwordx4 v249, s[50:51]
    s_add_u32 m0, s48, 102400
    s_add_u32 s50, s50, 5120
    s_addc_u32 s51, s51, 0
    global_load_lds_dwordx4 v246, s[50:51]
    s_add_u32 m0, s48, 107520
    s_add_u32 s50, s50, 5120
    s_addc_u32 s51, s51, 0
    global_load_lds_dwordx4 v247, s[50:51]
    s_branch L_xd5
L_xd5_3:
    s_add_u32 m0, s48, 97280
    s_add_u32 s52, s49, 15360
    s_add_u32 s50, s8, s52
    s_addc_u32 s51, s9, 0
    global_load_lds_dwordx4 v249, s[50:51]
    s_add_u32 m0, s48, 102400
    s_add_u32 s50, s50, 5120
    s_addc_u32 s51, s51, 0
    global_load_lds_dwordx4 v246, s[50:51]
    s_add_u32 m0, s48, 107520
    s_add_u32 s50, s50, 5120
    s_addc_u32 s51, s51, 0
    global_load_lds_dwordx4 v247, s[50:51]
    s_add_u32 m0, s48, 112640
    s_add_u32 s50, s50, 5120
    s_addc_u32 s51, s51, 0
    global_load_lds_dwordx4 v248, s[50:51]
    s_add_u32 m0, s48, 117760
    s_add_u32 s50, s50, 5120
    s_addc_u32 s51, s51, 0
    global_load_lds_dwordx4 v249, s[50:51]
    s_add_u32 m0, s48, 122880
    s_add_u32 s50, s50, 5120
    s_addc_u32 s51, s51, 0
    global_load_lds_dwordx4 v246, s[50:51]
    s_add_u32 m0, s48, 128000
    s_add_u32 s50, s50, 5120
    s_addc_u32 s51, s51, 0
    global_load_lds_dwordx4 v247, s[50:51]
    s_add_u32 m0, s48, 133120
    s_add_u32 s50, s50, 5120
    s_addc_u32 s51, s51, 0
    global_load_lds_dwordx4 v248, s[50:51]
L_xd5:
L_xs4:
    s_mov_b32 m0, s46
    s_waitcnt lgkmcnt(0)
    v_mfma_f32_16x16x32_f16 v[84:87], v[52:55], v[68:71], 0
    v_mfma_f32_16x16x32_f16 v[84:87], v[56:59], v[72:75], v[84:87]
    v_mfma_f32_16x16x32_f16 v[84:87], v[60:63], v[76:79], v[84:87]
    v_mfma_f32_16x16x32_f16 v[84:87], v[64:67], v[80:83], v[84:87]
    v_cvt_pk_f16_f32 v52, v18, v19
    v_cvt_pk_f16_f32 v53, v22, v23
    v_cvt_pk_f16_f32 v54, v26, v27
    v_cvt_pk_f16_f32 v55, v30, v31
    v_cvt_pk_f16_f32 v56, v34, v35
    v_cvt_pk_f16_f32 v57, v38, v39
    v_cvt_pk_f16_f32 v58, v42, v43
    v_cvt_pk_f16_f32 v59, v46, v47
    v_cvt_pk_f16_f32 v60, v20, v21
    v_cvt_pk_f16_f32 v61, v28, v29
    v_cvt_pk_f16_f32 v62, v36, v37
    v_cvt_pk_f16_f32 v63, v44, v45
    v_cvt_pk_f16_f32 v64, v24, v25
    v_cvt_pk_f16_f32 v65, v40, v41
    v_cvt_pk_f16_f32 v66, v48, v49
    v_cvt_pk_f16_f32 v67, v50, v51
    ds_write_addtid_b32 v52 offset:0
    ds_write_addtid_b32 v53 offset:288
    ds_write_addtid_b32 v54 offset:576
    ds_write_addtid_b32 v55 offset:864
    ds_write_addtid_b32 v56 offset:1152
    ds_write_addtid_b32 v57 offset:1440
    ds_write_addtid_b32 v58 offset:1728
    ds_write_addtid_b32 v59 offset:2016
    ds_write_addtid_b32 v60 offset:2304
    ds_write_addtid_b32 v61 offset:2592
    ds_write_addtid_b32 v62 offset:2880
    ds_write_addtid_b32 v63 offset:3168
    ds_write_addtid_b32 v64 offset:3456
    ds_write_addtid_b32 v65 offset:3744
    ds_write_addtid_b32 v66 offset:4032
    ds_write_addtid_b32 v67 offset:4320
    v_pk_mul_f32 v[18:19], v[16:17], v[14:15] op_sel:[0,0] op_sel_hi:[1,0]
    v_pk_mul_f32 v[22:23], v[32:33], v[14:15] op_sel:[0,0] op_sel_hi:[1,0]
    v_pk_fma_f32 v[18:19], v[16:17], v[14:15], v[18:19] op_sel:[1,1,0] op_sel_hi:[0,1,1] neg_lo:[1,0,0]
    v_pk_fma_f32 v[22:23], v[32:33], v[14:15], v[22:23] op_sel:[1,1,0] op_sel_hi:[0,1,1] neg_lo:[1,0,0]
    s_waitcnt lgkmcnt(0)
    ds_read_b128 v[52:55], v3 offset:0
    ds_read_b128 v[56:59], v3 offset:64
    ds_read_b128 v[60:63], v3 offset:128
    ds_read_b128 v[64:67], v3 offset:192
    v_pk_mul_f32 v[26:27], v[18:19], v[10:11] op_sel:[0,0] op_sel_hi:[1,0]
    v_pk_mul_f32 v[30:31], v[22:23], v[10:11] op_sel:[0,0] op_sel_hi:[1,0]
    v_pk_mul_f32 v[34:35], v[18:19], v[12:13] op_sel:[0,0] op_sel_hi:[1,0]
    v_pk_mul_f32 v[38:39], v[22:23], v[12:13] op_sel:[0,0] op_sel_hi:[1,0]
    v_pk_mul_f32 v[20:21], v[18:19], v[14:15] op_sel:[0,0] op_sel_hi:[1,0]
    v_pk_fma_f32 v[26:27], v[18:19], v[10:11], v[26:27] op_sel:[1,1,0] op_sel_hi:[0,1,1] neg_lo:[1,0,0]
    v_pk_fma_f32 v[30:31], v[22:23], v[10:11], v[30:31] op_sel:[1,1,0] op_sel_hi:[0,1,1] neg_lo:[1,0,0]
    v_pk_fma_f32 v[34:35], v[18:19], v[12:13], v[34:35] op_sel:[1,1,0] op_sel_hi:[0,1,1] neg_lo:[1,0,0]
    v_pk_fma_f32 v[38:39], v[22:23], v[12:13], v[38:39] op_sel:[1,1,0] op_sel_hi:[0,1,1] neg_lo:[1,0,0]
    v_pk_fma_f32 v[20:21], v[18:19], v[14:15], v[20:21] op_sel:[1,1,0] op_sel_hi:[0,1,1] neg_lo:[1,0,0]
    v_pk_mul_f32 v[42:43], v[34:35], v[10:11] op_sel:[0,0] op_sel_hi:[1,0]
    v_pk_mul_f32 v[46:47], v[38:39], v[10:11] op_sel:[0,0] op_sel_hi:[1,0]
    v_pk_fma_f32 v[42:43], v[34:35], v[10:11], v[42:43] op_sel:[1,1,0] op_sel_hi:[0,1,1] neg_lo:[1,0,0]
    v_pk_fma_f32 v[46:47], v[38:39], v[10:11], v[46:47] op_sel:[1,1,0] op_sel_hi:[0,1,1] neg_lo:[1,0,0]
    s_waitcnt lgkmcnt(0)
    v_mfma_f32_16x16x32_f16 v[88:91], v[52:55], v[68:71], 0
    v_mfma_f32_16x16x32_f16 v[88:91], v[56:59], v[72:75], v[88:91]
    v_mfma_f32_16x16x32_f16 v[88:91], v[60:63], v[76:79], v[88:91]
    v_mfma_f32_16x16x32_f16 v[88:91], v[64:67], v[80:83], v[88:91]
    v_cvt_pk_f16_f32 v52, v18, v19
    v_cvt_pk_f16_f32 v53, v22, v23
    v_cvt_pk_f16_f32 v54, v26, v27
    v_cvt_pk_f16_f32 v55, v30, v31
    v_cvt_pk_f16_f32 v56, v34, v35
    v_cvt_pk_f16_f32 v57, v38, v39
    v_cvt_pk_f16_f32 v58, v42, v43
    v_cvt_pk_f16_f32 v59, v46, v47
    v_cvt_pk_f16_f32 v60, v20, v21
    ds_write_addtid_b32 v52 offset:0
    ds_write_addtid_b32 v53 offset:288
    ds_write_addtid_b32 v54 offset:576
    ds_write_addtid_b32 v55 offset:864
    ds_write_addtid_b32 v56 offset:1152
    ds_write_addtid_b32 v57 offset:1440
    ds_write_addtid_b32 v58 offset:1728
    ds_write_addtid_b32 v59 offset:2016
    ds_write_addtid_b32 v60 offset:2304
    s_waitcnt lgkmcnt(0)
    ds_read_b128 v[52:55], v3 offset:0
    ds_read_b128 v[56:59], v3 offset:64
    ds_read_b128 v[60:63], v3 offset:128
    ds_read_b128 v[64:67], v3 offset:192
    v_lshl_add_u32 v2, v1, 4, s46
    v_mov_b32 v4, 0
    s_waitcnt lgkmcnt(0)
    v_mfma_f32_16x16x32_f16 v[92:95], v[52:55], v[68:71], 0
    v_mfma_f32_16x16x32_f16 v[92:95], v[56:59], v[72:75], v[92:95]
    v_mfma_f32_16x16x32_f16 v[92:95], v[60:63], v[76:79], v[92:95]
    v_mfma_f32_16x16x32_f16 v[92:95], v[64:67], v[80:83], v[92:95]
    ds_write_b128 v2, v[84:87]
    ds_write_b128 v2, v[88:91] offset:1024
    ds_write_addtid_b32 v4 offset:3072
    s_nop 4
    ds_write_b128 v2, v[92:95] offset:2048
    s_cmp_eq_u32 s3, 0
    s_cbranch_scc0 L_st_np
    s_mul_i32 s46, s4, 30
    v_min_u32 v2, 29, v1
    v_add_u32 v2, s46, v2
    v_lshlrev_b32 v2, 7, v2
    v_add_u32 v2, 4096, v2
    s_mov_b32 s57, 0
L_poll6:
    global_load_dwordx2 v[4:5], v2, s[32:33] sc1
    s_add_u32 s57, s57, 1
    s_waitcnt vmcnt(0)
    v_cmp_ne_u64 vcc, s[34:35], v[4:5]
    s_cmp_gt_u32 s57, 200000
    s_nop 2
    s_cbranch_scc1 L_end
    s_cbranch_vccnz L_poll6
    v_mov_b32 v2, 45316
    v_mov_b32 v3, 1
    ds_write_b32 v2, v3
L_st_np:
    v_and_b32 v16, 15, v1
    v_lshrrev_b32 v17, 4, v1
    v_lshrrev_b32 v18, 2, v16
    v_and_b32 v19, 3, v1
    s_and_b32 s42, s3, 3
    s_lshr_b32 s43, s3, 2
    s_mul_i32 s43, s43, 48
    s_mul_i32 s44, s4, 80
    s_add_u32 s43, s43, s44
    v_mov_b32 v10, 0x3f803f80
    v_mov_b32 v11, 0x3f803f80
    v_mov_b32 v12, 0x3f803f80
    v_mov_b32 v13, 0x3f803f80
    s_mul_i32 s46, s4, 15
    s_lshl_b32 s47, s3, 1
    s_add_u32 s46, s46, s47
    s_mul_i32 s46, s46, 20480
    s_add_u32 s46, s46, 1048576
    s_add_u32 s48, s32, s46
    s_addc_u32 s49, s33, 0
    s_add_u32 s50, s48, 20480
    s_addc_u32 s51, s49, 0
    s_xor_b32 s46, s6, 0
    s_lshl_b32 s46, s46, 10
    v_lshl_add_u32 v44, v1, 4, s46
    s_xor_b32 s46, s6, 1
    s_lshl_b32 s46, s46, 10
    v_lshl_add_u32 v45, v1, 4, s46
    s_xor_b32 s46, s6, 2
    s_lshl_b32 s46, s46, 10
    v_lshl_add_u32 v46, v1, 4, s46
    s_xor_b32 s46, s6, 3
    s_lshl_b32 s46, s46, 10
    v_lshl_add_u32 v47, v1, 4, s46
    v_mul_u32_u24 v20, 1280, v16
    v_add_u32 v20, 61440, v20
    v_add_u32 v21, 0, v17
    v_xor_b32 v21, v21, v16
    v_lshl_add_u32 v2, v21, 4, v20
    v_add_u32 v21, 4, v17
    v_xor_b32 v21, v21, v16
    v_lshl_add_u32 v3, v21, 4, v20
    v_add_u32 v21, 8, v17
    v_xor_b32 v21, v21, v16
    v_lshl_add_u32 v4, v21, 4, v20
    v_add_u32 v21, 12, v17
    v_xor_b32 v21, v21, v16
    v_lshl_add_u32 v5, v21, 4, v20
    v_lshl_add_u32 v20, v17, 2, v18
    s_lshl_b32 s44, s6, 2
    v_xor_b32 v21, s44, v20
    s_lshl_b32 s44, s42, 4
    s_add_u32 s44, s44, 16
    v_add_u32 v20, s44, v20
    v_mul_u32_u24 v20, 1280, v20
    v_add_u32 v20, 61440, v20
    v_and_b32 v22, 1, v19
    v_lshl_add_u32 v20, v22, 3, v20
    v_lshrrev_b32 v22, 1, v19
    s_lshr_b32 s44, s43, 3
    v_add_u32 v22, s44, v22
    v_add_u32 v23, 0, v22
    v_min_u32 v23, 79, v23
    v_xor_b32 v23, v23, v21
    v_lshl_add_u32 v7, v23, 4, v20
    v_add_u32 v23, 2, v22
    v_min_u32 v23, 79, v23
    v_xor_b32 v23, v23, v21
    v_lshl_add_u32 v8, v23, 4, v20
    v_add_u32 v23, 4, v22
    v_min_u32 v23, 79, v23
    v_xor_b32 v23, v23, v21
    v_lshl_add_u32 v9, v23, 4, v20
    s_waitcnt vmcnt(0)
    s_sub_u32 s46, s3, 3
    s_cmp_lt_u32 s46, 2
    s_cbranch_scc0 L_st_w
    s_lshl_b32 s46, s46, 10
    s_add_u32 s46, s46, 61440
    v_lshl_add_u32 v24, v1, 4, s46
    v_min_u32 v24, 62704, v24
    ds_write_b128 v24, v[10:13]
L_st_w:
    v_mov_b32 v24, 45316
    s_mov_b32 s57, 0
L_sp7:
    ds_read_b32 v25, v24
    s_add_u32 s57, s57, 1
    s_waitcnt lgkmcnt(0)
    v_readfirstlane_b32 s56, v25
    s_cmp_gt_u32 s57, 2000000
    s_nop 2
    s_cbranch_scc1 L_end
    s_cmp_lt_u32 s56, 1
    s_cbranch_scc1 L_sp7
    s_cmp_eq_u32 s3, 0
    s_cbranch_scc1 L_g1A
    s_cmp_eq_u32 s3, 1
    s_cbranch_scc1 L_g1B
    s_cmp_eq_u32 s3, 3
    s_cbranch_scc1 L_g1D
    s_cmp_eq_u32 s3, 7
    s_cbranch_scc1 L_g1E
    global_load_dwordx4 v[96:99], v44, s[48:49] sc1
    global_load_dwordx4 v[176:179], v44, s[50:51] sc1
    global_load_dwordx4 v[100:103], v45, s[48:49] sc1
    global_load_dwordx4 v[180:183], v45, s[50:51] sc1
    global_load_dwordx4 v[104:107], v46, s[48:49] sc1
    global_load_dwordx4 v[184:187], v46, s[50:51] sc1
    global_load_dwordx4 v[108:111], v47, s[48:49] sc1
    global_load_dwordx4 v[188:191], v47, s[50:51] sc1
    s_add_u32 s48, s48, 4096
    s_addc_u32 s49, s49, 0
    s_add_u32 s50, s50, 4096
    s_addc_u32 s51, s51, 0
    s_waitcnt lgkmcnt(0)
    s_barrier
    global_load_dwordx4 v[112:115], v44, s[48:49] sc1
    global_load_dwordx4 v[192:195], v44, s[50:51] sc1
    global_load_dwordx4 v[116:119], v45, s[48:49] sc1
    global_load_dwordx4 v[196:199], v45, s[50:51] sc1
    global_load_dwordx4 v[120:123], v46, s[48:49] sc1
    global_load_dwordx4 v[200:203], v46, s[50:51] sc1
    global_load_dwordx4 v[124:127], v47, s[48:49] sc1
    global_load_dwordx4 v[204:207], v47, s[50:51] sc1
    s_add_u32 s48, s48, 4096
    s_addc_u32 s49, s49, 0
    s_add_u32 s50, s50, 4096
    s_addc_u32 s51, s51, 0
    ds_read_b128 v[16:19], v2 offset:0
    ds_read_b128 v[20:23], v2 offset:20480
    ds_read_b128 v[24:27], v2 offset:40960
    ds_read_b128 v[28:31], v2 offset:61440
    v_add_u32 v6, 81920, v2
    ds_read_b128 v[32:35], v6 offset:0
    ds_read_b128 v[36:39], v3 offset:0
    global_load_dwordx4 v[128:131], v44, s[48:49] sc1
    global_load_dwordx4 v[208:211], v44, s[50:51] sc1
    ds_read_b128 v[40:43], v3 offset:20480
    s_waitcnt vmcnt(16) lgkmcnt(6)
    v_mfma_f32_16x16x32_bf16 v[48:51], v[96:99], v[16:19], 0
    v_mfma_f32_16x16x32_bf16 v[52:55], v[176:179], v[16:19], 0
    ds_read_b128 v[16:19], v3 offset:40960
    s_waitcnt lgkmcnt(6)
    v_mfma_f32_16x16x32_bf16 v[56:59], v[96:99], v[20:23], 0
    v_mfma_f32_16x16x32_bf16 v[60:63], v[176:179], v[20:23], 0
    ds_read_b128 v[20:23], v3 offset:61440
    s_waitcnt lgkmcnt(6)
    v_mfma_f32_16x16x32_bf16 v[64:67], v[96:99], v[24:27], 0
    v_mfma_f32_16x16x32_bf16 v[68:71], v[176:179], v[24:27], 0
    v_add_u32 v6, 81920, v3
    ds_read_b128 v[24:27], v6 offset:0
    s_waitcnt lgkmcnt(6)
    v_mfma_f32_16x16x32_bf16 v[72:75], v[96:99], v[28:31], 0
    v_mfma_f32_16x16x32_bf16 v[76:79], v[176:179], v[28:31], 0
    ds_read_b128 v[28:31], v4 offset:0
    s_waitcnt lgkmcnt(6)
    v_mfma_f32_16x16x32_bf16 v[80:83], v[96:99], v[32:35], 0
    v_mfma_f32_16x16x32_bf16 v[84:87], v[176:179], v[32:35], 0
    global_load_dwordx4 v[132:135], v45, s[48:49] sc1
    global_load_dwordx4 v[212:215], v45, s[50:51] sc1
    ds_read_b128 v[32:35], v4 offset:20480
    s_waitcnt vmcnt(16) lgkmcnt(6)
    v_mfma_f32_16x16x32_bf16 v[48:51], v[100:103], v[36:39], v[48:51]
    v_mfma_f32_16x16x32_bf16 v[52:55], v[180:183], v[36:39], v[52:55]
    ds_read_b128 v[36:39], v4 offset:40960
    s_waitcnt lgkmcnt(6)
    v_mfma_f32_16x16x32_bf16 v[56:59], v[100:103], v[40:43], v[56:59]
    v_mfma_f32_16x16x32_bf16 v[60:63], v[180:183], v[40:43], v[60:63]
    ds_read_b128 v[40:43], v4 offset:61440
    s_waitcnt lgkmcnt(6)
    v_mfma_f32_16x16x32_bf16 v[64:67], v[100:103], v[16:19], v[64:67]
    v_mfma_f32_16x16x32_bf16 v[68:71], v[180:183], v[16:19], v[68:71]
    v_add_u32 v6, 81920, v4
    ds_read_b128 v[16:19], v6 offset:0
    s_waitcnt lgkmcnt(6)
    v_mfma_f32_16x16x32_bf16 v[72:75], v[100:103], v[20:23], v[72:75]
    v_mfma_f32_16x16x32_bf16 v[76:79], v[180:183], v[20:23], v[76:79]
    ds_read_b128 v[20:23], v5 offset:0
    s_waitcnt lgkmcnt(6)
    v_mfma_f32_16x16x32_bf16 v[80:83], v[100:103], v[24:27], v[80:83]
    v_mfma_f32_16x16x32_bf16 v[84:87], v[180:183], v[24:27], v[84:87]
    global_load_dwordx4 v[136:139], v46, s[48:49] sc1
    global_load_dwordx4 v[216:219], v46, s[50:51] sc1
    ds_read_b128 v[24:27], v5 offset:20480
    s_waitcnt vmcnt(16) lgkmcnt(6)
    v_mfma_f32_16x16x32_bf16 v[48:51], v[104:107], v[28:31], v[48:51]
    v_mfma_f32_16x16x32_bf16 v[52:55], v[184:187], v[28:31], v[52:55]
    ds_read_b128 v[28:31], v5 offset:40960
    s_waitcnt lgkmcnt(6)
    v_mfma_f32_16x16x32_bf16 v[56:59], v[104:107], v[32:35], v[56:59]
    v_mfma_f32_16x16x32_bf16 v[60:63], v[184:187], v[32:35], v[60:63]
    ds_read_b128 v[32:35], v5 offset:61440
    s_waitcnt lgkmcnt(6)
    v_mfma_f32_16x16x32_bf16 v[64:67], v[104:107], v[36:39], v[64:67]
    v_mfma_f32_16x16x32_bf16 v[68:71], v[184:187], v[36:39], v[68:71]
    v_add_u32 v6, 81920, v5
    ds_read_b128 v[36:39], v6 offset:0
    s_waitcnt lgkmcnt(6)
    v_mfma_f32_16x16x32_bf16 v[72:75], v[104:107], v[40:43], v[72:75]
    v_mfma_f32_16x16x32_bf16 v[76:79], v[184:187], v[40:43], v[76:79]
    ds_read_b128 v[40:43], v2 offset:256
    s_waitcnt lgkmcnt(6)
    v_mfma_f32_16x16x32_bf16 v[80:83], v[104:107], v[16:19], v[80:83]
    v_mfma_f32_16x16x32_bf16 v[84:87], v[184:187], v[16:19], v[84:87]
    global_load_dwordx4 v[140:143], v47, s[48:49] sc1
    global_load_dwordx4 v[220:223], v47, s[50:51] sc1
    s_add_u32 s48, s48, 4096
    s_addc_u32 s49, s49, 0
    s_add_u32 s50, s50, 4096
    s_addc_u32 s51, s51, 0
    ds_read_b128 v[16:19], v2 offset:20736
    s_waitcnt vmcnt(16) lgkmcnt(6)
    v_mfma_f32_16x16x32_bf16 v[48:51], v[108:111], v[20:23], v[48:51]
    v_mfma_f32_16x16x32_bf16 v[52:55], v[188:191], v[20:23], v[52:55]
    ds_read_b128 v[20:23], v2 offset:41216
    s_waitcnt lgkmcnt(6)
    v_mfma_f32_16x16x32_bf16 v[56:59], v[108:111], v[24:27], v[56:59]
    v_mfma_f32_16x16x32_bf16 v[60:63], v[188:191], v[24:27], v[60:63]
    ds_read_b128 v[24:27], v2 offset:61696
    s_waitcnt lgkmcnt(6)
    v_mfma_f32_16x16x32_bf16 v[64:67], v[108:111], v[28:31], v[64:67]
    v_mfma_f32_16x16x32_bf16 v[68:71], v[188:191], v[28:31], v[68:71]
    v_add_u32 v6, 81920, v2
    ds_read_b128 v[28:31], v6 offset:256
    s_waitcnt lgkmcnt(6)
    v_mfma_f32_16x16x32_bf16 v[72:75], v[108:111], v[32:35], v[72:75]
    v_mfma_f32_16x16x32_bf16 v[76:79], v[188:191], v[32:35], v[76:79]
    ds_read_b128 v[32:35], v3 offset:256
    s_waitcnt lgkmcnt(6)
    v_mfma_f32_16x16x32_bf16 v[80:83], v[108:111], v[36:39], v[80:83]
    v_mfma_f32_16x16x32_bf16 v[84:87], v[188:191], v[36:39], v[84:87]
    global_load_dwordx4 v[144:147], v44, s[48:49] sc1
    global_load_dwordx4 v[224:227], v44, s[50:51] sc1
    ds_read_b128 v[36:39], v3 offset:20736
    s_waitcnt vmcnt(16) lgkmcnt(6)
    v_mfma_f32_16x16x32_bf16 v[48:51], v[112:115], v[40:43], v[48:51]
    v_mfma_f32_16x16x32_bf16 v[52:55], v[192:195], v[40:43], v[52:55]
    ds_read_b128 v[40:43], v3 offset:41216
    s_waitcnt lgkmcnt(6)
    v_mfma_f32_16x16x32_bf16 v[56:59], v[112:115], v[16:19], v[56:59]
    v_mfma_f32_16x16x32_bf16 v[60:63], v[192:195], v[16:19], v[60:63]
    ds_read_b128 v[16:19], v3 offset:61696
    s_waitcnt lgkmcnt(6)
    v_mfma_f32_16x16x32_bf16 v[64:67], v[112:115], v[20:23], v[64:67]
    v_mfma_f32_16x16x32_bf16 v[68:71], v[192:195], v[20:23], v[68:71]
    v_add_u32 v6, 81920, v3
    ds_read_b128 v[20:23], v6 offset:256
    s_waitcnt lgkmcnt(6)
    v_mfma_f32_16x16x32_bf16 v[72:75], v[112:115], v[24:27], v[72:75]
    v_mfma_f32_16x16x32_bf16 v[76:79], v[192:195], v[24:27], v[76:79]
    ds_read_b128 v[24:27], v4 offset:256
    s_waitcnt lgkmcnt(6)
    v_mfma_f32_16x16x32_bf16 v[80:83], v[112:115], v[28:31], v[80:83]
    v_mfma_f32_16x16x32_bf16 v[84:87], v[192:195], v[28:31], v[84:87]
    global_load_dwordx4 v[148:151], v45, s[48:49] sc1
    global_load_dwordx4 v[228:231], v45, s[50:51] sc1
    ds_read_b128 v[28:31], v4 offset:20736
    s_waitcnt vmcnt(16) lgkmcnt(6)
    v_mfma_f32_16x16x32_bf16 v[48:51], v[116:119], v[32:35], v[48:51]
    v_mfma_f32_16x16x32_bf16 v[52:55], v[196:199], v[32:35], v[52:55]
    ds_read_b128 v[32:35], v4 offset:41216
    s_waitcnt lgkmcnt(6)
    v_mfma_f32_16x16x32_bf16 v[56:59], v[116:119], v[36:39], v[56:59]
    v_mfma_f32_16x16x32_bf16 v[60:63], v[196:199], v[36:39], v[60:63]
    ds_read_b128 v[36:39], v4 offset:61696
    s_waitcnt lgkmcnt(6)
    v_mfma_f32_16x16x32_bf16 v[64:67], v[116:119], v[40:43], v[64:67]
    v_mfma_f32_16x16x32_bf16 v[68:71], v[196:199], v[40:43], v[68:71]
    v_add_u32 v6, 81920, v4
    ds_read_b128 v[40:43], v6 offset:256
    s_waitcnt lgkmcnt(6)
    v_mfma_f32_16x16x32_bf16 v[72:75], v[116:119], v[16:19], v[72:75]
    v_mfma_f32_16x16x32_bf16 v[76:79], v[196:199], v[16:19], v[76:79]
    ds_read_b128 v[16:19], v5 offset:256
    s_waitcnt lgkmcnt(6)
    v_mfma_f32_16x16x32_bf16 v[80:83], v[116:119], v[20:23], v[80:83]
    v_mfma_f32_16x16x32_bf16 v[84:87], v[196:199], v[20:23], v[84:87]
    global_load_dwordx4 v[152:155], v46, s[48:49] sc1
    global_load_dwordx4 v[232:235], v46, s[50:51] sc1
    ds_read_b128 v[20:23], v5 offset:20736
    s_waitcnt vmcnt(16) lgkmcnt(6)
    v_mfma_f32_16x16x32_bf16 v[48:51], v[120:123], v[24:27], v[48:51]
    v_mfma_f32_16x16x32_bf16 v[52:55], v[200:203], v[24:27], v[52:55]
    ds_read_b128 v[24:27], v5 offset:41216
    s_waitcnt lgkmcnt(6)
    v_mfma_f32_16x16x32_bf16 v[56:59], v[120:123], v[28:31], v[56:59]
    v_mfma_f32_16x16x32_bf16 v[60:63], v[200:203], v[28:31], v[60:63]
    ds_read_b128 v[28:31], v5 offset:61696
    s_waitcnt lgkmcnt(6)
    v_mfma_f32_16x16x32_bf16 v[64:67], v[120:123], v[32:35], v[64:67]
    v_mfma_f32_16x16x32_bf16 v[68:71], v[200:203], v[32:35], v[68:71]
    v_add_u32 v6, 81920, v5
    ds_read_b128 v[32:35], v6 offset:256
    s_waitcnt lgkmcnt(6)
    v_mfma_f32_16x16x32_bf16 v[72:75], v[120:123], v[36:39], v[72:75]
    v_mfma_f32_16x16x32_bf16 v[76:79], v[200:203], v[36:39], v[76:79]
    ds_read_b128 v[36:39], v2 offset:512
    s_waitcnt lgkmcnt(6)
    v_mfma_f32_16x16x32_bf16 v[80:83], v[120:123], v[40:43], v[80:83]
    v_mfma_f32_16x16x32_bf16 v[84:87], v[200:203], v[40:43], v[84:87]
    global_load_dwordx4 v[156:159], v47, s[48:49] sc1
    global_load_dwordx4 v[236:239], v47, s[50:51] sc1
    s_add_u32 s48, s48, 4096
    s_addc_u32 s49, s49, 0
    s_add_u32 s50, s50, 4096
    s_addc_u32 s51, s51, 0
    ds_read_b128 v[40:43], v2 offset:20992
    s_waitcnt vmcnt(16) lgkmcnt(6)
    v_mfma_f32_16x16x32_bf16 v[48:51], v[124:127], v[16:19], v[48:51]
    v_mfma_f32_16x16x32_bf16 v[52:55], v[204:207], v[16:19], v[52:55]
    ds_read_b128 v[16:19], v2 offset:41472
    s_waitcnt lgkmcnt(6)
    v_mfma_f32_16x16x32_bf16 v[56:59], v[124:127], v[20:23], v[56:59]
    v_mfma_f32_16x16x32_bf16 v[60:63], v[204:207], v[20:23], v[60:63]
    ds_read_b128 v[20:23], v2 offset:61952
    s_waitcnt lgkmcnt(6)
    v_mfma_f32_16x16x32_bf16 v[64:67], v[124:127], v[24:27], v[64:67]
    v_mfma_f32_16x16x32_bf16 v[68:71], v[204:207], v[24:27], v[68:71]
    v_add_u32 v6, 81920, v2
    ds_read_b128 v[24:27], v6 offset:512
    s_waitcnt lgkmcnt(6)
    v_mfma_f32_16x16x32_bf16 v[72:75], v[124:127], v[28:31], v[72:75]
    v_mfma_f32_16x16x32_bf16 v[76:79], v[204:207], v[28:31], v[76:79]
    ds_read_b128 v[28:31], v3 offset:512
    s_waitcnt lgkmcnt(6)
    v_mfma_f32_16x16x32_bf16 v[80:83], v[124:127], v[32:35], v[80:83]
    v_mfma_f32_16x16x32_bf16 v[84:87], v[204:207], v[32:35], v[84:87]
    global_load_dwordx4 v[160:163], v44, s[48:49] sc1
    global_load_dwordx4 v[240:243], v44, s[50:51] sc1
    ds_read_b128 v[32:35], v3 offset:20992
    s_waitcnt vmcnt(16) lgkmcnt(6)
    v_mfma_f32_16x16x32_bf16 v[48:51], v[128:131], v[36:39], v[48:51]
    v_mfma_f32_16x16x32_bf16 v[52:55], v[208:211], v[36:39], v[52:55]
    ds_read_b128 v[36:39], v3 offset:41472
    s_waitcnt lgkmcnt(6)
    v_mfma_f32_16x16x32_bf16 v[56:59], v[128:131], v[40:43], v[56:59]
    v_mfma_f32_16x16x32_bf16 v[60:63], v[208:211], v[40:43], v[60:63]
    ds_read_b128 v[40:43], v3 offset:61952
    s_waitcnt lgkmcnt(6)
    v_mfma_f32_16x16x32_bf16 v[64:67], v[128:131], v[16:19], v[64:67]
    v_mfma_f32_16x16x32_bf16 v[68:71], v[208:211], v[16:19], v[68:71]
    v_add_u32 v6, 81920, v3
    ds_read_b128 v[16:19], v6 offset:512
    s_waitcnt lgkmcnt(6)
    v_mfma_f32_16x16x32_bf16 v[72:75], v[128:131], v[20:23], v[72:75]
    v_mfma_f32_16x16x32_bf16 v[76:79], v[208:211], v[20:23], v[76:79]
    ds_read_b128 v[20:23], v4 offset:512
    s_waitcnt lgkmcnt(6)
    v_mfma_f32_16x16x32_bf16 v[80:83], v[128:131], v[24:27], v[80:83]
    v_mfma_f32_16x16x32_bf16 v[84:87], v[208:211], v[24:27], v[84:87]
    global_load_dwordx4 v[164:167], v45, s[48:49] sc1
    global_load_dwordx4 v[244:247], v45, s[50:51] sc1
    ds_read_b128 v[24:27], v4 offset:20992
    s_waitcnt vmcnt(16) lgkmcnt(6)
    v_mfma_f32_16x16x32_bf16 v[48:51], v[132:135], v[28:31], v[48:51]
    v_mfma_f32_16x16x32_bf16 v[52:55], v[212:215], v[28:31], v[52:55]
    ds_read_b128 v[28:31], v4 offset:41472
    s_waitcnt lgkmcnt(6)
    v_mfma_f32_16x16x32_bf16 v[56:59], v[132:135], v[32:35], v[56:59]
    v_mfma_f32_16x16x32_bf16 v[60:63], v[212:215], v[32:35], v[60:63]
    ds_read_b128 v[32:35], v4 offset:61952
    s_waitcnt lgkmcnt(6)
    v_mfma_f32_16x16x32_bf16 v[64:67], v[132:135], v[36:39], v[64:67]
    v_mfma_f32_16x16x32_bf16 v[68:71], v[212:215], v[36:39], v[68:71]
    v_add_u32 v6, 81920, v4
    ds_read_b128 v[36:39], v6 offset:512
    s_waitcnt lgkmcnt(6)
    v_mfma_f32_16x16x32_bf16 v[72:75], v[132:135], v[40:43], v[72:75]
    v_mfma_f32_16x16x32_bf16 v[76:79], v[212:215], v[40:43], v[76:79]
    ds_read_b128 v[40:43], v5 offset:512
    s_waitcnt lgkmcnt(6)
    v_mfma_f32_16x16x32_bf16 v[80:83], v[132:135], v[16:19], v[80:83]
    v_mfma_f32_16x16x32_bf16 v[84:87], v[212:215], v[16:19], v[84:87]
    global_load_dwordx4 v[168:171], v46, s[48:49] sc1
    global_load_dwordx4 v[248:251], v46, s[50:51] sc1
    ds_read_b128 v[16:19], v5 offset:20992
    s_waitcnt vmcnt(16) lgkmcnt(6)
    v_mfma_f32_16x16x32_bf16 v[48:51], v[136:139], v[20:23], v[48:51]
    v_mfma_f32_16x16x32_bf16 v[52:55], v[216:219], v[20:23], v[52:55]
    ds_read_b128 v[20:23], v5 offset:41472
    s_waitcnt lgkmcnt(6)
    v_mfma_f32_16x16x32_bf16 v[56:59], v[136:139], v[24:27], v[56:59]
    v_mfma_f32_16x16x32_bf16 v[60:63], v[216:219], v[24:27], v[60:63]
    ds_read_b128 v[24:27], v5 offset:61952
    s_waitcnt lgkmcnt(6)
    v_mfma_f32_16x16x32_bf16 v[64:67], v[136:139], v[28:31], v[64:67]
    v_mfma_f32_16x16x32_bf16 v[68:71], v[216:219], v[28:31], v[68:71]
    v_add_u32 v6, 81920, v5
    ds_read_b128 v[28:31], v6 offset:512
    s_waitcnt lgkmcnt(6)
    v_mfma_f32_16x16x32_bf16 v[72:75], v[136:139], v[32:35], v[72:75]
    v_mfma_f32_16x16x32_bf16 v[76:79], v[216:219], v[32:35], v[76:79]
    ds_read_b128 v[32:35], v2 offset:768
    s_waitcnt lgkmcnt(6)
    v_mfma_f32_16x16x32_bf16 v[80:83], v[136:139], v[36:39], v[80:83]
    v_mfma_f32_16x16x32_bf16 v[84:87], v[216:219], v[36:39], v[84:87]
    global_load_dwordx4 v[172:175], v47, s[48:49] sc1
    global_load_dwordx4 v[252:255], v47, s[50:51] sc1
    ds_read_b128 v[36:39], v2 offset:21248
    s_waitcnt vmcnt(16) lgkmcnt(6)
    v_mfma_f32_16x16x32_bf16 v[48:51], v[140:143], v[40:43], v[48:51]
    v_mfma_f32_16x16x32_bf16 v[52:55], v[220:223], v[40:43], v[52:55]
    ds_read_b128 v[40:43], v2 offset:41728
    s_waitcnt lgkmcnt(6)
    v_mfma_f32_16x16x32_bf16 v[56:59], v[140:143], v[16:19], v[56:59]
    v_mfma_f32_16x16x32_bf16 v[60:63], v[220:223], v[16:19], v[60:63]
    ds_read_b128 v[16:19], v2 offset:62208
    s_waitcnt lgkmcnt(6)
    v_mfma_f32_16x16x32_bf16 v[64:67], v[140:143], v[20:23], v[64:67]
    v_mfma_f32_16x16x32_bf16 v[68:71], v[220:223], v[20:23], v[68:71]
    v_add_u32 v6, 81920, v2
    ds_read_b128 v[20:23], v6 offset:768
    s_waitcnt lgkmcnt(6)
    v_mfma_f32_16x16x32_bf16 v[72:75], v[140:143], v[24:27], v[72:75]
    v_mfma_f32_16x16x32_bf16 v[76:79], v[220:223], v[24:27], v[76:79]
    ds_read_b128 v[24:27], v3 offset:768
    s_waitcnt lgkmcnt(6)
    v_mfma_f32_16x16x32_bf16 v[80:83], v[140:143], v[28:31], v[80:83]
    v_mfma_f32_16x16x32_bf16 v[84:87], v[220:223], v[28:31], v[84:87]
    ds_read_b128 v[28:31], v3 offset:21248
    s_waitcnt vmcnt(14) lgkmcnt(6)
    v_mfma_f32_16x16x32_bf16 v[48:51], v[144:147], v[32:35], v[48:51]
    v_mfma_f32_16x16x32_bf16 v[52:55], v[224:227], v[32:35], v[52:55]
    ds_read_b128 v[32:35], v3 offset:41728
    s_waitcnt lgkmcnt(6)
    v_mfma_f32_16x16x32_bf16 v[56:59], v[144:147], v[36:39], v[56:59]
    v_mfma_f32_16x16x32_bf16 v[60:63], v[224:227], v[36:39], v[60:63]
    ds_read_b128 v[36:39], v3 offset:62208
    s_waitcnt lgkmcnt(6)
    v_mfma_f32_16x16x32_bf16 v[64:67], v[144:147], v[40:43], v[64:67]
    v_mfma_f32_16x16x32_bf16 v[68:71], v[224:227], v[40:43], v[68:71]
    v_add_u32 v6, 81920, v3
    ds_read_b128 v[40:43], v6 offset:768
    s_waitcnt lgkmcnt(6)
    v_mfma_f32_16x16x32_bf16 v[72:75], v[144:147], v[16:19], v[72:75]
    v_mfma_f32_16x16x32_bf16 v[76:79], v[224:227], v[16:19], v[76:79]
    ds_read_b128 v[16:19], v4 offset:768
    s_waitcnt lgkmcnt(6)
    v_mfma_f32_16x16x32_bf16 v[80:83], v[144:147], v[20:23], v[80:83]
    v_mfma_f32_16x16x32_bf16 v[84:87], v[224:227], v[20:23], v[84:87]
    ds_read_b128 v[20:23], v4 offset:21248
    s_waitcnt vmcnt(12) lgkmcnt(6)
    v_mfma_f32_16x16x32_bf16 v[48:51], v[148:151], v[24:27], v[48:51]
    v_mfma_f32_16x16x32_bf16 v[52:55], v[228:231], v[24:27], v[52:55]
    ds_read_b128 v[24:27], v4 offset:41728
    s_waitcnt lgkmcnt(6)
    v_mfma_f32_16x16x32_bf16 v[56:59], v[148:151], v[28:31], v[56:59]
    v_mfma_f32_16x16x32_bf16 v[60:63], v[228:231], v[28:31], v[60:63]
    ds_read_b128 v[28:31], v4 offset:62208
    s_waitcnt lgkmcnt(6)
    v_mfma_f32_16x16x32_bf16 v[64:67], v[148:151], v[32:35], v[64:67]
    v_mfma_f32_16x16x32_bf16 v[68:71], v[228:231], v[32:35], v[68:71]
    v_add_u32 v6, 81920, v4
    ds_read_b128 v[32:35], v6 offset:768
    s_waitcnt lgkmcnt(6)
    v_mfma_f32_16x16x32_bf16 v[72:75], v[148:151], v[36:39], v[72:75]
    v_mfma_f32_16x16x32_bf16 v[76:79], v[228:231], v[36:39], v[76:79]
    ds_read_b128 v[36:39], v5 offset:768
    s_waitcnt lgkmcnt(6)
    v_mfma_f32_16x16x32_bf16 v[80:83], v[148:151], v[40:43], v[80:83]
    v_mfma_f32_16x16x32_bf16 v[84:87], v[228:231], v[40:43], v[84:87]
    ds_read_b128 v[40:43], v5 offset:21248
    s_waitcnt vmcnt(10) lgkmcnt(6)
    v_mfma_f32_16x16x32_bf16 v[48:51], v[152:155], v[16:19], v[48:51]
    v_mfma_f32_16x16x32_bf16 v[52:55], v[232:235], v[16:19], v[52:55]
    ds_read_b128 v[16:19], v5 offset:41728
    s_waitcnt lgkmcnt(6)
    v_mfma_f32_16x16x32_bf16 v[56:59], v[152:155], v[20:23], v[56:59]
    v_mfma_f32_16x16x32_bf16 v[60:63], v[232:235], v[20:23], v[60:63]
    ds_read_b128 v[20:23], v5 offset:62208
    s_waitcnt lgkmcnt(6)
    v_mfma_f32_16x16x32_bf16 v[64:67], v[152:155], v[24:27], v[64:67]
    v_mfma_f32_16x16x32_bf16 v[68:71], v[232:235], v[24:27], v[68:71]
    v_add_u32 v6, 81920, v5
    ds_read_b128 v[24:27], v6 offset:768
    s_waitcnt lgkmcnt(6)
    v_mfma_f32_16x16x32_bf16 v[72:75], v[152:155], v[28:31], v[72:75]
    v_mfma_f32_16x16x32_bf16 v[76:79], v[232:235], v[28:31], v[76:79]
    ds_read_b128 v[28:31], v2 offset:1024
    s_waitcnt lgkmcnt(6)
    v_mfma_f32_16x16x32_bf16 v[80:83], v[152:155], v[32:35], v[80:83]
    v_mfma_f32_16x16x32_bf16 v[84:87], v[232:235], v[32:35], v[84:87]
    ds_read_b128 v[32:35], v2 offset:21504
    s_waitcnt vmcnt(8) lgkmcnt(6)
    v_mfma_f32_16x16x32_bf16 v[48:51], v[156:159], v[36:39], v[48:51]
    v_mfma_f32_16x16x32_bf16 v[52:55], v[236:239], v[36:39], v[52:55]
    ds_read_b128 v[36:39], v2 offset:41984
    s_waitcnt lgkmcnt(6)
    v_mfma_f32_16x16x32_bf16 v[56:59], v[156:159], v[40:43], v[56:59]
    v_mfma_f32_16x16x32_bf16 v[60:63], v[236:239], v[40:43], v[60:63]
    ds_read_b128 v[40:43], v2 offset:62464
    s_waitcnt lgkmcnt(6)
    v_mfma_f32_16x16x32_bf16 v[64:67], v[156:159], v[16:19], v[64:67]
    v_mfma_f32_16x16x32_bf16 v[68:71], v[236:239], v[16:19], v[68:71]
    v_add_u32 v6, 81920, v2
    ds_read_b128 v[16:19], v6 offset:1024
    s_waitcnt lgkmcnt(6)
    v_mfma_f32_16x16x32_bf16 v[72:75], v[156:159], v[20:23], v[72:75]
    v_mfma_f32_16x16x32_bf16 v[76:79], v[236:239], v[20:23], v[76:79]
    ds_read_b128 v[20:23], v3 offset:1024
    s_waitcnt lgkmcnt(6)
    v_mfma_f32_16x16x32_bf16 v[80:83], v[156:159], v[24:27], v[80:83]
    v_mfma_f32_16x16x32_bf16 v[84:87], v[236:239], v[24:27], v[84:87]
    ds_read_b128 v[24:27], v3 offset:21504
    s_waitcnt vmcnt(6) lgkmcnt(6)
    v_mfma_f32_16x16x32_bf16 v[48:51], v[160:163], v[28:31], v[48:51]
    v_mfma_f32_16x16x32_bf16 v[52:55], v[240:243], v[28:31], v[52:55]
    ds_read_b128 v[28:31], v3 offset:41984
    s_waitcnt lgkmcnt(6)
    v_mfma_f32_16x16x32_bf16 v[56:59], v[160:163], v[32:35], v[56:59]
    v_mfma_f32_16x16x32_bf16 v[60:63], v[240:243], v[32:35], v[60:63]
    ds_read_b128 v[32:35], v3 offset:62464
    s_waitcnt lgkmcnt(6)
    v_mfma_f32_16x16x32_bf16 v[64:67], v[160:163], v[36:39], v[64:67]
    v_mfma_f32_16x16x32_bf16 v[68:71], v[240:243], v[36:39], v[68:71]
    v_add_u32 v6, 81920, v3
    ds_read_b128 v[36:39], v6 offset:1024
    s_waitcnt lgkmcnt(6)
    v_mfma_f32_16x16x32_bf16 v[72:75], v[160:163], v[40:43], v[72:75]
    v_mfma_f32_16x16x32_bf16 v[76:79], v[240:243], v[40:43], v[76:79]
    ds_read_b128 v[40:43], v4 offset:1024
    s_waitcnt lgkmcnt(6)
    v_mfma_f32_16x16x32_bf16 v[80:83], v[160:163], v[16:19], v[80:83]
    v_mfma_f32_16x16x32_bf16 v[84:87], v[240:243], v[16:19], v[84:87]
    ds_read_b128 v[16:19], v4 offset:21504
    s_waitcnt vmcnt(4) lgkmcnt(6)
    v_mfma_f32_16x16x32_bf16 v[48:51], v[164:167], v[20:23], v[48:51]
    v_mfma_f32_16x16x32_bf16 v[52:55], v[244:247], v[20:23], v[52:55]
    ds_read_b128 v[20:23], v4 offset:41984
    s_waitcnt lgkmcnt(6)
    v_mfma_f32_16x16x32_bf16 v[56:59], v[164:167], v[24:27], v[56:59]
    v_mfma_f32_16x16x32_bf16 v[60:63], v[244:247], v[24:27], v[60:63]
    ds_read_b128 v[24:27], v4 offset:62464
    s_waitcnt lgkmcnt(6)
    v_mfma_f32_16x16x32_bf16 v[64:67], v[164:167], v[28:31], v[64:67]
    v_mfma_f32_16x16x32_bf16 v[68:71], v[244:247], v[28:31], v[68:71]
    v_add_u32 v6, 81920, v4
    ds_read_b128 v[28:31], v6 offset:1024
    s_waitcnt lgkmcnt(6)
    v_mfma_f32_16x16x32_bf16 v[72:75], v[164:167], v[32:35], v[72:75]
    v_mfma_f32_16x16x32_bf16 v[76:79], v[244:247], v[32:35], v[76:79]
    ds_read_b128 v[32:35], v5 offset:1024
    s_waitcnt lgkmcnt(6)
    v_mfma_f32_16x16x32_bf16 v[80:83], v[164:167], v[36:39], v[80:83]
    v_mfma_f32_16x16x32_bf16 v[84:87], v[244:247], v[36:39], v[84:87]
    ds_read_b128 v[36:39], v5 offset:21504
    s_waitcnt vmcnt(2) lgkmcnt(6)
    v_mfma_f32_16x16x32_bf16 v[48:51], v[168:171], v[40:43], v[48:51]
    v_mfma_f32_16x16x32_bf16 v[52:55], v[248:251], v[40:43], v[52:55]
    ds_read_b128 v[40:43], v5 offset:41984
    s_waitcnt lgkmcnt(6)
    v_mfma_f32_16x16x32_bf16 v[56:59], v[168:171], v[16:19], v[56:59]
    v_mfma_f32_16x16x32_bf16 v[60:63], v[248:251], v[16:19], v[60:63]
    ds_read_b128 v[16:19], v5 offset:62464
    s_waitcnt lgkmcnt(6)
    v_mfma_f32_16x16x32_bf16 v[64:67], v[168:171], v[20:23], v[64:67]
    v_mfma_f32_16x16x32_bf16 v[68:71], v[248:251], v[20:23], v[68:71]
    v_add_u32 v6, 81920, v5
    ds_read_b128 v[20:23], v6 offset:1024
    s_waitcnt lgkmcnt(6)
    v_mfma_f32_16x16x32_bf16 v[72:75], v[168:171], v[24:27], v[72:75]
    v_mfma_f32_16x16x32_bf16 v[76:79], v[248:251], v[24:27], v[76:79]
    s_waitcnt lgkmcnt(5)
    v_mfma_f32_16x16x32_bf16 v[80:83], v[168:171], v[28:31], v[80:83]
    v_mfma_f32_16x16x32_bf16 v[84:87], v[248:251], v[28:31], v[84:87]
    s_waitcnt vmcnt(0) lgkmcnt(4)
    v_mfma_f32_16x16x32_bf16 v[48:51], v[172:175], v[32:35], v[48:51]
    v_mfma_f32_16x16x32_bf16 v[52:55], v[252:255], v[32:35], v[52:55]
    s_waitcnt lgkmcnt(3)
    v_mfma_f32_16x16x32_bf16 v[56:59], v[172:175], v[36:39], v[56:59]
    v_mfma_f32_16x16x32_bf16 v[60:63], v[252:255], v[36:39], v[60:63]
    s_waitcnt lgkmcnt(2)
    v_mfma_f32_16x16x32_bf16 v[64:67], v[172:175], v[40:43], v[64:67]
    v_mfma_f32_16x16x32_bf16 v[68:71], v[252:255], v[40:43], v[68:71]
    s_waitcnt lgkmcnt(1)
    v_mfma_f32_16x16x32_bf16 v[72:75], v[172:175], v[16:19], v[72:75]
    v_mfma_f32_16x16x32_bf16 v[76:79], v[252:255], v[16:19], v[76:79]
    s_waitcnt lgkmcnt(0)
    v_mfma_f32_16x16x32_bf16 v[80:83], v[172:175], v[20:23], v[80:83]
    v_mfma_f32_16x16x32_bf16 v[84:87], v[252:255], v[20:23], v[84:87]
    ds_read_b64_tr_b16 v[10:11], v7
    ds_read_b64_tr_b16 v[12:13], v8
    ds_read_b64_tr_b16 v[14:15], v9
    v_and_b32 v16, 15, v1
    v_lshrrev_b32 v17, 4, v1
    s_lshl_b32 s42, s3, 7
    s_add_u32 s42, s42, 46016
    v_lshl_add_u32 v19, v17, 4, s42
    s_mov_b64 exec, 0x10001
    s_mov_b32 exec_hi, 0x10001
    ds_write_b128 v19, v[48:51] offset:0
    ds_write_b128 v19, v[52:55] offset:64
    s_mov_b64 exec, -1
    s_lshl_b32 s42, s3, 6
    s_cmp_eq_u32 s3, 2
    s_cselect_b32 s42, 192, s42
    s_cmp_eq_u32 s3, 3
    s_cselect_b32 s42, 128, s42
    s_add_u32 s42, s42, 61440
    v_mul_u32_u24 v20, 496, v16
    v_lshl_add_u32 v20, v17, 4, v20
    v_add_u32 v20, s42, v20
    v_lshlrev_b32 v18, 3, v16
    v_add_u32 v18, 45376, v18
    s_waitcnt lgkmcnt(0)
    s_barrier
    ds_read_b64 v[24:25], v18 offset:0
    ds_read_b64 v[26:27], v18 offset:128
    ds_read_b64 v[28:29], v18 offset:256
    ds_read_b64 v[30:31], v18 offset:384
    ds_read_b64 v[32:33], v18 offset:512
    ds_read_b128 v[36:39], v19 offset:0
    ds_read_b128 v[40:43], v19 offset:64
    s_waitcnt lgkmcnt(0)
    v_fma_f32 v48, -v24, v36, v48
    v_fma_f32 v49, -v24, v37, v49
    v_fma_f32 v50, -v24, v38, v50
    v_fma_f32 v51, -v24, v39, v51
    v_fma_f32 v52, -v24, v40, v52
    v_fma_f32 v53, -v24, v41, v53
    v_fma_f32 v54, -v24, v42, v54
    v_fma_f32 v55, -v24, v43, v55
    v_fma_f32 v56, -v26, v36, v56
    v_fma_f32 v57, -v26, v37, v57
    v_fma_f32 v58, -v26, v38, v58
    v_fma_f32 v59, -v26, v39, v59
    v_fma_f32 v60, -v26, v40, v60
    v_fma_f32 v61, -v26, v41, v61
    v_fma_f32 v62, -v26, v42, v62
    v_fma_f32 v63, -v26, v43, v63
    v_fma_f32 v64, -v28, v36, v64
    v_fma_f32 v65, -v28, v37, v65
    v_fma_f32 v66, -v28, v38, v66
    v_fma_f32 v67, -v28, v39, v67
    v_fma_f32 v68, -v28, v40, v68
    v_fma_f32 v69, -v28, v41, v69
    v_fma_f32 v70, -v28, v42, v70
    v_fma_f32 v71, -v28, v43, v71
    v_fma_f32 v72, -v30, v36, v72
    v_fma_f32 v73, -v30, v37, v73
    v_fma_f32 v74, -v30, v38, v74
    v_fma_f32 v75, -v30, v39, v75
    v_fma_f32 v76, -v30, v40, v76
    v_fma_f32 v77, -v30, v41, v77
    v_fma_f32 v78, -v30, v42, v78
    v_fma_f32 v79, -v30, v43, v79
    v_fma_f32 v80, -v32, v36, v80
    v_fma_f32 v81, -v32, v37, v81
    v_fma_f32 v82, -v32, v38, v82
    v_fma_f32 v83, -v32, v39, v83
    v_fma_f32 v84, -v32, v40, v84
    v_fma_f32 v85, -v32, v41, v85
    v_fma_f32 v86, -v32, v42, v86
    v_fma_f32 v87, -v32, v43, v87
    v_mul_f32 v48, v48, v25
    v_mul_f32 v49, v49, v25
    v_mul_f32 v50, v50, v25
    v_mul_f32 v51, v51, v25
    v_mul_f32 v52, v52, v25
    v_mul_f32 v53, v53, v25
    v_mul_f32 v54, v54, v25
    v_mul_f32 v55, v55, v25
    v_mul_f32 v56, v56, v27
    v_mul_f32 v57, v57, v27
    v_mul_f32 v58, v58, v27
    v_mul_f32 v59, v59, v27
    v_mul_f32 v60, v60, v27
    v_mul_f32 v61, v61, v27
    v_mul_f32 v62, v62, v27
    v_mul_f32 v63, v63, v27
    v_mul_f32 v64, v64, v29
    v_mul_f32 v65, v65, v29
    v_mul_f32 v66, v66, v29
    v_mul_f32 v67, v67, v29
    v_mul_f32 v68, v68, v29
    v_mul_f32 v69, v69, v29
    v_mul_f32 v70, v70, v29
    v_mul_f32 v71, v71, v29
    v_mul_f32 v72, v72, v31
    v_mul_f32 v73, v73, v31
    v_mul_f32 v74, v74, v31
    v_mul_f32 v75, v75, v31
    v_mul_f32 v76, v76, v31
    v_mul_f32 v77, v77, v31
    v_mul_f32 v78, v78, v31
    v_mul_f32 v79, v79, v31
    v_mul_f32 v80, v80, v33
    v_mul_f32 v81, v81, v33
    v_mul_f32 v82, v82, v33
    v_mul_f32 v83, v83, v33
    v_mul_f32 v84, v84, v33
    v_mul_f32 v85, v85, v33
    v_mul_f32 v86, v86, v33
    v_mul_f32 v87, v87, v33
    v_cvt_pk_bf16_f32 v48, v48, v52
    v_cvt_pk_bf16_f32 v49, v49, v53
    v_cvt_pk_bf16_f32 v50, v50, v54
    v_cvt_pk_bf16_f32 v51, v51, v55
    ds_write_b128 v20, v[48:51] offset:0
    v_cvt_pk_bf16_f32 v56, v56, v60
    v_cvt_pk_bf16_f32 v57, v57, v61
    v_cvt_pk_bf16_f32 v58, v58, v62
    v_cvt_pk_bf16_f32 v59, v59, v63
    ds_write_b128 v20, v[56:59] offset:7936
    v_cvt_pk_bf16_f32 v64, v64, v68
    v_cvt_pk_bf16_f32 v65, v65, v69
    v_cvt_pk_bf16_f32 v66, v66, v70
    v_cvt_pk_bf16_f32 v67, v67, v71
    ds_write_b128 v20, v[64:67] offset:15872
    v_cvt_pk_bf16_f32 v72, v72, v76
    v_cvt_pk_bf16_f32 v73, v73, v77
    v_cvt_pk_bf16_f32 v74, v74, v78
    v_cvt_pk_bf16_f32 v75, v75, v79
    ds_write_b128 v20, v[72:75] offset:23808
    v_cvt_pk_bf16_f32 v80, v80, v84
    v_cvt_pk_bf16_f32 v81, v81, v85
    v_cvt_pk_bf16_f32 v82, v82, v86
    v_cvt_pk_bf16_f32 v83, v83, v87
    ds_write_b128 v20, v[80:83] offset:31744
    s_branch L_a1_post
L_g1A:
    global_load_dwordx4 v[96:99], v44, s[48:49] sc1
    global_load_dwordx4 v[176:179], v44, s[50:51] sc1
    global_load_dwordx4 v[100:103], v45, s[48:49] sc1
    global_load_dwordx4 v[180:183], v45, s[50:51] sc1
    global_load_dwordx4 v[104:107], v46, s[48:49] sc1
    global_load_dwordx4 v[184:187], v46, s[50:51] sc1
    global_load_dwordx4 v[108:111], v47, s[48:49] sc1
    global_load_dwordx4 v[188:191], v47, s[50:51] sc1
    s_add_u32 s48, s48, 4096
    s_addc_u32 s49, s49, 0
    s_add_u32 s50, s50, 4096
    s_addc_u32 s51, s51, 0
    s_waitcnt lgkmcnt(0)
    s_barrier
    global_load_dwordx4 v[112:115], v44, s[48:49] sc1
    global_load_dwordx4 v[192:195], v44, s[50:51] sc1
    global_load_dwordx4 v[116:119], v45, s[48:49] sc1
    global_load_dwordx4 v[196:199], v45, s[50:51] sc1
    global_load_dwordx4 v[120:123], v46, s[48:49] sc1
    global_load_dwordx4 v[200:203], v46, s[50:51] sc1
    global_load_dwordx4 v[124:127], v47, s[48:49] sc1
    global_load_dwordx4 v[204:207], v47, s[50:51] sc1
    s_add_u32 s48, s48, 4096
    s_addc_u32 s49, s49, 0
    s_add_u32 s50, s50, 4096
    s_addc_u32 s51, s51, 0
    ds_read_b128 v[16:19], v2 offset:0
    ds_read_b128 v[20:23], v2 offset:20480
    ds_read_b128 v[24:27], v2 offset:40960
    ds_read_b128 v[28:31], v2 offset:61440
    v_add_u32 v6, 81920, v2
    ds_read_b128 v[32:35], v6 offset:0
    ds_read_b128 v[36:39], v3 offset:0
    global_load_dwordx4 v[128:131], v44, s[48:49] sc1
    global_load_dwordx4 v[208:211], v44, s[50:51] sc1
    ds_read_b128 v[40:43], v3 offset:20480
    s_waitcnt vmcnt(16) lgkmcnt(6)
    v_mfma_f32_16x16x32_bf16 v[48:51], v[96:99], v[16:19], 0
    v_mfma_f32_16x16x32_bf16 v[52:55], v[176:179], v[16:19], 0
    ds_read_b128 v[16:19], v3 offset:40960
    s_waitcnt lgkmcnt(6)
    v_mfma_f32_16x16x32_bf16 v[56:59], v[96:99], v[20:23], 0
    v_mfma_f32_16x16x32_bf16 v[60:63], v[176:179], v[20:23], 0
    v_mfma_f32_16x16x32_bf16 v[64:67], v[20:23], v[20:23], 0
    v_mfma_f32_16x16x32_bf16 v[68:71], v[10:13], v[20:23], 0
    ds_read_b128 v[20:23], v3 offset:61440
    s_waitcnt lgkmcnt(6)
    v_mfma_f32_16x16x32_bf16 v[72:75], v[96:99], v[24:27], 0
    v_mfma_f32_16x16x32_bf16 v[76:79], v[176:179], v[24:27], 0
    v_add_u32 v6, 81920, v3
    ds_read_b128 v[24:27], v6 offset:0
    s_waitcnt lgkmcnt(6)
    v_mfma_f32_16x16x32_bf16 v[80:83], v[96:99], v[28:31], 0
    v_mfma_f32_16x16x32_bf16 v[84:87], v[176:179], v[28:31], 0
    ds_read_b128 v[28:31], v4 offset:0
    s_waitcnt lgkmcnt(6)
    v_mfma_f32_16x16x32_bf16 v[88:91], v[96:99], v[32:35], 0
    v_mfma_f32_16x16x32_bf16 v[92:95], v[176:179], v[32:35], 0
    global_load_dwordx4 v[132:135], v45, s[48:49] sc1
    global_load_dwordx4 v[212:215], v45, s[50:51] sc1
    ds_read_b128 v[32:35], v4 offset:20480
    s_waitcnt vmcnt(16) lgkmcnt(6)
    v_mfma_f32_16x16x32_bf16 v[48:51], v[100:103], v[36:39], v[48:51]
    v_mfma_f32_16x16x32_bf16 v[52:55], v[180:183], v[36:39], v[52:55]
    ds_read_b128 v[36:39], v4 offset:40960
    s_waitcnt lgkmcnt(6)
    v_mfma_f32_16x16x32_bf16 v[56:59], v[100:103], v[40:43], v[56:59]
    v_mfma_f32_16x16x32_bf16 v[60:63], v[180:183], v[40:43], v[60:63]
    v_mfma_f32_16x16x32_bf16 v[64:67], v[40:43], v[40:43], v[64:67]
    v_mfma_f32_16x16x32_bf16 v[68:71], v[10:13], v[40:43], v[68:71]
    ds_read_b128 v[40:43], v4 offset:61440
    s_waitcnt lgkmcnt(6)
    v_mfma_f32_16x16x32_bf16 v[72:75], v[100:103], v[16:19], v[72:75]
    v_mfma_f32_16x16x32_bf16 v[76:79], v[180:183], v[16:19], v[76:79]
    v_add_u32 v6, 81920, v4
    ds_read_b128 v[16:19], v6 offset:0
    s_waitcnt lgkmcnt(6)
    v_mfma_f32_16x16x32_bf16 v[80:83], v[100:103], v[20:23], v[80:83]
    v_mfma_f32_16x16x32_bf16 v[84:87], v[180:183], v[20:23], v[84:87]
    ds_read_b128 v[20:23], v5 offset:0
    s_waitcnt lgkmcnt(6)
    v_mfma_f32_16x16x32_bf16 v[88:91], v[100:103], v[24:27], v[88:91]
    v_mfma_f32_16x16x32_bf16 v[92:95], v[180:183], v[24:27], v[92:95]
    global_load_dwordx4 v[136:139], v46, s[48:49] sc1
    global_load_dwordx4 v[216:219], v46, s[50:51] sc1
    ds_read_b128 v[24:27], v5 offset:20480
    s_waitcnt vmcnt(16) lgkmcnt(6)
    v_mfma_f32_16x16x32_bf16 v[48:51], v[104:107], v[28:31], v[48:51]
    v_mfma_f32_16x16x32_bf16 v[52:55], v[184:187], v[28:31], v[52:55]
    ds_read_b128 v[28:31], v5 offset:40960
    s_waitcnt lgkmcnt(6)
    v_mfma_f32_16x16x32_bf16 v[56:59], v[104:107], v[32:35], v[56:59]
    v_mfma_f32_16x16x32_bf16 v[60:63], v[184:187], v[32:35], v[60:63]
    v_mfma_f32_16x16x32_bf16 v[64:67], v[32:35], v[32:35], v[64:67]
    v_mfma_f32_16x16x32_bf16 v[68:71], v[10:13], v[32:35], v[68:71]
    ds_read_b128 v[32:35], v5 offset:61440
    s_waitcnt lgkmcnt(6)
    v_mfma_f32_16x16x32_bf16 v[72:75], v[104:107], v[36:39], v[72:75]
    v_mfma_f32_16x16x32_bf16 v[76:79], v[184:187], v[36:39], v[76:79]
    v_add_u32 v6, 81920, v5
    ds_read_b128 v[36:39], v6 offset:0
    s_waitcnt lgkmcnt(6)
    v_mfma_f32_16x16x32_bf16 v[80:83], v[104:107], v[40:43], v[80:83]
    v_mfma_f32_16x16x32_bf16 v[84:87], v[184:187], v[40:43], v[84:87]
    ds_read_b128 v[40:43], v2 offset:256
    s_waitcnt lgkmcnt(6)
    v_mfma_f32_16x16x32_bf16 v[88:91], v[104:107], v[16:19], v[88:91]
    v_mfma_f32_16x16x32_bf16 v[92:95], v[184:187], v[16:19], v[92:95]
    global_load_dwordx4 v[140:143], v47, s[48:49] sc1
    global_load_dwordx4 v[220:223], v47, s[50:51] sc1
    s_add_u32 s48, s48, 4096
    s_addc_u32 s49, s49, 0
    s_add_u32 s50, s50, 4096
    s_addc_u32 s51, s51, 0
    ds_read_b128 v[16:19], v2 offset:20736
    s_waitcnt vmcnt(16) lgkmcnt(6)
    v_mfma_f32_16x16x32_bf16 v[48:51], v[108:111], v[20:23], v[48:51]
    v_mfma_f32_16x16x32_bf16 v[52:55], v[188:191], v[20:23], v[52:55]
    ds_read_b128 v[20:23], v2 offset:41216
    s_waitcnt lgkmcnt(6)
    v_mfma_f32_16x16x32_bf16 v[56:59], v[108:111], v[24:27], v[56:59]
    v_mfma_f32_16x16x32_bf16 v[60:63], v[188:191], v[24:27], v[60:63]
    v_mfma_f32_16x16x32_bf16 v[64:67], v[24:27], v[24:27], v[64:67]
    v_mfma_f32_16x16x32_bf16 v[68:71], v[10:13], v[24:27], v[68:71]
    ds_read_b128 v[24:27], v2 offset:61696
    s_waitcnt lgkmcnt(6)
    v_mfma_f32_16x16x32_bf16 v[72:75], v[108:111], v[28:31], v[72:75]
    v_mfma_f32_16x16x32_bf16 v[76:79], v[188:191], v[28:31], v[76:79]
    v_add_u32 v6, 81920, v2
    ds_read_b128 v[28:31], v6 offset:256
    s_waitcnt lgkmcnt(6)
    v_mfma_f32_16x16x32_bf16 v[80:83], v[108:111], v[32:35], v[80:83]
    v_mfma_f32_16x16x32_bf16 v[84:87], v[188:191], v[32:35], v[84:87]
    ds_read_b128 v[32:35], v3 offset:256
    s_waitcnt lgkmcnt(6)
    v_mfma_f32_16x16x32_bf16 v[88:91], v[108:111], v[36:39], v[88:91]
    v_mfma_f32_16x16x32_bf16 v[92:95], v[188:191], v[36:39], v[92:95]
    global_load_dwordx4 v[144:147], v44, s[48:49] sc1
    global_load_dwordx4 v[224:227], v44, s[50:51] sc1
    ds_read_b128 v[36:39], v3 offset:20736
    s_waitcnt vmcnt(16) lgkmcnt(6)
    v_mfma_f32_16x16x32_bf16 v[48:51], v[112:115], v[40:43], v[48:51]
    v_mfma_f32_16x16x32_bf16 v[52:55], v[192:195], v[40:43], v[52:55]
    ds_read_b128 v[40:43], v3 offset:41216
    s_waitcnt lgkmcnt(6)
    v_mfma_f32_16x16x32_bf16 v[56:59], v[112:115], v[16:19], v[56:59]
    v_mfma_f32_16x16x32_bf16 v[60:63], v[192:195], v[16:19], v[60:63]
    v_mfma_f32_16x16x32_bf16 v[64:67], v[16:19], v[16:19], v[64:67]
    v_mfma_f32_16x16x32_bf16 v[68:71], v[10:13], v[16:19], v[68:71]
    ds_read_b128 v[16:19], v3 offset:61696
    s_waitcnt lgkmcnt(6)
    v_mfma_f32_16x16x32_bf16 v[72:75], v[112:115], v[20:23], v[72:75]
    v_mfma_f32_16x16x32_bf16 v[76:79], v[192:195], v[20:23], v[76:79]
    v_add_u32 v6, 81920, v3
    ds_read_b128 v[20:23], v6 offset:256
    s_waitcnt lgkmcnt(6)
    v_mfma_f32_16x16x32_bf16 v[80:83], v[112:115], v[24:27], v[80:83]
    v_mfma_f32_16x16x32_bf16 v[84:87], v[192:195], v[24:27], v[84:87]
    ds_read_b128 v[24:27], v4 offset:256
    s_waitcnt lgkmcnt(6)
    v_mfma_f32_16x16x32_bf16 v[88:91], v[112:115], v[28:31], v[88:91]
    v_mfma_f32_16x16x32_bf16 v[92:95], v[192:195], v[28:31], v[92:95]
    global_load_dwordx4 v[148:151], v45, s[48:49] sc1
    global_load_dwordx4 v[228:231], v45, s[50:51] sc1
    ds_read_b128 v[28:31], v4 offset:20736
    s_waitcnt vmcnt(16) lgkmcnt(6)
    v_mfma_f32_16x16x32_bf16 v[48:51], v[116:119], v[32:35], v[48:51]
    v_mfma_f32_16x16x32_bf16 v[52:55], v[196:199], v[32:35], v[52:55]
    ds_read_b128 v[32:35], v4 offset:41216
    s_waitcnt lgkmcnt(6)
    v_mfma_f32_16x16x32_bf16 v[56:59], v[116:119], v[36:39], v[56:59]
    v_mfma_f32_16x16x32_bf16 v[60:63], v[196:199], v[36:39], v[60:63]
    v_mfma_f32_16x16x32_bf16 v[64:67], v[36:39], v[36:39], v[64:67]
    v_mfma_f32_16x16x32_bf16 v[68:71], v[10:13], v[36:39], v[68:71]
    ds_read_b128 v[36:39], v4 offset:61696
    s_waitcnt lgkmcnt(6)
    v_mfma_f32_16x16x32_bf16 v[72:75], v[116:119], v[40:43], v[72:75]
    v_mfma_f32_16x16x32_bf16 v[76:79], v[196:199], v[40:43], v[76:79]
    v_add_u32 v6, 81920, v4
    ds_read_b128 v[40:43], v6 offset:256
    s_waitcnt lgkmcnt(6)
    v_mfma_f32_16x16x32_bf16 v[80:83], v[116:119], v[16:19], v[80:83]
    v_mfma_f32_16x16x32_bf16 v[84:87], v[196:199], v[16:19], v[84:87]
    ds_read_b128 v[16:19], v5 offset:256
    s_waitcnt lgkmcnt(6)
    v_mfma_f32_16x16x32_bf16 v[88:91], v[116:119], v[20:23], v[88:91]
    v_mfma_f32_16x16x32_bf16 v[92:95], v[196:199], v[20:23], v[92:95]
    global_load_dwordx4 v[152:155], v46, s[48:49] sc1
    global_load_dwordx4 v[232:235], v46, s[50:51] sc1
    ds_read_b128 v[20:23], v5 offset:20736
    s_waitcnt vmcnt(16) lgkmcnt(6)
    v_mfma_f32_16x16x32_bf16 v[48:51], v[120:123], v[24:27], v[48:51]
    v_mfma_f32_16x16x32_bf16 v[52:55], v[200:203], v[24:27], v[52:55]
    ds_read_b128 v[24:27], v5 offset:41216
    s_waitcnt lgkmcnt(6)
    v_mfma_f32_16x16x32_bf16 v[56:59], v[120:123], v[28:31], v[56:59]
    v_mfma_f32_16x16x32_bf16 v[60:63], v[200:203], v[28:31], v[60:63]
    v_mfma_f32_16x16x32_bf16 v[64:67], v[28:31], v[28:31], v[64:67]
    v_mfma_f32_16x16x32_bf16 v[68:71], v[10:13], v[28:31], v[68:71]
    ds_read_b128 v[28:31], v5 offset:61696
    s_waitcnt lgkmcnt(6)
    v_mfma_f32_16x16x32_bf16 v[72:75], v[120:123], v[32:35], v[72:75]
    v_mfma_f32_16x16x32_bf16 v[76:79], v[200:203], v[32:35], v[76:79]
    v_add_u32 v6, 81920, v5
    ds_read_b128 v[32:35], v6 offset:256
    s_waitcnt lgkmcnt(6)
    v_mfma_f32_16x16x32_bf16 v[80:83], v[120:123], v[36:39], v[80:83]
    v_mfma_f32_16x16x32_bf16 v[84:87], v[200:203], v[36:39], v[84:87]
    ds_read_b128 v[36:39], v2 offset:512
    s_waitcnt lgkmcnt(6)
    v_mfma_f32_16x16x32_bf16 v[88:91], v[120:123], v[40:43], v[88:91]
    v_mfma_f32_16x16x32_bf16 v[92:95], v[200:203], v[40:43], v[92:95]
    global_load_dwordx4 v[156:159], v47, s[48:49] sc1
    global_load_dwordx4 v[236:239], v47, s[50:51] sc1
    s_add_u32 s48, s48, 4096
    s_addc_u32 s49, s49, 0
    s_add_u32 s50, s50, 4096
    s_addc_u32 s51, s51, 0
    ds_read_b128 v[40:43], v2 offset:20992
    s_waitcnt vmcnt(16) lgkmcnt(6)
    v_mfma_f32_16x16x32_bf16 v[48:51], v[124:127], v[16:19], v[48:51]
    v_mfma_f32_16x16x32_bf16 v[52:55], v[204:207], v[16:19], v[52:55]
    ds_read_b128 v[16:19], v2 offset:41472
    s_waitcnt lgkmcnt(6)
    v_mfma_f32_16x16x32_bf16 v[56:59], v[124:127], v[20:23], v[56:59]
    v_mfma_f32_16x16x32_bf16 v[60:63], v[204:207], v[20:23], v[60:63]
    v_mfma_f32_16x16x32_bf16 v[64:67], v[20:23], v[20:23], v[64:67]
    v_mfma_f32_16x16x32_bf16 v[68:71], v[10:13], v[20:23], v[68:71]
    ds_read_b128 v[20:23], v2 offset:61952
    s_waitcnt lgkmcnt(6)
    v_mfma_f32_16x16x32_bf16 v[72:75], v[124:127], v[24:27], v[72:75]
    v_mfma_f32_16x16x32_bf16 v[76:79], v[204:207], v[24:27], v[76:79]
    v_add_u32 v6, 81920, v2
    ds_read_b128 v[24:27], v6 offset:512
    s_waitcnt lgkmcnt(6)
    v_mfma_f32_16x16x32_bf16 v[80:83], v[124:127], v[28:31], v[80:83]
    v_mfma_f32_16x16x32_bf16 v[84:87], v[204:207], v[28:31], v[84:87]
    ds_read_b128 v[28:31], v3 offset:512
    s_waitcnt lgkmcnt(6)
    v_mfma_f32_16x16x32_bf16 v[88:91], v[124:127], v[32:35], v[88:91]
    v_mfma_f32_16x16x32_bf16 v[92:95], v[204:207], v[32:35], v[92:95]
    global_load_dwordx4 v[160:163], v44, s[48:49] sc1
    global_load_dwordx4 v[240:243], v44, s[50:51] sc1
    ds_read_b128 v[32:35], v3 offset:20992
    s_waitcnt vmcnt(16) lgkmcnt(6)
    v_mfma_f32_16x16x32_bf16 v[48:51], v[128:131], v[36:39], v[48:51]
    v_mfma_f32_16x16x32_bf16 v[52:55], v[208:211], v[36:39], v[52:55]
    ds_read_b128 v[36:39], v3 offset:41472
    s_waitcnt lgkmcnt(6)
    v_mfma_f32_16x16x32_bf16 v[56:59], v[128:131], v[40:43], v[56:59]
    v_mfma_f32_16x16x32_bf16 v[60:63], v[208:211], v[40:43], v[60:63]
    v_mfma_f32_16x16x32_bf16 v[64:67], v[40:43], v[40:43], v[64:67]
    v_mfma_f32_16x16x32_bf16 v[68:71], v[10:13], v[40:43], v[68:71]
    ds_read_b128 v[40:43], v3 offset:61952
    s_waitcnt lgkmcnt(6)
    v_mfma_f32_16x16x32_bf16 v[72:75], v[128:131], v[16:19], v[72:75]
    v_mfma_f32_16x16x32_bf16 v[76:79], v[208:211], v[16:19], v[76:79]
    v_add_u32 v6, 81920, v3
    ds_read_b128 v[16:19], v6 offset:512
    s_waitcnt lgkmcnt(6)
    v_mfma_f32_16x16x32_bf16 v[80:83], v[128:131], v[20:23], v[80:83]
    v_mfma_f32_16x16x32_bf16 v[84:87], v[208:211], v[20:23], v[84:87]
    ds_read_b128 v[20:23], v4 offset:512
    s_waitcnt lgkmcnt(6)
    v_mfma_f32_16x16x32_bf16 v[88:91], v[128:131], v[24:27], v[88:91]
    v_mfma_f32_16x16x32_bf16 v[92:95], v[208:211], v[24:27], v[92:95]
    global_load_dwordx4 v[164:167], v45, s[48:49] sc1
    global_load_dwordx4 v[244:247], v45, s[50:51] sc1
    ds_read_b128 v[24:27], v4 offset:20992
    s_waitcnt vmcnt(16) lgkmcnt(6)
    v_mfma_f32_16x16x32_bf16 v[48:51], v[132:135], v[28:31], v[48:51]
    v_mfma_f32_16x16x32_bf16 v[52:55], v[212:215], v[28:31], v[52:55]
    ds_read_b128 v[28:31], v4 offset:41472
    s_waitcnt lgkmcnt(6)
    v_mfma_f32_16x16x32_bf16 v[56:59], v[132:135], v[32:35], v[56:59]
    v_mfma_f32_16x16x32_bf16 v[60:63], v[212:215], v[32:35], v[60:63]
    v_mfma_f32_16x16x32_bf16 v[64:67], v[32:35], v[32:35], v[64:67]
    v_mfma_f32_16x16x32_bf16 v[68:71], v[10:13], v[32:35], v[68:71]
    ds_read_b128 v[32:35], v4 offset:61952
    s_waitcnt lgkmcnt(6)
    v_mfma_f32_16x16x32_bf16 v[72:75], v[132:135], v[36:39], v[72:75]
    v_mfma_f32_16x16x32_bf16 v[76:79], v[212:215], v[36:39], v[76:79]
    v_add_u32 v6, 81920, v4
    ds_read_b128 v[36:39], v6 offset:512
    s_waitcnt lgkmcnt(6)
    v_mfma_f32_16x16x32_bf16 v[80:83], v[132:135], v[40:43], v[80:83]
    v_mfma_f32_16x16x32_bf16 v[84:87], v[212:215], v[40:43], v[84:87]
    ds_read_b128 v[40:43], v5 offset:512
    s_waitcnt lgkmcnt(6)
    v_mfma_f32_16x16x32_bf16 v[88:91], v[132:135], v[16:19], v[88:91]
    v_mfma_f32_16x16x32_bf16 v[92:95], v[212:215], v[16:19], v[92:95]
    global_load_dwordx4 v[168:171], v46, s[48:49] sc1
    global_load_dwordx4 v[248:251], v46, s[50:51] sc1
    ds_read_b128 v[16:19], v5 offset:20992
    s_waitcnt vmcnt(16) lgkmcnt(6)
    v_mfma_f32_16x16x32_bf16 v[48:51], v[136:139], v[20:23], v[48:51]
    v_mfma_f32_16x16x32_bf16 v[52:55], v[216:219], v[20:23], v[52:55]
    ds_read_b128 v[20:23], v5 offset:41472
    s_waitcnt lgkmcnt(6)
    v_mfma_f32_16x16x32_bf16 v[56:59], v[136:139], v[24:27], v[56:59]
    v_mfma_f32_16x16x32_bf16 v[60:63], v[216:219], v[24:27], v[60:63]
    v_mfma_f32_16x16x32_bf16 v[64:67], v[24:27], v[24:27], v[64:67]
    v_mfma_f32_16x16x32_bf16 v[68:71], v[10:13], v[24:27], v[68:71]
    ds_read_b128 v[24:27], v5 offset:61952
    s_waitcnt lgkmcnt(6)
    v_mfma_f32_16x16x32_bf16 v[72:75], v[136:139], v[28:31], v[72:75]
    v_mfma_f32_16x16x32_bf16 v[76:79], v[216:219], v[28:31], v[76:79]
    v_add_u32 v6, 81920, v5
    ds_read_b128 v[28:31], v6 offset:512
    s_waitcnt lgkmcnt(6)
    v_mfma_f32_16x16x32_bf16 v[80:83], v[136:139], v[32:35], v[80:83]
    v_mfma_f32_16x16x32_bf16 v[84:87], v[216:219], v[32:35], v[84:87]
    ds_read_b128 v[32:35], v2 offset:768
    s_waitcnt lgkmcnt(6)
    v_mfma_f32_16x16x32_bf16 v[88:91], v[136:139], v[36:39], v[88:91]
    v_mfma_f32_16x16x32_bf16 v[92:95], v[216:219], v[36:39], v[92:95]
    global_load_dwordx4 v[172:175], v47, s[48:49] sc1
    global_load_dwordx4 v[252:255], v47, s[50:51] sc1
    ds_read_b128 v[36:39], v2 offset:21248
    s_waitcnt vmcnt(16) lgkmcnt(6)
    v_mfma_f32_16x16x32_bf16 v[48:51], v[140:143], v[40:43], v[48:51]
    v_mfma_f32_16x16x32_bf16 v[52:55], v[220:223], v[40:43], v[52:55]
    ds_read_b128 v[40:43], v2 offset:41728
    s_waitcnt lgkmcnt(6)
    v_mfma_f32_16x16x32_bf16 v[56:59], v[140:143], v[16:19], v[56:59]
    v_mfma_f32_16x16x32_bf16 v[60:63], v[220:223], v[16:19], v[60:63]
    v_mfma_f32_16x16x32_bf16 v[64:67], v[16:19], v[16:19], v[64:67]
    v_mfma_f32_16x16x32_bf16 v[68:71], v[10:13], v[16:19], v[68:71]
    ds_read_b128 v[16:19], v2 offset:62208
    s_waitcnt lgkmcnt(6)
    v_mfma_f32_16x16x32_bf16 v[72:75], v[140:143], v[20:23], v[72:75]
    v_mfma_f32_16x16x32_bf16 v[76:79], v[220:223], v[20:23], v[76:79]
    v_add_u32 v6, 81920, v2
    ds_read_b128 v[20:23], v6 offset:768
    s_waitcnt lgkmcnt(6)
    v_mfma_f32_16x16x32_bf16 v[80:83], v[140:143], v[24:27], v[80:83]
    v_mfma_f32_16x16x32_bf16 v[84:87], v[220:223], v[24:27], v[84:87]
    ds_read_b128 v[24:27], v3 offset:768
    s_waitcnt lgkmcnt(6)
    v_mfma_f32_16x16x32_bf16 v[88:91], v[140:143], v[28:31], v[88:91]
    v_mfma_f32_16x16x32_bf16 v[92:95], v[220:223], v[28:31], v[92:95]
    ds_read_b128 v[28:31], v3 offset:21248
    s_waitcnt vmcnt(14) lgkmcnt(6)
    v_mfma_f32_16x16x32_bf16 v[48:51], v[144:147], v[32:35], v[48:51]
    v_mfma_f32_16x16x32_bf16 v[52:55], v[224:227], v[32:35], v[52:55]
    ds_read_b128 v[32:35], v3 offset:41728
    s_waitcnt lgkmcnt(6)
    v_mfma_f32_16x16x32_bf16 v[56:59], v[144:147], v[36:39], v[56:59]
    v_mfma_f32_16x16x32_bf16 v[60:63], v[224:227], v[36:39], v[60:63]
    v_mfma_f32_16x16x32_bf16 v[64:67], v[36:39], v[36:39], v[64:67]
    v_mfma_f32_16x16x32_bf16 v[68:71], v[10:13], v[36:39], v[68:71]
    ds_read_b128 v[36:39], v3 offset:62208
    s_waitcnt lgkmcnt(6)
    v_mfma_f32_16x16x32_bf16 v[72:75], v[144:147], v[40:43], v[72:75]
    v_mfma_f32_16x16x32_bf16 v[76:79], v[224:227], v[40:43], v[76:79]
    v_add_u32 v6, 81920, v3
    ds_read_b128 v[40:43], v6 offset:768
    s_waitcnt lgkmcnt(6)
    v_mfma_f32_16x16x32_bf16 v[80:83], v[144:147], v[16:19], v[80:83]
    v_mfma_f32_16x16x32_bf16 v[84:87], v[224:227], v[16:19], v[84:87]
    ds_read_b128 v[16:19], v4 offset:768
    s_waitcnt lgkmcnt(6)
    v_mfma_f32_16x16x32_bf16 v[88:91], v[144:147], v[20:23], v[88:91]
    v_mfma_f32_16x16x32_bf16 v[92:95], v[224:227], v[20:23], v[92:95]
    ds_read_b128 v[20:23], v4 offset:21248
    s_waitcnt vmcnt(12) lgkmcnt(6)
    v_mfma_f32_16x16x32_bf16 v[48:51], v[148:151], v[24:27], v[48:51]
    v_mfma_f32_16x16x32_bf16 v[52:55], v[228:231], v[24:27], v[52:55]
    ds_read_b128 v[24:27], v4 offset:41728
    s_waitcnt lgkmcnt(6)
    v_mfma_f32_16x16x32_bf16 v[56:59], v[148:151], v[28:31], v[56:59]
    v_mfma_f32_16x16x32_bf16 v[60:63], v[228:231], v[28:31], v[60:63]
    v_mfma_f32_16x16x32_bf16 v[64:67], v[28:31], v[28:31], v[64:67]
    v_mfma_f32_16x16x32_bf16 v[68:71], v[10:13], v[28:31], v[68:71]
    ds_read_b128 v[28:31], v4 offset:62208
    s_waitcnt lgkmcnt(6)
    v_mfma_f32_16x16x32_bf16 v[72:75], v[148:151], v[32:35], v[72:75]
    v_mfma_f32_16x16x32_bf16 v[76:79], v[228:231], v[32:35], v[76:79]
    v_add_u32 v6, 81920, v4
    ds_read_b128 v[32:35], v6 offset:768
    s_waitcnt lgkmcnt(6)
    v_mfma_f32_16x16x32_bf16 v[80:83], v[148:151], v[36:39], v[80:83]
    v_mfma_f32_16x16x32_bf16 v[84:87], v[228:231], v[36:39], v[84:87]
    ds_read_b128 v[36:39], v5 offset:768
    s_waitcnt lgkmcnt(6)
    v_mfma_f32_16x16x32_bf16 v[88:91], v[148:151], v[40:43], v[88:91]
    v_mfma_f32_16x16x32_bf16 v[92:95], v[228:231], v[40:43], v[92:95]
    ds_read_b128 v[40:43], v5 offset:21248
    s_waitcnt vmcnt(10) lgkmcnt(6)
    v_mfma_f32_16x16x32_bf16 v[48:51], v[152:155], v[16:19], v[48:51]
    v_mfma_f32_16x16x32_bf16 v[52:55], v[232:235], v[16:19], v[52:55]
    ds_read_b128 v[16:19], v5 offset:41728
    s_waitcnt lgkmcnt(6)
    v_mfma_f32_16x16x32_bf16 v[56:59], v[152:155], v[20:23], v[56:59]
    v_mfma_f32_16x16x32_bf16 v[60:63], v[232:235], v[20:23], v[60:63]
    v_mfma_f32_16x16x32_bf16 v[64:67], v[20:23], v[20:23], v[64:67]
    v_mfma_f32_16x16x32_bf16 v[68:71], v[10:13], v[20:23], v[68:71]
    ds_read_b128 v[20:23], v5 offset:62208
    s_waitcnt lgkmcnt(6)
    v_mfma_f32_16x16x32_bf16 v[72:75], v[152:155], v[24:27], v[72:75]
    v_mfma_f32_16x16x32_bf16 v[76:79], v[232:235], v[24:27], v[76:79]
    v_add_u32 v6, 81920, v5
    ds_read_b128 v[24:27], v6 offset:768
    s_waitcnt lgkmcnt(6)
    v_mfma_f32_16x16x32_bf16 v[80:83], v[152:155], v[28:31], v[80:83]
    v_mfma_f32_16x16x32_bf16 v[84:87], v[232:235], v[28:31], v[84:87]
    ds_read_b128 v[28:31], v2 offset:1024
    s_waitcnt lgkmcnt(6)
    v_mfma_f32_16x16x32_bf16 v[88:91], v[152:155], v[32:35], v[88:91]
    v_mfma_f32_16x16x32_bf16 v[92:95], v[232:235], v[32:35], v[92:95]
    ds_read_b128 v[32:35], v2 offset:21504
    s_waitcnt vmcnt(8) lgkmcnt(6)
    v_mfma_f32_16x16x32_bf16 v[48:51], v[156:159], v[36:39], v[48:51]
    v_mfma_f32_16x16x32_bf16 v[52:55], v[236:239], v[36:39], v[52:55]
    ds_read_b128 v[36:39], v2 offset:41984
    s_waitcnt lgkmcnt(6)
    v_mfma_f32_16x16x32_bf16 v[56:59], v[156:159], v[40:43], v[56:59]
    v_mfma_f32_16x16x32_bf16 v[60:63], v[236:239], v[40:43], v[60:63]
    v_mfma_f32_16x16x32_bf16 v[64:67], v[40:43], v[40:43], v[64:67]
    v_mfma_f32_16x16x32_bf16 v[68:71], v[10:13], v[40:43], v[68:71]
    ds_read_b128 v[40:43], v2 offset:62464
    s_waitcnt lgkmcnt(6)
    v_mfma_f32_16x16x32_bf16 v[72:75], v[156:159], v[16:19], v[72:75]
    v_mfma_f32_16x16x32_bf16 v[76:79], v[236:239], v[16:19], v[76:79]
    v_add_u32 v6, 81920, v2
    ds_read_b128 v[16:19], v6 offset:1024
    s_waitcnt lgkmcnt(6)
    v_mfma_f32_16x16x32_bf16 v[80:83], v[156:159], v[20:23], v[80:83]
    v_mfma_f32_16x16x32_bf16 v[84:87], v[236:239], v[20:23], v[84:87]
    ds_read_b128 v[20:23], v3 offset:1024
    s_waitcnt lgkmcnt(6)
    v_mfma_f32_16x16x32_bf16 v[88:91], v[156:159], v[24:27], v[88:91]
    v_mfma_f32_16x16x32_bf16 v[92:95], v[236:239], v[24:27], v[92:95]
    ds_read_b128 v[24:27], v3 offset:21504
    s_waitcnt vmcnt(6) lgkmcnt(6)
    v_mfma_f32_16x16x32_bf16 v[48:51], v[160:163], v[28:31], v[48:51]
    v_mfma_f32_16x16x32_bf16 v[52:55], v[240:243], v[28:31], v[52:55]
    ds_read_b128 v[28:31], v3 offset:41984
    s_waitcnt lgkmcnt(6)
    v_mfma_f32_16x16x32_bf16 v[56:59], v[160:163], v[32:35], v[56:59]
    v_mfma_f32_16x16x32_bf16 v[60:63], v[240:243], v[32:35], v[60:63]
    v_mfma_f32_16x16x32_bf16 v[64:67], v[32:35], v[32:35], v[64:67]
    v_mfma_f32_16x16x32_bf16 v[68:71], v[10:13], v[32:35], v[68:71]
    ds_read_b128 v[32:35], v3 offset:62464
    s_waitcnt lgkmcnt(6)
    v_mfma_f32_16x16x32_bf16 v[72:75], v[160:163], v[36:39], v[72:75]
    v_mfma_f32_16x16x32_bf16 v[76:79], v[240:243], v[36:39], v[76:79]
    v_add_u32 v6, 81920, v3
    ds_read_b128 v[36:39], v6 offset:1024
    s_waitcnt lgkmcnt(6)
    v_mfma_f32_16x16x32_bf16 v[80:83], v[160:163], v[40:43], v[80:83]
    v_mfma_f32_16x16x32_bf16 v[84:87], v[240:243], v[40:43], v[84:87]
    ds_read_b128 v[40:43], v4 offset:1024
    s_waitcnt lgkmcnt(6)
    v_mfma_f32_16x16x32_bf16 v[88:91], v[160:163], v[16:19], v[88:91]
    v_mfma_f32_16x16x32_bf16 v[92:95], v[240:243], v[16:19], v[92:95]
    ds_read_b128 v[16:19], v4 offset:21504
    s_waitcnt vmcnt(4) lgkmcnt(6)
    v_mfma_f32_16x16x32_bf16 v[48:51], v[164:167], v[20:23], v[48:51]
    v_mfma_f32_16x16x32_bf16 v[52:55], v[244:247], v[20:23], v[52:55]
    ds_read_b128 v[20:23], v4 offset:41984
    s_waitcnt lgkmcnt(6)
    v_mfma_f32_16x16x32_bf16 v[56:59], v[164:167], v[24:27], v[56:59]
    v_mfma_f32_16x16x32_bf16 v[60:63], v[244:247], v[24:27], v[60:63]
    v_mfma_f32_16x16x32_bf16 v[64:67], v[24:27], v[24:27], v[64:67]
    v_mfma_f32_16x16x32_bf16 v[68:71], v[10:13], v[24:27], v[68:71]
    ds_read_b128 v[24:27], v4 offset:62464
    s_waitcnt lgkmcnt(6)
    v_mfma_f32_16x16x32_bf16 v[72:75], v[164:167], v[28:31], v[72:75]
    v_mfma_f32_16x16x32_bf16 v[76:79], v[244:247], v[28:31], v[76:79]
    v_add_u32 v6, 81920, v4
    ds_read_b128 v[28:31], v6 offset:1024
    s_waitcnt lgkmcnt(6)
    v_mfma_f32_16x16x32_bf16 v[80:83], v[164:167], v[32:35], v[80:83]
    v_mfma_f32_16x16x32_bf16 v[84:87], v[244:247], v[32:35], v[84:87]
    ds_read_b128 v[32:35], v5 offset:1024
    s_waitcnt lgkmcnt(6)
    v_mfma_f32_16x16x32_bf16 v[88:91], v[164:167], v[36:39], v[88:91]
    v_mfma_f32_16x16x32_bf16 v[92:95], v[244:247], v[36:39], v[92:95]
    ds_read_b128 v[36:39], v5 offset:21504
    s_waitcnt vmcnt(2) lgkmcnt(6)
    v_mfma_f32_16x16x32_bf16 v[48:51], v[168:171], v[40:43], v[48:51]
    v_mfma_f32_16x16x32_bf16 v[52:55], v[248:251], v[40:43], v[52:55]
    ds_read_b128 v[40:43], v5 offset:41984
    s_waitcnt lgkmcnt(6)
    v_mfma_f32_16x16x32_bf16 v[56:59], v[168:171], v[16:19], v[56:59]
    v_mfma_f32_16x16x32_bf16 v[60:63], v[248:251], v[16:19], v[60:63]
    v_mfma_f32_16x16x32_bf16 v[64:67], v[16:19], v[16:19], v[64:67]
    v_mfma_f32_16x16x32_bf16 v[68:71], v[10:13], v[16:19], v[68:71]
    ds_read_b128 v[16:19], v5 offset:62464
    s_waitcnt lgkmcnt(6)
    v_mfma_f32_16x16x32_bf16 v[72:75], v[168:171], v[20:23], v[72:75]
    v_mfma_f32_16x16x32_bf16 v[76:79], v[248:251], v[20:23], v[76:79]
    v_add_u32 v6, 81920, v5
    ds_read_b128 v[20:23], v6 offset:1024
    s_waitcnt lgkmcnt(6)
    v_mfma_f32_16x16x32_bf16 v[80:83], v[168:171], v[24:27], v[80:83]
    v_mfma_f32_16x16x32_bf16 v[84:87], v[248:251], v[24:27], v[84:87]
    s_waitcnt lgkmcnt(5)
    v_mfma_f32_16x16x32_bf16 v[88:91], v[168:171], v[28:31], v[88:91]
    v_mfma_f32_16x16x32_bf16 v[92:95], v[248:251], v[28:31], v[92:95]
    s_waitcnt vmcnt(0) lgkmcnt(4)
    v_mfma_f32_16x16x32_bf16 v[48:51], v[172:175], v[32:35], v[48:51]
    v_mfma_f32_16x16x32_bf16 v[52:55], v[252:255], v[32:35], v[52:55]
    s_waitcnt lgkmcnt(3)
    v_mfma_f32_16x16x32_bf16 v[56:59], v[172:175], v[36:39], v[56:59]
    v_mfma_f32_16x16x32_bf16 v[60:63], v[252:255], v[36:39], v[60:63]
    v_mfma_f32_16x16x32_bf16 v[64:67], v[36:39], v[36:39], v[64:67]
    v_mfma_f32_16x16x32_bf16 v[68:71], v[10:13], v[36:39], v[68:71]
    s_waitcnt lgkmcnt(2)
    v_mfma_f32_16x16x32_bf16 v[72:75], v[172:175], v[40:43], v[72:75]
    v_mfma_f32_16x16x32_bf16 v[76:79], v[252:255], v[40:43], v[76:79]
    s_waitcnt lgkmcnt(1)
    v_mfma_f32_16x16x32_bf16 v[80:83], v[172:175], v[16:19], v[80:83]
    v_mfma_f32_16x16x32_bf16 v[84:87], v[252:255], v[16:19], v[84:87]
    s_waitcnt lgkmcnt(0)
    v_mfma_f32_16x16x32_bf16 v[88:91], v[172:175], v[20:23], v[88:91]
    v_mfma_f32_16x16x32_bf16 v[92:95], v[252:255], v[20:23], v[92:95]
    ds_read_b64_tr_b16 v[10:11], v7
    ds_read_b64_tr_b16 v[12:13], v8
    ds_read_b64_tr_b16 v[14:15], v9
    v_and_b32 v16, 15, v1
    v_lshrrev_b32 v17, 4, v1
    v_and_b32 v18, 3, v1
    v_lshrrev_b32 v19, 2, v16
    v_cmp_eq_u32 s[42:43], 1, v18
    v_cmp_eq_u32 s[44:45], 2, v18
    v_cmp_eq_u32 s[46:47], 3, v18
    v_cmp_eq_u32 s[48:49], v19, v17
    v_lshlrev_b32 v18, 3, v16
    v_add_u32 v18, 45376, v18
    v_cndmask_b32 v64, v64, v65, s[42:43]
    v_cndmask_b32 v64, v64, v66, s[44:45]
    v_cndmask_b32 v64, v64, v67, s[46:47]
    v_mul_f32 v68, 0x3acccccd, v68
    v_mul_f32 v64, 0x3acccccd, v64
    v_fma_f32 v64, -v68, v68, v64
    v_max_f32 v64, 0, v64
    v_cvt_pk_bf16_f32 v68, v68, v64
    v_and_b32 v64, 0xffff0000, v68
    v_lshlrev_b32 v68, 16, v68
    v_add_f32 v64, 0x3727c5ac, v64
    v_cvt_pk_bf16_f32 v64, v64, v64
    v_lshlrev_b32 v64, 16, v64
    v_sqrt_f32 v64, v64
    s_nop 0
    v_cvt_pk_bf16_f32 v64, v64, v64
    v_lshlrev_b32 v64, 16, v64
    v_rcp_f32 v69, v64
    s_mov_b64 exec, s[48:49]
    ds_write_b64 v18, v[68:69] offset:128
    s_mov_b64 exec, -1
    s_lshl_b32 s42, s3, 7
    s_add_u32 s42, s42, 46016
    v_lshl_add_u32 v19, v17, 4, s42
    s_mov_b64 exec, 0x10001
    s_mov_b32 exec_hi, 0x10001
    ds_write_b128 v19, v[48:51] offset:0
    ds_write_b128 v19, v[52:55] offset:64
    s_mov_b64 exec, -1
    s_lshl_b32 s42, s3, 6
    s_cmp_eq_u32 s3, 2
    s_cselect_b32 s42, 192, s42
    s_cmp_eq_u32 s3, 3
    s_cselect_b32 s42, 128, s42
    s_add_u32 s42, s42, 61440
    v_mul_u32_u24 v20, 496, v16
    v_lshl_add_u32 v20, v17, 4, v20
    v_add_u32 v20, s42, v20
    v_lshlrev_b32 v18, 3, v16
    v_add_u32 v18, 45376, v18
    s_waitcnt lgkmcnt(0)
    s_barrier
    ds_read_b64 v[26:27], v18 offset:128
    ds_read_b64 v[28:29], v18 offset:256
    ds_read_b64 v[30:31], v18 offset:384
    ds_read_b64 v[32:33], v18 offset:512
    ds_read_b128 v[36:39], v19 offset:0
    ds_read_b128 v[40:43], v19 offset:64
    s_waitcnt lgkmcnt(0)
    v_fma_f32 v56, -v26, v36, v56
    v_fma_f32 v57, -v26, v37, v57
    v_fma_f32 v58, -v26, v38, v58
    v_fma_f32 v59, -v26, v39, v59
    v_fma_f32 v60, -v26, v40, v60
    v_fma_f32 v61, -v26, v41, v61
    v_fma_f32 v62, -v26, v42, v62
    v_fma_f32 v63, -v26, v43, v63
    v_fma_f32 v72, -v28, v36, v72
    v_fma_f32 v73, -v28, v37, v73
    v_fma_f32 v74, -v28, v38, v74
    v_fma_f32 v75, -v28, v39, v75
    v_fma_f32 v76, -v28, v40, v76
    v_fma_f32 v77, -v28, v41, v77
    v_fma_f32 v78, -v28, v42, v78
    v_fma_f32 v79, -v28, v43, v79
    v_fma_f32 v80, -v30, v36, v80
    v_fma_f32 v81, -v30, v37, v81
    v_fma_f32 v82, -v30, v38, v82
    v_fma_f32 v83, -v30, v39, v83
    v_fma_f32 v84, -v30, v40, v84
    v_fma_f32 v85, -v30, v41, v85
    v_fma_f32 v86, -v30, v42, v86
    v_fma_f32 v87, -v30, v43, v87
    v_fma_f32 v88, -v32, v36, v88
    v_fma_f32 v89, -v32, v37, v89
    v_fma_f32 v90, -v32, v38, v90
    v_fma_f32 v91, -v32, v39, v91
    v_fma_f32 v92, -v32, v40, v92
    v_fma_f32 v93, -v32, v41, v93
    v_fma_f32 v94, -v32, v42, v94
    v_fma_f32 v95, -v32, v43, v95
    v_mul_f32 v56, v56, v27
    v_mul_f32 v57, v57, v27
    v_mul_f32 v58, v58, v27
    v_mul_f32 v59, v59, v27
    v_mul_f32 v60, v60, v27
    v_mul_f32 v61, v61, v27
    v_mul_f32 v62, v62, v27
    v_mul_f32 v63, v63, v27
    v_mul_f32 v72, v72, v29
    v_mul_f32 v73, v73, v29
    v_mul_f32 v74, v74, v29
    v_mul_f32 v75, v75, v29
    v_mul_f32 v76, v76, v29
    v_mul_f32 v77, v77, v29
    v_mul_f32 v78, v78, v29
    v_mul_f32 v79, v79, v29
    v_mul_f32 v80, v80, v31
    v_mul_f32 v81, v81, v31
    v_mul_f32 v82, v82, v31
    v_mul_f32 v83, v83, v31
    v_mul_f32 v84, v84, v31
    v_mul_f32 v85, v85, v31
    v_mul_f32 v86, v86, v31
    v_mul_f32 v87, v87, v31
    v_mul_f32 v88, v88, v33
    v_mul_f32 v89, v89, v33
    v_mul_f32 v90, v90, v33
    v_mul_f32 v91, v91, v33
    v_mul_f32 v92, v92, v33
    v_mul_f32 v93, v93, v33
    v_mul_f32 v94, v94, v33
    v_mul_f32 v95, v95, v33
    v_cvt_pk_bf16_f32 v56, v56, v60
    v_cvt_pk_bf16_f32 v57, v57, v61
    v_cvt_pk_bf16_f32 v58, v58, v62
    v_cvt_pk_bf16_f32 v59, v59, v63
    ds_write_b128 v20, v[56:59] offset:7936
    v_cvt_pk_bf16_f32 v72, v72, v76
    v_cvt_pk_bf16_f32 v73, v73, v77
    v_cvt_pk_bf16_f32 v74, v74, v78
    v_cvt_pk_bf16_f32 v75, v75, v79
    ds_write_b128 v20, v[72:75] offset:15872
    v_cvt_pk_bf16_f32 v80, v80, v84
    v_cvt_pk_bf16_f32 v81, v81, v85
    v_cvt_pk_bf16_f32 v82, v82, v86
    v_cvt_pk_bf16_f32 v83, v83, v87
    ds_write_b128 v20, v[80:83] offset:23808
    v_cvt_pk_bf16_f32 v88, v88, v92
    v_cvt_pk_bf16_f32 v89, v89, v93
    v_cvt_pk_bf16_f32 v90, v90, v94
    v_cvt_pk_bf16_f32 v91, v91, v95
    ds_write_b128 v20, v[88:91] offset:31744
    s_branch L_a1_post
L_g1B:
    global_load_dwordx4 v[96:99], v44, s[48:49] sc1
    global_load_dwordx4 v[176:179], v44, s[50:51] sc1
    global_load_dwordx4 v[100:103], v45, s[48:49] sc1
    global_load_dwordx4 v[180:183], v45, s[50:51] sc1
    global_load_dwordx4 v[104:107], v46, s[48:49] sc1
    global_load_dwordx4 v[184:187], v46, s[50:51] sc1
    global_load_dwordx4 v[108:111], v47, s[48:49] sc1
    global_load_dwordx4 v[188:191], v47, s[50:51] sc1
    s_add_u32 s48, s48, 4096
    s_addc_u32 s49, s49, 0
    s_add_u32 s50, s50, 4096
    s_addc_u32 s51, s51, 0
    s_waitcnt lgkmcnt(0)
    s_barrier
    global_load_dwordx4 v[112:115], v44, s[48:49] sc1
    global_load_dwordx4 v[192:195], v44, s[50:51] sc1
    global_load_dwordx4 v[116:119], v45, s[48:49] sc1
    global_load_dwordx4 v[196:199], v45, s[50:51] sc1
    global_load_dwordx4 v[120:123], v46, s[48:49] sc1
    global_load_dwordx4 v[200:203], v46, s[50:51] sc1
    global_load_dwordx4 v[124:127], v47, s[48:49] sc1
    global_load_dwordx4 v[204:207], v47, s[50:51] sc1
    s_add_u32 s48, s48, 4096
    s_addc_u32 s49, s49, 0
    s_add_u32 s50, s50, 4096
    s_addc_u32 s51, s51, 0
    ds_read_b128 v[16:19], v2 offset:0
    ds_read_b128 v[20:23], v2 offset:20480
    ds_read_b128 v[24:27], v2 offset:40960
    ds_read_b128 v[28:31], v2 offset:61440
    v_add_u32 v6, 81920, v2
    ds_read_b128 v[32:35], v6 offset:0
    ds_read_b128 v[36:39], v3 offset:0
    global_load_dwordx4 v[128:131], v44, s[48:49] sc1
    global_load_dwordx4 v[208:211], v44, s[50:51] sc1
    ds_read_b128 v[40:43], v3 offset:20480
    s_waitcnt vmcnt(16) lgkmcnt(6)
    v_mfma_f32_16x16x32_bf16 v[48:51], v[96:99], v[16:19], 0
    v_mfma_f32_16x16x32_bf16 v[52:55], v[176:179], v[16:19], 0
    ds_read_b128 v[16:19], v3 offset:40960
    s_waitcnt lgkmcnt(6)
    v_mfma_f32_16x16x32_bf16 v[56:59], v[96:99], v[20:23], 0
    v_mfma_f32_16x16x32_bf16 v[60:63], v[176:179], v[20:23], 0
    ds_read_b128 v[20:23], v3 offset:61440
    s_waitcnt lgkmcnt(6)
    v_mfma_f32_16x16x32_bf16 v[64:67], v[96:99], v[24:27], 0
    v_mfma_f32_16x16x32_bf16 v[68:71], v[176:179], v[24:27], 0
    v_mfma_f32_16x16x32_bf16 v[72:75], v[24:27], v[24:27], 0
    v_mfma_f32_16x16x32_bf16 v[76:79], v[10:13], v[24:27], 0
    v_add_u32 v6, 81920, v3
    ds_read_b128 v[24:27], v6 offset:0
    s_waitcnt lgkmcnt(6)
    v_mfma_f32_16x16x32_bf16 v[80:83], v[96:99], v[28:31], 0
    v_mfma_f32_16x16x32_bf16 v[84:87], v[176:179], v[28:31], 0
    ds_read_b128 v[28:31], v4 offset:0
    s_waitcnt lgkmcnt(6)
    v_mfma_f32_16x16x32_bf16 v[88:91], v[96:99], v[32:35], 0
    v_mfma_f32_16x16x32_bf16 v[92:95], v[176:179], v[32:35], 0
    global_load_dwordx4 v[132:135], v45, s[48:49] sc1
    global_load_dwordx4 v[212:215], v45, s[50:51] sc1
    ds_read_b128 v[32:35], v4 offset:20480
    s_waitcnt vmcnt(16) lgkmcnt(6)
    v_mfma_f32_16x16x32_bf16 v[48:51], v[100:103], v[36:39], v[48:51]
    v_mfma_f32_16x16x32_bf16 v[52:55], v[180:183], v[36:39], v[52:55]
    ds_read_b128 v[36:39], v4 offset:40960
    s_waitcnt lgkmcnt(6)
    v_mfma_f32_16x16x32_bf16 v[56:59], v[100:103], v[40:43], v[56:59]
    v_mfma_f32_16x16x32_bf16 v[60:63], v[180:183], v[40:43], v[60:63]
    ds_read_b128 v[40:43], v4 offset:61440
    s_waitcnt lgkmcnt(6)
    v_mfma_f32_16x16x32_bf16 v[64:67], v[100:103], v[16:19], v[64:67]
    v_mfma_f32_16x16x32_bf16 v[68:71], v[180:183], v[16:19], v[68:71]
    v_mfma_f32_16x16x32_bf16 v[72:75], v[16:19], v[16:19], v[72:75]
    v_mfma_f32_16x16x32_bf16 v[76:79], v[10:13], v[16:19], v[76:79]
    v_add_u32 v6, 81920, v4
    ds_read_b128 v[16:19], v6 offset:0
    s_waitcnt lgkmcnt(6)
    v_mfma_f32_16x16x32_bf16 v[80:83], v[100:103], v[20:23], v[80:83]
    v_mfma_f32_16x16x32_bf16 v[84:87], v[180:183], v[20:23], v[84:87]
    ds_read_b128 v[20:23], v5 offset:0
    s_waitcnt lgkmcnt(6)
    v_mfma_f32_16x16x32_bf16 v[88:91], v[100:103], v[24:27], v[88:91]
    v_mfma_f32_16x16x32_bf16 v[92:95], v[180:183], v[24:27], v[92:95]
    global_load_dwordx4 v[136:139], v46, s[48:49] sc1
    global_load_dwordx4 v[216:219], v46, s[50:51] sc1
    ds_read_b128 v[24:27], v5 offset:20480
    s_waitcnt vmcnt(16) lgkmcnt(6)
    v_mfma_f32_16x16x32_bf16 v[48:51], v[104:107], v[28:31], v[48:51]
    v_mfma_f32_16x16x32_bf16 v[52:55], v[184:187], v[28:31], v[52:55]
    ds_read_b128 v[28:31], v5 offset:40960
    s_waitcnt lgkmcnt(6)
    v_mfma_f32_16x16x32_bf16 v[56:59], v[104:107], v[32:35], v[56:59]
    v_mfma_f32_16x16x32_bf16 v[60:63], v[184:187], v[32:35], v[60:63]
    ds_read_b128 v[32:35], v5 offset:61440
    s_waitcnt lgkmcnt(6)
    v_mfma_f32_16x16x32_bf16 v[64:67], v[104:107], v[36:39], v[64:67]
    v_mfma_f32_16x16x32_bf16 v[68:71], v[184:187], v[36:39], v[68:71]
    v_mfma_f32_16x16x32_bf16 v[72:75], v[36:39], v[36:39], v[72:75]
    v_mfma_f32_16x16x32_bf16 v[76:79], v[10:13], v[36:39], v[76:79]
    v_add_u32 v6, 81920, v5
    ds_read_b128 v[36:39], v6 offset:0
    s_waitcnt lgkmcnt(6)
    v_mfma_f32_16x16x32_bf16 v[80:83], v[104:107], v[40:43], v[80:83]
    v_mfma_f32_16x16x32_bf16 v[84:87], v[184:187], v[40:43], v[84:87]
    ds_read_b128 v[40:43], v2 offset:256
    s_waitcnt lgkmcnt(6)
    v_mfma_f32_16x16x32_bf16 v[88:91], v[104:107], v[16:19], v[88:91]
    v_mfma_f32_16x16x32_bf16 v[92:95], v[184:187], v[16:19], v[92:95]
    global_load_dwordx4 v[140:143], v47, s[48:49] sc1
    global_load_dwordx4 v[220:223], v47, s[50:51] sc1
    s_add_u32 s48, s48, 4096
    s_addc_u32 s49, s49, 0
    s_add_u32 s50, s50, 4096
    s_addc_u32 s51, s51, 0
    ds_read_b128 v[16:19], v2 offset:20736
    s_waitcnt vmcnt(16) lgkmcnt(6)
    v_mfma_f32_16x16x32_bf16 v[48:51], v[108:111], v[20:23], v[48:51]
    v_mfma_f32_16x16x32_bf16 v[52:55], v[188:191], v[20:23], v[52:55]
    ds_read_b128 v[20:23], v2 offset:41216
    s_waitcnt lgkmcnt(6)
    v_mfma_f32_16x16x32_bf16 v[56:59], v[108:111], v[24:27], v[56:59]
    v_mfma_f32_16x16x32_bf16 v[60:63], v[188:191], v[24:27], v[60:63]
    ds_read_b128 v[24:27], v2 offset:61696
    s_waitcnt lgkmcnt(6)
    v_mfma_f32_16x16x32_bf16 v[64:67], v[108:111], v[28:31], v[64:67]
    v_mfma_f32_16x16x32_bf16 v[68:71], v[188:191], v[28:31], v[68:71]
    v_mfma_f32_16x16x32_bf16 v[72:75], v[28:31], v[28:31], v[72:75]
    v_mfma_f32_16x16x32_bf16 v[76:79], v[10:13], v[28:31], v[76:79]
    v_add_u32 v6, 81920, v2
    ds_read_b128 v[28:31], v6 offset:256
    s_waitcnt lgkmcnt(6)
    v_mfma_f32_16x16x32_bf16 v[80:83], v[108:111], v[32:35], v[80:83]
    v_mfma_f32_16x16x32_bf16 v[84:87], v[188:191], v[32:35], v[84:87]
    ds_read_b128 v[32:35], v3 offset:256
    s_waitcnt lgkmcnt(6)
    v_mfma_f32_16x16x32_bf16 v[88:91], v[108:111], v[36:39], v[88:91]
    v_mfma_f32_16x16x32_bf16 v[92:95], v[188:191], v[36:39], v[92:95]
    global_load_dwordx4 v[144:147], v44, s[48:49] sc1
    global_load_dwordx4 v[224:227], v44, s[50:51] sc1
    ds_read_b128 v[36:39], v3 offset:20736
    s_waitcnt vmcnt(16) lgkmcnt(6)
    v_mfma_f32_16x16x32_bf16 v[48:51], v[112:115], v[40:43], v[48:51]
    v_mfma_f32_16x16x32_bf16 v[52:55], v[192:195], v[40:43], v[52:55]
    ds_read_b128 v[40:43], v3 offset:41216
    s_waitcnt lgkmcnt(6)
    v_mfma_f32_16x16x32_bf16 v[56:59], v[112:115], v[16:19], v[56:59]
    v_mfma_f32_16x16x32_bf16 v[60:63], v[192:195], v[16:19], v[60:63]
    ds_read_b128 v[16:19], v3 offset:61696
    s_waitcnt lgkmcnt(6)
    v_mfma_f32_16x16x32_bf16 v[64:67], v[112:115], v[20:23], v[64:67]
    v_mfma_f32_16x16x32_bf16 v[68:71], v[192:195], v[20:23], v[68:71]
    v_mfma_f32_16x16x32_bf16 v[72:75], v[20:23], v[20:23], v[72:75]
    v_mfma_f32_16x16x32_bf16 v[76:79], v[10:13], v[20:23], v[76:79]
    v_add_u32 v6, 81920, v3
    ds_read_b128 v[20:23], v6 offset:256
    s_waitcnt lgkmcnt(6)
    v_mfma_f32_16x16x32_bf16 v[80:83], v[112:115], v[24:27], v[80:83]
    v_mfma_f32_16x16x32_bf16 v[84:87], v[192:195], v[24:27], v[84:87]
    ds_read_b128 v[24:27], v4 offset:256
    s_waitcnt lgkmcnt(6)
    v_mfma_f32_16x16x32_bf16 v[88:91], v[112:115], v[28:31], v[88:91]
    v_mfma_f32_16x16x32_bf16 v[92:95], v[192:195], v[28:31], v[92:95]
    global_load_dwordx4 v[148:151], v45, s[48:49] sc1
    global_load_dwordx4 v[228:231], v45, s[50:51] sc1
    ds_read_b128 v[28:31], v4 offset:20736
    s_waitcnt vmcnt(16) lgkmcnt(6)
    v_mfma_f32_16x16x32_bf16 v[48:51], v[116:119], v[32:35], v[48:51]
    v_mfma_f32_16x16x32_bf16 v[52:55], v[196:199], v[32:35], v[52:55]
    ds_read_b128 v[32:35], v4 offset:41216
    s_waitcnt lgkmcnt(6)
    v_mfma_f32_16x16x32_bf16 v[56:59], v[116:119], v[36:39], v[56:59]
    v_mfma_f32_16x16x32_bf16 v[60:63], v[196:199], v[36:39], v[60:63]
    ds_read_b128 v[36:39], v4 offset:61696
    s_waitcnt lgkmcnt(6)
    v_mfma_f32_16x16x32_bf16 v[64:67], v[116:119], v[40:43], v[64:67]
    v_mfma_f32_16x16x32_bf16 v[68:71], v[196:199], v[40:43], v[68:71]
    v_mfma_f32_16x16x32_bf16 v[72:75], v[40:43], v[40:43], v[72:75]
    v_mfma_f32_16x16x32_bf16 v[76:79], v[10:13], v[40:43], v[76:79]
    v_add_u32 v6, 81920, v4
    ds_read_b128 v[40:43], v6 offset:256
    s_waitcnt lgkmcnt(6)
    v_mfma_f32_16x16x32_bf16 v[80:83], v[116:119], v[16:19], v[80:83]
    v_mfma_f32_16x16x32_bf16 v[84:87], v[196:199], v[16:19], v[84:87]
    ds_read_b128 v[16:19], v5 offset:256
    s_waitcnt lgkmcnt(6)
    v_mfma_f32_16x16x32_bf16 v[88:91], v[116:119], v[20:23], v[88:91]
    v_mfma_f32_16x16x32_bf16 v[92:95], v[196:199], v[20:23], v[92:95]
    global_load_dwordx4 v[152:155], v46, s[48:49] sc1
    global_load_dwordx4 v[232:235], v46, s[50:51] sc1
    ds_read_b128 v[20:23], v5 offset:20736
    s_waitcnt vmcnt(16) lgkmcnt(6)
    v_mfma_f32_16x16x32_bf16 v[48:51], v[120:123], v[24:27], v[48:51]
    v_mfma_f32_16x16x32_bf16 v[52:55], v[200:203], v[24:27], v[52:55]
    ds_read_b128 v[24:27], v5 offset:41216
    s_waitcnt lgkmcnt(6)
    v_mfma_f32_16x16x32_bf16 v[56:59], v[120:123], v[28:31], v[56:59]
    v_mfma_f32_16x16x32_bf16 v[60:63], v[200:203], v[28:31], v[60:63]
    ds_read_b128 v[28:31], v5 offset:61696
    s_waitcnt lgkmcnt(6)
    v_mfma_f32_16x16x32_bf16 v[64:67], v[120:123], v[32:35], v[64:67]
    v_mfma_f32_16x16x32_bf16 v[68:71], v[200:203], v[32:35], v[68:71]
    v_mfma_f32_16x16x32_bf16 v[72:75], v[32:35], v[32:35], v[72:75]
    v_mfma_f32_16x16x32_bf16 v[76:79], v[10:13], v[32:35], v[76:79]
    v_add_u32 v6, 81920, v5
    ds_read_b128 v[32:35], v6 offset:256
    s_waitcnt lgkmcnt(6)
    v_mfma_f32_16x16x32_bf16 v[80:83], v[120:123], v[36:39], v[80:83]
    v_mfma_f32_16x16x32_bf16 v[84:87], v[200:203], v[36:39], v[84:87]
    ds_read_b128 v[36:39], v2 offset:512
    s_waitcnt lgkmcnt(6)
    v_mfma_f32_16x16x32_bf16 v[88:91], v[120:123], v[40:43], v[88:91]
    v_mfma_f32_16x16x32_bf16 v[92:95], v[200:203], v[40:43], v[92:95]
    global_load_dwordx4 v[156:159], v47, s[48:49] sc1
    global_load_dwordx4 v[236:239], v47, s[50:51] sc1
    s_add_u32 s48, s48, 4096
    s_addc_u32 s49, s49, 0
    s_add_u32 s50, s50, 4096
    s_addc_u32 s51, s51, 0
    ds_read_b128 v[40:43], v2 offset:20992
    s_waitcnt vmcnt(16) lgkmcnt(6)
    v_mfma_f32_16x16x32_bf16 v[48:51], v[124:127], v[16:19], v[48:51]
    v_mfma_f32_16x16x32_bf16 v[52:55], v[204:207], v[16:19], v[52:55]
    ds_read_b128 v[16:19], v2 offset:41472
    s_waitcnt lgkmcnt(6)
    v_mfma_f32_16x16x32_bf16 v[56:59], v[124:127], v[20:23], v[56:59]
    v_mfma_f32_16x16x32_bf16 v[60:63], v[204:207], v[20:23], v[60:63]
    ds_read_b128 v[20:23], v2 offset:61952
    s_waitcnt lgkmcnt(6)
    v_mfma_f32_16x16x32_bf16 v[64:67], v[124:127], v[24:27], v[64:67]
    v_mfma_f32_16x16x32_bf16 v[68:71], v[204:207], v[24:27], v[68:71]
    v_mfma_f32_16x16x32_bf16 v[72:75], v[24:27], v[24:27], v[72:75]
    v_mfma_f32_16x16x32_bf16 v[76:79], v[10:13], v[24:27], v[76:79]
    v_add_u32 v6, 81920, v2
    ds_read_b128 v[24:27], v6 offset:512
    s_waitcnt lgkmcnt(6)
    v_mfma_f32_16x16x32_bf16 v[80:83], v[124:127], v[28:31], v[80:83]
    v_mfma_f32_16x16x32_bf16 v[84:87], v[204:207], v[28:31], v[84:87]
    ds_read_b128 v[28:31], v3 offset:512
    s_waitcnt lgkmcnt(6)
    v_mfma_f32_16x16x32_bf16 v[88:91], v[124:127], v[32:35], v[88:91]
    v_mfma_f32_16x16x32_bf16 v[92:95], v[204:207], v[32:35], v[92:95]
    global_load_dwordx4 v[160:163], v44, s[48:49] sc1
    global_load_dwordx4 v[240:243], v44, s[50:51] sc1
    ds_read_b128 v[32:35], v3 offset:20992
    s_waitcnt vmcnt(16) lgkmcnt(6)
    v_mfma_f32_16x16x32_bf16 v[48:51], v[128:131], v[36:39], v[48:51]
    v_mfma_f32_16x16x32_bf16 v[52:55], v[208:211], v[36:39], v[52:55]
    ds_read_b128 v[36:39], v3 offset:41472
    s_waitcnt lgkmcnt(6)
    v_mfma_f32_16x16x32_bf16 v[56:59], v[128:131], v[40:43], v[56:59]
    v_mfma_f32_16x16x32_bf16 v[60:63], v[208:211], v[40:43], v[60:63]
    ds_read_b128 v[40:43], v3 offset:61952
    s_waitcnt lgkmcnt(6)
    v_mfma_f32_16x16x32_bf16 v[64:67], v[128:131], v[16:19], v[64:67]
    v_mfma_f32_16x16x32_bf16 v[68:71], v[208:211], v[16:19], v[68:71]
    v_mfma_f32_16x16x32_bf16 v[72:75], v[16:19], v[16:19], v[72:75]
    v_mfma_f32_16x16x32_bf16 v[76:79], v[10:13], v[16:19], v[76:79]
    v_add_u32 v6, 81920, v3
    ds_read_b128 v[16:19], v6 offset:512
    s_waitcnt lgkmcnt(6)
    v_mfma_f32_16x16x32_bf16 v[80:83], v[128:131], v[20:23], v[80:83]
    v_mfma_f32_16x16x32_bf16 v[84:87], v[208:211], v[20:23], v[84:87]
    ds_read_b128 v[20:23], v4 offset:512
    s_waitcnt lgkmcnt(6)
    v_mfma_f32_16x16x32_bf16 v[88:91], v[128:131], v[24:27], v[88:91]
    v_mfma_f32_16x16x32_bf16 v[92:95], v[208:211], v[24:27], v[92:95]
    global_load_dwordx4 v[164:167], v45, s[48:49] sc1
    global_load_dwordx4 v[244:247], v45, s[50:51] sc1
    ds_read_b128 v[24:27], v4 offset:20992
    s_waitcnt vmcnt(16) lgkmcnt(6)
    v_mfma_f32_16x16x32_bf16 v[48:51], v[132:135], v[28:31], v[48:51]
    v_mfma_f32_16x16x32_bf16 v[52:55], v[212:215], v[28:31], v[52:55]
    ds_read_b128 v[28:31], v4 offset:41472
    s_waitcnt lgkmcnt(6)
    v_mfma_f32_16x16x32_bf16 v[56:59], v[132:135], v[32:35], v[56:59]
    v_mfma_f32_16x16x32_bf16 v[60:63], v[212:215], v[32:35], v[60:63]
    ds_read_b128 v[32:35], v4 offset:61952
    s_waitcnt lgkmcnt(6)
    v_mfma_f32_16x16x32_bf16 v[64:67], v[132:135], v[36:39], v[64:67]
    v_mfma_f32_16x16x32_bf16 v[68:71], v[212:215], v[36:39], v[68:71]
    v_mfma_f32_16x16x32_bf16 v[72:75], v[36:39], v[36:39], v[72:75]
    v_mfma_f32_16x16x32_bf16 v[76:79], v[10:13], v[36:39], v[76:79]
    v_add_u32 v6, 81920, v4
    ds_read_b128 v[36:39], v6 offset:512
    s_waitcnt lgkmcnt(6)
    v_mfma_f32_16x16x32_bf16 v[80:83], v[132:135], v[40:43], v[80:83]
    v_mfma_f32_16x16x32_bf16 v[84:87], v[212:215], v[40:43], v[84:87]
    ds_read_b128 v[40:43], v5 offset:512
    s_waitcnt lgkmcnt(6)
    v_mfma_f32_16x16x32_bf16 v[88:91], v[132:135], v[16:19], v[88:91]
    v_mfma_f32_16x16x32_bf16 v[92:95], v[212:215], v[16:19], v[92:95]
    global_load_dwordx4 v[168:171], v46, s[48:49] sc1
    global_load_dwordx4 v[248:251], v46, s[50:51] sc1
    ds_read_b128 v[16:19], v5 offset:20992
    s_waitcnt vmcnt(16) lgkmcnt(6)
    v_mfma_f32_16x16x32_bf16 v[48:51], v[136:139], v[20:23], v[48:51]
    v_mfma_f32_16x16x32_bf16 v[52:55], v[216:219], v[20:23], v[52:55]
    ds_read_b128 v[20:23], v5 offset:41472
    s_waitcnt lgkmcnt(6)
    v_mfma_f32_16x16x32_bf16 v[56:59], v[136:139], v[24:27], v[56:59]
    v_mfma_f32_16x16x32_bf16 v[60:63], v[216:219], v[24:27], v[60:63]
    ds_read_b128 v[24:27], v5 offset:61952
    s_waitcnt lgkmcnt(6)
    v_mfma_f32_16x16x32_bf16 v[64:67], v[136:139], v[28:31], v[64:67]
    v_mfma_f32_16x16x32_bf16 v[68:71], v[216:219], v[28:31], v[68:71]
    v_mfma_f32_16x16x32_bf16 v[72:75], v[28:31], v[28:31], v[72:75]
    v_mfma_f32_16x16x32_bf16 v[76:79], v[10:13], v[28:31], v[76:79]
    v_add_u32 v6, 81920, v5
    ds_read_b128 v[28:31], v6 offset:512
    s_waitcnt lgkmcnt(6)
    v_mfma_f32_16x16x32_bf16 v[80:83], v[136:139], v[32:35], v[80:83]
    v_mfma_f32_16x16x32_bf16 v[84:87], v[216:219], v[32:35], v[84:87]
    ds_read_b128 v[32:35], v2 offset:768
    s_waitcnt lgkmcnt(6)
    v_mfma_f32_16x16x32_bf16 v[88:91], v[136:139], v[36:39], v[88:91]
    v_mfma_f32_16x16x32_bf16 v[92:95], v[216:219], v[36:39], v[92:95]
    global_load_dwordx4 v[172:175], v47, s[48:49] sc1
    global_load_dwordx4 v[252:255], v47, s[50:51] sc1
    ds_read_b128 v[36:39], v2 offset:21248
    s_waitcnt vmcnt(16) lgkmcnt(6)
    v_mfma_f32_16x16x32_bf16 v[48:51], v[140:143], v[40:43], v[48:51]
    v_mfma_f32_16x16x32_bf16 v[52:55], v[220:223], v[40:43], v[52:55]
    ds_read_b128 v[40:43], v2 offset:41728
    s_waitcnt lgkmcnt(6)
    v_mfma_f32_16x16x32_bf16 v[56:59], v[140:143], v[16:19], v[56:59]
    v_mfma_f32_16x16x32_bf16 v[60:63], v[220:223], v[16:19], v[60:63]
    ds_read_b128 v[16:19], v2 offset:62208
    s_waitcnt lgkmcnt(6)
    v_mfma_f32_16x16x32_bf16 v[64:67], v[140:143], v[20:23], v[64:67]
    v_mfma_f32_16x16x32_bf16 v[68:71], v[220:223], v[20:23], v[68:71]
    v_mfma_f32_16x16x32_bf16 v[72:75], v[20:23], v[20:23], v[72:75]
    v_mfma_f32_16x16x32_bf16 v[76:79], v[10:13], v[20:23], v[76:79]
    v_add_u32 v6, 81920, v2
    ds_read_b128 v[20:23], v6 offset:768
    s_waitcnt lgkmcnt(6)
    v_mfma_f32_16x16x32_bf16 v[80:83], v[140:143], v[24:27], v[80:83]
    v_mfma_f32_16x16x32_bf16 v[84:87], v[220:223], v[24:27], v[84:87]
    ds_read_b128 v[24:27], v3 offset:768
    s_waitcnt lgkmcnt(6)
    v_mfma_f32_16x16x32_bf16 v[88:91], v[140:143], v[28:31], v[88:91]
    v_mfma_f32_16x16x32_bf16 v[92:95], v[220:223], v[28:31], v[92:95]
    ds_read_b128 v[28:31], v3 offset:21248
    s_waitcnt vmcnt(14) lgkmcnt(6)
    v_mfma_f32_16x16x32_bf16 v[48:51], v[144:147], v[32:35], v[48:51]
    v_mfma_f32_16x16x32_bf16 v[52:55], v[224:227], v[32:35], v[52:55]
    ds_read_b128 v[32:35], v3 offset:41728
    s_waitcnt lgkmcnt(6)
    v_mfma_f32_16x16x32_bf16 v[56:59], v[144:147], v[36:39], v[56:59]
    v_mfma_f32_16x16x32_bf16 v[60:63], v[224:227], v[36:39], v[60:63]
    ds_read_b128 v[36:39], v3 offset:62208
    s_waitcnt lgkmcnt(6)
    v_mfma_f32_16x16x32_bf16 v[64:67], v[144:147], v[40:43], v[64:67]
    v_mfma_f32_16x16x32_bf16 v[68:71], v[224:227], v[40:43], v[68:71]
    v_mfma_f32_16x16x32_bf16 v[72:75], v[40:43], v[40:43], v[72:75]
    v_mfma_f32_16x16x32_bf16 v[76:79], v[10:13], v[40:43], v[76:79]
    v_add_u32 v6, 81920, v3
    ds_read_b128 v[40:43], v6 offset:768
    s_waitcnt lgkmcnt(6)
    v_mfma_f32_16x16x32_bf16 v[80:83], v[144:147], v[16:19], v[80:83]
    v_mfma_f32_16x16x32_bf16 v[84:87], v[224:227], v[16:19], v[84:87]
    ds_read_b128 v[16:19], v4 offset:768
    s_waitcnt lgkmcnt(6)
    v_mfma_f32_16x16x32_bf16 v[88:91], v[144:147], v[20:23], v[88:91]
    v_mfma_f32_16x16x32_bf16 v[92:95], v[224:227], v[20:23], v[92:95]
    ds_read_b128 v[20:23], v4 offset:21248
    s_waitcnt vmcnt(12) lgkmcnt(6)
    v_mfma_f32_16x16x32_bf16 v[48:51], v[148:151], v[24:27], v[48:51]
    v_mfma_f32_16x16x32_bf16 v[52:55], v[228:231], v[24:27], v[52:55]
    ds_read_b128 v[24:27], v4 offset:41728
    s_waitcnt lgkmcnt(6)
    v_mfma_f32_16x16x32_bf16 v[56:59], v[148:151], v[28:31], v[56:59]
    v_mfma_f32_16x16x32_bf16 v[60:63], v[228:231], v[28:31], v[60:63]
    ds_read_b128 v[28:31], v4 offset:62208
    s_waitcnt lgkmcnt(6)
    v_mfma_f32_16x16x32_bf16 v[64:67], v[148:151], v[32:35], v[64:67]
    v_mfma_f32_16x16x32_bf16 v[68:71], v[228:231], v[32:35], v[68:71]
    v_mfma_f32_16x16x32_bf16 v[72:75], v[32:35], v[32:35], v[72:75]
    v_mfma_f32_16x16x32_bf16 v[76:79], v[10:13], v[32:35], v[76:79]
    v_add_u32 v6, 81920, v4
    ds_read_b128 v[32:35], v6 offset:768
    s_waitcnt lgkmcnt(6)
    v_mfma_f32_16x16x32_bf16 v[80:83], v[148:151], v[36:39], v[80:83]
    v_mfma_f32_16x16x32_bf16 v[84:87], v[228:231], v[36:39], v[84:87]
    ds_read_b128 v[36:39], v5 offset:768
    s_waitcnt lgkmcnt(6)
    v_mfma_f32_16x16x32_bf16 v[88:91], v[148:151], v[40:43], v[88:91]
    v_mfma_f32_16x16x32_bf16 v[92:95], v[228:231], v[40:43], v[92:95]
    ds_read_b128 v[40:43], v5 offset:21248
    s_waitcnt vmcnt(10) lgkmcnt(6)
    v_mfma_f32_16x16x32_bf16 v[48:51], v[152:155], v[16:19], v[48:51]
    v_mfma_f32_16x16x32_bf16 v[52:55], v[232:235], v[16:19], v[52:55]
    ds_read_b128 v[16:19], v5 offset:41728
    s_waitcnt lgkmcnt(6)
    v_mfma_f32_16x16x32_bf16 v[56:59], v[152:155], v[20:23], v[56:59]
    v_mfma_f32_16x16x32_bf16 v[60:63], v[232:235], v[20:23], v[60:63]
    ds_read_b128 v[20:23], v5 offset:62208
    s_waitcnt lgkmcnt(6)
    v_mfma_f32_16x16x32_bf16 v[64:67], v[152:155], v[24:27], v[64:67]
    v_mfma_f32_16x16x32_bf16 v[68:71], v[232:235], v[24:27], v[68:71]
    v_mfma_f32_16x16x32_bf16 v[72:75], v[24:27], v[24:27], v[72:75]
    v_mfma_f32_16x16x32_bf16 v[76:79], v[10:13], v[24:27], v[76:79]
    v_add_u32 v6, 81920, v5
    ds_read_b128 v[24:27], v6 offset:768
    s_waitcnt lgkmcnt(6)
    v_mfma_f32_16x16x32_bf16 v[80:83], v[152:155], v[28:31], v[80:83]
    v_mfma_f32_16x16x32_bf16 v[84:87], v[232:235], v[28:31], v[84:87]
    ds_read_b128 v[28:31], v2 offset:1024
    s_waitcnt lgkmcnt(6)
    v_mfma_f32_16x16x32_bf16 v[88:91], v[152:155], v[32:35], v[88:91]
    v_mfma_f32_16x16x32_bf16 v[92:95], v[232:235], v[32:35], v[92:95]
    ds_read_b128 v[32:35], v2 offset:21504
    s_waitcnt vmcnt(8) lgkmcnt(6)
    v_mfma_f32_16x16x32_bf16 v[48:51], v[156:159], v[36:39], v[48:51]
    v_mfma_f32_16x16x32_bf16 v[52:55], v[236:239], v[36:39], v[52:55]
    ds_read_b128 v[36:39], v2 offset:41984
    s_waitcnt lgkmcnt(6)
    v_mfma_f32_16x16x32_bf16 v[56:59], v[156:159], v[40:43], v[56:59]
    v_mfma_f32_16x16x32_bf16 v[60:63], v[236:239], v[40:43], v[60:63]
    ds_read_b128 v[40:43], v2 offset:62464
    s_waitcnt lgkmcnt(6)
    v_mfma_f32_16x16x32_bf16 v[64:67], v[156:159], v[16:19], v[64:67]
    v_mfma_f32_16x16x32_bf16 v[68:71], v[236:239], v[16:19], v[68:71]
    v_mfma_f32_16x16x32_bf16 v[72:75], v[16:19], v[16:19], v[72:75]
    v_mfma_f32_16x16x32_bf16 v[76:79], v[10:13], v[16:19], v[76:79]
    v_add_u32 v6, 81920, v2
    ds_read_b128 v[16:19], v6 offset:1024
    s_waitcnt lgkmcnt(6)
    v_mfma_f32_16x16x32_bf16 v[80:83], v[156:159], v[20:23], v[80:83]
    v_mfma_f32_16x16x32_bf16 v[84:87], v[236:239], v[20:23], v[84:87]
    ds_read_b128 v[20:23], v3 offset:1024
    s_waitcnt lgkmcnt(6)
    v_mfma_f32_16x16x32_bf16 v[88:91], v[156:159], v[24:27], v[88:91]
    v_mfma_f32_16x16x32_bf16 v[92:95], v[236:239], v[24:27], v[92:95]
    ds_read_b128 v[24:27], v3 offset:21504
    s_waitcnt vmcnt(6) lgkmcnt(6)
    v_mfma_f32_16x16x32_bf16 v[48:51], v[160:163], v[28:31], v[48:51]
    v_mfma_f32_16x16x32_bf16 v[52:55], v[240:243], v[28:31], v[52:55]
    ds_read_b128 v[28:31], v3 offset:41984
    s_waitcnt lgkmcnt(6)
    v_mfma_f32_16x16x32_bf16 v[56:59], v[160:163], v[32:35], v[56:59]
    v_mfma_f32_16x16x32_bf16 v[60:63], v[240:243], v[32:35], v[60:63]
    ds_read_b128 v[32:35], v3 offset:62464
    s_waitcnt lgkmcnt(6)
    v_mfma_f32_16x16x32_bf16 v[64:67], v[160:163], v[36:39], v[64:67]
    v_mfma_f32_16x16x32_bf16 v[68:71], v[240:243], v[36:39], v[68:71]
    v_mfma_f32_16x16x32_bf16 v[72:75], v[36:39], v[36:39], v[72:75]
    v_mfma_f32_16x16x32_bf16 v[76:79], v[10:13], v[36:39], v[76:79]
    v_add_u32 v6, 81920, v3
    ds_read_b128 v[36:39], v6 offset:1024
    s_waitcnt lgkmcnt(6)
    v_mfma_f32_16x16x32_bf16 v[80:83], v[160:163], v[40:43], v[80:83]
    v_mfma_f32_16x16x32_bf16 v[84:87], v[240:243], v[40:43], v[84:87]
    ds_read_b128 v[40:43], v4 offset:1024
    s_waitcnt lgkmcnt(6)
    v_mfma_f32_16x16x32_bf16 v[88:91], v[160:163], v[16:19], v[88:91]
    v_mfma_f32_16x16x32_bf16 v[92:95], v[240:243], v[16:19], v[92:95]
    ds_read_b128 v[16:19], v4 offset:21504
    s_waitcnt vmcnt(4) lgkmcnt(6)
    v_mfma_f32_16x16x32_bf16 v[48:51], v[164:167], v[20:23], v[48:51]
    v_mfma_f32_16x16x32_bf16 v[52:55], v[244:247], v[20:23], v[52:55]
    ds_read_b128 v[20:23], v4 offset:41984
    s_waitcnt lgkmcnt(6)
    v_mfma_f32_16x16x32_bf16 v[56:59], v[164:167], v[24:27], v[56:59]
    v_mfma_f32_16x16x32_bf16 v[60:63], v[244:247], v[24:27], v[60:63]
    ds_read_b128 v[24:27], v4 offset:62464
    s_waitcnt lgkmcnt(6)
    v_mfma_f32_16x16x32_bf16 v[64:67], v[164:167], v[28:31], v[64:67]
    v_mfma_f32_16x16x32_bf16 v[68:71], v[244:247], v[28:31], v[68:71]
    v_mfma_f32_16x16x32_bf16 v[72:75], v[28:31], v[28:31], v[72:75]
    v_mfma_f32_16x16x32_bf16 v[76:79], v[10:13], v[28:31], v[76:79]
    v_add_u32 v6, 81920, v4
    ds_read_b128 v[28:31], v6 offset:1024
    s_waitcnt lgkmcnt(6)
    v_mfma_f32_16x16x32_bf16 v[80:83], v[164:167], v[32:35], v[80:83]
    v_mfma_f32_16x16x32_bf16 v[84:87], v[244:247], v[32:35], v[84:87]
    ds_read_b128 v[32:35], v5 offset:1024
    s_waitcnt lgkmcnt(6)
    v_mfma_f32_16x16x32_bf16 v[88:91], v[164:167], v[36:39], v[88:91]
    v_mfma_f32_16x16x32_bf16 v[92:95], v[244:247], v[36:39], v[92:95]
    ds_read_b128 v[36:39], v5 offset:21504
    s_waitcnt vmcnt(2) lgkmcnt(6)
    v_mfma_f32_16x16x32_bf16 v[48:51], v[168:171], v[40:43], v[48:51]
    v_mfma_f32_16x16x32_bf16 v[52:55], v[248:251], v[40:43], v[52:55]
    ds_read_b128 v[40:43], v5 offset:41984
    s_waitcnt lgkmcnt(6)
    v_mfma_f32_16x16x32_bf16 v[56:59], v[168:171], v[16:19], v[56:59]
    v_mfma_f32_16x16x32_bf16 v[60:63], v[248:251], v[16:19], v[60:63]
    ds_read_b128 v[16:19], v5 offset:62464
    s_waitcnt lgkmcnt(6)
    v_mfma_f32_16x16x32_bf16 v[64:67], v[168:171], v[20:23], v[64:67]
    v_mfma_f32_16x16x32_bf16 v[68:71], v[248:251], v[20:23], v[68:71]
    v_mfma_f32_16x16x32_bf16 v[72:75], v[20:23], v[20:23], v[72:75]
    v_mfma_f32_16x16x32_bf16 v[76:79], v[10:13], v[20:23], v[76:79]
    v_add_u32 v6, 81920, v5
    ds_read_b128 v[20:23], v6 offset:1024
    s_waitcnt lgkmcnt(6)
    v_mfma_f32_16x16x32_bf16 v[80:83], v[168:171], v[24:27], v[80:83]
    v_mfma_f32_16x16x32_bf16 v[84:87], v[248:251], v[24:27], v[84:87]
    s_waitcnt lgkmcnt(5)
    v_mfma_f32_16x16x32_bf16 v[88:91], v[168:171], v[28:31], v[88:91]
    v_mfma_f32_16x16x32_bf16 v[92:95], v[248:251], v[28:31], v[92:95]
    s_waitcnt vmcnt(0) lgkmcnt(4)
    v_mfma_f32_16x16x32_bf16 v[48:51], v[172:175], v[32:35], v[48:51]
    v_mfma_f32_16x16x32_bf16 v[52:55], v[252:255], v[32:35], v[52:55]
    s_waitcnt lgkmcnt(3)
    v_mfma_f32_16x16x32_bf16 v[56:59], v[172:175], v[36:39], v[56:59]
    v_mfma_f32_16x16x32_bf16 v[60:63], v[252:255], v[36:39], v[60:63]
    s_waitcnt lgkmcnt(2)
    v_mfma_f32_16x16x32_bf16 v[64:67], v[172:175], v[40:43], v[64:67]
    v_mfma_f32_16x16x32_bf16 v[68:71], v[252:255], v[40:43], v[68:71]
    v_mfma_f32_16x16x32_bf16 v[72:75], v[40:43], v[40:43], v[72:75]
    v_mfma_f32_16x16x32_bf16 v[76:79], v[10:13], v[40:43], v[76:79]
    s_waitcnt lgkmcnt(1)
    v_mfma_f32_16x16x32_bf16 v[80:83], v[172:175], v[16:19], v[80:83]
    v_mfma_f32_16x16x32_bf16 v[84:87], v[252:255], v[16:19], v[84:87]
    s_waitcnt lgkmcnt(0)
    v_mfma_f32_16x16x32_bf16 v[88:91], v[172:175], v[20:23], v[88:91]
    v_mfma_f32_16x16x32_bf16 v[92:95], v[252:255], v[20:23], v[92:95]
    ds_read_b64_tr_b16 v[10:11], v7
    ds_read_b64_tr_b16 v[12:13], v8
    ds_read_b64_tr_b16 v[14:15], v9
    v_and_b32 v16, 15, v1
    v_lshrrev_b32 v17, 4, v1
    v_and_b32 v18, 3, v1
    v_lshrrev_b32 v19, 2, v16
    v_cmp_eq_u32 s[42:43], 1, v18
    v_cmp_eq_u32 s[44:45], 2, v18
    v_cmp_eq_u32 s[46:47], 3, v18
    v_cmp_eq_u32 s[48:49], v19, v17
    v_lshlrev_b32 v18, 3, v16
    v_add_u32 v18, 45376, v18
    v_cndmask_b32 v72, v72, v73, s[42:43]
    v_cndmask_b32 v72, v72, v74, s[44:45]
    v_cndmask_b32 v72, v72, v75, s[46:47]
    v_mul_f32 v76, 0x3acccccd, v76
    v_mul_f32 v72, 0x3acccccd, v72
    v_fma_f32 v72, -v76, v76, v72
    v_max_f32 v72, 0, v72
    v_cvt_pk_bf16_f32 v76, v76, v72
    v_and_b32 v72, 0xffff0000, v76
    v_lshlrev_b32 v76, 16, v76
    v_add_f32 v72, 0x3727c5ac, v72
    v_cvt_pk_bf16_f32 v72, v72, v72
    v_lshlrev_b32 v72, 16, v72
    v_sqrt_f32 v72, v72
    s_nop 0
    v_cvt_pk_bf16_f32 v72, v72, v72
    v_lshlrev_b32 v72, 16, v72
    v_rcp_f32 v77, v72
    s_mov_b64 exec, s[48:49]
    ds_write_b64 v18, v[76:77] offset:256
    s_mov_b64 exec, -1
    s_lshl_b32 s42, s3, 7
    s_add_u32 s42, s42, 46016
    v_lshl_add_u32 v19, v17, 4, s42
    s_mov_b64 exec, 0x10001
    s_mov_b32 exec_hi, 0x10001
    ds_write_b128 v19, v[48:51] offset:0
    ds_write_b128 v19, v[52:55] offset:64
    s_mov_b64 exec, -1
    s_lshl_b32 s42, s3, 6
    s_cmp_eq_u32 s3, 2
    s_cselect_b32 s42, 192, s42
    s_cmp_eq_u32 s3, 3
    s_cselect_b32 s42, 128, s42
    s_add_u32 s42, s42, 61440
    v_mul_u32_u24 v20, 496, v16
    v_lshl_add_u32 v20, v17, 4, v20
    v_add_u32 v20, s42, v20
    v_lshlrev_b32 v18, 3, v16
    v_add_u32 v18, 45376, v18
    s_waitcnt lgkmcnt(0)
    s_barrier
    ds_read_b64 v[26:27], v18 offset:128
    ds_read_b64 v[28:29], v18 offset:256
    ds_read_b64 v[30:31], v18 offset:384
    ds_read_b64 v[32:33], v18 offset:512
    ds_read_b128 v[36:39], v19 offset:0
    ds_read_b128 v[40:43], v19 offset:64
    s_waitcnt lgkmcnt(0)
    v_fma_f32 v56, -v26, v36, v56
    v_fma_f32 v57, -v26, v37, v57
    v_fma_f32 v58, -v26, v38, v58
    v_fma_f32 v59, -v26, v39, v59
    v_fma_f32 v60, -v26, v40, v60
    v_fma_f32 v61, -v26, v41, v61
    v_fma_f32 v62, -v26, v42, v62
    v_fma_f32 v63, -v26, v43, v63
    v_fma_f32 v64, -v28, v36, v64
    v_fma_f32 v65, -v28, v37, v65
    v_fma_f32 v66, -v28, v38, v66
    v_fma_f32 v67, -v28, v39, v67
    v_fma_f32 v68, -v28, v40, v68
    v_fma_f32 v69, -v28, v41, v69
    v_fma_f32 v70, -v28, v42, v70
    v_fma_f32 v71, -v28, v43, v71
    v_fma_f32 v80, -v30, v36, v80
    v_fma_f32 v81, -v30, v37, v81
    v_fma_f32 v82, -v30, v38, v82
    v_fma_f32 v83, -v30, v39, v83
    v_fma_f32 v84, -v30, v40, v84
    v_fma_f32 v85, -v30, v41, v85
    v_fma_f32 v86, -v30, v42, v86
    v_fma_f32 v87, -v30, v43, v87
    v_fma_f32 v88, -v32, v36, v88
    v_fma_f32 v89, -v32, v37, v89
    v_fma_f32 v90, -v32, v38, v90
    v_fma_f32 v91, -v32, v39, v91
    v_fma_f32 v92, -v32, v40, v92
    v_fma_f32 v93, -v32, v41, v93
    v_fma_f32 v94, -v32, v42, v94
    v_fma_f32 v95, -v32, v43, v95
    v_mul_f32 v56, v56, v27
    v_mul_f32 v57, v57, v27
    v_mul_f32 v58, v58, v27
    v_mul_f32 v59, v59, v27
    v_mul_f32 v60, v60, v27
    v_mul_f32 v61, v61, v27
    v_mul_f32 v62, v62, v27
    v_mul_f32 v63, v63, v27
    v_mul_f32 v64, v64, v29
    v_mul_f32 v65, v65, v29
    v_mul_f32 v66, v66, v29
    v_mul_f32 v67, v67, v29
    v_mul_f32 v68, v68, v29
    v_mul_f32 v69, v69, v29
    v_mul_f32 v70, v70, v29
    v_mul_f32 v71, v71, v29
    v_mul_f32 v80, v80, v31
    v_mul_f32 v81, v81, v31
    v_mul_f32 v82, v82, v31
    v_mul_f32 v83, v83, v31
    v_mul_f32 v84, v84, v31
    v_mul_f32 v85, v85, v31
    v_mul_f32 v86, v86, v31
    v_mul_f32 v87, v87, v31
    v_mul_f32 v88, v88, v33
    v_mul_f32 v89, v89, v33
    v_mul_f32 v90, v90, v33
    v_mul_f32 v91, v91, v33
    v_mul_f32 v92, v92, v33
    v_mul_f32 v93, v93, v33
    v_mul_f32 v94, v94, v33
    v_mul_f32 v95, v95, v33
    v_cvt_pk_bf16_f32 v56, v56, v60
    v_cvt_pk_bf16_f32 v57, v57, v61
    v_cvt_pk_bf16_f32 v58, v58, v62
    v_cvt_pk_bf16_f32 v59, v59, v63
    ds_write_b128 v20, v[56:59] offset:7936
    v_cvt_pk_bf16_f32 v64, v64, v68
    v_cvt_pk_bf16_f32 v65, v65, v69
    v_cvt_pk_bf16_f32 v66, v66, v70
    v_cvt_pk_bf16_f32 v67, v67, v71
    ds_write_b128 v20, v[64:67] offset:15872
    v_cvt_pk_bf16_f32 v80, v80, v84
    v_cvt_pk_bf16_f32 v81, v81, v85
    v_cvt_pk_bf16_f32 v82, v82, v86
    v_cvt_pk_bf16_f32 v83, v83, v87
    ds_write_b128 v20, v[80:83] offset:23808
    v_cvt_pk_bf16_f32 v88, v88, v92
    v_cvt_pk_bf16_f32 v89, v89, v93
    v_cvt_pk_bf16_f32 v90, v90, v94
    v_cvt_pk_bf16_f32 v91, v91, v95
    ds_write_b128 v20, v[88:91] offset:31744
    s_branch L_a1_post
L_g1D:
    global_load_dwordx4 v[96:99], v44, s[48:49] sc1
    global_load_dwordx4 v[176:179], v44, s[50:51] sc1
    global_load_dwordx4 v[100:103], v45, s[48:49] sc1
    global_load_dwordx4 v[180:183], v45, s[50:51] sc1
    global_load_dwordx4 v[104:107], v46, s[48:49] sc1
    global_load_dwordx4 v[184:187], v46, s[50:51] sc1
    global_load_dwordx4 v[108:111], v47, s[48:49] sc1
    global_load_dwordx4 v[188:191], v47, s[50:51] sc1
    s_add_u32 s48, s48, 4096
    s_addc_u32 s49, s49, 0
    s_add_u32 s50, s50, 4096
    s_addc_u32 s51, s51, 0
    s_waitcnt lgkmcnt(0)
    s_barrier
    global_load_dwordx4 v[112:115], v44, s[48:49] sc1
    global_load_dwordx4 v[192:195], v44, s[50:51] sc1
    global_load_dwordx4 v[116:119], v45, s[48:49] sc1
    global_load_dwordx4 v[196:199], v45, s[50:51] sc1
    global_load_dwordx4 v[120:123], v46, s[48:49] sc1
    global_load_dwordx4 v[200:203], v46, s[50:51] sc1
    global_load_dwordx4 v[124:127], v47, s[48:49] sc1
    global_load_dwordx4 v[204:207], v47, s[50:51] sc1
    s_add_u32 s48, s48, 4096
    s_addc_u32 s49, s49, 0
    s_add_u32 s50, s50, 4096
    s_addc_u32 s51, s51, 0
    ds_read_b128 v[16:19], v2 offset:0
    ds_read_b128 v[20:23], v2 offset:20480
    ds_read_b128 v[24:27], v2 offset:40960
    ds_read_b128 v[28:31], v2 offset:61440
    v_add_u32 v6, 81920, v2
    ds_read_b128 v[32:35], v6 offset:0
    ds_read_b128 v[36:39], v3 offset:0
    global_load_dwordx4 v[128:131], v44, s[48:49] sc1
    global_load_dwordx4 v[208:211], v44, s[50:51] sc1
    ds_read_b128 v[40:43], v3 offset:20480
    s_waitcnt vmcnt(16) lgkmcnt(6)
    v_mfma_f32_16x16x32_bf16 v[48:51], v[96:99], v[16:19], 0
    v_mfma_f32_16x16x32_bf16 v[52:55], v[176:179], v[16:19], 0
    v_mfma_f32_16x16x32_bf16 v[56:59], v[16:19], v[16:19], 0
    v_mfma_f32_16x16x32_bf16 v[60:63], v[10:13], v[16:19], 0
    ds_read_b128 v[16:19], v3 offset:40960
    s_waitcnt lgkmcnt(6)
    v_mfma_f32_16x16x32_bf16 v[64:67], v[96:99], v[20:23], 0
    v_mfma_f32_16x16x32_bf16 v[68:71], v[176:179], v[20:23], 0
    ds_read_b128 v[20:23], v3 offset:61440
    s_waitcnt lgkmcnt(6)
    v_mfma_f32_16x16x32_bf16 v[72:75], v[96:99], v[24:27], 0
    v_mfma_f32_16x16x32_bf16 v[76:79], v[176:179], v[24:27], 0
    v_add_u32 v6, 81920, v3
    ds_read_b128 v[24:27], v6 offset:0
    s_waitcnt lgkmcnt(6)
    v_mfma_f32_16x16x32_bf16 v[80:83], v[96:99], v[28:31], 0
    v_mfma_f32_16x16x32_bf16 v[84:87], v[176:179], v[28:31], 0
    ds_read_b128 v[28:31], v4 offset:0
    s_waitcnt lgkmcnt(6)
    v_mfma_f32_16x16x32_bf16 v[88:91], v[96:99], v[32:35], 0
    v_mfma_f32_16x16x32_bf16 v[92:95], v[176:179], v[32:35], 0
    global_load_dwordx4 v[132:135], v45, s[48:49] sc1
    global_load_dwordx4 v[212:215], v45, s[50:51] sc1
    ds_read_b128 v[32:35], v4 offset:20480
    s_waitcnt vmcnt(16) lgkmcnt(6)
    v_mfma_f32_16x16x32_bf16 v[48:51], v[100:103], v[36:39], v[48:51]
    v_mfma_f32_16x16x32_bf16 v[52:55], v[180:183], v[36:39], v[52:55]
    v_mfma_f32_16x16x32_bf16 v[56:59], v[36:39], v[36:39], v[56:59]
    v_mfma_f32_16x16x32_bf16 v[60:63], v[10:13], v[36:39], v[60:63]
    ds_read_b128 v[36:39], v4 offset:40960
    s_waitcnt lgkmcnt(6)
    v_mfma_f32_16x16x32_bf16 v[64:67], v[100:103], v[40:43], v[64:67]
    v_mfma_f32_16x16x32_bf16 v[68:71], v[180:183], v[40:43], v[68:71]
    ds_read_b128 v[40:43], v4 offset:61440
    s_waitcnt lgkmcnt(6)
    v_mfma_f32_16x16x32_bf16 v[72:75], v[100:103], v[16:19], v[72:75]
    v_mfma_f32_16x16x32_bf16 v[76:79], v[180:183], v[16:19], v[76:79]
    v_add_u32 v6, 81920, v4
    ds_read_b128 v[16:19], v6 offset:0
    s_waitcnt lgkmcnt(6)
    v_mfma_f32_16x16x32_bf16 v[80:83], v[100:103], v[20:23], v[80:83]
    v_mfma_f32_16x16x32_bf16 v[84:87], v[180:183], v[20:23], v[84:87]
    ds_read_b128 v[20:23], v5 offset:0
    s_waitcnt lgkmcnt(6)
    v_mfma_f32_16x16x32_bf16 v[88:91], v[100:103], v[24:27], v[88:91]
    v_mfma_f32_16x16x32_bf16 v[92:95], v[180:183], v[24:27], v[92:95]
    global_load_dwordx4 v[136:139], v46, s[48:49] sc1
    global_load_dwordx4 v[216:219], v46, s[50:51] sc1
    ds_read_b128 v[24:27], v5 offset:20480
    s_waitcnt vmcnt(16) lgkmcnt(6)
    v_mfma_f32_16x16x32_bf16 v[48:51], v[104:107], v[28:31], v[48:51]
    v_mfma_f32_16x16x32_bf16 v[52:55], v[184:187], v[28:31], v[52:55]
    v_mfma_f32_16x16x32_bf16 v[56:59], v[28:31], v[28:31], v[56:59]
    v_mfma_f32_16x16x32_bf16 v[60:63], v[10:13], v[28:31], v[60:63]
    ds_read_b128 v[28:31], v5 offset:40960
    s_waitcnt lgkmcnt(6)
    v_mfma_f32_16x16x32_bf16 v[64:67], v[104:107], v[32:35], v[64:67]
    v_mfma_f32_16x16x32_bf16 v[68:71], v[184:187], v[32:35], v[68:71]
    ds_read_b128 v[32:35], v5 offset:61440
    s_waitcnt lgkmcnt(6)
    v_mfma_f32_16x16x32_bf16 v[72:75], v[104:107], v[36:39], v[72:75]
    v_mfma_f32_16x16x32_bf16 v[76:79], v[184:187], v[36:39], v[76:79]
    v_add_u32 v6, 81920, v5
    ds_read_b128 v[36:39], v6 offset:0
    s_waitcnt lgkmcnt(6)
    v_mfma_f32_16x16x32_bf16 v[80:83], v[104:107], v[40:43], v[80:83]
    v_mfma_f32_16x16x32_bf16 v[84:87], v[184:187], v[40:43], v[84:87]
    ds_read_b128 v[40:43], v2 offset:256
    s_waitcnt lgkmcnt(6)
    v_mfma_f32_16x16x32_bf16 v[88:91], v[104:107], v[16:19], v[88:91]
    v_mfma_f32_16x16x32_bf16 v[92:95], v[184:187], v[16:19], v[92:95]
    global_load_dwordx4 v[140:143], v47, s[48:49] sc1
    global_load_dwordx4 v[220:223], v47, s[50:51] sc1
    s_add_u32 s48, s48, 4096
    s_addc_u32 s49, s49, 0
    s_add_u32 s50, s50, 4096
    s_addc_u32 s51, s51, 0
    ds_read_b128 v[16:19], v2 offset:20736
    s_waitcnt vmcnt(16) lgkmcnt(6)
    v_mfma_f32_16x16x32_bf16 v[48:51], v[108:111], v[20:23], v[48:51]
    v_mfma_f32_16x16x32_bf16 v[52:55], v[188:191], v[20:23], v[52:55]
    v_mfma_f32_16x16x32_bf16 v[56:59], v[20:23], v[20:23], v[56:59]
    v_mfma_f32_16x16x32_bf16 v[60:63], v[10:13], v[20:23], v[60:63]
    ds_read_b128 v[20:23], v2 offset:41216
    s_waitcnt lgkmcnt(6)
    v_mfma_f32_16x16x32_bf16 v[64:67], v[108:111], v[24:27], v[64:67]
    v_mfma_f32_16x16x32_bf16 v[68:71], v[188:191], v[24:27], v[68:71]
    ds_read_b128 v[24:27], v2 offset:61696
    s_waitcnt lgkmcnt(6)
    v_mfma_f32_16x16x32_bf16 v[72:75], v[108:111], v[28:31], v[72:75]
    v_mfma_f32_16x16x32_bf16 v[76:79], v[188:191], v[28:31], v[76:79]
    v_add_u32 v6, 81920, v2
    ds_read_b128 v[28:31], v6 offset:256
    s_waitcnt lgkmcnt(6)
    v_mfma_f32_16x16x32_bf16 v[80:83], v[108:111], v[32:35], v[80:83]
    v_mfma_f32_16x16x32_bf16 v[84:87], v[188:191], v[32:35], v[84:87]
    ds_read_b128 v[32:35], v3 offset:256
    s_waitcnt lgkmcnt(6)
    v_mfma_f32_16x16x32_bf16 v[88:91], v[108:111], v[36:39], v[88:91]
    v_mfma_f32_16x16x32_bf16 v[92:95], v[188:191], v[36:39], v[92:95]
    global_load_dwordx4 v[144:147], v44, s[48:49] sc1
    global_load_dwordx4 v[224:227], v44, s[50:51] sc1
    ds_read_b128 v[36:39], v3 offset:20736
    s_waitcnt vmcnt(16) lgkmcnt(6)
    v_mfma_f32_16x16x32_bf16 v[48:51], v[112:115], v[40:43], v[48:51]
    v_mfma_f32_16x16x32_bf16 v[52:55], v[192:195], v[40:43], v[52:55]
    v_mfma_f32_16x16x32_bf16 v[56:59], v[40:43], v[40:43], v[56:59]
    v_mfma_f32_16x16x32_bf16 v[60:63], v[10:13], v[40:43], v[60:63]
    ds_read_b128 v[40:43], v3 offset:41216
    s_waitcnt lgkmcnt(6)
    v_mfma_f32_16x16x32_bf16 v[64:67], v[112:115], v[16:19], v[64:67]
    v_mfma_f32_16x16x32_bf16 v[68:71], v[192:195], v[16:19], v[68:71]
    ds_read_b128 v[16:19], v3 offset:61696
    s_waitcnt lgkmcnt(6)
    v_mfma_f32_16x16x32_bf16 v[72:75], v[112:115], v[20:23], v[72:75]
    v_mfma_f32_16x16x32_bf16 v[76:79], v[192:195], v[20:23], v[76:79]
    v_add_u32 v6, 81920, v3
    ds_read_b128 v[20:23], v6 offset:256
    s_waitcnt lgkmcnt(6)
    v_mfma_f32_16x16x32_bf16 v[80:83], v[112:115], v[24:27], v[80:83]
    v_mfma_f32_16x16x32_bf16 v[84:87], v[192:195], v[24:27], v[84:87]
    ds_read_b128 v[24:27], v4 offset:256
    s_waitcnt lgkmcnt(6)
    v_mfma_f32_16x16x32_bf16 v[88:91], v[112:115], v[28:31], v[88:91]
    v_mfma_f32_16x16x32_bf16 v[92:95], v[192:195], v[28:31], v[92:95]
    global_load_dwordx4 v[148:151], v45, s[48:49] sc1
    global_load_dwordx4 v[228:231], v45, s[50:51] sc1
    ds_read_b128 v[28:31], v4 offset:20736
    s_waitcnt vmcnt(16) lgkmcnt(6)
    v_mfma_f32_16x16x32_bf16 v[48:51], v[116:119], v[32:35], v[48:51]
    v_mfma_f32_16x16x32_bf16 v[52:55], v[196:199], v[32:35], v[52:55]
    v_mfma_f32_16x16x32_bf16 v[56:59], v[32:35], v[32:35], v[56:59]
    v_mfma_f32_16x16x32_bf16 v[60:63], v[10:13], v[32:35], v[60:63]
    ds_read_b128 v[32:35], v4 offset:41216
    s_waitcnt lgkmcnt(6)
    v_mfma_f32_16x16x32_bf16 v[64:67], v[116:119], v[36:39], v[64:67]
    v_mfma_f32_16x16x32_bf16 v[68:71], v[196:199], v[36:39], v[68:71]
    ds_read_b128 v[36:39], v4 offset:61696
    s_waitcnt lgkmcnt(6)
    v_mfma_f32_16x16x32_bf16 v[72:75], v[116:119], v[40:43], v[72:75]
    v_mfma_f32_16x16x32_bf16 v[76:79], v[196:199], v[40:43], v[76:79]
    v_add_u32 v6, 81920, v4
    ds_read_b128 v[40:43], v6 offset:256
    s_waitcnt lgkmcnt(6)
    v_mfma_f32_16x16x32_bf16 v[80:83], v[116:119], v[16:19], v[80:83]
    v_mfma_f32_16x16x32_bf16 v[84:87], v[196:199], v[16:19], v[84:87]
    ds_read_b128 v[16:19], v5 offset:256
    s_waitcnt lgkmcnt(6)
    v_mfma_f32_16x16x32_bf16 v[88:91], v[116:119], v[20:23], v[88:91]
    v_mfma_f32_16x16x32_bf16 v[92:95], v[196:199], v[20:23], v[92:95]
    global_load_dwordx4 v[152:155], v46, s[48:49] sc1
    global_load_dwordx4 v[232:235], v46, s[50:51] sc1
    ds_read_b128 v[20:23], v5 offset:20736
    s_waitcnt vmcnt(16) lgkmcnt(6)
    v_mfma_f32_16x16x32_bf16 v[48:51], v[120:123], v[24:27], v[48:51]
    v_mfma_f32_16x16x32_bf16 v[52:55], v[200:203], v[24:27], v[52:55]
    v_mfma_f32_16x16x32_bf16 v[56:59], v[24:27], v[24:27], v[56:59]
    v_mfma_f32_16x16x32_bf16 v[60:63], v[10:13], v[24:27], v[60:63]
    ds_read_b128 v[24:27], v5 offset:41216
    s_waitcnt lgkmcnt(6)
    v_mfma_f32_16x16x32_bf16 v[64:67], v[120:123], v[28:31], v[64:67]
    v_mfma_f32_16x16x32_bf16 v[68:71], v[200:203], v[28:31], v[68:71]
    ds_read_b128 v[28:31], v5 offset:61696
    s_waitcnt lgkmcnt(6)
    v_mfma_f32_16x16x32_bf16 v[72:75], v[120:123], v[32:35], v[72:75]
    v_mfma_f32_16x16x32_bf16 v[76:79], v[200:203], v[32:35], v[76:79]
    v_add_u32 v6, 81920, v5
    ds_read_b128 v[32:35], v6 offset:256
    s_waitcnt lgkmcnt(6)
    v_mfma_f32_16x16x32_bf16 v[80:83], v[120:123], v[36:39], v[80:83]
    v_mfma_f32_16x16x32_bf16 v[84:87], v[200:203], v[36:39], v[84:87]
    ds_read_b128 v[36:39], v2 offset:512
    s_waitcnt lgkmcnt(6)
    v_mfma_f32_16x16x32_bf16 v[88:91], v[120:123], v[40:43], v[88:91]
    v_mfma_f32_16x16x32_bf16 v[92:95], v[200:203], v[40:43], v[92:95]
    global_load_dwordx4 v[156:159], v47, s[48:49] sc1
    global_load_dwordx4 v[236:239], v47, s[50:51] sc1
    s_add_u32 s48, s48, 4096
    s_addc_u32 s49, s49, 0
    s_add_u32 s50, s50, 4096
    s_addc_u32 s51, s51, 0
    ds_read_b128 v[40:43], v2 offset:20992
    s_waitcnt vmcnt(16) lgkmcnt(6)
    v_mfma_f32_16x16x32_bf16 v[48:51], v[124:127], v[16:19], v[48:51]
    v_mfma_f32_16x16x32_bf16 v[52:55], v[204:207], v[16:19], v[52:55]
    v_mfma_f32_16x16x32_bf16 v[56:59], v[16:19], v[16:19], v[56:59]
    v_mfma_f32_16x16x32_bf16 v[60:63], v[10:13], v[16:19], v[60:63]
    ds_read_b128 v[16:19], v2 offset:41472
    s_waitcnt lgkmcnt(6)
    v_mfma_f32_16x16x32_bf16 v[64:67], v[124:127], v[20:23], v[64:67]
    v_mfma_f32_16x16x32_bf16 v[68:71], v[204:207], v[20:23], v[68:71]
    ds_read_b128 v[20:23], v2 offset:61952
    s_waitcnt lgkmcnt(6)
    v_mfma_f32_16x16x32_bf16 v[72:75], v[124:127], v[24:27], v[72:75]
    v_mfma_f32_16x16x32_bf16 v[76:79], v[204:207], v[24:27], v[76:79]
    v_add_u32 v6, 81920, v2
    ds_read_b128 v[24:27], v6 offset:512
    s_waitcnt lgkmcnt(6)
    v_mfma_f32_16x16x32_bf16 v[80:83], v[124:127], v[28:31], v[80:83]
    v_mfma_f32_16x16x32_bf16 v[84:87], v[204:207], v[28:31], v[84:87]
    ds_read_b128 v[28:31], v3 offset:512
    s_waitcnt lgkmcnt(6)
    v_mfma_f32_16x16x32_bf16 v[88:91], v[124:127], v[32:35], v[88:91]
    v_mfma_f32_16x16x32_bf16 v[92:95], v[204:207], v[32:35], v[92:95]
    global_load_dwordx4 v[160:163], v44, s[48:49] sc1
    global_load_dwordx4 v[240:243], v44, s[50:51] sc1
    ds_read_b128 v[32:35], v3 offset:20992
    s_waitcnt vmcnt(16) lgkmcnt(6)
    v_mfma_f32_16x16x32_bf16 v[48:51], v[128:131], v[36:39], v[48:51]
    v_mfma_f32_16x16x32_bf16 v[52:55], v[208:211], v[36:39], v[52:55]
    v_mfma_f32_16x16x32_bf16 v[56:59], v[36:39], v[36:39], v[56:59]
    v_mfma_f32_16x16x32_bf16 v[60:63], v[10:13], v[36:39], v[60:63]
    ds_read_b128 v[36:39], v3 offset:41472
    s_waitcnt lgkmcnt(6)
    v_mfma_f32_16x16x32_bf16 v[64:67], v[128:131], v[40:43], v[64:67]
    v_mfma_f32_16x16x32_bf16 v[68:71], v[208:211], v[40:43], v[68:71]
    ds_read_b128 v[40:43], v3 offset:61952
    s_waitcnt lgkmcnt(6)
    v_mfma_f32_16x16x32_bf16 v[72:75], v[128:131], v[16:19], v[72:75]
    v_mfma_f32_16x16x32_bf16 v[76:79], v[208:211], v[16:19], v[76:79]
    v_add_u32 v6, 81920, v3
    ds_read_b128 v[16:19], v6 offset:512
    s_waitcnt lgkmcnt(6)
    v_mfma_f32_16x16x32_bf16 v[80:83], v[128:131], v[20:23], v[80:83]
    v_mfma_f32_16x16x32_bf16 v[84:87], v[208:211], v[20:23], v[84:87]
    ds_read_b128 v[20:23], v4 offset:512
    s_waitcnt lgkmcnt(6)
    v_mfma_f32_16x16x32_bf16 v[88:91], v[128:131], v[24:27], v[88:91]
    v_mfma_f32_16x16x32_bf16 v[92:95], v[208:211], v[24:27], v[92:95]
    global_load_dwordx4 v[164:167], v45, s[48:49] sc1
    global_load_dwordx4 v[244:247], v45, s[50:51] sc1
    ds_read_b128 v[24:27], v4 offset:20992
    s_waitcnt vmcnt(16) lgkmcnt(6)
    v_mfma_f32_16x16x32_bf16 v[48:51], v[132:135], v[28:31], v[48:51]
    v_mfma_f32_16x16x32_bf16 v[52:55], v[212:215], v[28:31], v[52:55]
    v_mfma_f32_16x16x32_bf16 v[56:59], v[28:31], v[28:31], v[56:59]
    v_mfma_f32_16x16x32_bf16 v[60:63], v[10:13], v[28:31], v[60:63]
    ds_read_b128 v[28:31], v4 offset:41472
    s_waitcnt lgkmcnt(6)
    v_mfma_f32_16x16x32_bf16 v[64:67], v[132:135], v[32:35], v[64:67]
    v_mfma_f32_16x16x32_bf16 v[68:71], v[212:215], v[32:35], v[68:71]
    ds_read_b128 v[32:35], v4 offset:61952
    s_waitcnt lgkmcnt(6)
    v_mfma_f32_16x16x32_bf16 v[72:75], v[132:135], v[36:39], v[72:75]
    v_mfma_f32_16x16x32_bf16 v[76:79], v[212:215], v[36:39], v[76:79]
    v_add_u32 v6, 81920, v4
    ds_read_b128 v[36:39], v6 offset:512
    s_waitcnt lgkmcnt(6)
    v_mfma_f32_16x16x32_bf16 v[80:83], v[132:135], v[40:43], v[80:83]
    v_mfma_f32_16x16x32_bf16 v[84:87], v[212:215], v[40:43], v[84:87]
    ds_read_b128 v[40:43], v5 offset:512
    s_waitcnt lgkmcnt(6)
    v_mfma_f32_16x16x32_bf16 v[88:91], v[132:135], v[16:19], v[88:91]
    v_mfma_f32_16x16x32_bf16 v[92:95], v[212:215], v[16:19], v[92:95]
    global_load_dwordx4 v[168:171], v46, s[48:49] sc1
    global_load_dwordx4 v[248:251], v46, s[50:51] sc1
    ds_read_b128 v[16:19], v5 offset:20992
    s_waitcnt vmcnt(16) lgkmcnt(6)
    v_mfma_f32_16x16x32_bf16 v[48:51], v[136:139], v[20:23], v[48:51]
    v_mfma_f32_16x16x32_bf16 v[52:55], v[216:219], v[20:23], v[52:55]
    v_mfma_f32_16x16x32_bf16 v[56:59], v[20:23], v[20:23], v[56:59]
    v_mfma_f32_16x16x32_bf16 v[60:63], v[10:13], v[20:23], v[60:63]
    ds_read_b128 v[20:23], v5 offset:41472
    s_waitcnt lgkmcnt(6)
    v_mfma_f32_16x16x32_bf16 v[64:67], v[136:139], v[24:27], v[64:67]
    v_mfma_f32_16x16x32_bf16 v[68:71], v[216:219], v[24:27], v[68:71]
    ds_read_b128 v[24:27], v5 offset:61952
    s_waitcnt lgkmcnt(6)
    v_mfma_f32_16x16x32_bf16 v[72:75], v[136:139], v[28:31], v[72:75]
    v_mfma_f32_16x16x32_bf16 v[76:79], v[216:219], v[28:31], v[76:79]
    v_add_u32 v6, 81920, v5
    ds_read_b128 v[28:31], v6 offset:512
    s_waitcnt lgkmcnt(6)
    v_mfma_f32_16x16x32_bf16 v[80:83], v[136:139], v[32:35], v[80:83]
    v_mfma_f32_16x16x32_bf16 v[84:87], v[216:219], v[32:35], v[84:87]
    ds_read_b128 v[32:35], v2 offset:768
    s_waitcnt lgkmcnt(6)
    v_mfma_f32_16x16x32_bf16 v[88:91], v[136:139], v[36:39], v[88:91]
    v_mfma_f32_16x16x32_bf16 v[92:95], v[216:219], v[36:39], v[92:95]
    global_load_dwordx4 v[172:175], v47, s[48:49] sc1
    global_load_dwordx4 v[252:255], v47, s[50:51] sc1
    ds_read_b128 v[36:39], v2 offset:21248
    s_waitcnt vmcnt(16) lgkmcnt(6)
    v_mfma_f32_16x16x32_bf16 v[48:51], v[140:143], v[40:43], v[48:51]
    v_mfma_f32_16x16x32_bf16 v[52:55], v[220:223], v[40:43], v[52:55]
    v_mfma_f32_16x16x32_bf16 v[56:59], v[40:43], v[40:43], v[56:59]
    v_mfma_f32_16x16x32_bf16 v[60:63], v[10:13], v[40:43], v[60:63]
    ds_read_b128 v[40:43], v2 offset:41728
    s_waitcnt lgkmcnt(6)
    v_mfma_f32_16x16x32_bf16 v[64:67], v[140:143], v[16:19], v[64:67]
    v_mfma_f32_16x16x32_bf16 v[68:71], v[220:223], v[16:19], v[68:71]
    ds_read_b128 v[16:19], v2 offset:62208
    s_waitcnt lgkmcnt(6)
    v_mfma_f32_16x16x32_bf16 v[72:75], v[140:143], v[20:23], v[72:75]
    v_mfma_f32_16x16x32_bf16 v[76:79], v[220:223], v[20:23], v[76:79]
    v_add_u32 v6, 81920, v2
    ds_read_b128 v[20:23], v6 offset:768
    s_waitcnt lgkmcnt(6)
    v_mfma_f32_16x16x32_bf16 v[80:83], v[140:143], v[24:27], v[80:83]
    v_mfma_f32_16x16x32_bf16 v[84:87], v[220:223], v[24:27], v[84:87]
    ds_read_b128 v[24:27], v3 offset:768
    s_waitcnt lgkmcnt(6)
    v_mfma_f32_16x16x32_bf16 v[88:91], v[140:143], v[28:31], v[88:91]
    v_mfma_f32_16x16x32_bf16 v[92:95], v[220:223], v[28:31], v[92:95]
    ds_read_b128 v[28:31], v3 offset:21248
    s_waitcnt vmcnt(14) lgkmcnt(6)
    v_mfma_f32_16x16x32_bf16 v[48:51], v[144:147], v[32:35], v[48:51]
    v_mfma_f32_16x16x32_bf16 v[52:55], v[224:227], v[32:35], v[52:55]
    v_mfma_f32_16x16x32_bf16 v[56:59], v[32:35], v[32:35], v[56:59]
    v_mfma_f32_16x16x32_bf16 v[60:63], v[10:13], v[32:35], v[60:63]
    ds_read_b128 v[32:35], v3 offset:41728
    s_waitcnt lgkmcnt(6)
    v_mfma_f32_16x16x32_bf16 v[64:67], v[144:147], v[36:39], v[64:67]
    v_mfma_f32_16x16x32_bf16 v[68:71], v[224:227], v[36:39], v[68:71]
    ds_read_b128 v[36:39], v3 offset:62208
    s_waitcnt lgkmcnt(6)
    v_mfma_f32_16x16x32_bf16 v[72:75], v[144:147], v[40:43], v[72:75]
    v_mfma_f32_16x16x32_bf16 v[76:79], v[224:227], v[40:43], v[76:79]
    v_add_u32 v6, 81920, v3
    ds_read_b128 v[40:43], v6 offset:768
    s_waitcnt lgkmcnt(6)
    v_mfma_f32_16x16x32_bf16 v[80:83], v[144:147], v[16:19], v[80:83]
    v_mfma_f32_16x16x32_bf16 v[84:87], v[224:227], v[16:19], v[84:87]
    ds_read_b128 v[16:19], v4 offset:768
    s_waitcnt lgkmcnt(6)
    v_mfma_f32_16x16x32_bf16 v[88:91], v[144:147], v[20:23], v[88:91]
    v_mfma_f32_16x16x32_bf16 v[92:95], v[224:227], v[20:23], v[92:95]
    ds_read_b128 v[20:23], v4 offset:21248
    s_waitcnt vmcnt(12) lgkmcnt(6)
    v_mfma_f32_16x16x32_bf16 v[48:51], v[148:151], v[24:27], v[48:51]
    v_mfma_f32_16x16x32_bf16 v[52:55], v[228:231], v[24:27], v[52:55]
    v_mfma_f32_16x16x32_bf16 v[56:59], v[24:27], v[24:27], v[56:59]
    v_mfma_f32_16x16x32_bf16 v[60:63], v[10:13], v[24:27], v[60:63]
    ds_read_b128 v[24:27], v4 offset:41728
    s_waitcnt lgkmcnt(6)
    v_mfma_f32_16x16x32_bf16 v[64:67], v[148:151], v[28:31], v[64:67]
    v_mfma_f32_16x16x32_bf16 v[68:71], v[228:231], v[28:31], v[68:71]
    ds_read_b128 v[28:31], v4 offset:62208
    s_waitcnt lgkmcnt(6)
    v_mfma_f32_16x16x32_bf16 v[72:75], v[148:151], v[32:35], v[72:75]
    v_mfma_f32_16x16x32_bf16 v[76:79], v[228:231], v[32:35], v[76:79]
    v_add_u32 v6, 81920, v4
    ds_read_b128 v[32:35], v6 offset:768
    s_waitcnt lgkmcnt(6)
    v_mfma_f32_16x16x32_bf16 v[80:83], v[148:151], v[36:39], v[80:83]
    v_mfma_f32_16x16x32_bf16 v[84:87], v[228:231], v[36:39], v[84:87]
    ds_read_b128 v[36:39], v5 offset:768
    s_waitcnt lgkmcnt(6)
    v_mfma_f32_16x16x32_bf16 v[88:91], v[148:151], v[40:43], v[88:91]
    v_mfma_f32_16x16x32_bf16 v[92:95], v[228:231], v[40:43], v[92:95]
    ds_read_b128 v[40:43], v5 offset:21248
    s_waitcnt vmcnt(10) lgkmcnt(6)
    v_mfma_f32_16x16x32_bf16 v[48:51], v[152:155], v[16:19], v[48:51]
    v_mfma_f32_16x16x32_bf16 v[52:55], v[232:235], v[16:19], v[52:55]
    v_mfma_f32_16x16x32_bf16 v[56:59], v[16:19], v[16:19], v[56:59]
    v_mfma_f32_16x16x32_bf16 v[60:63], v[10:13], v[16:19], v[60:63]
    ds_read_b128 v[16:19], v5 offset:41728
    s_waitcnt lgkmcnt(6)
    v_mfma_f32_16x16x32_bf16 v[64:67], v[152:155], v[20:23], v[64:67]
    v_mfma_f32_16x16x32_bf16 v[68:71], v[232:235], v[20:23], v[68:71]
    ds_read_b128 v[20:23], v5 offset:62208
    s_waitcnt lgkmcnt(6)
    v_mfma_f32_16x16x32_bf16 v[72:75], v[152:155], v[24:27], v[72:75]
    v_mfma_f32_16x16x32_bf16 v[76:79], v[232:235], v[24:27], v[76:79]
    v_add_u32 v6, 81920, v5
    ds_read_b128 v[24:27], v6 offset:768
    s_waitcnt lgkmcnt(6)
    v_mfma_f32_16x16x32_bf16 v[80:83], v[152:155], v[28:31], v[80:83]
    v_mfma_f32_16x16x32_bf16 v[84:87], v[232:235], v[28:31], v[84:87]
    ds_read_b128 v[28:31], v2 offset:1024
    s_waitcnt lgkmcnt(6)
    v_mfma_f32_16x16x32_bf16 v[88:91], v[152:155], v[32:35], v[88:91]
    v_mfma_f32_16x16x32_bf16 v[92:95], v[232:235], v[32:35], v[92:95]
    ds_read_b128 v[32:35], v2 offset:21504
    s_waitcnt vmcnt(8) lgkmcnt(6)
    v_mfma_f32_16x16x32_bf16 v[48:51], v[156:159], v[36:39], v[48:51]
    v_mfma_f32_16x16x32_bf16 v[52:55], v[236:239], v[36:39], v[52:55]
    v_mfma_f32_16x16x32_bf16 v[56:59], v[36:39], v[36:39], v[56:59]
    v_mfma_f32_16x16x32_bf16 v[60:63], v[10:13], v[36:39], v[60:63]
    ds_read_b128 v[36:39], v2 offset:41984
    s_waitcnt lgkmcnt(6)
    v_mfma_f32_16x16x32_bf16 v[64:67], v[156:159], v[40:43], v[64:67]
    v_mfma_f32_16x16x32_bf16 v[68:71], v[236:239], v[40:43], v[68:71]
    ds_read_b128 v[40:43], v2 offset:62464
    s_waitcnt lgkmcnt(6)
    v_mfma_f32_16x16x32_bf16 v[72:75], v[156:159], v[16:19], v[72:75]
    v_mfma_f32_16x16x32_bf16 v[76:79], v[236:239], v[16:19], v[76:79]
    v_add_u32 v6, 81920, v2
    ds_read_b128 v[16:19], v6 offset:1024
    s_waitcnt lgkmcnt(6)
    v_mfma_f32_16x16x32_bf16 v[80:83], v[156:159], v[20:23], v[80:83]
    v_mfma_f32_16x16x32_bf16 v[84:87], v[236:239], v[20:23], v[84:87]
    ds_read_b128 v[20:23], v3 offset:1024
    s_waitcnt lgkmcnt(6)
    v_mfma_f32_16x16x32_bf16 v[88:91], v[156:159], v[24:27], v[88:91]
    v_mfma_f32_16x16x32_bf16 v[92:95], v[236:239], v[24:27], v[92:95]
    ds_read_b128 v[24:27], v3 offset:21504
    s_waitcnt vmcnt(6) lgkmcnt(6)
    v_mfma_f32_16x16x32_bf16 v[48:51], v[160:163], v[28:31], v[48:51]
    v_mfma_f32_16x16x32_bf16 v[52:55], v[240:243], v[28:31], v[52:55]
    v_mfma_f32_16x16x32_bf16 v[56:59], v[28:31], v[28:31], v[56:59]
    v_mfma_f32_16x16x32_bf16 v[60:63], v[10:13], v[28:31], v[60:63]
    ds_read_b128 v[28:31], v3 offset:41984
    s_waitcnt lgkmcnt(6)
    v_mfma_f32_16x16x32_bf16 v[64:67], v[160:163], v[32:35], v[64:67]
    v_mfma_f32_16x16x32_bf16 v[68:71], v[240:243], v[32:35], v[68:71]
    ds_read_b128 v[32:35], v3 offset:62464
    s_waitcnt lgkmcnt(6)
    v_mfma_f32_16x16x32_bf16 v[72:75], v[160:163], v[36:39], v[72:75]
    v_mfma_f32_16x16x32_bf16 v[76:79], v[240:243], v[36:39], v[76:79]
    v_add_u32 v6, 81920, v3
    ds_read_b128 v[36:39], v6 offset:1024
    s_waitcnt lgkmcnt(6)
    v_mfma_f32_16x16x32_bf16 v[80:83], v[160:163], v[40:43], v[80:83]
    v_mfma_f32_16x16x32_bf16 v[84:87], v[240:243], v[40:43], v[84:87]
    ds_read_b128 v[40:43], v4 offset:1024
    s_waitcnt lgkmcnt(6)
    v_mfma_f32_16x16x32_bf16 v[88:91], v[160:163], v[16:19], v[88:91]
    v_mfma_f32_16x16x32_bf16 v[92:95], v[240:243], v[16:19], v[92:95]
    ds_read_b128 v[16:19], v4 offset:21504
    s_waitcnt vmcnt(4) lgkmcnt(6)
    v_mfma_f32_16x16x32_bf16 v[48:51], v[164:167], v[20:23], v[48:51]
    v_mfma_f32_16x16x32_bf16 v[52:55], v[244:247], v[20:23], v[52:55]
    v_mfma_f32_16x16x32_bf16 v[56:59], v[20:23], v[20:23], v[56:59]
    v_mfma_f32_16x16x32_bf16 v[60:63], v[10:13], v[20:23], v[60:63]
    ds_read_b128 v[20:23], v4 offset:41984
    s_waitcnt lgkmcnt(6)
    v_mfma_f32_16x16x32_bf16 v[64:67], v[164:167], v[24:27], v[64:67]
    v_mfma_f32_16x16x32_bf16 v[68:71], v[244:247], v[24:27], v[68:71]
    ds_read_b128 v[24:27], v4 offset:62464
    s_waitcnt lgkmcnt(6)
    v_mfma_f32_16x16x32_bf16 v[72:75], v[164:167], v[28:31], v[72:75]
    v_mfma_f32_16x16x32_bf16 v[76:79], v[244:247], v[28:31], v[76:79]
    v_add_u32 v6, 81920, v4
    ds_read_b128 v[28:31], v6 offset:1024
    s_waitcnt lgkmcnt(6)
    v_mfma_f32_16x16x32_bf16 v[80:83], v[164:167], v[32:35], v[80:83]
    v_mfma_f32_16x16x32_bf16 v[84:87], v[244:247], v[32:35], v[84:87]
    ds_read_b128 v[32:35], v5 offset:1024
    s_waitcnt lgkmcnt(6)
    v_mfma_f32_16x16x32_bf16 v[88:91], v[164:167], v[36:39], v[88:91]
    v_mfma_f32_16x16x32_bf16 v[92:95], v[244:247], v[36:39], v[92:95]
    ds_read_b128 v[36:39], v5 offset:21504
    s_waitcnt vmcnt(2) lgkmcnt(6)
    v_mfma_f32_16x16x32_bf16 v[48:51], v[168:171], v[40:43], v[48:51]
    v_mfma_f32_16x16x32_bf16 v[52:55], v[248:251], v[40:43], v[52:55]
    v_mfma_f32_16x16x32_bf16 v[56:59], v[40:43], v[40:43], v[56:59]
    v_mfma_f32_16x16x32_bf16 v[60:63], v[10:13], v[40:43], v[60:63]
    ds_read_b128 v[40:43], v5 offset:41984
    s_waitcnt lgkmcnt(6)
    v_mfma_f32_16x16x32_bf16 v[64:67], v[168:171], v[16:19], v[64:67]
    v_mfma_f32_16x16x32_bf16 v[68:71], v[248:251], v[16:19], v[68:71]
    ds_read_b128 v[16:19], v5 offset:62464
    s_waitcnt lgkmcnt(6)
    v_mfma_f32_16x16x32_bf16 v[72:75], v[168:171], v[20:23], v[72:75]
    v_mfma_f32_16x16x32_bf16 v[76:79], v[248:251], v[20:23], v[76:79]
    v_add_u32 v6, 81920, v5
    ds_read_b128 v[20:23], v6 offset:1024
    s_waitcnt lgkmcnt(6)
    v_mfma_f32_16x16x32_bf16 v[80:83], v[168:171], v[24:27], v[80:83]
    v_mfma_f32_16x16x32_bf16 v[84:87], v[248:251], v[24:27], v[84:87]
    s_waitcnt lgkmcnt(5)
    v_mfma_f32_16x16x32_bf16 v[88:91], v[168:171], v[28:31], v[88:91]
    v_mfma_f32_16x16x32_bf16 v[92:95], v[248:251], v[28:31], v[92:95]
    s_waitcnt vmcnt(0) lgkmcnt(4)
    v_mfma_f32_16x16x32_bf16 v[48:51], v[172:175], v[32:35], v[48:51]
    v_mfma_f32_16x16x32_bf16 v[52:55], v[252:255], v[32:35], v[52:55]
    v_mfma_f32_16x16x32_bf16 v[56:59], v[32:35], v[32:35], v[56:59]
    v_mfma_f32_16x16x32_bf16 v[60:63], v[10:13], v[32:35], v[60:63]
    s_waitcnt lgkmcnt(3)
    v_mfma_f32_16x16x32_bf16 v[64:67], v[172:175], v[36:39], v[64:67]
    v_mfma_f32_16x16x32_bf16 v[68:71], v[252:255], v[36:39], v[68:71]
    s_waitcnt lgkmcnt(2)
    v_mfma_f32_16x16x32_bf16 v[72:75], v[172:175], v[40:43], v[72:75]
    v_mfma_f32_16x16x32_bf16 v[76:79], v[252:255], v[40:43], v[76:79]
    s_waitcnt lgkmcnt(1)
    v_mfma_f32_16x16x32_bf16 v[80:83], v[172:175], v[16:19], v[80:83]
    v_mfma_f32_16x16x32_bf16 v[84:87], v[252:255], v[16:19], v[84:87]
    s_waitcnt lgkmcnt(0)
    v_mfma_f32_16x16x32_bf16 v[88:91], v[172:175], v[20:23], v[88:91]
    v_mfma_f32_16x16x32_bf16 v[92:95], v[252:255], v[20:23], v[92:95]
    ds_read_b64_tr_b16 v[10:11], v7
    ds_read_b64_tr_b16 v[12:13], v8
    ds_read_b64_tr_b16 v[14:15], v9
    v_and_b32 v16, 15, v1
    v_lshrrev_b32 v17, 4, v1
    v_and_b32 v18, 3, v1
    v_lshrrev_b32 v19, 2, v16
    v_cmp_eq_u32 s[42:43], 1, v18
    v_cmp_eq_u32 s[44:45], 2, v18
    v_cmp_eq_u32 s[46:47], 3, v18
    v_cmp_eq_u32 s[48:49], v19, v17
    v_lshlrev_b32 v18, 3, v16
    v_add_u32 v18, 45376, v18
    v_cndmask_b32 v56, v56, v57, s[42:43]
    v_cndmask_b32 v56, v56, v58, s[44:45]
    v_cndmask_b32 v56, v56, v59, s[46:47]
    v_mul_f32 v60, 0x3acccccd, v60
    v_mul_f32 v56, 0x3acccccd, v56
    v_fma_f32 v56, -v60, v60, v56
    v_max_f32 v56, 0, v56
    v_cvt_pk_bf16_f32 v60, v60, v56
    v_and_b32 v56, 0xffff0000, v60
    v_lshlrev_b32 v60, 16, v60
    v_add_f32 v56, 0x3727c5ac, v56
    v_cvt_pk_bf16_f32 v56, v56, v56
    v_lshlrev_b32 v56, 16, v56
    v_sqrt_f32 v56, v56
    s_nop 0
    v_cvt_pk_bf16_f32 v56, v56, v56
    v_lshlrev_b32 v56, 16, v56
    v_rcp_f32 v61, v56
    s_mov_b64 exec, s[48:49]
    ds_write_b64 v18, v[60:61] offset:0
    s_mov_b64 exec, -1
    s_lshl_b32 s42, s3, 7
    s_add_u32 s42, s42, 46016
    v_lshl_add_u32 v19, v17, 4, s42
    s_mov_b64 exec, 0x10001
    s_mov_b32 exec_hi, 0x10001
    ds_write_b128 v19, v[48:51] offset:0
    ds_write_b128 v19, v[52:55] offset:64
    s_mov_b64 exec, -1
    s_lshl_b32 s42, s3, 6
    s_cmp_eq_u32 s3, 2
    s_cselect_b32 s42, 192, s42
    s_cmp_eq_u32 s3, 3
    s_cselect_b32 s42, 128, s42
    s_add_u32 s42, s42, 61440
    v_mul_u32_u24 v20, 496, v16
    v_lshl_add_u32 v20, v17, 3, v20
    v_add_u32 v20, s42, v20
    v_lshlrev_b32 v18, 3, v16
    v_add_u32 v18, 45376, v18
    s_waitcnt lgkmcnt(0)
    s_barrier
    ds_read_b64 v[24:25], v18 offset:0
    ds_read_b64 v[26:27], v18 offset:128
    ds_read_b64 v[28:29], v18 offset:256
    ds_read_b64 v[30:31], v18 offset:384
    ds_read_b64 v[32:33], v18 offset:512
    ds_read_b128 v[36:39], v19 offset:0
    ds_read_b128 v[40:43], v19 offset:64
    s_waitcnt lgkmcnt(0)
    v_fma_f32 v52, -v24, v40, v52
    v_fma_f32 v53, -v24, v41, v53
    v_fma_f32 v54, -v24, v42, v54
    v_fma_f32 v55, -v24, v43, v55
    v_fma_f32 v64, -v26, v36, v64
    v_fma_f32 v65, -v26, v37, v65
    v_fma_f32 v66, -v26, v38, v66
    v_fma_f32 v67, -v26, v39, v67
    v_fma_f32 v68, -v26, v40, v68
    v_fma_f32 v69, -v26, v41, v69
    v_fma_f32 v70, -v26, v42, v70
    v_fma_f32 v71, -v26, v43, v71
    v_fma_f32 v72, -v28, v36, v72
    v_fma_f32 v73, -v28, v37, v73
    v_fma_f32 v74, -v28, v38, v74
    v_fma_f32 v75, -v28, v39, v75
    v_fma_f32 v76, -v28, v40, v76
    v_fma_f32 v77, -v28, v41, v77
    v_fma_f32 v78, -v28, v42, v78
    v_fma_f32 v79, -v28, v43, v79
    v_fma_f32 v80, -v30, v36, v80
    v_fma_f32 v81, -v30, v37, v81
    v_fma_f32 v82, -v30, v38, v82
    v_fma_f32 v83, -v30, v39, v83
    v_fma_f32 v84, -v30, v40, v84
    v_fma_f32 v85, -v30, v41, v85
    v_fma_f32 v86, -v30, v42, v86
    v_fma_f32 v87, -v30, v43, v87
    v_fma_f32 v88, -v32, v36, v88
    v_fma_f32 v89, -v32, v37, v89
    v_fma_f32 v90, -v32, v38, v90
    v_fma_f32 v91, -v32, v39, v91
    v_fma_f32 v92, -v32, v40, v92
    v_fma_f32 v93, -v32, v41, v93
    v_fma_f32 v94, -v32, v42, v94
    v_fma_f32 v95, -v32, v43, v95
    v_mul_f32 v52, v52, v25
    v_mul_f32 v53, v53, v25
    v_mul_f32 v54, v54, v25
    v_mul_f32 v55, v55, v25
    v_mul_f32 v64, v64, v27
    v_mul_f32 v65, v65, v27
    v_mul_f32 v66, v66, v27
    v_mul_f32 v67, v67, v27
    v_mul_f32 v68, v68, v27
    v_mul_f32 v69, v69, v27
    v_mul_f32 v70, v70, v27
    v_mul_f32 v71, v71, v27
    v_mul_f32 v72, v72, v29
    v_mul_f32 v73, v73, v29
    v_mul_f32 v74, v74, v29
    v_mul_f32 v75, v75, v29
    v_mul_f32 v76, v76, v29
    v_mul_f32 v77, v77, v29
    v_mul_f32 v78, v78, v29
    v_mul_f32 v79, v79, v29
    v_mul_f32 v80, v80, v31
    v_mul_f32 v81, v81, v31
    v_mul_f32 v82, v82, v31
    v_mul_f32 v83, v83, v31
    v_mul_f32 v84, v84, v31
    v_mul_f32 v85, v85, v31
    v_mul_f32 v86, v86, v31
    v_mul_f32 v87, v87, v31
    v_mul_f32 v88, v88, v33
    v_mul_f32 v89, v89, v33
    v_mul_f32 v90, v90, v33
    v_mul_f32 v91, v91, v33
    v_mul_f32 v92, v92, v33
    v_mul_f32 v93, v93, v33
    v_mul_f32 v94, v94, v33
    v_mul_f32 v95, v95, v33
    v_cvt_pk_bf16_f32 v52, v52, v53
    v_cvt_pk_bf16_f32 v53, v54, v55
    ds_write_b64 v20, v[52:53] offset:32
    v_cvt_pk_bf16_f32 v64, v64, v65
    v_cvt_pk_bf16_f32 v65, v66, v67
    ds_write_b64 v20, v[64:65] offset:7936
    v_cvt_pk_bf16_f32 v68, v68, v69
    v_cvt_pk_bf16_f32 v69, v70, v71
    ds_write_b64 v20, v[68:69] offset:7968
    v_cvt_pk_bf16_f32 v72, v72, v73
    v_cvt_pk_bf16_f32 v73, v74, v75
    ds_write_b64 v20, v[72:73] offset:15872
    v_cvt_pk_bf16_f32 v76, v76, v77
    v_cvt_pk_bf16_f32 v77, v78, v79
    ds_write_b64 v20, v[76:77] offset:15904
    v_cvt_pk_bf16_f32 v80, v80, v81
    v_cvt_pk_bf16_f32 v81, v82, v83
    ds_write_b64 v20, v[80:81] offset:23808
    v_cvt_pk_bf16_f32 v84, v84, v85
    v_cvt_pk_bf16_f32 v85, v86, v87
    ds_write_b64 v20, v[84:85] offset:23840
    v_cvt_pk_bf16_f32 v88, v88, v89
    v_cvt_pk_bf16_f32 v89, v90, v91
    ds_write_b64 v20, v[88:89] offset:31744
    v_cvt_pk_bf16_f32 v92, v92, v93
    v_cvt_pk_bf16_f32 v93, v94, v95
    ds_write_b64 v20, v[92:93] offset:31776
    s_branch L_a1_post
L_g1E:
    global_load_dwordx4 v[96:99], v44, s[48:49] sc1
    global_load_dwordx4 v[100:103], v45, s[48:49] sc1
    global_load_dwordx4 v[104:107], v46, s[48:49] sc1
    global_load_dwordx4 v[108:111], v47, s[48:49] sc1
    s_add_u32 s48, s48, 4096
    s_addc_u32 s49, s49, 0
    s_waitcnt lgkmcnt(0)
    s_barrier
    global_load_dwordx4 v[112:115], v44, s[48:49] sc1
    global_load_dwordx4 v[116:119], v45, s[48:49] sc1
    global_load_dwordx4 v[120:123], v46, s[48:49] sc1
    global_load_dwordx4 v[124:127], v47, s[48:49] sc1
    s_add_u32 s48, s48, 4096
    s_addc_u32 s49, s49, 0
    ds_read_b128 v[16:19], v2 offset:0
    ds_read_b128 v[20:23], v2 offset:20480
    ds_read_b128 v[24:27], v2 offset:40960
    ds_read_b128 v[28:31], v2 offset:61440
    v_add_u32 v6, 81920, v2
    ds_read_b128 v[32:35], v6 offset:0
    ds_read_b128 v[36:39], v3 offset:0
    global_load_dwordx4 v[128:131], v44, s[48:49] sc1
    ds_read_b128 v[40:43], v3 offset:20480
    s_waitcnt vmcnt(8) lgkmcnt(6)
    v_mfma_f32_16x16x32_bf16 v[48:51], v[96:99], v[16:19], 0
    ds_read_b128 v[16:19], v3 offset:40960
    s_waitcnt lgkmcnt(6)
    v_mfma_f32_16x16x32_bf16 v[52:55], v[96:99], v[20:23], 0
    ds_read_b128 v[20:23], v3 offset:61440
    s_waitcnt lgkmcnt(6)
    v_mfma_f32_16x16x32_bf16 v[56:59], v[96:99], v[24:27], 0
    v_add_u32 v6, 81920, v3
    ds_read_b128 v[24:27], v6 offset:0
    s_waitcnt lgkmcnt(6)
    v_mfma_f32_16x16x32_bf16 v[60:63], v[96:99], v[28:31], 0
    v_mfma_f32_16x16x32_bf16 v[64:67], v[28:31], v[28:31], 0
    v_mfma_f32_16x16x32_bf16 v[68:71], v[10:13], v[28:31], 0
    ds_read_b128 v[28:31], v4 offset:0
    s_waitcnt lgkmcnt(6)
    v_mfma_f32_16x16x32_bf16 v[72:75], v[96:99], v[32:35], 0
    v_mfma_f32_16x16x32_bf16 v[76:79], v[32:35], v[32:35], 0
    v_mfma_f32_16x16x32_bf16 v[80:83], v[10:13], v[32:35], 0
    global_load_dwordx4 v[132:135], v45, s[48:49] sc1
    ds_read_b128 v[32:35], v4 offset:20480
    s_waitcnt vmcnt(8) lgkmcnt(6)
    v_mfma_f32_16x16x32_bf16 v[48:51], v[100:103], v[36:39], v[48:51]
    ds_read_b128 v[36:39], v4 offset:40960
    s_waitcnt lgkmcnt(6)
    v_mfma_f32_16x16x32_bf16 v[52:55], v[100:103], v[40:43], v[52:55]
    ds_read_b128 v[40:43], v4 offset:61440
    s_waitcnt lgkmcnt(6)
    v_mfma_f32_16x16x32_bf16 v[56:59], v[100:103], v[16:19], v[56:59]
    v_add_u32 v6, 81920, v4
    ds_read_b128 v[16:19], v6 offset:0
    s_waitcnt lgkmcnt(6)
    v_mfma_f32_16x16x32_bf16 v[60:63], v[100:103], v[20:23], v[60:63]
    v_mfma_f32_16x16x32_bf16 v[64:67], v[20:23], v[20:23], v[64:67]
    v_mfma_f32_16x16x32_bf16 v[68:71], v[10:13], v[20:23], v[68:71]
    ds_read_b128 v[20:23], v5 offset:0
    s_waitcnt lgkmcnt(6)
    v_mfma_f32_16x16x32_bf16 v[72:75], v[100:103], v[24:27], v[72:75]
    v_mfma_f32_16x16x32_bf16 v[76:79], v[24:27], v[24:27], v[76:79]
    v_mfma_f32_16x16x32_bf16 v[80:83], v[10:13], v[24:27], v[80:83]
    global_load_dwordx4 v[136:139], v46, s[48:49] sc1
    ds_read_b128 v[24:27], v5 offset:20480
    s_waitcnt vmcnt(8) lgkmcnt(6)
    v_mfma_f32_16x16x32_bf16 v[48:51], v[104:107], v[28:31], v[48:51]
    ds_read_b128 v[28:31], v5 offset:40960
    s_waitcnt lgkmcnt(6)
    v_mfma_f32_16x16x32_bf16 v[52:55], v[104:107], v[32:35], v[52:55]
    ds_read_b128 v[32:35], v5 offset:61440
    s_waitcnt lgkmcnt(6)
    v_mfma_f32_16x16x32_bf16 v[56:59], v[104:107], v[36:39], v[56:59]
    v_add_u32 v6, 81920, v5
    ds_read_b128 v[36:39], v6 offset:0
    s_waitcnt lgkmcnt(6)
    v_mfma_f32_16x16x32_bf16 v[60:63], v[104:107], v[40:43], v[60:63]
    v_mfma_f32_16x16x32_bf16 v[64:67], v[40:43], v[40:43], v[64:67]
    v_mfma_f32_16x16x32_bf16 v[68:71], v[10:13], v[40:43], v[68:71]
    ds_read_b128 v[40:43], v2 offset:256
    s_waitcnt lgkmcnt(6)
    v_mfma_f32_16x16x32_bf16 v[72:75], v[104:107], v[16:19], v[72:75]
    v_mfma_f32_16x16x32_bf16 v[76:79], v[16:19], v[16:19], v[76:79]
    v_mfma_f32_16x16x32_bf16 v[80:83], v[10:13], v[16:19], v[80:83]
    global_load_dwordx4 v[140:143], v47, s[48:49] sc1
    s_add_u32 s48, s48, 4096
    s_addc_u32 s49, s49, 0
    ds_read_b128 v[16:19], v2 offset:20736
    s_waitcnt vmcnt(8) lgkmcnt(6)
    v_mfma_f32_16x16x32_bf16 v[48:51], v[108:111], v[20:23], v[48:51]
    ds_read_b128 v[20:23], v2 offset:41216
    s_waitcnt lgkmcnt(6)
    v_mfma_f32_16x16x32_bf16 v[52:55], v[108:111], v[24:27], v[52:55]
    ds_read_b128 v[24:27], v2 offset:61696
    s_waitcnt lgkmcnt(6)
    v_mfma_f32_16x16x32_bf16 v[56:59], v[108:111], v[28:31], v[56:59]
    v_add_u32 v6, 81920, v2
    ds_read_b128 v[28:31], v6 offset:256
    s_waitcnt lgkmcnt(6)
    v_mfma_f32_16x16x32_bf16 v[60:63], v[108:111], v[32:35], v[60:63]
    v_mfma_f32_16x16x32_bf16 v[64:67], v[32:35], v[32:35], v[64:67]
    v_mfma_f32_16x16x32_bf16 v[68:71], v[10:13], v[32:35], v[68:71]
    ds_read_b128 v[32:35], v3 offset:256
    s_waitcnt lgkmcnt(6)
    v_mfma_f32_16x16x32_bf16 v[72:75], v[108:111], v[36:39], v[72:75]
    v_mfma_f32_16x16x32_bf16 v[76:79], v[36:39], v[36:39], v[76:79]
    v_mfma_f32_16x16x32_bf16 v[80:83], v[10:13], v[36:39], v[80:83]
    global_load_dwordx4 v[144:147], v44, s[48:49] sc1
    ds_read_b128 v[36:39], v3 offset:20736
    s_waitcnt vmcnt(8) lgkmcnt(6)
    v_mfma_f32_16x16x32_bf16 v[48:51], v[112:115], v[40:43], v[48:51]
    ds_read_b128 v[40:43], v3 offset:41216
    s_waitcnt lgkmcnt(6)
    v_mfma_f32_16x16x32_bf16 v[52:55], v[112:115], v[16:19], v[52:55]
    ds_read_b128 v[16:19], v3 offset:61696
    s_waitcnt lgkmcnt(6)
    v_mfma_f32_16x16x32_bf16 v[56:59], v[112:115], v[20:23], v[56:59]
    v_add_u32 v6, 81920, v3
    ds_read_b128 v[20:23], v6 offset:256
    s_waitcnt lgkmcnt(6)
    v_mfma_f32_16x16x32_bf16 v[60:63], v[112:115], v[24:27], v[60:63]
    v_mfma_f32_16x16x32_bf16 v[64:67], v[24:27], v[24:27], v[64:67]
    v_mfma_f32_16x16x32_bf16 v[68:71], v[10:13], v[24:27], v[68:71]
    ds_read_b128 v[24:27], v4 offset:256
    s_waitcnt lgkmcnt(6)
    v_mfma_f32_16x16x32_bf16 v[72:75], v[112:115], v[28:31], v[72:75]
    v_mfma_f32_16x16x32_bf16 v[76:79], v[28:31], v[28:31], v[76:79]
    v_mfma_f32_16x16x32_bf16 v[80:83], v[10:13], v[28:31], v[80:83]
    global_load_dwordx4 v[148:151], v45, s[48:49] sc1
    ds_read_b128 v[28:31], v4 offset:20736
    s_waitcnt vmcnt(8) lgkmcnt(6)
    v_mfma_f32_16x16x32_bf16 v[48:51], v[116:119], v[32:35], v[48:51]
    ds_read_b128 v[32:35], v4 offset:41216
    s_waitcnt lgkmcnt(6)
    v_mfma_f32_16x16x32_bf16 v[52:55], v[116:119], v[36:39], v[52:55]
    ds_read_b128 v[36:39], v4 offset:61696
    s_waitcnt lgkmcnt(6)
    v_mfma_f32_16x16x32_bf16 v[56:59], v[116:119], v[40:43], v[56:59]
    v_add_u32 v6, 81920, v4
    ds_read_b128 v[40:43], v6 offset:256
    s_waitcnt lgkmcnt(6)
    v_mfma_f32_16x16x32_bf16 v[60:63], v[116:119], v[16:19], v[60:63]
    v_mfma_f32_16x16x32_bf16 v[64:67], v[16:19], v[16:19], v[64:67]
    v_mfma_f32_16x16x32_bf16 v[68:71], v[10:13], v[16:19], v[68:71]
    ds_read_b128 v[16:19], v5 offset:256
    s_waitcnt lgkmcnt(6)
    v_mfma_f32_16x16x32_bf16 v[72:75], v[116:119], v[20:23], v[72:75]
    v_mfma_f32_16x16x32_bf16 v[76:79], v[20:23], v[20:23], v[76:79]
    v_mfma_f32_16x16x32_bf16 v[80:83], v[10:13], v[20:23], v[80:83]
    global_load_dwordx4 v[152:155], v46, s[48:49] sc1
    ds_read_b128 v[20:23], v5 offset:20736
    s_waitcnt vmcnt(8) lgkmcnt(6)
    v_mfma_f32_16x16x32_bf16 v[48:51], v[120:123], v[24:27], v[48:51]
    ds_read_b128 v[24:27], v5 offset:41216
    s_waitcnt lgkmcnt(6)
    v_mfma_f32_16x16x32_bf16 v[52:55], v[120:123], v[28:31], v[52:55]
    ds_read_b128 v[28:31], v5 offset:61696
    s_waitcnt lgkmcnt(6)
    v_mfma_f32_16x16x32_bf16 v[56:59], v[120:123], v[32:35], v[56:59]
    v_add_u32 v6, 81920, v5
    ds_read_b128 v[32:35], v6 offset:256
    s_waitcnt lgkmcnt(6)
    v_mfma_f32_16x16x32_bf16 v[60:63], v[120:123], v[36:39], v[60:63]
    v_mfma_f32_16x16x32_bf16 v[64:67], v[36:39], v[36:39], v[64:67]
    v_mfma_f32_16x16x32_bf16 v[68:71], v[10:13], v[36:39], v[68:71]
    ds_read_b128 v[36:39], v2 offset:512
    s_waitcnt lgkmcnt(6)
    v_mfma_f32_16x16x32_bf16 v[72:75], v[120:123], v[40:43], v[72:75]
    v_mfma_f32_16x16x32_bf16 v[76:79], v[40:43], v[40:43], v[76:79]
    v_mfma_f32_16x16x32_bf16 v[80:83], v[10:13], v[40:43], v[80:83]
    global_load_dwordx4 v[156:159], v47, s[48:49] sc1
    s_add_u32 s48, s48, 4096
    s_addc_u32 s49, s49, 0
    ds_read_b128 v[40:43], v2 offset:20992
    s_waitcnt vmcnt(8) lgkmcnt(6)
    v_mfma_f32_16x16x32_bf16 v[48:51], v[124:127], v[16:19], v[48:51]
    ds_read_b128 v[16:19], v2 offset:41472
    s_waitcnt lgkmcnt(6)
    v_mfma_f32_16x16x32_bf16 v[52:55], v[124:127], v[20:23], v[52:55]
    ds_read_b128 v[20:23], v2 offset:61952
    s_waitcnt lgkmcnt(6)
    v_mfma_f32_16x16x32_bf16 v[56:59], v[124:127], v[24:27], v[56:59]
    v_add_u32 v6, 81920, v2
    ds_read_b128 v[24:27], v6 offset:512
    s_waitcnt lgkmcnt(6)
    v_mfma_f32_16x16x32_bf16 v[60:63], v[124:127], v[28:31], v[60:63]
    v_mfma_f32_16x16x32_bf16 v[64:67], v[28:31], v[28:31], v[64:67]
    v_mfma_f32_16x16x32_bf16 v[68:71], v[10:13], v[28:31], v[68:71]
    ds_read_b128 v[28:31], v3 offset:512
    s_waitcnt lgkmcnt(6)
    v_mfma_f32_16x16x32_bf16 v[72:75], v[124:127], v[32:35], v[72:75]
    v_mfma_f32_16x16x32_bf16 v[76:79], v[32:35], v[32:35], v[76:79]
    v_mfma_f32_16x16x32_bf16 v[80:83], v[10:13], v[32:35], v[80:83]
    global_load_dwordx4 v[160:163], v44, s[48:49] sc1
    ds_read_b128 v[32:35], v3 offset:20992
    s_waitcnt vmcnt(8) lgkmcnt(6)
    v_mfma_f32_16x16x32_bf16 v[48:51], v[128:131], v[36:39], v[48:51]
    ds_read_b128 v[36:39], v3 offset:41472
    s_waitcnt lgkmcnt(6)
    v_mfma_f32_16x16x32_bf16 v[52:55], v[128:131], v[40:43], v[52:55]
    ds_read_b128 v[40:43], v3 offset:61952
    s_waitcnt lgkmcnt(6)
    v_mfma_f32_16x16x32_bf16 v[56:59], v[128:131], v[16:19], v[56:59]
    v_add_u32 v6, 81920, v3
    ds_read_b128 v[16:19], v6 offset:512
    s_waitcnt lgkmcnt(6)
    v_mfma_f32_16x16x32_bf16 v[60:63], v[128:131], v[20:23], v[60:63]
    v_mfma_f32_16x16x32_bf16 v[64:67], v[20:23], v[20:23], v[64:67]
    v_mfma_f32_16x16x32_bf16 v[68:71], v[10:13], v[20:23], v[68:71]
    ds_read_b128 v[20:23], v4 offset:512
    s_waitcnt lgkmcnt(6)
    v_mfma_f32_16x16x32_bf16 v[72:75], v[128:131], v[24:27], v[72:75]
    v_mfma_f32_16x16x32_bf16 v[76:79], v[24:27], v[24:27], v[76:79]
    v_mfma_f32_16x16x32_bf16 v[80:83], v[10:13], v[24:27], v[80:83]
    global_load_dwordx4 v[164:167], v45, s[48:49] sc1
    ds_read_b128 v[24:27], v4 offset:20992
    s_waitcnt vmcnt(8) lgkmcnt(6)
    v_mfma_f32_16x16x32_bf16 v[48:51], v[132:135], v[28:31], v[48:51]
    ds_read_b128 v[28:31], v4 offset:41472
    s_waitcnt lgkmcnt(6)
    v_mfma_f32_16x16x32_bf16 v[52:55], v[132:135], v[32:35], v[52:55]
    ds_read_b128 v[32:35], v4 offset:61952
    s_waitcnt lgkmcnt(6)
    v_mfma_f32_16x16x32_bf16 v[56:59], v[132:135], v[36:39], v[56:59]
    v_add_u32 v6, 81920, v4
    ds_read_b128 v[36:39], v6 offset:512
    s_waitcnt lgkmcnt(6)
    v_mfma_f32_16x16x32_bf16 v[60:63], v[132:135], v[40:43], v[60:63]
    v_mfma_f32_16x16x32_bf16 v[64:67], v[40:43], v[40:43], v[64:67]
    v_mfma_f32_16x16x32_bf16 v[68:71], v[10:13], v[40:43], v[68:71]
    ds_read_b128 v[40:43], v5 offset:512
    s_waitcnt lgkmcnt(6)
    v_mfma_f32_16x16x32_bf16 v[72:75], v[132:135], v[16:19], v[72:75]
    v_mfma_f32_16x16x32_bf16 v[76:79], v[16:19], v[16:19], v[76:79]
    v_mfma_f32_16x16x32_bf16 v[80:83], v[10:13], v[16:19], v[80:83]
    global_load_dwordx4 v[168:171], v46, s[48:49] sc1
    ds_read_b128 v[16:19], v5 offset:20992
    s_waitcnt vmcnt(8) lgkmcnt(6)
    v_mfma_f32_16x16x32_bf16 v[48:51], v[136:139], v[20:23], v[48:51]
    ds_read_b128 v[20:23], v5 offset:41472
    s_waitcnt lgkmcnt(6)
    v_mfma_f32_16x16x32_bf16 v[52:55], v[136:139], v[24:27], v[52:55]
    ds_read_b128 v[24:27], v5 offset:61952
    s_waitcnt lgkmcnt(6)
    v_mfma_f32_16x16x32_bf16 v[56:59], v[136:139], v[28:31], v[56:59]
    v_add_u32 v6, 81920, v5
    ds_read_b128 v[28:31], v6 offset:512
    s_waitcnt lgkmcnt(6)
    v_mfma_f32_16x16x32_bf16 v[60:63], v[136:139], v[32:35], v[60:63]
    v_mfma_f32_16x16x32_bf16 v[64:67], v[32:35], v[32:35], v[64:67]
    v_mfma_f32_16x16x32_bf16 v[68:71], v[10:13], v[32:35], v[68:71]
    ds_read_b128 v[32:35], v2 offset:768
    s_waitcnt lgkmcnt(6)
    v_mfma_f32_16x16x32_bf16 v[72:75], v[136:139], v[36:39], v[72:75]
    v_mfma_f32_16x16x32_bf16 v[76:79], v[36:39], v[36:39], v[76:79]
    v_mfma_f32_16x16x32_bf16 v[80:83], v[10:13], v[36:39], v[80:83]
    global_load_dwordx4 v[172:175], v47, s[48:49] sc1
    ds_read_b128 v[36:39], v2 offset:21248
    s_waitcnt vmcnt(8) lgkmcnt(6)
    v_mfma_f32_16x16x32_bf16 v[48:51], v[140:143], v[40:43], v[48:51]
    ds_read_b128 v[40:43], v2 offset:41728
    s_waitcnt lgkmcnt(6)
    v_mfma_f32_16x16x32_bf16 v[52:55], v[140:143], v[16:19], v[52:55]
    ds_read_b128 v[16:19], v2 offset:62208
    s_waitcnt lgkmcnt(6)
    v_mfma_f32_16x16x32_bf16 v[56:59], v[140:143], v[20:23], v[56:59]
    v_add_u32 v6, 81920, v2
    ds_read_b128 v[20:23], v6 offset:768
    s_waitcnt lgkmcnt(6)
    v_mfma_f32_16x16x32_bf16 v[60:63], v[140:143], v[24:27], v[60:63]
    v_mfma_f32_16x16x32_bf16 v[64:67], v[24:27], v[24:27], v[64:67]
    v_mfma_f32_16x16x32_bf16 v[68:71], v[10:13], v[24:27], v[68:71]
    ds_read_b128 v[24:27], v3 offset:768
    s_waitcnt lgkmcnt(6)
    v_mfma_f32_16x16x32_bf16 v[72:75], v[140:143], v[28:31], v[72:75]
    v_mfma_f32_16x16x32_bf16 v[76:79], v[28:31], v[28:31], v[76:79]
    v_mfma_f32_16x16x32_bf16 v[80:83], v[10:13], v[28:31], v[80:83]
    ds_read_b128 v[28:31], v3 offset:21248
    s_waitcnt vmcnt(7) lgkmcnt(6)
    v_mfma_f32_16x16x32_bf16 v[48:51], v[144:147], v[32:35], v[48:51]
    ds_read_b128 v[32:35], v3 offset:41728
    s_waitcnt lgkmcnt(6)
    v_mfma_f32_16x16x32_bf16 v[52:55], v[144:147], v[36:39], v[52:55]
    ds_read_b128 v[36:39], v3 offset:62208
    s_waitcnt lgkmcnt(6)
    v_mfma_f32_16x16x32_bf16 v[56:59], v[144:147], v[40:43], v[56:59]
    v_add_u32 v6, 81920, v3
    ds_read_b128 v[40:43], v6 offset:768
    s_waitcnt lgkmcnt(6)
    v_mfma_f32_16x16x32_bf16 v[60:63], v[144:147], v[16:19], v[60:63]
    v_mfma_f32_16x16x32_bf16 v[64:67], v[16:19], v[16:19], v[64:67]
    v_mfma_f32_16x16x32_bf16 v[68:71], v[10:13], v[16:19], v[68:71]
    ds_read_b128 v[16:19], v4 offset:768
    s_waitcnt lgkmcnt(6)
    v_mfma_f32_16x16x32_bf16 v[72:75], v[144:147], v[20:23], v[72:75]
    v_mfma_f32_16x16x32_bf16 v[76:79], v[20:23], v[20:23], v[76:79]
    v_mfma_f32_16x16x32_bf16 v[80:83], v[10:13], v[20:23], v[80:83]
    ds_read_b128 v[20:23], v4 offset:21248
    s_waitcnt vmcnt(6) lgkmcnt(6)
    v_mfma_f32_16x16x32_bf16 v[48:51], v[148:151], v[24:27], v[48:51]
    ds_read_b128 v[24:27], v4 offset:41728
    s_waitcnt lgkmcnt(6)
    v_mfma_f32_16x16x32_bf16 v[52:55], v[148:151], v[28:31], v[52:55]
    ds_read_b128 v[28:31], v4 offset:62208
    s_waitcnt lgkmcnt(6)
    v_mfma_f32_16x16x32_bf16 v[56:59], v[148:151], v[32:35], v[56:59]
    v_add_u32 v6, 81920, v4
    ds_read_b128 v[32:35], v6 offset:768
    s_waitcnt lgkmcnt(6)
    v_mfma_f32_16x16x32_bf16 v[60:63], v[148:151], v[36:39], v[60:63]
    v_mfma_f32_16x16x32_bf16 v[64:67], v[36:39], v[36:39], v[64:67]
    v_mfma_f32_16x16x32_bf16 v[68:71], v[10:13], v[36:39], v[68:71]
    ds_read_b128 v[36:39], v5 offset:768
    s_waitcnt lgkmcnt(6)
    v_mfma_f32_16x16x32_bf16 v[72:75], v[148:151], v[40:43], v[72:75]
    v_mfma_f32_16x16x32_bf16 v[76:79], v[40:43], v[40:43], v[76:79]
    v_mfma_f32_16x16x32_bf16 v[80:83], v[10:13], v[40:43], v[80:83]
    ds_read_b128 v[40:43], v5 offset:21248
    s_waitcnt vmcnt(5) lgkmcnt(6)
    v_mfma_f32_16x16x32_bf16 v[48:51], v[152:155], v[16:19], v[48:51]
    ds_read_b128 v[16:19], v5 offset:41728
    s_waitcnt lgkmcnt(6)
    v_mfma_f32_16x16x32_bf16 v[52:55], v[152:155], v[20:23], v[52:55]
    ds_read_b128 v[20:23], v5 offset:62208
    s_waitcnt lgkmcnt(6)
    v_mfma_f32_16x16x32_bf16 v[56:59], v[152:155], v[24:27], v[56:59]
    v_add_u32 v6, 81920, v5
    ds_read_b128 v[24:27], v6 offset:768
    s_waitcnt lgkmcnt(6)
    v_mfma_f32_16x16x32_bf16 v[60:63], v[152:155], v[28:31], v[60:63]
    v_mfma_f32_16x16x32_bf16 v[64:67], v[28:31], v[28:31], v[64:67]
    v_mfma_f32_16x16x32_bf16 v[68:71], v[10:13], v[28:31], v[68:71]
    ds_read_b128 v[28:31], v2 offset:1024
    s_waitcnt lgkmcnt(6)
    v_mfma_f32_16x16x32_bf16 v[72:75], v[152:155], v[32:35], v[72:75]
    v_mfma_f32_16x16x32_bf16 v[76:79], v[32:35], v[32:35], v[76:79]
    v_mfma_f32_16x16x32_bf16 v[80:83], v[10:13], v[32:35], v[80:83]
    ds_read_b128 v[32:35], v2 offset:21504
    s_waitcnt vmcnt(4) lgkmcnt(6)
    v_mfma_f32_16x16x32_bf16 v[48:51], v[156:159], v[36:39], v[48:51]
    ds_read_b128 v[36:39], v2 offset:41984
    s_waitcnt lgkmcnt(6)
    v_mfma_f32_16x16x32_bf16 v[52:55], v[156:159], v[40:43], v[52:55]
    ds_read_b128 v[40:43], v2 offset:62464
    s_waitcnt lgkmcnt(6)
    v_mfma_f32_16x16x32_bf16 v[56:59], v[156:159], v[16:19], v[56:59]
    v_add_u32 v6, 81920, v2
    ds_read_b128 v[16:19], v6 offset:1024
    s_waitcnt lgkmcnt(6)
    v_mfma_f32_16x16x32_bf16 v[60:63], v[156:159], v[20:23], v[60:63]
    v_mfma_f32_16x16x32_bf16 v[64:67], v[20:23], v[20:23], v[64:67]
    v_mfma_f32_16x16x32_bf16 v[68:71], v[10:13], v[20:23], v[68:71]
    ds_read_b128 v[20:23], v3 offset:1024
    s_waitcnt lgkmcnt(6)
    v_mfma_f32_16x16x32_bf16 v[72:75], v[156:159], v[24:27], v[72:75]
    v_mfma_f32_16x16x32_bf16 v[76:79], v[24:27], v[24:27], v[76:79]
    v_mfma_f32_16x16x32_bf16 v[80:83], v[10:13], v[24:27], v[80:83]
    ds_read_b128 v[24:27], v3 offset:21504
    s_waitcnt vmcnt(3) lgkmcnt(6)
    v_mfma_f32_16x16x32_bf16 v[48:51], v[160:163], v[28:31], v[48:51]
    ds_read_b128 v[28:31], v3 offset:41984
    s_waitcnt lgkmcnt(6)
    v_mfma_f32_16x16x32_bf16 v[52:55], v[160:163], v[32:35], v[52:55]
    ds_read_b128 v[32:35], v3 offset:62464
    s_waitcnt lgkmcnt(6)
    v_mfma_f32_16x16x32_bf16 v[56:59], v[160:163], v[36:39], v[56:59]
    v_add_u32 v6, 81920, v3
    ds_read_b128 v[36:39], v6 offset:1024
    s_waitcnt lgkmcnt(6)
    v_mfma_f32_16x16x32_bf16 v[60:63], v[160:163], v[40:43], v[60:63]
    v_mfma_f32_16x16x32_bf16 v[64:67], v[40:43], v[40:43], v[64:67]
    v_mfma_f32_16x16x32_bf16 v[68:71], v[10:13], v[40:43], v[68:71]
    ds_read_b128 v[40:43], v4 offset:1024
    s_waitcnt lgkmcnt(6)
    v_mfma_f32_16x16x32_bf16 v[72:75], v[160:163], v[16:19], v[72:75]
    v_mfma_f32_16x16x32_bf16 v[76:79], v[16:19], v[16:19], v[76:79]
    v_mfma_f32_16x16x32_bf16 v[80:83], v[10:13], v[16:19], v[80:83]
    ds_read_b128 v[16:19], v4 offset:21504
    s_waitcnt vmcnt(2) lgkmcnt(6)
    v_mfma_f32_16x16x32_bf16 v[48:51], v[164:167], v[20:23], v[48:51]
    ds_read_b128 v[20:23], v4 offset:41984
    s_waitcnt lgkmcnt(6)
    v_mfma_f32_16x16x32_bf16 v[52:55], v[164:167], v[24:27], v[52:55]
    ds_read_b128 v[24:27], v4 offset:62464
    s_waitcnt lgkmcnt(6)
    v_mfma_f32_16x16x32_bf16 v[56:59], v[164:167], v[28:31], v[56:59]
    v_add_u32 v6, 81920, v4
    ds_read_b128 v[28:31], v6 offset:1024
    s_waitcnt lgkmcnt(6)
    v_mfma_f32_16x16x32_bf16 v[60:63], v[164:167], v[32:35], v[60:63]
    v_mfma_f32_16x16x32_bf16 v[64:67], v[32:35], v[32:35], v[64:67]
    v_mfma_f32_16x16x32_bf16 v[68:71], v[10:13], v[32:35], v[68:71]
    ds_read_b128 v[32:35], v5 offset:1024
    s_waitcnt lgkmcnt(6)
    v_mfma_f32_16x16x32_bf16 v[72:75], v[164:167], v[36:39], v[72:75]
    v_mfma_f32_16x16x32_bf16 v[76:79], v[36:39], v[36:39], v[76:79]
    v_mfma_f32_16x16x32_bf16 v[80:83], v[10:13], v[36:39], v[80:83]
    ds_read_b128 v[36:39], v5 offset:21504
    s_waitcnt vmcnt(1) lgkmcnt(6)
    v_mfma_f32_16x16x32_bf16 v[48:51], v[168:171], v[40:43], v[48:51]
    ds_read_b128 v[40:43], v5 offset:41984
    s_waitcnt lgkmcnt(6)
    v_mfma_f32_16x16x32_bf16 v[52:55], v[168:171], v[16:19], v[52:55]
    ds_read_b128 v[16:19], v5 offset:62464
    s_waitcnt lgkmcnt(6)
    v_mfma_f32_16x16x32_bf16 v[56:59], v[168:171], v[20:23], v[56:59]
    v_add_u32 v6, 81920, v5
    ds_read_b128 v[20:23], v6 offset:1024
    s_waitcnt lgkmcnt(6)
    v_mfma_f32_16x16x32_bf16 v[60:63], v[168:171], v[24:27], v[60:63]
    v_mfma_f32_16x16x32_bf16 v[64:67], v[24:27], v[24:27], v[64:67]
    v_mfma_f32_16x16x32_bf16 v[68:71], v[10:13], v[24:27], v[68:71]
    s_waitcnt lgkmcnt(5)
    v_mfma_f32_16x16x32_bf16 v[72:75], v[168:171], v[28:31], v[72:75]
    v_mfma_f32_16x16x32_bf16 v[76:79], v[28:31], v[28:31], v[76:79]
    v_mfma_f32_16x16x32_bf16 v[80:83], v[10:13], v[28:31], v[80:83]
    s_waitcnt vmcnt(0) lgkmcnt(4)
    v_mfma_f32_16x16x32_bf16 v[48:51], v[172:175], v[32:35], v[48:51]
    s_waitcnt lgkmcnt(3)
    v_mfma_f32_16x16x32_bf16 v[52:55], v[172:175], v[36:39], v[52:55]
    s_waitcnt lgkmcnt(2)
    v_mfma_f32_16x16x32_bf16 v[56:59], v[172:175], v[40:43], v[56:59]
    s_waitcnt lgkmcnt(1)
    v_mfma_f32_16x16x32_bf16 v[60:63], v[172:175], v[16:19], v[60:63]
    v_mfma_f32_16x16x32_bf16 v[64:67], v[16:19], v[16:19], v[64:67]
    v_mfma_f32_16x16x32_bf16 v[68:71], v[10:13], v[16:19], v[68:71]
    s_waitcnt lgkmcnt(0)
    v_mfma_f32_16x16x32_bf16 v[72:75], v[172:175], v[20:23], v[72:75]
    v_mfma_f32_16x16x32_bf16 v[76:79], v[20:23], v[20:23], v[76:79]
    v_mfma_f32_16x16x32_bf16 v[80:83], v[10:13], v[20:23], v[80:83]
    ds_read_b64_tr_b16 v[10:11], v7
    ds_read_b64_tr_b16 v[12:13], v8
    ds_read_b64_tr_b16 v[14:15], v9
    v_and_b32 v16, 15, v1
    v_lshrrev_b32 v17, 4, v1
    v_and_b32 v18, 3, v1
    v_lshrrev_b32 v19, 2, v16
    v_cmp_eq_u32 s[42:43], 1, v18
    v_cmp_eq_u32 s[44:45], 2, v18
    v_cmp_eq_u32 s[46:47], 3, v18
    v_cmp_eq_u32 s[48:49], v19, v17
    v_lshlrev_b32 v18, 3, v16
    v_add_u32 v18, 45376, v18
    v_cndmask_b32 v64, v64, v65, s[42:43]
    v_cndmask_b32 v76, v76, v77, s[42:43]
    v_cndmask_b32 v64, v64, v66, s[44:45]
    v_cndmask_b32 v76, v76, v78, s[44:45]
    v_cndmask_b32 v64, v64, v67, s[46:47]
    v_cndmask_b32 v76, v76, v79, s[46:47]
    v_mul_f32 v68, 0x3acccccd, v68
    v_mul_f32 v64, 0x3acccccd, v64
    v_mul_f32 v80, 0x3acccccd, v80
    v_mul_f32 v76, 0x3acccccd, v76
    v_fma_f32 v64, -v68, v68, v64
    v_fma_f32 v76, -v80, v80, v76
    v_max_f32 v64, 0, v64
    v_max_f32 v76, 0, v76
    v_cvt_pk_bf16_f32 v68, v68, v64
    v_cvt_pk_bf16_f32 v80, v80, v76
    v_and_b32 v64, 0xffff0000, v68
    v_lshlrev_b32 v68, 16, v68
    v_and_b32 v76, 0xffff0000, v80
    v_lshlrev_b32 v80, 16, v80
    v_add_f32 v64, 0x3727c5ac, v64
    v_add_f32 v76, 0x3727c5ac, v76
    v_cvt_pk_bf16_f32 v64, v64, v64
    v_cvt_pk_bf16_f32 v76, v76, v76
    v_lshlrev_b32 v64, 16, v64
    v_lshlrev_b32 v76, 16, v76
    v_sqrt_f32 v64, v64
    v_sqrt_f32 v76, v76
    v_cvt_pk_bf16_f32 v64, v64, v64
    v_cvt_pk_bf16_f32 v76, v76, v76
    v_lshlrev_b32 v64, 16, v64
    v_lshlrev_b32 v76, 16, v76
    v_rcp_f32 v69, v64
    v_rcp_f32 v81, v76
    s_mov_b64 exec, s[48:49]
    ds_write_b64 v18, v[68:69] offset:384
    ds_write_b64 v18, v[80:81] offset:512
    s_mov_b64 exec, -1
    s_lshl_b32 s42, s3, 7
    s_add_u32 s42, s42, 46016
    v_lshl_add_u32 v19, v17, 4, s42
    s_mov_b64 exec, 0x10001
    s_mov_b32 exec_hi, 0x10001
    ds_write_b128 v19, v[48:51] offset:0
    s_mov_b64 exec, -1
    s_lshl_b32 s42, s3, 6
    s_cmp_eq_u32 s3, 2
    s_cselect_b32 s42, 192, s42
    s_cmp_eq_u32 s3, 3
    s_cselect_b32 s42, 128, s42
    s_add_u32 s42, s42, 61440
    v_mul_u32_u24 v20, 496, v16
    v_lshl_add_u32 v20, v17, 3, v20
    v_add_u32 v20, s42, v20
    v_lshlrev_b32 v18, 3, v16
    v_add_u32 v18, 45376, v18
    s_waitcnt lgkmcnt(0)
    s_barrier
    ds_read_b64 v[24:25], v18 offset:0
    ds_read_b64 v[26:27], v18 offset:128
    ds_read_b64 v[28:29], v18 offset:256
    ds_read_b64 v[30:31], v18 offset:384
    ds_read_b64 v[32:33], v18 offset:512
    ds_read_b128 v[36:39], v19 offset:0
    s_waitcnt lgkmcnt(0)
    v_fma_f32 v48, -v24, v36, v48
    v_fma_f32 v49, -v24, v37, v49
    v_fma_f32 v50, -v24, v38, v50
    v_fma_f32 v51, -v24, v39, v51
    v_fma_f32 v52, -v26, v36, v52
    v_fma_f32 v53, -v26, v37, v53
    v_fma_f32 v54, -v26, v38, v54
    v_fma_f32 v55, -v26, v39, v55
    v_fma_f32 v56, -v28, v36, v56
    v_fma_f32 v57, -v28, v37, v57
    v_fma_f32 v58, -v28, v38, v58
    v_fma_f32 v59, -v28, v39, v59
    v_fma_f32 v60, -v30, v36, v60
    v_fma_f32 v61, -v30, v37, v61
    v_fma_f32 v62, -v30, v38, v62
    v_fma_f32 v63, -v30, v39, v63
    v_fma_f32 v72, -v32, v36, v72
    v_fma_f32 v73, -v32, v37, v73
    v_fma_f32 v74, -v32, v38, v74
    v_fma_f32 v75, -v32, v39, v75
    v_mul_f32 v48, v48, v25
    v_mul_f32 v49, v49, v25
    v_mul_f32 v50, v50, v25
    v_mul_f32 v51, v51, v25
    v_mul_f32 v52, v52, v27
    v_mul_f32 v53, v53, v27
    v_mul_f32 v54, v54, v27
    v_mul_f32 v55, v55, v27
    v_mul_f32 v56, v56, v29
    v_mul_f32 v57, v57, v29
    v_mul_f32 v58, v58, v29
    v_mul_f32 v59, v59, v29
    v_mul_f32 v60, v60, v31
    v_mul_f32 v61, v61, v31
    v_mul_f32 v62, v62, v31
    v_mul_f32 v63, v63, v31
    v_mul_f32 v72, v72, v33
    v_mul_f32 v73, v73, v33
    v_mul_f32 v74, v74, v33
    v_mul_f32 v75, v75, v33
    v_cvt_pk_bf16_f32 v48, v48, v49
    v_cvt_pk_bf16_f32 v49, v50, v51
    ds_write_b64 v20, v[48:49] offset:0
    v_cvt_pk_bf16_f32 v52, v52, v53
    v_cvt_pk_bf16_f32 v53, v54, v55
    ds_write_b64 v20, v[52:53] offset:7936
    v_cvt_pk_bf16_f32 v56, v56, v57
    v_cvt_pk_bf16_f32 v57, v58, v59
    ds_write_b64 v20, v[56:57] offset:15872
    v_cvt_pk_bf16_f32 v60, v60, v61
    v_cvt_pk_bf16_f32 v61, v62, v63
    ds_write_b64 v20, v[60:61] offset:23808
    v_cvt_pk_bf16_f32 v72, v72, v73
    v_cvt_pk_bf16_f32 v73, v74, v75
    ds_write_b64 v20, v[72:73] offset:31744
    s_branch L_a1_post
L_a1_post:
    s_cmp_lt_u32 s3, 4
    s_cbranch_scc1 L_pg_lo
    s_cmp_eq_u32 s3, 7
    s_cbranch_scc0 L_pg_n9
    s_cmp_eq_u32 s7, 0
    s_cbranch_scc0 L_pg_n9
    s_mov_b32 s43, 2
    s_mul_i32 s54, s39, 384
    s_lshl_b32 s55, s43, 7
    s_add_u32 s54, s54, s55
    v_lshl_add_u32 v2, v1, 1, s54
    s_lshl_b32 s55, s39, 1
    v_mov_b32 v3, s55
    global_load_ushort v240, v2, s[16:17]
    global_load_ushort v244, v3, s[24:25]
    global_load_ushort v241, v2, s[18:19]
    global_load_ushort v242, v2, s[20:21]
    global_load_ushort v243, v2, s[22:23]
L_pg_n9:
    s_waitcnt lgkmcnt(0)
    s_barrier
    s_sub_u32 s42, s3, 4
    s_mul_i32 s42, s42, 15360
    s_add_u32 s42, s42, 40960
    s_mul_i32 s43, s4, 102400
    s_add_u32 s43, s43, s42
    s_add_u32 s43, s43, 14680064
    v_lshlrev_b32 v24, 4, v1
    s_add_u32 s44, s32, s43
    s_addc_u32 s45, s33, 0
    s_add_u32 m0, s42, 61440
    s_nop 0
    global_load_lds_dwordx4 v24, s[44:45] offset:0 sc1
    global_load_lds_dwordx4 v24, s[44:45] offset:1024 sc1
    global_load_lds_dwordx4 v24, s[44:45] offset:2048 sc1
    global_load_lds_dwordx4 v24, s[44:45] offset:3072 sc1
    s_add_u32 m0, s42, 65536
    s_add_u32 s44, s44, 4096
    s_addc_u32 s45, s45, 0
    global_load_lds_dwordx4 v24, s[44:45] offset:0 sc1
    global_load_lds_dwordx4 v24, s[44:45] offset:1024 sc1
    global_load_lds_dwordx4 v24, s[44:45] offset:2048 sc1
    global_load_lds_dwordx4 v24, s[44:45] offset:3072 sc1
    s_add_u32 m0, s42, 69632
    s_add_u32 s44, s44, 4096
    s_addc_u32 s45, s45, 0
    global_load_lds_dwordx4 v24, s[44:45] offset:0 sc1
    global_load_lds_dwordx4 v24, s[44:45] offset:1024 sc1
    global_load_lds_dwordx4 v24, s[44:45] offset:2048 sc1
    global_load_lds_dwordx4 v24, s[44:45] offset:3072 sc1
    s_add_u32 m0, s42, 73728
    s_add_u32 s44, s44, 4096
    s_addc_u32 s45, s45, 0
    global_load_lds_dwordx4 v24, s[44:45] offset:0 sc1
    global_load_lds_dwordx4 v24, s[44:45] offset:1024 sc1
    global_load_lds_dwordx4 v24, s[44:45] offset:2048 sc1
    s_cmp_eq_u32 s3, 7
    s_cbranch_scc0 L_pg_p2
    s_cmp_eq_u32 s7, 0
    s_cbranch_scc0 L_pg_p2
    v_mov_b32 v180, v10
    v_mov_b32 v181, v11
    v_mov_b32 v182, v12
    v_mov_b32 v183, v13
    v_mov_b32 v184, v14
    v_mov_b32 v185, v15
    s_mov_b32 s46, 36864
    s_waitcnt vmcnt(15)
    v_lshlrev_b32 v52, 16, v240
    v_lshlrev_b32 v56, 16, v244
    v_mul_f32 v52, 1069066811, v52
    v_mul_f32 v56, 1069066811, v56
    v_exp_f32 v52, v52
    v_exp_f32 v56, v56
    v_lshlrev_b32 v53, 16, v241
    v_lshlrev_b32 v54, 16, v242
    v_lshlrev_b32 v55, 16, v243
    v_cvt_pk_bf16_f32 v52, v52, v56
    v_and_b32 v3, 15, v1
    v_mul_u32_u24 v3, 288, v3
    v_and_b32 v2, 0x30, v1
    v_add3_u32 v3, v3, v2, s46
    s_mov_b32 m0, s46
    v_and_b32 v56, 0xffff0000, v52
    v_lshlrev_b32 v52, 16, v52
    v_mul_f32 v52, v52, v56
    v_mul_f32 v53, v53, v56
    v_mul_f32 v84, v54, v56
    v_mul_f32 v85, v55, v56
    v_mul_f32 v52, 3216550459, v52
    v_mul_f32 v53, 1042479491, v53
    v_mul_f32 v84, 0x44000000, v84
    v_mul_f32 v85, 0x44000000, v85
    v_mul_f32 v54, 1065353216, v52
    v_mul_f32 v60, 1065353216, v53
    v_mul_f32 v55, 1090519040, v52
    v_mul_f32 v61, 1090519040, v53
    v_mul_f32 v56, 1124073472, v52
    v_mul_f32 v62, 1124073472, v53
    v_mul_f32 v57, 1132462080, v52
    v_mul_f32 v63, 1132462080, v53
    v_mul_f32 v58, 1140850688, v52
    v_mul_f32 v64, 1140850688, v53
    v_mul_f32 v59, 1149239296, v52
    v_mul_f32 v65, 1149239296, v53
    v_exp_f32 v54, v54
    v_fract_f32 v60, v60
    v_exp_f32 v55, v55
    v_fract_f32 v61, v61
    v_exp_f32 v56, v56
    v_fract_f32 v62, v62
    v_exp_f32 v57, v57
    v_fract_f32 v63, v63
    v_exp_f32 v58, v58
    v_fract_f32 v64, v64
    v_exp_f32 v59, v59
    v_fract_f32 v65, v65
    v_cos_f32 v4, v60
    v_sin_f32 v5, v60
    v_cos_f32 v6, v61
    v_sin_f32 v7, v61
    v_cos_f32 v8, v62
    v_sin_f32 v9, v62
    v_cos_f32 v10, v63
    v_sin_f32 v11, v63
    v_cos_f32 v12, v64
    v_sin_f32 v13, v64
    v_cos_f32 v14, v65
    v_sin_f32 v15, v65
    v_mul_f32 v4, v4, v54
    v_mul_f32 v5, v5, v54
    v_mul_f32 v6, v6, v55
    v_mul_f32 v7, v7, v55
    v_mul_f32 v8, v8, v56
    v_mul_f32 v9, v9, v56
    v_mul_f32 v10, v10, v57
    v_mul_f32 v11, v11, v57
    v_mul_f32 v12, v12, v58
    v_mul_f32 v13, v13, v58
    v_mul_f32 v14, v14, v59
    v_mul_f32 v15, v15, v59
    v_mov_b32 v16, 1.0
    v_mov_b32 v17, 0
    v_mov_b32 v18, v6
    v_mov_b32 v19, v7
    v_pk_mul_f32 v[20:21], v[6:7], v[6:7] op_sel:[0,0] op_sel_hi:[1,0]
    v_pk_mul_f32 v[48:49], v[4:5], v[4:5] op_sel:[0,0] op_sel_hi:[1,0]
    v_pk_fma_f32 v[20:21], v[6:7], v[6:7], v[20:21] op_sel:[1,1,0] op_sel_hi:[0,1,1] neg_lo:[1,0,0]
    v_pk_fma_f32 v[48:49], v[4:5], v[4:5], v[48:49] op_sel:[1,1,0] op_sel_hi:[0,1,1] neg_lo:[1,0,0]
    v_pk_mul_f32 v[22:23], v[20:21], v[6:7] op_sel:[0,0] op_sel_hi:[1,0]
    v_pk_mul_f32 v[24:25], v[20:21], v[20:21] op_sel:[0,0] op_sel_hi:[1,0]
    v_pk_mul_f32 v[50:51], v[48:49], v[48:49] op_sel:[0,0] op_sel_hi:[1,0]
    v_pk_fma_f32 v[22:23], v[20:21], v[6:7], v[22:23] op_sel:[1,1,0] op_sel_hi:[0,1,1] neg_lo:[1,0,0]
    v_pk_fma_f32 v[24:25], v[20:21], v[20:21], v[24:25] op_sel:[1,1,0] op_sel_hi:[0,1,1] neg_lo:[1,0,0]
    v_pk_fma_f32 v[50:51], v[48:49], v[48:49], v[50:51] op_sel:[1,1,0] op_sel_hi:[0,1,1] neg_lo:[1,0,0]
    v_pk_mul_f32 v[26:27], v[18:19], v[24:25] op_sel:[0,0] op_sel_hi:[1,0]
    v_pk_mul_f32 v[28:29], v[20:21], v[24:25] op_sel:[0,0] op_sel_hi:[1,0]
    v_pk_mul_f32 v[30:31], v[22:23], v[24:25] op_sel:[0,0] op_sel_hi:[1,0]
    v_pk_mul_f32 v[32:33], v[24:25], v[24:25] op_sel:[0,0] op_sel_hi:[1,0]
    v_pk_fma_f32 v[26:27], v[18:19], v[24:25], v[26:27] op_sel:[1,1,0] op_sel_hi:[0,1,1] neg_lo:[1,0,0]
    v_pk_fma_f32 v[28:29], v[20:21], v[24:25], v[28:29] op_sel:[1,1,0] op_sel_hi:[0,1,1] neg_lo:[1,0,0]
    v_pk_fma_f32 v[30:31], v[22:23], v[24:25], v[30:31] op_sel:[1,1,0] op_sel_hi:[0,1,1] neg_lo:[1,0,0]
    v_pk_fma_f32 v[32:33], v[24:25], v[24:25], v[32:33] op_sel:[1,1,0] op_sel_hi:[0,1,1] neg_lo:[1,0,0]
    v_pk_mul_f32 v[34:35], v[26:27], v[24:25] op_sel:[0,0] op_sel_hi:[1,0]
    v_pk_mul_f32 v[36:37], v[28:29], v[24:25] op_sel:[0,0] op_sel_hi:[1,0]
    v_pk_mul_f32 v[38:39], v[30:31], v[24:25] op_sel:[0,0] op_sel_hi:[1,0]
    v_pk_mul_f32 v[40:41], v[32:33], v[24:25] op_sel:[0,0] op_sel_hi:[1,0]
    v_pk_fma_f32 v[34:35], v[26:27], v[24:25], v[34:35] op_sel:[1,1,0] op_sel_hi:[0,1,1] neg_lo:[1,0,0]
    v_pk_fma_f32 v[36:37], v[28:29], v[24:25], v[36:37] op_sel:[1,1,0] op_sel_hi:[0,1,1] neg_lo:[1,0,0]
    v_pk_fma_f32 v[38:39], v[30:31], v[24:25], v[38:39] op_sel:[1,1,0] op_sel_hi:[0,1,1] neg_lo:[1,0,0]
    v_pk_fma_f32 v[40:41], v[32:33], v[24:25], v[40:41] op_sel:[1,1,0] op_sel_hi:[0,1,1] neg_lo:[1,0,0]
    v_pk_mul_f32 v[42:43], v[34:35], v[24:25] op_sel:[0,0] op_sel_hi:[1,0]
    v_pk_mul_f32 v[44:45], v[36:37], v[24:25] op_sel:[0,0] op_sel_hi:[1,0]
    v_pk_mul_f32 v[46:47], v[38:39], v[24:25] op_sel:[0,0] op_sel_hi:[1,0]
    v_pk_fma_f32 v[42:43], v[34:35], v[24:25], v[42:43] op_sel:[1,1,0] op_sel_hi:[0,1,1] neg_lo:[1,0,0]
    v_pk_fma_f32 v[44:45], v[36:37], v[24:25], v[44:45] op_sel:[1,1,0] op_sel_hi:[0,1,1] neg_lo:[1,0,0]
    v_pk_fma_f32 v[46:47], v[38:39], v[24:25], v[46:47] op_sel:[1,1,0] op_sel_hi:[0,1,1] neg_lo:[1,0,0]
    v_cvt_pk_f16_f32 v52, v16, -v17
    v_cvt_pk_f16_f32 v53, v18, -v19
    v_cvt_pk_f16_f32 v54, v20, -v21
    v_cvt_pk_f16_f32 v55, v22, -v23
    v_cvt_pk_f16_f32 v56, v24, -v25
    v_cvt_pk_f16_f32 v57, v26, -v27
    v_cvt_pk_f16_f32 v58, v28, -v29
    v_cvt_pk_f16_f32 v59, v30, -v31
    v_cvt_pk_f16_f32 v60, v32, -v33
    v_cvt_pk_f16_f32 v61, v34, -v35
    v_cvt_pk_f16_f32 v62, v36, -v37
    v_cvt_pk_f16_f32 v63, v38, -v39
    v_cvt_pk_f16_f32 v64, v40, -v41
    v_cvt_pk_f16_f32 v65, v42, -v43
    v_cvt_pk_f16_f32 v66, v44, -v45
    v_cvt_pk_f16_f32 v67, v46, -v47
    ds_write_addtid_b32 v52 offset:0
    ds_write_addtid_b32 v53 offset:288
    ds_write_addtid_b32 v54 offset:576
    ds_write_addtid_b32 v55 offset:864
    ds_write_addtid_b32 v56 offset:1152
    ds_write_addtid_b32 v57 offset:1440
    ds_write_addtid_b32 v58 offset:1728
    ds_write_addtid_b32 v59 offset:2016
    ds_write_addtid_b32 v60 offset:2304
    ds_write_addtid_b32 v61 offset:2592
    ds_write_addtid_b32 v62 offset:2880
    ds_write_addtid_b32 v63 offset:3168
    ds_write_addtid_b32 v64 offset:3456
    ds_write_addtid_b32 v65 offset:3744
    ds_write_addtid_b32 v66 offset:4032
    ds_write_addtid_b32 v67 offset:4320
    v_mov_b32 v16, v84
    v_mov_b32 v17, v85
    v_pk_mul_f32 v[18:19], v[16:17], v[4:5] op_sel:[0,0] op_sel_hi:[1,0]
    v_pk_mul_f32 v[20:21], v[16:17], v[48:49] op_sel:[0,0] op_sel_hi:[1,0]
    v_pk_mul_f32 v[24:25], v[16:17], v[50:51] op_sel:[0,0] op_sel_hi:[1,0]
    v_pk_mul_f32 v[32:33], v[16:17], v[8:9] op_sel:[0,0] op_sel_hi:[1,0]
    v_pk_fma_f32 v[18:19], v[16:17], v[4:5], v[18:19] op_sel:[1,1,0] op_sel_hi:[0,1,1] neg_lo:[1,0,0]
    v_pk_fma_f32 v[20:21], v[16:17], v[48:49], v[20:21] op_sel:[1,1,0] op_sel_hi:[0,1,1] neg_lo:[1,0,0]
    v_pk_fma_f32 v[24:25], v[16:17], v[50:51], v[24:25] op_sel:[1,1,0] op_sel_hi:[0,1,1] neg_lo:[1,0,0]
    v_pk_fma_f32 v[32:33], v[16:17], v[8:9], v[32:33] op_sel:[1,1,0] op_sel_hi:[0,1,1] neg_lo:[1,0,0]
    s_waitcnt lgkmcnt(0)
    ds_read_b128 v[68:71], v3 offset:0
    ds_read_b128 v[72:75], v3 offset:64
    ds_read_b128 v[76:79], v3 offset:128
    ds_read_b128 v[80:83], v3 offset:192
    v_pk_mul_f32 v[22:23], v[18:19], v[48:49] op_sel:[0,0] op_sel_hi:[1,0]
    v_pk_mul_f32 v[26:27], v[18:19], v[50:51] op_sel:[0,0] op_sel_hi:[1,0]
    v_pk_mul_f32 v[28:29], v[20:21], v[50:51] op_sel:[0,0] op_sel_hi:[1,0]
    v_pk_mul_f32 v[34:35], v[18:19], v[8:9] op_sel:[0,0] op_sel_hi:[1,0]
    v_pk_mul_f32 v[36:37], v[20:21], v[8:9] op_sel:[0,0] op_sel_hi:[1,0]
    v_pk_mul_f32 v[40:41], v[24:25], v[8:9] op_sel:[0,0] op_sel_hi:[1,0]
    v_pk_fma_f32 v[22:23], v[18:19], v[48:49], v[22:23] op_sel:[1,1,0] op_sel_hi:[0,1,1] neg_lo:[1,0,0]
    v_pk_fma_f32 v[26:27], v[18:19], v[50:51], v[26:27] op_sel:[1,1,0] op_sel_hi:[0,1,1] neg_lo:[1,0,0]
    v_pk_fma_f32 v[28:29], v[20:21], v[50:51], v[28:29] op_sel:[1,1,0] op_sel_hi:[0,1,1] neg_lo:[1,0,0]
    v_pk_fma_f32 v[34:35], v[18:19], v[8:9], v[34:35] op_sel:[1,1,0] op_sel_hi:[0,1,1] neg_lo:[1,0,0]
    v_pk_fma_f32 v[36:37], v[20:21], v[8:9], v[36:37] op_sel:[1,1,0] op_sel_hi:[0,1,1] neg_lo:[1,0,0]
    v_pk_fma_f32 v[40:41], v[24:25], v[8:9], v[40:41] op_sel:[1,1,0] op_sel_hi:[0,1,1] neg_lo:[1,0,0]
    v_pk_mul_f32 v[30:31], v[22:23], v[50:51] op_sel:[0,0] op_sel_hi:[1,0]
    v_pk_mul_f32 v[38:39], v[22:23], v[8:9] op_sel:[0,0] op_sel_hi:[1,0]
    v_pk_mul_f32 v[42:43], v[26:27], v[8:9] op_sel:[0,0] op_sel_hi:[1,0]
    v_pk_mul_f32 v[44:45], v[28:29], v[8:9] op_sel:[0,0] op_sel_hi:[1,0]
    v_pk_fma_f32 v[30:31], v[22:23], v[50:51], v[30:31] op_sel:[1,1,0] op_sel_hi:[0,1,1] neg_lo:[1,0,0]
    v_pk_fma_f32 v[38:39], v[22:23], v[8:9], v[38:39] op_sel:[1,1,0] op_sel_hi:[0,1,1] neg_lo:[1,0,0]
    v_pk_fma_f32 v[42:43], v[26:27], v[8:9], v[42:43] op_sel:[1,1,0] op_sel_hi:[0,1,1] neg_lo:[1,0,0]
    v_pk_fma_f32 v[44:45], v[28:29], v[8:9], v[44:45] op_sel:[1,1,0] op_sel_hi:[0,1,1] neg_lo:[1,0,0]
    v_pk_mul_f32 v[46:47], v[30:31], v[8:9] op_sel:[0,0] op_sel_hi:[1,0]
    v_pk_fma_f32 v[46:47], v[30:31], v[8:9], v[46:47] op_sel:[1,1,0] op_sel_hi:[0,1,1] neg_lo:[1,0,0]
    s_waitcnt lgkmcnt(0)
    v_cvt_pk_f16_f32 v52, v16, v17
    v_cvt_pk_f16_f32 v53, v18, v19
    v_cvt_pk_f16_f32 v54, v20, v21
    v_cvt_pk_f16_f32 v55, v22, v23
    v_cvt_pk_f16_f32 v56, v24, v25
    v_cvt_pk_f16_f32 v57, v26, v27
    v_cvt_pk_f16_f32 v58, v28, v29
    v_cvt_pk_f16_f32 v59, v30, v31
    v_cvt_pk_f16_f32 v60, v32, v33
    v_cvt_pk_f16_f32 v61, v34, v35
    v_cvt_pk_f16_f32 v62, v36, v37
    v_cvt_pk_f16_f32 v63, v38, v39
    v_cvt_pk_f16_f32 v64, v40, v41
    v_cvt_pk_f16_f32 v65, v42, v43
    v_cvt_pk_f16_f32 v66, v44, v45
    v_cvt_pk_f16_f32 v67, v46, v47
    ds_write_addtid_b32 v52 offset:0
    ds_write_addtid_b32 v53 offset:288
    ds_write_addtid_b32 v54 offset:576
    ds_write_addtid_b32 v55 offset:864
    ds_write_addtid_b32 v56 offset:1152
    ds_write_addtid_b32 v57 offset:1440
    ds_write_addtid_b32 v58 offset:1728
    ds_write_addtid_b32 v59 offset:2016
    ds_write_addtid_b32 v60 offset:2304
    ds_write_addtid_b32 v61 offset:2592
    ds_write_addtid_b32 v62 offset:2880
    ds_write_addtid_b32 v63 offset:3168
    ds_write_addtid_b32 v64 offset:3456
    ds_write_addtid_b32 v65 offset:3744
    ds_write_addtid_b32 v66 offset:4032
    ds_write_addtid_b32 v67 offset:4320
    v_pk_mul_f32 v[18:19], v[16:17], v[10:11] op_sel:[0,0] op_sel_hi:[1,0]
    v_pk_mul_f32 v[22:23], v[20:21], v[10:11] op_sel:[0,0] op_sel_hi:[1,0]
    v_pk_mul_f32 v[26:27], v[24:25], v[10:11] op_sel:[0,0] op_sel_hi:[1,0]
    v_pk_mul_f32 v[30:31], v[28:29], v[10:11] op_sel:[0,0] op_sel_hi:[1,0]
    v_pk_mul_f32 v[34:35], v[32:33], v[10:11] op_sel:[0,0] op_sel_hi:[1,0]
    v_pk_mul_f32 v[38:39], v[36:37], v[10:11] op_sel:[0,0] op_sel_hi:[1,0]
    v_pk_mul_f32 v[42:43], v[40:41], v[10:11] op_sel:[0,0] op_sel_hi:[1,0]
    v_pk_mul_f32 v[46:47], v[44:45], v[10:11] op_sel:[0,0] op_sel_hi:[1,0]
    v_pk_fma_f32 v[18:19], v[16:17], v[10:11], v[18:19] op_sel:[1,1,0] op_sel_hi:[0,1,1] neg_lo:[1,0,0]
    v_pk_fma_f32 v[22:23], v[20:21], v[10:11], v[22:23] op_sel:[1,1,0] op_sel_hi:[0,1,1] neg_lo:[1,0,0]
    v_pk_fma_f32 v[26:27], v[24:25], v[10:11], v[26:27] op_sel:[1,1,0] op_sel_hi:[0,1,1] neg_lo:[1,0,0]
    v_pk_fma_f32 v[30:31], v[28:29], v[10:11], v[30:31] op_sel:[1,1,0] op_sel_hi:[0,1,1] neg_lo:[1,0,0]
    v_pk_fma_f32 v[34:35], v[32:33], v[10:11], v[34:35] op_sel:[1,1,0] op_sel_hi:[0,1,1] neg_lo:[1,0,0]
    v_pk_fma_f32 v[38:39], v[36:37], v[10:11], v[38:39] op_sel:[1,1,0] op_sel_hi:[0,1,1] neg_lo:[1,0,0]
    v_pk_fma_f32 v[42:43], v[40:41], v[10:11], v[42:43] op_sel:[1,1,0] op_sel_hi:[0,1,1] neg_lo:[1,0,0]
    v_pk_fma_f32 v[46:47], v[44:45], v[10:11], v[46:47] op_sel:[1,1,0] op_sel_hi:[0,1,1] neg_lo:[1,0,0]
    s_waitcnt lgkmcnt(0)
    ds_read_b128 v[52:55], v3 offset:0
    ds_read_b128 v[56:59], v3 offset:64
    ds_read_b128 v[60:63], v3 offset:128
    ds_read_b128 v[64:67], v3 offset:192
    v_pk_mul_f32 v[20:21], v[16:17], v[12:13] op_sel:[0,0] op_sel_hi:[1,0]
    v_pk_mul_f32 v[28:29], v[24:25], v[12:13] op_sel:[0,0] op_sel_hi:[1,0]
    v_pk_mul_f32 v[36:37], v[32:33], v[12:13] op_sel:[0,0] op_sel_hi:[1,0]
    v_pk_mul_f32 v[44:45], v[40:41], v[12:13] op_sel:[0,0] op_sel_hi:[1,0]
    v_pk_fma_f32 v[20:21], v[16:17], v[12:13], v[20:21] op_sel:[1,1,0] op_sel_hi:[0,1,1] neg_lo:[1,0,0]
    v_pk_fma_f32 v[28:29], v[24:25], v[12:13], v[28:29] op_sel:[1,1,0] op_sel_hi:[0,1,1] neg_lo:[1,0,0]
    v_pk_fma_f32 v[36:37], v[32:33], v[12:13], v[36:37] op_sel:[1,1,0] op_sel_hi:[0,1,1] neg_lo:[1,0,0]
    v_pk_fma_f32 v[44:45], v[40:41], v[12:13], v[44:45] op_sel:[1,1,0] op_sel_hi:[0,1,1] neg_lo:[1,0,0]
    v_pk_mul_f32 v[24:25], v[20:21], v[10:11] op_sel:[0,0] op_sel_hi:[1,0]
    v_pk_mul_f32 v[40:41], v[28:29], v[10:11] op_sel:[0,0] op_sel_hi:[1,0]
    v_pk_mul_f32 v[48:49], v[36:37], v[10:11] op_sel:[0,0] op_sel_hi:[1,0]
    v_pk_mul_f32 v[50:51], v[44:45], v[10:11] op_sel:[0,0] op_sel_hi:[1,0]
    v_pk_fma_f32 v[24:25], v[20:21], v[10:11], v[24:25] op_sel:[1,1,0] op_sel_hi:[0,1,1] neg_lo:[1,0,0]
    v_pk_fma_f32 v[40:41], v[28:29], v[10:11], v[40:41] op_sel:[1,1,0] op_sel_hi:[0,1,1] neg_lo:[1,0,0]
    v_pk_fma_f32 v[48:49], v[36:37], v[10:11], v[48:49] op_sel:[1,1,0] op_sel_hi:[0,1,1] neg_lo:[1,0,0]
    v_pk_fma_f32 v[50:51], v[44:45], v[10:11], v[50:51] op_sel:[1,1,0] op_sel_hi:[0,1,1] neg_lo:[1,0,0]
    s_waitcnt lgkmcnt(0)
    v_mfma_f32_16x16x32_f16 v[84:87], v[52:55], v[68:71], 0
    v_mfma_f32_16x16x32_f16 v[84:87], v[56:59], v[72:75], v[84:87]
    v_mfma_f32_16x16x32_f16 v[84:87], v[60:63], v[76:79], v[84:87]
    v_mfma_f32_16x16x32_f16 v[84:87], v[64:67], v[80:83], v[84:87]
    v_cvt_pk_f16_f32 v52, v18, v19
    v_cvt_pk_f16_f32 v53, v22, v23
    v_cvt_pk_f16_f32 v54, v26, v27
    v_cvt_pk_f16_f32 v55, v30, v31
    v_cvt_pk_f16_f32 v56, v34, v35
    v_cvt_pk_f16_f32 v57, v38, v39
    v_cvt_pk_f16_f32 v58, v42, v43
    v_cvt_pk_f16_f32 v59, v46, v47
    v_cvt_pk_f16_f32 v60, v20, v21
    v_cvt_pk_f16_f32 v61, v28, v29
    v_cvt_pk_f16_f32 v62, v36, v37
    v_cvt_pk_f16_f32 v63, v44, v45
    v_cvt_pk_f16_f32 v64, v24, v25
    v_cvt_pk_f16_f32 v65, v40, v41
    v_cvt_pk_f16_f32 v66, v48, v49
    v_cvt_pk_f16_f32 v67, v50, v51
    ds_write_addtid_b32 v52 offset:0
    ds_write_addtid_b32 v53 offset:288
    ds_write_addtid_b32 v54 offset:576
    ds_write_addtid_b32 v55 offset:864
    ds_write_addtid_b32 v56 offset:1152
    ds_write_addtid_b32 v57 offset:1440
    ds_write_addtid_b32 v58 offset:1728
    ds_write_addtid_b32 v59 offset:2016
    ds_write_addtid_b32 v60 offset:2304
    ds_write_addtid_b32 v61 offset:2592
    ds_write_addtid_b32 v62 offset:2880
    ds_write_addtid_b32 v63 offset:3168
    ds_write_addtid_b32 v64 offset:3456
    ds_write_addtid_b32 v65 offset:3744
    ds_write_addtid_b32 v66 offset:4032
    ds_write_addtid_b32 v67 offset:4320
    v_pk_mul_f32 v[18:19], v[16:17], v[14:15] op_sel:[0,0] op_sel_hi:[1,0]
    v_pk_mul_f32 v[22:23], v[32:33], v[14:15] op_sel:[0,0] op_sel_hi:[1,0]
    v_pk_fma_f32 v[18:19], v[16:17], v[14:15], v[18:19] op_sel:[1,1,0] op_sel_hi:[0,1,1] neg_lo:[1,0,0]
    v_pk_fma_f32 v[22:23], v[32:33], v[14:15], v[22:23] op_sel:[1,1,0] op_sel_hi:[0,1,1] neg_lo:[1,0,0]
    s_waitcnt lgkmcnt(0)
    ds_read_b128 v[52:55], v3 offset:0
    ds_read_b128 v[56:59], v3 offset:64
    ds_read_b128 v[60:63], v3 offset:128
    ds_read_b128 v[64:67], v3 offset:192
    v_pk_mul_f32 v[26:27], v[18:19], v[10:11] op_sel:[0,0] op_sel_hi:[1,0]
    v_pk_mul_f32 v[30:31], v[22:23], v[10:11] op_sel:[0,0] op_sel_hi:[1,0]
    v_pk_mul_f32 v[34:35], v[18:19], v[12:13] op_sel:[0,0] op_sel_hi:[1,0]
    v_pk_mul_f32 v[38:39], v[22:23], v[12:13] op_sel:[0,0] op_sel_hi:[1,0]
    v_pk_mul_f32 v[20:21], v[18:19], v[14:15] op_sel:[0,0] op_sel_hi:[1,0]
    v_pk_fma_f32 v[26:27], v[18:19], v[10:11], v[26:27] op_sel:[1,1,0] op_sel_hi:[0,1,1] neg_lo:[1,0,0]
    v_pk_fma_f32 v[30:31], v[22:23], v[10:11], v[30:31] op_sel:[1,1,0] op_sel_hi:[0,1,1] neg_lo:[1,0,0]
    v_pk_fma_f32 v[34:35], v[18:19], v[12:13], v[34:35] op_sel:[1,1,0] op_sel_hi:[0,1,1] neg_lo:[1,0,0]
    v_pk_fma_f32 v[38:39], v[22:23], v[12:13], v[38:39] op_sel:[1,1,0] op_sel_hi:[0,1,1] neg_lo:[1,0,0]
    v_pk_fma_f32 v[20:21], v[18:19], v[14:15], v[20:21] op_sel:[1,1,0] op_sel_hi:[0,1,1] neg_lo:[1,0,0]
    v_pk_mul_f32 v[42:43], v[34:35], v[10:11] op_sel:[0,0] op_sel_hi:[1,0]
    v_pk_mul_f32 v[46:47], v[38:39], v[10:11] op_sel:[0,0] op_sel_hi:[1,0]
    v_pk_fma_f32 v[42:43], v[34:35], v[10:11], v[42:43] op_sel:[1,1,0] op_sel_hi:[0,1,1] neg_lo:[1,0,0]
    v_pk_fma_f32 v[46:47], v[38:39], v[10:11], v[46:47] op_sel:[1,1,0] op_sel_hi:[0,1,1] neg_lo:[1,0,0]
    s_waitcnt lgkmcnt(0)
    v_mfma_f32_16x16x32_f16 v[88:91], v[52:55], v[68:71], 0
    v_mfma_f32_16x16x32_f16 v[88:91], v[56:59], v[72:75], v[88:91]
    v_mfma_f32_16x16x32_f16 v[88:91], v[60:63], v[76:79], v[88:91]
    v_mfma_f32_16x16x32_f16 v[88:91], v[64:67], v[80:83], v[88:91]
    v_cvt_pk_f16_f32 v52, v18, v19
    v_cvt_pk_f16_f32 v53, v22, v23
    v_cvt_pk_f16_f32 v54, v26, v27
    v_cvt_pk_f16_f32 v55, v30, v31
    v_cvt_pk_f16_f32 v56, v34, v35
    v_cvt_pk_f16_f32 v57, v38, v39
    v_cvt_pk_f16_f32 v58, v42, v43
    v_cvt_pk_f16_f32 v59, v46, v47
    v_cvt_pk_f16_f32 v60, v20, v21
    ds_write_addtid_b32 v52 offset:0
    ds_write_addtid_b32 v53 offset:288
    ds_write_addtid_b32 v54 offset:576
    ds_write_addtid_b32 v55 offset:864
    ds_write_addtid_b32 v56 offset:1152
    ds_write_addtid_b32 v57 offset:1440
    ds_write_addtid_b32 v58 offset:1728
    ds_write_addtid_b32 v59 offset:2016
    ds_write_addtid_b32 v60 offset:2304
    s_waitcnt lgkmcnt(0)
    ds_read_b128 v[52:55], v3 offset:0
    ds_read_b128 v[56:59], v3 offset:64
    ds_read_b128 v[60:63], v3 offset:128
    ds_read_b128 v[64:67], v3 offset:192
    v_lshl_add_u32 v2, v1, 4, s46
    v_mov_b32 v4, 0
    s_waitcnt lgkmcnt(0)
    v_mfma_f32_16x16x32_f16 v[92:95], v[52:55], v[68:71], 0
    v_mfma_f32_16x16x32_f16 v[92:95], v[56:59], v[72:75], v[92:95]
    v_mfma_f32_16x16x32_f16 v[92:95], v[60:63], v[76:79], v[92:95]
    v_mfma_f32_16x16x32_f16 v[92:95], v[64:67], v[80:83], v[92:95]
    ds_write_b128 v2, v[84:87]
    ds_write_b128 v2, v[88:91] offset:1024
    ds_write_addtid_b32 v4 offset:3072
    s_nop 4
    ds_write_b128 v2, v[92:95] offset:2048
    v_mov_b32 v10, v180
    v_mov_b32 v11, v181
    v_mov_b32 v12, v182
    v_mov_b32 v13, v183
    v_mov_b32 v14, v184
    v_mov_b32 v15, v185
L_pg_p2:
    s_lshl_b32 s42, s7, 2
    s_add_u32 s42, s42, 45328
    v_mov_b32 v30, s42
    s_mov_b32 s57, 0
L_sp8:
    ds_read_b32 v31, v30
    s_add_u32 s57, s57, 1
    s_waitcnt lgkmcnt(0)
    v_readfirstlane_b32 s56, v31
    s_cmp_gt_u32 s57, 2000000
    s_nop 2
    s_cbranch_scc1 L_end
    s_cmp_lt_u32 s56, 5
    s_cbranch_scc1 L_sp8
    s_sub_u32 s42, s3, 4
    s_mul_i32 s42, s42, 10240
    s_add_u32 s42, s42, 0
    s_mul_i32 s43, s4, 102400
    s_add_u32 s43, s43, s42
    s_add_u32 s43, s43, 14680064
    v_lshlrev_b32 v24, 4, v1
    s_add_u32 s44, s32, s43
    s_addc_u32 s45, s33, 0
    s_add_u32 m0, s42, 61440
    s_nop 0
    global_load_lds_dwordx4 v24, s[44:45] offset:0 sc1
    global_load_lds_dwordx4 v24, s[44:45] offset:1024 sc1
    global_load_lds_dwordx4 v24, s[44:45] offset:2048 sc1
    global_load_lds_dwordx4 v24, s[44:45] offset:3072 sc1
    s_add_u32 m0, s42, 65536
    s_add_u32 s44, s44, 4096
    s_addc_u32 s45, s45, 0
    global_load_lds_dwordx4 v24, s[44:45] offset:0 sc1
    global_load_lds_dwordx4 v24, s[44:45] offset:1024 sc1
    global_load_lds_dwordx4 v24, s[44:45] offset:2048 sc1
    global_load_lds_dwordx4 v24, s[44:45] offset:3072 sc1
    s_add_u32 m0, s42, 69632
    s_add_u32 s44, s44, 4096
    s_addc_u32 s45, s45, 0
    global_load_lds_dwordx4 v24, s[44:45] offset:0 sc1
    global_load_lds_dwordx4 v24, s[44:45] offset:1024 sc1
    s_branch L_pg_join
L_pg_lo:
    s_waitcnt lgkmcnt(0)
    s_barrier
    v_bfe_u32 v2, v1, 2, 1
    v_lshrrev_b32 v3, 5, v1
    v_bfe_u32 v4, v1, 2, 2
    v_and_b32 v5, 3, v1
    s_and_b32 s43, s3, 1
    s_lshl_b32 s43, s43, 2
    v_bfe_u32 v6, v1, 3, 2
    v_add_u32 v6, s43, v6
    v_lshl_add_u32 v7, v6, 2, v5
    v_lshl_add_u32 v7, v7, 1, v2
    s_lshr_b32 s42, s3, 1
    s_mul_i32 s42, s42, 80
    s_add_u32 s42, s42, 61440
    v_mul_u32_u24 v94, 40, v3
    v_add_u32 v94, s42, v94
    v_mul_u32_u24 v8, 496, v7
    v_add_u32 v8, v94, v8
    v_bfe_u32 v9, v1, 4, 1
    v_lshl_add_u32 v9, v9, 1, s43
    v_bfe_u32 v2, v1, 1, 1
    v_add_u32 v9, v9, v2
    v_lshl_add_u32 v9, v9, 2, v4
    v_and_b32 v2, 1, v1
    v_lshl_add_u32 v9, v9, 1, v2
    v_mul_u32_u24 v9, 496, v9
    v_add_u32 v9, v94, v9
    v_mul_u32_u24 v2, 40, v3
    v_lshl_add_u32 v9, v3, 3, v9
    v_sub_u32 v94, v9, v2
    ds_read_b64 v[16:17], v8 offset:7936
    ds_read_b64 v[18:19], v8 offset:7944
    ds_read_b64 v[20:21], v8 offset:7952
    ds_read_b64 v[22:23], v8 offset:7960
    ds_read_b64 v[24:25], v8 offset:7968
    ds_read_b64 v[36:37], v8 offset:4128
    ds_read_b64 v[38:39], v8 offset:4136
    ds_read_b64 v[40:41], v8 offset:4144
    ds_read_b64 v[42:43], v8 offset:4152
    ds_read_b64 v[44:45], v8 offset:4160
    ds_read_b64 v[26:27], v8 offset:8096
    ds_read_b64 v[28:29], v8 offset:8104
    ds_read_b64 v[30:31], v8 offset:8112
    ds_read_b64 v[32:33], v8 offset:8120
    ds_read_b64 v[34:35], v8 offset:8128
    s_waitcnt lgkmcnt(10)
    ds_read_b64 v[46:47], v8 offset:160
    ds_read_b64 v[48:49], v8 offset:168
    ds_read_b64 v[50:51], v8 offset:176
    ds_read_b64 v[52:53], v8 offset:184
    ds_read_b64 v[54:55], v8 offset:192
    s_mul_i32 s42, s4, 10
    s_lshr_b32 s43, s3, 1
    s_mul_i32 s43, s43, 5
    s_add_u32 s42, s42, s43
    s_lshl_b32 s42, s42, 8
    s_mul_i32 s43, s5, 81920
    s_add_u32 s42, s42, s43
    s_add_u32 s42, s42, s41
    s_add_u32 s42, s42, 4194304
    v_mul_u32_u24 v4, 768, v3
    v_lshrrev_b32 v2, 4, v7
    v_mul_u32_u24 v2, 20480, v2
    v_and_b32 v3, 15, v7
    v_lshl_add_u32 v2, v3, 4, v2
    v_add_u32 v2, v2, v4
    v_add_u32 v2, s42, v2
    v_cmp_le_u32 s[44:45], 1, v5
    v_cmp_le_u32 s[46:47], 2, v5
    v_cmp_le_u32 s[48:49], 3, v5
    v_mov_b32 v3, 0xffff
    v_cndmask_b32 v4, 0, v3, s[46:47]
    v_cndmask_b32 v3, v3, -1, s[44:45]
    v_cndmask_b32 v4, v4, -1, s[48:49]
    s_waitcnt lgkmcnt(5)
    v_mfma_f32_4x4x4_16b_bf16 v[60:63], v[36:37], v[16:17], 0
    v_mfma_f32_4x4x4_16b_bf16 v[56:59], v[26:27], v[16:17], 0
    s_nop 0
    v_mfma_f32_4x4x4_16b_bf16 v[60:63], v[38:39], v[18:19], v[60:63]
    v_mfma_f32_4x4x4_16b_bf16 v[56:59], v[28:29], v[18:19], v[56:59]
    s_nop 0
    v_mfma_f32_4x4x4_16b_bf16 v[60:63], v[40:41], v[20:21], v[60:63]
    v_mfma_f32_4x4x4_16b_bf16 v[56:59], v[30:31], v[20:21], v[56:59]
    s_nop 0
    v_mfma_f32_4x4x4_16b_bf16 v[60:63], v[42:43], v[22:23], v[60:63]
    v_mfma_f32_4x4x4_16b_bf16 v[56:59], v[32:33], v[22:23], v[56:59]
    s_nop 0
    v_mfma_f32_4x4x4_16b_bf16 v[60:63], v[44:45], v[24:25], v[60:63]
    v_mfma_f32_4x4x4_16b_bf16 v[56:59], v[34:35], v[24:25], v[56:59]
    s_waitcnt lgkmcnt(0)
    v_mfma_f32_4x4x4_16b_bf16 v[64:67], v[46:47], v[16:17], 0
    s_nop 1
    v_mfma_f32_4x4x4_16b_bf16 v[64:67], v[48:49], v[18:19], v[64:67]
    s_nop 1
    v_mfma_f32_4x4x4_16b_bf16 v[64:67], v[50:51], v[20:21], v[64:67]
    s_nop 1
    v_mfma_f32_4x4x4_16b_bf16 v[64:67], v[52:53], v[22:23], v[64:67]
    s_nop 1
    v_mfma_f32_4x4x4_16b_bf16 v[64:67], v[54:55], v[24:25], v[64:67]
    ds_read_b64_tr_b16 v[26:27], v9 offset:8256
    ds_read_b64_tr_b16 v[28:29], v9 offset:8264
    ds_read_b64_tr_b16 v[30:31], v9 offset:8272
    ds_read_b64_tr_b16 v[32:33], v9 offset:8280
    ds_read_b64_tr_b16 v[34:35], v94 offset:8288
    ds_read_b64_tr_b16 v[36:37], v9 offset:4288
    ds_read_b64_tr_b16 v[38:39], v9 offset:4296
    ds_read_b64_tr_b16 v[40:41], v9 offset:4304
    ds_read_b64_tr_b16 v[42:43], v9 offset:4312
    ds_read_b64_tr_b16 v[44:45], v94 offset:4320
    ds_read_b64_tr_b16 v[46:47], v9 offset:320
    ds_read_b64_tr_b16 v[48:49], v9 offset:328
    ds_read_b64_tr_b16 v[50:51], v9 offset:336
    ds_read_b64_tr_b16 v[52:53], v9 offset:344
    ds_read_b64_tr_b16 v[54:55], v94 offset:352
    s_cmp_lg_u32 s5, 0
    s_cbranch_scc1 L_at_nomask
    v_mov_b32 v88, 0xce6e6b28
    v_cmp_eq_u32 vcc, 0, v6
    v_cmp_ge_u32 s[50:51], 1, v6
    s_nop 0
    v_cndmask_b32 v60, v60, v88, vcc
    v_cndmask_b32 v61, v61, v88, vcc
    v_cndmask_b32 v62, v62, v88, vcc
    v_cndmask_b32 v63, v63, v88, vcc
    v_cndmask_b32 v65, v65, v88, s[50:51]
    v_cndmask_b32 v66, v66, v88, s[50:51]
    v_cndmask_b32 v67, v67, v88, s[50:51]
L_at_nomask:
    v_cndmask_b32 v57, v65, v57, s[44:45]
    v_cndmask_b32 v58, v66, v58, s[46:47]
    v_cndmask_b32 v59, v67, v59, s[48:49]
    v_cvt_pk_bf16_f32 v88, v56, v57
    v_cvt_pk_bf16_f32 v89, v58, v59
    v_cvt_pk_bf16_f32 v90, v60, v61
    v_cvt_pk_bf16_f32 v91, v62, v63
    v_lshlrev_b32 v56, 16, v88
    v_and_b32 v57, 0xffff0000, v88
    v_lshlrev_b32 v58, 16, v89
    v_and_b32 v59, 0xffff0000, v89
    v_lshlrev_b32 v60, 16, v90
    v_and_b32 v61, 0xffff0000, v90
    v_lshlrev_b32 v62, 16, v91
    v_and_b32 v63, 0xffff0000, v91
    s_mov_b32 s50, 1046804782
    s_mov_b32 s51, 1046804782
    v_pk_mul_f32 v[56:57], v[56:57], s[50:51]
    v_pk_mul_f32 v[58:59], v[58:59], s[50:51]
    v_pk_mul_f32 v[60:61], v[60:61], s[50:51]
    v_pk_mul_f32 v[62:63], v[62:63], s[50:51]
    v_cvt_pk_bf16_f32 v88, v56, v57
    v_cvt_pk_bf16_f32 v89, v58, v59
    v_cvt_pk_bf16_f32 v90, v60, v61
    v_cvt_pk_bf16_f32 v91, v62, v63
    v_lshlrev_b32 v56, 16, v88
    v_and_b32 v57, 0xffff0000, v88
    v_lshlrev_b32 v58, 16, v89
    v_and_b32 v59, 0xffff0000, v89
    v_lshlrev_b32 v60, 16, v90
    v_and_b32 v61, 0xffff0000, v90
    v_lshlrev_b32 v62, 16, v91
    v_and_b32 v63, 0xffff0000, v91
    v_max3_f32 v88, v56, v57, v58
    v_max3_f32 v89, v59, v60, v61
    v_max3_f32 v88, v88, v62, v63
    v_max_f32 v88, v88, v89
    s_mov_b32 s50, 1069066811
    s_mov_b32 s51, 1069066811
    v_mov_b32 v89, v88
    v_pk_add_f32 v[56:57], v[56:57], v[88:89] neg_lo:[0,1] neg_hi:[0,1]
    v_pk_add_f32 v[58:59], v[58:59], v[88:89] neg_lo:[0,1] neg_hi:[0,1]
    v_pk_add_f32 v[60:61], v[60:61], v[88:89] neg_lo:[0,1] neg_hi:[0,1]
    v_pk_add_f32 v[62:63], v[62:63], v[88:89] neg_lo:[0,1] neg_hi:[0,1]
    v_pk_mul_f32 v[56:57], v[56:57], s[50:51]
    v_pk_mul_f32 v[58:59], v[58:59], s[50:51]
    v_pk_mul_f32 v[60:61], v[60:61], s[50:51]
    v_pk_mul_f32 v[62:63], v[62:63], s[50:51]
    v_exp_f32 v56, v56
    v_exp_f32 v57, v57
    v_exp_f32 v58, v58
    v_exp_f32 v59, v59
    v_exp_f32 v60, v60
    v_exp_f32 v61, v61
    v_exp_f32 v62, v62
    v_exp_f32 v63, v63
    v_add_f32 v88, v56, v57
    v_add_f32 v89, v58, v59
    v_add_f32 v90, v60, v61
    v_add_f32 v91, v62, v63
    v_add_f32 v88, v88, v89
    v_add_f32 v90, v90, v91
    v_add_f32 v88, v88, v90
    v_rcp_f32 v88, v88
    s_nop 0
    v_mul_f32 v56, v56, v88
    v_mul_f32 v57, v57, v88
    v_mul_f32 v58, v58, v88
    v_mul_f32 v59, v59, v88
    v_mul_f32 v60, v60, v88
    v_mul_f32 v61, v61, v88
    v_mul_f32 v62, v62, v88
    v_mul_f32 v63, v63, v88
    v_cvt_pk_bf16_f32 v92, v56, v57
    v_cvt_pk_bf16_f32 v93, v58, v59
    v_cvt_pk_bf16_f32 v90, v60, v61
    v_cvt_pk_bf16_f32 v91, v62, v63
    v_and_b32 v88, v3, v92
    v_and_b32 v89, v4, v93
    v_xor_b32 v92, v88, v92
    v_xor_b32 v93, v89, v93
    s_waitcnt lgkmcnt(0)
    v_mfma_f32_4x4x4_16b_bf16 v[68:71], v[36:37], v[90:91], 0
    v_mfma_f32_4x4x4_16b_bf16 v[72:75], v[38:39], v[90:91], 0
    v_mfma_f32_4x4x4_16b_bf16 v[76:79], v[40:41], v[90:91], 0
    v_mfma_f32_4x4x4_16b_bf16 v[80:83], v[42:43], v[90:91], 0
    v_mfma_f32_4x4x4_16b_bf16 v[84:87], v[44:45], v[90:91], 0
    v_mfma_f32_4x4x4_16b_bf16 v[68:71], v[26:27], v[88:89], v[68:71]
    v_mfma_f32_4x4x4_16b_bf16 v[72:75], v[28:29], v[88:89], v[72:75]
    v_mfma_f32_4x4x4_16b_bf16 v[76:79], v[30:31], v[88:89], v[76:79]
    v_mfma_f32_4x4x4_16b_bf16 v[80:83], v[32:33], v[88:89], v[80:83]
    v_mfma_f32_4x4x4_16b_bf16 v[84:87], v[34:35], v[88:89], v[84:87]
    v_mfma_f32_4x4x4_16b_bf16 v[68:71], v[46:47], v[92:93], v[68:71]
    v_mfma_f32_4x4x4_16b_bf16 v[72:75], v[48:49], v[92:93], v[72:75]
    v_mfma_f32_4x4x4_16b_bf16 v[76:79], v[50:51], v[92:93], v[76:79]
    v_mfma_f32_4x4x4_16b_bf16 v[80:83], v[52:53], v[92:93], v[80:83]
    v_mfma_f32_4x4x4_16b_bf16 v[84:87], v[54:55], v[92:93], v[84:87]
    s_nop 0
    v_cvt_pk_bf16_f32 v16, v68, v69
    v_cvt_pk_bf16_f32 v17, v70, v71
    v_cvt_pk_bf16_f32 v18, v72, v73
    v_cvt_pk_bf16_f32 v19, v74, v75
    v_cvt_pk_bf16_f32 v20, v76, v77
    v_cvt_pk_bf16_f32 v21, v78, v79
    v_cvt_pk_bf16_f32 v22, v80, v81
    v_cvt_pk_bf16_f32 v23, v82, v83
    v_cvt_pk_bf16_f32 v24, v84, v85
    v_cvt_pk_bf16_f32 v25, v86, v87
    global_store_dwordx4 v2, v[16:19], s[32:33] sc1
    global_store_dwordx4 v2, v[20:23], s[32:33] offset:256 sc1
    v_mov_b32 v26, v24
    v_mov_b32 v27, v25
    s_nop 0
    v_permlane32_swap_b32 v24, v26
    v_permlane32_swap_b32 v25, v27
    s_mov_b32 exec_hi, 0
    global_store_dwordx4 v2, v[24:27], s[32:33] offset:512 sc1
    s_mov_b64 exec, -1
    s_lshl_b32 s42, s7, 2
    s_add_u32 s42, s42, 45328
    s_waitcnt vmcnt(0)
    v_mov_b32 v2, s42
    v_mov_b32 v4, 1
    s_mov_b64 exec, 1
    ds_add_rtn_u32 v4, v2, v4
    s_waitcnt lgkmcnt(0)
    s_mov_b64 exec, -1
    v_readfirstlane_b32 s56, v4
    s_nop 1
    s_cmp_eq_u32 s56, 3
    s_nop 0
    s_cbranch_scc0 L_pg_np
    s_lshl_b32 s43, s5, 3
    s_add_u32 s43, s43, s4
    s_lshl_b32 s43, s43, 7
    s_add_u32 s43, s43, s40
    s_add_u32 s43, s43, 36864
    v_lshl_add_u32 v3, v1, 4, s43
    v_mov_b32 v4, s34
    v_mov_b32 v5, s35
    v_mov_b32 v6, s34
    v_mov_b32 v7, s35
    s_mov_b64 exec, 0xff
    global_store_dwordx4 v3, v[4:7], s[32:33] sc1
    s_mov_b64 exec, -1
    v_mov_b32 v3, 1
    s_mov_b64 exec, 1
    ds_add_u32 v2, v3
    s_mov_b64 exec, -1
L_pg_np:
    s_cmp_eq_u32 s3, 0
    s_cbranch_scc0 L_pg_join
    s_lshl_b32 s42, s5, 10
    s_add_u32 s42, s42, s40
    s_add_u32 s42, s42, 36864
    v_and_b32 v2, 7, v1
    v_lshl_add_u32 v2, v2, 7, s42
    s_mov_b32 s57, 0
L_poll9:
    global_load_dwordx2 v[4:5], v2, s[32:33] sc1
    s_add_u32 s57, s57, 1
    s_waitcnt vmcnt(0)
    v_cmp_ne_u64 vcc, s[34:35], v[4:5]
    s_cmp_gt_u32 s57, 200000
    s_nop 2
    s_cbranch_scc1 L_end
    s_cbranch_vccnz L_poll9
L_pg_join:
    v_and_b32 v6, 15, v1
    v_lshrrev_b32 v7, 4, v1
    s_and_b32 s42, s3, 3
    s_lshr_b32 s43, s3, 2
    s_lshl_b32 s44, s5, 2
    s_add_u32 s44, s44, s42
    s_mul_i32 s44, s44, 20480
    s_mul_i32 s45, s43, 10240
    s_add_u32 s44, s44, s45
    s_add_u32 s44, s44, s41
    s_add_u32 s44, s44, 4194304
    v_lshl_add_u32 v2, v1, 4, s44
    v_add_u32 v3, 4096, v2
    v_add_u32 v4, 8192, v2
    s_mul_i32 s45, s43, 51200
    s_add_u32 s45, s45, 61440
    v_lshrrev_b32 v5, 2, v1
    v_mul_u32_u24 v5, 160, v5
    v_and_b32 v8, 3, v1
    v_lshl_add_u32 v5, v8, 3, v5
    v_add_u32 v5, s45, v5
    s_waitcnt vmcnt(0) lgkmcnt(0)
    s_barrier
    global_load_dwordx4 v[16:19], v2, s[32:33] offset:0 sc1
    global_load_dwordx4 v[20:23], v2, s[32:33] offset:1024 sc1
    global_load_dwordx4 v[24:27], v2, s[32:33] offset:2048 sc1
    global_load_dwordx4 v[28:31], v2, s[32:33] offset:3072 sc1
    global_load_dwordx4 v[32:35], v3, s[32:33] offset:0 sc1
    global_load_dwordx4 v[36:39], v3, s[32:33] offset:1024 sc1
    global_load_dwordx4 v[40:43], v3, s[32:33] offset:2048 sc1
    global_load_dwordx4 v[44:47], v3, s[32:33] offset:3072 sc1
    global_load_dwordx4 v[48:51], v4, s[32:33] offset:0 sc1
    global_load_dwordx4 v[52:55], v4, s[32:33] offset:1024 sc1
    ds_read_b64_tr_b16 v[76:77], v5 offset:0
    ds_read_b64_tr_b16 v[78:79], v5 offset:2560
    ds_read_b64_tr_b16 v[80:81], v5 offset:32
    ds_read_b64_tr_b16 v[82:83], v5 offset:2592
    ds_read_b64_tr_b16 v[84:85], v5 offset:64
    ds_read_b64_tr_b16 v[86:87], v5 offset:2624
    ds_read_b64_tr_b16 v[88:89], v5 offset:96
    ds_read_b64_tr_b16 v[90:91], v5 offset:2656
    s_mul_i32 s44, s42, 5120
    s_add_u32 s44, s44, 61440
    v_lshl_add_u32 v2, v1, 4, s44
    s_mul_i32 s44, s43, 6912
    s_lshl_b32 s45, s42, 5
    s_add_u32 s44, s44, s45
    s_add_u32 s44, s44, 81920
    v_mul_u32_u24 v3, 144, v6
    v_lshl_add_u32 v3, v7, 3, v3
    v_add_u32 v3, s44, v3
    s_mul_i32 s44, s7, 16384
    s_lshl_b32 s45, s5, 9
    s_add_u32 s44, s44, s45
    s_lshl_b32 s45, s42, 7
    s_add_u32 s44, s44, s45
    s_add_u32 s44, s44, 262144
    v_lshl_add_u32 v9, v7, 2, v8
    v_lshl_add_u32 v9, v9, 3, s44
    v_and_b32 v8, 4, v1
    v_add_u32 v9, v9, v8
    v_cmp_eq_u32 s[50:51], 0, v8
    v_and_b32 v8, 1, v1
    v_cmp_eq_u32 s[46:47], 0, v8
    v_and_b32 v8, 2, v1
    v_cmp_eq_u32 s[48:49], 0, v8
    ds_read_b64_tr_b16 v[92:93], v5 offset:128
    ds_read_b64_tr_b16 v[94:95], v5 offset:2688
    s_waitcnt vmcnt(9) lgkmcnt(8)
    v_mfma_f32_16x16x32_bf16 v[56:59], v[16:19], v[76:79], 0
    ds_read_b64_tr_b16 v[76:77], v5 offset:5120
    ds_read_b64_tr_b16 v[78:79], v5 offset:7680
    s_waitcnt lgkmcnt(8)
    v_mfma_f32_16x16x32_bf16 v[60:63], v[16:19], v[80:83], 0
    ds_read_b64_tr_b16 v[80:81], v5 offset:5152
    ds_read_b64_tr_b16 v[82:83], v5 offset:7712
    s_waitcnt lgkmcnt(8)
    v_mfma_f32_16x16x32_bf16 v[64:67], v[16:19], v[84:87], 0
    ds_read_b64_tr_b16 v[84:85], v5 offset:5184
    ds_read_b64_tr_b16 v[86:87], v5 offset:7744
    s_waitcnt lgkmcnt(8)
    v_mfma_f32_16x16x32_bf16 v[68:71], v[16:19], v[88:91], 0
    ds_read_b64_tr_b16 v[88:89], v5 offset:5216
    ds_read_b64_tr_b16 v[90:91], v5 offset:7776
    s_waitcnt lgkmcnt(8)
    v_mfma_f32_16x16x32_bf16 v[72:75], v[16:19], v[92:95], 0
    ds_read_b64_tr_b16 v[92:93], v5 offset:5248
    ds_read_b64_tr_b16 v[94:95], v5 offset:7808
    s_waitcnt vmcnt(8) lgkmcnt(8)
    v_mfma_f32_16x16x32_bf16 v[56:59], v[20:23], v[76:79], v[56:59]
    ds_read_b64_tr_b16 v[76:77], v5 offset:10240
    ds_read_b64_tr_b16 v[78:79], v5 offset:12800
    s_waitcnt lgkmcnt(8)
    v_mfma_f32_16x16x32_bf16 v[60:63], v[20:23], v[80:83], v[60:63]
    ds_read_b64_tr_b16 v[80:81], v5 offset:10272
    ds_read_b64_tr_b16 v[82:83], v5 offset:12832
    s_waitcnt lgkmcnt(8)
    v_mfma_f32_16x16x32_bf16 v[64:67], v[20:23], v[84:87], v[64:67]
    ds_read_b64_tr_b16 v[84:85], v5 offset:10304
    ds_read_b64_tr_b16 v[86:87], v5 offset:12864
    s_waitcnt lgkmcnt(8)
    v_mfma_f32_16x16x32_bf16 v[68:71], v[20:23], v[88:91], v[68:71]
    ds_read_b64_tr_b16 v[88:89], v5 offset:10336
    ds_read_b64_tr_b16 v[90:91], v5 offset:12896
    s_waitcnt lgkmcnt(8)
    v_mfma_f32_16x16x32_bf16 v[72:75], v[20:23], v[92:95], v[72:75]
    ds_read_b64_tr_b16 v[92:93], v5 offset:10368
    ds_read_b64_tr_b16 v[94:95], v5 offset:12928
    s_waitcnt vmcnt(7) lgkmcnt(8)
    v_mfma_f32_16x16x32_bf16 v[56:59], v[24:27], v[76:79], v[56:59]
    ds_read_b64_tr_b16 v[76:77], v5 offset:15360
    ds_read_b64_tr_b16 v[78:79], v5 offset:17920
    s_waitcnt lgkmcnt(8)
    v_mfma_f32_16x16x32_bf16 v[60:63], v[24:27], v[80:83], v[60:63]
    ds_read_b64_tr_b16 v[80:81], v5 offset:15392
    ds_read_b64_tr_b16 v[82:83], v5 offset:17952
    s_waitcnt lgkmcnt(8)
    v_mfma_f32_16x16x32_bf16 v[64:67], v[24:27], v[84:87], v[64:67]
    ds_read_b64_tr_b16 v[84:85], v5 offset:15424
    ds_read_b64_tr_b16 v[86:87], v5 offset:17984
    s_waitcnt lgkmcnt(8)
    v_mfma_f32_16x16x32_bf16 v[68:71], v[24:27], v[88:91], v[68:71]
    ds_read_b64_tr_b16 v[88:89], v5 offset:15456
    ds_read_b64_tr_b16 v[90:91], v5 offset:18016
    s_waitcnt lgkmcnt(8)
    v_mfma_f32_16x16x32_bf16 v[72:75], v[24:27], v[92:95], v[72:75]
    ds_read_b64_tr_b16 v[92:93], v5 offset:15488
    ds_read_b64_tr_b16 v[94:95], v5 offset:18048
    s_waitcnt vmcnt(6) lgkmcnt(8)
    v_mfma_f32_16x16x32_bf16 v[56:59], v[28:31], v[76:79], v[56:59]
    ds_read_b64_tr_b16 v[76:77], v5 offset:20480
    ds_read_b64_tr_b16 v[78:79], v5 offset:23040
    s_waitcnt lgkmcnt(8)
    v_mfma_f32_16x16x32_bf16 v[60:63], v[28:31], v[80:83], v[60:63]
    ds_read_b64_tr_b16 v[80:81], v5 offset:20512
    ds_read_b64_tr_b16 v[82:83], v5 offset:23072
    s_waitcnt lgkmcnt(8)
    v_mfma_f32_16x16x32_bf16 v[64:67], v[28:31], v[84:87], v[64:67]
    ds_read_b64_tr_b16 v[84:85], v5 offset:20544
    ds_read_b64_tr_b16 v[86:87], v5 offset:23104
    s_waitcnt lgkmcnt(8)
    v_mfma_f32_16x16x32_bf16 v[68:71], v[28:31], v[88:91], v[68:71]
    ds_read_b64_tr_b16 v[88:89], v5 offset:20576
    ds_read_b64_tr_b16 v[90:91], v5 offset:23136
    s_waitcnt lgkmcnt(8)
    v_mfma_f32_16x16x32_bf16 v[72:75], v[28:31], v[92:95], v[72:75]
    ds_read_b64_tr_b16 v[92:93], v5 offset:20608
    ds_read_b64_tr_b16 v[94:95], v5 offset:23168
    s_waitcnt vmcnt(5) lgkmcnt(8)
    v_mfma_f32_16x16x32_bf16 v[56:59], v[32:35], v[76:79], v[56:59]
    ds_read_b64_tr_b16 v[76:77], v5 offset:25600
    ds_read_b64_tr_b16 v[78:79], v5 offset:28160
    s_waitcnt lgkmcnt(8)
    v_mfma_f32_16x16x32_bf16 v[60:63], v[32:35], v[80:83], v[60:63]
    ds_read_b64_tr_b16 v[80:81], v5 offset:25632
    ds_read_b64_tr_b16 v[82:83], v5 offset:28192
    s_waitcnt lgkmcnt(8)
    v_mfma_f32_16x16x32_bf16 v[64:67], v[32:35], v[84:87], v[64:67]
    ds_read_b64_tr_b16 v[84:85], v5 offset:25664
    ds_read_b64_tr_b16 v[86:87], v5 offset:28224
    s_waitcnt lgkmcnt(8)
    v_mfma_f32_16x16x32_bf16 v[68:71], v[32:35], v[88:91], v[68:71]
    ds_read_b64_tr_b16 v[88:89], v5 offset:25696
    ds_read_b64_tr_b16 v[90:91], v5 offset:28256
    s_waitcnt lgkmcnt(8)
    v_mfma_f32_16x16x32_bf16 v[72:75], v[32:35], v[92:95], v[72:75]
    ds_read_b64_tr_b16 v[92:93], v5 offset:25728
    ds_read_b64_tr_b16 v[94:95], v5 offset:28288
    s_waitcnt vmcnt(4) lgkmcnt(8)
    v_mfma_f32_16x16x32_bf16 v[56:59], v[36:39], v[76:79], v[56:59]
    ds_read_b64_tr_b16 v[76:77], v5 offset:30720
    ds_read_b64_tr_b16 v[78:79], v5 offset:33280
    s_waitcnt lgkmcnt(8)
    v_mfma_f32_16x16x32_bf16 v[60:63], v[36:39], v[80:83], v[60:63]
    ds_read_b64_tr_b16 v[80:81], v5 offset:30752
    ds_read_b64_tr_b16 v[82:83], v5 offset:33312
    s_waitcnt lgkmcnt(8)
    v_mfma_f32_16x16x32_bf16 v[64:67], v[36:39], v[84:87], v[64:67]
    ds_read_b64_tr_b16 v[84:85], v5 offset:30784
    ds_read_b64_tr_b16 v[86:87], v5 offset:33344
    s_waitcnt lgkmcnt(8)
    v_mfma_f32_16x16x32_bf16 v[68:71], v[36:39], v[88:91], v[68:71]
    ds_read_b64_tr_b16 v[88:89], v5 offset:30816
    ds_read_b64_tr_b16 v[90:91], v5 offset:33376
    s_waitcnt lgkmcnt(8)
    v_mfma_f32_16x16x32_bf16 v[72:75], v[36:39], v[92:95], v[72:75]
    ds_read_b64_tr_b16 v[92:93], v5 offset:30848
    ds_read_b64_tr_b16 v[94:95], v5 offset:33408
    s_waitcnt vmcnt(3) lgkmcnt(8)
    v_mfma_f32_16x16x32_bf16 v[56:59], v[40:43], v[76:79], v[56:59]
    ds_read_b64_tr_b16 v[76:77], v5 offset:35840
    ds_read_b64_tr_b16 v[78:79], v5 offset:38400
    s_waitcnt lgkmcnt(8)
    v_mfma_f32_16x16x32_bf16 v[60:63], v[40:43], v[80:83], v[60:63]
    ds_read_b64_tr_b16 v[80:81], v5 offset:35872
    ds_read_b64_tr_b16 v[82:83], v5 offset:38432
    s_waitcnt lgkmcnt(8)
    v_mfma_f32_16x16x32_bf16 v[64:67], v[40:43], v[84:87], v[64:67]
    ds_read_b64_tr_b16 v[84:85], v5 offset:35904
    ds_read_b64_tr_b16 v[86:87], v5 offset:38464
    s_waitcnt lgkmcnt(8)
    v_mfma_f32_16x16x32_bf16 v[68:71], v[40:43], v[88:91], v[68:71]
    ds_read_b64_tr_b16 v[88:89], v5 offset:35936
    ds_read_b64_tr_b16 v[90:91], v5 offset:38496
    s_waitcnt lgkmcnt(8)
    v_mfma_f32_16x16x32_bf16 v[72:75], v[40:43], v[92:95], v[72:75]
    ds_read_b64_tr_b16 v[92:93], v5 offset:35968
    ds_read_b64_tr_b16 v[94:95], v5 offset:38528
    s_waitcnt vmcnt(2) lgkmcnt(8)
    v_mfma_f32_16x16x32_bf16 v[56:59], v[44:47], v[76:79], v[56:59]
    ds_read_b64_tr_b16 v[76:77], v5 offset:40960
    ds_read_b64_tr_b16 v[78:79], v5 offset:43520
    s_waitcnt lgkmcnt(8)
    v_mfma_f32_16x16x32_bf16 v[60:63], v[44:47], v[80:83], v[60:63]
    ds_read_b64_tr_b16 v[80:81], v5 offset:40992
    ds_read_b64_tr_b16 v[82:83], v5 offset:43552
    s_waitcnt lgkmcnt(8)
    v_mfma_f32_16x16x32_bf16 v[64:67], v[44:47], v[84:87], v[64:67]
    ds_read_b64_tr_b16 v[84:85], v5 offset:41024
    ds_read_b64_tr_b16 v[86:87], v5 offset:43584
    s_waitcnt lgkmcnt(8)
    v_mfma_f32_16x16x32_bf16 v[68:71], v[44:47], v[88:91], v[68:71]
    ds_read_b64_tr_b16 v[88:89], v5 offset:41056
    ds_read_b64_tr_b16 v[90:91], v5 offset:43616
    s_waitcnt lgkmcnt(8)
    v_mfma_f32_16x16x32_bf16 v[72:75], v[44:47], v[92:95], v[72:75]
    ds_read_b64_tr_b16 v[92:93], v5 offset:41088
    ds_read_b64_tr_b16 v[94:95], v5 offset:43648
    s_waitcnt vmcnt(1) lgkmcnt(8)
    v_mfma_f32_16x16x32_bf16 v[56:59], v[48:51], v[76:79], v[56:59]
    ds_read_b64_tr_b16 v[76:77], v5 offset:46080
    ds_read_b64_tr_b16 v[78:79], v5 offset:48640
    s_waitcnt lgkmcnt(8)
    v_mfma_f32_16x16x32_bf16 v[60:63], v[48:51], v[80:83], v[60:63]
    ds_read_b64_tr_b16 v[80:81], v5 offset:46112
    ds_read_b64_tr_b16 v[82:83], v5 offset:48672
    s_waitcnt lgkmcnt(8)
    v_mfma_f32_16x16x32_bf16 v[64:67], v[48:51], v[84:87], v[64:67]
    ds_read_b64_tr_b16 v[84:85], v5 offset:46144
    ds_read_b64_tr_b16 v[86:87], v5 offset:48704
    s_waitcnt lgkmcnt(8)
    v_mfma_f32_16x16x32_bf16 v[68:71], v[48:51], v[88:91], v[68:71]
    ds_read_b64_tr_b16 v[88:89], v5 offset:46176
    ds_read_b64_tr_b16 v[90:91], v5 offset:48736
    s_waitcnt lgkmcnt(8)
    v_mfma_f32_16x16x32_bf16 v[72:75], v[48:51], v[92:95], v[72:75]
    ds_read_b64_tr_b16 v[92:93], v5 offset:46208
    ds_read_b64_tr_b16 v[94:95], v5 offset:48768
    s_waitcnt vmcnt(0) lgkmcnt(8)
    v_mfma_f32_16x16x32_bf16 v[56:59], v[52:55], v[76:79], v[56:59]
    s_waitcnt lgkmcnt(6)
    v_mfma_f32_16x16x32_bf16 v[60:63], v[52:55], v[80:83], v[60:63]
    s_waitcnt lgkmcnt(4)
    v_mfma_f32_16x16x32_bf16 v[64:67], v[52:55], v[84:87], v[64:67]
    s_waitcnt lgkmcnt(2)
    v_mfma_f32_16x16x32_bf16 v[68:71], v[52:55], v[88:91], v[68:71]
    s_waitcnt lgkmcnt(0)
    v_mfma_f32_16x16x32_bf16 v[72:75], v[52:55], v[92:95], v[72:75]
    s_barrier
    s_cmp_ge_u32 s3, 4
    s_nop 4
    s_cbranch_scc1 L_a2_k1
    ds_write_b128 v2, v[68:71] offset:3072
    ds_write_b128 v2, v[72:75] offset:4096
    s_waitcnt lgkmcnt(0)
    s_barrier
    ds_read_b128 v[16:19], v2 offset:0
    ds_read_b128 v[20:23], v2 offset:1024
    ds_read_b128 v[24:27], v2 offset:2048
    v_lshlrev_b32 v28, 16, v10
    v_and_b32 v29, 0xffff0000, v10
    v_lshlrev_b32 v30, 16, v11
    v_and_b32 v31, 0xffff0000, v11
    v_lshlrev_b32 v32, 16, v12
    v_and_b32 v33, 0xffff0000, v12
    v_lshlrev_b32 v34, 16, v13
    v_and_b32 v35, 0xffff0000, v13
    v_lshlrev_b32 v36, 16, v14
    v_and_b32 v37, 0xffff0000, v14
    v_lshlrev_b32 v38, 16, v15
    v_and_b32 v39, 0xffff0000, v15
    s_waitcnt lgkmcnt(0)
    v_add_f32 v16, v16, v56
    v_add_f32 v17, v17, v57
    v_add_f32 v18, v18, v58
    v_add_f32 v19, v19, v59
    v_add_f32 v20, v20, v60
    v_add_f32 v21, v21, v61
    v_add_f32 v22, v22, v62
    v_add_f32 v23, v23, v63
    v_add_f32 v24, v24, v64
    v_add_f32 v25, v25, v65
    v_add_f32 v26, v26, v66
    v_add_f32 v27, v27, v67
    v_cvt_pk_bf16_f32 v40, v16, v17
    v_cvt_pk_bf16_f32 v41, v18, v19
    v_cvt_pk_bf16_f32 v42, v20, v21
    v_cvt_pk_bf16_f32 v43, v22, v23
    v_cvt_pk_bf16_f32 v44, v24, v25
    v_cvt_pk_bf16_f32 v45, v26, v27
    v_lshlrev_b32 v16, 16, v40
    v_and_b32 v17, 0xffff0000, v40
    v_lshlrev_b32 v18, 16, v41
    v_and_b32 v19, 0xffff0000, v41
    v_lshlrev_b32 v20, 16, v42
    v_and_b32 v21, 0xffff0000, v42
    v_lshlrev_b32 v22, 16, v43
    v_and_b32 v23, 0xffff0000, v43
    v_lshlrev_b32 v24, 16, v44
    v_and_b32 v25, 0xffff0000, v44
    v_lshlrev_b32 v26, 16, v45
    v_and_b32 v27, 0xffff0000, v45
    v_add_f32 v28, v28, v16
    v_add_f32 v29, v29, v17
    v_add_f32 v30, v30, v18
    v_add_f32 v31, v31, v19
    v_add_f32 v32, v32, v20
    v_add_f32 v33, v33, v21
    v_add_f32 v34, v34, v22
    v_add_f32 v35, v35, v23
    v_add_f32 v36, v36, v24
    v_add_f32 v37, v37, v25
    v_add_f32 v38, v38, v26
    v_add_f32 v39, v39, v27
    v_cvt_pk_bf16_f32 v40, v28, v29
    v_cvt_pk_bf16_f32 v41, v30, v31
    v_cvt_pk_bf16_f32 v42, v32, v33
    v_cvt_pk_bf16_f32 v43, v34, v35
    v_cvt_pk_bf16_f32 v44, v36, v37
    v_cvt_pk_bf16_f32 v45, v38, v39
    ds_write_b64 v3, v[40:41] offset:0
    ds_write_b64 v3, v[42:43] offset:2304
    ds_write_b64 v3, v[44:45] offset:4608
    v_lshlrev_b32 v28, 16, v40
    v_and_b32 v29, 0xffff0000, v40
    v_lshlrev_b32 v30, 16, v41
    v_and_b32 v31, 0xffff0000, v41
    v_lshlrev_b32 v32, 16, v42
    v_and_b32 v33, 0xffff0000, v42
    v_lshlrev_b32 v34, 16, v43
    v_and_b32 v35, 0xffff0000, v43
    v_lshlrev_b32 v36, 16, v44
    v_and_b32 v37, 0xffff0000, v44
    v_lshlrev_b32 v38, 16, v45
    v_and_b32 v39, 0xffff0000, v45
    v_add_f32 v56, v28, v32
    v_mul_f32 v60, v28, v28
    v_add_f32 v57, v29, v33
    v_mul_f32 v61, v29, v29
    v_add_f32 v58, v30, v34
    v_mul_f32 v62, v30, v30
    v_add_f32 v59, v31, v35
    v_mul_f32 v63, v31, v31
    v_fmac_f32 v60, v32, v32
    v_fmac_f32 v61, v33, v33
    v_fmac_f32 v62, v34, v34
    v_fmac_f32 v63, v35, v35
    v_add_f32 v56, v56, v36
    v_fmac_f32 v60, v36, v36
    v_add_f32 v57, v57, v37
    v_fmac_f32 v61, v37, v37
    v_add_f32 v58, v58, v38
    v_fmac_f32 v62, v38, v38
    v_add_f32 v59, v59, v39
    v_fmac_f32 v63, v39, v39
    v_cndmask_b32 v64, v57, v56, s[46:47]
    v_cndmask_b32 v68, v56, v57, s[46:47]
    v_cndmask_b32 v65, v61, v60, s[46:47]
    v_cndmask_b32 v69, v60, v61, s[46:47]
    v_cndmask_b32 v66, v59, v58, s[46:47]
    v_cndmask_b32 v70, v58, v59, s[46:47]
    v_cndmask_b32 v67, v63, v62, s[46:47]
    v_cndmask_b32 v71, v62, v63, s[46:47]
    v_add_f32_dpp v64, v68, v64 quad_perm:[1,0,3,2] row_mask:0xf bank_mask:0xf
    v_add_f32_dpp v65, v69, v65 quad_perm:[1,0,3,2] row_mask:0xf bank_mask:0xf
    v_add_f32_dpp v66, v70, v66 quad_perm:[1,0,3,2] row_mask:0xf bank_mask:0xf
    v_add_f32_dpp v67, v71, v67 quad_perm:[1,0,3,2] row_mask:0xf bank_mask:0xf
    v_cndmask_b32 v68, v64, v66, s[48:49]
    v_cndmask_b32 v64, v66, v64, s[48:49]
    v_cndmask_b32 v69, v65, v67, s[48:49]
    v_cndmask_b32 v65, v67, v65, s[48:49]
    v_add_f32_dpp v64, v68, v64 quad_perm:[2,3,0,1] row_mask:0xf bank_mask:0xf
    s_nop 0
    v_add_f32_dpp v65, v69, v65 quad_perm:[2,3,0,1] row_mask:0xf bank_mask:0xf
    v_add_f32_dpp v64, v64, v64 row_ror:4 row_mask:0xf bank_mask:0xf
    s_nop 0
    v_add_f32_dpp v65, v65, v65 row_ror:4 row_mask:0xf bank_mask:0xf
    v_add_f32_dpp v64, v64, v64 row_ror:8 row_mask:0xf bank_mask:0xf
    s_nop 0
    v_add_f32_dpp v65, v65, v65 row_ror:8 row_mask:0xf bank_mask:0xf
    v_cndmask_b32 v64, v65, v64, s[50:51]
    s_mov_b32 exec_lo, 0x00ff00ff
    s_mov_b32 exec_hi, 0x00ff00ff
    global_atomic_add_f32 v9, v64, s[32:33]
    s_mov_b64 exec, -1
    s_branch L_a2_done
L_a2_k1:
    ds_write_b128 v2, v[56:59] offset:0
    ds_write_b128 v2, v[60:63] offset:1024
    ds_write_b128 v2, v[64:67] offset:2048
    s_waitcnt lgkmcnt(0)
    s_barrier
    ds_read_b128 v[16:19], v2 offset:3072
    ds_read_b128 v[20:23], v2 offset:4096
    v_lshlrev_b32 v28, 16, v10
    v_and_b32 v29, 0xffff0000, v10
    v_lshlrev_b32 v30, 16, v11
    v_and_b32 v31, 0xffff0000, v11
    v_lshlrev_b32 v32, 16, v12
    v_and_b32 v33, 0xffff0000, v12
    v_lshlrev_b32 v34, 16, v13
    v_and_b32 v35, 0xffff0000, v13
    s_waitcnt lgkmcnt(0)
    v_add_f32 v16, v16, v68
    v_add_f32 v17, v17, v69
    v_add_f32 v18, v18, v70
    v_add_f32 v19, v19, v71
    v_add_f32 v20, v20, v72
    v_add_f32 v21, v21, v73
    v_add_f32 v22, v22, v74
    v_add_f32 v23, v23, v75
    v_cvt_pk_bf16_f32 v40, v16, v17
    v_cvt_pk_bf16_f32 v41, v18, v19
    v_cvt_pk_bf16_f32 v42, v20, v21
    v_cvt_pk_bf16_f32 v43, v22, v23
    v_lshlrev_b32 v16, 16, v40
    v_and_b32 v17, 0xffff0000, v40
    v_lshlrev_b32 v18, 16, v41
    v_and_b32 v19, 0xffff0000, v41
    v_lshlrev_b32 v20, 16, v42
    v_and_b32 v21, 0xffff0000, v42
    v_lshlrev_b32 v22, 16, v43
    v_and_b32 v23, 0xffff0000, v43
    v_add_f32 v28, v28, v16
    v_add_f32 v29, v29, v17
    v_add_f32 v30, v30, v18
    v_add_f32 v31, v31, v19
    v_add_f32 v32, v32, v20
    v_add_f32 v33, v33, v21
    v_add_f32 v34, v34, v22
    v_add_f32 v35, v35, v23
    v_cvt_pk_bf16_f32 v40, v28, v29
    v_cvt_pk_bf16_f32 v41, v30, v31
    v_cvt_pk_bf16_f32 v42, v32, v33
    v_cvt_pk_bf16_f32 v43, v34, v35
    ds_write_b64 v3, v[40:41] offset:0
    ds_write_b64 v3, v[42:43] offset:2304
    v_lshlrev_b32 v28, 16, v40
    v_and_b32 v29, 0xffff0000, v40
    v_lshlrev_b32 v30, 16, v41
    v_and_b32 v31, 0xffff0000, v41
    v_lshlrev_b32 v32, 16, v42
    v_and_b32 v33, 0xffff0000, v42
    v_lshlrev_b32 v34, 16, v43
    v_and_b32 v35, 0xffff0000, v43
    v_add_f32 v56, v28, v32
    v_mul_f32 v60, v28, v28
    v_add_f32 v57, v29, v33
    v_mul_f32 v61, v29, v29
    v_add_f32 v58, v30, v34
    v_mul_f32 v62, v30, v30
    v_add_f32 v59, v31, v35
    v_mul_f32 v63, v31, v31
    v_fmac_f32 v60, v32, v32
    v_fmac_f32 v61, v33, v33
    v_fmac_f32 v62, v34, v34
    v_fmac_f32 v63, v35, v35
    v_cndmask_b32 v64, v57, v56, s[46:47]
    v_cndmask_b32 v68, v56, v57, s[46:47]
    v_cndmask_b32 v65, v61, v60, s[46:47]
    v_cndmask_b32 v69, v60, v61, s[46:47]
    v_cndmask_b32 v66, v59, v58, s[46:47]
    v_cndmask_b32 v70, v58, v59, s[46:47]
    v_cndmask_b32 v67, v63, v62, s[46:47]
    v_cndmask_b32 v71, v62, v63, s[46:47]
    v_add_f32_dpp v64, v68, v64 quad_perm:[1,0,3,2] row_mask:0xf bank_mask:0xf
    v_add_f32_dpp v65, v69, v65 quad_perm:[1,0,3,2] row_mask:0xf bank_mask:0xf
    v_add_f32_dpp v66, v70, v66 quad_perm:[1,0,3,2] row_mask:0xf bank_mask:0xf
    v_add_f32_dpp v67, v71, v67 quad_perm:[1,0,3,2] row_mask:0xf bank_mask:0xf
    v_cndmask_b32 v68, v64, v66, s[48:49]
    v_cndmask_b32 v64, v66, v64, s[48:49]
    v_cndmask_b32 v69, v65, v67, s[48:49]
    v_cndmask_b32 v65, v67, v65, s[48:49]
    v_add_f32_dpp v64, v68, v64 quad_perm:[2,3,0,1] row_mask:0xf bank_mask:0xf
    s_nop 0
    v_add_f32_dpp v65, v69, v65 quad_perm:[2,3,0,1] row_mask:0xf bank_mask:0xf
    v_add_f32_dpp v64, v64, v64 row_ror:4 row_mask:0xf bank_mask:0xf
    s_nop 0
    v_add_f32_dpp v65, v65, v65 row_ror:4 row_mask:0xf bank_mask:0xf
    v_add_f32_dpp v64, v64, v64 row_ror:8 row_mask:0xf bank_mask:0xf
    s_nop 0
    v_add_f32_dpp v65, v65, v65 row_ror:8 row_mask:0xf bank_mask:0xf
    v_cndmask_b32 v64, v65, v64, s[50:51]
    s_mov_b32 exec_lo, 0x00ff00ff
    s_mov_b32 exec_hi, 0x00ff00ff
    global_atomic_add_f32 v9, v64, s[32:33]
    s_mov_b64 exec, -1
L_a2_done:
    v_lshrrev_b32 v2, 3, v0
    v_and_b32 v3, 7, v0
    v_mul_u32_u24 v4, 144, v2
    v_lshl_add_u32 v4, v3, 4, v4
    v_add_u32 v4, 81920, v4
    s_mul_i32 s44, s4, 327680
    s_lshl_b32 s45, s5, 7
    s_add_u32 s44, s44, s45
    s_add_u32 s44, s44, s41
    s_add_u32 s44, s44, 9437184
    v_lshl_add_u32 v5, v2, 12, s44
    v_lshl_add_u32 v5, v3, 4, v5
    v_add_u32 v8, 262144, v5
    s_waitcnt lgkmcnt(0)
    s_barrier
    ds_read_b128 v[20:23], v4
    ds_read_b128 v[24:27], v4 offset:9216
    s_waitcnt lgkmcnt(1)
    global_store_dwordx4 v5, v[20:23], s[32:33] sc1
    s_cmp_ge_u32 s3, 2
    s_cbranch_scc1 L_a2_st
    s_waitcnt lgkmcnt(0)
    global_store_dwordx4 v8, v[24:27], s[32:33] sc1
L_a2_st:
    s_cmp_eq_u32 s7, 0
    s_cbranch_scc0 L_u_nt
    s_getpc_b64 s[50:51]
L_tbref:
    s_add_u32 s50, s50, L_tab1-L_tbref
    s_addc_u32 s51, s51, 0
    v_lshlrev_b32 v70, 1, v0
    v_lshlrev_b32 v71, 2, v0
    v_and_b32 v72, 0x7e, v70
    global_load_ushort v80, v70, s[50:51]
    global_load_ushort v81, v70, s[50:51] offset:1024
    global_load_ushort v82, v72, s[50:51] offset:2048
    global_load_dword v83, v71, s[50:51] offset:2176
    v_add_u32 v71, 2048, v71
    global_load_dword v84, v71, s[50:51] offset:2176
L_u_nt:
    s_waitcnt vmcnt(0)
    s_barrier
    s_cmp_eq_u32 s3, 0
    s_cbranch_scc0 L_u_np
    s_lshl_b32 s42, s4, 5
    s_add_u32 s42, s42, s5
    s_lshl_b32 s42, s42, 7
    s_add_u32 s42, s42, s40
    s_add_u32 s42, s42, 69632
    v_lshl_add_u32 v2, v1, 4, s42
    v_mov_b32 v4, s34
    v_mov_b32 v5, s35
    v_mov_b32 v6, s34
    v_mov_b32 v7, s35
    s_mov_b64 exec, 0xff
    global_store_dwordx4 v2, v[4:7], s[32:33] sc1
    s_mov_b64 exec, -1
L_u_np:
    s_cmp_eq_u32 s7, 0
    s_cbranch_scc0 L_u_nb
    ds_read_b32 v16, v80 offset:0
    ds_read_b32 v17, v80 offset:4608
    ds_read_b32 v18, v80 offset:9216
    ds_read_b32 v19, v80 offset:13824
    ds_read_b32 v20, v80 offset:18432
    ds_read_b32 v21, v80 offset:23040
    ds_read_b32 v22, v80 offset:27648
    ds_read_b32 v23, v80 offset:32256
    ds_read_b32 v24, v80 offset:36864
    s_waitcnt lgkmcnt(6)
    ds_read_b32 v25, v81 offset:0
    ds_read_b32 v26, v81 offset:4608
    ds_read_b32 v27, v81 offset:9216
    ds_read_b32 v28, v81 offset:13824
    ds_read_b32 v29, v81 offset:18432
    ds_read_b32 v30, v81 offset:23040
    ds_read_b32 v31, v81 offset:27648
    ds_read_b32 v32, v81 offset:32256
    ds_read_b32 v33, v81 offset:36864
    s_waitcnt lgkmcnt(6)
    ds_read_b32 v34, v82 offset:0
    ds_read_b32 v35, v82 offset:4608
    ds_read_b32 v36, v82 offset:9216
    ds_read_b32 v37, v82 offset:13824
    ds_read_b32 v38, v82 offset:18432
    ds_read_b32 v39, v82 offset:23040
    ds_read_b32 v40, v82 offset:27648
    ds_read_b32 v41, v82 offset:32256
    ds_read_b32 v42, v82 offset:36864
    v_lshlrev_b32 v70, 1, v0
    v_and_b32 v72, 0x7e, v70
    v_add_u32 v70, 61440, v70
    v_add_u32 v72, 63488, v72
    v_mov_b32 v73, 46976
    s_waitcnt lgkmcnt(0)
    v_add_f32 v16, v16, v17
    v_add_f32 v19, v19, v20
    v_add_f32 v22, v22, v23
    v_add_f32 v25, v25, v26
    v_add_f32 v28, v28, v29
    v_add_f32 v31, v31, v32
    v_add_f32 v34, v34, v35
    v_add_f32 v37, v37, v38
    v_add_f32 v40, v40, v41
    v_add_f32 v16, v16, v18
    v_add_f32 v19, v19, v21
    v_add_f32 v22, v22, v24
    v_add_f32 v25, v25, v27
    v_add_f32 v28, v28, v30
    v_add_f32 v31, v31, v33
    v_add_f32 v34, v34, v36
    v_add_f32 v37, v37, v39
    v_add_f32 v40, v40, v42
    v_max3_f32 v48, abs(v16), abs(v25), abs(v34)
    v_max3_f32 v49, abs(v19), abs(v28), abs(v37)
    v_max3_f32 v50, abs(v22), abs(v31), abs(v40)
    v_max_f32_dpp v48, v48, v48 row_ror:1 row_mask:0xf bank_mask:0xf
    v_max_f32_dpp v49, v49, v49 row_ror:1 row_mask:0xf bank_mask:0xf
    v_max_f32_dpp v50, v50, v50 row_ror:1 row_mask:0xf bank_mask:0xf
    v_max_f32_dpp v48, v48, v48 row_ror:2 row_mask:0xf bank_mask:0xf
    v_max_f32_dpp v49, v49, v49 row_ror:2 row_mask:0xf bank_mask:0xf
    v_max_f32_dpp v50, v50, v50 row_ror:2 row_mask:0xf bank_mask:0xf
    v_max_f32_dpp v48, v48, v48 row_ror:4 row_mask:0xf bank_mask:0xf
    v_max_f32_dpp v49, v49, v49 row_ror:4 row_mask:0xf bank_mask:0xf
    v_max_f32_dpp v50, v50, v50 row_ror:4 row_mask:0xf bank_mask:0xf
    v_max_f32_dpp v48, v48, v48 row_ror:8 row_mask:0xf bank_mask:0xf
    v_max_f32_dpp v49, v49, v49 row_ror:8 row_mask:0xf bank_mask:0xf
    v_max_f32_dpp v50, v50, v50 row_ror:8 row_mask:0xf bank_mask:0xf
    s_mov_b32 exec_lo, 0x00010001
    s_mov_b32 exec_hi, 0x00010001
    ds_max_f32 v73, v48 offset:0
    ds_max_f32 v73, v49 offset:4
    ds_max_f32 v73, v50 offset:8
    s_mov_b64 exec, -1
    s_waitcnt lgkmcnt(0)
    s_barrier
    ds_read_b128 v[52:55], v73
    v_and_b32 v74, 0xffff, v83
    v_lshrrev_b32 v75, 16, v83
    v_and_b32 v76, 0xffff, v84
    v_lshrrev_b32 v77, 16, v84
    v_add_u32 v74, 61440, v74
    v_add_u32 v76, 61440, v76
    s_waitcnt lgkmcnt(0)
    v_frexp_exp_i32_f32 v52, v52
    v_frexp_exp_i32_f32 v53, v53
    v_frexp_exp_i32_f32 v54, v54
    v_sub_u32 v48, 14, v52
    v_subrev_u32 v52, 22, v52
    v_sub_u32 v49, 14, v53
    v_subrev_u32 v53, 22, v53
    v_sub_u32 v50, 14, v54
    v_subrev_u32 v54, 22, v54
    v_ldexp_f32 v52, 1.0, v52
    v_ldexp_f32 v53, 1.0, v53
    v_ldexp_f32 v54, 1.0, v54
    v_ldexp_f32 v16, v16, v48
    v_ldexp_f32 v19, v19, v49
    v_ldexp_f32 v22, v22, v50
    v_ldexp_f32 v25, v25, v48
    v_ldexp_f32 v28, v28, v49
    v_ldexp_f32 v31, v31, v50
    v_ldexp_f32 v34, v34, v48
    v_ldexp_f32 v37, v37, v49
    v_ldexp_f32 v40, v40, v50
    v_cvt_f16_f32 v16, v16
    v_cvt_f16_f32 v19, v19
    v_cvt_f16_f32 v22, v22
    v_cvt_f16_f32 v25, v25
    v_cvt_f16_f32 v28, v28
    v_cvt_f16_f32 v31, v31
    v_cvt_f16_f32 v34, v34
    v_cvt_f16_f32 v37, v37
    v_cvt_f16_f32 v40, v40
    ds_write_b128 v73, v[52:55] offset:16
    ds_write_b16 v70, v16 offset:0
    ds_write_b16 v70, v16 offset:2306
    ds_write_b16 v70, v19 offset:4608
    ds_write_b16 v70, v19 offset:6914
    ds_write_b16 v70, v22 offset:9216
    ds_write_b16 v70, v22 offset:11522
    ds_write_b16 v70, v25 offset:1024
    ds_write_b16 v70, v25 offset:3330
    ds_write_b16 v70, v28 offset:5632
    ds_write_b16 v70, v28 offset:7938
    ds_write_b16 v70, v31 offset:10240
    ds_write_b16 v70, v31 offset:12546
    ds_write_b16 v72, v34 offset:0
    ds_write_b16 v72, v34 offset:2306
    ds_write_b16 v72, v37 offset:4608
    ds_write_b16 v72, v37 offset:6914
    ds_write_b16 v72, v40 offset:9216
    ds_write_b16 v72, v40 offset:11522
    v_add_u32 v58, 4608, v74
    v_add_u32 v59, 4608, v76
    v_add_u32 v60, 9216, v74
    v_add_u32 v61, 9216, v76
    s_waitcnt lgkmcnt(0)
    s_barrier
    ds_read2_b32 v[16:17], v74 offset0:0 offset1:1
    ds_read2_b32 v[18:19], v74 offset0:2 offset1:3
    ds_read2_b32 v[20:21], v76 offset0:0 offset1:1
    ds_read2_b32 v[22:23], v76 offset0:2 offset1:3
    ds_read2_b32 v[24:25], v58 offset0:0 offset1:1
    ds_read2_b32 v[26:27], v58 offset0:2 offset1:3
    ds_read2_b32 v[28:29], v59 offset0:0 offset1:1
    ds_read2_b32 v[30:31], v59 offset0:2 offset1:3
    ds_read2_b32 v[32:33], v60 offset0:0 offset1:1
    ds_read2_b32 v[34:35], v60 offset0:2 offset1:3
    ds_read2_b32 v[36:37], v61 offset0:0 offset1:1
    ds_read2_b32 v[38:39], v61 offset0:2 offset1:3
    s_waitcnt lgkmcnt(8)
    ds_write_b128 v75, v[16:19] offset:0
    ds_write_b128 v77, v[20:23] offset:0
    s_waitcnt lgkmcnt(4)
    ds_write_b128 v75, v[24:27] offset:15104
    ds_write_b128 v77, v[28:31] offset:15104
    s_waitcnt lgkmcnt(0)
    ds_write_b128 v75, v[32:35] offset:30208
    ds_write_b128 v77, v[36:39] offset:30208
    s_waitcnt lgkmcnt(0)
    s_barrier
L_u_nb:
    s_and_b32 s44, s3, 3
    s_lshr_b32 s45, s3, 2
    s_cmp_eq_u32 s44, 3
    s_cselect_b32 s42, s45, s44
    s_add_u32 s43, s45, 1
    s_cmp_eq_u32 s44, 3
    s_cselect_b32 s43, 3, s43
    s_cmp_eq_u32 s44, 2
    s_cbranch_scc0 L_b_role
    s_add_u32 s43, s43, s36
    s_cmp_eq_u32 s43, 2
    s_cselect_b32 s46, 1, 0
    s_andn2_b32 s46, s46, s36
    s_cmp_eq_u32 s46, 1
    s_cselect_b32 s43, 0, s43
L_b_role:
    s_cmp_eq_u32 s42, 1
    s_cselect_b32 s44, s38, s37
    s_cmp_eq_u32 s42, 2
    s_cselect_b32 s44, s39, s44
    s_mul_i32 s45, s42, 15104
    s_mul_i32 s46, s42, 14976
    s_add_u32 s46, s46, 61440
    v_and_b32 v14, 15, v1
    v_lshrrev_b32 v15, 4, v1
    v_and_b32 v16, 7, v1
    v_mul_u32_u24 v16, 100, v16
    v_bfe_u32 v17, v1, 3, 1
    v_sub_u32 v16, v16, v17
    v_add3_u32 v3, v16, v15, 1
    v_lshl_add_u32 v3, v3, 4, s45
    v_and_b32 v17, 1, v15
    v_add3_u32 v16, v16, v17, 3
    v_and_b32 v18, 2, v15
    v_sub_u32 v16, v16, v18
    v_lshl_add_u32 v2, v16, 4, s45
    v_and_b32 v16, 3, v1
    v_mul_u32_u24 v16, 36, v16
    v_lshrrev_b32 v19, 2, v14
    v_sub_u32 v16, v16, v19
    v_add3_u32 v16, v16, v15, 3
    s_add_u32 s47, s45, 12800
    v_lshl_add_u32 v4, v16, 4, s47
    v_lshlrev_b32 v16, 5, v14
    v_lshl_add_u32 v5, v17, 4, v16
    v_lshlrev_b32 v18, 4, v18
    v_sub_u32 v5, v5, v18
    s_add_u32 s47, s46, 64
    v_add_u32 v5, s47, v5
    v_and_b32 v17, 3, v1
    v_lshl_add_u32 v17, v17, 3, s46
    v_lshl_add_u32 v6, v15, 7, v17
    v_lshl_add_u32 v6, v19, 4, v6
    v_lshl_add_u32 v7, v15, 8, v17
    v_lshl_add_u32 v7, v19, 5, v7
    v_lshl_add_u32 v16, v15, 3, v16
    s_add_u32 s47, s46, 512
    v_add_u32 v8, s47, v16
    s_lshl_b32 s47, s44, 12
    s_add_u32 s47, s47, s41
    s_add_u32 s47, s47, 9437184
    v_add_u32 v9, s47, v16
    s_lshl_b32 s47, s44, 1
    v_mov_b32 v12, s47
    global_load_ushort v11, v12, s[26:27]
    s_lshl_b32 s47, s42, 2
    s_add_u32 s47, s47, 46992
    v_mov_b32 v12, s47
    ds_read_b32 v10, v12
    v_and_b32 v16, 255, v0
    v_lshlrev_b32 v17, 4, v16
    s_cmp_ge_u32 s3, 4
    s_cselect_b32 s47, s38, s37
    s_cselect_b32 s48, 14976, 0
    s_add_u32 s48, s48, 61440
    s_lshl_b32 s47, s47, 12
    s_add_u32 s49, s41, 9437184
    s_add_u32 s47, s47, s49
    v_add_u32 v20, s47, v17
    s_lshl_b32 s47, s39, 12
    s_add_u32 s47, s47, s49
    v_add_u32 v22, s47, v17
    s_mul_i32 s47, s7, 16384
    s_add_u32 s47, s47, 262144
    v_lshl_add_u32 v21, v0, 4, s47
    v_add_u32 v23, 8192, v21
    v_lshlrev_b32 v26, 2, v0
    v_add_u32 v26, 106368, v26
    v_lshlrev_b32 v27, 3, v0
    v_add_u32 v27, 110464, v27
    v_add_u32 v14, 106368, v17
    v_lshlrev_b32 v15, 5, v16
    v_add_u32 v15, 110464, v15
    v_add_u32 v24, s48, v17
    v_add_u32 v25, 91392, v17
    s_cmp_ge_u32 s3, 3
    s_cbranch_scc1 L_b_nz
    v_mov_b32 v28, 0
    v_mov_b32 v29, 0
    v_mov_b32 v30, 0
    v_mov_b32 v31, 0
    s_mul_i32 s47, s3, 14976
    s_add_u32 s47, s47, 61440
    v_and_b32 v16, 31, v1
    v_lshl_add_u32 v16, v16, 4, s47
    ds_write_b128 v16, v[28:31] offset:0
    v_bfe_u32 v16, v1, 1, 2
    v_mul_u32_u24 v17, 3104, v16
    v_cmp_eq_u32 vcc, 3, v16
    v_subrev_u32 v18, 1024, v17
    s_nop 0
    v_cndmask_b32 v17, v17, v18, vcc
    v_and_b32 v16, 1, v1
    v_lshl_add_u32 v17, v16, 4, v17
    v_add_u32 v17, s47, v17
    ds_write_b128 v17, v[28:31] offset:4608
L_b_nz:
    s_cmp_eq_u32 s3, 0
    s_cbranch_scc0 L_b_np
    s_and_b32 s47, s2, 7
    s_lshl_b32 s47, s47, 12
    s_add_u32 s47, s47, s40
    s_add_u32 s47, s47, 69632
    v_and_b32 v16, 31, v1
    v_lshl_add_u32 v16, v16, 7, s47
    s_mov_b32 s57, 0
L_poll10:
    global_load_dwordx2 v[18:19], v16, s[32:33] sc1
    s_add_u32 s57, s57, 1
    s_waitcnt vmcnt(0)
    v_cmp_ne_u64 vcc, s[34:35], v[18:19]
    s_cmp_gt_u32 s57, 200000
    s_nop 2
    s_cbranch_scc1 L_end
    s_cbranch_vccnz L_poll10
L_b_np:
    s_waitcnt vmcnt(0) lgkmcnt(0)
    v_lshlrev_b32 v11, 16, v11
    s_barrier
    global_load_dwordx4 v[48:51], v21, s[32:33] sc1
    global_load_dwordx4 v[52:55], v23, s[32:33] sc1
    global_load_dwordx4 v[40:43], v20, s[32:33] sc1
    s_cmp_ge_u32 s3, 4
    s_cbranch_scc1 L_b_l1
    global_load_dwordx4 v[44:47], v22, s[32:33] sc1
L_b_l1:
    s_max_u32 s47, s43, 1
    s_lshl_b32 s47, s47, 10
    s_cmp_gt_u32 s47, 1024
    s_cselect_b32 s47, s47, 0
    v_add_u32 v12, s47, v9
    global_load_dwordx2 v[32:33], v12, s[32:33] sc1
    global_load_dwordx2 v[34:35], v12, s[32:33] offset:512 sc1
    s_cbranch_scc1 L_b_l2
    global_load_dwordx2 v[36:37], v12, s[32:33] offset:1024 sc1
    global_load_dwordx2 v[38:39], v12, s[32:33] offset:1536 sc1
L_b_l2:
    s_waitcnt vmcnt(0)
    v_mul_f32 v48, 0x3acccccd, v48
    v_mul_f32 v49, 0x3acccccd, v49
    v_mul_f32 v50, 0x3acccccd, v50
    v_mul_f32 v51, 0x3acccccd, v51
    v_mul_f32 v52, 0x3acccccd, v52
    v_mul_f32 v53, 0x3acccccd, v53
    v_mul_f32 v54, 0x3acccccd, v54
    v_mul_f32 v55, 0x3acccccd, v55
    v_fma_f32 v49, -v48, v48, v49
    v_fma_f32 v51, -v50, v50, v51
    v_fma_f32 v53, -v52, v52, v53
    v_fma_f32 v55, -v54, v54, v55
    v_max_f32 v49, 0, v49
    v_max_f32 v51, 0, v51
    v_max_f32 v53, 0, v53
    v_max_f32 v55, 0, v55
    v_cvt_pk_bf16_f32 v56, v48, v50
    v_cvt_pk_bf16_f32 v57, v52, v54
    ds_write_b32 v26, v56
    ds_write_b32 v26, v57 offset:2048
    v_cvt_pk_bf16_f32 v58, v49, v51
    v_cvt_pk_bf16_f32 v59, v53, v55
    v_lshlrev_b32 v60, 16, v58
    v_and_b32 v61, 0xffff0000, v58
    v_lshlrev_b32 v62, 16, v59
    v_and_b32 v63, 0xffff0000, v59
    v_add_f32 v60, 0x3727c5ac, v60
    v_add_f32 v61, 0x3727c5ac, v61
    v_add_f32 v62, 0x3727c5ac, v62
    v_add_f32 v63, 0x3727c5ac, v63
    v_cvt_pk_bf16_f32 v58, v60, v61
    v_cvt_pk_bf16_f32 v59, v62, v63
    v_lshlrev_b32 v60, 16, v58
    v_and_b32 v61, 0xffff0000, v58
    v_lshlrev_b32 v62, 16, v59
    v_and_b32 v63, 0xffff0000, v59
    v_sqrt_f32 v60, v60
    v_sqrt_f32 v61, v61
    v_sqrt_f32 v62, v62
    v_sqrt_f32 v63, v63
    v_cvt_pk_bf16_f32 v58, v60, v61
    v_cvt_pk_bf16_f32 v59, v62, v63
    v_lshlrev_b32 v60, 16, v58
    v_and_b32 v61, 0xffff0000, v58
    v_lshlrev_b32 v62, 16, v59
    v_and_b32 v63, 0xffff0000, v59
    v_rcp_f32 v60, v60
    v_rcp_f32 v61, v61
    v_rcp_f32 v62, v62
    v_rcp_f32 v63, v63
    ds_write_b64 v27, v[60:61]
    ds_write_b64 v27, v[62:63] offset:4096
    s_waitcnt lgkmcnt(0)
    s_barrier
    ds_read_b128 v[76:79], v14
    ds_read_b128 v[56:59], v15
    ds_read_b128 v[60:63], v15 offset:16
    s_waitcnt lgkmcnt(2)
    v_lshlrev_b32 v48, 16, v76
    v_and_b32 v49, 0xffff0000, v76
    v_lshlrev_b32 v50, 16, v77
    v_and_b32 v51, 0xffff0000, v77
    v_lshlrev_b32 v52, 16, v78
    v_and_b32 v53, 0xffff0000, v78
    v_lshlrev_b32 v54, 16, v79
    v_and_b32 v55, 0xffff0000, v79
    v_lshlrev_b32 v64, 16, v40
    v_and_b32 v65, 0xffff0000, v40
    v_lshlrev_b32 v66, 16, v41
    v_and_b32 v67, 0xffff0000, v41
    v_lshlrev_b32 v68, 16, v42
    v_and_b32 v69, 0xffff0000, v42
    v_lshlrev_b32 v70, 16, v43
    v_and_b32 v71, 0xffff0000, v43
    v_sub_f32 v64, v64, v48
    v_sub_f32 v65, v65, v49
    v_sub_f32 v66, v66, v50
    v_sub_f32 v67, v67, v51
    v_sub_f32 v68, v68, v52
    v_sub_f32 v69, v69, v53
    v_sub_f32 v70, v70, v54
    v_sub_f32 v71, v71, v55
    v_cvt_pk_bf16_f32 v72, v64, v65
    v_cvt_pk_bf16_f32 v73, v66, v67
    v_cvt_pk_bf16_f32 v74, v68, v69
    v_cvt_pk_bf16_f32 v75, v70, v71
    v_lshlrev_b32 v64, 16, v72
    v_and_b32 v65, 0xffff0000, v72
    v_lshlrev_b32 v66, 16, v73
    v_and_b32 v67, 0xffff0000, v73
    v_lshlrev_b32 v68, 16, v74
    v_and_b32 v69, 0xffff0000, v74
    v_lshlrev_b32 v70, 16, v75
    v_and_b32 v71, 0xffff0000, v75
    s_waitcnt lgkmcnt(0)
    v_mul_f32 v64, v64, v56
    v_mul_f32 v65, v65, v57
    v_mul_f32 v66, v66, v58
    v_mul_f32 v67, v67, v59
    v_mul_f32 v68, v68, v60
    v_mul_f32 v69, v69, v61
    v_mul_f32 v70, v70, v62
    v_mul_f32 v71, v71, v63
    v_cvt_pk_bf16_f32 v72, v64, v65
    v_cvt_pk_bf16_f32 v73, v66, v67
    v_cvt_pk_bf16_f32 v74, v68, v69
    v_cvt_pk_bf16_f32 v75, v70, v71
    v_lshlrev_b32 v64, 16, v72
    v_and_b32 v65, 0xffff0000, v72
    v_lshlrev_b32 v66, 16, v73
    v_and_b32 v67, 0xffff0000, v73
    v_lshlrev_b32 v68, 16, v74
    v_and_b32 v69, 0xffff0000, v74
    v_lshlrev_b32 v70, 16, v75
    v_and_b32 v71, 0xffff0000, v75
    v_cvt_pk_f16_f32 v80, v64, v65
    v_cvt_pk_f16_f32 v81, v66, v67
    v_cvt_pk_f16_f32 v82, v68, v69
    v_cvt_pk_f16_f32 v83, v70, v71
    ds_write_b128 v24, v[80:83] offset:512
    s_cmp_ge_u32 s3, 4
    s_cbranch_scc1 L_b_u
    v_lshlrev_b32 v64, 16, v44
    v_and_b32 v65, 0xffff0000, v44
    v_lshlrev_b32 v66, 16, v45
    v_and_b32 v67, 0xffff0000, v45
    v_lshlrev_b32 v68, 16, v46
    v_and_b32 v69, 0xffff0000, v46
    v_lshlrev_b32 v70, 16, v47
    v_and_b32 v71, 0xffff0000, v47
    v_sub_f32 v64, v64, v48
    v_sub_f32 v65, v65, v49
    v_sub_f32 v66, v66, v50
    v_sub_f32 v67, v67, v51
    v_sub_f32 v68, v68, v52
    v_sub_f32 v69, v69, v53
    v_sub_f32 v70, v70, v54
    v_sub_f32 v71, v71, v55
    v_cvt_pk_bf16_f32 v72, v64, v65
    v_cvt_pk_bf16_f32 v73, v66, v67
    v_cvt_pk_bf16_f32 v74, v68, v69
    v_cvt_pk_bf16_f32 v75, v70, v71
    v_lshlrev_b32 v64, 16, v72
    v_and_b32 v65, 0xffff0000, v72
    v_lshlrev_b32 v66, 16, v73
    v_and_b32 v67, 0xffff0000, v73
    v_lshlrev_b32 v68, 16, v74
    v_and_b32 v69, 0xffff0000, v74
    v_lshlrev_b32 v70, 16, v75
    v_and_b32 v71, 0xffff0000, v75
    s_waitcnt lgkmcnt(0)
    v_mul_f32 v64, v64, v56
    v_mul_f32 v65, v65, v57
    v_mul_f32 v66, v66, v58
    v_mul_f32 v67, v67, v59
    v_mul_f32 v68, v68, v60
    v_mul_f32 v69, v69, v61
    v_mul_f32 v70, v70, v62
    v_mul_f32 v71, v71, v63
    v_cvt_pk_bf16_f32 v72, v64, v65
    v_cvt_pk_bf16_f32 v73, v66, v67
    v_cvt_pk_bf16_f32 v74, v68, v69
    v_cvt_pk_bf16_f32 v75, v70, v71
    v_lshlrev_b32 v64, 16, v72
    v_and_b32 v65, 0xffff0000, v72
    v_lshlrev_b32 v66, 16, v73
    v_and_b32 v67, 0xffff0000, v73
    v_lshlrev_b32 v68, 16, v74
    v_and_b32 v69, 0xffff0000, v74
    v_lshlrev_b32 v70, 16, v75
    v_and_b32 v71, 0xffff0000, v75
    v_cvt_pk_f16_f32 v88, v64, v65
    v_cvt_pk_f16_f32 v89, v66, v67
    v_cvt_pk_f16_f32 v90, v68, v69
    v_cvt_pk_f16_f32 v91, v70, v71
    ds_write_b128 v25, v[88:91] offset:512
L_b_u:
    s_and_b32 s50, s3, 3
    s_waitcnt lgkmcnt(0)
    s_barrier
    s_cmp_eq_u32 s50, 3
    s_cbranch_scc1 L_b_go
    ds_read_b128 v[76:79], v24 offset:496
    ds_read_b128 v[84:87], v25 offset:496
    s_waitcnt lgkmcnt(1)
    v_alignbyte_b32 v48, v77, v76, 2
    v_alignbyte_b32 v49, v78, v77, 2
    v_alignbyte_b32 v50, v79, v78, 2
    v_alignbyte_b32 v51, v80, v79, 2
    v_alignbyte_b32 v52, v81, v80, 2
    v_alignbyte_b32 v53, v82, v81, 2
    v_alignbyte_b32 v54, v83, v82, 2
    v_pk_add_f16 v72, v49, v50
    v_pk_add_f16 v60, v77, v79
    v_pk_add_f16 v73, v50, v51
    v_pk_add_f16 v61, v78, v80
    v_pk_add_f16 v74, v51, v52
    v_pk_add_f16 v62, v79, v81
    v_pk_add_f16 v75, v52, v53
    v_pk_add_f16 v63, v80, v82
    v_pk_add_f16 v56, v78, v72
    v_pk_add_f16 v57, v79, v73
    v_pk_add_f16 v58, v80, v74
    v_pk_add_f16 v59, v81, v75
    v_pk_add_f16 v60, v60, v56
    v_pk_add_f16 v61, v61, v57
    v_pk_add_f16 v62, v62, v58
    v_pk_add_f16 v63, v63, v59
    ds_write_b128 v24, v[56:59] offset:7744
    ds_write_b128 v24, v[60:63] offset:4640
    s_cmp_ge_u32 s50, 2
    s_cbranch_scc1 L_bx11
    v_pk_add_f16 v64, v48, v51
    v_pk_add_f16 v68, v76, v80
    v_pk_add_f16 v65, v49, v52
    v_pk_add_f16 v69, v77, v81
    v_pk_add_f16 v66, v50, v53
    v_pk_add_f16 v70, v78, v82
    v_pk_add_f16 v67, v51, v54
    v_pk_add_f16 v71, v79, v83
    v_pk_add_f16 v64, v64, v60
    v_pk_add_f16 v65, v65, v61
    v_pk_add_f16 v66, v66, v62
    v_pk_add_f16 v67, v67, v63
    v_pk_add_f16 v68, v68, v64
    v_pk_add_f16 v69, v69, v65
    v_pk_add_f16 v70, v70, v66
    v_pk_add_f16 v71, v71, v67
    ds_write_b128 v24, v[64:67] offset:12928
    ds_write_b128 v24, v[68:71] offset:10848
L_bx11:
    s_cmp_ge_u32 s3, 4
    s_cbranch_scc1 L_b_go
    s_waitcnt lgkmcnt(0)
    v_alignbyte_b32 v48, v85, v84, 2
    v_alignbyte_b32 v49, v86, v85, 2
    v_alignbyte_b32 v50, v87, v86, 2
    v_alignbyte_b32 v51, v88, v87, 2
    v_alignbyte_b32 v52, v89, v88, 2
    v_alignbyte_b32 v53, v90, v89, 2
    v_alignbyte_b32 v54, v91, v90, 2
    v_pk_add_f16 v72, v49, v50
    v_pk_add_f16 v60, v85, v87
    v_pk_add_f16 v73, v50, v51
    v_pk_add_f16 v61, v86, v88
    v_pk_add_f16 v74, v51, v52
    v_pk_add_f16 v62, v87, v89
    v_pk_add_f16 v75, v52, v53
    v_pk_add_f16 v63, v88, v90
    v_pk_add_f16 v56, v86, v72
    v_pk_add_f16 v57, v87, v73
    v_pk_add_f16 v58, v88, v74
    v_pk_add_f16 v59, v89, v75
    v_pk_add_f16 v60, v60, v56
    v_pk_add_f16 v61, v61, v57
    v_pk_add_f16 v62, v62, v58
    v_pk_add_f16 v63, v63, v59
    ds_write_b128 v25, v[56:59] offset:7744
    ds_write_b128 v25, v[60:63] offset:4640
    s_cmp_ge_u32 s50, 2
    s_cbranch_scc1 L_bx12
    v_pk_add_f16 v64, v48, v51
    v_pk_add_f16 v68, v84, v88
    v_pk_add_f16 v65, v49, v52
    v_pk_add_f16 v69, v85, v89
    v_pk_add_f16 v66, v50, v53
    v_pk_add_f16 v70, v86, v90
    v_pk_add_f16 v67, v51, v54
    v_pk_add_f16 v71, v87, v91
    v_pk_add_f16 v64, v64, v60
    v_pk_add_f16 v65, v65, v61
    v_pk_add_f16 v66, v66, v62
    v_pk_add_f16 v67, v67, v63
    v_pk_add_f16 v68, v68, v64
    v_pk_add_f16 v69, v69, v65
    v_pk_add_f16 v70, v70, v66
    v_pk_add_f16 v71, v71, v67
    ds_write_b128 v25, v[64:67] offset:12928
    ds_write_b128 v25, v[68:71] offset:10848
L_bx12:
L_b_go:
    s_waitcnt lgkmcnt(0)
    s_barrier
    s_cmp_eq_u32 s43, 0
    s_cbranch_scc1 L_b_done
    s_cmp_eq_u32 s43, 2
    s_cbranch_scc1 L_b_p2
    s_cmp_eq_u32 s43, 3
    s_cbranch_scc1 L_b_p3
    ds_read_b128 v[40:43], v2 offset:1088
    ds_read_b128 v[44:47], v5 offset:448
    ds_read_b128 v[48:51], v5 offset:960
    ds_read_b128 v[52:55], v5 offset:1472
    ds_read_b128 v[56:59], v5 offset:1984
    ds_read_b128 v[60:63], v2 offset:1024
    ds_read_b128 v[64:67], v5 offset:384
    ds_read_b128 v[68:71], v5 offset:896
    ds_read_b128 v[72:75], v5 offset:1408
    ds_read_b128 v[76:79], v5 offset:1920
    s_waitcnt lgkmcnt(8)
    v_mfma_f32_16x16x32_f16 v[16:19], v[40:43], v[44:47], 0
    ds_read_b128 v[80:83], v2 offset:960
    s_waitcnt lgkmcnt(8)
    v_mfma_f32_16x16x32_f16 v[20:23], v[40:43], v[48:51], 0
    ds_read_b128 v[84:87], v5 offset:320
    s_waitcnt lgkmcnt(8)
    v_mfma_f32_16x16x32_f16 v[24:27], v[40:43], v[52:55], 0
    s_waitcnt lgkmcnt(7)
    v_mfma_f32_16x16x32_f16 v[28:31], v[40:43], v[56:59], 0
    ds_read_b128 v[40:43], v5 offset:832
    ds_read_b128 v[44:47], v5 offset:1344
    ds_read_b128 v[48:51], v5 offset:1856
    s_waitcnt lgkmcnt(8)
    v_mfma_f32_16x16x32_f16 v[16:19], v[60:63], v[64:67], v[16:19]
    ds_read_b128 v[52:55], v2 offset:896
    s_waitcnt lgkmcnt(8)
    v_mfma_f32_16x16x32_f16 v[20:23], v[60:63], v[68:71], v[20:23]
    ds_read_b128 v[56:59], v5 offset:256
    s_waitcnt lgkmcnt(8)
    v_mfma_f32_16x16x32_f16 v[24:27], v[60:63], v[72:75], v[24:27]
    s_waitcnt lgkmcnt(7)
    v_mfma_f32_16x16x32_f16 v[28:31], v[60:63], v[76:79], v[28:31]
    ds_read_b128 v[60:63], v5 offset:768
    ds_read_b128 v[64:67], v5 offset:1280
    ds_read_b128 v[68:71], v5 offset:1792
    s_waitcnt lgkmcnt(8)
    v_mfma_f32_16x16x32_f16 v[16:19], v[80:83], v[84:87], v[16:19]
    ds_read_b128 v[72:75], v2 offset:832
    s_waitcnt lgkmcnt(8)
    v_mfma_f32_16x16x32_f16 v[20:23], v[80:83], v[40:43], v[20:23]
    ds_read_b128 v[76:79], v5 offset:192
    s_waitcnt lgkmcnt(8)
    v_mfma_f32_16x16x32_f16 v[24:27], v[80:83], v[44:47], v[24:27]
    s_waitcnt lgkmcnt(7)
    v_mfma_f32_16x16x32_f16 v[28:31], v[80:83], v[48:51], v[28:31]
    ds_read_b128 v[80:83], v5 offset:704
    ds_read_b128 v[84:87], v5 offset:1216
    ds_read_b128 v[40:43], v5 offset:1728
    s_waitcnt lgkmcnt(8)
    v_mfma_f32_16x16x32_f16 v[16:19], v[52:55], v[56:59], v[16:19]
    ds_read_b128 v[44:47], v2 offset:768
    s_waitcnt lgkmcnt(8)
    v_mfma_f32_16x16x32_f16 v[20:23], v[52:55], v[60:63], v[20:23]
    ds_read_b128 v[48:51], v5 offset:128
    s_waitcnt lgkmcnt(8)
    v_mfma_f32_16x16x32_f16 v[24:27], v[52:55], v[64:67], v[24:27]
    s_waitcnt lgkmcnt(7)
    v_mfma_f32_16x16x32_f16 v[28:31], v[52:55], v[68:71], v[28:31]
    ds_read_b128 v[52:55], v5 offset:640
    ds_read_b128 v[56:59], v5 offset:1152
    ds_read_b128 v[60:63], v5 offset:1664
    s_waitcnt lgkmcnt(8)
    v_mfma_f32_16x16x32_f16 v[16:19], v[72:75], v[76:79], v[16:19]
    ds_read_b128 v[64:67], v2 offset:704
    s_waitcnt lgkmcnt(8)
    v_mfma_f32_16x16x32_f16 v[20:23], v[72:75], v[80:83], v[20:23]
    ds_read_b128 v[68:71], v5 offset:64
    s_waitcnt lgkmcnt(8)
    v_mfma_f32_16x16x32_f16 v[24:27], v[72:75], v[84:87], v[24:27]
    s_waitcnt lgkmcnt(7)
    v_mfma_f32_16x16x32_f16 v[28:31], v[72:75], v[40:43], v[28:31]
    ds_read_b128 v[72:75], v5 offset:576
    ds_read_b128 v[76:79], v5 offset:1088
    ds_read_b128 v[80:83], v5 offset:1600
    s_waitcnt lgkmcnt(8)
    v_mfma_f32_16x16x32_f16 v[16:19], v[44:47], v[48:51], v[16:19]
    ds_read_b128 v[84:87], v2 offset:640
    s_waitcnt lgkmcnt(8)
    v_mfma_f32_16x16x32_f16 v[20:23], v[44:47], v[52:55], v[20:23]
    ds_read_b128 v[40:43], v5 offset:0
    s_waitcnt lgkmcnt(8)
    v_mfma_f32_16x16x32_f16 v[24:27], v[44:47], v[56:59], v[24:27]
    s_waitcnt lgkmcnt(7)
    v_mfma_f32_16x16x32_f16 v[28:31], v[44:47], v[60:63], v[28:31]
    ds_read_b128 v[44:47], v5 offset:512
    ds_read_b128 v[48:51], v5 offset:1024
    ds_read_b128 v[52:55], v5 offset:1536
    s_waitcnt lgkmcnt(8)
    v_mfma_f32_16x16x32_f16 v[16:19], v[64:67], v[68:71], v[16:19]
    ds_read_b128 v[56:59], v2 offset:576
    s_waitcnt lgkmcnt(8)
    v_mfma_f32_16x16x32_f16 v[20:23], v[64:67], v[72:75], v[20:23]
    ds_read_b128 v[60:63], v5 offset:448
    s_waitcnt lgkmcnt(8)
    v_mfma_f32_16x16x32_f16 v[24:27], v[64:67], v[76:79], v[24:27]
    s_waitcnt lgkmcnt(7)
    v_mfma_f32_16x16x32_f16 v[28:31], v[64:67], v[80:83], v[28:31]
    ds_read_b128 v[64:67], v5 offset:960
    ds_read_b128 v[68:71], v5 offset:1472
    ds_read_b128 v[72:75], v2 offset:512
    s_waitcnt lgkmcnt(8)
    v_mfma_f32_16x16x32_f16 v[16:19], v[84:87], v[40:43], v[16:19]
    ds_read_b128 v[76:79], v5 offset:384
    s_waitcnt lgkmcnt(8)
    v_mfma_f32_16x16x32_f16 v[20:23], v[84:87], v[44:47], v[20:23]
    ds_read_b128 v[80:83], v5 offset:896
    s_waitcnt lgkmcnt(8)
    v_mfma_f32_16x16x32_f16 v[24:27], v[84:87], v[48:51], v[24:27]
    s_waitcnt lgkmcnt(7)
    v_mfma_f32_16x16x32_f16 v[28:31], v[84:87], v[52:55], v[28:31]
    ds_read_b128 v[84:87], v5 offset:1408
    ds_read_b128 v[40:43], v2 offset:448
    ds_read_b128 v[44:47], v5 offset:320
    s_waitcnt lgkmcnt(8)
    v_mfma_f32_16x16x32_f16 v[20:23], v[56:59], v[60:63], v[20:23]
    ds_read_b128 v[48:51], v5 offset:832
    s_waitcnt lgkmcnt(8)
    v_mfma_f32_16x16x32_f16 v[24:27], v[56:59], v[64:67], v[24:27]
    ds_read_b128 v[52:55], v5 offset:1344
    s_waitcnt lgkmcnt(8)
    v_mfma_f32_16x16x32_f16 v[28:31], v[56:59], v[68:71], v[28:31]
    ds_read_b128 v[56:59], v2 offset:384
    ds_read_b128 v[60:63], v5 offset:256
    s_waitcnt lgkmcnt(8)
    v_mfma_f32_16x16x32_f16 v[20:23], v[72:75], v[76:79], v[20:23]
    ds_read_b128 v[64:67], v5 offset:768
    s_waitcnt lgkmcnt(8)
    v_mfma_f32_16x16x32_f16 v[24:27], v[72:75], v[80:83], v[24:27]
    ds_read_b128 v[68:71], v5 offset:1280
    s_waitcnt lgkmcnt(8)
    v_mfma_f32_16x16x32_f16 v[28:31], v[72:75], v[84:87], v[28:31]
    ds_read_b128 v[72:75], v2 offset:320
    ds_read_b128 v[76:79], v5 offset:192
    s_waitcnt lgkmcnt(8)
    v_mfma_f32_16x16x32_f16 v[20:23], v[40:43], v[44:47], v[20:23]
    ds_read_b128 v[80:83], v5 offset:704
    s_waitcnt lgkmcnt(8)
    v_mfma_f32_16x16x32_f16 v[24:27], v[40:43], v[48:51], v[24:27]
    ds_read_b128 v[84:87], v5 offset:1216
    s_waitcnt lgkmcnt(8)
    v_mfma_f32_16x16x32_f16 v[28:31], v[40:43], v[52:55], v[28:31]
    ds_read_b128 v[40:43], v2 offset:256
    ds_read_b128 v[44:47], v5 offset:128
    s_waitcnt lgkmcnt(8)
    v_mfma_f32_16x16x32_f16 v[20:23], v[56:59], v[60:63], v[20:23]
    ds_read_b128 v[48:51], v5 offset:640
    s_waitcnt lgkmcnt(8)
    v_mfma_f32_16x16x32_f16 v[24:27], v[56:59], v[64:67], v[24:27]
    ds_read_b128 v[52:55], v5 offset:1152
    s_waitcnt lgkmcnt(8)
    v_mfma_f32_16x16x32_f16 v[28:31], v[56:59], v[68:71], v[28:31]
    ds_read_b128 v[56:59], v2 offset:192
    ds_read_b128 v[60:63], v5 offset:64
    s_waitcnt lgkmcnt(8)
    v_mfma_f32_16x16x32_f16 v[20:23], v[72:75], v[76:79], v[20:23]
    ds_read_b128 v[64:67], v5 offset:576
    s_waitcnt lgkmcnt(8)
    v_mfma_f32_16x16x32_f16 v[24:27], v[72:75], v[80:83], v[24:27]
    ds_read_b128 v[68:71], v5 offset:1088
    s_waitcnt lgkmcnt(8)
    v_mfma_f32_16x16x32_f16 v[28:31], v[72:75], v[84:87], v[28:31]
    ds_read_b128 v[72:75], v2 offset:128
    ds_read_b128 v[76:79], v5 offset:0
    s_waitcnt lgkmcnt(8)
    v_mfma_f32_16x16x32_f16 v[20:23], v[40:43], v[44:47], v[20:23]
    ds_read_b128 v[80:83], v5 offset:512
    s_waitcnt lgkmcnt(8)
    v_mfma_f32_16x16x32_f16 v[24:27], v[40:43], v[48:51], v[24:27]
    ds_read_b128 v[84:87], v5 offset:1024
    s_waitcnt lgkmcnt(8)
    v_mfma_f32_16x16x32_f16 v[28:31], v[40:43], v[52:55], v[28:31]
    ds_read_b128 v[40:43], v2 offset:64
    ds_read_b128 v[44:47], v5 offset:448
    s_waitcnt lgkmcnt(8)
    v_mfma_f32_16x16x32_f16 v[20:23], v[56:59], v[60:63], v[20:23]
    ds_read_b128 v[48:51], v5 offset:960
    s_waitcnt lgkmcnt(8)
    v_mfma_f32_16x16x32_f16 v[24:27], v[56:59], v[64:67], v[24:27]
    ds_read_b128 v[52:55], v4 offset:128
    s_waitcnt lgkmcnt(8)
    v_mfma_f32_16x16x32_f16 v[28:31], v[56:59], v[68:71], v[28:31]
    ds_read_b64_tr_b16 v[56:57], v6 offset:4616
    ds_read_b64_tr_b16 v[58:59], v6 offset:4680
    ds_read_b64_tr_b16 v[60:61], v6 offset:5128
    ds_read_b64_tr_b16 v[62:63], v6 offset:5192
    s_waitcnt lgkmcnt(10)
    v_mfma_f32_16x16x32_f16 v[20:23], v[72:75], v[76:79], v[20:23]
    ds_read_b128 v[64:67], v4 offset:64
    s_waitcnt lgkmcnt(10)
    v_mfma_f32_16x16x32_f16 v[24:27], v[72:75], v[80:83], v[24:27]
    ds_read_b64_tr_b16 v[68:69], v6 offset:4616
    ds_read_b64_tr_b16 v[70:71], v6 offset:4680
    s_waitcnt lgkmcnt(11)
    v_mfma_f32_16x16x32_f16 v[28:31], v[72:75], v[84:87], v[28:31]
    ds_read_b128 v[72:75], v4 offset:368
    ds_read_b64_tr_b16 v[76:77], v6 offset:7728
    ds_read_b64_tr_b16 v[78:79], v6 offset:7792
    s_waitcnt lgkmcnt(12)
    v_mfma_f32_16x16x32_f16 v[24:27], v[40:43], v[44:47], v[24:27]
    s_waitcnt lgkmcnt(11)
    v_mfma_f32_16x16x32_f16 v[28:31], v[40:43], v[48:51], v[28:31]
    ds_read_b64_tr_b16 v[80:81], v6 offset:8240
    ds_read_b64_tr_b16 v[82:83], v6 offset:8304
    ds_read_b128 v[84:87], v4 offset:304
    s_waitcnt lgkmcnt(11)
    v_mfma_f32_16x16x32_f16 v[24:27], v[56:59], v[52:55], v[24:27]
    ds_read_b64_tr_b16 v[40:41], v6 offset:7728
    ds_read_b64_tr_b16 v[42:43], v6 offset:7792
    s_waitcnt lgkmcnt(11)
    v_mfma_f32_16x16x32_f16 v[28:31], v[60:63], v[52:55], v[28:31]
    s_waitcnt lgkmcnt(8)
    v_mfma_f32_16x16x32_f16 v[28:31], v[68:71], v[64:67], v[28:31]
    s_waitcnt lgkmcnt(5)
    v_mfma_f32_16x16x32_f16 v[24:27], v[76:79], v[72:75], v[24:27]
    s_waitcnt lgkmcnt(3)
    v_mfma_f32_16x16x32_f16 v[28:31], v[80:83], v[72:75], v[28:31]
    s_waitcnt lgkmcnt(0)
    v_mfma_f32_16x16x32_f16 v[28:31], v[40:43], v[84:87], v[28:31]
    ds_read_b64 v[88:89], v8 offset:0
    ds_read_b64 v[90:91], v8 offset:512
    ds_read_b64 v[92:93], v8 offset:1024
    ds_read_b64 v[94:95], v8 offset:1536
    v_mul_f32 v40, v16, v10
    v_mul_f32 v41, v17, v10
    v_mul_f32 v42, v18, v10
    v_mul_f32 v43, v19, v10
    v_mul_f32 v44, v20, v10
    v_mul_f32 v45, v21, v10
    v_mul_f32 v46, v22, v10
    v_mul_f32 v47, v23, v10
    v_mul_f32 v48, v24, v10
    v_mul_f32 v49, v25, v10
    v_mul_f32 v50, v26, v10
    v_mul_f32 v51, v27, v10
    v_mul_f32 v52, v28, v10
    v_mul_f32 v53, v29, v10
    v_mul_f32 v54, v30, v10
    v_mul_f32 v55, v31, v10
    v_cvt_pk_bf16_f32 v72, v40, v41
    v_cvt_pk_bf16_f32 v73, v42, v43
    v_cvt_pk_bf16_f32 v74, v44, v45
    v_cvt_pk_bf16_f32 v75, v46, v47
    v_cvt_pk_bf16_f32 v76, v48, v49
    v_cvt_pk_bf16_f32 v77, v50, v51
    v_cvt_pk_bf16_f32 v78, v52, v53
    v_cvt_pk_bf16_f32 v79, v54, v55
    v_lshlrev_b32 v40, 16, v72
    v_and_b32 v41, 0xffff0000, v72
    v_lshlrev_b32 v42, 16, v73
    v_and_b32 v43, 0xffff0000, v73
    v_lshlrev_b32 v44, 16, v74
    v_and_b32 v45, 0xffff0000, v74
    v_lshlrev_b32 v46, 16, v75
    v_and_b32 v47, 0xffff0000, v75
    v_lshlrev_b32 v48, 16, v76
    v_and_b32 v49, 0xffff0000, v76
    v_lshlrev_b32 v50, 16, v77
    v_and_b32 v51, 0xffff0000, v77
    v_lshlrev_b32 v52, 16, v78
    v_and_b32 v53, 0xffff0000, v78
    v_lshlrev_b32 v54, 16, v79
    v_and_b32 v55, 0xffff0000, v79
    s_waitcnt vmcnt(0) lgkmcnt(0)
    v_fma_mix_f32 v56, v88, v11, 0 op_sel:[0,0,0] op_sel_hi:[1,0,0]
    v_fma_mix_f32 v57, v88, v11, 0 op_sel:[1,0,0] op_sel_hi:[1,0,0]
    v_fma_mix_f32 v58, v89, v11, 0 op_sel:[0,0,0] op_sel_hi:[1,0,0]
    v_fma_mix_f32 v59, v89, v11, 0 op_sel:[1,0,0] op_sel_hi:[1,0,0]
    v_fma_mix_f32 v60, v90, v11, 0 op_sel:[0,0,0] op_sel_hi:[1,0,0]
    v_fma_mix_f32 v61, v90, v11, 0 op_sel:[1,0,0] op_sel_hi:[1,0,0]
    v_fma_mix_f32 v62, v91, v11, 0 op_sel:[0,0,0] op_sel_hi:[1,0,0]
    v_fma_mix_f32 v63, v91, v11, 0 op_sel:[1,0,0] op_sel_hi:[1,0,0]
    v_fma_mix_f32 v64, v92, v11, 0 op_sel:[0,0,0] op_sel_hi:[1,0,0]
    v_fma_mix_f32 v65, v92, v11, 0 op_sel:[1,0,0] op_sel_hi:[1,0,0]
    v_fma_mix_f32 v66, v93, v11, 0 op_sel:[0,0,0] op_sel_hi:[1,0,0]
    v_fma_mix_f32 v67, v93, v11, 0 op_sel:[1,0,0] op_sel_hi:[1,0,0]
    v_fma_mix_f32 v68, v94, v11, 0 op_sel:[0,0,0] op_sel_hi:[1,0,0]
    v_fma_mix_f32 v69, v94, v11, 0 op_sel:[1,0,0] op_sel_hi:[1,0,0]
    v_fma_mix_f32 v70, v95, v11, 0 op_sel:[0,0,0] op_sel_hi:[1,0,0]
    v_fma_mix_f32 v71, v95, v11, 0 op_sel:[1,0,0] op_sel_hi:[1,0,0]
    v_cvt_pk_bf16_f32 v72, v56, v57
    v_cvt_pk_bf16_f32 v73, v58, v59
    v_cvt_pk_bf16_f32 v74, v60, v61
    v_cvt_pk_bf16_f32 v75, v62, v63
    v_cvt_pk_bf16_f32 v76, v64, v65
    v_cvt_pk_bf16_f32 v77, v66, v67
    v_cvt_pk_bf16_f32 v78, v68, v69
    v_cvt_pk_bf16_f32 v79, v70, v71
    v_lshlrev_b32 v56, 16, v72
    v_and_b32 v57, 0xffff0000, v72
    v_lshlrev_b32 v58, 16, v73
    v_and_b32 v59, 0xffff0000, v73
    v_lshlrev_b32 v60, 16, v74
    v_and_b32 v61, 0xffff0000, v74
    v_lshlrev_b32 v62, 16, v75
    v_and_b32 v63, 0xffff0000, v75
    v_lshlrev_b32 v64, 16, v76
    v_and_b32 v65, 0xffff0000, v76
    v_lshlrev_b32 v66, 16, v77
    v_and_b32 v67, 0xffff0000, v77
    v_lshlrev_b32 v68, 16, v78
    v_and_b32 v69, 0xffff0000, v78
    v_lshlrev_b32 v70, 16, v79
    v_and_b32 v71, 0xffff0000, v79
    v_add_f32 v40, v40, v56
    v_add_f32 v41, v41, v57
    v_add_f32 v42, v42, v58
    v_add_f32 v43, v43, v59
    v_add_f32 v44, v44, v60
    v_add_f32 v45, v45, v61
    v_add_f32 v46, v46, v62
    v_add_f32 v47, v47, v63
    v_add_f32 v48, v48, v64
    v_add_f32 v49, v49, v65
    v_add_f32 v50, v50, v66
    v_add_f32 v51, v51, v67
    v_add_f32 v52, v52, v68
    v_add_f32 v53, v53, v69
    v_add_f32 v54, v54, v70
    v_add_f32 v55, v55, v71
    v_cvt_pk_bf16_f32 v72, v40, v41
    v_cvt_pk_bf16_f32 v73, v42, v43
    v_cvt_pk_bf16_f32 v74, v44, v45
    v_cvt_pk_bf16_f32 v75, v46, v47
    v_cvt_pk_bf16_f32 v76, v48, v49
    v_cvt_pk_bf16_f32 v77, v50, v51
    v_cvt_pk_bf16_f32 v78, v52, v53
    v_cvt_pk_bf16_f32 v79, v54, v55
    v_lshlrev_b32 v40, 16, v72
    v_and_b32 v41, 0xffff0000, v72
    v_lshlrev_b32 v42, 16, v73
    v_and_b32 v43, 0xffff0000, v73
    v_lshlrev_b32 v56, 16, v32
    v_and_b32 v57, 0xffff0000, v32
    v_lshlrev_b32 v58, 16, v33
    v_and_b32 v59, 0xffff0000, v33
    v_lshlrev_b32 v44, 16, v74
    v_and_b32 v45, 0xffff0000, v74
    v_lshlrev_b32 v46, 16, v75
    v_and_b32 v47, 0xffff0000, v75
    v_lshlrev_b32 v60, 16, v34
    v_and_b32 v61, 0xffff0000, v34
    v_lshlrev_b32 v62, 16, v35
    v_and_b32 v63, 0xffff0000, v35
    v_lshlrev_b32 v48, 16, v76
    v_and_b32 v49, 0xffff0000, v76
    v_lshlrev_b32 v50, 16, v77
    v_and_b32 v51, 0xffff0000, v77
    v_lshlrev_b32 v64, 16, v36
    v_and_b32 v65, 0xffff0000, v36
    v_lshlrev_b32 v66, 16, v37
    v_and_b32 v67, 0xffff0000, v37
    v_lshlrev_b32 v52, 16, v78
    v_and_b32 v53, 0xffff0000, v78
    v_lshlrev_b32 v54, 16, v79
    v_and_b32 v55, 0xffff0000, v79
    v_lshlrev_b32 v68, 16, v38
    v_and_b32 v69, 0xffff0000, v38
    v_lshlrev_b32 v70, 16, v39
    v_and_b32 v71, 0xffff0000, v39
    v_add_f32 v40, v40, v56
    v_add_f32 v41, v41, v57
    v_add_f32 v42, v42, v58
    v_add_f32 v43, v43, v59
    v_add_f32 v44, v44, v60
    v_add_f32 v45, v45, v61
    v_add_f32 v46, v46, v62
    v_add_f32 v47, v47, v63
    v_add_f32 v48, v48, v64
    v_add_f32 v49, v49, v65
    v_add_f32 v50, v50, v66
    v_add_f32 v51, v51, v67
    v_add_f32 v52, v52, v68
    v_add_f32 v53, v53, v69
    v_add_f32 v54, v54, v70
    v_add_f32 v55, v55, v71
    v_cvt_pk_bf16_f32 v72, v40, v41
    v_cvt_pk_bf16_f32 v73, v42, v43
    v_cvt_pk_bf16_f32 v74, v44, v45
    v_cvt_pk_bf16_f32 v75, v46, v47
    v_cvt_pk_bf16_f32 v76, v48, v49
    v_cvt_pk_bf16_f32 v77, v50, v51
    v_cvt_pk_bf16_f32 v78, v52, v53
    v_cvt_pk_bf16_f32 v79, v54, v55
    s_add_u32 s50, s32, 10485760
    s_addc_u32 s51, s33, 0
    global_store_dwordx2 v9, v[72:73], s[50:51] offset:0 sc1
    global_store_dwordx2 v9, v[74:75], s[50:51] offset:512 sc1
    global_store_dwordx2 v9, v[76:77], s[50:51] offset:1024 sc1
    global_store_dwordx2 v9, v[78:79], s[50:51] offset:1536 sc1
    s_branch L_b_done
L_b_p2:
    ds_read_b128 v[40:43], v2 offset:1088
    ds_read_b128 v[44:47], v5 offset:2496
    ds_read_b128 v[48:51], v5 offset:3008
    ds_read_b128 v[52:55], v2 offset:1024
    ds_read_b128 v[56:59], v5 offset:2432
    ds_read_b128 v[60:63], v5 offset:2944
    ds_read_b128 v[64:67], v2 offset:960
    ds_read_b128 v[68:71], v5 offset:2368
    ds_read_b128 v[72:75], v5 offset:2880
    ds_read_b128 v[76:79], v2 offset:896
    s_waitcnt lgkmcnt(8)
    v_mfma_f32_16x16x32_f16 v[16:19], v[40:43], v[44:47], 0
    ds_read_b128 v[80:83], v5 offset:2304
    s_waitcnt lgkmcnt(8)
    v_mfma_f32_16x16x32_f16 v[20:23], v[40:43], v[48:51], 0
    ds_read_b128 v[84:87], v5 offset:2816
    ds_read_b128 v[40:43], v2 offset:832
    s_waitcnt lgkmcnt(8)
    v_mfma_f32_16x16x32_f16 v[16:19], v[52:55], v[56:59], v[16:19]
    ds_read_b128 v[44:47], v5 offset:2240
    s_waitcnt lgkmcnt(8)
    v_mfma_f32_16x16x32_f16 v[20:23], v[52:55], v[60:63], v[20:23]
    ds_read_b128 v[48:51], v5 offset:2752
    ds_read_b128 v[52:55], v2 offset:768
    s_waitcnt lgkmcnt(8)
    v_mfma_f32_16x16x32_f16 v[16:19], v[64:67], v[68:71], v[16:19]
    ds_read_b128 v[56:59], v5 offset:2176
    s_waitcnt lgkmcnt(8)
    v_mfma_f32_16x16x32_f16 v[20:23], v[64:67], v[72:75], v[20:23]
    ds_read_b128 v[60:63], v5 offset:2688
    ds_read_b128 v[64:67], v2 offset:704
    s_waitcnt lgkmcnt(8)
    v_mfma_f32_16x16x32_f16 v[16:19], v[76:79], v[80:83], v[16:19]
    ds_read_b128 v[68:71], v5 offset:2112
    s_waitcnt lgkmcnt(8)
    v_mfma_f32_16x16x32_f16 v[20:23], v[76:79], v[84:87], v[20:23]
    ds_read_b128 v[72:75], v5 offset:2624
    ds_read_b128 v[76:79], v2 offset:640
    s_waitcnt lgkmcnt(8)
    v_mfma_f32_16x16x32_f16 v[16:19], v[40:43], v[44:47], v[16:19]
    ds_read_b128 v[80:83], v5 offset:2048
    s_waitcnt lgkmcnt(8)
    v_mfma_f32_16x16x32_f16 v[20:23], v[40:43], v[48:51], v[20:23]
    ds_read_b128 v[84:87], v5 offset:2560
    ds_read_b128 v[40:43], v2 offset:576
    s_waitcnt lgkmcnt(8)
    v_mfma_f32_16x16x32_f16 v[16:19], v[52:55], v[56:59], v[16:19]
    ds_read_b128 v[44:47], v5 offset:1984
    s_waitcnt lgkmcnt(8)
    v_mfma_f32_16x16x32_f16 v[20:23], v[52:55], v[60:63], v[20:23]
    ds_read_b128 v[48:51], v5 offset:2496
    ds_read_b128 v[52:55], v2 offset:512
    s_waitcnt lgkmcnt(8)
    v_mfma_f32_16x16x32_f16 v[16:19], v[64:67], v[68:71], v[16:19]
    ds_read_b128 v[56:59], v5 offset:1920
    s_waitcnt lgkmcnt(8)
    v_mfma_f32_16x16x32_f16 v[20:23], v[64:67], v[72:75], v[20:23]
    ds_read_b128 v[60:63], v5 offset:2432
    ds_read_b128 v[64:67], v2 offset:448
    s_waitcnt lgkmcnt(8)
    v_mfma_f32_16x16x32_f16 v[16:19], v[76:79], v[80:83], v[16:19]
    ds_read_b128 v[68:71], v5 offset:1856
    s_waitcnt lgkmcnt(8)
    v_mfma_f32_16x16x32_f16 v[20:23], v[76:79], v[84:87], v[20:23]
    ds_read_b128 v[72:75], v5 offset:2368
    ds_read_b128 v[76:79], v2 offset:384
    s_waitcnt lgkmcnt(8)
    v_mfma_f32_16x16x32_f16 v[16:19], v[40:43], v[44:47], v[16:19]
    ds_read_b128 v[80:83], v5 offset:1792
    s_waitcnt lgkmcnt(8)
    v_mfma_f32_16x16x32_f16 v[20:23], v[40:43], v[48:51], v[20:23]
    ds_read_b128 v[84:87], v5 offset:2304
    ds_read_b128 v[40:43], v2 offset:320
    s_waitcnt lgkmcnt(8)
    v_mfma_f32_16x16x32_f16 v[16:19], v[52:55], v[56:59], v[16:19]
    ds_read_b128 v[44:47], v5 offset:1728
    s_waitcnt lgkmcnt(8)
    v_mfma_f32_16x16x32_f16 v[20:23], v[52:55], v[60:63], v[20:23]
    ds_read_b128 v[48:51], v5 offset:2240
    ds_read_b128 v[52:55], v2 offset:256
    s_waitcnt lgkmcnt(8)
    v_mfma_f32_16x16x32_f16 v[16:19], v[64:67], v[68:71], v[16:19]
    ds_read_b128 v[56:59], v5 offset:1664
    s_waitcnt lgkmcnt(8)
    v_mfma_f32_16x16x32_f16 v[20:23], v[64:67], v[72:75], v[20:23]
    ds_read_b128 v[60:63], v5 offset:2176
    ds_read_b128 v[64:67], v2 offset:192
    s_waitcnt lgkmcnt(8)
    v_mfma_f32_16x16x32_f16 v[16:19], v[76:79], v[80:83], v[16:19]
    ds_read_b128 v[68:71], v5 offset:1600
    s_waitcnt lgkmcnt(8)
    v_mfma_f32_16x16x32_f16 v[20:23], v[76:79], v[84:87], v[20:23]
    ds_read_b128 v[72:75], v5 offset:2112
    ds_read_b128 v[76:79], v2 offset:128
    s_waitcnt lgkmcnt(8)
    v_mfma_f32_16x16x32_f16 v[16:19], v[40:43], v[44:47], v[16:19]
    ds_read_b128 v[80:83], v5 offset:1536
    s_waitcnt lgkmcnt(8)
    v_mfma_f32_16x16x32_f16 v[20:23], v[40:43], v[48:51], v[20:23]
    ds_read_b128 v[84:87], v5 offset:2048
    ds_read_b128 v[40:43], v2 offset:64
    s_waitcnt lgkmcnt(8)
    v_mfma_f32_16x16x32_f16 v[16:19], v[52:55], v[56:59], v[16:19]
    ds_read_b128 v[44:47], v5 offset:1472
    s_waitcnt lgkmcnt(8)
    v_mfma_f32_16x16x32_f16 v[20:23], v[52:55], v[60:63], v[20:23]
    ds_read_b128 v[48:51], v5 offset:1984
    ds_read_b128 v[52:55], v2 offset:0
    s_waitcnt lgkmcnt(8)
    v_mfma_f32_16x16x32_f16 v[16:19], v[64:67], v[68:71], v[16:19]
    ds_read_b128 v[56:59], v5 offset:448
    s_waitcnt lgkmcnt(8)
    v_mfma_f32_16x16x32_f16 v[20:23], v[64:67], v[72:75], v[20:23]
    ds_read_b128 v[60:63], v5 offset:960
    ds_read_b128 v[64:67], v4 offset:128
    s_waitcnt lgkmcnt(8)
    v_mfma_f32_16x16x32_f16 v[16:19], v[76:79], v[80:83], v[16:19]
    ds_read_b64_tr_b16 v[68:69], v6 offset:5640
    ds_read_b64_tr_b16 v[70:71], v6 offset:5704
    s_waitcnt lgkmcnt(9)
    v_mfma_f32_16x16x32_f16 v[20:23], v[76:79], v[84:87], v[20:23]
    ds_read_b64_tr_b16 v[72:73], v6 offset:6152
    ds_read_b64_tr_b16 v[74:75], v6 offset:6216
    ds_read_b128 v[76:79], v4 offset:64
    s_waitcnt lgkmcnt(10)
    v_mfma_f32_16x16x32_f16 v[16:19], v[40:43], v[44:47], v[16:19]
    ds_read_b64_tr_b16 v[80:81], v6 offset:5128
    ds_read_b64_tr_b16 v[82:83], v6 offset:5192
    s_waitcnt lgkmcnt(11)
    v_mfma_f32_16x16x32_f16 v[20:23], v[40:43], v[48:51], v[20:23]
    ds_read_b64_tr_b16 v[84:85], v6 offset:5640
    ds_read_b64_tr_b16 v[86:87], v6 offset:5704
    ds_read_b128 v[40:43], v4 offset:0
    s_waitcnt lgkmcnt(12)
    v_mfma_f32_16x16x32_f16 v[16:19], v[52:55], v[56:59], v[16:19]
    s_waitcnt lgkmcnt(11)
    v_mfma_f32_16x16x32_f16 v[20:23], v[52:55], v[60:63], v[20:23]
    ds_read_b64_tr_b16 v[44:45], v6 offset:4616
    ds_read_b64_tr_b16 v[46:47], v6 offset:4680
    ds_read_b64_tr_b16 v[48:49], v6 offset:5128
    ds_read_b64_tr_b16 v[50:51], v6 offset:5192
    s_waitcnt lgkmcnt(12)
    v_mfma_f32_16x16x32_f16 v[16:19], v[68:71], v[64:67], v[16:19]
    ds_read_b128 v[52:55], v4 offset:368
    s_waitcnt lgkmcnt(11)
    v_mfma_f32_16x16x32_f16 v[20:23], v[72:75], v[64:67], v[20:23]
    ds_read_b64_tr_b16 v[56:57], v6 offset:8752
    ds_read_b64_tr_b16 v[58:59], v6 offset:8816
    ds_read_b64_tr_b16 v[60:61], v6 offset:9264
    ds_read_b64_tr_b16 v[62:63], v6 offset:9328
    s_waitcnt lgkmcnt(12)
    v_mfma_f32_16x16x32_f16 v[16:19], v[80:83], v[76:79], v[16:19]
    ds_read_b128 v[64:67], v4 offset:304
    s_waitcnt lgkmcnt(11)
    v_mfma_f32_16x16x32_f16 v[20:23], v[84:87], v[76:79], v[20:23]
    ds_read_b64_tr_b16 v[68:69], v6 offset:8240
    ds_read_b64_tr_b16 v[70:71], v6 offset:8304
    ds_read_b64_tr_b16 v[72:73], v6 offset:8752
    ds_read_b64_tr_b16 v[74:75], v6 offset:8816
    s_waitcnt lgkmcnt(12)
    v_mfma_f32_16x16x32_f16 v[16:19], v[44:47], v[40:43], v[16:19]
    ds_read_b128 v[76:79], v4 offset:240
    s_waitcnt lgkmcnt(11)
    v_mfma_f32_16x16x32_f16 v[20:23], v[48:51], v[40:43], v[20:23]
    ds_read_b64_tr_b16 v[80:81], v6 offset:7728
    ds_read_b64_tr_b16 v[82:83], v6 offset:7792
    ds_read_b64_tr_b16 v[84:85], v6 offset:8240
    ds_read_b64_tr_b16 v[86:87], v6 offset:8304
    s_waitcnt lgkmcnt(12)
    v_mfma_f32_16x16x32_f16 v[16:19], v[56:59], v[52:55], v[16:19]
    ds_read_b128 v[40:43], v3 offset:1264
    s_waitcnt lgkmcnt(11)
    v_mfma_f32_16x16x32_f16 v[20:23], v[60:63], v[52:55], v[20:23]
    ds_read_b64_tr_b16 v[44:45], v7 offset:10824
    ds_read_b64_tr_b16 v[46:47], v7 offset:10952
    ds_read_b128 v[48:51], v3 offset:1232
    s_waitcnt lgkmcnt(11)
    v_mfma_f32_16x16x32_f16 v[16:19], v[68:71], v[64:67], v[16:19]
    ds_read_b64_tr_b16 v[52:53], v7 offset:10824
    ds_read_b64_tr_b16 v[54:55], v7 offset:10952
    ds_read_b128 v[56:59], v3 offset:1440
    s_waitcnt lgkmcnt(12)
    v_mfma_f32_16x16x32_f16 v[20:23], v[72:75], v[64:67], v[20:23]
    ds_read_b64_tr_b16 v[60:61], v7 offset:12920
    ds_read_b64_tr_b16 v[62:63], v7 offset:13048
    ds_read_b128 v[64:67], v3 offset:1408
    s_waitcnt lgkmcnt(12)
    v_mfma_f32_16x16x32_f16 v[16:19], v[80:83], v[76:79], v[16:19]
    ds_read_b64_tr_b16 v[68:69], v7 offset:12920
    ds_read_b64_tr_b16 v[70:71], v7 offset:13048
    s_waitcnt lgkmcnt(12)
    v_mfma_f32_16x16x32_f16 v[20:23], v[84:87], v[76:79], v[20:23]
    s_waitcnt lgkmcnt(9)
    v_mfma_f32_16x16x32_f16 v[16:19], v[44:47], v[40:43], v[16:19]
    s_waitcnt lgkmcnt(6)
    v_mfma_f32_16x16x32_f16 v[20:23], v[52:55], v[48:51], v[20:23]
    s_waitcnt lgkmcnt(3)
    v_mfma_f32_16x16x32_f16 v[16:19], v[60:63], v[56:59], v[16:19]
    s_waitcnt lgkmcnt(0)
    v_mfma_f32_16x16x32_f16 v[20:23], v[68:71], v[64:67], v[20:23]
    ds_read_b64 v[88:89], v8 offset:2048
    ds_read_b64 v[90:91], v8 offset:2560
    s_nop 3
    v_mul_f32 v40, v16, v10
    v_mul_f32 v41, v17, v10
    v_mul_f32 v42, v18, v10
    v_mul_f32 v43, v19, v10
    v_mul_f32 v44, v20, v10
    v_mul_f32 v45, v21, v10
    v_mul_f32 v46, v22, v10
    v_mul_f32 v47, v23, v10
    v_cvt_pk_bf16_f32 v72, v40, v41
    v_cvt_pk_bf16_f32 v73, v42, v43
    v_cvt_pk_bf16_f32 v74, v44, v45
    v_cvt_pk_bf16_f32 v75, v46, v47
    v_lshlrev_b32 v40, 16, v72
    v_and_b32 v41, 0xffff0000, v72
    v_lshlrev_b32 v42, 16, v73
    v_and_b32 v43, 0xffff0000, v73
    v_lshlrev_b32 v44, 16, v74
    v_and_b32 v45, 0xffff0000, v74
    v_lshlrev_b32 v46, 16, v75
    v_and_b32 v47, 0xffff0000, v75
    s_waitcnt vmcnt(0) lgkmcnt(0)
    v_fma_mix_f32 v56, v88, v11, 0 op_sel:[0,0,0] op_sel_hi:[1,0,0]
    v_fma_mix_f32 v57, v88, v11, 0 op_sel:[1,0,0] op_sel_hi:[1,0,0]
    v_fma_mix_f32 v58, v89, v11, 0 op_sel:[0,0,0] op_sel_hi:[1,0,0]
    v_fma_mix_f32 v59, v89, v11, 0 op_sel:[1,0,0] op_sel_hi:[1,0,0]
    v_fma_mix_f32 v60, v90, v11, 0 op_sel:[0,0,0] op_sel_hi:[1,0,0]
    v_fma_mix_f32 v61, v90, v11, 0 op_sel:[1,0,0] op_sel_hi:[1,0,0]
    v_fma_mix_f32 v62, v91, v11, 0 op_sel:[0,0,0] op_sel_hi:[1,0,0]
    v_fma_mix_f32 v63, v91, v11, 0 op_sel:[1,0,0] op_sel_hi:[1,0,0]
    v_cvt_pk_bf16_f32 v72, v56, v57
    v_cvt_pk_bf16_f32 v73, v58, v59
    v_cvt_pk_bf16_f32 v74, v60, v61
    v_cvt_pk_bf16_f32 v75, v62, v63
    v_lshlrev_b32 v56, 16, v72
    v_and_b32 v57, 0xffff0000, v72
    v_lshlrev_b32 v58, 16, v73
    v_and_b32 v59, 0xffff0000, v73
    v_lshlrev_b32 v60, 16, v74
    v_and_b32 v61, 0xffff0000, v74
    v_lshlrev_b32 v62, 16, v75
    v_and_b32 v63, 0xffff0000, v75
    v_add_f32 v40, v40, v56
    v_add_f32 v41, v41, v57
    v_add_f32 v42, v42, v58
    v_add_f32 v43, v43, v59
    v_add_f32 v44, v44, v60
    v_add_f32 v45, v45, v61
    v_add_f32 v46, v46, v62
    v_add_f32 v47, v47, v63
    v_cvt_pk_bf16_f32 v72, v40, v41
    v_cvt_pk_bf16_f32 v73, v42, v43
    v_cvt_pk_bf16_f32 v74, v44, v45
    v_cvt_pk_bf16_f32 v75, v46, v47
    v_lshlrev_b32 v40, 16, v72
    v_and_b32 v41, 0xffff0000, v72
    v_lshlrev_b32 v42, 16, v73
    v_and_b32 v43, 0xffff0000, v73
    v_lshlrev_b32 v56, 16, v32
    v_and_b32 v57, 0xffff0000, v32
    v_lshlrev_b32 v58, 16, v33
    v_and_b32 v59, 0xffff0000, v33
    v_lshlrev_b32 v44, 16, v74
    v_and_b32 v45, 0xffff0000, v74
    v_lshlrev_b32 v46, 16, v75
    v_and_b32 v47, 0xffff0000, v75
    v_lshlrev_b32 v60, 16, v34
    v_and_b32 v61, 0xffff0000, v34
    v_lshlrev_b32 v62, 16, v35
    v_and_b32 v63, 0xffff0000, v35
    v_add_f32 v40, v40, v56
    v_add_f32 v41, v41, v57
    v_add_f32 v42, v42, v58
    v_add_f32 v43, v43, v59
    v_add_f32 v44, v44, v60
    v_add_f32 v45, v45, v61
    v_add_f32 v46, v46, v62
    v_add_f32 v47, v47, v63
    v_cvt_pk_bf16_f32 v72, v40, v41
    v_cvt_pk_bf16_f32 v73, v42, v43
    v_cvt_pk_bf16_f32 v74, v44, v45
    v_cvt_pk_bf16_f32 v75, v46, v47
    s_add_u32 s50, s32, 10485760
    s_addc_u32 s51, s33, 0
    global_store_dwordx2 v9, v[72:73], s[50:51] offset:2048 sc1
    global_store_dwordx2 v9, v[74:75], s[50:51] offset:2560 sc1
    s_branch L_b_done
L_b_p3:
    ds_read_b128 v[40:43], v2 offset:1088
    ds_read_b128 v[44:47], v5 offset:3520
    ds_read_b128 v[48:51], v5 offset:4032
    ds_read_b128 v[52:55], v2 offset:1024
    ds_read_b128 v[56:59], v5 offset:3456
    ds_read_b128 v[60:63], v5 offset:3968
    ds_read_b128 v[64:67], v2 offset:960
    ds_read_b128 v[68:71], v5 offset:3392
    ds_read_b128 v[72:75], v5 offset:3904
    ds_read_b128 v[76:79], v2 offset:896
    s_waitcnt lgkmcnt(8)
    v_mfma_f32_16x16x32_f16 v[16:19], v[40:43], v[44:47], 0
    ds_read_b128 v[80:83], v5 offset:3328
    s_waitcnt lgkmcnt(8)
    v_mfma_f32_16x16x32_f16 v[20:23], v[40:43], v[48:51], 0
    ds_read_b128 v[84:87], v5 offset:3840
    ds_read_b128 v[40:43], v2 offset:832
    s_waitcnt lgkmcnt(8)
    v_mfma_f32_16x16x32_f16 v[16:19], v[52:55], v[56:59], v[16:19]
    ds_read_b128 v[44:47], v5 offset:3264
    s_waitcnt lgkmcnt(8)
    v_mfma_f32_16x16x32_f16 v[20:23], v[52:55], v[60:63], v[20:23]
    ds_read_b128 v[48:51], v5 offset:3776
    ds_read_b128 v[52:55], v2 offset:768
    s_waitcnt lgkmcnt(8)
    v_mfma_f32_16x16x32_f16 v[16:19], v[64:67], v[68:71], v[16:19]
    ds_read_b128 v[56:59], v5 offset:3200
    s_waitcnt lgkmcnt(8)
    v_mfma_f32_16x16x32_f16 v[20:23], v[64:67], v[72:75], v[20:23]
    ds_read_b128 v[60:63], v5 offset:3712
    ds_read_b128 v[64:67], v2 offset:704
    s_waitcnt lgkmcnt(8)
    v_mfma_f32_16x16x32_f16 v[16:19], v[76:79], v[80:83], v[16:19]
    ds_read_b128 v[68:71], v5 offset:3136
    s_waitcnt lgkmcnt(8)
    v_mfma_f32_16x16x32_f16 v[20:23], v[76:79], v[84:87], v[20:23]
    ds_read_b128 v[72:75], v5 offset:3648
    ds_read_b128 v[76:79], v2 offset:640
    s_waitcnt lgkmcnt(8)
    v_mfma_f32_16x16x32_f16 v[16:19], v[40:43], v[44:47], v[16:19]
    ds_read_b128 v[80:83], v5 offset:3072
    s_waitcnt lgkmcnt(8)
    v_mfma_f32_16x16x32_f16 v[20:23], v[40:43], v[48:51], v[20:23]
    ds_read_b128 v[84:87], v5 offset:3584
    ds_read_b128 v[40:43], v2 offset:576
    s_waitcnt lgkmcnt(8)
    v_mfma_f32_16x16x32_f16 v[16:19], v[52:55], v[56:59], v[16:19]
    ds_read_b128 v[44:47], v5 offset:3008
    s_waitcnt lgkmcnt(8)
    v_mfma_f32_16x16x32_f16 v[20:23], v[52:55], v[60:63], v[20:23]
    ds_read_b128 v[48:51], v5 offset:3520
    ds_read_b128 v[52:55], v2 offset:512
    s_waitcnt lgkmcnt(8)
    v_mfma_f32_16x16x32_f16 v[16:19], v[64:67], v[68:71], v[16:19]
    ds_read_b128 v[56:59], v5 offset:2944
    s_waitcnt lgkmcnt(8)
    v_mfma_f32_16x16x32_f16 v[20:23], v[64:67], v[72:75], v[20:23]
    ds_read_b128 v[60:63], v5 offset:3456
    ds_read_b128 v[64:67], v2 offset:448
    s_waitcnt lgkmcnt(8)
    v_mfma_f32_16x16x32_f16 v[16:19], v[76:79], v[80:83], v[16:19]
    ds_read_b128 v[68:71], v5 offset:2880
    s_waitcnt lgkmcnt(8)
    v_mfma_f32_16x16x32_f16 v[20:23], v[76:79], v[84:87], v[20:23]
    ds_read_b128 v[72:75], v5 offset:3392
    ds_read_b128 v[76:79], v2 offset:384
    s_waitcnt lgkmcnt(8)
    v_mfma_f32_16x16x32_f16 v[16:19], v[40:43], v[44:47], v[16:19]
    ds_read_b128 v[80:83], v5 offset:2816
    s_waitcnt lgkmcnt(8)
    v_mfma_f32_16x16x32_f16 v[20:23], v[40:43], v[48:51], v[20:23]
    ds_read_b128 v[84:87], v5 offset:3328
    ds_read_b128 v[40:43], v2 offset:320
    s_waitcnt lgkmcnt(8)
    v_mfma_f32_16x16x32_f16 v[16:19], v[52:55], v[56:59], v[16:19]
    ds_read_b128 v[44:47], v5 offset:2752
    s_waitcnt lgkmcnt(8)
    v_mfma_f32_16x16x32_f16 v[20:23], v[52:55], v[60:63], v[20:23]
    ds_read_b128 v[48:51], v5 offset:3264
    ds_read_b128 v[52:55], v2 offset:256
    s_waitcnt lgkmcnt(8)
    v_mfma_f32_16x16x32_f16 v[16:19], v[64:67], v[68:71], v[16:19]
    ds_read_b128 v[56:59], v5 offset:2688
    s_waitcnt lgkmcnt(8)
    v_mfma_f32_16x16x32_f16 v[20:23], v[64:67], v[72:75], v[20:23]
    ds_read_b128 v[60:63], v5 offset:3200
    ds_read_b128 v[64:67], v2 offset:192
    s_waitcnt lgkmcnt(8)
    v_mfma_f32_16x16x32_f16 v[16:19], v[76:79], v[80:83], v[16:19]
    ds_read_b128 v[68:71], v5 offset:2624
    s_waitcnt lgkmcnt(8)
    v_mfma_f32_16x16x32_f16 v[20:23], v[76:79], v[84:87], v[20:23]
    ds_read_b128 v[72:75], v5 offset:3136
    ds_read_b128 v[76:79], v2 offset:128
    s_waitcnt lgkmcnt(8)
    v_mfma_f32_16x16x32_f16 v[16:19], v[40:43], v[44:47], v[16:19]
    ds_read_b128 v[80:83], v5 offset:2560
    s_waitcnt lgkmcnt(8)
    v_mfma_f32_16x16x32_f16 v[20:23], v[40:43], v[48:51], v[20:23]
    ds_read_b128 v[84:87], v5 offset:3072
    ds_read_b128 v[40:43], v2 offset:64
    s_waitcnt lgkmcnt(8)
    v_mfma_f32_16x16x32_f16 v[16:19], v[52:55], v[56:59], v[16:19]
    ds_read_b128 v[44:47], v5 offset:2496
    s_waitcnt lgkmcnt(8)
    v_mfma_f32_16x16x32_f16 v[20:23], v[52:55], v[60:63], v[20:23]
    ds_read_b128 v[48:51], v5 offset:3008
    ds_read_b128 v[52:55], v2 offset:0
    s_waitcnt lgkmcnt(8)
    v_mfma_f32_16x16x32_f16 v[16:19], v[64:67], v[68:71], v[16:19]
    ds_read_b128 v[56:59], v5 offset:1472
    s_waitcnt lgkmcnt(8)
    v_mfma_f32_16x16x32_f16 v[20:23], v[64:67], v[72:75], v[20:23]
    ds_read_b128 v[60:63], v5 offset:1984
    ds_read_b128 v[64:67], v4 offset:128
    s_waitcnt lgkmcnt(8)
    v_mfma_f32_16x16x32_f16 v[16:19], v[76:79], v[80:83], v[16:19]
    ds_read_b64_tr_b16 v[68:69], v6 offset:6664
    ds_read_b64_tr_b16 v[70:71], v6 offset:6728
    s_waitcnt lgkmcnt(9)
    v_mfma_f32_16x16x32_f16 v[20:23], v[76:79], v[84:87], v[20:23]
    ds_read_b64_tr_b16 v[72:73], v6 offset:7176
    ds_read_b64_tr_b16 v[74:75], v6 offset:7240
    ds_read_b128 v[76:79], v4 offset:64
    s_waitcnt lgkmcnt(10)
    v_mfma_f32_16x16x32_f16 v[16:19], v[40:43], v[44:47], v[16:19]
    ds_read_b64_tr_b16 v[80:81], v6 offset:6152
    ds_read_b64_tr_b16 v[82:83], v6 offset:6216
    s_waitcnt lgkmcnt(11)
    v_mfma_f32_16x16x32_f16 v[20:23], v[40:43], v[48:51], v[20:23]
    ds_read_b64_tr_b16 v[84:85], v6 offset:6664
    ds_read_b64_tr_b16 v[86:87], v6 offset:6728
    ds_read_b128 v[40:43], v4 offset:0
    s_waitcnt lgkmcnt(12)
    v_mfma_f32_16x16x32_f16 v[16:19], v[52:55], v[56:59], v[16:19]
    s_waitcnt lgkmcnt(11)
    v_mfma_f32_16x16x32_f16 v[20:23], v[52:55], v[60:63], v[20:23]
    ds_read_b64_tr_b16 v[44:45], v6 offset:5640
    ds_read_b64_tr_b16 v[46:47], v6 offset:5704
    ds_read_b64_tr_b16 v[48:49], v6 offset:6152
    ds_read_b64_tr_b16 v[50:51], v6 offset:6216
    s_waitcnt lgkmcnt(12)
    v_mfma_f32_16x16x32_f16 v[16:19], v[68:71], v[64:67], v[16:19]
    ds_read_b128 v[52:55], v4 offset:368
    s_waitcnt lgkmcnt(11)
    v_mfma_f32_16x16x32_f16 v[20:23], v[72:75], v[64:67], v[20:23]
    ds_read_b64_tr_b16 v[56:57], v6 offset:9776
    ds_read_b64_tr_b16 v[58:59], v6 offset:9840
    ds_read_b64_tr_b16 v[60:61], v6 offset:10288
    ds_read_b64_tr_b16 v[62:63], v6 offset:10352
    s_waitcnt lgkmcnt(12)
    v_mfma_f32_16x16x32_f16 v[16:19], v[80:83], v[76:79], v[16:19]
    ds_read_b128 v[64:67], v4 offset:304
    s_waitcnt lgkmcnt(11)
    v_mfma_f32_16x16x32_f16 v[20:23], v[84:87], v[76:79], v[20:23]
    ds_read_b64_tr_b16 v[68:69], v6 offset:9264
    ds_read_b64_tr_b16 v[70:71], v6 offset:9328
    ds_read_b64_tr_b16 v[72:73], v6 offset:9776
    ds_read_b64_tr_b16 v[74:75], v6 offset:9840
    s_waitcnt lgkmcnt(12)
    v_mfma_f32_16x16x32_f16 v[16:19], v[44:47], v[40:43], v[16:19]
    ds_read_b128 v[76:79], v4 offset:240
    s_waitcnt lgkmcnt(11)
    v_mfma_f32_16x16x32_f16 v[20:23], v[48:51], v[40:43], v[20:23]
    ds_read_b64_tr_b16 v[80:81], v6 offset:8752
    ds_read_b64_tr_b16 v[82:83], v6 offset:8816
    ds_read_b64_tr_b16 v[84:85], v6 offset:9264
    ds_read_b64_tr_b16 v[86:87], v6 offset:9328
    s_waitcnt lgkmcnt(12)
    v_mfma_f32_16x16x32_f16 v[16:19], v[56:59], v[52:55], v[16:19]
    ds_read_b128 v[40:43], v3 offset:1264
    s_waitcnt lgkmcnt(11)
    v_mfma_f32_16x16x32_f16 v[20:23], v[60:63], v[52:55], v[20:23]
    ds_read_b64_tr_b16 v[44:45], v7 offset:11848
    ds_read_b64_tr_b16 v[46:47], v7 offset:11976
    ds_read_b128 v[48:51], v3 offset:1232
    s_waitcnt lgkmcnt(11)
    v_mfma_f32_16x16x32_f16 v[16:19], v[68:71], v[64:67], v[16:19]
    ds_read_b64_tr_b16 v[52:53], v7 offset:11848
    ds_read_b64_tr_b16 v[54:55], v7 offset:11976
    ds_read_b128 v[56:59], v3 offset:1200
    s_waitcnt lgkmcnt(12)
    v_mfma_f32_16x16x32_f16 v[20:23], v[72:75], v[64:67], v[20:23]
    ds_read_b64_tr_b16 v[60:61], v7 offset:10824
    ds_read_b64_tr_b16 v[62:63], v7 offset:10952
    ds_read_b128 v[64:67], v3 offset:1168
    s_waitcnt lgkmcnt(12)
    v_mfma_f32_16x16x32_f16 v[16:19], v[80:83], v[76:79], v[16:19]
    ds_read_b64_tr_b16 v[68:69], v7 offset:10824
    ds_read_b64_tr_b16 v[70:71], v7 offset:10952
    s_waitcnt lgkmcnt(12)
    v_mfma_f32_16x16x32_f16 v[20:23], v[84:87], v[76:79], v[20:23]
    ds_read_b128 v[72:75], v3 offset:1440
    ds_read_b64_tr_b16 v[76:77], v7 offset:13944
    ds_read_b64_tr_b16 v[78:79], v7 offset:14072
    s_waitcnt lgkmcnt(12)
    v_mfma_f32_16x16x32_f16 v[16:19], v[44:47], v[40:43], v[16:19]
    ds_read_b128 v[80:83], v3 offset:1408
    ds_read_b64_tr_b16 v[84:85], v7 offset:13944
    ds_read_b64_tr_b16 v[86:87], v7 offset:14072
    s_waitcnt lgkmcnt(12)
    v_mfma_f32_16x16x32_f16 v[20:23], v[52:55], v[48:51], v[20:23]
    ds_read_b128 v[40:43], v3 offset:1376
    ds_read_b64_tr_b16 v[44:45], v7 offset:12920
    ds_read_b64_tr_b16 v[46:47], v7 offset:13048
    s_waitcnt lgkmcnt(12)
    v_mfma_f32_16x16x32_f16 v[16:19], v[60:63], v[56:59], v[16:19]
    ds_read_b128 v[48:51], v3 offset:1344
    ds_read_b64_tr_b16 v[52:53], v7 offset:12920
    ds_read_b64_tr_b16 v[54:55], v7 offset:13048
    s_waitcnt lgkmcnt(12)
    v_mfma_f32_16x16x32_f16 v[20:23], v[68:71], v[64:67], v[20:23]
    s_waitcnt lgkmcnt(9)
    v_mfma_f32_16x16x32_f16 v[16:19], v[76:79], v[72:75], v[16:19]
    s_waitcnt lgkmcnt(6)
    v_mfma_f32_16x16x32_f16 v[20:23], v[84:87], v[80:83], v[20:23]
    s_waitcnt lgkmcnt(3)
    v_mfma_f32_16x16x32_f16 v[16:19], v[44:47], v[40:43], v[16:19]
    s_waitcnt lgkmcnt(0)
    v_mfma_f32_16x16x32_f16 v[20:23], v[52:55], v[48:51], v[20:23]
    ds_read_b64 v[88:89], v8 offset:3072
    ds_read_b64 v[90:91], v8 offset:3584
    s_nop 3
    v_mul_f32 v40, v16, v10
    v_mul_f32 v41, v17, v10
    v_mul_f32 v42, v18, v10
    v_mul_f32 v43, v19, v10
    v_mul_f32 v44, v20, v10
    v_mul_f32 v45, v21, v10
    v_mul_f32 v46, v22, v10
    v_mul_f32 v47, v23, v10
    v_cvt_pk_bf16_f32 v72, v40, v41
    v_cvt_pk_bf16_f32 v73, v42, v43
    v_cvt_pk_bf16_f32 v74, v44, v45
    v_cvt_pk_bf16_f32 v75, v46, v47
    v_lshlrev_b32 v40, 16, v72
    v_and_b32 v41, 0xffff0000, v72
    v_lshlrev_b32 v42, 16, v73
    v_and_b32 v43, 0xffff0000, v73
    v_lshlrev_b32 v44, 16, v74
    v_and_b32 v45, 0xffff0000, v74
    v_lshlrev_b32 v46, 16, v75
    v_and_b32 v47, 0xffff0000, v75
    s_waitcnt vmcnt(0) lgkmcnt(0)
    v_fma_mix_f32 v56, v88, v11, 0 op_sel:[0,0,0] op_sel_hi:[1,0,0]
    v_fma_mix_f32 v57, v88, v11, 0 op_sel:[1,0,0] op_sel_hi:[1,0,0]
    v_fma_mix_f32 v58, v89, v11, 0 op_sel:[0,0,0] op_sel_hi:[1,0,0]
    v_fma_mix_f32 v59, v89, v11, 0 op_sel:[1,0,0] op_sel_hi:[1,0,0]
    v_fma_mix_f32 v60, v90, v11, 0 op_sel:[0,0,0] op_sel_hi:[1,0,0]
    v_fma_mix_f32 v61, v90, v11, 0 op_sel:[1,0,0] op_sel_hi:[1,0,0]
    v_fma_mix_f32 v62, v91, v11, 0 op_sel:[0,0,0] op_sel_hi:[1,0,0]
    v_fma_mix_f32 v63, v91, v11, 0 op_sel:[1,0,0] op_sel_hi:[1,0,0]
    v_cvt_pk_bf16_f32 v72, v56, v57
    v_cvt_pk_bf16_f32 v73, v58, v59
    v_cvt_pk_bf16_f32 v74, v60, v61
    v_cvt_pk_bf16_f32 v75, v62, v63
    v_lshlrev_b32 v56, 16, v72
    v_and_b32 v57, 0xffff0000, v72
    v_lshlrev_b32 v58, 16, v73
    v_and_b32 v59, 0xffff0000, v73
    v_lshlrev_b32 v60, 16, v74
    v_and_b32 v61, 0xffff0000, v74
    v_lshlrev_b32 v62, 16, v75
    v_and_b32 v63, 0xffff0000, v75
    v_add_f32 v40, v40, v56
    v_add_f32 v41, v41, v57
    v_add_f32 v42, v42, v58
    v_add_f32 v43, v43, v59
    v_add_f32 v44, v44, v60
    v_add_f32 v45, v45, v61
    v_add_f32 v46, v46, v62
    v_add_f32 v47, v47, v63
    v_cvt_pk_bf16_f32 v72, v40, v41
    v_cvt_pk_bf16_f32 v73, v42, v43
    v_cvt_pk_bf16_f32 v74, v44, v45
    v_cvt_pk_bf16_f32 v75, v46, v47
    v_lshlrev_b32 v40, 16, v72
    v_and_b32 v41, 0xffff0000, v72
    v_lshlrev_b32 v42, 16, v73
    v_and_b32 v43, 0xffff0000, v73
    v_lshlrev_b32 v56, 16, v32
    v_and_b32 v57, 0xffff0000, v32
    v_lshlrev_b32 v58, 16, v33
    v_and_b32 v59, 0xffff0000, v33
    v_lshlrev_b32 v44, 16, v74
    v_and_b32 v45, 0xffff0000, v74
    v_lshlrev_b32 v46, 16, v75
    v_and_b32 v47, 0xffff0000, v75
    v_lshlrev_b32 v60, 16, v34
    v_and_b32 v61, 0xffff0000, v34
    v_lshlrev_b32 v62, 16, v35
    v_and_b32 v63, 0xffff0000, v35
    v_add_f32 v40, v40, v56
    v_add_f32 v41, v41, v57
    v_add_f32 v42, v42, v58
    v_add_f32 v43, v43, v59
    v_add_f32 v44, v44, v60
    v_add_f32 v45, v45, v61
    v_add_f32 v46, v46, v62
    v_add_f32 v47, v47, v63
    v_cvt_pk_bf16_f32 v72, v40, v41
    v_cvt_pk_bf16_f32 v73, v42, v43
    v_cvt_pk_bf16_f32 v74, v44, v45
    v_cvt_pk_bf16_f32 v75, v46, v47
    s_add_u32 s50, s32, 10485760
    s_addc_u32 s51, s33, 0
    global_store_dwordx2 v9, v[72:73], s[50:51] offset:3072 sc1
    global_store_dwordx2 v9, v[74:75], s[50:51] offset:3584 sc1
    s_branch L_b_done
L_b_done:
    s_waitcnt vmcnt(0)
    s_barrier
    s_cmp_eq_u32 s3, 0
    s_cbranch_scc0 L_x_np
    s_lshl_b32 s42, s14, 7
    s_add_u32 s42, s42, s40
    s_add_u32 s42, s42, 102400
    v_lshl_add_u32 v2, v1, 4, s42
    v_mov_b32 v4, s34
    v_mov_b32 v5, s35
    v_mov_b32 v6, s34
    v_mov_b32 v7, s35
    s_mov_b64 exec, 0xff
    global_store_dwordx4 v2, v[4:7], s[32:33] sc1
    s_mov_b64 exec, -1
L_x_np:
    s_cmp_eq_u32 s7, 1
    s_cbranch_scc1 L_final
    s_mov_b32 s7, 1
    s_mov_b32 s40, 98304
    s_mov_b32 s41, 2621440
    v_and_b32 v16, 15, v1
    v_lshrrev_b32 v17, 4, v1
    v_lshrrev_b32 v18, 2, v16
    v_and_b32 v19, 3, v1
    s_and_b32 s42, s3, 3
    s_lshr_b32 s43, s3, 2
    s_mul_i32 s43, s43, 48
    s_mul_i32 s44, s4, 80
    s_add_u32 s43, s43, s44
    v_mov_b32 v10, 0x3f803f80
    v_mov_b32 v11, 0x3f803f80
    v_mov_b32 v12, 0x3f803f80
    v_mov_b32 v13, 0x3f803f80
    v_lshl_add_u32 v20, v17, 2, v18
    v_mul_u32_u24 v20, 160, v20
    v_add_u32 v20, 61440, v20
    v_lshl_add_u32 v2, v19, 3, v20
    v_add_u32 v3, 61440, v2
    s_lshl_b32 s44, s42, 5
    s_add_u32 s44, s44, 61472
    v_lshl_add_u32 v20, v17, 3, s44
    s_lshl_b32 s44, s6, 5
    v_add_u32 v21, 0, v16
    v_add_u32 v21, s43, v21
    v_min_u32 v21, 639, v21
    v_xor_b32 v21, s44, v21
    v_and_b32 v22, 0x3e3, v21
    v_bfe_u32 v23, v21, 3, 2
    v_lshl_or_b32 v22, v23, 2, v22
    v_and_b32 v22, 0x3ef, v22
    v_bfe_u32 v23, v21, 2, 1
    v_lshl_or_b32 v22, v23, 4, v22
    v_mul_u32_u24 v22, 160, v22
    v_add_u32 v7, v22, v20
    v_add_u32 v21, 16, v16
    v_add_u32 v21, s43, v21
    v_min_u32 v21, 639, v21
    v_xor_b32 v21, s44, v21
    v_and_b32 v22, 0x3e3, v21
    v_bfe_u32 v23, v21, 3, 2
    v_lshl_or_b32 v22, v23, 2, v22
    v_and_b32 v22, 0x3ef, v22
    v_bfe_u32 v23, v21, 2, 1
    v_lshl_or_b32 v22, v23, 4, v22
    v_mul_u32_u24 v22, 160, v22
    v_add_u32 v8, v22, v20
    v_add_u32 v21, 32, v16
    v_add_u32 v21, s43, v21
    v_min_u32 v21, 639, v21
    v_xor_b32 v21, s44, v21
    v_and_b32 v22, 0x3e3, v21
    v_bfe_u32 v23, v21, 3, 2
    v_lshl_or_b32 v22, v23, 2, v22
    v_and_b32 v22, 0x3ef, v22
    v_bfe_u32 v23, v21, 2, 1
    v_lshl_or_b32 v22, v23, 4, v22
    v_mul_u32_u24 v22, 160, v22
    v_add_u32 v9, v22, v20
    s_lshl_b32 s44, s6, 5
    s_mov_b32 s45, 52429
    v_add_u32 v4, 0, v0
    v_mul_u32_u24 v24, s45, v4
    v_lshrrev_b32 v24, 19, v24
    v_mul_u32_u24 v25, 10, v24
    v_sub_u32 v4, v4, v25
    v_xor_b32 v24, s44, v24
    v_and_b32 v25, 0xe3, v24
    v_bfe_u32 v26, v24, 2, 2
    v_lshl_or_b32 v25, v26, 3, v25
    v_bfe_u32 v26, v24, 4, 1
    v_lshl_or_b32 v25, v26, 2, v25
    v_lshlrev_b32 v25, 12, v25
    v_lshl_add_u32 v4, v4, 4, v25
    v_add_u32 v5, 512, v0
    v_mul_u32_u24 v24, s45, v5
    v_lshrrev_b32 v24, 19, v24
    v_mul_u32_u24 v25, 10, v24
    v_sub_u32 v5, v5, v25
    v_xor_b32 v24, s44, v24
    v_and_b32 v25, 0xe3, v24
    v_bfe_u32 v26, v24, 2, 2
    v_lshl_or_b32 v25, v26, 3, v25
    v_bfe_u32 v26, v24, 4, 1
    v_lshl_or_b32 v25, v26, 2, v25
    v_lshlrev_b32 v25, 12, v25
    v_lshl_add_u32 v5, v5, 4, v25
    v_add_u32 v6, 1024, v0
    v_mul_u32_u24 v24, s45, v6
    v_lshrrev_b32 v24, 19, v24
    v_mul_u32_u24 v25, 10, v24
    v_sub_u32 v6, v6, v25
    v_xor_b32 v24, s44, v24
    v_and_b32 v25, 0xe3, v24
    v_bfe_u32 v26, v24, 2, 2
    v_lshl_or_b32 v25, v26, 3, v25
    v_bfe_u32 v26, v24, 4, 1
    v_lshl_or_b32 v25, v26, 2, v25
    v_lshlrev_b32 v25, 12, v25
    v_lshl_add_u32 v6, v6, 4, v25
    v_add_u32 v14, 1536, v0
    v_mul_u32_u24 v24, s45, v14
    v_lshrrev_b32 v24, 19, v24
    v_mul_u32_u24 v25, 10, v24
    v_sub_u32 v14, v14, v25
    v_xor_b32 v24, s44, v24
    v_and_b32 v25, 0xe3, v24
    v_bfe_u32 v26, v24, 2, 2
    v_lshl_or_b32 v25, v26, 3, v25
    v_bfe_u32 v26, v24, 4, 1
    v_lshl_or_b32 v25, v26, 2, v25
    v_lshlrev_b32 v25, 12, v25
    v_lshl_add_u32 v14, v14, 4, v25
    v_add_u32 v15, 2048, v0
    v_mul_u32_u24 v24, s45, v15
    v_lshrrev_b32 v24, 19, v24
    v_mul_u32_u24 v25, 10, v24
    v_sub_u32 v15, v15, v25
    v_xor_b32 v24, s44, v24
    v_and_b32 v25, 0xe3, v24
    v_bfe_u32 v26, v24, 2, 2
    v_lshl_or_b32 v25, v26, 3, v25
    v_bfe_u32 v26, v24, 4, 1
    v_lshl_or_b32 v25, v26, 2, v25
    v_lshlrev_b32 v25, 12, v25
    v_lshl_add_u32 v15, v15, 4, v25
    s_lshl_b32 s42, s5, 7
    s_add_u32 s42, s42, 19922912
    s_lshl_b32 s52, s3, 10
    s_add_u32 s50, s32, s42
    s_addc_u32 s51, s33, 0
    s_cmp_eq_u32 s3, 0
    s_cbranch_scc0 L_x_go
    v_lshlrev_b32 v32, 7, v1
    v_add_u32 v32, 102400, v32
    v_add_u32 v33, 8192, v32
    v_add_u32 v34, 16384, v32
    v_add_u32 v35, 24576, v32
    s_mov_b32 s57, 0
L_poll13:
    global_load_dwordx2 v[36:37], v32, s[32:33] sc1
    global_load_dwordx2 v[38:39], v33, s[32:33] sc1
    global_load_dwordx2 v[40:41], v34, s[32:33] sc1
    global_load_dwordx2 v[42:43], v35, s[32:33] sc1
    s_add_u32 s57, s57, 1
    s_waitcnt vmcnt(0)
    v_cmp_ne_u64 vcc, s[34:35], v[36:37]
    v_cmp_ne_u64 s[54:55], s[34:35], v[38:39]
    s_nop 1
    s_or_b64 vcc, vcc, s[54:55]
    v_cmp_ne_u64 s[54:55], s[34:35], v[40:41]
    s_nop 1
    s_or_b64 vcc, vcc, s[54:55]
    v_cmp_ne_u64 s[54:55], s[34:35], v[42:43]
    s_nop 1
    s_or_b64 vcc, vcc, s[54:55]
    s_cmp_gt_u32 s57, 200000
    s_cbranch_scc1 L_end
    s_cbranch_vccnz L_poll13
L_x_go:
    s_barrier
    s_add_u32 m0, s52, 61440
    s_nop 0
    global_load_lds_dwordx4 v4, s[50:51] sc1
    s_add_u32 m0, s52, 69632
    s_nop 0
    global_load_lds_dwordx4 v5, s[50:51] sc1
    s_add_u32 m0, s52, 77824
    s_nop 0
    global_load_lds_dwordx4 v6, s[50:51] sc1
    s_add_u32 m0, s52, 86016
    s_nop 0
    global_load_lds_dwordx4 v14, s[50:51] sc1
    s_cmp_eq_u32 s3, 0
    s_cbranch_scc1 L_g2A
    s_cmp_eq_u32 s3, 1
    s_cbranch_scc1 L_g2B
    s_cmp_eq_u32 s3, 3
    s_cbranch_scc1 L_g2D
    s_cmp_eq_u32 s3, 7
    s_cbranch_scc1 L_g2E
    s_waitcnt vmcnt(2)
    s_barrier
    ds_read_b64_tr_b16 v[16:17], v2 offset:0
    ds_read_b64_tr_b16 v[18:19], v2 offset:2560
    ds_read_b64_tr_b16 v[20:21], v2 offset:32
    ds_read_b64_tr_b16 v[22:23], v2 offset:2592
    ds_read_b64_tr_b16 v[24:25], v2 offset:64
    ds_read_b64_tr_b16 v[26:27], v2 offset:2624
    ds_read_b64_tr_b16 v[28:29], v2 offset:96
    ds_read_b64_tr_b16 v[30:31], v2 offset:2656
    ds_read_b64_tr_b16 v[32:33], v2 offset:128
    ds_read_b64_tr_b16 v[34:35], v2 offset:2688
    ds_read_b64_tr_b16 v[36:37], v2 offset:5120
    ds_read_b64_tr_b16 v[38:39], v2 offset:7680
    ds_read_b64_tr_b16 v[40:41], v2 offset:5152
    ds_read_b64_tr_b16 v[42:43], v2 offset:7712
    ds_read_b64_tr_b16 v[44:45], v2 offset:5184
    ds_read_b64_tr_b16 v[46:47], v2 offset:7744
    s_waitcnt lgkmcnt(14)
    v_mfma_f32_16x16x32_bf16 v[48:51], v[96:99], v[16:19], 0
    v_mfma_f32_16x16x32_bf16 v[52:55], v[176:179], v[16:19], 0
    s_add_u32 m0, s52, 94208
    s_nop 0
    global_load_lds_dwordx4 v15, s[50:51] sc1
    ds_read_b64_tr_b16 v[16:17], v2 offset:5216
    ds_read_b64_tr_b16 v[18:19], v2 offset:7776
    s_waitcnt lgkmcnt(14)
    v_mfma_f32_16x16x32_bf16 v[56:59], v[96:99], v[20:23], 0
    v_mfma_f32_16x16x32_bf16 v[60:63], v[176:179], v[20:23], 0
    ds_read_b64_tr_b16 v[20:21], v2 offset:5248
    ds_read_b64_tr_b16 v[22:23], v2 offset:7808
    s_waitcnt lgkmcnt(14)
    v_mfma_f32_16x16x32_bf16 v[64:67], v[96:99], v[24:27], 0
    v_mfma_f32_16x16x32_bf16 v[68:71], v[176:179], v[24:27], 0
    ds_read_b64_tr_b16 v[24:25], v2 offset:10240
    ds_read_b64_tr_b16 v[26:27], v2 offset:12800
    s_waitcnt lgkmcnt(14)
    v_mfma_f32_16x16x32_bf16 v[72:75], v[96:99], v[28:31], 0
    v_mfma_f32_16x16x32_bf16 v[76:79], v[176:179], v[28:31], 0
    ds_read_b64_tr_b16 v[28:29], v2 offset:10272
    ds_read_b64_tr_b16 v[30:31], v2 offset:12832
    s_waitcnt lgkmcnt(14)
    v_mfma_f32_16x16x32_bf16 v[80:83], v[96:99], v[32:35], 0
    v_mfma_f32_16x16x32_bf16 v[84:87], v[176:179], v[32:35], 0
    ds_read_b64_tr_b16 v[32:33], v2 offset:10304
    ds_read_b64_tr_b16 v[34:35], v2 offset:12864
    s_waitcnt lgkmcnt(14)
    v_mfma_f32_16x16x32_bf16 v[48:51], v[100:103], v[36:39], v[48:51]
    v_mfma_f32_16x16x32_bf16 v[52:55], v[180:183], v[36:39], v[52:55]
    s_add_u32 m0, s52, 102400
    s_add_u32 s50, s50, 1048576
    s_addc_u32 s51, s51, 0
    global_load_lds_dwordx4 v4, s[50:51] sc1
    ds_read_b64_tr_b16 v[36:37], v2 offset:10336
    ds_read_b64_tr_b16 v[38:39], v2 offset:12896
    s_waitcnt lgkmcnt(14)
    v_mfma_f32_16x16x32_bf16 v[56:59], v[100:103], v[40:43], v[56:59]
    v_mfma_f32_16x16x32_bf16 v[60:63], v[180:183], v[40:43], v[60:63]
    ds_read_b64_tr_b16 v[40:41], v2 offset:10368
    ds_read_b64_tr_b16 v[42:43], v2 offset:12928
    s_waitcnt lgkmcnt(14)
    v_mfma_f32_16x16x32_bf16 v[64:67], v[100:103], v[44:47], v[64:67]
    v_mfma_f32_16x16x32_bf16 v[68:71], v[180:183], v[44:47], v[68:71]
    s_waitcnt vmcnt(2)
    s_barrier
    ds_read_b64_tr_b16 v[44:45], v2 offset:15360
    ds_read_b64_tr_b16 v[46:47], v2 offset:17920
    s_waitcnt lgkmcnt(14)
    v_mfma_f32_16x16x32_bf16 v[72:75], v[100:103], v[16:19], v[72:75]
    v_mfma_f32_16x16x32_bf16 v[76:79], v[180:183], v[16:19], v[76:79]
    ds_read_b64_tr_b16 v[16:17], v2 offset:15392
    ds_read_b64_tr_b16 v[18:19], v2 offset:17952
    s_waitcnt lgkmcnt(14)
    v_mfma_f32_16x16x32_bf16 v[80:83], v[100:103], v[20:23], v[80:83]
    v_mfma_f32_16x16x32_bf16 v[84:87], v[180:183], v[20:23], v[84:87]
    ds_read_b64_tr_b16 v[20:21], v2 offset:15424
    ds_read_b64_tr_b16 v[22:23], v2 offset:17984
    s_waitcnt lgkmcnt(14)
    v_mfma_f32_16x16x32_bf16 v[48:51], v[104:107], v[24:27], v[48:51]
    v_mfma_f32_16x16x32_bf16 v[52:55], v[184:187], v[24:27], v[52:55]
    s_add_u32 m0, s52, 110592
    s_nop 0
    global_load_lds_dwordx4 v5, s[50:51] sc1
    ds_read_b64_tr_b16 v[24:25], v2 offset:15456
    ds_read_b64_tr_b16 v[26:27], v2 offset:18016
    s_waitcnt lgkmcnt(14)
    v_mfma_f32_16x16x32_bf16 v[56:59], v[104:107], v[28:31], v[56:59]
    v_mfma_f32_16x16x32_bf16 v[60:63], v[184:187], v[28:31], v[60:63]
    ds_read_b64_tr_b16 v[28:29], v2 offset:15488
    ds_read_b64_tr_b16 v[30:31], v2 offset:18048
    s_waitcnt lgkmcnt(14)
    v_mfma_f32_16x16x32_bf16 v[64:67], v[104:107], v[32:35], v[64:67]
    v_mfma_f32_16x16x32_bf16 v[68:71], v[184:187], v[32:35], v[68:71]
    ds_read_b64_tr_b16 v[32:33], v2 offset:20480
    ds_read_b64_tr_b16 v[34:35], v2 offset:23040
    s_waitcnt lgkmcnt(14)
    v_mfma_f32_16x16x32_bf16 v[72:75], v[104:107], v[36:39], v[72:75]
    v_mfma_f32_16x16x32_bf16 v[76:79], v[184:187], v[36:39], v[76:79]
    ds_read_b64_tr_b16 v[36:37], v2 offset:20512
    ds_read_b64_tr_b16 v[38:39], v2 offset:23072
    s_waitcnt lgkmcnt(14)
    v_mfma_f32_16x16x32_bf16 v[80:83], v[104:107], v[40:43], v[80:83]
    v_mfma_f32_16x16x32_bf16 v[84:87], v[184:187], v[40:43], v[84:87]
    ds_read_b64_tr_b16 v[40:41], v2 offset:20544
    ds_read_b64_tr_b16 v[42:43], v2 offset:23104
    s_waitcnt lgkmcnt(14)
    v_mfma_f32_16x16x32_bf16 v[48:51], v[108:111], v[44:47], v[48:51]
    v_mfma_f32_16x16x32_bf16 v[52:55], v[188:191], v[44:47], v[52:55]
    s_add_u32 m0, s52, 118784
    s_nop 0
    global_load_lds_dwordx4 v6, s[50:51] sc1
    ds_read_b64_tr_b16 v[44:45], v2 offset:20576
    ds_read_b64_tr_b16 v[46:47], v2 offset:23136
    s_waitcnt lgkmcnt(14)
    v_mfma_f32_16x16x32_bf16 v[56:59], v[108:111], v[16:19], v[56:59]
    v_mfma_f32_16x16x32_bf16 v[60:63], v[188:191], v[16:19], v[60:63]
    ds_read_b64_tr_b16 v[16:17], v2 offset:20608
    ds_read_b64_tr_b16 v[18:19], v2 offset:23168
    s_waitcnt lgkmcnt(14)
    v_mfma_f32_16x16x32_bf16 v[64:67], v[108:111], v[20:23], v[64:67]
    v_mfma_f32_16x16x32_bf16 v[68:71], v[188:191], v[20:23], v[68:71]
    ds_read_b64_tr_b16 v[20:21], v2 offset:25600
    ds_read_b64_tr_b16 v[22:23], v2 offset:28160
    s_waitcnt lgkmcnt(14)
    v_mfma_f32_16x16x32_bf16 v[72:75], v[108:111], v[24:27], v[72:75]
    v_mfma_f32_16x16x32_bf16 v[76:79], v[188:191], v[24:27], v[76:79]
    ds_read_b64_tr_b16 v[24:25], v2 offset:25632
    ds_read_b64_tr_b16 v[26:27], v2 offset:28192
    s_waitcnt lgkmcnt(14)
    v_mfma_f32_16x16x32_bf16 v[80:83], v[108:111], v[28:31], v[80:83]
    v_mfma_f32_16x16x32_bf16 v[84:87], v[188:191], v[28:31], v[84:87]
    ds_read_b64_tr_b16 v[28:29], v2 offset:25664
    ds_read_b64_tr_b16 v[30:31], v2 offset:28224
    s_waitcnt lgkmcnt(14)
    v_mfma_f32_16x16x32_bf16 v[48:51], v[112:115], v[32:35], v[48:51]
    v_mfma_f32_16x16x32_bf16 v[52:55], v[192:195], v[32:35], v[52:55]
    s_add_u32 m0, s52, 126976
    s_nop 0
    global_load_lds_dwordx4 v14, s[50:51] sc1
    ds_read_b64_tr_b16 v[32:33], v2 offset:25696
    ds_read_b64_tr_b16 v[34:35], v2 offset:28256
    s_waitcnt lgkmcnt(14)
    v_mfma_f32_16x16x32_bf16 v[56:59], v[112:115], v[36:39], v[56:59]
    v_mfma_f32_16x16x32_bf16 v[60:63], v[192:195], v[36:39], v[60:63]
    ds_read_b64_tr_b16 v[36:37], v2 offset:25728
    ds_read_b64_tr_b16 v[38:39], v2 offset:28288
    s_waitcnt lgkmcnt(14)
    v_mfma_f32_16x16x32_bf16 v[64:67], v[112:115], v[40:43], v[64:67]
    v_mfma_f32_16x16x32_bf16 v[68:71], v[192:195], v[40:43], v[68:71]
    s_waitcnt vmcnt(2)
    s_barrier
    ds_read_b64_tr_b16 v[40:41], v2 offset:30720
    ds_read_b64_tr_b16 v[42:43], v2 offset:33280
    s_waitcnt lgkmcnt(14)
    v_mfma_f32_16x16x32_bf16 v[72:75], v[112:115], v[44:47], v[72:75]
    v_mfma_f32_16x16x32_bf16 v[76:79], v[192:195], v[44:47], v[76:79]
    ds_read_b64_tr_b16 v[44:45], v2 offset:30752
    ds_read_b64_tr_b16 v[46:47], v2 offset:33312
    s_waitcnt lgkmcnt(14)
    v_mfma_f32_16x16x32_bf16 v[80:83], v[112:115], v[16:19], v[80:83]
    v_mfma_f32_16x16x32_bf16 v[84:87], v[192:195], v[16:19], v[84:87]
    ds_read_b64_tr_b16 v[16:17], v2 offset:30784
    ds_read_b64_tr_b16 v[18:19], v2 offset:33344
    s_waitcnt lgkmcnt(14)
    v_mfma_f32_16x16x32_bf16 v[48:51], v[116:119], v[20:23], v[48:51]
    v_mfma_f32_16x16x32_bf16 v[52:55], v[196:199], v[20:23], v[52:55]
    s_add_u32 m0, s52, 135168
    s_nop 0
    global_load_lds_dwordx4 v15, s[50:51] sc1
    ds_read_b64_tr_b16 v[20:21], v2 offset:30816
    ds_read_b64_tr_b16 v[22:23], v2 offset:33376
    s_waitcnt lgkmcnt(14)
    v_mfma_f32_16x16x32_bf16 v[56:59], v[116:119], v[24:27], v[56:59]
    v_mfma_f32_16x16x32_bf16 v[60:63], v[196:199], v[24:27], v[60:63]
    ds_read_b64_tr_b16 v[24:25], v2 offset:30848
    ds_read_b64_tr_b16 v[26:27], v2 offset:33408
    s_waitcnt lgkmcnt(14)
    v_mfma_f32_16x16x32_bf16 v[64:67], v[116:119], v[28:31], v[64:67]
    v_mfma_f32_16x16x32_bf16 v[68:71], v[196:199], v[28:31], v[68:71]
    ds_read_b64_tr_b16 v[28:29], v2 offset:35840
    ds_read_b64_tr_b16 v[30:31], v2 offset:38400
    s_waitcnt lgkmcnt(14)
    v_mfma_f32_16x16x32_bf16 v[72:75], v[116:119], v[32:35], v[72:75]
    v_mfma_f32_16x16x32_bf16 v[76:79], v[196:199], v[32:35], v[76:79]
    ds_read_b64_tr_b16 v[32:33], v2 offset:35872
    ds_read_b64_tr_b16 v[34:35], v2 offset:38432
    s_waitcnt lgkmcnt(14)
    v_mfma_f32_16x16x32_bf16 v[80:83], v[116:119], v[36:39], v[80:83]
    v_mfma_f32_16x16x32_bf16 v[84:87], v[196:199], v[36:39], v[84:87]
    ds_read_b64_tr_b16 v[36:37], v2 offset:35904
    ds_read_b64_tr_b16 v[38:39], v2 offset:38464
    s_waitcnt lgkmcnt(14)
    v_mfma_f32_16x16x32_bf16 v[48:51], v[120:123], v[40:43], v[48:51]
    v_mfma_f32_16x16x32_bf16 v[52:55], v[200:203], v[40:43], v[52:55]
    s_add_u32 m0, s52, 143360
    s_add_u32 s50, s50, 1048576
    s_addc_u32 s51, s51, 0
    global_load_lds_dwordx4 v4, s[50:51] sc1
    ds_read_b64_tr_b16 v[40:41], v2 offset:35936
    ds_read_b64_tr_b16 v[42:43], v2 offset:38496
    s_waitcnt lgkmcnt(14)
    v_mfma_f32_16x16x32_bf16 v[56:59], v[120:123], v[44:47], v[56:59]
    v_mfma_f32_16x16x32_bf16 v[60:63], v[200:203], v[44:47], v[60:63]
    ds_read_b64_tr_b16 v[44:45], v2 offset:35968
    ds_read_b64_tr_b16 v[46:47], v2 offset:38528
    s_waitcnt lgkmcnt(14)
    v_mfma_f32_16x16x32_bf16 v[64:67], v[120:123], v[16:19], v[64:67]
    v_mfma_f32_16x16x32_bf16 v[68:71], v[200:203], v[16:19], v[68:71]
    ds_read_b64_tr_b16 v[16:17], v2 offset:40960
    ds_read_b64_tr_b16 v[18:19], v2 offset:43520
    s_waitcnt lgkmcnt(14)
    v_mfma_f32_16x16x32_bf16 v[72:75], v[120:123], v[20:23], v[72:75]
    v_mfma_f32_16x16x32_bf16 v[76:79], v[200:203], v[20:23], v[76:79]
    ds_read_b64_tr_b16 v[20:21], v2 offset:40992
    ds_read_b64_tr_b16 v[22:23], v2 offset:43552
    s_waitcnt lgkmcnt(14)
    v_mfma_f32_16x16x32_bf16 v[80:83], v[120:123], v[24:27], v[80:83]
    v_mfma_f32_16x16x32_bf16 v[84:87], v[200:203], v[24:27], v[84:87]
    ds_read_b64_tr_b16 v[24:25], v2 offset:41024
    ds_read_b64_tr_b16 v[26:27], v2 offset:43584
    s_waitcnt lgkmcnt(14)
    v_mfma_f32_16x16x32_bf16 v[48:51], v[124:127], v[28:31], v[48:51]
    v_mfma_f32_16x16x32_bf16 v[52:55], v[204:207], v[28:31], v[52:55]
    s_add_u32 m0, s52, 151552
    s_nop 0
    global_load_lds_dwordx4 v5, s[50:51] sc1
    ds_read_b64_tr_b16 v[28:29], v2 offset:41056
    ds_read_b64_tr_b16 v[30:31], v2 offset:43616
    s_waitcnt lgkmcnt(14)
    v_mfma_f32_16x16x32_bf16 v[56:59], v[124:127], v[32:35], v[56:59]
    v_mfma_f32_16x16x32_bf16 v[60:63], v[204:207], v[32:35], v[60:63]
    ds_read_b64_tr_b16 v[32:33], v2 offset:41088
    ds_read_b64_tr_b16 v[34:35], v2 offset:43648
    s_waitcnt lgkmcnt(14)
    v_mfma_f32_16x16x32_bf16 v[64:67], v[124:127], v[36:39], v[64:67]
    v_mfma_f32_16x16x32_bf16 v[68:71], v[204:207], v[36:39], v[68:71]
    ds_read_b64_tr_b16 v[36:37], v2 offset:46080
    ds_read_b64_tr_b16 v[38:39], v2 offset:48640
    s_waitcnt lgkmcnt(14)
    v_mfma_f32_16x16x32_bf16 v[72:75], v[124:127], v[40:43], v[72:75]
    v_mfma_f32_16x16x32_bf16 v[76:79], v[204:207], v[40:43], v[76:79]
    ds_read_b64_tr_b16 v[40:41], v2 offset:46112
    ds_read_b64_tr_b16 v[42:43], v2 offset:48672
    s_waitcnt lgkmcnt(14)
    v_mfma_f32_16x16x32_bf16 v[80:83], v[124:127], v[44:47], v[80:83]
    v_mfma_f32_16x16x32_bf16 v[84:87], v[204:207], v[44:47], v[84:87]
    ds_read_b64_tr_b16 v[44:45], v2 offset:46144
    ds_read_b64_tr_b16 v[46:47], v2 offset:48704
    s_waitcnt lgkmcnt(14)
    v_mfma_f32_16x16x32_bf16 v[48:51], v[128:131], v[16:19], v[48:51]
    v_mfma_f32_16x16x32_bf16 v[52:55], v[208:211], v[16:19], v[52:55]
    s_cmp_ge_u32 s3, 4
    s_nop 5
    s_cbranch_scc1 L_r1214
    s_add_u32 m0, s52, 159744
    s_nop 0
    global_load_lds_dwordx4 v6, s[50:51] sc1
L_r1214:
    ds_read_b64_tr_b16 v[16:17], v2 offset:46176
    ds_read_b64_tr_b16 v[18:19], v2 offset:48736
    s_waitcnt lgkmcnt(14)
    v_mfma_f32_16x16x32_bf16 v[56:59], v[128:131], v[20:23], v[56:59]
    v_mfma_f32_16x16x32_bf16 v[60:63], v[208:211], v[20:23], v[60:63]
    ds_read_b64_tr_b16 v[20:21], v2 offset:46208
    ds_read_b64_tr_b16 v[22:23], v2 offset:48768
    s_waitcnt lgkmcnt(14)
    v_mfma_f32_16x16x32_bf16 v[64:67], v[128:131], v[24:27], v[64:67]
    v_mfma_f32_16x16x32_bf16 v[68:71], v[208:211], v[24:27], v[68:71]
    ds_read_b64_tr_b16 v[24:25], v2 offset:51200
    ds_read_b64_tr_b16 v[26:27], v2 offset:53760
    s_waitcnt lgkmcnt(14)
    v_mfma_f32_16x16x32_bf16 v[72:75], v[128:131], v[28:31], v[72:75]
    v_mfma_f32_16x16x32_bf16 v[76:79], v[208:211], v[28:31], v[76:79]
    ds_read_b64_tr_b16 v[28:29], v2 offset:51232
    ds_read_b64_tr_b16 v[30:31], v2 offset:53792
    s_waitcnt lgkmcnt(14)
    v_mfma_f32_16x16x32_bf16 v[80:83], v[128:131], v[32:35], v[80:83]
    v_mfma_f32_16x16x32_bf16 v[84:87], v[208:211], v[32:35], v[84:87]
    ds_read_b64_tr_b16 v[32:33], v2 offset:51264
    ds_read_b64_tr_b16 v[34:35], v2 offset:53824
    s_waitcnt lgkmcnt(14)
    v_mfma_f32_16x16x32_bf16 v[48:51], v[132:135], v[36:39], v[48:51]
    v_mfma_f32_16x16x32_bf16 v[52:55], v[212:215], v[36:39], v[52:55]
    ds_read_b64_tr_b16 v[36:37], v2 offset:51296
    ds_read_b64_tr_b16 v[38:39], v2 offset:53856
    s_waitcnt lgkmcnt(14)
    v_mfma_f32_16x16x32_bf16 v[56:59], v[132:135], v[40:43], v[56:59]
    v_mfma_f32_16x16x32_bf16 v[60:63], v[212:215], v[40:43], v[60:63]
    ds_read_b64_tr_b16 v[40:41], v2 offset:51328
    ds_read_b64_tr_b16 v[42:43], v2 offset:53888
    s_waitcnt lgkmcnt(14)
    v_mfma_f32_16x16x32_bf16 v[64:67], v[132:135], v[44:47], v[64:67]
    v_mfma_f32_16x16x32_bf16 v[68:71], v[212:215], v[44:47], v[68:71]
    s_waitcnt vmcnt(2)
    s_barrier
    ds_read_b64_tr_b16 v[44:45], v2 offset:56320
    ds_read_b64_tr_b16 v[46:47], v2 offset:58880
    s_waitcnt lgkmcnt(14)
    v_mfma_f32_16x16x32_bf16 v[72:75], v[132:135], v[16:19], v[72:75]
    v_mfma_f32_16x16x32_bf16 v[76:79], v[212:215], v[16:19], v[76:79]
    ds_read_b64_tr_b16 v[16:17], v2 offset:56352
    ds_read_b64_tr_b16 v[18:19], v2 offset:58912
    s_waitcnt lgkmcnt(14)
    v_mfma_f32_16x16x32_bf16 v[80:83], v[132:135], v[20:23], v[80:83]
    v_mfma_f32_16x16x32_bf16 v[84:87], v[212:215], v[20:23], v[84:87]
    ds_read_b64_tr_b16 v[20:21], v2 offset:56384
    ds_read_b64_tr_b16 v[22:23], v2 offset:58944
    s_waitcnt lgkmcnt(14)
    v_mfma_f32_16x16x32_bf16 v[48:51], v[136:139], v[24:27], v[48:51]
    v_mfma_f32_16x16x32_bf16 v[52:55], v[216:219], v[24:27], v[52:55]
    ds_read_b64_tr_b16 v[24:25], v2 offset:56416
    ds_read_b64_tr_b16 v[26:27], v2 offset:58976
    s_waitcnt lgkmcnt(14)
    v_mfma_f32_16x16x32_bf16 v[56:59], v[136:139], v[28:31], v[56:59]
    v_mfma_f32_16x16x32_bf16 v[60:63], v[216:219], v[28:31], v[60:63]
    ds_read_b64_tr_b16 v[28:29], v2 offset:56448
    ds_read_b64_tr_b16 v[30:31], v2 offset:59008
    s_waitcnt lgkmcnt(14)
    v_mfma_f32_16x16x32_bf16 v[64:67], v[136:139], v[32:35], v[64:67]
    v_mfma_f32_16x16x32_bf16 v[68:71], v[216:219], v[32:35], v[68:71]
    ds_read_b64_tr_b16 v[32:33], v3 offset:0
    ds_read_b64_tr_b16 v[34:35], v3 offset:2560
    s_waitcnt lgkmcnt(14)
    v_mfma_f32_16x16x32_bf16 v[72:75], v[136:139], v[36:39], v[72:75]
    v_mfma_f32_16x16x32_bf16 v[76:79], v[216:219], v[36:39], v[76:79]
    ds_read_b64_tr_b16 v[36:37], v3 offset:32
    ds_read_b64_tr_b16 v[38:39], v3 offset:2592
    s_waitcnt lgkmcnt(14)
    v_mfma_f32_16x16x32_bf16 v[80:83], v[136:139], v[40:43], v[80:83]
    v_mfma_f32_16x16x32_bf16 v[84:87], v[216:219], v[40:43], v[84:87]
    ds_read_b64_tr_b16 v[40:41], v3 offset:64
    ds_read_b64_tr_b16 v[42:43], v3 offset:2624
    s_waitcnt lgkmcnt(14)
    v_mfma_f32_16x16x32_bf16 v[48:51], v[140:143], v[44:47], v[48:51]
    v_mfma_f32_16x16x32_bf16 v[52:55], v[220:223], v[44:47], v[52:55]
    ds_read_b64_tr_b16 v[44:45], v3 offset:96
    ds_read_b64_tr_b16 v[46:47], v3 offset:2656
    s_waitcnt lgkmcnt(14)
    v_mfma_f32_16x16x32_bf16 v[56:59], v[140:143], v[16:19], v[56:59]
    v_mfma_f32_16x16x32_bf16 v[60:63], v[220:223], v[16:19], v[60:63]
    ds_read_b64_tr_b16 v[16:17], v3 offset:128
    ds_read_b64_tr_b16 v[18:19], v3 offset:2688
    s_waitcnt lgkmcnt(14)
    v_mfma_f32_16x16x32_bf16 v[64:67], v[140:143], v[20:23], v[64:67]
    v_mfma_f32_16x16x32_bf16 v[68:71], v[220:223], v[20:23], v[68:71]
    ds_read_b64_tr_b16 v[20:21], v3 offset:5120
    ds_read_b64_tr_b16 v[22:23], v3 offset:7680
    s_waitcnt lgkmcnt(14)
    v_mfma_f32_16x16x32_bf16 v[72:75], v[140:143], v[24:27], v[72:75]
    v_mfma_f32_16x16x32_bf16 v[76:79], v[220:223], v[24:27], v[76:79]
    ds_read_b64_tr_b16 v[24:25], v3 offset:5152
    ds_read_b64_tr_b16 v[26:27], v3 offset:7712
    s_waitcnt lgkmcnt(14)
    v_mfma_f32_16x16x32_bf16 v[80:83], v[140:143], v[28:31], v[80:83]
    v_mfma_f32_16x16x32_bf16 v[84:87], v[220:223], v[28:31], v[84:87]
    ds_read_b64_tr_b16 v[28:29], v3 offset:5184
    ds_read_b64_tr_b16 v[30:31], v3 offset:7744
    s_waitcnt lgkmcnt(14)
    v_mfma_f32_16x16x32_bf16 v[48:51], v[144:147], v[32:35], v[48:51]
    v_mfma_f32_16x16x32_bf16 v[52:55], v[224:227], v[32:35], v[52:55]
    ds_read_b64_tr_b16 v[32:33], v3 offset:5216
    ds_read_b64_tr_b16 v[34:35], v3 offset:7776
    s_waitcnt lgkmcnt(14)
    v_mfma_f32_16x16x32_bf16 v[56:59], v[144:147], v[36:39], v[56:59]
    v_mfma_f32_16x16x32_bf16 v[60:63], v[224:227], v[36:39], v[60:63]
    ds_read_b64_tr_b16 v[36:37], v3 offset:5248
    ds_read_b64_tr_b16 v[38:39], v3 offset:7808
    s_waitcnt lgkmcnt(14)
    v_mfma_f32_16x16x32_bf16 v[64:67], v[144:147], v[40:43], v[64:67]
    v_mfma_f32_16x16x32_bf16 v[68:71], v[224:227], v[40:43], v[68:71]
    ds_read_b64_tr_b16 v[40:41], v3 offset:10240
    ds_read_b64_tr_b16 v[42:43], v3 offset:12800
    s_waitcnt lgkmcnt(14)
    v_mfma_f32_16x16x32_bf16 v[72:75], v[144:147], v[44:47], v[72:75]
    v_mfma_f32_16x16x32_bf16 v[76:79], v[224:227], v[44:47], v[76:79]
    ds_read_b64_tr_b16 v[44:45], v3 offset:10272
    ds_read_b64_tr_b16 v[46:47], v3 offset:12832
    s_waitcnt lgkmcnt(14)
    v_mfma_f32_16x16x32_bf16 v[80:83], v[144:147], v[16:19], v[80:83]
    v_mfma_f32_16x16x32_bf16 v[84:87], v[224:227], v[16:19], v[84:87]
    ds_read_b64_tr_b16 v[16:17], v3 offset:10304
    ds_read_b64_tr_b16 v[18:19], v3 offset:12864
    s_waitcnt lgkmcnt(14)
    v_mfma_f32_16x16x32_bf16 v[48:51], v[148:151], v[20:23], v[48:51]
    v_mfma_f32_16x16x32_bf16 v[52:55], v[228:231], v[20:23], v[52:55]
    ds_read_b64_tr_b16 v[20:21], v3 offset:10336
    ds_read_b64_tr_b16 v[22:23], v3 offset:12896
    s_waitcnt lgkmcnt(14)
    v_mfma_f32_16x16x32_bf16 v[56:59], v[148:151], v[24:27], v[56:59]
    v_mfma_f32_16x16x32_bf16 v[60:63], v[228:231], v[24:27], v[60:63]
    ds_read_b64_tr_b16 v[24:25], v3 offset:10368
    ds_read_b64_tr_b16 v[26:27], v3 offset:12928
    s_waitcnt lgkmcnt(14)
    v_mfma_f32_16x16x32_bf16 v[64:67], v[148:151], v[28:31], v[64:67]
    v_mfma_f32_16x16x32_bf16 v[68:71], v[228:231], v[28:31], v[68:71]
    ds_read_b64_tr_b16 v[28:29], v3 offset:15360
    ds_read_b64_tr_b16 v[30:31], v3 offset:17920
    s_waitcnt lgkmcnt(14)
    v_mfma_f32_16x16x32_bf16 v[72:75], v[148:151], v[32:35], v[72:75]
    v_mfma_f32_16x16x32_bf16 v[76:79], v[228:231], v[32:35], v[76:79]
    ds_read_b64_tr_b16 v[32:33], v3 offset:15392
    ds_read_b64_tr_b16 v[34:35], v3 offset:17952
    s_waitcnt lgkmcnt(14)
    v_mfma_f32_16x16x32_bf16 v[80:83], v[148:151], v[36:39], v[80:83]
    v_mfma_f32_16x16x32_bf16 v[84:87], v[228:231], v[36:39], v[84:87]
    ds_read_b64_tr_b16 v[36:37], v3 offset:15424
    ds_read_b64_tr_b16 v[38:39], v3 offset:17984
    s_waitcnt lgkmcnt(14)
    v_mfma_f32_16x16x32_bf16 v[48:51], v[152:155], v[40:43], v[48:51]
    v_mfma_f32_16x16x32_bf16 v[52:55], v[232:235], v[40:43], v[52:55]
    ds_read_b64_tr_b16 v[40:41], v3 offset:15456
    ds_read_b64_tr_b16 v[42:43], v3 offset:18016
    s_waitcnt lgkmcnt(14)
    v_mfma_f32_16x16x32_bf16 v[56:59], v[152:155], v[44:47], v[56:59]
    v_mfma_f32_16x16x32_bf16 v[60:63], v[232:235], v[44:47], v[60:63]
    ds_read_b64_tr_b16 v[44:45], v3 offset:15488
    ds_read_b64_tr_b16 v[46:47], v3 offset:18048
    s_waitcnt lgkmcnt(14)
    v_mfma_f32_16x16x32_bf16 v[64:67], v[152:155], v[16:19], v[64:67]
    v_mfma_f32_16x16x32_bf16 v[68:71], v[232:235], v[16:19], v[68:71]
    s_waitcnt vmcnt(0)
    s_barrier
    ds_read_b64_tr_b16 v[16:17], v3 offset:20480
    ds_read_b64_tr_b16 v[18:19], v3 offset:23040
    s_waitcnt lgkmcnt(14)
    v_mfma_f32_16x16x32_bf16 v[72:75], v[152:155], v[20:23], v[72:75]
    v_mfma_f32_16x16x32_bf16 v[76:79], v[232:235], v[20:23], v[76:79]
    ds_read_b64_tr_b16 v[20:21], v3 offset:20512
    ds_read_b64_tr_b16 v[22:23], v3 offset:23072
    s_waitcnt lgkmcnt(14)
    v_mfma_f32_16x16x32_bf16 v[80:83], v[152:155], v[24:27], v[80:83]
    v_mfma_f32_16x16x32_bf16 v[84:87], v[232:235], v[24:27], v[84:87]
    ds_read_b64_tr_b16 v[24:25], v3 offset:20544
    ds_read_b64_tr_b16 v[26:27], v3 offset:23104
    s_waitcnt lgkmcnt(14)
    v_mfma_f32_16x16x32_bf16 v[48:51], v[156:159], v[28:31], v[48:51]
    v_mfma_f32_16x16x32_bf16 v[52:55], v[236:239], v[28:31], v[52:55]
    ds_read_b64_tr_b16 v[28:29], v3 offset:20576
    ds_read_b64_tr_b16 v[30:31], v3 offset:23136
    s_waitcnt lgkmcnt(14)
    v_mfma_f32_16x16x32_bf16 v[56:59], v[156:159], v[32:35], v[56:59]
    v_mfma_f32_16x16x32_bf16 v[60:63], v[236:239], v[32:35], v[60:63]
    ds_read_b64_tr_b16 v[32:33], v3 offset:20608
    ds_read_b64_tr_b16 v[34:35], v3 offset:23168
    s_waitcnt lgkmcnt(14)
    v_mfma_f32_16x16x32_bf16 v[64:67], v[156:159], v[36:39], v[64:67]
    v_mfma_f32_16x16x32_bf16 v[68:71], v[236:239], v[36:39], v[68:71]
    ds_read_b64_tr_b16 v[36:37], v3 offset:25600
    ds_read_b64_tr_b16 v[38:39], v3 offset:28160
    s_waitcnt lgkmcnt(14)
    v_mfma_f32_16x16x32_bf16 v[72:75], v[156:159], v[40:43], v[72:75]
    v_mfma_f32_16x16x32_bf16 v[76:79], v[236:239], v[40:43], v[76:79]
    ds_read_b64_tr_b16 v[40:41], v3 offset:25632
    ds_read_b64_tr_b16 v[42:43], v3 offset:28192
    s_waitcnt lgkmcnt(14)
    v_mfma_f32_16x16x32_bf16 v[80:83], v[156:159], v[44:47], v[80:83]
    v_mfma_f32_16x16x32_bf16 v[84:87], v[236:239], v[44:47], v[84:87]
    ds_read_b64_tr_b16 v[44:45], v3 offset:25664
    ds_read_b64_tr_b16 v[46:47], v3 offset:28224
    s_waitcnt lgkmcnt(14)
    v_mfma_f32_16x16x32_bf16 v[48:51], v[160:163], v[16:19], v[48:51]
    v_mfma_f32_16x16x32_bf16 v[52:55], v[240:243], v[16:19], v[52:55]
    ds_read_b64_tr_b16 v[16:17], v3 offset:25696
    ds_read_b64_tr_b16 v[18:19], v3 offset:28256
    s_waitcnt lgkmcnt(14)
    v_mfma_f32_16x16x32_bf16 v[56:59], v[160:163], v[20:23], v[56:59]
    v_mfma_f32_16x16x32_bf16 v[60:63], v[240:243], v[20:23], v[60:63]
    ds_read_b64_tr_b16 v[20:21], v3 offset:25728
    ds_read_b64_tr_b16 v[22:23], v3 offset:28288
    s_waitcnt lgkmcnt(14)
    v_mfma_f32_16x16x32_bf16 v[64:67], v[160:163], v[24:27], v[64:67]
    v_mfma_f32_16x16x32_bf16 v[68:71], v[240:243], v[24:27], v[68:71]
    ds_read_b64_tr_b16 v[24:25], v3 offset:30720
    ds_read_b64_tr_b16 v[26:27], v3 offset:33280
    s_waitcnt lgkmcnt(14)
    v_mfma_f32_16x16x32_bf16 v[72:75], v[160:163], v[28:31], v[72:75]
    v_mfma_f32_16x16x32_bf16 v[76:79], v[240:243], v[28:31], v[76:79]
    ds_read_b64_tr_b16 v[28:29], v3 offset:30752
    ds_read_b64_tr_b16 v[30:31], v3 offset:33312
    s_waitcnt lgkmcnt(14)
    v_mfma_f32_16x16x32_bf16 v[80:83], v[160:163], v[32:35], v[80:83]
    v_mfma_f32_16x16x32_bf16 v[84:87], v[240:243], v[32:35], v[84:87]
    ds_read_b64_tr_b16 v[32:33], v3 offset:30784
    ds_read_b64_tr_b16 v[34:35], v3 offset:33344
    s_waitcnt lgkmcnt(14)
    v_mfma_f32_16x16x32_bf16 v[48:51], v[164:167], v[36:39], v[48:51]
    v_mfma_f32_16x16x32_bf16 v[52:55], v[244:247], v[36:39], v[52:55]
    ds_read_b64_tr_b16 v[36:37], v3 offset:30816
    ds_read_b64_tr_b16 v[38:39], v3 offset:33376
    s_waitcnt lgkmcnt(14)
    v_mfma_f32_16x16x32_bf16 v[56:59], v[164:167], v[40:43], v[56:59]
    v_mfma_f32_16x16x32_bf16 v[60:63], v[244:247], v[40:43], v[60:63]
    ds_read_b64_tr_b16 v[40:41], v3 offset:30848
    ds_read_b64_tr_b16 v[42:43], v3 offset:33408
    s_waitcnt lgkmcnt(14)
    v_mfma_f32_16x16x32_bf16 v[64:67], v[164:167], v[44:47], v[64:67]
    v_mfma_f32_16x16x32_bf16 v[68:71], v[244:247], v[44:47], v[68:71]
    ds_read_b64_tr_b16 v[44:45], v3 offset:35840
    ds_read_b64_tr_b16 v[46:47], v3 offset:38400
    s_waitcnt lgkmcnt(14)
    v_mfma_f32_16x16x32_bf16 v[72:75], v[164:167], v[16:19], v[72:75]
    v_mfma_f32_16x16x32_bf16 v[76:79], v[244:247], v[16:19], v[76:79]
    ds_read_b64_tr_b16 v[16:17], v3 offset:35872
    ds_read_b64_tr_b16 v[18:19], v3 offset:38432
    s_waitcnt lgkmcnt(14)
    v_mfma_f32_16x16x32_bf16 v[80:83], v[164:167], v[20:23], v[80:83]
    v_mfma_f32_16x16x32_bf16 v[84:87], v[244:247], v[20:23], v[84:87]
    ds_read_b64_tr_b16 v[20:21], v3 offset:35904
    ds_read_b64_tr_b16 v[22:23], v3 offset:38464
    s_waitcnt lgkmcnt(14)
    v_mfma_f32_16x16x32_bf16 v[48:51], v[168:171], v[24:27], v[48:51]
    v_mfma_f32_16x16x32_bf16 v[52:55], v[248:251], v[24:27], v[52:55]
    ds_read_b64_tr_b16 v[24:25], v3 offset:35936
    ds_read_b64_tr_b16 v[26:27], v3 offset:38496
    s_waitcnt lgkmcnt(14)
    v_mfma_f32_16x16x32_bf16 v[56:59], v[168:171], v[28:31], v[56:59]
    v_mfma_f32_16x16x32_bf16 v[60:63], v[248:251], v[28:31], v[60:63]
    ds_read_b64_tr_b16 v[28:29], v3 offset:35968
    ds_read_b64_tr_b16 v[30:31], v3 offset:38528
    s_waitcnt lgkmcnt(14)
    v_mfma_f32_16x16x32_bf16 v[64:67], v[168:171], v[32:35], v[64:67]
    v_mfma_f32_16x16x32_bf16 v[68:71], v[248:251], v[32:35], v[68:71]
    s_waitcnt lgkmcnt(12)
    v_mfma_f32_16x16x32_bf16 v[72:75], v[168:171], v[36:39], v[72:75]
    v_mfma_f32_16x16x32_bf16 v[76:79], v[248:251], v[36:39], v[76:79]
    s_waitcnt lgkmcnt(10)
    v_mfma_f32_16x16x32_bf16 v[80:83], v[168:171], v[40:43], v[80:83]
    v_mfma_f32_16x16x32_bf16 v[84:87], v[248:251], v[40:43], v[84:87]
    s_waitcnt lgkmcnt(8)
    v_mfma_f32_16x16x32_bf16 v[48:51], v[172:175], v[44:47], v[48:51]
    v_mfma_f32_16x16x32_bf16 v[52:55], v[252:255], v[44:47], v[52:55]
    s_waitcnt lgkmcnt(6)
    v_mfma_f32_16x16x32_bf16 v[56:59], v[172:175], v[16:19], v[56:59]
    v_mfma_f32_16x16x32_bf16 v[60:63], v[252:255], v[16:19], v[60:63]
    s_waitcnt lgkmcnt(4)
    v_mfma_f32_16x16x32_bf16 v[64:67], v[172:175], v[20:23], v[64:67]
    v_mfma_f32_16x16x32_bf16 v[68:71], v[252:255], v[20:23], v[68:71]
    s_waitcnt lgkmcnt(2)
    v_mfma_f32_16x16x32_bf16 v[72:75], v[172:175], v[24:27], v[72:75]
    v_mfma_f32_16x16x32_bf16 v[76:79], v[252:255], v[24:27], v[76:79]
    s_waitcnt lgkmcnt(0)
    v_mfma_f32_16x16x32_bf16 v[80:83], v[172:175], v[28:31], v[80:83]
    v_mfma_f32_16x16x32_bf16 v[84:87], v[252:255], v[28:31], v[84:87]
    ds_read_b64 v[10:11], v7
    ds_read_b64 v[12:13], v8
    ds_read_b64 v[14:15], v9
    v_and_b32 v16, 15, v1
    v_lshrrev_b32 v17, 4, v1
    s_lshl_b32 s42, s3, 7
    s_add_u32 s42, s42, 46016
    v_lshl_add_u32 v19, v17, 4, s42
    s_lshl_b32 s42, s3, 6
    s_cmp_eq_u32 s3, 2
    s_cselect_b32 s42, 192, s42
    s_cmp_eq_u32 s3, 3
    s_cselect_b32 s42, 128, s42
    s_add_u32 s42, s42, 61440
    v_mul_u32_u24 v20, 496, v16
    v_lshl_add_u32 v20, v17, 4, v20
    v_add_u32 v20, s42, v20
    v_lshlrev_b32 v18, 3, v16
    v_add_u32 v18, 45376, v18
    s_waitcnt lgkmcnt(0)
    s_barrier
    ds_read_b64 v[24:25], v18 offset:0
    ds_read_b64 v[26:27], v18 offset:128
    ds_read_b64 v[28:29], v18 offset:256
    ds_read_b64 v[30:31], v18 offset:384
    ds_read_b64 v[32:33], v18 offset:512
    ds_read_b128 v[36:39], v19 offset:0
    ds_read_b128 v[40:43], v19 offset:64
    s_waitcnt lgkmcnt(0)
    v_fma_f32 v48, -v24, v36, v48
    v_fma_f32 v49, -v24, v37, v49
    v_fma_f32 v50, -v24, v38, v50
    v_fma_f32 v51, -v24, v39, v51
    v_fma_f32 v52, -v24, v40, v52
    v_fma_f32 v53, -v24, v41, v53
    v_fma_f32 v54, -v24, v42, v54
    v_fma_f32 v55, -v24, v43, v55
    v_fma_f32 v56, -v26, v36, v56
    v_fma_f32 v57, -v26, v37, v57
    v_fma_f32 v58, -v26, v38, v58
    v_fma_f32 v59, -v26, v39, v59
    v_fma_f32 v60, -v26, v40, v60
    v_fma_f32 v61, -v26, v41, v61
    v_fma_f32 v62, -v26, v42, v62
    v_fma_f32 v63, -v26, v43, v63
    v_fma_f32 v64, -v28, v36, v64
    v_fma_f32 v65, -v28, v37, v65
    v_fma_f32 v66, -v28, v38, v66
    v_fma_f32 v67, -v28, v39, v67
    v_fma_f32 v68, -v28, v40, v68
    v_fma_f32 v69, -v28, v41, v69
    v_fma_f32 v70, -v28, v42, v70
    v_fma_f32 v71, -v28, v43, v71
    v_fma_f32 v72, -v30, v36, v72
    v_fma_f32 v73, -v30, v37, v73
    v_fma_f32 v74, -v30, v38, v74
    v_fma_f32 v75, -v30, v39, v75
    v_fma_f32 v76, -v30, v40, v76
    v_fma_f32 v77, -v30, v41, v77
    v_fma_f32 v78, -v30, v42, v78
    v_fma_f32 v79, -v30, v43, v79
    v_fma_f32 v80, -v32, v36, v80
    v_fma_f32 v81, -v32, v37, v81
    v_fma_f32 v82, -v32, v38, v82
    v_fma_f32 v83, -v32, v39, v83
    v_fma_f32 v84, -v32, v40, v84
    v_fma_f32 v85, -v32, v41, v85
    v_fma_f32 v86, -v32, v42, v86
    v_fma_f32 v87, -v32, v43, v87
    v_mul_f32 v48, v48, v25
    v_mul_f32 v49, v49, v25
    v_mul_f32 v50, v50, v25
    v_mul_f32 v51, v51, v25
    v_mul_f32 v52, v52, v25
    v_mul_f32 v53, v53, v25
    v_mul_f32 v54, v54, v25
    v_mul_f32 v55, v55, v25
    v_mul_f32 v56, v56, v27
    v_mul_f32 v57, v57, v27
    v_mul_f32 v58, v58, v27
    v_mul_f32 v59, v59, v27
    v_mul_f32 v60, v60, v27
    v_mul_f32 v61, v61, v27
    v_mul_f32 v62, v62, v27
    v_mul_f32 v63, v63, v27
    v_mul_f32 v64, v64, v29
    v_mul_f32 v65, v65, v29
    v_mul_f32 v66, v66, v29
    v_mul_f32 v67, v67, v29
    v_mul_f32 v68, v68, v29
    v_mul_f32 v69, v69, v29
    v_mul_f32 v70, v70, v29
    v_mul_f32 v71, v71, v29
    v_mul_f32 v72, v72, v31
    v_mul_f32 v73, v73, v31
    v_mul_f32 v74, v74, v31
    v_mul_f32 v75, v75, v31
    v_mul_f32 v76, v76, v31
    v_mul_f32 v77, v77, v31
    v_mul_f32 v78, v78, v31
    v_mul_f32 v79, v79, v31
    v_mul_f32 v80, v80, v33
    v_mul_f32 v81, v81, v33
    v_mul_f32 v82, v82, v33
    v_mul_f32 v83, v83, v33
    v_mul_f32 v84, v84, v33
    v_mul_f32 v85, v85, v33
    v_mul_f32 v86, v86, v33
    v_mul_f32 v87, v87, v33
    v_cvt_pk_bf16_f32 v48, v48, v52
    v_cvt_pk_bf16_f32 v49, v49, v53
    v_cvt_pk_bf16_f32 v50, v50, v54
    v_cvt_pk_bf16_f32 v51, v51, v55
    ds_write_b128 v20, v[48:51] offset:0
    v_cvt_pk_bf16_f32 v56, v56, v60
    v_cvt_pk_bf16_f32 v57, v57, v61
    v_cvt_pk_bf16_f32 v58, v58, v62
    v_cvt_pk_bf16_f32 v59, v59, v63
    ds_write_b128 v20, v[56:59] offset:7936
    v_cvt_pk_bf16_f32 v64, v64, v68
    v_cvt_pk_bf16_f32 v65, v65, v69
    v_cvt_pk_bf16_f32 v66, v66, v70
    v_cvt_pk_bf16_f32 v67, v67, v71
    ds_write_b128 v20, v[64:67] offset:15872
    v_cvt_pk_bf16_f32 v72, v72, v76
    v_cvt_pk_bf16_f32 v73, v73, v77
    v_cvt_pk_bf16_f32 v74, v74, v78
    v_cvt_pk_bf16_f32 v75, v75, v79
    ds_write_b128 v20, v[72:75] offset:23808
    v_cvt_pk_bf16_f32 v80, v80, v84
    v_cvt_pk_bf16_f32 v81, v81, v85
    v_cvt_pk_bf16_f32 v82, v82, v86
    v_cvt_pk_bf16_f32 v83, v83, v87
    ds_write_b128 v20, v[80:83] offset:31744
    s_branch L_a1_post
L_g2A:
    s_waitcnt vmcnt(2)
    s_barrier
    ds_read_b64_tr_b16 v[16:17], v2 offset:32
    ds_read_b64_tr_b16 v[18:19], v2 offset:2592
    ds_read_b64_tr_b16 v[20:21], v2 offset:64
    ds_read_b64_tr_b16 v[22:23], v2 offset:2624
    ds_read_b64_tr_b16 v[24:25], v2 offset:96
    ds_read_b64_tr_b16 v[26:27], v2 offset:2656
    ds_read_b64_tr_b16 v[28:29], v2 offset:128
    ds_read_b64_tr_b16 v[30:31], v2 offset:2688
    ds_read_b64_tr_b16 v[32:33], v2 offset:5152
    ds_read_b64_tr_b16 v[34:35], v2 offset:7712
    ds_read_b64_tr_b16 v[36:37], v2 offset:5184
    ds_read_b64_tr_b16 v[38:39], v2 offset:7744
    ds_read_b64_tr_b16 v[40:41], v2 offset:5216
    ds_read_b64_tr_b16 v[42:43], v2 offset:7776
    ds_read_b64_tr_b16 v[44:45], v2 offset:5248
    ds_read_b64_tr_b16 v[46:47], v2 offset:7808
    s_waitcnt lgkmcnt(14)
    v_mfma_f32_16x16x32_bf16 v[48:51], v[96:99], v[16:19], 0
    v_mfma_f32_16x16x32_bf16 v[52:55], v[176:179], v[16:19], 0
    v_mfma_f32_16x16x32_bf16 v[56:59], v[16:19], v[16:19], 0
    v_mfma_f32_16x16x32_bf16 v[60:63], v[10:13], v[16:19], 0
    s_add_u32 m0, s52, 94208
    s_nop 0
    global_load_lds_dwordx4 v15, s[50:51] sc1
    ds_read_b64_tr_b16 v[16:17], v2 offset:10272
    ds_read_b64_tr_b16 v[18:19], v2 offset:12832
    s_waitcnt lgkmcnt(14)
    v_mfma_f32_16x16x32_bf16 v[64:67], v[96:99], v[20:23], 0
    v_mfma_f32_16x16x32_bf16 v[68:71], v[176:179], v[20:23], 0
    ds_read_b64_tr_b16 v[20:21], v2 offset:10304
    ds_read_b64_tr_b16 v[22:23], v2 offset:12864
    s_waitcnt lgkmcnt(14)
    v_mfma_f32_16x16x32_bf16 v[72:75], v[96:99], v[24:27], 0
    v_mfma_f32_16x16x32_bf16 v[76:79], v[176:179], v[24:27], 0
    ds_read_b64_tr_b16 v[24:25], v2 offset:10336
    ds_read_b64_tr_b16 v[26:27], v2 offset:12896
    s_waitcnt lgkmcnt(14)
    v_mfma_f32_16x16x32_bf16 v[80:83], v[96:99], v[28:31], 0
    v_mfma_f32_16x16x32_bf16 v[84:87], v[176:179], v[28:31], 0
    ds_read_b64_tr_b16 v[28:29], v2 offset:10368
    ds_read_b64_tr_b16 v[30:31], v2 offset:12928
    s_waitcnt lgkmcnt(14)
    v_mfma_f32_16x16x32_bf16 v[48:51], v[100:103], v[32:35], v[48:51]
    v_mfma_f32_16x16x32_bf16 v[52:55], v[180:183], v[32:35], v[52:55]
    v_mfma_f32_16x16x32_bf16 v[56:59], v[32:35], v[32:35], v[56:59]
    v_mfma_f32_16x16x32_bf16 v[60:63], v[10:13], v[32:35], v[60:63]
    s_add_u32 m0, s52, 102400
    s_add_u32 s50, s50, 1048576
    s_addc_u32 s51, s51, 0
    global_load_lds_dwordx4 v4, s[50:51] sc1
    s_waitcnt vmcnt(2)
    s_barrier
    ds_read_b64_tr_b16 v[32:33], v2 offset:15392
    ds_read_b64_tr_b16 v[34:35], v2 offset:17952
    s_waitcnt lgkmcnt(14)
    v_mfma_f32_16x16x32_bf16 v[64:67], v[100:103], v[36:39], v[64:67]
    v_mfma_f32_16x16x32_bf16 v[68:71], v[180:183], v[36:39], v[68:71]
    ds_read_b64_tr_b16 v[36:37], v2 offset:15424
    ds_read_b64_tr_b16 v[38:39], v2 offset:17984
    s_waitcnt lgkmcnt(14)
    v_mfma_f32_16x16x32_bf16 v[72:75], v[100:103], v[40:43], v[72:75]
    v_mfma_f32_16x16x32_bf16 v[76:79], v[180:183], v[40:43], v[76:79]
    ds_read_b64_tr_b16 v[40:41], v2 offset:15456
    ds_read_b64_tr_b16 v[42:43], v2 offset:18016
    s_waitcnt lgkmcnt(14)
    v_mfma_f32_16x16x32_bf16 v[80:83], v[100:103], v[44:47], v[80:83]
    v_mfma_f32_16x16x32_bf16 v[84:87], v[180:183], v[44:47], v[84:87]
    ds_read_b64_tr_b16 v[44:45], v2 offset:15488
    ds_read_b64_tr_b16 v[46:47], v2 offset:18048
    s_waitcnt lgkmcnt(14)
    v_mfma_f32_16x16x32_bf16 v[48:51], v[104:107], v[16:19], v[48:51]
    v_mfma_f32_16x16x32_bf16 v[52:55], v[184:187], v[16:19], v[52:55]
    v_mfma_f32_16x16x32_bf16 v[56:59], v[16:19], v[16:19], v[56:59]
    v_mfma_f32_16x16x32_bf16 v[60:63], v[10:13], v[16:19], v[60:63]
    s_add_u32 m0, s52, 110592
    s_nop 0
    global_load_lds_dwordx4 v5, s[50:51] sc1
    ds_read_b64_tr_b16 v[16:17], v2 offset:20512
    ds_read_b64_tr_b16 v[18:19], v2 offset:23072
    s_waitcnt lgkmcnt(14)
    v_mfma_f32_16x16x32_bf16 v[64:67], v[104:107], v[20:23], v[64:67]
    v_mfma_f32_16x16x32_bf16 v[68:71], v[184:187], v[20:23], v[68:71]
    ds_read_b64_tr_b16 v[20:21], v2 offset:20544
    ds_read_b64_tr_b16 v[22:23], v2 offset:23104
    s_waitcnt lgkmcnt(14)
    v_mfma_f32_16x16x32_bf16 v[72:75], v[104:107], v[24:27], v[72:75]
    v_mfma_f32_16x16x32_bf16 v[76:79], v[184:187], v[24:27], v[76:79]
    ds_read_b64_tr_b16 v[24:25], v2 offset:20576
    ds_read_b64_tr_b16 v[26:27], v2 offset:23136
    s_waitcnt lgkmcnt(14)
    v_mfma_f32_16x16x32_bf16 v[80:83], v[104:107], v[28:31], v[80:83]
    v_mfma_f32_16x16x32_bf16 v[84:87], v[184:187], v[28:31], v[84:87]
    ds_read_b64_tr_b16 v[28:29], v2 offset:20608
    ds_read_b64_tr_b16 v[30:31], v2 offset:23168
    s_waitcnt lgkmcnt(14)
    v_mfma_f32_16x16x32_bf16 v[48:51], v[108:111], v[32:35], v[48:51]
    v_mfma_f32_16x16x32_bf16 v[52:55], v[188:191], v[32:35], v[52:55]
    v_mfma_f32_16x16x32_bf16 v[56:59], v[32:35], v[32:35], v[56:59]
    v_mfma_f32_16x16x32_bf16 v[60:63], v[10:13], v[32:35], v[60:63]
    s_add_u32 m0, s52, 118784
    s_nop 0
    global_load_lds_dwordx4 v6, s[50:51] sc1
    ds_read_b64_tr_b16 v[32:33], v2 offset:25632
    ds_read_b64_tr_b16 v[34:35], v2 offset:28192
    s_waitcnt lgkmcnt(14)
    v_mfma_f32_16x16x32_bf16 v[64:67], v[108:111], v[36:39], v[64:67]
    v_mfma_f32_16x16x32_bf16 v[68:71], v[188:191], v[36:39], v[68:71]
    ds_read_b64_tr_b16 v[36:37], v2 offset:25664
    ds_read_b64_tr_b16 v[38:39], v2 offset:28224
    s_waitcnt lgkmcnt(14)
    v_mfma_f32_16x16x32_bf16 v[72:75], v[108:111], v[40:43], v[72:75]
    v_mfma_f32_16x16x32_bf16 v[76:79], v[188:191], v[40:43], v[76:79]
    ds_read_b64_tr_b16 v[40:41], v2 offset:25696
    ds_read_b64_tr_b16 v[42:43], v2 offset:28256
    s_waitcnt lgkmcnt(14)
    v_mfma_f32_16x16x32_bf16 v[80:83], v[108:111], v[44:47], v[80:83]
    v_mfma_f32_16x16x32_bf16 v[84:87], v[188:191], v[44:47], v[84:87]
    ds_read_b64_tr_b16 v[44:45], v2 offset:25728
    ds_read_b64_tr_b16 v[46:47], v2 offset:28288
    s_waitcnt lgkmcnt(14)
    v_mfma_f32_16x16x32_bf16 v[48:51], v[112:115], v[16:19], v[48:51]
    v_mfma_f32_16x16x32_bf16 v[52:55], v[192:195], v[16:19], v[52:55]
    v_mfma_f32_16x16x32_bf16 v[56:59], v[16:19], v[16:19], v[56:59]
    v_mfma_f32_16x16x32_bf16 v[60:63], v[10:13], v[16:19], v[60:63]
    s_add_u32 m0, s52, 126976
    s_nop 0
    global_load_lds_dwordx4 v14, s[50:51] sc1
    s_waitcnt vmcnt(2)
    s_barrier
    ds_read_b64_tr_b16 v[16:17], v2 offset:30752
    ds_read_b64_tr_b16 v[18:19], v2 offset:33312
    s_waitcnt lgkmcnt(14)
    v_mfma_f32_16x16x32_bf16 v[64:67], v[112:115], v[20:23], v[64:67]
    v_mfma_f32_16x16x32_bf16 v[68:71], v[192:195], v[20:23], v[68:71]
    ds_read_b64_tr_b16 v[20:21], v2 offset:30784
    ds_read_b64_tr_b16 v[22:23], v2 offset:33344
    s_waitcnt lgkmcnt(14)
    v_mfma_f32_16x16x32_bf16 v[72:75], v[112:115], v[24:27], v[72:75]
    v_mfma_f32_16x16x32_bf16 v[76:79], v[192:195], v[24:27], v[76:79]
    ds_read_b64_tr_b16 v[24:25], v2 offset:30816
    ds_read_b64_tr_b16 v[26:27], v2 offset:33376
    s_waitcnt lgkmcnt(14)
    v_mfma_f32_16x16x32_bf16 v[80:83], v[112:115], v[28:31], v[80:83]
    v_mfma_f32_16x16x32_bf16 v[84:87], v[192:195], v[28:31], v[84:87]
    ds_read_b64_tr_b16 v[28:29], v2 offset:30848
    ds_read_b64_tr_b16 v[30:31], v2 offset:33408
    s_waitcnt lgkmcnt(14)
    v_mfma_f32_16x16x32_bf16 v[48:51], v[116:119], v[32:35], v[48:51]
    v_mfma_f32_16x16x32_bf16 v[52:55], v[196:199], v[32:35], v[52:55]
    v_mfma_f32_16x16x32_bf16 v[56:59], v[32:35], v[32:35], v[56:59]
    v_mfma_f32_16x16x32_bf16 v[60:63], v[10:13], v[32:35], v[60:63]
    s_add_u32 m0, s52, 135168
    s_nop 0
    global_load_lds_dwordx4 v15, s[50:51] sc1
    ds_read_b64_tr_b16 v[32:33], v2 offset:35872
    ds_read_b64_tr_b16 v[34:35], v2 offset:38432
    s_waitcnt lgkmcnt(14)
    v_mfma_f32_16x16x32_bf16 v[64:67], v[116:119], v[36:39], v[64:67]
    v_mfma_f32_16x16x32_bf16 v[68:71], v[196:199], v[36:39], v[68:71]
    ds_read_b64_tr_b16 v[36:37], v2 offset:35904
    ds_read_b64_tr_b16 v[38:39], v2 offset:38464
    s_waitcnt lgkmcnt(14)
    v_mfma_f32_16x16x32_bf16 v[72:75], v[116:119], v[40:43], v[72:75]
    v_mfma_f32_16x16x32_bf16 v[76:79], v[196:199], v[40:43], v[76:79]
    ds_read_b64_tr_b16 v[40:41], v2 offset:35936
    ds_read_b64_tr_b16 v[42:43], v2 offset:38496
    s_waitcnt lgkmcnt(14)
    v_mfma_f32_16x16x32_bf16 v[80:83], v[116:119], v[44:47], v[80:83]
    v_mfma_f32_16x16x32_bf16 v[84:87], v[196:199], v[44:47], v[84:87]
    ds_read_b64_tr_b16 v[44:45], v2 offset:35968
    ds_read_b64_tr_b16 v[46:47], v2 offset:38528
    s_waitcnt lgkmcnt(14)
    v_mfma_f32_16x16x32_bf16 v[48:51], v[120:123], v[16:19], v[48:51]
    v_mfma_f32_16x16x32_bf16 v[52:55], v[200:203], v[16:19], v[52:55]
    v_mfma_f32_16x16x32_bf16 v[56:59], v[16:19], v[16:19], v[56:59]
    v_mfma_f32_16x16x32_bf16 v[60:63], v[10:13], v[16:19], v[60:63]
    s_add_u32 m0, s52, 143360
    s_add_u32 s50, s50, 1048576
    s_addc_u32 s51, s51, 0
    global_load_lds_dwordx4 v4, s[50:51] sc1
    ds_read_b64_tr_b16 v[16:17], v2 offset:40992
    ds_read_b64_tr_b16 v[18:19], v2 offset:43552
    s_waitcnt lgkmcnt(14)
    v_mfma_f32_16x16x32_bf16 v[64:67], v[120:123], v[20:23], v[64:67]
    v_mfma_f32_16x16x32_bf16 v[68:71], v[200:203], v[20:23], v[68:71]
    ds_read_b64_tr_b16 v[20:21], v2 offset:41024
    ds_read_b64_tr_b16 v[22:23], v2 offset:43584
    s_waitcnt lgkmcnt(14)
    v_mfma_f32_16x16x32_bf16 v[72:75], v[120:123], v[24:27], v[72:75]
    v_mfma_f32_16x16x32_bf16 v[76:79], v[200:203], v[24:27], v[76:79]
    ds_read_b64_tr_b16 v[24:25], v2 offset:41056
    ds_read_b64_tr_b16 v[26:27], v2 offset:43616
    s_waitcnt lgkmcnt(14)
    v_mfma_f32_16x16x32_bf16 v[80:83], v[120:123], v[28:31], v[80:83]
    v_mfma_f32_16x16x32_bf16 v[84:87], v[200:203], v[28:31], v[84:87]
    ds_read_b64_tr_b16 v[28:29], v2 offset:41088
    ds_read_b64_tr_b16 v[30:31], v2 offset:43648
    s_waitcnt lgkmcnt(14)
    v_mfma_f32_16x16x32_bf16 v[48:51], v[124:127], v[32:35], v[48:51]
    v_mfma_f32_16x16x32_bf16 v[52:55], v[204:207], v[32:35], v[52:55]
    v_mfma_f32_16x16x32_bf16 v[56:59], v[32:35], v[32:35], v[56:59]
    v_mfma_f32_16x16x32_bf16 v[60:63], v[10:13], v[32:35], v[60:63]
    s_add_u32 m0, s52, 151552
    s_nop 0
    global_load_lds_dwordx4 v5, s[50:51] sc1
    ds_read_b64_tr_b16 v[32:33], v2 offset:46112
    ds_read_b64_tr_b16 v[34:35], v2 offset:48672
    s_waitcnt lgkmcnt(14)
    v_mfma_f32_16x16x32_bf16 v[64:67], v[124:127], v[36:39], v[64:67]
    v_mfma_f32_16x16x32_bf16 v[68:71], v[204:207], v[36:39], v[68:71]
    ds_read_b64_tr_b16 v[36:37], v2 offset:46144
    ds_read_b64_tr_b16 v[38:39], v2 offset:48704
    s_waitcnt lgkmcnt(14)
    v_mfma_f32_16x16x32_bf16 v[72:75], v[124:127], v[40:43], v[72:75]
    v_mfma_f32_16x16x32_bf16 v[76:79], v[204:207], v[40:43], v[76:79]
    ds_read_b64_tr_b16 v[40:41], v2 offset:46176
    ds_read_b64_tr_b16 v[42:43], v2 offset:48736
    s_waitcnt lgkmcnt(14)
    v_mfma_f32_16x16x32_bf16 v[80:83], v[124:127], v[44:47], v[80:83]
    v_mfma_f32_16x16x32_bf16 v[84:87], v[204:207], v[44:47], v[84:87]
    ds_read_b64_tr_b16 v[44:45], v2 offset:46208
    ds_read_b64_tr_b16 v[46:47], v2 offset:48768
    s_waitcnt lgkmcnt(14)
    v_mfma_f32_16x16x32_bf16 v[48:51], v[128:131], v[16:19], v[48:51]
    v_mfma_f32_16x16x32_bf16 v[52:55], v[208:211], v[16:19], v[52:55]
    v_mfma_f32_16x16x32_bf16 v[56:59], v[16:19], v[16:19], v[56:59]
    v_mfma_f32_16x16x32_bf16 v[60:63], v[10:13], v[16:19], v[60:63]
    s_cmp_ge_u32 s3, 4
    s_nop 5
    s_cbranch_scc1 L_r1215
    s_add_u32 m0, s52, 159744
    s_nop 0
    global_load_lds_dwordx4 v6, s[50:51] sc1
L_r1215:
    ds_read_b64_tr_b16 v[16:17], v2 offset:51232
    ds_read_b64_tr_b16 v[18:19], v2 offset:53792
    s_waitcnt lgkmcnt(14)
    v_mfma_f32_16x16x32_bf16 v[64:67], v[128:131], v[20:23], v[64:67]
    v_mfma_f32_16x16x32_bf16 v[68:71], v[208:211], v[20:23], v[68:71]
    ds_read_b64_tr_b16 v[20:21], v2 offset:51264
    ds_read_b64_tr_b16 v[22:23], v2 offset:53824
    s_waitcnt lgkmcnt(14)
    v_mfma_f32_16x16x32_bf16 v[72:75], v[128:131], v[24:27], v[72:75]
    v_mfma_f32_16x16x32_bf16 v[76:79], v[208:211], v[24:27], v[76:79]
    ds_read_b64_tr_b16 v[24:25], v2 offset:51296
    ds_read_b64_tr_b16 v[26:27], v2 offset:53856
    s_waitcnt lgkmcnt(14)
    v_mfma_f32_16x16x32_bf16 v[80:83], v[128:131], v[28:31], v[80:83]
    v_mfma_f32_16x16x32_bf16 v[84:87], v[208:211], v[28:31], v[84:87]
    ds_read_b64_tr_b16 v[28:29], v2 offset:51328
    ds_read_b64_tr_b16 v[30:31], v2 offset:53888
    s_waitcnt lgkmcnt(14)
    v_mfma_f32_16x16x32_bf16 v[48:51], v[132:135], v[32:35], v[48:51]
    v_mfma_f32_16x16x32_bf16 v[52:55], v[212:215], v[32:35], v[52:55]
    v_mfma_f32_16x16x32_bf16 v[56:59], v[32:35], v[32:35], v[56:59]
    v_mfma_f32_16x16x32_bf16 v[60:63], v[10:13], v[32:35], v[60:63]
    s_waitcnt vmcnt(2)
    s_barrier
    ds_read_b64_tr_b16 v[32:33], v2 offset:56352
    ds_read_b64_tr_b16 v[34:35], v2 offset:58912
    s_waitcnt lgkmcnt(14)
    v_mfma_f32_16x16x32_bf16 v[64:67], v[132:135], v[36:39], v[64:67]
    v_mfma_f32_16x16x32_bf16 v[68:71], v[212:215], v[36:39], v[68:71]
    ds_read_b64_tr_b16 v[36:37], v2 offset:56384
    ds_read_b64_tr_b16 v[38:39], v2 offset:58944
    s_waitcnt lgkmcnt(14)
    v_mfma_f32_16x16x32_bf16 v[72:75], v[132:135], v[40:43], v[72:75]
    v_mfma_f32_16x16x32_bf16 v[76:79], v[212:215], v[40:43], v[76:79]
    ds_read_b64_tr_b16 v[40:41], v2 offset:56416
    ds_read_b64_tr_b16 v[42:43], v2 offset:58976
    s_waitcnt lgkmcnt(14)
    v_mfma_f32_16x16x32_bf16 v[80:83], v[132:135], v[44:47], v[80:83]
    v_mfma_f32_16x16x32_bf16 v[84:87], v[212:215], v[44:47], v[84:87]
    ds_read_b64_tr_b16 v[44:45], v2 offset:56448
    ds_read_b64_tr_b16 v[46:47], v2 offset:59008
    s_waitcnt lgkmcnt(14)
    v_mfma_f32_16x16x32_bf16 v[48:51], v[136:139], v[16:19], v[48:51]
    v_mfma_f32_16x16x32_bf16 v[52:55], v[216:219], v[16:19], v[52:55]
    v_mfma_f32_16x16x32_bf16 v[56:59], v[16:19], v[16:19], v[56:59]
    v_mfma_f32_16x16x32_bf16 v[60:63], v[10:13], v[16:19], v[60:63]
    ds_read_b64_tr_b16 v[16:17], v3 offset:32
    ds_read_b64_tr_b16 v[18:19], v3 offset:2592
    s_waitcnt lgkmcnt(14)
    v_mfma_f32_16x16x32_bf16 v[64:67], v[136:139], v[20:23], v[64:67]
    v_mfma_f32_16x16x32_bf16 v[68:71], v[216:219], v[20:23], v[68:71]
    ds_read_b64_tr_b16 v[20:21], v3 offset:64
    ds_read_b64_tr_b16 v[22:23], v3 offset:2624
    s_waitcnt lgkmcnt(14)
    v_mfma_f32_16x16x32_bf16 v[72:75], v[136:139], v[24:27], v[72:75]
    v_mfma_f32_16x16x32_bf16 v[76:79], v[216:219], v[24:27], v[76:79]
    ds_read_b64_tr_b16 v[24:25], v3 offset:96
    ds_read_b64_tr_b16 v[26:27], v3 offset:2656
    s_waitcnt lgkmcnt(14)
    v_mfma_f32_16x16x32_bf16 v[80:83], v[136:139], v[28:31], v[80:83]
    v_mfma_f32_16x16x32_bf16 v[84:87], v[216:219], v[28:31], v[84:87]
    ds_read_b64_tr_b16 v[28:29], v3 offset:128
    ds_read_b64_tr_b16 v[30:31], v3 offset:2688
    s_waitcnt lgkmcnt(14)
    v_mfma_f32_16x16x32_bf16 v[48:51], v[140:143], v[32:35], v[48:51]
    v_mfma_f32_16x16x32_bf16 v[52:55], v[220:223], v[32:35], v[52:55]
    v_mfma_f32_16x16x32_bf16 v[56:59], v[32:35], v[32:35], v[56:59]
    v_mfma_f32_16x16x32_bf16 v[60:63], v[10:13], v[32:35], v[60:63]
    ds_read_b64_tr_b16 v[32:33], v3 offset:5152
    ds_read_b64_tr_b16 v[34:35], v3 offset:7712
    s_waitcnt lgkmcnt(14)
    v_mfma_f32_16x16x32_bf16 v[64:67], v[140:143], v[36:39], v[64:67]
    v_mfma_f32_16x16x32_bf16 v[68:71], v[220:223], v[36:39], v[68:71]
    ds_read_b64_tr_b16 v[36:37], v3 offset:5184
    ds_read_b64_tr_b16 v[38:39], v3 offset:7744
    s_waitcnt lgkmcnt(14)
    v_mfma_f32_16x16x32_bf16 v[72:75], v[140:143], v[40:43], v[72:75]
    v_mfma_f32_16x16x32_bf16 v[76:79], v[220:223], v[40:43], v[76:79]
    ds_read_b64_tr_b16 v[40:41], v3 offset:5216
    ds_read_b64_tr_b16 v[42:43], v3 offset:7776
    s_waitcnt lgkmcnt(14)
    v_mfma_f32_16x16x32_bf16 v[80:83], v[140:143], v[44:47], v[80:83]
    v_mfma_f32_16x16x32_bf16 v[84:87], v[220:223], v[44:47], v[84:87]
    ds_read_b64_tr_b16 v[44:45], v3 offset:5248
    ds_read_b64_tr_b16 v[46:47], v3 offset:7808
    s_waitcnt lgkmcnt(14)
    v_mfma_f32_16x16x32_bf16 v[48:51], v[144:147], v[16:19], v[48:51]
    v_mfma_f32_16x16x32_bf16 v[52:55], v[224:227], v[16:19], v[52:55]
    v_mfma_f32_16x16x32_bf16 v[56:59], v[16:19], v[16:19], v[56:59]
    v_mfma_f32_16x16x32_bf16 v[60:63], v[10:13], v[16:19], v[60:63]
    ds_read_b64_tr_b16 v[16:17], v3 offset:10272
    ds_read_b64_tr_b16 v[18:19], v3 offset:12832
    s_waitcnt lgkmcnt(14)
    v_mfma_f32_16x16x32_bf16 v[64:67], v[144:147], v[20:23], v[64:67]
    v_mfma_f32_16x16x32_bf16 v[68:71], v[224:227], v[20:23], v[68:71]
    ds_read_b64_tr_b16 v[20:21], v3 offset:10304
    ds_read_b64_tr_b16 v[22:23], v3 offset:12864
    s_waitcnt lgkmcnt(14)
    v_mfma_f32_16x16x32_bf16 v[72:75], v[144:147], v[24:27], v[72:75]
    v_mfma_f32_16x16x32_bf16 v[76:79], v[224:227], v[24:27], v[76:79]
    ds_read_b64_tr_b16 v[24:25], v3 offset:10336
    ds_read_b64_tr_b16 v[26:27], v3 offset:12896
    s_waitcnt lgkmcnt(14)
    v_mfma_f32_16x16x32_bf16 v[80:83], v[144:147], v[28:31], v[80:83]
    v_mfma_f32_16x16x32_bf16 v[84:87], v[224:227], v[28:31], v[84:87]
    ds_read_b64_tr_b16 v[28:29], v3 offset:10368
    ds_read_b64_tr_b16 v[30:31], v3 offset:12928
    s_waitcnt lgkmcnt(14)
    v_mfma_f32_16x16x32_bf16 v[48:51], v[148:151], v[32:35], v[48:51]
    v_mfma_f32_16x16x32_bf16 v[52:55], v[228:231], v[32:35], v[52:55]
    v_mfma_f32_16x16x32_bf16 v[56:59], v[32:35], v[32:35], v[56:59]
    v_mfma_f32_16x16x32_bf16 v[60:63], v[10:13], v[32:35], v[60:63]
    ds_read_b64_tr_b16 v[32:33], v3 offset:15392
    ds_read_b64_tr_b16 v[34:35], v3 offset:17952
    s_waitcnt lgkmcnt(14)
    v_mfma_f32_16x16x32_bf16 v[64:67], v[148:151], v[36:39], v[64:67]
    v_mfma_f32_16x16x32_bf16 v[68:71], v[228:231], v[36:39], v[68:71]
    ds_read_b64_tr_b16 v[36:37], v3 offset:15424
    ds_read_b64_tr_b16 v[38:39], v3 offset:17984
    s_waitcnt lgkmcnt(14)
    v_mfma_f32_16x16x32_bf16 v[72:75], v[148:151], v[40:43], v[72:75]
    v_mfma_f32_16x16x32_bf16 v[76:79], v[228:231], v[40:43], v[76:79]
    ds_read_b64_tr_b16 v[40:41], v3 offset:15456
    ds_read_b64_tr_b16 v[42:43], v3 offset:18016
    s_waitcnt lgkmcnt(14)
    v_mfma_f32_16x16x32_bf16 v[80:83], v[148:151], v[44:47], v[80:83]
    v_mfma_f32_16x16x32_bf16 v[84:87], v[228:231], v[44:47], v[84:87]
    ds_read_b64_tr_b16 v[44:45], v3 offset:15488
    ds_read_b64_tr_b16 v[46:47], v3 offset:18048
    s_waitcnt lgkmcnt(14)
    v_mfma_f32_16x16x32_bf16 v[48:51], v[152:155], v[16:19], v[48:51]
    v_mfma_f32_16x16x32_bf16 v[52:55], v[232:235], v[16:19], v[52:55]
    v_mfma_f32_16x16x32_bf16 v[56:59], v[16:19], v[16:19], v[56:59]
    v_mfma_f32_16x16x32_bf16 v[60:63], v[10:13], v[16:19], v[60:63]
    s_waitcnt vmcnt(0)
    s_barrier
    ds_read_b64_tr_b16 v[16:17], v3 offset:20512
    ds_read_b64_tr_b16 v[18:19], v3 offset:23072
    s_waitcnt lgkmcnt(14)
    v_mfma_f32_16x16x32_bf16 v[64:67], v[152:155], v[20:23], v[64:67]
    v_mfma_f32_16x16x32_bf16 v[68:71], v[232:235], v[20:23], v[68:71]
    ds_read_b64_tr_b16 v[20:21], v3 offset:20544
    ds_read_b64_tr_b16 v[22:23], v3 offset:23104
    s_waitcnt lgkmcnt(14)
    v_mfma_f32_16x16x32_bf16 v[72:75], v[152:155], v[24:27], v[72:75]
    v_mfma_f32_16x16x32_bf16 v[76:79], v[232:235], v[24:27], v[76:79]
    ds_read_b64_tr_b16 v[24:25], v3 offset:20576
    ds_read_b64_tr_b16 v[26:27], v3 offset:23136
    s_waitcnt lgkmcnt(14)
    v_mfma_f32_16x16x32_bf16 v[80:83], v[152:155], v[28:31], v[80:83]
    v_mfma_f32_16x16x32_bf16 v[84:87], v[232:235], v[28:31], v[84:87]
    ds_read_b64_tr_b16 v[28:29], v3 offset:20608
    ds_read_b64_tr_b16 v[30:31], v3 offset:23168
    s_waitcnt lgkmcnt(14)
    v_mfma_f32_16x16x32_bf16 v[48:51], v[156:159], v[32:35], v[48:51]
    v_mfma_f32_16x16x32_bf16 v[52:55], v[236:239], v[32:35], v[52:55]
    v_mfma_f32_16x16x32_bf16 v[56:59], v[32:35], v[32:35], v[56:59]
    v_mfma_f32_16x16x32_bf16 v[60:63], v[10:13], v[32:35], v[60:63]
    ds_read_b64_tr_b16 v[32:33], v3 offset:25632
    ds_read_b64_tr_b16 v[34:35], v3 offset:28192
    s_waitcnt lgkmcnt(14)
    v_mfma_f32_16x16x32_bf16 v[64:67], v[156:159], v[36:39], v[64:67]
    v_mfma_f32_16x16x32_bf16 v[68:71], v[236:239], v[36:39], v[68:71]
    ds_read_b64_tr_b16 v[36:37], v3 offset:25664
    ds_read_b64_tr_b16 v[38:39], v3 offset:28224
    s_waitcnt lgkmcnt(14)
    v_mfma_f32_16x16x32_bf16 v[72:75], v[156:159], v[40:43], v[72:75]
    v_mfma_f32_16x16x32_bf16 v[76:79], v[236:239], v[40:43], v[76:79]
    ds_read_b64_tr_b16 v[40:41], v3 offset:25696
    ds_read_b64_tr_b16 v[42:43], v3 offset:28256
    s_waitcnt lgkmcnt(14)
    v_mfma_f32_16x16x32_bf16 v[80:83], v[156:159], v[44:47], v[80:83]
    v_mfma_f32_16x16x32_bf16 v[84:87], v[236:239], v[44:47], v[84:87]
    ds_read_b64_tr_b16 v[44:45], v3 offset:25728
    ds_read_b64_tr_b16 v[46:47], v3 offset:28288
    s_waitcnt lgkmcnt(14)
    v_mfma_f32_16x16x32_bf16 v[48:51], v[160:163], v[16:19], v[48:51]
    v_mfma_f32_16x16x32_bf16 v[52:55], v[240:243], v[16:19], v[52:55]
    v_mfma_f32_16x16x32_bf16 v[56:59], v[16:19], v[16:19], v[56:59]
    v_mfma_f32_16x16x32_bf16 v[60:63], v[10:13], v[16:19], v[60:63]
    ds_read_b64_tr_b16 v[16:17], v3 offset:30752
    ds_read_b64_tr_b16 v[18:19], v3 offset:33312
    s_waitcnt lgkmcnt(14)
    v_mfma_f32_16x16x32_bf16 v[64:67], v[160:163], v[20:23], v[64:67]
    v_mfma_f32_16x16x32_bf16 v[68:71], v[240:243], v[20:23], v[68:71]
    ds_read_b64_tr_b16 v[20:21], v3 offset:30784
    ds_read_b64_tr_b16 v[22:23], v3 offset:33344
    s_waitcnt lgkmcnt(14)
    v_mfma_f32_16x16x32_bf16 v[72:75], v[160:163], v[24:27], v[72:75]
    v_mfma_f32_16x16x32_bf16 v[76:79], v[240:243], v[24:27], v[76:79]
    ds_read_b64_tr_b16 v[24:25], v3 offset:30816
    ds_read_b64_tr_b16 v[26:27], v3 offset:33376
    s_waitcnt lgkmcnt(14)
    v_mfma_f32_16x16x32_bf16 v[80:83], v[160:163], v[28:31], v[80:83]
    v_mfma_f32_16x16x32_bf16 v[84:87], v[240:243], v[28:31], v[84:87]
    ds_read_b64_tr_b16 v[28:29], v3 offset:30848
    ds_read_b64_tr_b16 v[30:31], v3 offset:33408
    s_waitcnt lgkmcnt(14)
    v_mfma_f32_16x16x32_bf16 v[48:51], v[164:167], v[32:35], v[48:51]
    v_mfma_f32_16x16x32_bf16 v[52:55], v[244:247], v[32:35], v[52:55]
    v_mfma_f32_16x16x32_bf16 v[56:59], v[32:35], v[32:35], v[56:59]
    v_mfma_f32_16x16x32_bf16 v[60:63], v[10:13], v[32:35], v[60:63]
    ds_read_b64_tr_b16 v[32:33], v3 offset:35872
    ds_read_b64_tr_b16 v[34:35], v3 offset:38432
    s_waitcnt lgkmcnt(14)
    v_mfma_f32_16x16x32_bf16 v[64:67], v[164:167], v[36:39], v[64:67]
    v_mfma_f32_16x16x32_bf16 v[68:71], v[244:247], v[36:39], v[68:71]
    ds_read_b64_tr_b16 v[36:37], v3 offset:35904
    ds_read_b64_tr_b16 v[38:39], v3 offset:38464
    s_waitcnt lgkmcnt(14)
    v_mfma_f32_16x16x32_bf16 v[72:75], v[164:167], v[40:43], v[72:75]
    v_mfma_f32_16x16x32_bf16 v[76:79], v[244:247], v[40:43], v[76:79]
    ds_read_b64_tr_b16 v[40:41], v3 offset:35936
    ds_read_b64_tr_b16 v[42:43], v3 offset:38496
    s_waitcnt lgkmcnt(14)
    v_mfma_f32_16x16x32_bf16 v[80:83], v[164:167], v[44:47], v[80:83]
    v_mfma_f32_16x16x32_bf16 v[84:87], v[244:247], v[44:47], v[84:87]
    ds_read_b64_tr_b16 v[44:45], v3 offset:35968
    ds_read_b64_tr_b16 v[46:47], v3 offset:38528
    s_waitcnt lgkmcnt(14)
    v_mfma_f32_16x16x32_bf16 v[48:51], v[168:171], v[16:19], v[48:51]
    v_mfma_f32_16x16x32_bf16 v[52:55], v[248:251], v[16:19], v[52:55]
    v_mfma_f32_16x16x32_bf16 v[56:59], v[16:19], v[16:19], v[56:59]
    v_mfma_f32_16x16x32_bf16 v[60:63], v[10:13], v[16:19], v[60:63]
    s_waitcnt lgkmcnt(12)
    v_mfma_f32_16x16x32_bf16 v[64:67], v[168:171], v[20:23], v[64:67]
    v_mfma_f32_16x16x32_bf16 v[68:71], v[248:251], v[20:23], v[68:71]
    s_waitcnt lgkmcnt(10)
    v_mfma_f32_16x16x32_bf16 v[72:75], v[168:171], v[24:27], v[72:75]
    v_mfma_f32_16x16x32_bf16 v[76:79], v[248:251], v[24:27], v[76:79]
    s_waitcnt lgkmcnt(8)
    v_mfma_f32_16x16x32_bf16 v[80:83], v[168:171], v[28:31], v[80:83]
    v_mfma_f32_16x16x32_bf16 v[84:87], v[248:251], v[28:31], v[84:87]
    s_waitcnt lgkmcnt(6)
    v_mfma_f32_16x16x32_bf16 v[48:51], v[172:175], v[32:35], v[48:51]
    v_mfma_f32_16x16x32_bf16 v[52:55], v[252:255], v[32:35], v[52:55]
    v_mfma_f32_16x16x32_bf16 v[56:59], v[32:35], v[32:35], v[56:59]
    v_mfma_f32_16x16x32_bf16 v[60:63], v[10:13], v[32:35], v[60:63]
    s_waitcnt lgkmcnt(4)
    v_mfma_f32_16x16x32_bf16 v[64:67], v[172:175], v[36:39], v[64:67]
    v_mfma_f32_16x16x32_bf16 v[68:71], v[252:255], v[36:39], v[68:71]
    s_waitcnt lgkmcnt(2)
    v_mfma_f32_16x16x32_bf16 v[72:75], v[172:175], v[40:43], v[72:75]
    v_mfma_f32_16x16x32_bf16 v[76:79], v[252:255], v[40:43], v[76:79]
    s_waitcnt lgkmcnt(0)
    v_mfma_f32_16x16x32_bf16 v[80:83], v[172:175], v[44:47], v[80:83]
    v_mfma_f32_16x16x32_bf16 v[84:87], v[252:255], v[44:47], v[84:87]
    ds_read_b64 v[10:11], v7
    ds_read_b64 v[12:13], v8
    ds_read_b64 v[14:15], v9
    v_and_b32 v16, 15, v1
    v_lshrrev_b32 v17, 4, v1
    v_and_b32 v18, 3, v1
    v_lshrrev_b32 v19, 2, v16
    v_cmp_eq_u32 s[42:43], 1, v18
    v_cmp_eq_u32 s[44:45], 2, v18
    v_cmp_eq_u32 s[46:47], 3, v18
    v_cmp_eq_u32 s[48:49], v19, v17
    v_lshlrev_b32 v18, 3, v16
    v_add_u32 v18, 45376, v18
    v_cndmask_b32 v56, v56, v57, s[42:43]
    v_cndmask_b32 v56, v56, v58, s[44:45]
    v_cndmask_b32 v56, v56, v59, s[46:47]
    v_mul_f32 v60, 0x3acccccd, v60
    v_mul_f32 v56, 0x3acccccd, v56
    v_fma_f32 v56, -v60, v60, v56
    v_max_f32 v56, 0, v56
    v_cvt_pk_bf16_f32 v60, v60, v56
    v_and_b32 v56, 0xffff0000, v60
    v_lshlrev_b32 v60, 16, v60
    v_add_f32 v56, 0x3727c5ac, v56
    v_cvt_pk_bf16_f32 v56, v56, v56
    v_lshlrev_b32 v56, 16, v56
    v_sqrt_f32 v56, v56
    s_nop 0
    v_cvt_pk_bf16_f32 v56, v56, v56
    v_lshlrev_b32 v56, 16, v56
    v_rcp_f32 v61, v56
    s_mov_b64 exec, s[48:49]
    ds_write_b64 v18, v[60:61] offset:128
    s_mov_b64 exec, -1
    s_lshl_b32 s42, s3, 7
    s_add_u32 s42, s42, 46016
    v_lshl_add_u32 v19, v17, 4, s42
    s_lshl_b32 s42, s3, 6
    s_cmp_eq_u32 s3, 2
    s_cselect_b32 s42, 192, s42
    s_cmp_eq_u32 s3, 3
    s_cselect_b32 s42, 128, s42
    s_add_u32 s42, s42, 61440
    v_mul_u32_u24 v20, 496, v16
    v_lshl_add_u32 v20, v17, 4, v20
    v_add_u32 v20, s42, v20
    v_lshlrev_b32 v18, 3, v16
    v_add_u32 v18, 45376, v18
    s_waitcnt lgkmcnt(0)
    s_barrier
    ds_read_b64 v[26:27], v18 offset:128
    ds_read_b64 v[28:29], v18 offset:256
    ds_read_b64 v[30:31], v18 offset:384
    ds_read_b64 v[32:33], v18 offset:512
    ds_read_b128 v[36:39], v19 offset:0
    ds_read_b128 v[40:43], v19 offset:64
    s_waitcnt lgkmcnt(0)
    v_fma_f32 v48, -v26, v36, v48
    v_fma_f32 v49, -v26, v37, v49
    v_fma_f32 v50, -v26, v38, v50
    v_fma_f32 v51, -v26, v39, v51
    v_fma_f32 v52, -v26, v40, v52
    v_fma_f32 v53, -v26, v41, v53
    v_fma_f32 v54, -v26, v42, v54
    v_fma_f32 v55, -v26, v43, v55
    v_fma_f32 v64, -v28, v36, v64
    v_fma_f32 v65, -v28, v37, v65
    v_fma_f32 v66, -v28, v38, v66
    v_fma_f32 v67, -v28, v39, v67
    v_fma_f32 v68, -v28, v40, v68
    v_fma_f32 v69, -v28, v41, v69
    v_fma_f32 v70, -v28, v42, v70
    v_fma_f32 v71, -v28, v43, v71
    v_fma_f32 v72, -v30, v36, v72
    v_fma_f32 v73, -v30, v37, v73
    v_fma_f32 v74, -v30, v38, v74
    v_fma_f32 v75, -v30, v39, v75
    v_fma_f32 v76, -v30, v40, v76
    v_fma_f32 v77, -v30, v41, v77
    v_fma_f32 v78, -v30, v42, v78
    v_fma_f32 v79, -v30, v43, v79
    v_fma_f32 v80, -v32, v36, v80
    v_fma_f32 v81, -v32, v37, v81
    v_fma_f32 v82, -v32, v38, v82
    v_fma_f32 v83, -v32, v39, v83
    v_fma_f32 v84, -v32, v40, v84
    v_fma_f32 v85, -v32, v41, v85
    v_fma_f32 v86, -v32, v42, v86
    v_fma_f32 v87, -v32, v43, v87
    v_mul_f32 v48, v48, v27
    v_mul_f32 v49, v49, v27
    v_mul_f32 v50, v50, v27
    v_mul_f32 v51, v51, v27
    v_mul_f32 v52, v52, v27
    v_mul_f32 v53, v53, v27
    v_mul_f32 v54, v54, v27
    v_mul_f32 v55, v55, v27
    v_mul_f32 v64, v64, v29
    v_mul_f32 v65, v65, v29
    v_mul_f32 v66, v66, v29
    v_mul_f32 v67, v67, v29
    v_mul_f32 v68, v68, v29
    v_mul_f32 v69, v69, v29
    v_mul_f32 v70, v70, v29
    v_mul_f32 v71, v71, v29
    v_mul_f32 v72, v72, v31
    v_mul_f32 v73, v73, v31
    v_mul_f32 v74, v74, v31
    v_mul_f32 v75, v75, v31
    v_mul_f32 v76, v76, v31
    v_mul_f32 v77, v77, v31
    v_mul_f32 v78, v78, v31
    v_mul_f32 v79, v79, v31
    v_mul_f32 v80, v80, v33
    v_mul_f32 v81, v81, v33
    v_mul_f32 v82, v82, v33
    v_mul_f32 v83, v83, v33
    v_mul_f32 v84, v84, v33
    v_mul_f32 v85, v85, v33
    v_mul_f32 v86, v86, v33
    v_mul_f32 v87, v87, v33
    v_cvt_pk_bf16_f32 v48, v48, v52
    v_cvt_pk_bf16_f32 v49, v49, v53
    v_cvt_pk_bf16_f32 v50, v50, v54
    v_cvt_pk_bf16_f32 v51, v51, v55
    ds_write_b128 v20, v[48:51] offset:7936
    v_cvt_pk_bf16_f32 v64, v64, v68
    v_cvt_pk_bf16_f32 v65, v65, v69
    v_cvt_pk_bf16_f32 v66, v66, v70
    v_cvt_pk_bf16_f32 v67, v67, v71
    ds_write_b128 v20, v[64:67] offset:15872
    v_cvt_pk_bf16_f32 v72, v72, v76
    v_cvt_pk_bf16_f32 v73, v73, v77
    v_cvt_pk_bf16_f32 v74, v74, v78
    v_cvt_pk_bf16_f32 v75, v75, v79
    ds_write_b128 v20, v[72:75] offset:23808
    v_cvt_pk_bf16_f32 v80, v80, v84
    v_cvt_pk_bf16_f32 v81, v81, v85
    v_cvt_pk_bf16_f32 v82, v82, v86
    v_cvt_pk_bf16_f32 v83, v83, v87
    ds_write_b128 v20, v[80:83] offset:31744
    s_branch L_a1_post
L_g2B:
    s_waitcnt vmcnt(2)
    s_barrier
    ds_read_b64_tr_b16 v[16:17], v2 offset:32
    ds_read_b64_tr_b16 v[18:19], v2 offset:2592
    ds_read_b64_tr_b16 v[20:21], v2 offset:64
    ds_read_b64_tr_b16 v[22:23], v2 offset:2624
    ds_read_b64_tr_b16 v[24:25], v2 offset:96
    ds_read_b64_tr_b16 v[26:27], v2 offset:2656
    ds_read_b64_tr_b16 v[28:29], v2 offset:128
    ds_read_b64_tr_b16 v[30:31], v2 offset:2688
    ds_read_b64_tr_b16 v[32:33], v2 offset:5152
    ds_read_b64_tr_b16 v[34:35], v2 offset:7712
    ds_read_b64_tr_b16 v[36:37], v2 offset:5184
    ds_read_b64_tr_b16 v[38:39], v2 offset:7744
    ds_read_b64_tr_b16 v[40:41], v2 offset:5216
    ds_read_b64_tr_b16 v[42:43], v2 offset:7776
    ds_read_b64_tr_b16 v[44:45], v2 offset:5248
    ds_read_b64_tr_b16 v[46:47], v2 offset:7808
    s_waitcnt lgkmcnt(14)
    v_mfma_f32_16x16x32_bf16 v[48:51], v[96:99], v[16:19], 0
    v_mfma_f32_16x16x32_bf16 v[52:55], v[176:179], v[16:19], 0
    s_add_u32 m0, s52, 94208
    s_nop 0
    global_load_lds_dwordx4 v15, s[50:51] sc1
    ds_read_b64_tr_b16 v[16:17], v2 offset:10272
    ds_read_b64_tr_b16 v[18:19], v2 offset:12832
    s_waitcnt lgkmcnt(14)
    v_mfma_f32_16x16x32_bf16 v[56:59], v[96:99], v[20:23], 0
    v_mfma_f32_16x16x32_bf16 v[60:63], v[176:179], v[20:23], 0
    v_mfma_f32_16x16x32_bf16 v[64:67], v[20:23], v[20:23], 0
    v_mfma_f32_16x16x32_bf16 v[68:71], v[10:13], v[20:23], 0
    ds_read_b64_tr_b16 v[20:21], v2 offset:10304
    ds_read_b64_tr_b16 v[22:23], v2 offset:12864
    s_waitcnt lgkmcnt(14)
    v_mfma_f32_16x16x32_bf16 v[72:75], v[96:99], v[24:27], 0
    v_mfma_f32_16x16x32_bf16 v[76:79], v[176:179], v[24:27], 0
    ds_read_b64_tr_b16 v[24:25], v2 offset:10336
    ds_read_b64_tr_b16 v[26:27], v2 offset:12896
    s_waitcnt lgkmcnt(14)
    v_mfma_f32_16x16x32_bf16 v[80:83], v[96:99], v[28:31], 0
    v_mfma_f32_16x16x32_bf16 v[84:87], v[176:179], v[28:31], 0
    ds_read_b64_tr_b16 v[28:29], v2 offset:10368
    ds_read_b64_tr_b16 v[30:31], v2 offset:12928
    s_waitcnt lgkmcnt(14)
    v_mfma_f32_16x16x32_bf16 v[48:51], v[100:103], v[32:35], v[48:51]
    v_mfma_f32_16x16x32_bf16 v[52:55], v[180:183], v[32:35], v[52:55]
    s_add_u32 m0, s52, 102400
    s_add_u32 s50, s50, 1048576
    s_addc_u32 s51, s51, 0
    global_load_lds_dwordx4 v4, s[50:51] sc1
    s_waitcnt vmcnt(2)
    s_barrier
    ds_read_b64_tr_b16 v[32:33], v2 offset:15392
    ds_read_b64_tr_b16 v[34:35], v2 offset:17952
    s_waitcnt lgkmcnt(14)
    v_mfma_f32_16x16x32_bf16 v[56:59], v[100:103], v[36:39], v[56:59]
    v_mfma_f32_16x16x32_bf16 v[60:63], v[180:183], v[36:39], v[60:63]
    v_mfma_f32_16x16x32_bf16 v[64:67], v[36:39], v[36:39], v[64:67]
    v_mfma_f32_16x16x32_bf16 v[68:71], v[10:13], v[36:39], v[68:71]
    ds_read_b64_tr_b16 v[36:37], v2 offset:15424
    ds_read_b64_tr_b16 v[38:39], v2 offset:17984
    s_waitcnt lgkmcnt(14)
    v_mfma_f32_16x16x32_bf16 v[72:75], v[100:103], v[40:43], v[72:75]
    v_mfma_f32_16x16x32_bf16 v[76:79], v[180:183], v[40:43], v[76:79]
    ds_read_b64_tr_b16 v[40:41], v2 offset:15456
    ds_read_b64_tr_b16 v[42:43], v2 offset:18016
    s_waitcnt lgkmcnt(14)
    v_mfma_f32_16x16x32_bf16 v[80:83], v[100:103], v[44:47], v[80:83]
    v_mfma_f32_16x16x32_bf16 v[84:87], v[180:183], v[44:47], v[84:87]
    ds_read_b64_tr_b16 v[44:45], v2 offset:15488
    ds_read_b64_tr_b16 v[46:47], v2 offset:18048
    s_waitcnt lgkmcnt(14)
    v_mfma_f32_16x16x32_bf16 v[48:51], v[104:107], v[16:19], v[48:51]
    v_mfma_f32_16x16x32_bf16 v[52:55], v[184:187], v[16:19], v[52:55]
    s_add_u32 m0, s52, 110592
    s_nop 0
    global_load_lds_dwordx4 v5, s[50:51] sc1
    ds_read_b64_tr_b16 v[16:17], v2 offset:20512
    ds_read_b64_tr_b16 v[18:19], v2 offset:23072
    s_waitcnt lgkmcnt(14)
    v_mfma_f32_16x16x32_bf16 v[56:59], v[104:107], v[20:23], v[56:59]
    v_mfma_f32_16x16x32_bf16 v[60:63], v[184:187], v[20:23], v[60:63]
    v_mfma_f32_16x16x32_bf16 v[64:67], v[20:23], v[20:23], v[64:67]
    v_mfma_f32_16x16x32_bf16 v[68:71], v[10:13], v[20:23], v[68:71]
    ds_read_b64_tr_b16 v[20:21], v2 offset:20544
    ds_read_b64_tr_b16 v[22:23], v2 offset:23104
    s_waitcnt lgkmcnt(14)
    v_mfma_f32_16x16x32_bf16 v[72:75], v[104:107], v[24:27], v[72:75]
    v_mfma_f32_16x16x32_bf16 v[76:79], v[184:187], v[24:27], v[76:79]
    ds_read_b64_tr_b16 v[24:25], v2 offset:20576
    ds_read_b64_tr_b16 v[26:27], v2 offset:23136
    s_waitcnt lgkmcnt(14)
    v_mfma_f32_16x16x32_bf16 v[80:83], v[104:107], v[28:31], v[80:83]
    v_mfma_f32_16x16x32_bf16 v[84:87], v[184:187], v[28:31], v[84:87]
    ds_read_b64_tr_b16 v[28:29], v2 offset:20608
    ds_read_b64_tr_b16 v[30:31], v2 offset:23168
    s_waitcnt lgkmcnt(14)
    v_mfma_f32_16x16x32_bf16 v[48:51], v[108:111], v[32:35], v[48:51]
    v_mfma_f32_16x16x32_bf16 v[52:55], v[188:191], v[32:35], v[52:55]
    s_add_u32 m0, s52, 118784
    s_nop 0
    global_load_lds_dwordx4 v6, s[50:51] sc1
    ds_read_b64_tr_b16 v[32:33], v2 offset:25632
    ds_read_b64_tr_b16 v[34:35], v2 offset:28192
    s_waitcnt lgkmcnt(14)
    v_mfma_f32_16x16x32_bf16 v[56:59], v[108:111], v[36:39], v[56:59]
    v_mfma_f32_16x16x32_bf16 v[60:63], v[188:191], v[36:39], v[60:63]
    v_mfma_f32_16x16x32_bf16 v[64:67], v[36:39], v[36:39], v[64:67]
    v_mfma_f32_16x16x32_bf16 v[68:71], v[10:13], v[36:39], v[68:71]
    ds_read_b64_tr_b16 v[36:37], v2 offset:25664
    ds_read_b64_tr_b16 v[38:39], v2 offset:28224
    s_waitcnt lgkmcnt(14)
    v_mfma_f32_16x16x32_bf16 v[72:75], v[108:111], v[40:43], v[72:75]
    v_mfma_f32_16x16x32_bf16 v[76:79], v[188:191], v[40:43], v[76:79]
    ds_read_b64_tr_b16 v[40:41], v2 offset:25696
    ds_read_b64_tr_b16 v[42:43], v2 offset:28256
    s_waitcnt lgkmcnt(14)
    v_mfma_f32_16x16x32_bf16 v[80:83], v[108:111], v[44:47], v[80:83]
    v_mfma_f32_16x16x32_bf16 v[84:87], v[188:191], v[44:47], v[84:87]
    ds_read_b64_tr_b16 v[44:45], v2 offset:25728
    ds_read_b64_tr_b16 v[46:47], v2 offset:28288
    s_waitcnt lgkmcnt(14)
    v_mfma_f32_16x16x32_bf16 v[48:51], v[112:115], v[16:19], v[48:51]
    v_mfma_f32_16x16x32_bf16 v[52:55], v[192:195], v[16:19], v[52:55]
    s_add_u32 m0, s52, 126976
    s_nop 0
    global_load_lds_dwordx4 v14, s[50:51] sc1
    s_waitcnt vmcnt(2)
    s_barrier
    ds_read_b64_tr_b16 v[16:17], v2 offset:30752
    ds_read_b64_tr_b16 v[18:19], v2 offset:33312
    s_waitcnt lgkmcnt(14)
    v_mfma_f32_16x16x32_bf16 v[56:59], v[112:115], v[20:23], v[56:59]
    v_mfma_f32_16x16x32_bf16 v[60:63], v[192:195], v[20:23], v[60:63]
    v_mfma_f32_16x16x32_bf16 v[64:67], v[20:23], v[20:23], v[64:67]
    v_mfma_f32_16x16x32_bf16 v[68:71], v[10:13], v[20:23], v[68:71]
    ds_read_b64_tr_b16 v[20:21], v2 offset:30784
    ds_read_b64_tr_b16 v[22:23], v2 offset:33344
    s_waitcnt lgkmcnt(14)
    v_mfma_f32_16x16x32_bf16 v[72:75], v[112:115], v[24:27], v[72:75]
    v_mfma_f32_16x16x32_bf16 v[76:79], v[192:195], v[24:27], v[76:79]
    ds_read_b64_tr_b16 v[24:25], v2 offset:30816
    ds_read_b64_tr_b16 v[26:27], v2 offset:33376
    s_waitcnt lgkmcnt(14)
    v_mfma_f32_16x16x32_bf16 v[80:83], v[112:115], v[28:31], v[80:83]
    v_mfma_f32_16x16x32_bf16 v[84:87], v[192:195], v[28:31], v[84:87]
    ds_read_b64_tr_b16 v[28:29], v2 offset:30848
    ds_read_b64_tr_b16 v[30:31], v2 offset:33408
    s_waitcnt lgkmcnt(14)
    v_mfma_f32_16x16x32_bf16 v[48:51], v[116:119], v[32:35], v[48:51]
    v_mfma_f32_16x16x32_bf16 v[52:55], v[196:199], v[32:35], v[52:55]
    s_add_u32 m0, s52, 135168
    s_nop 0
    global_load_lds_dwordx4 v15, s[50:51] sc1
    ds_read_b64_tr_b16 v[32:33], v2 offset:35872
    ds_read_b64_tr_b16 v[34:35], v2 offset:38432
    s_waitcnt lgkmcnt(14)
    v_mfma_f32_16x16x32_bf16 v[56:59], v[116:119], v[36:39], v[56:59]
    v_mfma_f32_16x16x32_bf16 v[60:63], v[196:199], v[36:39], v[60:63]
    v_mfma_f32_16x16x32_bf16 v[64:67], v[36:39], v[36:39], v[64:67]
    v_mfma_f32_16x16x32_bf16 v[68:71], v[10:13], v[36:39], v[68:71]
    ds_read_b64_tr_b16 v[36:37], v2 offset:35904
    ds_read_b64_tr_b16 v[38:39], v2 offset:38464
    s_waitcnt lgkmcnt(14)
    v_mfma_f32_16x16x32_bf16 v[72:75], v[116:119], v[40:43], v[72:75]
    v_mfma_f32_16x16x32_bf16 v[76:79], v[196:199], v[40:43], v[76:79]
    ds_read_b64_tr_b16 v[40:41], v2 offset:35936
    ds_read_b64_tr_b16 v[42:43], v2 offset:38496
    s_waitcnt lgkmcnt(14)
    v_mfma_f32_16x16x32_bf16 v[80:83], v[116:119], v[44:47], v[80:83]
    v_mfma_f32_16x16x32_bf16 v[84:87], v[196:199], v[44:47], v[84:87]
    ds_read_b64_tr_b16 v[44:45], v2 offset:35968
    ds_read_b64_tr_b16 v[46:47], v2 offset:38528
    s_waitcnt lgkmcnt(14)
    v_mfma_f32_16x16x32_bf16 v[48:51], v[120:123], v[16:19], v[48:51]
    v_mfma_f32_16x16x32_bf16 v[52:55], v[200:203], v[16:19], v[52:55]
    s_add_u32 m0, s52, 143360
    s_add_u32 s50, s50, 1048576
    s_addc_u32 s51, s51, 0
    global_load_lds_dwordx4 v4, s[50:51] sc1
    ds_read_b64_tr_b16 v[16:17], v2 offset:40992
    ds_read_b64_tr_b16 v[18:19], v2 offset:43552
    s_waitcnt lgkmcnt(14)
    v_mfma_f32_16x16x32_bf16 v[56:59], v[120:123], v[20:23], v[56:59]
    v_mfma_f32_16x16x32_bf16 v[60:63], v[200:203], v[20:23], v[60:63]
    v_mfma_f32_16x16x32_bf16 v[64:67], v[20:23], v[20:23], v[64:67]
    v_mfma_f32_16x16x32_bf16 v[68:71], v[10:13], v[20:23], v[68:71]
    ds_read_b64_tr_b16 v[20:21], v2 offset:41024
    ds_read_b64_tr_b16 v[22:23], v2 offset:43584
    s_waitcnt lgkmcnt(14)
    v_mfma_f32_16x16x32_bf16 v[72:75], v[120:123], v[24:27], v[72:75]
    v_mfma_f32_16x16x32_bf16 v[76:79], v[200:203], v[24:27], v[76:79]
    ds_read_b64_tr_b16 v[24:25], v2 offset:41056
    ds_read_b64_tr_b16 v[26:27], v2 offset:43616
    s_waitcnt lgkmcnt(14)
    v_mfma_f32_16x16x32_bf16 v[80:83], v[120:123], v[28:31], v[80:83]
    v_mfma_f32_16x16x32_bf16 v[84:87], v[200:203], v[28:31], v[84:87]
    ds_read_b64_tr_b16 v[28:29], v2 offset:41088
    ds_read_b64_tr_b16 v[30:31], v2 offset:43648
    s_waitcnt lgkmcnt(14)
    v_mfma_f32_16x16x32_bf16 v[48:51], v[124:127], v[32:35], v[48:51]
    v_mfma_f32_16x16x32_bf16 v[52:55], v[204:207], v[32:35], v[52:55]
    s_add_u32 m0, s52, 151552
    s_nop 0
    global_load_lds_dwordx4 v5, s[50:51] sc1
    ds_read_b64_tr_b16 v[32:33], v2 offset:46112
    ds_read_b64_tr_b16 v[34:35], v2 offset:48672
    s_waitcnt lgkmcnt(14)
    v_mfma_f32_16x16x32_bf16 v[56:59], v[124:127], v[36:39], v[56:59]
    v_mfma_f32_16x16x32_bf16 v[60:63], v[204:207], v[36:39], v[60:63]
    v_mfma_f32_16x16x32_bf16 v[64:67], v[36:39], v[36:39], v[64:67]
    v_mfma_f32_16x16x32_bf16 v[68:71], v[10:13], v[36:39], v[68:71]
    ds_read_b64_tr_b16 v[36:37], v2 offset:46144
    ds_read_b64_tr_b16 v[38:39], v2 offset:48704
    s_waitcnt lgkmcnt(14)
    v_mfma_f32_16x16x32_bf16 v[72:75], v[124:127], v[40:43], v[72:75]
    v_mfma_f32_16x16x32_bf16 v[76:79], v[204:207], v[40:43], v[76:79]
    ds_read_b64_tr_b16 v[40:41], v2 offset:46176
    ds_read_b64_tr_b16 v[42:43], v2 offset:48736
    s_waitcnt lgkmcnt(14)
    v_mfma_f32_16x16x32_bf16 v[80:83], v[124:127], v[44:47], v[80:83]
    v_mfma_f32_16x16x32_bf16 v[84:87], v[204:207], v[44:47], v[84:87]
    ds_read_b64_tr_b16 v[44:45], v2 offset:46208
    ds_read_b64_tr_b16 v[46:47], v2 offset:48768
    s_waitcnt lgkmcnt(14)
    v_mfma_f32_16x16x32_bf16 v[48:51], v[128:131], v[16:19], v[48:51]
    v_mfma_f32_16x16x32_bf16 v[52:55], v[208:211], v[16:19], v[52:55]
    s_cmp_ge_u32 s3, 4
    s_nop 5
    s_cbranch_scc1 L_r1216
    s_add_u32 m0, s52, 159744
    s_nop 0
    global_load_lds_dwordx4 v6, s[50:51] sc1
L_r1216:
    ds_read_b64_tr_b16 v[16:17], v2 offset:51232
    ds_read_b64_tr_b16 v[18:19], v2 offset:53792
    s_waitcnt lgkmcnt(14)
    v_mfma_f32_16x16x32_bf16 v[56:59], v[128:131], v[20:23], v[56:59]
    v_mfma_f32_16x16x32_bf16 v[60:63], v[208:211], v[20:23], v[60:63]
    v_mfma_f32_16x16x32_bf16 v[64:67], v[20:23], v[20:23], v[64:67]
    v_mfma_f32_16x16x32_bf16 v[68:71], v[10:13], v[20:23], v[68:71]
    ds_read_b64_tr_b16 v[20:21], v2 offset:51264
    ds_read_b64_tr_b16 v[22:23], v2 offset:53824
    s_waitcnt lgkmcnt(14)
    v_mfma_f32_16x16x32_bf16 v[72:75], v[128:131], v[24:27], v[72:75]
    v_mfma_f32_16x16x32_bf16 v[76:79], v[208:211], v[24:27], v[76:79]
    ds_read_b64_tr_b16 v[24:25], v2 offset:51296
    ds_read_b64_tr_b16 v[26:27], v2 offset:53856
    s_waitcnt lgkmcnt(14)
    v_mfma_f32_16x16x32_bf16 v[80:83], v[128:131], v[28:31], v[80:83]
    v_mfma_f32_16x16x32_bf16 v[84:87], v[208:211], v[28:31], v[84:87]
    ds_read_b64_tr_b16 v[28:29], v2 offset:51328
    ds_read_b64_tr_b16 v[30:31], v2 offset:53888
    s_waitcnt lgkmcnt(14)
    v_mfma_f32_16x16x32_bf16 v[48:51], v[132:135], v[32:35], v[48:51]
    v_mfma_f32_16x16x32_bf16 v[52:55], v[212:215], v[32:35], v[52:55]
    s_waitcnt vmcnt(2)
    s_barrier
    ds_read_b64_tr_b16 v[32:33], v2 offset:56352
    ds_read_b64_tr_b16 v[34:35], v2 offset:58912
    s_waitcnt lgkmcnt(14)
    v_mfma_f32_16x16x32_bf16 v[56:59], v[132:135], v[36:39], v[56:59]
    v_mfma_f32_16x16x32_bf16 v[60:63], v[212:215], v[36:39], v[60:63]
    v_mfma_f32_16x16x32_bf16 v[64:67], v[36:39], v[36:39], v[64:67]
    v_mfma_f32_16x16x32_bf16 v[68:71], v[10:13], v[36:39], v[68:71]
    ds_read_b64_tr_b16 v[36:37], v2 offset:56384
    ds_read_b64_tr_b16 v[38:39], v2 offset:58944
    s_waitcnt lgkmcnt(14)
    v_mfma_f32_16x16x32_bf16 v[72:75], v[132:135], v[40:43], v[72:75]
    v_mfma_f32_16x16x32_bf16 v[76:79], v[212:215], v[40:43], v[76:79]
    ds_read_b64_tr_b16 v[40:41], v2 offset:56416
    ds_read_b64_tr_b16 v[42:43], v2 offset:58976
    s_waitcnt lgkmcnt(14)
    v_mfma_f32_16x16x32_bf16 v[80:83], v[132:135], v[44:47], v[80:83]
    v_mfma_f32_16x16x32_bf16 v[84:87], v[212:215], v[44:47], v[84:87]
    ds_read_b64_tr_b16 v[44:45], v2 offset:56448
    ds_read_b64_tr_b16 v[46:47], v2 offset:59008
    s_waitcnt lgkmcnt(14)
    v_mfma_f32_16x16x32_bf16 v[48:51], v[136:139], v[16:19], v[48:51]
    v_mfma_f32_16x16x32_bf16 v[52:55], v[216:219], v[16:19], v[52:55]
    ds_read_b64_tr_b16 v[16:17], v3 offset:32
    ds_read_b64_tr_b16 v[18:19], v3 offset:2592
    s_waitcnt lgkmcnt(14)
    v_mfma_f32_16x16x32_bf16 v[56:59], v[136:139], v[20:23], v[56:59]
    v_mfma_f32_16x16x32_bf16 v[60:63], v[216:219], v[20:23], v[60:63]
    v_mfma_f32_16x16x32_bf16 v[64:67], v[20:23], v[20:23], v[64:67]
    v_mfma_f32_16x16x32_bf16 v[68:71], v[10:13], v[20:23], v[68:71]
    ds_read_b64_tr_b16 v[20:21], v3 offset:64
    ds_read_b64_tr_b16 v[22:23], v3 offset:2624
    s_waitcnt lgkmcnt(14)
    v_mfma_f32_16x16x32_bf16 v[72:75], v[136:139], v[24:27], v[72:75]
    v_mfma_f32_16x16x32_bf16 v[76:79], v[216:219], v[24:27], v[76:79]
    ds_read_b64_tr_b16 v[24:25], v3 offset:96
    ds_read_b64_tr_b16 v[26:27], v3 offset:2656
    s_waitcnt lgkmcnt(14)
    v_mfma_f32_16x16x32_bf16 v[80:83], v[136:139], v[28:31], v[80:83]
    v_mfma_f32_16x16x32_bf16 v[84:87], v[216:219], v[28:31], v[84:87]
    ds_read_b64_tr_b16 v[28:29], v3 offset:128
    ds_read_b64_tr_b16 v[30:31], v3 offset:2688
    s_waitcnt lgkmcnt(14)
    v_mfma_f32_16x16x32_bf16 v[48:51], v[140:143], v[32:35], v[48:51]
    v_mfma_f32_16x16x32_bf16 v[52:55], v[220:223], v[32:35], v[52:55]
    ds_read_b64_tr_b16 v[32:33], v3 offset:5152
    ds_read_b64_tr_b16 v[34:35], v3 offset:7712
    s_waitcnt lgkmcnt(14)
    v_mfma_f32_16x16x32_bf16 v[56:59], v[140:143], v[36:39], v[56:59]
    v_mfma_f32_16x16x32_bf16 v[60:63], v[220:223], v[36:39], v[60:63]
    v_mfma_f32_16x16x32_bf16 v[64:67], v[36:39], v[36:39], v[64:67]
    v_mfma_f32_16x16x32_bf16 v[68:71], v[10:13], v[36:39], v[68:71]
    ds_read_b64_tr_b16 v[36:37], v3 offset:5184
    ds_read_b64_tr_b16 v[38:39], v3 offset:7744
    s_waitcnt lgkmcnt(14)
    v_mfma_f32_16x16x32_bf16 v[72:75], v[140:143], v[40:43], v[72:75]
    v_mfma_f32_16x16x32_bf16 v[76:79], v[220:223], v[40:43], v[76:79]
    ds_read_b64_tr_b16 v[40:41], v3 offset:5216
    ds_read_b64_tr_b16 v[42:43], v3 offset:7776
    s_waitcnt lgkmcnt(14)
    v_mfma_f32_16x16x32_bf16 v[80:83], v[140:143], v[44:47], v[80:83]
    v_mfma_f32_16x16x32_bf16 v[84:87], v[220:223], v[44:47], v[84:87]
    ds_read_b64_tr_b16 v[44:45], v3 offset:5248
    ds_read_b64_tr_b16 v[46:47], v3 offset:7808
    s_waitcnt lgkmcnt(14)
    v_mfma_f32_16x16x32_bf16 v[48:51], v[144:147], v[16:19], v[48:51]
    v_mfma_f32_16x16x32_bf16 v[52:55], v[224:227], v[16:19], v[52:55]
    ds_read_b64_tr_b16 v[16:17], v3 offset:10272
    ds_read_b64_tr_b16 v[18:19], v3 offset:12832
    s_waitcnt lgkmcnt(14)
    v_mfma_f32_16x16x32_bf16 v[56:59], v[144:147], v[20:23], v[56:59]
    v_mfma_f32_16x16x32_bf16 v[60:63], v[224:227], v[20:23], v[60:63]
    v_mfma_f32_16x16x32_bf16 v[64:67], v[20:23], v[20:23], v[64:67]
    v_mfma_f32_16x16x32_bf16 v[68:71], v[10:13], v[20:23], v[68:71]
    ds_read_b64_tr_b16 v[20:21], v3 offset:10304
    ds_read_b64_tr_b16 v[22:23], v3 offset:12864
    s_waitcnt lgkmcnt(14)
    v_mfma_f32_16x16x32_bf16 v[72:75], v[144:147], v[24:27], v[72:75]
    v_mfma_f32_16x16x32_bf16 v[76:79], v[224:227], v[24:27], v[76:79]
    ds_read_b64_tr_b16 v[24:25], v3 offset:10336
    ds_read_b64_tr_b16 v[26:27], v3 offset:12896
    s_waitcnt lgkmcnt(14)
    v_mfma_f32_16x16x32_bf16 v[80:83], v[144:147], v[28:31], v[80:83]
    v_mfma_f32_16x16x32_bf16 v[84:87], v[224:227], v[28:31], v[84:87]
    ds_read_b64_tr_b16 v[28:29], v3 offset:10368
    ds_read_b64_tr_b16 v[30:31], v3 offset:12928
    s_waitcnt lgkmcnt(14)
    v_mfma_f32_16x16x32_bf16 v[48:51], v[148:151], v[32:35], v[48:51]
    v_mfma_f32_16x16x32_bf16 v[52:55], v[228:231], v[32:35], v[52:55]
    ds_read_b64_tr_b16 v[32:33], v3 offset:15392
    ds_read_b64_tr_b16 v[34:35], v3 offset:17952
    s_waitcnt lgkmcnt(14)
    v_mfma_f32_16x16x32_bf16 v[56:59], v[148:151], v[36:39], v[56:59]
    v_mfma_f32_16x16x32_bf16 v[60:63], v[228:231], v[36:39], v[60:63]
    v_mfma_f32_16x16x32_bf16 v[64:67], v[36:39], v[36:39], v[64:67]
    v_mfma_f32_16x16x32_bf16 v[68:71], v[10:13], v[36:39], v[68:71]
    ds_read_b64_tr_b16 v[36:37], v3 offset:15424
    ds_read_b64_tr_b16 v[38:39], v3 offset:17984
    s_waitcnt lgkmcnt(14)
    v_mfma_f32_16x16x32_bf16 v[72:75], v[148:151], v[40:43], v[72:75]
    v_mfma_f32_16x16x32_bf16 v[76:79], v[228:231], v[40:43], v[76:79]
    ds_read_b64_tr_b16 v[40:41], v3 offset:15456
    ds_read_b64_tr_b16 v[42:43], v3 offset:18016
    s_waitcnt lgkmcnt(14)
    v_mfma_f32_16x16x32_bf16 v[80:83], v[148:151], v[44:47], v[80:83]
    v_mfma_f32_16x16x32_bf16 v[84:87], v[228:231], v[44:47], v[84:87]
    ds_read_b64_tr_b16 v[44:45], v3 offset:15488
    ds_read_b64_tr_b16 v[46:47], v3 offset:18048
    s_waitcnt lgkmcnt(14)
    v_mfma_f32_16x16x32_bf16 v[48:51], v[152:155], v[16:19], v[48:51]
    v_mfma_f32_16x16x32_bf16 v[52:55], v[232:235], v[16:19], v[52:55]
    s_waitcnt vmcnt(0)
    s_barrier
    ds_read_b64_tr_b16 v[16:17], v3 offset:20512
    ds_read_b64_tr_b16 v[18:19], v3 offset:23072
    s_waitcnt lgkmcnt(14)
    v_mfma_f32_16x16x32_bf16 v[56:59], v[152:155], v[20:23], v[56:59]
    v_mfma_f32_16x16x32_bf16 v[60:63], v[232:235], v[20:23], v[60:63]
    v_mfma_f32_16x16x32_bf16 v[64:67], v[20:23], v[20:23], v[64:67]
    v_mfma_f32_16x16x32_bf16 v[68:71], v[10:13], v[20:23], v[68:71]
    ds_read_b64_tr_b16 v[20:21], v3 offset:20544
    ds_read_b64_tr_b16 v[22:23], v3 offset:23104
    s_waitcnt lgkmcnt(14)
    v_mfma_f32_16x16x32_bf16 v[72:75], v[152:155], v[24:27], v[72:75]
    v_mfma_f32_16x16x32_bf16 v[76:79], v[232:235], v[24:27], v[76:79]
    ds_read_b64_tr_b16 v[24:25], v3 offset:20576
    ds_read_b64_tr_b16 v[26:27], v3 offset:23136
    s_waitcnt lgkmcnt(14)
    v_mfma_f32_16x16x32_bf16 v[80:83], v[152:155], v[28:31], v[80:83]
    v_mfma_f32_16x16x32_bf16 v[84:87], v[232:235], v[28:31], v[84:87]
    ds_read_b64_tr_b16 v[28:29], v3 offset:20608
    ds_read_b64_tr_b16 v[30:31], v3 offset:23168
    s_waitcnt lgkmcnt(14)
    v_mfma_f32_16x16x32_bf16 v[48:51], v[156:159], v[32:35], v[48:51]
    v_mfma_f32_16x16x32_bf16 v[52:55], v[236:239], v[32:35], v[52:55]
    ds_read_b64_tr_b16 v[32:33], v3 offset:25632
    ds_read_b64_tr_b16 v[34:35], v3 offset:28192
    s_waitcnt lgkmcnt(14)
    v_mfma_f32_16x16x32_bf16 v[56:59], v[156:159], v[36:39], v[56:59]
    v_mfma_f32_16x16x32_bf16 v[60:63], v[236:239], v[36:39], v[60:63]
    v_mfma_f32_16x16x32_bf16 v[64:67], v[36:39], v[36:39], v[64:67]
    v_mfma_f32_16x16x32_bf16 v[68:71], v[10:13], v[36:39], v[68:71]
    ds_read_b64_tr_b16 v[36:37], v3 offset:25664
    ds_read_b64_tr_b16 v[38:39], v3 offset:28224
    s_waitcnt lgkmcnt(14)
    v_mfma_f32_16x16x32_bf16 v[72:75], v[156:159], v[40:43], v[72:75]
    v_mfma_f32_16x16x32_bf16 v[76:79], v[236:239], v[40:43], v[76:79]
    ds_read_b64_tr_b16 v[40:41], v3 offset:25696
    ds_read_b64_tr_b16 v[42:43], v3 offset:28256
    s_waitcnt lgkmcnt(14)
    v_mfma_f32_16x16x32_bf16 v[80:83], v[156:159], v[44:47], v[80:83]
    v_mfma_f32_16x16x32_bf16 v[84:87], v[236:239], v[44:47], v[84:87]
    ds_read_b64_tr_b16 v[44:45], v3 offset:25728
    ds_read_b64_tr_b16 v[46:47], v3 offset:28288
    s_waitcnt lgkmcnt(14)
    v_mfma_f32_16x16x32_bf16 v[48:51], v[160:163], v[16:19], v[48:51]
    v_mfma_f32_16x16x32_bf16 v[52:55], v[240:243], v[16:19], v[52:55]
    ds_read_b64_tr_b16 v[16:17], v3 offset:30752
    ds_read_b64_tr_b16 v[18:19], v3 offset:33312
    s_waitcnt lgkmcnt(14)
    v_mfma_f32_16x16x32_bf16 v[56:59], v[160:163], v[20:23], v[56:59]
    v_mfma_f32_16x16x32_bf16 v[60:63], v[240:243], v[20:23], v[60:63]
    v_mfma_f32_16x16x32_bf16 v[64:67], v[20:23], v[20:23], v[64:67]
    v_mfma_f32_16x16x32_bf16 v[68:71], v[10:13], v[20:23], v[68:71]
    ds_read_b64_tr_b16 v[20:21], v3 offset:30784
    ds_read_b64_tr_b16 v[22:23], v3 offset:33344
    s_waitcnt lgkmcnt(14)
    v_mfma_f32_16x16x32_bf16 v[72:75], v[160:163], v[24:27], v[72:75]
    v_mfma_f32_16x16x32_bf16 v[76:79], v[240:243], v[24:27], v[76:79]
    ds_read_b64_tr_b16 v[24:25], v3 offset:30816
    ds_read_b64_tr_b16 v[26:27], v3 offset:33376
    s_waitcnt lgkmcnt(14)
    v_mfma_f32_16x16x32_bf16 v[80:83], v[160:163], v[28:31], v[80:83]
    v_mfma_f32_16x16x32_bf16 v[84:87], v[240:243], v[28:31], v[84:87]
    ds_read_b64_tr_b16 v[28:29], v3 offset:30848
    ds_read_b64_tr_b16 v[30:31], v3 offset:33408
    s_waitcnt lgkmcnt(14)
    v_mfma_f32_16x16x32_bf16 v[48:51], v[164:167], v[32:35], v[48:51]
    v_mfma_f32_16x16x32_bf16 v[52:55], v[244:247], v[32:35], v[52:55]
    ds_read_b64_tr_b16 v[32:33], v3 offset:35872
    ds_read_b64_tr_b16 v[34:35], v3 offset:38432
    s_waitcnt lgkmcnt(14)
    v_mfma_f32_16x16x32_bf16 v[56:59], v[164:167], v[36:39], v[56:59]
    v_mfma_f32_16x16x32_bf16 v[60:63], v[244:247], v[36:39], v[60:63]
    v_mfma_f32_16x16x32_bf16 v[64:67], v[36:39], v[36:39], v[64:67]
    v_mfma_f32_16x16x32_bf16 v[68:71], v[10:13], v[36:39], v[68:71]
    ds_read_b64_tr_b16 v[36:37], v3 offset:35904
    ds_read_b64_tr_b16 v[38:39], v3 offset:38464
    s_waitcnt lgkmcnt(14)
    v_mfma_f32_16x16x32_bf16 v[72:75], v[164:167], v[40:43], v[72:75]
    v_mfma_f32_16x16x32_bf16 v[76:79], v[244:247], v[40:43], v[76:79]
    ds_read_b64_tr_b16 v[40:41], v3 offset:35936
    ds_read_b64_tr_b16 v[42:43], v3 offset:38496
    s_waitcnt lgkmcnt(14)
    v_mfma_f32_16x16x32_bf16 v[80:83], v[164:167], v[44:47], v[80:83]
    v_mfma_f32_16x16x32_bf16 v[84:87], v[244:247], v[44:47], v[84:87]
    ds_read_b64_tr_b16 v[44:45], v3 offset:35968
    ds_read_b64_tr_b16 v[46:47], v3 offset:38528
    s_waitcnt lgkmcnt(14)
    v_mfma_f32_16x16x32_bf16 v[48:51], v[168:171], v[16:19], v[48:51]
    v_mfma_f32_16x16x32_bf16 v[52:55], v[248:251], v[16:19], v[52:55]
    s_waitcnt lgkmcnt(12)
    v_mfma_f32_16x16x32_bf16 v[56:59], v[168:171], v[20:23], v[56:59]
    v_mfma_f32_16x16x32_bf16 v[60:63], v[248:251], v[20:23], v[60:63]
    v_mfma_f32_16x16x32_bf16 v[64:67], v[20:23], v[20:23], v[64:67]
    v_mfma_f32_16x16x32_bf16 v[68:71], v[10:13], v[20:23], v[68:71]
    s_waitcnt lgkmcnt(10)
    v_mfma_f32_16x16x32_bf16 v[72:75], v[168:171], v[24:27], v[72:75]
    v_mfma_f32_16x16x32_bf16 v[76:79], v[248:251], v[24:27], v[76:79]
    s_waitcnt lgkmcnt(8)
    v_mfma_f32_16x16x32_bf16 v[80:83], v[168:171], v[28:31], v[80:83]
    v_mfma_f32_16x16x32_bf16 v[84:87], v[248:251], v[28:31], v[84:87]
    s_waitcnt lgkmcnt(6)
    v_mfma_f32_16x16x32_bf16 v[48:51], v[172:175], v[32:35], v[48:51]
    v_mfma_f32_16x16x32_bf16 v[52:55], v[252:255], v[32:35], v[52:55]
    s_waitcnt lgkmcnt(4)
    v_mfma_f32_16x16x32_bf16 v[56:59], v[172:175], v[36:39], v[56:59]
    v_mfma_f32_16x16x32_bf16 v[60:63], v[252:255], v[36:39], v[60:63]
    v_mfma_f32_16x16x32_bf16 v[64:67], v[36:39], v[36:39], v[64:67]
    v_mfma_f32_16x16x32_bf16 v[68:71], v[10:13], v[36:39], v[68:71]
    s_waitcnt lgkmcnt(2)
    v_mfma_f32_16x16x32_bf16 v[72:75], v[172:175], v[40:43], v[72:75]
    v_mfma_f32_16x16x32_bf16 v[76:79], v[252:255], v[40:43], v[76:79]
    s_waitcnt lgkmcnt(0)
    v_mfma_f32_16x16x32_bf16 v[80:83], v[172:175], v[44:47], v[80:83]
    v_mfma_f32_16x16x32_bf16 v[84:87], v[252:255], v[44:47], v[84:87]
    ds_read_b64 v[10:11], v7
    ds_read_b64 v[12:13], v8
    ds_read_b64 v[14:15], v9
    v_and_b32 v16, 15, v1
    v_lshrrev_b32 v17, 4, v1
    v_and_b32 v18, 3, v1
    v_lshrrev_b32 v19, 2, v16
    v_cmp_eq_u32 s[42:43], 1, v18
    v_cmp_eq_u32 s[44:45], 2, v18
    v_cmp_eq_u32 s[46:47], 3, v18
    v_cmp_eq_u32 s[48:49], v19, v17
    v_lshlrev_b32 v18, 3, v16
    v_add_u32 v18, 45376, v18
    v_cndmask_b32 v64, v64, v65, s[42:43]
    v_cndmask_b32 v64, v64, v66, s[44:45]
    v_cndmask_b32 v64, v64, v67, s[46:47]
    v_mul_f32 v68, 0x3acccccd, v68
    v_mul_f32 v64, 0x3acccccd, v64
    v_fma_f32 v64, -v68, v68, v64
    v_max_f32 v64, 0, v64
    v_cvt_pk_bf16_f32 v68, v68, v64
    v_and_b32 v64, 0xffff0000, v68
    v_lshlrev_b32 v68, 16, v68
    v_add_f32 v64, 0x3727c5ac, v64
    v_cvt_pk_bf16_f32 v64, v64, v64
    v_lshlrev_b32 v64, 16, v64
    v_sqrt_f32 v64, v64
    s_nop 0
    v_cvt_pk_bf16_f32 v64, v64, v64
    v_lshlrev_b32 v64, 16, v64
    v_rcp_f32 v69, v64
    s_mov_b64 exec, s[48:49]
    ds_write_b64 v18, v[68:69] offset:256
    s_mov_b64 exec, -1
    s_lshl_b32 s42, s3, 7
    s_add_u32 s42, s42, 46016
    v_lshl_add_u32 v19, v17, 4, s42
    s_lshl_b32 s42, s3, 6
    s_cmp_eq_u32 s3, 2
    s_cselect_b32 s42, 192, s42
    s_cmp_eq_u32 s3, 3
    s_cselect_b32 s42, 128, s42
    s_add_u32 s42, s42, 61440
    v_mul_u32_u24 v20, 496, v16
    v_lshl_add_u32 v20, v17, 4, v20
    v_add_u32 v20, s42, v20
    v_lshlrev_b32 v18, 3, v16
    v_add_u32 v18, 45376, v18
    s_waitcnt lgkmcnt(0)
    s_barrier
    ds_read_b64 v[26:27], v18 offset:128
    ds_read_b64 v[28:29], v18 offset:256
    ds_read_b64 v[30:31], v18 offset:384
    ds_read_b64 v[32:33], v18 offset:512
    ds_read_b128 v[36:39], v19 offset:0
    ds_read_b128 v[40:43], v19 offset:64
    s_waitcnt lgkmcnt(0)
    v_fma_f32 v48, -v26, v36, v48
    v_fma_f32 v49, -v26, v37, v49
    v_fma_f32 v50, -v26, v38, v50
    v_fma_f32 v51, -v26, v39, v51
    v_fma_f32 v52, -v26, v40, v52
    v_fma_f32 v53, -v26, v41, v53
    v_fma_f32 v54, -v26, v42, v54
    v_fma_f32 v55, -v26, v43, v55
    v_fma_f32 v56, -v28, v36, v56
    v_fma_f32 v57, -v28, v37, v57
    v_fma_f32 v58, -v28, v38, v58
    v_fma_f32 v59, -v28, v39, v59
    v_fma_f32 v60, -v28, v40, v60
    v_fma_f32 v61, -v28, v41, v61
    v_fma_f32 v62, -v28, v42, v62
    v_fma_f32 v63, -v28, v43, v63
    v_fma_f32 v72, -v30, v36, v72
    v_fma_f32 v73, -v30, v37, v73
    v_fma_f32 v74, -v30, v38, v74
    v_fma_f32 v75, -v30, v39, v75
    v_fma_f32 v76, -v30, v40, v76
    v_fma_f32 v77, -v30, v41, v77
    v_fma_f32 v78, -v30, v42, v78
    v_fma_f32 v79, -v30, v43, v79
    v_fma_f32 v80, -v32, v36, v80
    v_fma_f32 v81, -v32, v37, v81
    v_fma_f32 v82, -v32, v38, v82
    v_fma_f32 v83, -v32, v39, v83
    v_fma_f32 v84, -v32, v40, v84
    v_fma_f32 v85, -v32, v41, v85
    v_fma_f32 v86, -v32, v42, v86
    v_fma_f32 v87, -v32, v43, v87
    v_mul_f32 v48, v48, v27
    v_mul_f32 v49, v49, v27
    v_mul_f32 v50, v50, v27
    v_mul_f32 v51, v51, v27
    v_mul_f32 v52, v52, v27
    v_mul_f32 v53, v53, v27
    v_mul_f32 v54, v54, v27
    v_mul_f32 v55, v55, v27
    v_mul_f32 v56, v56, v29
    v_mul_f32 v57, v57, v29
    v_mul_f32 v58, v58, v29
    v_mul_f32 v59, v59, v29
    v_mul_f32 v60, v60, v29
    v_mul_f32 v61, v61, v29
    v_mul_f32 v62, v62, v29
    v_mul_f32 v63, v63, v29
    v_mul_f32 v72, v72, v31
    v_mul_f32 v73, v73, v31
    v_mul_f32 v74, v74, v31
    v_mul_f32 v75, v75, v31
    v_mul_f32 v76, v76, v31
    v_mul_f32 v77, v77, v31
    v_mul_f32 v78, v78, v31
    v_mul_f32 v79, v79, v31
    v_mul_f32 v80, v80, v33
    v_mul_f32 v81, v81, v33
    v_mul_f32 v82, v82, v33
    v_mul_f32 v83, v83, v33
    v_mul_f32 v84, v84, v33
    v_mul_f32 v85, v85, v33
    v_mul_f32 v86, v86, v33
    v_mul_f32 v87, v87, v33
    v_cvt_pk_bf16_f32 v48, v48, v52
    v_cvt_pk_bf16_f32 v49, v49, v53
    v_cvt_pk_bf16_f32 v50, v50, v54
    v_cvt_pk_bf16_f32 v51, v51, v55
    ds_write_b128 v20, v[48:51] offset:7936
    v_cvt_pk_bf16_f32 v56, v56, v60
    v_cvt_pk_bf16_f32 v57, v57, v61
    v_cvt_pk_bf16_f32 v58, v58, v62
    v_cvt_pk_bf16_f32 v59, v59, v63
    ds_write_b128 v20, v[56:59] offset:15872
    v_cvt_pk_bf16_f32 v72, v72, v76
    v_cvt_pk_bf16_f32 v73, v73, v77
    v_cvt_pk_bf16_f32 v74, v74, v78
    v_cvt_pk_bf16_f32 v75, v75, v79
    ds_write_b128 v20, v[72:75] offset:23808
    v_cvt_pk_bf16_f32 v80, v80, v84
    v_cvt_pk_bf16_f32 v81, v81, v85
    v_cvt_pk_bf16_f32 v82, v82, v86
    v_cvt_pk_bf16_f32 v83, v83, v87
    ds_write_b128 v20, v[80:83] offset:31744
    s_branch L_a1_post
L_g2D:
    s_waitcnt vmcnt(2)
    s_barrier
    ds_read_b64_tr_b16 v[16:17], v2 offset:0
    ds_read_b64_tr_b16 v[18:19], v2 offset:2560
    ds_read_b64_tr_b16 v[20:21], v2 offset:32
    ds_read_b64_tr_b16 v[22:23], v2 offset:2592
    ds_read_b64_tr_b16 v[24:25], v2 offset:64
    ds_read_b64_tr_b16 v[26:27], v2 offset:2624
    ds_read_b64_tr_b16 v[28:29], v2 offset:96
    ds_read_b64_tr_b16 v[30:31], v2 offset:2656
    ds_read_b64_tr_b16 v[32:33], v2 offset:128
    ds_read_b64_tr_b16 v[34:35], v2 offset:2688
    ds_read_b64_tr_b16 v[36:37], v2 offset:5120
    ds_read_b64_tr_b16 v[38:39], v2 offset:7680
    ds_read_b64_tr_b16 v[40:41], v2 offset:5152
    ds_read_b64_tr_b16 v[42:43], v2 offset:7712
    ds_read_b64_tr_b16 v[44:45], v2 offset:5184
    ds_read_b64_tr_b16 v[46:47], v2 offset:7744
    s_waitcnt lgkmcnt(14)
    v_mfma_f32_16x16x32_bf16 v[48:51], v[176:179], v[16:19], 0
    v_mfma_f32_16x16x32_bf16 v[52:55], v[16:19], v[16:19], 0
    v_mfma_f32_16x16x32_bf16 v[56:59], v[10:13], v[16:19], 0
    s_add_u32 m0, s52, 94208
    s_nop 0
    global_load_lds_dwordx4 v15, s[50:51] sc1
    ds_read_b64_tr_b16 v[16:17], v2 offset:5216
    ds_read_b64_tr_b16 v[18:19], v2 offset:7776
    s_waitcnt lgkmcnt(14)
    v_mfma_f32_16x16x32_bf16 v[60:63], v[96:99], v[20:23], 0
    v_mfma_f32_16x16x32_bf16 v[64:67], v[176:179], v[20:23], 0
    ds_read_b64_tr_b16 v[20:21], v2 offset:5248
    ds_read_b64_tr_b16 v[22:23], v2 offset:7808
    s_waitcnt lgkmcnt(14)
    v_mfma_f32_16x16x32_bf16 v[68:71], v[96:99], v[24:27], 0
    v_mfma_f32_16x16x32_bf16 v[72:75], v[176:179], v[24:27], 0
    ds_read_b64_tr_b16 v[24:25], v2 offset:10240
    ds_read_b64_tr_b16 v[26:27], v2 offset:12800
    s_waitcnt lgkmcnt(14)
    v_mfma_f32_16x16x32_bf16 v[76:79], v[96:99], v[28:31], 0
    v_mfma_f32_16x16x32_bf16 v[80:83], v[176:179], v[28:31], 0
    ds_read_b64_tr_b16 v[28:29], v2 offset:10272
    ds_read_b64_tr_b16 v[30:31], v2 offset:12832
    s_waitcnt lgkmcnt(14)
    v_mfma_f32_16x16x32_bf16 v[84:87], v[96:99], v[32:35], 0
    v_mfma_f32_16x16x32_bf16 v[88:91], v[176:179], v[32:35], 0
    ds_read_b64_tr_b16 v[32:33], v2 offset:10304
    ds_read_b64_tr_b16 v[34:35], v2 offset:12864
    s_waitcnt lgkmcnt(14)
    v_mfma_f32_16x16x32_bf16 v[48:51], v[180:183], v[36:39], v[48:51]
    v_mfma_f32_16x16x32_bf16 v[52:55], v[36:39], v[36:39], v[52:55]
    v_mfma_f32_16x16x32_bf16 v[56:59], v[10:13], v[36:39], v[56:59]
    s_add_u32 m0, s52, 102400
    s_add_u32 s50, s50, 1048576
    s_addc_u32 s51, s51, 0
    global_load_lds_dwordx4 v4, s[50:51] sc1
    ds_read_b64_tr_b16 v[36:37], v2 offset:10336
    ds_read_b64_tr_b16 v[38:39], v2 offset:12896
    s_waitcnt lgkmcnt(14)
    v_mfma_f32_16x16x32_bf16 v[60:63], v[100:103], v[40:43], v[60:63]
    v_mfma_f32_16x16x32_bf16 v[64:67], v[180:183], v[40:43], v[64:67]
    ds_read_b64_tr_b16 v[40:41], v2 offset:10368
    ds_read_b64_tr_b16 v[42:43], v2 offset:12928
    s_waitcnt lgkmcnt(14)
    v_mfma_f32_16x16x32_bf16 v[68:71], v[100:103], v[44:47], v[68:71]
    v_mfma_f32_16x16x32_bf16 v[72:75], v[180:183], v[44:47], v[72:75]
    s_waitcnt vmcnt(2)
    s_barrier
    ds_read_b64_tr_b16 v[44:45], v2 offset:15360
    ds_read_b64_tr_b16 v[46:47], v2 offset:17920
    s_waitcnt lgkmcnt(14)
    v_mfma_f32_16x16x32_bf16 v[76:79], v[100:103], v[16:19], v[76:79]
    v_mfma_f32_16x16x32_bf16 v[80:83], v[180:183], v[16:19], v[80:83]
    ds_read_b64_tr_b16 v[16:17], v2 offset:15392
    ds_read_b64_tr_b16 v[18:19], v2 offset:17952
    s_waitcnt lgkmcnt(14)
    v_mfma_f32_16x16x32_bf16 v[84:87], v[100:103], v[20:23], v[84:87]
    v_mfma_f32_16x16x32_bf16 v[88:91], v[180:183], v[20:23], v[88:91]
    ds_read_b64_tr_b16 v[20:21], v2 offset:15424
    ds_read_b64_tr_b16 v[22:23], v2 offset:17984
    s_waitcnt lgkmcnt(14)
    v_mfma_f32_16x16x32_bf16 v[48:51], v[184:187], v[24:27], v[48:51]
    v_mfma_f32_16x16x32_bf16 v[52:55], v[24:27], v[24:27], v[52:55]
    v_mfma_f32_16x16x32_bf16 v[56:59], v[10:13], v[24:27], v[56:59]
    s_add_u32 m0, s52, 110592
    s_nop 0
    global_load_lds_dwordx4 v5, s[50:51] sc1
    ds_read_b64_tr_b16 v[24:25], v2 offset:15456
    ds_read_b64_tr_b16 v[26:27], v2 offset:18016
    s_waitcnt lgkmcnt(14)
    v_mfma_f32_16x16x32_bf16 v[60:63], v[104:107], v[28:31], v[60:63]
    v_mfma_f32_16x16x32_bf16 v[64:67], v[184:187], v[28:31], v[64:67]
    ds_read_b64_tr_b16 v[28:29], v2 offset:15488
    ds_read_b64_tr_b16 v[30:31], v2 offset:18048
    s_waitcnt lgkmcnt(14)
    v_mfma_f32_16x16x32_bf16 v[68:71], v[104:107], v[32:35], v[68:71]
    v_mfma_f32_16x16x32_bf16 v[72:75], v[184:187], v[32:35], v[72:75]
    ds_read_b64_tr_b16 v[32:33], v2 offset:20480
    ds_read_b64_tr_b16 v[34:35], v2 offset:23040
    s_waitcnt lgkmcnt(14)
    v_mfma_f32_16x16x32_bf16 v[76:79], v[104:107], v[36:39], v[76:79]
    v_mfma_f32_16x16x32_bf16 v[80:83], v[184:187], v[36:39], v[80:83]
    ds_read_b64_tr_b16 v[36:37], v2 offset:20512
    ds_read_b64_tr_b16 v[38:39], v2 offset:23072
    s_waitcnt lgkmcnt(14)
    v_mfma_f32_16x16x32_bf16 v[84:87], v[104:107], v[40:43], v[84:87]
    v_mfma_f32_16x16x32_bf16 v[88:91], v[184:187], v[40:43], v[88:91]
    ds_read_b64_tr_b16 v[40:41], v2 offset:20544
    ds_read_b64_tr_b16 v[42:43], v2 offset:23104
    s_waitcnt lgkmcnt(14)
    v_mfma_f32_16x16x32_bf16 v[48:51], v[188:191], v[44:47], v[48:51]
    v_mfma_f32_16x16x32_bf16 v[52:55], v[44:47], v[44:47], v[52:55]
    v_mfma_f32_16x16x32_bf16 v[56:59], v[10:13], v[44:47], v[56:59]
    s_add_u32 m0, s52, 118784
    s_nop 0
    global_load_lds_dwordx4 v6, s[50:51] sc1
    ds_read_b64_tr_b16 v[44:45], v2 offset:20576
    ds_read_b64_tr_b16 v[46:47], v2 offset:23136
    s_waitcnt lgkmcnt(14)
    v_mfma_f32_16x16x32_bf16 v[60:63], v[108:111], v[16:19], v[60:63]
    v_mfma_f32_16x16x32_bf16 v[64:67], v[188:191], v[16:19], v[64:67]
    ds_read_b64_tr_b16 v[16:17], v2 offset:20608
    ds_read_b64_tr_b16 v[18:19], v2 offset:23168
    s_waitcnt lgkmcnt(14)
    v_mfma_f32_16x16x32_bf16 v[68:71], v[108:111], v[20:23], v[68:71]
    v_mfma_f32_16x16x32_bf16 v[72:75], v[188:191], v[20:23], v[72:75]
    ds_read_b64_tr_b16 v[20:21], v2 offset:25600
    ds_read_b64_tr_b16 v[22:23], v2 offset:28160
    s_waitcnt lgkmcnt(14)
    v_mfma_f32_16x16x32_bf16 v[76:79], v[108:111], v[24:27], v[76:79]
    v_mfma_f32_16x16x32_bf16 v[80:83], v[188:191], v[24:27], v[80:83]
    ds_read_b64_tr_b16 v[24:25], v2 offset:25632
    ds_read_b64_tr_b16 v[26:27], v2 offset:28192
    s_waitcnt lgkmcnt(14)
    v_mfma_f32_16x16x32_bf16 v[84:87], v[108:111], v[28:31], v[84:87]
    v_mfma_f32_16x16x32_bf16 v[88:91], v[188:191], v[28:31], v[88:91]
    ds_read_b64_tr_b16 v[28:29], v2 offset:25664
    ds_read_b64_tr_b16 v[30:31], v2 offset:28224
    s_waitcnt lgkmcnt(14)
    v_mfma_f32_16x16x32_bf16 v[48:51], v[192:195], v[32:35], v[48:51]
    v_mfma_f32_16x16x32_bf16 v[52:55], v[32:35], v[32:35], v[52:55]
    v_mfma_f32_16x16x32_bf16 v[56:59], v[10:13], v[32:35], v[56:59]
    s_add_u32 m0, s52, 126976
    s_nop 0
    global_load_lds_dwordx4 v14, s[50:51] sc1
    ds_read_b64_tr_b16 v[32:33], v2 offset:25696
    ds_read_b64_tr_b16 v[34:35], v2 offset:28256
    s_waitcnt lgkmcnt(14)
    v_mfma_f32_16x16x32_bf16 v[60:63], v[112:115], v[36:39], v[60:63]
    v_mfma_f32_16x16x32_bf16 v[64:67], v[192:195], v[36:39], v[64:67]
    ds_read_b64_tr_b16 v[36:37], v2 offset:25728
    ds_read_b64_tr_b16 v[38:39], v2 offset:28288
    s_waitcnt lgkmcnt(14)
    v_mfma_f32_16x16x32_bf16 v[68:71], v[112:115], v[40:43], v[68:71]
    v_mfma_f32_16x16x32_bf16 v[72:75], v[192:195], v[40:43], v[72:75]
    s_waitcnt vmcnt(2)
    s_barrier
    ds_read_b64_tr_b16 v[40:41], v2 offset:30720
    ds_read_b64_tr_b16 v[42:43], v2 offset:33280
    s_waitcnt lgkmcnt(14)
    v_mfma_f32_16x16x32_bf16 v[76:79], v[112:115], v[44:47], v[76:79]
    v_mfma_f32_16x16x32_bf16 v[80:83], v[192:195], v[44:47], v[80:83]
    ds_read_b64_tr_b16 v[44:45], v2 offset:30752
    ds_read_b64_tr_b16 v[46:47], v2 offset:33312
    s_waitcnt lgkmcnt(14)
    v_mfma_f32_16x16x32_bf16 v[84:87], v[112:115], v[16:19], v[84:87]
    v_mfma_f32_16x16x32_bf16 v[88:91], v[192:195], v[16:19], v[88:91]
    ds_read_b64_tr_b16 v[16:17], v2 offset:30784
    ds_read_b64_tr_b16 v[18:19], v2 offset:33344
    s_waitcnt lgkmcnt(14)
    v_mfma_f32_16x16x32_bf16 v[48:51], v[196:199], v[20:23], v[48:51]
    v_mfma_f32_16x16x32_bf16 v[52:55], v[20:23], v[20:23], v[52:55]
    v_mfma_f32_16x16x32_bf16 v[56:59], v[10:13], v[20:23], v[56:59]
    s_add_u32 m0, s52, 135168
    s_nop 0
    global_load_lds_dwordx4 v15, s[50:51] sc1
    ds_read_b64_tr_b16 v[20:21], v2 offset:30816
    ds_read_b64_tr_b16 v[22:23], v2 offset:33376
    s_waitcnt lgkmcnt(14)
    v_mfma_f32_16x16x32_bf16 v[60:63], v[116:119], v[24:27], v[60:63]
    v_mfma_f32_16x16x32_bf16 v[64:67], v[196:199], v[24:27], v[64:67]
    ds_read_b64_tr_b16 v[24:25], v2 offset:30848
    ds_read_b64_tr_b16 v[26:27], v2 offset:33408
    s_waitcnt lgkmcnt(14)
    v_mfma_f32_16x16x32_bf16 v[68:71], v[116:119], v[28:31], v[68:71]
    v_mfma_f32_16x16x32_bf16 v[72:75], v[196:199], v[28:31], v[72:75]
    ds_read_b64_tr_b16 v[28:29], v2 offset:35840
    ds_read_b64_tr_b16 v[30:31], v2 offset:38400
    s_waitcnt lgkmcnt(14)
    v_mfma_f32_16x16x32_bf16 v[76:79], v[116:119], v[32:35], v[76:79]
    v_mfma_f32_16x16x32_bf16 v[80:83], v[196:199], v[32:35], v[80:83]
    ds_read_b64_tr_b16 v[32:33], v2 offset:35872
    ds_read_b64_tr_b16 v[34:35], v2 offset:38432
    s_waitcnt lgkmcnt(14)
    v_mfma_f32_16x16x32_bf16 v[84:87], v[116:119], v[36:39], v[84:87]
    v_mfma_f32_16x16x32_bf16 v[88:91], v[196:199], v[36:39], v[88:91]
    ds_read_b64_tr_b16 v[36:37], v2 offset:35904
    ds_read_b64_tr_b16 v[38:39], v2 offset:38464
    s_waitcnt lgkmcnt(14)
    v_mfma_f32_16x16x32_bf16 v[48:51], v[200:203], v[40:43], v[48:51]
    v_mfma_f32_16x16x32_bf16 v[52:55], v[40:43], v[40:43], v[52:55]
    v_mfma_f32_16x16x32_bf16 v[56:59], v[10:13], v[40:43], v[56:59]
    s_add_u32 m0, s52, 143360
    s_add_u32 s50, s50, 1048576
    s_addc_u32 s51, s51, 0
    global_load_lds_dwordx4 v4, s[50:51] sc1
    ds_read_b64_tr_b16 v[40:41], v2 offset:35936
    ds_read_b64_tr_b16 v[42:43], v2 offset:38496
    s_waitcnt lgkmcnt(14)
    v_mfma_f32_16x16x32_bf16 v[60:63], v[120:123], v[44:47], v[60:63]
    v_mfma_f32_16x16x32_bf16 v[64:67], v[200:203], v[44:47], v[64:67]
    ds_read_b64_tr_b16 v[44:45], v2 offset:35968
    ds_read_b64_tr_b16 v[46:47], v2 offset:38528
    s_waitcnt lgkmcnt(14)
    v_mfma_f32_16x16x32_bf16 v[68:71], v[120:123], v[16:19], v[68:71]
    v_mfma_f32_16x16x32_bf16 v[72:75], v[200:203], v[16:19], v[72:75]
    ds_read_b64_tr_b16 v[16:17], v2 offset:40960
    ds_read_b64_tr_b16 v[18:19], v2 offset:43520
    s_waitcnt lgkmcnt(14)
    v_mfma_f32_16x16x32_bf16 v[76:79], v[120:123], v[20:23], v[76:79]
    v_mfma_f32_16x16x32_bf16 v[80:83], v[200:203], v[20:23], v[80:83]
    ds_read_b64_tr_b16 v[20:21], v2 offset:40992
    ds_read_b64_tr_b16 v[22:23], v2 offset:43552
    s_waitcnt lgkmcnt(14)
    v_mfma_f32_16x16x32_bf16 v[84:87], v[120:123], v[24:27], v[84:87]
    v_mfma_f32_16x16x32_bf16 v[88:91], v[200:203], v[24:27], v[88:91]
    ds_read_b64_tr_b16 v[24:25], v2 offset:41024
    ds_read_b64_tr_b16 v[26:27], v2 offset:43584
    s_waitcnt lgkmcnt(14)
    v_mfma_f32_16x16x32_bf16 v[48:51], v[204:207], v[28:31], v[48:51]
    v_mfma_f32_16x16x32_bf16 v[52:55], v[28:31], v[28:31], v[52:55]
    v_mfma_f32_16x16x32_bf16 v[56:59], v[10:13], v[28:31], v[56:59]
    s_add_u32 m0, s52, 151552
    s_nop 0
    global_load_lds_dwordx4 v5, s[50:51] sc1
    ds_read_b64_tr_b16 v[28:29], v2 offset:41056
    ds_read_b64_tr_b16 v[30:31], v2 offset:43616
    s_waitcnt lgkmcnt(14)
    v_mfma_f32_16x16x32_bf16 v[60:63], v[124:127], v[32:35], v[60:63]
    v_mfma_f32_16x16x32_bf16 v[64:67], v[204:207], v[32:35], v[64:67]
    ds_read_b64_tr_b16 v[32:33], v2 offset:41088
    ds_read_b64_tr_b16 v[34:35], v2 offset:43648
    s_waitcnt lgkmcnt(14)
    v_mfma_f32_16x16x32_bf16 v[68:71], v[124:127], v[36:39], v[68:71]
    v_mfma_f32_16x16x32_bf16 v[72:75], v[204:207], v[36:39], v[72:75]
    ds_read_b64_tr_b16 v[36:37], v2 offset:46080
    ds_read_b64_tr_b16 v[38:39], v2 offset:48640
    s_waitcnt lgkmcnt(14)
    v_mfma_f32_16x16x32_bf16 v[76:79], v[124:127], v[40:43], v[76:79]
    v_mfma_f32_16x16x32_bf16 v[80:83], v[204:207], v[40:43], v[80:83]
    ds_read_b64_tr_b16 v[40:41], v2 offset:46112
    ds_read_b64_tr_b16 v[42:43], v2 offset:48672
    s_waitcnt lgkmcnt(14)
    v_mfma_f32_16x16x32_bf16 v[84:87], v[124:127], v[44:47], v[84:87]
    v_mfma_f32_16x16x32_bf16 v[88:91], v[204:207], v[44:47], v[88:91]
    ds_read_b64_tr_b16 v[44:45], v2 offset:46144
    ds_read_b64_tr_b16 v[46:47], v2 offset:48704
    s_waitcnt lgkmcnt(14)
    v_mfma_f32_16x16x32_bf16 v[48:51], v[208:211], v[16:19], v[48:51]
    v_mfma_f32_16x16x32_bf16 v[52:55], v[16:19], v[16:19], v[52:55]
    v_mfma_f32_16x16x32_bf16 v[56:59], v[10:13], v[16:19], v[56:59]
    s_cmp_ge_u32 s3, 4
    s_nop 5
    s_cbranch_scc1 L_r1217
    s_add_u32 m0, s52, 159744
    s_nop 0
    global_load_lds_dwordx4 v6, s[50:51] sc1
L_r1217:
    ds_read_b64_tr_b16 v[16:17], v2 offset:46176
    ds_read_b64_tr_b16 v[18:19], v2 offset:48736
    s_waitcnt lgkmcnt(14)
    v_mfma_f32_16x16x32_bf16 v[60:63], v[128:131], v[20:23], v[60:63]
    v_mfma_f32_16x16x32_bf16 v[64:67], v[208:211], v[20:23], v[64:67]
    ds_read_b64_tr_b16 v[20:21], v2 offset:46208
    ds_read_b64_tr_b16 v[22:23], v2 offset:48768
    s_waitcnt lgkmcnt(14)
    v_mfma_f32_16x16x32_bf16 v[68:71], v[128:131], v[24:27], v[68:71]
    v_mfma_f32_16x16x32_bf16 v[72:75], v[208:211], v[24:27], v[72:75]
    ds_read_b64_tr_b16 v[24:25], v2 offset:51200
    ds_read_b64_tr_b16 v[26:27], v2 offset:53760
    s_waitcnt lgkmcnt(14)
    v_mfma_f32_16x16x32_bf16 v[76:79], v[128:131], v[28:31], v[76:79]
    v_mfma_f32_16x16x32_bf16 v[80:83], v[208:211], v[28:31], v[80:83]
    ds_read_b64_tr_b16 v[28:29], v2 offset:51232
    ds_read_b64_tr_b16 v[30:31], v2 offset:53792
    s_waitcnt lgkmcnt(14)
    v_mfma_f32_16x16x32_bf16 v[84:87], v[128:131], v[32:35], v[84:87]
    v_mfma_f32_16x16x32_bf16 v[88:91], v[208:211], v[32:35], v[88:91]
    ds_read_b64_tr_b16 v[32:33], v2 offset:51264
    ds_read_b64_tr_b16 v[34:35], v2 offset:53824
    s_waitcnt lgkmcnt(14)
    v_mfma_f32_16x16x32_bf16 v[48:51], v[212:215], v[36:39], v[48:51]
    v_mfma_f32_16x16x32_bf16 v[52:55], v[36:39], v[36:39], v[52:55]
    v_mfma_f32_16x16x32_bf16 v[56:59], v[10:13], v[36:39], v[56:59]
    ds_read_b64_tr_b16 v[36:37], v2 offset:51296
    ds_read_b64_tr_b16 v[38:39], v2 offset:53856
    s_waitcnt lgkmcnt(14)
    v_mfma_f32_16x16x32_bf16 v[60:63], v[132:135], v[40:43], v[60:63]
    v_mfma_f32_16x16x32_bf16 v[64:67], v[212:215], v[40:43], v[64:67]
    ds_read_b64_tr_b16 v[40:41], v2 offset:51328
    ds_read_b64_tr_b16 v[42:43], v2 offset:53888
    s_waitcnt lgkmcnt(14)
    v_mfma_f32_16x16x32_bf16 v[68:71], v[132:135], v[44:47], v[68:71]
    v_mfma_f32_16x16x32_bf16 v[72:75], v[212:215], v[44:47], v[72:75]
    s_waitcnt vmcnt(2)
    s_barrier
    ds_read_b64_tr_b16 v[44:45], v2 offset:56320
    ds_read_b64_tr_b16 v[46:47], v2 offset:58880
    s_waitcnt lgkmcnt(14)
    v_mfma_f32_16x16x32_bf16 v[76:79], v[132:135], v[16:19], v[76:79]
    v_mfma_f32_16x16x32_bf16 v[80:83], v[212:215], v[16:19], v[80:83]
    ds_read_b64_tr_b16 v[16:17], v2 offset:56352
    ds_read_b64_tr_b16 v[18:19], v2 offset:58912
    s_waitcnt lgkmcnt(14)
    v_mfma_f32_16x16x32_bf16 v[84:87], v[132:135], v[20:23], v[84:87]
    v_mfma_f32_16x16x32_bf16 v[88:91], v[212:215], v[20:23], v[88:91]
    ds_read_b64_tr_b16 v[20:21], v2 offset:56384
    ds_read_b64_tr_b16 v[22:23], v2 offset:58944
    s_waitcnt lgkmcnt(14)
    v_mfma_f32_16x16x32_bf16 v[48:51], v[216:219], v[24:27], v[48:51]
    v_mfma_f32_16x16x32_bf16 v[52:55], v[24:27], v[24:27], v[52:55]
    v_mfma_f32_16x16x32_bf16 v[56:59], v[10:13], v[24:27], v[56:59]
    ds_read_b64_tr_b16 v[24:25], v2 offset:56416
    ds_read_b64_tr_b16 v[26:27], v2 offset:58976
    s_waitcnt lgkmcnt(14)
    v_mfma_f32_16x16x32_bf16 v[60:63], v[136:139], v[28:31], v[60:63]
    v_mfma_f32_16x16x32_bf16 v[64:67], v[216:219], v[28:31], v[64:67]
    ds_read_b64_tr_b16 v[28:29], v2 offset:56448
    ds_read_b64_tr_b16 v[30:31], v2 offset:59008
    s_waitcnt lgkmcnt(14)
    v_mfma_f32_16x16x32_bf16 v[68:71], v[136:139], v[32:35], v[68:71]
    v_mfma_f32_16x16x32_bf16 v[72:75], v[216:219], v[32:35], v[72:75]
    ds_read_b64_tr_b16 v[32:33], v3 offset:0
    ds_read_b64_tr_b16 v[34:35], v3 offset:2560
    s_waitcnt lgkmcnt(14)
    v_mfma_f32_16x16x32_bf16 v[76:79], v[136:139], v[36:39], v[76:79]
    v_mfma_f32_16x16x32_bf16 v[80:83], v[216:219], v[36:39], v[80:83]
    ds_read_b64_tr_b16 v[36:37], v3 offset:32
    ds_read_b64_tr_b16 v[38:39], v3 offset:2592
    s_waitcnt lgkmcnt(14)
    v_mfma_f32_16x16x32_bf16 v[84:87], v[136:139], v[40:43], v[84:87]
    v_mfma_f32_16x16x32_bf16 v[88:91], v[216:219], v[40:43], v[88:91]
    ds_read_b64_tr_b16 v[40:41], v3 offset:64
    ds_read_b64_tr_b16 v[42:43], v3 offset:2624
    s_waitcnt lgkmcnt(14)
    v_mfma_f32_16x16x32_bf16 v[48:51], v[220:223], v[44:47], v[48:51]
    v_mfma_f32_16x16x32_bf16 v[52:55], v[44:47], v[44:47], v[52:55]
    v_mfma_f32_16x16x32_bf16 v[56:59], v[10:13], v[44:47], v[56:59]
    ds_read_b64_tr_b16 v[44:45], v3 offset:96
    ds_read_b64_tr_b16 v[46:47], v3 offset:2656
    s_waitcnt lgkmcnt(14)
    v_mfma_f32_16x16x32_bf16 v[60:63], v[140:143], v[16:19], v[60:63]
    v_mfma_f32_16x16x32_bf16 v[64:67], v[220:223], v[16:19], v[64:67]
    ds_read_b64_tr_b16 v[16:17], v3 offset:128
    ds_read_b64_tr_b16 v[18:19], v3 offset:2688
    s_waitcnt lgkmcnt(14)
    v_mfma_f32_16x16x32_bf16 v[68:71], v[140:143], v[20:23], v[68:71]
    v_mfma_f32_16x16x32_bf16 v[72:75], v[220:223], v[20:23], v[72:75]
    ds_read_b64_tr_b16 v[20:21], v3 offset:5120
    ds_read_b64_tr_b16 v[22:23], v3 offset:7680
    s_waitcnt lgkmcnt(14)
    v_mfma_f32_16x16x32_bf16 v[76:79], v[140:143], v[24:27], v[76:79]
    v_mfma_f32_16x16x32_bf16 v[80:83], v[220:223], v[24:27], v[80:83]
    ds_read_b64_tr_b16 v[24:25], v3 offset:5152
    ds_read_b64_tr_b16 v[26:27], v3 offset:7712
    s_waitcnt lgkmcnt(14)
    v_mfma_f32_16x16x32_bf16 v[84:87], v[140:143], v[28:31], v[84:87]
    v_mfma_f32_16x16x32_bf16 v[88:91], v[220:223], v[28:31], v[88:91]
    ds_read_b64_tr_b16 v[28:29], v3 offset:5184
    ds_read_b64_tr_b16 v[30:31], v3 offset:7744
    s_waitcnt lgkmcnt(14)
    v_mfma_f32_16x16x32_bf16 v[48:51], v[224:227], v[32:35], v[48:51]
    v_mfma_f32_16x16x32_bf16 v[52:55], v[32:35], v[32:35], v[52:55]
    v_mfma_f32_16x16x32_bf16 v[56:59], v[10:13], v[32:35], v[56:59]
    ds_read_b64_tr_b16 v[32:33], v3 offset:5216
    ds_read_b64_tr_b16 v[34:35], v3 offset:7776
    s_waitcnt lgkmcnt(14)
    v_mfma_f32_16x16x32_bf16 v[60:63], v[144:147], v[36:39], v[60:63]
    v_mfma_f32_16x16x32_bf16 v[64:67], v[224:227], v[36:39], v[64:67]
    ds_read_b64_tr_b16 v[36:37], v3 offset:5248
    ds_read_b64_tr_b16 v[38:39], v3 offset:7808
    s_waitcnt lgkmcnt(14)
    v_mfma_f32_16x16x32_bf16 v[68:71], v[144:147], v[40:43], v[68:71]
    v_mfma_f32_16x16x32_bf16 v[72:75], v[224:227], v[40:43], v[72:75]
    ds_read_b64_tr_b16 v[40:41], v3 offset:10240
    ds_read_b64_tr_b16 v[42:43], v3 offset:12800
    s_waitcnt lgkmcnt(14)
    v_mfma_f32_16x16x32_bf16 v[76:79], v[144:147], v[44:47], v[76:79]
    v_mfma_f32_16x16x32_bf16 v[80:83], v[224:227], v[44:47], v[80:83]
    ds_read_b64_tr_b16 v[44:45], v3 offset:10272
    ds_read_b64_tr_b16 v[46:47], v3 offset:12832
    s_waitcnt lgkmcnt(14)
    v_mfma_f32_16x16x32_bf16 v[84:87], v[144:147], v[16:19], v[84:87]
    v_mfma_f32_16x16x32_bf16 v[88:91], v[224:227], v[16:19], v[88:91]
    ds_read_b64_tr_b16 v[16:17], v3 offset:10304
    ds_read_b64_tr_b16 v[18:19], v3 offset:12864
    s_waitcnt lgkmcnt(14)
    v_mfma_f32_16x16x32_bf16 v[48:51], v[228:231], v[20:23], v[48:51]
    v_mfma_f32_16x16x32_bf16 v[52:55], v[20:23], v[20:23], v[52:55]
    v_mfma_f32_16x16x32_bf16 v[56:59], v[10:13], v[20:23], v[56:59]
    ds_read_b64_tr_b16 v[20:21], v3 offset:10336
    ds_read_b64_tr_b16 v[22:23], v3 offset:12896
    s_waitcnt lgkmcnt(14)
    v_mfma_f32_16x16x32_bf16 v[60:63], v[148:151], v[24:27], v[60:63]
    v_mfma_f32_16x16x32_bf16 v[64:67], v[228:231], v[24:27], v[64:67]
    ds_read_b64_tr_b16 v[24:25], v3 offset:10368
    ds_read_b64_tr_b16 v[26:27], v3 offset:12928
    s_waitcnt lgkmcnt(14)
    v_mfma_f32_16x16x32_bf16 v[68:71], v[148:151], v[28:31], v[68:71]
    v_mfma_f32_16x16x32_bf16 v[72:75], v[228:231], v[28:31], v[72:75]
    ds_read_b64_tr_b16 v[28:29], v3 offset:15360
    ds_read_b64_tr_b16 v[30:31], v3 offset:17920
    s_waitcnt lgkmcnt(14)
    v_mfma_f32_16x16x32_bf16 v[76:79], v[148:151], v[32:35], v[76:79]
    v_mfma_f32_16x16x32_bf16 v[80:83], v[228:231], v[32:35], v[80:83]
    ds_read_b64_tr_b16 v[32:33], v3 offset:15392
    ds_read_b64_tr_b16 v[34:35], v3 offset:17952
    s_waitcnt lgkmcnt(14)
    v_mfma_f32_16x16x32_bf16 v[84:87], v[148:151], v[36:39], v[84:87]
    v_mfma_f32_16x16x32_bf16 v[88:91], v[228:231], v[36:39], v[88:91]
    ds_read_b64_tr_b16 v[36:37], v3 offset:15424
    ds_read_b64_tr_b16 v[38:39], v3 offset:17984
    s_waitcnt lgkmcnt(14)
    v_mfma_f32_16x16x32_bf16 v[48:51], v[232:235], v[40:43], v[48:51]
    v_mfma_f32_16x16x32_bf16 v[52:55], v[40:43], v[40:43], v[52:55]
    v_mfma_f32_16x16x32_bf16 v[56:59], v[10:13], v[40:43], v[56:59]
    ds_read_b64_tr_b16 v[40:41], v3 offset:15456
    ds_read_b64_tr_b16 v[42:43], v3 offset:18016
    s_waitcnt lgkmcnt(14)
    v_mfma_f32_16x16x32_bf16 v[60:63], v[152:155], v[44:47], v[60:63]
    v_mfma_f32_16x16x32_bf16 v[64:67], v[232:235], v[44:47], v[64:67]
    ds_read_b64_tr_b16 v[44:45], v3 offset:15488
    ds_read_b64_tr_b16 v[46:47], v3 offset:18048
    s_waitcnt lgkmcnt(14)
    v_mfma_f32_16x16x32_bf16 v[68:71], v[152:155], v[16:19], v[68:71]
    v_mfma_f32_16x16x32_bf16 v[72:75], v[232:235], v[16:19], v[72:75]
    s_waitcnt vmcnt(0)
    s_barrier
    ds_read_b64_tr_b16 v[16:17], v3 offset:20480
    ds_read_b64_tr_b16 v[18:19], v3 offset:23040
    s_waitcnt lgkmcnt(14)
    v_mfma_f32_16x16x32_bf16 v[76:79], v[152:155], v[20:23], v[76:79]
    v_mfma_f32_16x16x32_bf16 v[80:83], v[232:235], v[20:23], v[80:83]
    ds_read_b64_tr_b16 v[20:21], v3 offset:20512
    ds_read_b64_tr_b16 v[22:23], v3 offset:23072
    s_waitcnt lgkmcnt(14)
    v_mfma_f32_16x16x32_bf16 v[84:87], v[152:155], v[24:27], v[84:87]
    v_mfma_f32_16x16x32_bf16 v[88:91], v[232:235], v[24:27], v[88:91]
    ds_read_b64_tr_b16 v[24:25], v3 offset:20544
    ds_read_b64_tr_b16 v[26:27], v3 offset:23104
    s_waitcnt lgkmcnt(14)
    v_mfma_f32_16x16x32_bf16 v[48:51], v[236:239], v[28:31], v[48:51]
    v_mfma_f32_16x16x32_bf16 v[52:55], v[28:31], v[28:31], v[52:55]
    v_mfma_f32_16x16x32_bf16 v[56:59], v[10:13], v[28:31], v[56:59]
    ds_read_b64_tr_b16 v[28:29], v3 offset:20576
    ds_read_b64_tr_b16 v[30:31], v3 offset:23136
    s_waitcnt lgkmcnt(14)
    v_mfma_f32_16x16x32_bf16 v[60:63], v[156:159], v[32:35], v[60:63]
    v_mfma_f32_16x16x32_bf16 v[64:67], v[236:239], v[32:35], v[64:67]
    ds_read_b64_tr_b16 v[32:33], v3 offset:20608
    ds_read_b64_tr_b16 v[34:35], v3 offset:23168
    s_waitcnt lgkmcnt(14)
    v_mfma_f32_16x16x32_bf16 v[68:71], v[156:159], v[36:39], v[68:71]
    v_mfma_f32_16x16x32_bf16 v[72:75], v[236:239], v[36:39], v[72:75]
    ds_read_b64_tr_b16 v[36:37], v3 offset:25600
    ds_read_b64_tr_b16 v[38:39], v3 offset:28160
    s_waitcnt lgkmcnt(14)
    v_mfma_f32_16x16x32_bf16 v[76:79], v[156:159], v[40:43], v[76:79]
    v_mfma_f32_16x16x32_bf16 v[80:83], v[236:239], v[40:43], v[80:83]
    ds_read_b64_tr_b16 v[40:41], v3 offset:25632
    ds_read_b64_tr_b16 v[42:43], v3 offset:28192
    s_waitcnt lgkmcnt(14)
    v_mfma_f32_16x16x32_bf16 v[84:87], v[156:159], v[44:47], v[84:87]
    v_mfma_f32_16x16x32_bf16 v[88:91], v[236:239], v[44:47], v[88:91]
    ds_read_b64_tr_b16 v[44:45], v3 offset:25664
    ds_read_b64_tr_b16 v[46:47], v3 offset:28224
    s_waitcnt lgkmcnt(14)
    v_mfma_f32_16x16x32_bf16 v[48:51], v[240:243], v[16:19], v[48:51]
    v_mfma_f32_16x16x32_bf16 v[52:55], v[16:19], v[16:19], v[52:55]
    v_mfma_f32_16x16x32_bf16 v[56:59], v[10:13], v[16:19], v[56:59]
    ds_read_b64_tr_b16 v[16:17], v3 offset:25696
    ds_read_b64_tr_b16 v[18:19], v3 offset:28256
    s_waitcnt lgkmcnt(14)
    v_mfma_f32_16x16x32_bf16 v[60:63], v[160:163], v[20:23], v[60:63]
    v_mfma_f32_16x16x32_bf16 v[64:67], v[240:243], v[20:23], v[64:67]
    ds_read_b64_tr_b16 v[20:21], v3 offset:25728
    ds_read_b64_tr_b16 v[22:23], v3 offset:28288
    s_waitcnt lgkmcnt(14)
    v_mfma_f32_16x16x32_bf16 v[68:71], v[160:163], v[24:27], v[68:71]
    v_mfma_f32_16x16x32_bf16 v[72:75], v[240:243], v[24:27], v[72:75]
    ds_read_b64_tr_b16 v[24:25], v3 offset:30720
    ds_read_b64_tr_b16 v[26:27], v3 offset:33280
    s_waitcnt lgkmcnt(14)
    v_mfma_f32_16x16x32_bf16 v[76:79], v[160:163], v[28:31], v[76:79]
    v_mfma_f32_16x16x32_bf16 v[80:83], v[240:243], v[28:31], v[80:83]
    ds_read_b64_tr_b16 v[28:29], v3 offset:30752
    ds_read_b64_tr_b16 v[30:31], v3 offset:33312
    s_waitcnt lgkmcnt(14)
    v_mfma_f32_16x16x32_bf16 v[84:87], v[160:163], v[32:35], v[84:87]
    v_mfma_f32_16x16x32_bf16 v[88:91], v[240:243], v[32:35], v[88:91]
    ds_read_b64_tr_b16 v[32:33], v3 offset:30784
    ds_read_b64_tr_b16 v[34:35], v3 offset:33344
    s_waitcnt lgkmcnt(14)
    v_mfma_f32_16x16x32_bf16 v[48:51], v[244:247], v[36:39], v[48:51]
    v_mfma_f32_16x16x32_bf16 v[52:55], v[36:39], v[36:39], v[52:55]
    v_mfma_f32_16x16x32_bf16 v[56:59], v[10:13], v[36:39], v[56:59]
    ds_read_b64_tr_b16 v[36:37], v3 offset:30816
    ds_read_b64_tr_b16 v[38:39], v3 offset:33376
    s_waitcnt lgkmcnt(14)
    v_mfma_f32_16x16x32_bf16 v[60:63], v[164:167], v[40:43], v[60:63]
    v_mfma_f32_16x16x32_bf16 v[64:67], v[244:247], v[40:43], v[64:67]
    ds_read_b64_tr_b16 v[40:41], v3 offset:30848
    ds_read_b64_tr_b16 v[42:43], v3 offset:33408
    s_waitcnt lgkmcnt(14)
    v_mfma_f32_16x16x32_bf16 v[68:71], v[164:167], v[44:47], v[68:71]
    v_mfma_f32_16x16x32_bf16 v[72:75], v[244:247], v[44:47], v[72:75]
    ds_read_b64_tr_b16 v[44:45], v3 offset:35840
    ds_read_b64_tr_b16 v[46:47], v3 offset:38400
    s_waitcnt lgkmcnt(14)
    v_mfma_f32_16x16x32_bf16 v[76:79], v[164:167], v[16:19], v[76:79]
    v_mfma_f32_16x16x32_bf16 v[80:83], v[244:247], v[16:19], v[80:83]
    ds_read_b64_tr_b16 v[16:17], v3 offset:35872
    ds_read_b64_tr_b16 v[18:19], v3 offset:38432
    s_waitcnt lgkmcnt(14)
    v_mfma_f32_16x16x32_bf16 v[84:87], v[164:167], v[20:23], v[84:87]
    v_mfma_f32_16x16x32_bf16 v[88:91], v[244:247], v[20:23], v[88:91]
    ds_read_b64_tr_b16 v[20:21], v3 offset:35904
    ds_read_b64_tr_b16 v[22:23], v3 offset:38464
    s_waitcnt lgkmcnt(14)
    v_mfma_f32_16x16x32_bf16 v[48:51], v[248:251], v[24:27], v[48:51]
    v_mfma_f32_16x16x32_bf16 v[52:55], v[24:27], v[24:27], v[52:55]
    v_mfma_f32_16x16x32_bf16 v[56:59], v[10:13], v[24:27], v[56:59]
    ds_read_b64_tr_b16 v[24:25], v3 offset:35936
    ds_read_b64_tr_b16 v[26:27], v3 offset:38496
    s_waitcnt lgkmcnt(14)
    v_mfma_f32_16x16x32_bf16 v[60:63], v[168:171], v[28:31], v[60:63]
    v_mfma_f32_16x16x32_bf16 v[64:67], v[248:251], v[28:31], v[64:67]
    ds_read_b64_tr_b16 v[28:29], v3 offset:35968
    ds_read_b64_tr_b16 v[30:31], v3 offset:38528
    s_waitcnt lgkmcnt(14)
    v_mfma_f32_16x16x32_bf16 v[68:71], v[168:171], v[32:35], v[68:71]
    v_mfma_f32_16x16x32_bf16 v[72:75], v[248:251], v[32:35], v[72:75]
    s_waitcnt lgkmcnt(12)
    v_mfma_f32_16x16x32_bf16 v[76:79], v[168:171], v[36:39], v[76:79]
    v_mfma_f32_16x16x32_bf16 v[80:83], v[248:251], v[36:39], v[80:83]
    s_waitcnt lgkmcnt(10)
    v_mfma_f32_16x16x32_bf16 v[84:87], v[168:171], v[40:43], v[84:87]
    v_mfma_f32_16x16x32_bf16 v[88:91], v[248:251], v[40:43], v[88:91]
    s_waitcnt lgkmcnt(8)
    v_mfma_f32_16x16x32_bf16 v[48:51], v[252:255], v[44:47], v[48:51]
    v_mfma_f32_16x16x32_bf16 v[52:55], v[44:47], v[44:47], v[52:55]
    v_mfma_f32_16x16x32_bf16 v[56:59], v[10:13], v[44:47], v[56:59]
    s_waitcnt lgkmcnt(6)
    v_mfma_f32_16x16x32_bf16 v[60:63], v[172:175], v[16:19], v[60:63]
    v_mfma_f32_16x16x32_bf16 v[64:67], v[252:255], v[16:19], v[64:67]
    s_waitcnt lgkmcnt(4)
    v_mfma_f32_16x16x32_bf16 v[68:71], v[172:175], v[20:23], v[68:71]
    v_mfma_f32_16x16x32_bf16 v[72:75], v[252:255], v[20:23], v[72:75]
    s_waitcnt lgkmcnt(2)
    v_mfma_f32_16x16x32_bf16 v[76:79], v[172:175], v[24:27], v[76:79]
    v_mfma_f32_16x16x32_bf16 v[80:83], v[252:255], v[24:27], v[80:83]
    s_waitcnt lgkmcnt(0)
    v_mfma_f32_16x16x32_bf16 v[84:87], v[172:175], v[28:31], v[84:87]
    v_mfma_f32_16x16x32_bf16 v[88:91], v[252:255], v[28:31], v[88:91]
    ds_read_b64 v[10:11], v7
    ds_read_b64 v[12:13], v8
    ds_read_b64 v[14:15], v9
    v_and_b32 v16, 15, v1
    v_lshrrev_b32 v17, 4, v1
    v_and_b32 v18, 3, v1
    v_lshrrev_b32 v19, 2, v16
    v_cmp_eq_u32 s[42:43], 1, v18
    v_cmp_eq_u32 s[44:45], 2, v18
    v_cmp_eq_u32 s[46:47], 3, v18
    v_cmp_eq_u32 s[48:49], v19, v17
    v_lshlrev_b32 v18, 3, v16
    v_add_u32 v18, 45376, v18
    v_cndmask_b32 v52, v52, v53, s[42:43]
    v_cndmask_b32 v52, v52, v54, s[44:45]
    v_cndmask_b32 v52, v52, v55, s[46:47]
    v_mul_f32 v56, 0x3acccccd, v56
    v_mul_f32 v52, 0x3acccccd, v52
    v_fma_f32 v52, -v56, v56, v52
    v_max_f32 v52, 0, v52
    v_cvt_pk_bf16_f32 v56, v56, v52
    v_and_b32 v52, 0xffff0000, v56
    v_lshlrev_b32 v56, 16, v56
    v_add_f32 v52, 0x3727c5ac, v52
    v_cvt_pk_bf16_f32 v52, v52, v52
    v_lshlrev_b32 v52, 16, v52
    v_sqrt_f32 v52, v52
    s_nop 0
    v_cvt_pk_bf16_f32 v52, v52, v52
    v_lshlrev_b32 v52, 16, v52
    v_rcp_f32 v57, v52
    s_mov_b64 exec, s[48:49]
    ds_write_b64 v18, v[56:57] offset:0
    s_mov_b64 exec, -1
    s_lshl_b32 s42, s3, 7
    s_add_u32 s42, s42, 46016
    v_lshl_add_u32 v19, v17, 4, s42
    s_lshl_b32 s42, s3, 6
    s_cmp_eq_u32 s3, 2
    s_cselect_b32 s42, 192, s42
    s_cmp_eq_u32 s3, 3
    s_cselect_b32 s42, 128, s42
    s_add_u32 s42, s42, 61440
    v_mul_u32_u24 v20, 496, v16
    v_lshl_add_u32 v20, v17, 3, v20
    v_add_u32 v20, s42, v20
    v_lshlrev_b32 v18, 3, v16
    v_add_u32 v18, 45376, v18
    s_waitcnt lgkmcnt(0)
    s_barrier
    ds_read_b64 v[24:25], v18 offset:0
    ds_read_b64 v[26:27], v18 offset:128
    ds_read_b64 v[28:29], v18 offset:256
    ds_read_b64 v[30:31], v18 offset:384
    ds_read_b64 v[32:33], v18 offset:512
    ds_read_b128 v[36:39], v19 offset:0
    ds_read_b128 v[40:43], v19 offset:64
    s_waitcnt lgkmcnt(0)
    v_fma_f32 v48, -v24, v40, v48
    v_fma_f32 v49, -v24, v41, v49
    v_fma_f32 v50, -v24, v42, v50
    v_fma_f32 v51, -v24, v43, v51
    v_fma_f32 v60, -v26, v36, v60
    v_fma_f32 v61, -v26, v37, v61
    v_fma_f32 v62, -v26, v38, v62
    v_fma_f32 v63, -v26, v39, v63
    v_fma_f32 v64, -v26, v40, v64
    v_fma_f32 v65, -v26, v41, v65
    v_fma_f32 v66, -v26, v42, v66
    v_fma_f32 v67, -v26, v43, v67
    v_fma_f32 v68, -v28, v36, v68
    v_fma_f32 v69, -v28, v37, v69
    v_fma_f32 v70, -v28, v38, v70
    v_fma_f32 v71, -v28, v39, v71
    v_fma_f32 v72, -v28, v40, v72
    v_fma_f32 v73, -v28, v41, v73
    v_fma_f32 v74, -v28, v42, v74
    v_fma_f32 v75, -v28, v43, v75
    v_fma_f32 v76, -v30, v36, v76
    v_fma_f32 v77, -v30, v37, v77
    v_fma_f32 v78, -v30, v38, v78
    v_fma_f32 v79, -v30, v39, v79
    v_fma_f32 v80, -v30, v40, v80
    v_fma_f32 v81, -v30, v41, v81
    v_fma_f32 v82, -v30, v42, v82
    v_fma_f32 v83, -v30, v43, v83
    v_fma_f32 v84, -v32, v36, v84
    v_fma_f32 v85, -v32, v37, v85
    v_fma_f32 v86, -v32, v38, v86
    v_fma_f32 v87, -v32, v39, v87
    v_fma_f32 v88, -v32, v40, v88
    v_fma_f32 v89, -v32, v41, v89
    v_fma_f32 v90, -v32, v42, v90
    v_fma_f32 v91, -v32, v43, v91
    v_mul_f32 v48, v48, v25
    v_mul_f32 v49, v49, v25
    v_mul_f32 v50, v50, v25
    v_mul_f32 v51, v51, v25
    v_mul_f32 v60, v60, v27
    v_mul_f32 v61, v61, v27
    v_mul_f32 v62, v62, v27
    v_mul_f32 v63, v63, v27
    v_mul_f32 v64, v64, v27
    v_mul_f32 v65, v65, v27
    v_mul_f32 v66, v66, v27
    v_mul_f32 v67, v67, v27
    v_mul_f32 v68, v68, v29
    v_mul_f32 v69, v69, v29
    v_mul_f32 v70, v70, v29
    v_mul_f32 v71, v71, v29
    v_mul_f32 v72, v72, v29
    v_mul_f32 v73, v73, v29
    v_mul_f32 v74, v74, v29
    v_mul_f32 v75, v75, v29
    v_mul_f32 v76, v76, v31
    v_mul_f32 v77, v77, v31
    v_mul_f32 v78, v78, v31
    v_mul_f32 v79, v79, v31
    v_mul_f32 v80, v80, v31
    v_mul_f32 v81, v81, v31
    v_mul_f32 v82, v82, v31
    v_mul_f32 v83, v83, v31
    v_mul_f32 v84, v84, v33
    v_mul_f32 v85, v85, v33
    v_mul_f32 v86, v86, v33
    v_mul_f32 v87, v87, v33
    v_mul_f32 v88, v88, v33
    v_mul_f32 v89, v89, v33
    v_mul_f32 v90, v90, v33
    v_mul_f32 v91, v91, v33
    v_cvt_pk_bf16_f32 v48, v48, v49
    v_cvt_pk_bf16_f32 v49, v50, v51
    ds_write_b64 v20, v[48:49] offset:32
    v_cvt_pk_bf16_f32 v60, v60, v61
    v_cvt_pk_bf16_f32 v61, v62, v63
    ds_write_b64 v20, v[60:61] offset:7936
    v_cvt_pk_bf16_f32 v64, v64, v65
    v_cvt_pk_bf16_f32 v65, v66, v67
    ds_write_b64 v20, v[64:65] offset:7968
    v_cvt_pk_bf16_f32 v68, v68, v69
    v_cvt_pk_bf16_f32 v69, v70, v71
    ds_write_b64 v20, v[68:69] offset:15872
    v_cvt_pk_bf16_f32 v72, v72, v73
    v_cvt_pk_bf16_f32 v73, v74, v75
    ds_write_b64 v20, v[72:73] offset:15904
    v_cvt_pk_bf16_f32 v76, v76, v77
    v_cvt_pk_bf16_f32 v77, v78, v79
    ds_write_b64 v20, v[76:77] offset:23808
    v_cvt_pk_bf16_f32 v80, v80, v81
    v_cvt_pk_bf16_f32 v81, v82, v83
    ds_write_b64 v20, v[80:81] offset:23840
    v_cvt_pk_bf16_f32 v84, v84, v85
    v_cvt_pk_bf16_f32 v85, v86, v87
    ds_write_b64 v20, v[84:85] offset:31744
    v_cvt_pk_bf16_f32 v88, v88, v89
    v_cvt_pk_bf16_f32 v89, v90, v91
    ds_write_b64 v20, v[88:89] offset:31776
    s_branch L_a1_post
L_g2E:
    s_waitcnt vmcnt(2)
    s_barrier
    ds_read_b64_tr_b16 v[16:17], v2 offset:0
    ds_read_b64_tr_b16 v[18:19], v2 offset:2560
    ds_read_b64_tr_b16 v[20:21], v2 offset:32
    ds_read_b64_tr_b16 v[22:23], v2 offset:2592
    ds_read_b64_tr_b16 v[24:25], v2 offset:64
    ds_read_b64_tr_b16 v[26:27], v2 offset:2624
    ds_read_b64_tr_b16 v[28:29], v2 offset:96
    ds_read_b64_tr_b16 v[30:31], v2 offset:2656
    ds_read_b64_tr_b16 v[32:33], v2 offset:128
    ds_read_b64_tr_b16 v[34:35], v2 offset:2688
    ds_read_b64_tr_b16 v[36:37], v2 offset:5120
    ds_read_b64_tr_b16 v[38:39], v2 offset:7680
    ds_read_b64_tr_b16 v[40:41], v2 offset:5152
    ds_read_b64_tr_b16 v[42:43], v2 offset:7712
    ds_read_b64_tr_b16 v[44:45], v2 offset:5184
    ds_read_b64_tr_b16 v[46:47], v2 offset:7744
    s_waitcnt lgkmcnt(14)
    v_mfma_f32_16x16x32_bf16 v[48:51], v[96:99], v[16:19], 0
    s_add_u32 m0, s52, 94208
    s_nop 0
    global_load_lds_dwordx4 v15, s[50:51] sc1
    ds_read_b64_tr_b16 v[16:17], v2 offset:5216
    ds_read_b64_tr_b16 v[18:19], v2 offset:7776
    s_waitcnt lgkmcnt(14)
    v_mfma_f32_16x16x32_bf16 v[52:55], v[96:99], v[20:23], 0
    ds_read_b64_tr_b16 v[20:21], v2 offset:5248
    ds_read_b64_tr_b16 v[22:23], v2 offset:7808
    s_waitcnt lgkmcnt(14)
    v_mfma_f32_16x16x32_bf16 v[56:59], v[96:99], v[24:27], 0
    ds_read_b64_tr_b16 v[24:25], v2 offset:10240
    ds_read_b64_tr_b16 v[26:27], v2 offset:12800
    s_waitcnt lgkmcnt(14)
    v_mfma_f32_16x16x32_bf16 v[60:63], v[96:99], v[28:31], 0
    v_mfma_f32_16x16x32_bf16 v[64:67], v[28:31], v[28:31], 0
    v_mfma_f32_16x16x32_bf16 v[68:71], v[10:13], v[28:31], 0
    ds_read_b64_tr_b16 v[28:29], v2 offset:10272
    ds_read_b64_tr_b16 v[30:31], v2 offset:12832
    s_waitcnt lgkmcnt(14)
    v_mfma_f32_16x16x32_bf16 v[72:75], v[96:99], v[32:35], 0
    v_mfma_f32_16x16x32_bf16 v[76:79], v[32:35], v[32:35], 0
    v_mfma_f32_16x16x32_bf16 v[80:83], v[10:13], v[32:35], 0
    ds_read_b64_tr_b16 v[32:33], v2 offset:10304
    ds_read_b64_tr_b16 v[34:35], v2 offset:12864
    s_waitcnt lgkmcnt(14)
    v_mfma_f32_16x16x32_bf16 v[48:51], v[100:103], v[36:39], v[48:51]
    s_add_u32 m0, s52, 102400
    s_add_u32 s50, s50, 1048576
    s_addc_u32 s51, s51, 0
    global_load_lds_dwordx4 v4, s[50:51] sc1
    ds_read_b64_tr_b16 v[36:37], v2 offset:10336
    ds_read_b64_tr_b16 v[38:39], v2 offset:12896
    s_waitcnt lgkmcnt(14)
    v_mfma_f32_16x16x32_bf16 v[52:55], v[100:103], v[40:43], v[52:55]
    ds_read_b64_tr_b16 v[40:41], v2 offset:10368
    ds_read_b64_tr_b16 v[42:43], v2 offset:12928
    s_waitcnt lgkmcnt(14)
    v_mfma_f32_16x16x32_bf16 v[56:59], v[100:103], v[44:47], v[56:59]
    s_waitcnt vmcnt(2)
    s_barrier
    ds_read_b64_tr_b16 v[44:45], v2 offset:15360
    ds_read_b64_tr_b16 v[46:47], v2 offset:17920
    s_waitcnt lgkmcnt(14)
    v_mfma_f32_16x16x32_bf16 v[60:63], v[100:103], v[16:19], v[60:63]
    v_mfma_f32_16x16x32_bf16 v[64:67], v[16:19], v[16:19], v[64:67]
    v_mfma_f32_16x16x32_bf16 v[68:71], v[10:13], v[16:19], v[68:71]
    ds_read_b64_tr_b16 v[16:17], v2 offset:15392
    ds_read_b64_tr_b16 v[18:19], v2 offset:17952
    s_waitcnt lgkmcnt(14)
    v_mfma_f32_16x16x32_bf16 v[72:75], v[100:103], v[20:23], v[72:75]
    v_mfma_f32_16x16x32_bf16 v[76:79], v[20:23], v[20:23], v[76:79]
    v_mfma_f32_16x16x32_bf16 v[80:83], v[10:13], v[20:23], v[80:83]
    ds_read_b64_tr_b16 v[20:21], v2 offset:15424
    ds_read_b64_tr_b16 v[22:23], v2 offset:17984
    s_waitcnt lgkmcnt(14)
    v_mfma_f32_16x16x32_bf16 v[48:51], v[104:107], v[24:27], v[48:51]
    s_add_u32 m0, s52, 110592
    s_nop 0
    global_load_lds_dwordx4 v5, s[50:51] sc1
    ds_read_b64_tr_b16 v[24:25], v2 offset:15456
    ds_read_b64_tr_b16 v[26:27], v2 offset:18016
    s_waitcnt lgkmcnt(14)
    v_mfma_f32_16x16x32_bf16 v[52:55], v[104:107], v[28:31], v[52:55]
    ds_read_b64_tr_b16 v[28:29], v2 offset:15488
    ds_read_b64_tr_b16 v[30:31], v2 offset:18048
    s_waitcnt lgkmcnt(14)
    v_mfma_f32_16x16x32_bf16 v[56:59], v[104:107], v[32:35], v[56:59]
    ds_read_b64_tr_b16 v[32:33], v2 offset:20480
    ds_read_b64_tr_b16 v[34:35], v2 offset:23040
    s_waitcnt lgkmcnt(14)
    v_mfma_f32_16x16x32_bf16 v[60:63], v[104:107], v[36:39], v[60:63]
    v_mfma_f32_16x16x32_bf16 v[64:67], v[36:39], v[36:39], v[64:67]
    v_mfma_f32_16x16x32_bf16 v[68:71], v[10:13], v[36:39], v[68:71]
    ds_read_b64_tr_b16 v[36:37], v2 offset:20512
    ds_read_b64_tr_b16 v[38:39], v2 offset:23072
    s_waitcnt lgkmcnt(14)
    v_mfma_f32_16x16x32_bf16 v[72:75], v[104:107], v[40:43], v[72:75]
    v_mfma_f32_16x16x32_bf16 v[76:79], v[40:43], v[40:43], v[76:79]
    v_mfma_f32_16x16x32_bf16 v[80:83], v[10:13], v[40:43], v[80:83]
    ds_read_b64_tr_b16 v[40:41], v2 offset:20544
    ds_read_b64_tr_b16 v[42:43], v2 offset:23104
    s_waitcnt lgkmcnt(14)
    v_mfma_f32_16x16x32_bf16 v[48:51], v[108:111], v[44:47], v[48:51]
    s_add_u32 m0, s52, 118784
    s_nop 0
    global_load_lds_dwordx4 v6, s[50:51] sc1
    ds_read_b64_tr_b16 v[44:45], v2 offset:20576
    ds_read_b64_tr_b16 v[46:47], v2 offset:23136
    s_waitcnt lgkmcnt(14)
    v_mfma_f32_16x16x32_bf16 v[52:55], v[108:111], v[16:19], v[52:55]
    ds_read_b64_tr_b16 v[16:17], v2 offset:20608
    ds_read_b64_tr_b16 v[18:19], v2 offset:23168
    s_waitcnt lgkmcnt(14)
    v_mfma_f32_16x16x32_bf16 v[56:59], v[108:111], v[20:23], v[56:59]
    ds_read_b64_tr_b16 v[20:21], v2 offset:25600
    ds_read_b64_tr_b16 v[22:23], v2 offset:28160
    s_waitcnt lgkmcnt(14)
    v_mfma_f32_16x16x32_bf16 v[60:63], v[108:111], v[24:27], v[60:63]
    v_mfma_f32_16x16x32_bf16 v[64:67], v[24:27], v[24:27], v[64:67]
    v_mfma_f32_16x16x32_bf16 v[68:71], v[10:13], v[24:27], v[68:71]
    ds_read_b64_tr_b16 v[24:25], v2 offset:25632
    ds_read_b64_tr_b16 v[26:27], v2 offset:28192
    s_waitcnt lgkmcnt(14)
    v_mfma_f32_16x16x32_bf16 v[72:75], v[108:111], v[28:31], v[72:75]
    v_mfma_f32_16x16x32_bf16 v[76:79], v[28:31], v[28:31], v[76:79]
    v_mfma_f32_16x16x32_bf16 v[80:83], v[10:13], v[28:31], v[80:83]
    ds_read_b64_tr_b16 v[28:29], v2 offset:25664
    ds_read_b64_tr_b16 v[30:31], v2 offset:28224
    s_waitcnt lgkmcnt(14)
    v_mfma_f32_16x16x32_bf16 v[48:51], v[112:115], v[32:35], v[48:51]
    s_add_u32 m0, s52, 126976
    s_nop 0
    global_load_lds_dwordx4 v14, s[50:51] sc1
    ds_read_b64_tr_b16 v[32:33], v2 offset:25696
    ds_read_b64_tr_b16 v[34:35], v2 offset:28256
    s_waitcnt lgkmcnt(14)
    v_mfma_f32_16x16x32_bf16 v[52:55], v[112:115], v[36:39], v[52:55]
    ds_read_b64_tr_b16 v[36:37], v2 offset:25728
    ds_read_b64_tr_b16 v[38:39], v2 offset:28288
    s_waitcnt lgkmcnt(14)
    v_mfma_f32_16x16x32_bf16 v[56:59], v[112:115], v[40:43], v[56:59]
    s_waitcnt vmcnt(2)
    s_barrier
    ds_read_b64_tr_b16 v[40:41], v2 offset:30720
    ds_read_b64_tr_b16 v[42:43], v2 offset:33280
    s_waitcnt lgkmcnt(14)
    v_mfma_f32_16x16x32_bf16 v[60:63], v[112:115], v[44:47], v[60:63]
    v_mfma_f32_16x16x32_bf16 v[64:67], v[44:47], v[44:47], v[64:67]
    v_mfma_f32_16x16x32_bf16 v[68:71], v[10:13], v[44:47], v[68:71]
    ds_read_b64_tr_b16 v[44:45], v2 offset:30752
    ds_read_b64_tr_b16 v[46:47], v2 offset:33312
    s_waitcnt lgkmcnt(14)
    v_mfma_f32_16x16x32_bf16 v[72:75], v[112:115], v[16:19], v[72:75]
    v_mfma_f32_16x16x32_bf16 v[76:79], v[16:19], v[16:19], v[76:79]
    v_mfma_f32_16x16x32_bf16 v[80:83], v[10:13], v[16:19], v[80:83]
    ds_read_b64_tr_b16 v[16:17], v2 offset:30784
    ds_read_b64_tr_b16 v[18:19], v2 offset:33344
    s_waitcnt lgkmcnt(14)
    v_mfma_f32_16x16x32_bf16 v[48:51], v[116:119], v[20:23], v[48:51]
    s_add_u32 m0, s52, 135168
    s_nop 0
    global_load_lds_dwordx4 v15, s[50:51] sc1
    ds_read_b64_tr_b16 v[20:21], v2 offset:30816
    ds_read_b64_tr_b16 v[22:23], v2 offset:33376
    s_waitcnt lgkmcnt(14)
    v_mfma_f32_16x16x32_bf16 v[52:55], v[116:119], v[24:27], v[52:55]
    ds_read_b64_tr_b16 v[24:25], v2 offset:30848
    ds_read_b64_tr_b16 v[26:27], v2 offset:33408
    s_waitcnt lgkmcnt(14)
    v_mfma_f32_16x16x32_bf16 v[56:59], v[116:119], v[28:31], v[56:59]
    ds_read_b64_tr_b16 v[28:29], v2 offset:35840
    ds_read_b64_tr_b16 v[30:31], v2 offset:38400
    s_waitcnt lgkmcnt(14)
    v_mfma_f32_16x16x32_bf16 v[60:63], v[116:119], v[32:35], v[60:63]
    v_mfma_f32_16x16x32_bf16 v[64:67], v[32:35], v[32:35], v[64:67]
    v_mfma_f32_16x16x32_bf16 v[68:71], v[10:13], v[32:35], v[68:71]
    ds_read_b64_tr_b16 v[32:33], v2 offset:35872
    ds_read_b64_tr_b16 v[34:35], v2 offset:38432
    s_waitcnt lgkmcnt(14)
    v_mfma_f32_16x16x32_bf16 v[72:75], v[116:119], v[36:39], v[72:75]
    v_mfma_f32_16x16x32_bf16 v[76:79], v[36:39], v[36:39], v[76:79]
    v_mfma_f32_16x16x32_bf16 v[80:83], v[10:13], v[36:39], v[80:83]
    ds_read_b64_tr_b16 v[36:37], v2 offset:35904
    ds_read_b64_tr_b16 v[38:39], v2 offset:38464
    s_waitcnt lgkmcnt(14)
    v_mfma_f32_16x16x32_bf16 v[48:51], v[120:123], v[40:43], v[48:51]
    s_add_u32 m0, s52, 143360
    s_add_u32 s50, s50, 1048576
    s_addc_u32 s51, s51, 0
    global_load_lds_dwordx4 v4, s[50:51] sc1
    ds_read_b64_tr_b16 v[40:41], v2 offset:35936
    ds_read_b64_tr_b16 v[42:43], v2 offset:38496
    s_waitcnt lgkmcnt(14)
    v_mfma_f32_16x16x32_bf16 v[52:55], v[120:123], v[44:47], v[52:55]
    ds_read_b64_tr_b16 v[44:45], v2 offset:35968
    ds_read_b64_tr_b16 v[46:47], v2 offset:38528
    s_waitcnt lgkmcnt(14)
    v_mfma_f32_16x16x32_bf16 v[56:59], v[120:123], v[16:19], v[56:59]
    ds_read_b64_tr_b16 v[16:17], v2 offset:40960
    ds_read_b64_tr_b16 v[18:19], v2 offset:43520
    s_waitcnt lgkmcnt(14)
    v_mfma_f32_16x16x32_bf16 v[60:63], v[120:123], v[20:23], v[60:63]
    v_mfma_f32_16x16x32_bf16 v[64:67], v[20:23], v[20:23], v[64:67]
    v_mfma_f32_16x16x32_bf16 v[68:71], v[10:13], v[20:23], v[68:71]
    ds_read_b64_tr_b16 v[20:21], v2 offset:40992
    ds_read_b64_tr_b16 v[22:23], v2 offset:43552
    s_waitcnt lgkmcnt(14)
    v_mfma_f32_16x16x32_bf16 v[72:75], v[120:123], v[24:27], v[72:75]
    v_mfma_f32_16x16x32_bf16 v[76:79], v[24:27], v[24:27], v[76:79]
    v_mfma_f32_16x16x32_bf16 v[80:83], v[10:13], v[24:27], v[80:83]
    ds_read_b64_tr_b16 v[24:25], v2 offset:41024
    ds_read_b64_tr_b16 v[26:27], v2 offset:43584
    s_waitcnt lgkmcnt(14)
    v_mfma_f32_16x16x32_bf16 v[48:51], v[124:127], v[28:31], v[48:51]
    s_add_u32 m0, s52, 151552
    s_nop 0
    global_load_lds_dwordx4 v5, s[50:51] sc1
    ds_read_b64_tr_b16 v[28:29], v2 offset:41056
    ds_read_b64_tr_b16 v[30:31], v2 offset:43616
    s_waitcnt lgkmcnt(14)
    v_mfma_f32_16x16x32_bf16 v[52:55], v[124:127], v[32:35], v[52:55]
    ds_read_b64_tr_b16 v[32:33], v2 offset:41088
    ds_read_b64_tr_b16 v[34:35], v2 offset:43648
    s_waitcnt lgkmcnt(14)
    v_mfma_f32_16x16x32_bf16 v[56:59], v[124:127], v[36:39], v[56:59]
    ds_read_b64_tr_b16 v[36:37], v2 offset:46080
    ds_read_b64_tr_b16 v[38:39], v2 offset:48640
    s_waitcnt lgkmcnt(14)
    v_mfma_f32_16x16x32_bf16 v[60:63], v[124:127], v[40:43], v[60:63]
    v_mfma_f32_16x16x32_bf16 v[64:67], v[40:43], v[40:43], v[64:67]
    v_mfma_f32_16x16x32_bf16 v[68:71], v[10:13], v[40:43], v[68:71]
    ds_read_b64_tr_b16 v[40:41], v2 offset:46112
    ds_read_b64_tr_b16 v[42:43], v2 offset:48672
    s_waitcnt lgkmcnt(14)
    v_mfma_f32_16x16x32_bf16 v[72:75], v[124:127], v[44:47], v[72:75]
    v_mfma_f32_16x16x32_bf16 v[76:79], v[44:47], v[44:47], v[76:79]
    v_mfma_f32_16x16x32_bf16 v[80:83], v[10:13], v[44:47], v[80:83]
    ds_read_b64_tr_b16 v[44:45], v2 offset:46144
    ds_read_b64_tr_b16 v[46:47], v2 offset:48704
    s_waitcnt lgkmcnt(14)
    v_mfma_f32_16x16x32_bf16 v[48:51], v[128:131], v[16:19], v[48:51]
    s_cmp_ge_u32 s3, 4
    s_nop 5
    s_cbranch_scc1 L_r1218
    s_add_u32 m0, s52, 159744
    s_nop 0
    global_load_lds_dwordx4 v6, s[50:51] sc1
L_r1218:
    ds_read_b64_tr_b16 v[16:17], v2 offset:46176
    ds_read_b64_tr_b16 v[18:19], v2 offset:48736
    s_waitcnt lgkmcnt(14)
    v_mfma_f32_16x16x32_bf16 v[52:55], v[128:131], v[20:23], v[52:55]
    ds_read_b64_tr_b16 v[20:21], v2 offset:46208
    ds_read_b64_tr_b16 v[22:23], v2 offset:48768
    s_waitcnt lgkmcnt(14)
    v_mfma_f32_16x16x32_bf16 v[56:59], v[128:131], v[24:27], v[56:59]
    ds_read_b64_tr_b16 v[24:25], v2 offset:51200
    ds_read_b64_tr_b16 v[26:27], v2 offset:53760
    s_waitcnt lgkmcnt(14)
    v_mfma_f32_16x16x32_bf16 v[60:63], v[128:131], v[28:31], v[60:63]
    v_mfma_f32_16x16x32_bf16 v[64:67], v[28:31], v[28:31], v[64:67]
    v_mfma_f32_16x16x32_bf16 v[68:71], v[10:13], v[28:31], v[68:71]
    ds_read_b64_tr_b16 v[28:29], v2 offset:51232
    ds_read_b64_tr_b16 v[30:31], v2 offset:53792
    s_waitcnt lgkmcnt(14)
    v_mfma_f32_16x16x32_bf16 v[72:75], v[128:131], v[32:35], v[72:75]
    v_mfma_f32_16x16x32_bf16 v[76:79], v[32:35], v[32:35], v[76:79]
    v_mfma_f32_16x16x32_bf16 v[80:83], v[10:13], v[32:35], v[80:83]
    ds_read_b64_tr_b16 v[32:33], v2 offset:51264
    ds_read_b64_tr_b16 v[34:35], v2 offset:53824
    s_waitcnt lgkmcnt(14)
    v_mfma_f32_16x16x32_bf16 v[48:51], v[132:135], v[36:39], v[48:51]
    ds_read_b64_tr_b16 v[36:37], v2 offset:51296
    ds_read_b64_tr_b16 v[38:39], v2 offset:53856
    s_waitcnt lgkmcnt(14)
    v_mfma_f32_16x16x32_bf16 v[52:55], v[132:135], v[40:43], v[52:55]
    ds_read_b64_tr_b16 v[40:41], v2 offset:51328
    ds_read_b64_tr_b16 v[42:43], v2 offset:53888
    s_waitcnt lgkmcnt(14)
    v_mfma_f32_16x16x32_bf16 v[56:59], v[132:135], v[44:47], v[56:59]
    s_waitcnt vmcnt(2)
    s_barrier
    ds_read_b64_tr_b16 v[44:45], v2 offset:56320
    ds_read_b64_tr_b16 v[46:47], v2 offset:58880
    s_waitcnt lgkmcnt(14)
    v_mfma_f32_16x16x32_bf16 v[60:63], v[132:135], v[16:19], v[60:63]
    v_mfma_f32_16x16x32_bf16 v[64:67], v[16:19], v[16:19], v[64:67]
    v_mfma_f32_16x16x32_bf16 v[68:71], v[10:13], v[16:19], v[68:71]
    ds_read_b64_tr_b16 v[16:17], v2 offset:56352
    ds_read_b64_tr_b16 v[18:19], v2 offset:58912
    s_waitcnt lgkmcnt(14)
    v_mfma_f32_16x16x32_bf16 v[72:75], v[132:135], v[20:23], v[72:75]
    v_mfma_f32_16x16x32_bf16 v[76:79], v[20:23], v[20:23], v[76:79]
    v_mfma_f32_16x16x32_bf16 v[80:83], v[10:13], v[20:23], v[80:83]
    ds_read_b64_tr_b16 v[20:21], v2 offset:56384
    ds_read_b64_tr_b16 v[22:23], v2 offset:58944
    s_waitcnt lgkmcnt(14)
    v_mfma_f32_16x16x32_bf16 v[48:51], v[136:139], v[24:27], v[48:51]
    ds_read_b64_tr_b16 v[24:25], v2 offset:56416
    ds_read_b64_tr_b16 v[26:27], v2 offset:58976
    s_waitcnt lgkmcnt(14)
    v_mfma_f32_16x16x32_bf16 v[52:55], v[136:139], v[28:31], v[52:55]
    ds_read_b64_tr_b16 v[28:29], v2 offset:56448
    ds_read_b64_tr_b16 v[30:31], v2 offset:59008
    s_waitcnt lgkmcnt(14)
    v_mfma_f32_16x16x32_bf16 v[56:59], v[136:139], v[32:35], v[56:59]
    ds_read_b64_tr_b16 v[32:33], v3 offset:0
    ds_read_b64_tr_b16 v[34:35], v3 offset:2560
    s_waitcnt lgkmcnt(14)
    v_mfma_f32_16x16x32_bf16 v[60:63], v[136:139], v[36:39], v[60:63]
    v_mfma_f32_16x16x32_bf16 v[64:67], v[36:39], v[36:39], v[64:67]
    v_mfma_f32_16x16x32_bf16 v[68:71], v[10:13], v[36:39], v[68:71]
    ds_read_b64_tr_b16 v[36:37], v3 offset:32
    ds_read_b64_tr_b16 v[38:39], v3 offset:2592
    s_waitcnt lgkmcnt(14)
    v_mfma_f32_16x16x32_bf16 v[72:75], v[136:139], v[40:43], v[72:75]
    v_mfma_f32_16x16x32_bf16 v[76:79], v[40:43], v[40:43], v[76:79]
    v_mfma_f32_16x16x32_bf16 v[80:83], v[10:13], v[40:43], v[80:83]
    ds_read_b64_tr_b16 v[40:41], v3 offset:64
    ds_read_b64_tr_b16 v[42:43], v3 offset:2624
    s_waitcnt lgkmcnt(14)
    v_mfma_f32_16x16x32_bf16 v[48:51], v[140:143], v[44:47], v[48:51]
    ds_read_b64_tr_b16 v[44:45], v3 offset:96
    ds_read_b64_tr_b16 v[46:47], v3 offset:2656
    s_waitcnt lgkmcnt(14)
    v_mfma_f32_16x16x32_bf16 v[52:55], v[140:143], v[16:19], v[52:55]
    ds_read_b64_tr_b16 v[16:17], v3 offset:128
    ds_read_b64_tr_b16 v[18:19], v3 offset:2688
    s_waitcnt lgkmcnt(14)
    v_mfma_f32_16x16x32_bf16 v[56:59], v[140:143], v[20:23], v[56:59]
    ds_read_b64_tr_b16 v[20:21], v3 offset:5120
    ds_read_b64_tr_b16 v[22:23], v3 offset:7680
    s_waitcnt lgkmcnt(14)
    v_mfma_f32_16x16x32_bf16 v[60:63], v[140:143], v[24:27], v[60:63]
    v_mfma_f32_16x16x32_bf16 v[64:67], v[24:27], v[24:27], v[64:67]
    v_mfma_f32_16x16x32_bf16 v[68:71], v[10:13], v[24:27], v[68:71]
    ds_read_b64_tr_b16 v[24:25], v3 offset:5152
    ds_read_b64_tr_b16 v[26:27], v3 offset:7712
    s_waitcnt lgkmcnt(14)
    v_mfma_f32_16x16x32_bf16 v[72:75], v[140:143], v[28:31], v[72:75]
    v_mfma_f32_16x16x32_bf16 v[76:79], v[28:31], v[28:31], v[76:79]
    v_mfma_f32_16x16x32_bf16 v[80:83], v[10:13], v[28:31], v[80:83]
    ds_read_b64_tr_b16 v[28:29], v3 offset:5184
    ds_read_b64_tr_b16 v[30:31], v3 offset:7744
    s_waitcnt lgkmcnt(14)
    v_mfma_f32_16x16x32_bf16 v[48:51], v[144:147], v[32:35], v[48:51]
    ds_read_b64_tr_b16 v[32:33], v3 offset:5216
    ds_read_b64_tr_b16 v[34:35], v3 offset:7776
    s_waitcnt lgkmcnt(14)
    v_mfma_f32_16x16x32_bf16 v[52:55], v[144:147], v[36:39], v[52:55]
    ds_read_b64_tr_b16 v[36:37], v3 offset:5248
    ds_read_b64_tr_b16 v[38:39], v3 offset:7808
    s_waitcnt lgkmcnt(14)
    v_mfma_f32_16x16x32_bf16 v[56:59], v[144:147], v[40:43], v[56:59]
    ds_read_b64_tr_b16 v[40:41], v3 offset:10240
    ds_read_b64_tr_b16 v[42:43], v3 offset:12800
    s_waitcnt lgkmcnt(14)
    v_mfma_f32_16x16x32_bf16 v[60:63], v[144:147], v[44:47], v[60:63]
    v_mfma_f32_16x16x32_bf16 v[64:67], v[44:47], v[44:47], v[64:67]
    v_mfma_f32_16x16x32_bf16 v[68:71], v[10:13], v[44:47], v[68:71]
    ds_read_b64_tr_b16 v[44:45], v3 offset:10272
    ds_read_b64_tr_b16 v[46:47], v3 offset:12832
    s_waitcnt lgkmcnt(14)
    v_mfma_f32_16x16x32_bf16 v[72:75], v[144:147], v[16:19], v[72:75]
    v_mfma_f32_16x16x32_bf16 v[76:79], v[16:19], v[16:19], v[76:79]
    v_mfma_f32_16x16x32_bf16 v[80:83], v[10:13], v[16:19], v[80:83]
    ds_read_b64_tr_b16 v[16:17], v3 offset:10304
    ds_read_b64_tr_b16 v[18:19], v3 offset:12864
    s_waitcnt lgkmcnt(14)
    v_mfma_f32_16x16x32_bf16 v[48:51], v[148:151], v[20:23], v[48:51]
    ds_read_b64_tr_b16 v[20:21], v3 offset:10336
    ds_read_b64_tr_b16 v[22:23], v3 offset:12896
    s_waitcnt lgkmcnt(14)
    v_mfma_f32_16x16x32_bf16 v[52:55], v[148:151], v[24:27], v[52:55]
    ds_read_b64_tr_b16 v[24:25], v3 offset:10368
    ds_read_b64_tr_b16 v[26:27], v3 offset:12928
    s_waitcnt lgkmcnt(14)
    v_mfma_f32_16x16x32_bf16 v[56:59], v[148:151], v[28:31], v[56:59]
    ds_read_b64_tr_b16 v[28:29], v3 offset:15360
    ds_read_b64_tr_b16 v[30:31], v3 offset:17920
    s_waitcnt lgkmcnt(14)
    v_mfma_f32_16x16x32_bf16 v[60:63], v[148:151], v[32:35], v[60:63]
    v_mfma_f32_16x16x32_bf16 v[64:67], v[32:35], v[32:35], v[64:67]
    v_mfma_f32_16x16x32_bf16 v[68:71], v[10:13], v[32:35], v[68:71]
    ds_read_b64_tr_b16 v[32:33], v3 offset:15392
    ds_read_b64_tr_b16 v[34:35], v3 offset:17952
    s_waitcnt lgkmcnt(14)
    v_mfma_f32_16x16x32_bf16 v[72:75], v[148:151], v[36:39], v[72:75]
    v_mfma_f32_16x16x32_bf16 v[76:79], v[36:39], v[36:39], v[76:79]
    v_mfma_f32_16x16x32_bf16 v[80:83], v[10:13], v[36:39], v[80:83]
    ds_read_b64_tr_b16 v[36:37], v3 offset:15424
    ds_read_b64_tr_b16 v[38:39], v3 offset:17984
    s_waitcnt lgkmcnt(14)
    v_mfma_f32_16x16x32_bf16 v[48:51], v[152:155], v[40:43], v[48:51]
    ds_read_b64_tr_b16 v[40:41], v3 offset:15456
    ds_read_b64_tr_b16 v[42:43], v3 offset:18016
    s_waitcnt lgkmcnt(14)
    v_mfma_f32_16x16x32_bf16 v[52:55], v[152:155], v[44:47], v[52:55]
    ds_read_b64_tr_b16 v[44:45], v3 offset:15488
    ds_read_b64_tr_b16 v[46:47], v3 offset:18048
    s_waitcnt lgkmcnt(14)
    v_mfma_f32_16x16x32_bf16 v[56:59], v[152:155], v[16:19], v[56:59]
    s_waitcnt vmcnt(0)
    s_barrier
    ds_read_b64_tr_b16 v[16:17], v3 offset:20480
    ds_read_b64_tr_b16 v[18:19], v3 offset:23040
    s_waitcnt lgkmcnt(14)
    v_mfma_f32_16x16x32_bf16 v[60:63], v[152:155], v[20:23], v[60:63]
    v_mfma_f32_16x16x32_bf16 v[64:67], v[20:23], v[20:23], v[64:67]
    v_mfma_f32_16x16x32_bf16 v[68:71], v[10:13], v[20:23], v[68:71]
    ds_read_b64_tr_b16 v[20:21], v3 offset:20512
    ds_read_b64_tr_b16 v[22:23], v3 offset:23072
    s_waitcnt lgkmcnt(14)
    v_mfma_f32_16x16x32_bf16 v[72:75], v[152:155], v[24:27], v[72:75]
    v_mfma_f32_16x16x32_bf16 v[76:79], v[24:27], v[24:27], v[76:79]
    v_mfma_f32_16x16x32_bf16 v[80:83], v[10:13], v[24:27], v[80:83]
    ds_read_b64_tr_b16 v[24:25], v3 offset:20544
    ds_read_b64_tr_b16 v[26:27], v3 offset:23104
    s_waitcnt lgkmcnt(14)
    v_mfma_f32_16x16x32_bf16 v[48:51], v[156:159], v[28:31], v[48:51]
    ds_read_b64_tr_b16 v[28:29], v3 offset:20576
    ds_read_b64_tr_b16 v[30:31], v3 offset:23136
    s_waitcnt lgkmcnt(14)
    v_mfma_f32_16x16x32_bf16 v[52:55], v[156:159], v[32:35], v[52:55]
    ds_read_b64_tr_b16 v[32:33], v3 offset:20608
    ds_read_b64_tr_b16 v[34:35], v3 offset:23168
    s_waitcnt lgkmcnt(14)
    v_mfma_f32_16x16x32_bf16 v[56:59], v[156:159], v[36:39], v[56:59]
    ds_read_b64_tr_b16 v[36:37], v3 offset:25600
    ds_read_b64_tr_b16 v[38:39], v3 offset:28160
    s_waitcnt lgkmcnt(14)
    v_mfma_f32_16x16x32_bf16 v[60:63], v[156:159], v[40:43], v[60:63]
    v_mfma_f32_16x16x32_bf16 v[64:67], v[40:43], v[40:43], v[64:67]
    v_mfma_f32_16x16x32_bf16 v[68:71], v[10:13], v[40:43], v[68:71]
    ds_read_b64_tr_b16 v[40:41], v3 offset:25632
    ds_read_b64_tr_b16 v[42:43], v3 offset:28192
    s_waitcnt lgkmcnt(14)
    v_mfma_f32_16x16x32_bf16 v[72:75], v[156:159], v[44:47], v[72:75]
    v_mfma_f32_16x16x32_bf16 v[76:79], v[44:47], v[44:47], v[76:79]
    v_mfma_f32_16x16x32_bf16 v[80:83], v[10:13], v[44:47], v[80:83]
    ds_read_b64_tr_b16 v[44:45], v3 offset:25664
    ds_read_b64_tr_b16 v[46:47], v3 offset:28224
    s_waitcnt lgkmcnt(14)
    v_mfma_f32_16x16x32_bf16 v[48:51], v[160:163], v[16:19], v[48:51]
    ds_read_b64_tr_b16 v[16:17], v3 offset:25696
    ds_read_b64_tr_b16 v[18:19], v3 offset:28256
    s_waitcnt lgkmcnt(14)
    v_mfma_f32_16x16x32_bf16 v[52:55], v[160:163], v[20:23], v[52:55]
    ds_read_b64_tr_b16 v[20:21], v3 offset:25728
    ds_read_b64_tr_b16 v[22:23], v3 offset:28288
    s_waitcnt lgkmcnt(14)
    v_mfma_f32_16x16x32_bf16 v[56:59], v[160:163], v[24:27], v[56:59]
    ds_read_b64_tr_b16 v[24:25], v3 offset:30720
    ds_read_b64_tr_b16 v[26:27], v3 offset:33280
    s_waitcnt lgkmcnt(14)
    v_mfma_f32_16x16x32_bf16 v[60:63], v[160:163], v[28:31], v[60:63]
    v_mfma_f32_16x16x32_bf16 v[64:67], v[28:31], v[28:31], v[64:67]
    v_mfma_f32_16x16x32_bf16 v[68:71], v[10:13], v[28:31], v[68:71]
    ds_read_b64_tr_b16 v[28:29], v3 offset:30752
    ds_read_b64_tr_b16 v[30:31], v3 offset:33312
    s_waitcnt lgkmcnt(14)
    v_mfma_f32_16x16x32_bf16 v[72:75], v[160:163], v[32:35], v[72:75]
    v_mfma_f32_16x16x32_bf16 v[76:79], v[32:35], v[32:35], v[76:79]
    v_mfma_f32_16x16x32_bf16 v[80:83], v[10:13], v[32:35], v[80:83]
    ds_read_b64_tr_b16 v[32:33], v3 offset:30784
    ds_read_b64_tr_b16 v[34:35], v3 offset:33344
    s_waitcnt lgkmcnt(14)
    v_mfma_f32_16x16x32_bf16 v[48:51], v[164:167], v[36:39], v[48:51]
    ds_read_b64_tr_b16 v[36:37], v3 offset:30816
    ds_read_b64_tr_b16 v[38:39], v3 offset:33376
    s_waitcnt lgkmcnt(14)
    v_mfma_f32_16x16x32_bf16 v[52:55], v[164:167], v[40:43], v[52:55]
    ds_read_b64_tr_b16 v[40:41], v3 offset:30848
    ds_read_b64_tr_b16 v[42:43], v3 offset:33408
    s_waitcnt lgkmcnt(14)
    v_mfma_f32_16x16x32_bf16 v[56:59], v[164:167], v[44:47], v[56:59]
    ds_read_b64_tr_b16 v[44:45], v3 offset:35840
    ds_read_b64_tr_b16 v[46:47], v3 offset:38400
    s_waitcnt lgkmcnt(14)
    v_mfma_f32_16x16x32_bf16 v[60:63], v[164:167], v[16:19], v[60:63]
    v_mfma_f32_16x16x32_bf16 v[64:67], v[16:19], v[16:19], v[64:67]
    v_mfma_f32_16x16x32_bf16 v[68:71], v[10:13], v[16:19], v[68:71]
    ds_read_b64_tr_b16 v[16:17], v3 offset:35872
    ds_read_b64_tr_b16 v[18:19], v3 offset:38432
    s_waitcnt lgkmcnt(14)
    v_mfma_f32_16x16x32_bf16 v[72:75], v[164:167], v[20:23], v[72:75]
    v_mfma_f32_16x16x32_bf16 v[76:79], v[20:23], v[20:23], v[76:79]
    v_mfma_f32_16x16x32_bf16 v[80:83], v[10:13], v[20:23], v[80:83]
    ds_read_b64_tr_b16 v[20:21], v3 offset:35904
    ds_read_b64_tr_b16 v[22:23], v3 offset:38464
    s_waitcnt lgkmcnt(14)
    v_mfma_f32_16x16x32_bf16 v[48:51], v[168:171], v[24:27], v[48:51]
    ds_read_b64_tr_b16 v[24:25], v3 offset:35936
    ds_read_b64_tr_b16 v[26:27], v3 offset:38496
    s_waitcnt lgkmcnt(14)
    v_mfma_f32_16x16x32_bf16 v[52:55], v[168:171], v[28:31], v[52:55]
    ds_read_b64_tr_b16 v[28:29], v3 offset:35968
    ds_read_b64_tr_b16 v[30:31], v3 offset:38528
    s_waitcnt lgkmcnt(14)
    v_mfma_f32_16x16x32_bf16 v[56:59], v[168:171], v[32:35], v[56:59]
    s_waitcnt lgkmcnt(12)
    v_mfma_f32_16x16x32_bf16 v[60:63], v[168:171], v[36:39], v[60:63]
    v_mfma_f32_16x16x32_bf16 v[64:67], v[36:39], v[36:39], v[64:67]
    v_mfma_f32_16x16x32_bf16 v[68:71], v[10:13], v[36:39], v[68:71]
    s_waitcnt lgkmcnt(10)
    v_mfma_f32_16x16x32_bf16 v[72:75], v[168:171], v[40:43], v[72:75]
    v_mfma_f32_16x16x32_bf16 v[76:79], v[40:43], v[40:43], v[76:79]
    v_mfma_f32_16x16x32_bf16 v[80:83], v[10:13], v[40:43], v[80:83]
    s_waitcnt lgkmcnt(8)
    v_mfma_f32_16x16x32_bf16 v[48:51], v[172:175], v[44:47], v[48:51]
    s_waitcnt lgkmcnt(6)
    v_mfma_f32_16x16x32_bf16 v[52:55], v[172:175], v[16:19], v[52:55]
    s_waitcnt lgkmcnt(4)
    v_mfma_f32_16x16x32_bf16 v[56:59], v[172:175], v[20:23], v[56:59]
    s_waitcnt lgkmcnt(2)
    v_mfma_f32_16x16x32_bf16 v[60:63], v[172:175], v[24:27], v[60:63]
    v_mfma_f32_16x16x32_bf16 v[64:67], v[24:27], v[24:27], v[64:67]
    v_mfma_f32_16x16x32_bf16 v[68:71], v[10:13], v[24:27], v[68:71]
    s_waitcnt lgkmcnt(0)
    v_mfma_f32_16x16x32_bf16 v[72:75], v[172:175], v[28:31], v[72:75]
    v_mfma_f32_16x16x32_bf16 v[76:79], v[28:31], v[28:31], v[76:79]
    v_mfma_f32_16x16x32_bf16 v[80:83], v[10:13], v[28:31], v[80:83]
    ds_read_b64 v[10:11], v7
    ds_read_b64 v[12:13], v8
    ds_read_b64 v[14:15], v9
    v_and_b32 v16, 15, v1
    v_lshrrev_b32 v17, 4, v1
    v_and_b32 v18, 3, v1
    v_lshrrev_b32 v19, 2, v16
    v_cmp_eq_u32 s[42:43], 1, v18
    v_cmp_eq_u32 s[44:45], 2, v18
    v_cmp_eq_u32 s[46:47], 3, v18
    v_cmp_eq_u32 s[48:49], v19, v17
    v_lshlrev_b32 v18, 3, v16
    v_add_u32 v18, 45376, v18
    v_cndmask_b32 v64, v64, v65, s[42:43]
    v_cndmask_b32 v76, v76, v77, s[42:43]
    v_cndmask_b32 v64, v64, v66, s[44:45]
    v_cndmask_b32 v76, v76, v78, s[44:45]
    v_cndmask_b32 v64, v64, v67, s[46:47]
    v_cndmask_b32 v76, v76, v79, s[46:47]
    v_mul_f32 v68, 0x3acccccd, v68
    v_mul_f32 v64, 0x3acccccd, v64
    v_mul_f32 v80, 0x3acccccd, v80
    v_mul_f32 v76, 0x3acccccd, v76
    v_fma_f32 v64, -v68, v68, v64
    v_fma_f32 v76, -v80, v80, v76
    v_max_f32 v64, 0, v64
    v_max_f32 v76, 0, v76
    v_cvt_pk_bf16_f32 v68, v68, v64
    v_cvt_pk_bf16_f32 v80, v80, v76
    v_and_b32 v64, 0xffff0000, v68
    v_lshlrev_b32 v68, 16, v68
    v_and_b32 v76, 0xffff0000, v80
    v_lshlrev_b32 v80, 16, v80
    v_add_f32 v64, 0x3727c5ac, v64
    v_add_f32 v76, 0x3727c5ac, v76
    v_cvt_pk_bf16_f32 v64, v64, v64
    v_cvt_pk_bf16_f32 v76, v76, v76
    v_lshlrev_b32 v64, 16, v64
    v_lshlrev_b32 v76, 16, v76
    v_sqrt_f32 v64, v64
    v_sqrt_f32 v76, v76
    v_cvt_pk_bf16_f32 v64, v64, v64
    v_cvt_pk_bf16_f32 v76, v76, v76
    v_lshlrev_b32 v64, 16, v64
    v_lshlrev_b32 v76, 16, v76
    v_rcp_f32 v69, v64
    v_rcp_f32 v81, v76
    s_mov_b64 exec, s[48:49]
    ds_write_b64 v18, v[68:69] offset:384
    ds_write_b64 v18, v[80:81] offset:512
    s_mov_b64 exec, -1
    s_lshl_b32 s42, s3, 7
    s_add_u32 s42, s42, 46016
    v_lshl_add_u32 v19, v17, 4, s42
    s_lshl_b32 s42, s3, 6
    s_cmp_eq_u32 s3, 2
    s_cselect_b32 s42, 192, s42
    s_cmp_eq_u32 s3, 3
    s_cselect_b32 s42, 128, s42
    s_add_u32 s42, s42, 61440
    v_mul_u32_u24 v20, 496, v16
    v_lshl_add_u32 v20, v17, 3, v20
    v_add_u32 v20, s42, v20
    v_lshlrev_b32 v18, 3, v16
    v_add_u32 v18, 45376, v18
    s_waitcnt lgkmcnt(0)
    s_barrier
    ds_read_b64 v[24:25], v18 offset:0
    ds_read_b64 v[26:27], v18 offset:128
    ds_read_b64 v[28:29], v18 offset:256
    ds_read_b64 v[30:31], v18 offset:384
    ds_read_b64 v[32:33], v18 offset:512
    ds_read_b128 v[36:39], v19 offset:0
    s_waitcnt lgkmcnt(0)
    v_fma_f32 v48, -v24, v36, v48
    v_fma_f32 v49, -v24, v37, v49
    v_fma_f32 v50, -v24, v38, v50
    v_fma_f32 v51, -v24, v39, v51
    v_fma_f32 v52, -v26, v36, v52
    v_fma_f32 v53, -v26, v37, v53
    v_fma_f32 v54, -v26, v38, v54
    v_fma_f32 v55, -v26, v39, v55
    v_fma_f32 v56, -v28, v36, v56
    v_fma_f32 v57, -v28, v37, v57
    v_fma_f32 v58, -v28, v38, v58
    v_fma_f32 v59, -v28, v39, v59
    v_fma_f32 v60, -v30, v36, v60
    v_fma_f32 v61, -v30, v37, v61
    v_fma_f32 v62, -v30, v38, v62
    v_fma_f32 v63, -v30, v39, v63
    v_fma_f32 v72, -v32, v36, v72
    v_fma_f32 v73, -v32, v37, v73
    v_fma_f32 v74, -v32, v38, v74
    v_fma_f32 v75, -v32, v39, v75
    v_mul_f32 v48, v48, v25
    v_mul_f32 v49, v49, v25
    v_mul_f32 v50, v50, v25
    v_mul_f32 v51, v51, v25
    v_mul_f32 v52, v52, v27
    v_mul_f32 v53, v53, v27
    v_mul_f32 v54, v54, v27
    v_mul_f32 v55, v55, v27
    v_mul_f32 v56, v56, v29
    v_mul_f32 v57, v57, v29
    v_mul_f32 v58, v58, v29
    v_mul_f32 v59, v59, v29
    v_mul_f32 v60, v60, v31
    v_mul_f32 v61, v61, v31
    v_mul_f32 v62, v62, v31
    v_mul_f32 v63, v63, v31
    v_mul_f32 v72, v72, v33
    v_mul_f32 v73, v73, v33
    v_mul_f32 v74, v74, v33
    v_mul_f32 v75, v75, v33
    v_cvt_pk_bf16_f32 v48, v48, v49
    v_cvt_pk_bf16_f32 v49, v50, v51
    ds_write_b64 v20, v[48:49] offset:0
    v_cvt_pk_bf16_f32 v52, v52, v53
    v_cvt_pk_bf16_f32 v53, v54, v55
    ds_write_b64 v20, v[52:53] offset:7936
    v_cvt_pk_bf16_f32 v56, v56, v57
    v_cvt_pk_bf16_f32 v57, v58, v59
    ds_write_b64 v20, v[56:57] offset:15872
    v_cvt_pk_bf16_f32 v60, v60, v61
    v_cvt_pk_bf16_f32 v61, v62, v63
    ds_write_b64 v20, v[60:61] offset:23808
    v_cvt_pk_bf16_f32 v72, v72, v73
    v_cvt_pk_bf16_f32 v73, v74, v75
    ds_write_b64 v20, v[72:73] offset:31744
    s_branch L_a1_post
L_final:
    s_cmp_ge_u32 s2, 160
    s_cbranch_scc1 L_fin
    s_mul_i32 s42, s2, 205
    s_lshr_b32 s42, s42, 11
    s_mul_i32 s43, s42, 10
    s_sub_u32 s43, s2, s43
    s_lshl_b32 s44, s43, 18
    s_lshl_b32 s45, s42, 8
    s_add_u32 s44, s44, s45
    s_lshl_b32 s45, s3, 15
    s_add_u32 s44, s44, s45
    s_add_u32 s44, s44, 22544384
    v_and_b32 v2, 15, v1
    v_lshrrev_b32 v3, 4, v1
    v_lshlrev_b32 v4, 12, v3
    v_lshl_add_u32 v4, v2, 4, v4
    v_add_u32 v4, s44, v4
    v_add_u32 v5, 16384, v4
    s_lshl_b32 s44, s3, 5
    s_add_u32 s44, s44, 61440
    v_lshrrev_b32 v6, 2, v2
    v_lshl_add_u32 v6, v3, 3, v6
    v_lshlrev_b32 v6, 8, v6
    v_and_b32 v7, 3, v1
    v_lshl_add_u32 v6, v7, 3, v6
    v_add_u32 v6, s44, v6
    s_lshl_b32 s44, s42, 3
    s_add_u32 s44, s44, s3
    s_mul_i32 s44, s44, 20480
    s_lshl_b32 s45, s43, 7
    s_add_u32 s44, s44, s45
    v_mul_u32_u24 v7, 1280, v2
    v_lshl_add_u32 v7, v3, 4, v7
    v_add_u32 v7, s44, v7
    s_lshl_b32 s46, s3, 11
    s_cmp_eq_u32 s3, 0
    s_cbranch_scc0 L_f_go
    s_mul_i32 s44, s43, 13120
    s_lshr_b32 s44, s44, 10
    s_lshl_b32 s44, s44, 1
    v_min_u32 v8, 27, v1
    v_add_u32 v8, s44, v8
    v_min_u32 v8, 255, v8
    v_lshlrev_b32 v8, 7, v8
    v_add_u32 v8, 200704, v8
    s_mov_b32 s57, 0
L_poll19:
    global_load_dwordx2 v[10:11], v8, s[32:33] sc1
    s_add_u32 s57, s57, 1
    s_waitcnt vmcnt(0)
    v_cmp_ne_u64 vcc, s[34:35], v[10:11]
    s_cmp_gt_u32 s57, 200000
    s_nop 2
    s_cbranch_scc1 L_end
    s_cbranch_vccnz L_poll19
L_f_go:
    s_barrier
    s_add_u32 m0, s46, 61440
    s_nop 0
    global_load_lds_dwordx4 v4, s[32:33] sc1
    s_add_u32 m0, s46, 62464
    s_nop 0
    global_load_lds_dwordx4 v5, s[32:33] sc1
    s_waitcnt vmcnt(0)
    s_barrier
    ds_read_b64_tr_b16 v[8:9], v6
    ds_read_b64_tr_b16 v[10:11], v6 offset:1024
    ds_read_b64_tr_b16 v[12:13], v6 offset:8192
    ds_read_b64_tr_b16 v[14:15], v6 offset:9216
    s_waitcnt lgkmcnt(2)
    global_store_dwordx4 v7, v[8:11], s[28:29]
    s_waitcnt lgkmcnt(0)
    global_store_dwordx4 v7, v[12:15], s[28:29] offset:64
L_fin:
    s_or_b32 s42, s2, s3
    s_cmp_eq_u32 s42, 0
    s_cbranch_scc0 L_fin2
    s_mov_b32 s42, 0
    v_lshl_add_u32 v2, v1, 4, s42
    v_mov_b32 v4, s34
    v_mov_b32 v5, s35
    v_mov_b32 v6, s34
    v_mov_b32 v7, s35
    s_mov_b64 exec, 0xff
    global_store_dwordx4 v2, v[4:7], s[32:33] sc1
    s_mov_b64 exec, -1
L_fin2:
L_end:
    s_endpgm
.p2align 7
L_tab1:
.short 3072, 3072, 3072, 3072, 3072, 3072, 3072, 3072, 3072, 3072, 3072, 3072, 3072, 3072, 3072, 3072
.short 3072, 3072, 3072, 3072, 3072, 3072, 3072, 3072, 3072, 3072, 3072, 3072, 2048, 2048, 3072, 3072
.short 3072, 3072, 3072, 3072, 3072, 3072, 3072, 3072, 3072, 3072, 3072, 3072, 3072, 3072, 3072, 3072
.short 3072, 3072, 3072, 3072, 3072, 3072, 3072, 3072, 3072, 3072, 3072, 3072, 3072, 3072, 1536, 1536
.short 1536, 1536, 1532, 1528, 1528, 1528, 1524, 1520, 1520, 1520, 1516, 1512, 1512, 1512, 1508, 1504
.short 1504, 1504, 1500, 1496, 1496, 1496, 1492, 1488, 1488, 1488, 1484, 1480, 1480, 1480, 1476, 1472
.short 1472, 1472, 1468, 1464, 1464, 1464, 1460, 1456, 1456, 1456, 1452, 1448, 1448, 1448, 1444, 1440
.short 1440, 1440, 1436, 1432, 1432, 1432, 1428, 1424, 1424, 1424, 1420, 1416, 1416, 1416, 1412, 1408
.short 1408, 1408, 1404, 1400, 1400, 1400, 1396, 1392, 1392, 1392, 1388, 1384, 1384, 1384, 1380, 1376
.short 1376, 1376, 1372, 1368, 1368, 1368, 1364, 1360, 1360, 1360, 1356, 1352, 1352, 1352, 1348, 1344
.short 1344, 1344, 1340, 1336, 1336, 1336, 1332, 1328, 1328, 1328, 1324, 1320, 1320, 1320, 1316, 1312
.short 1312, 1312, 1308, 1304, 1304, 1304, 1300, 1296, 1296, 1296, 1292, 1288, 1288, 1288, 1284, 1280
.short 1280, 1280, 1276, 1272, 1272, 1272, 1268, 1264, 1264, 1264, 1260, 1256, 1256, 1256, 1252, 1248
.short 1248, 1248, 1244, 1240, 1240, 1240, 1236, 1232, 1232, 1232, 1228, 1224, 1224, 1224, 1220, 1216
.short 1216, 1216, 1212, 1208, 1208, 1208, 1204, 1200, 1200, 1200, 1196, 1192, 1192, 1192, 1188, 1184
.short 1184, 1184, 1180, 1176, 1176, 1176, 1172, 1168, 1168, 1168, 1164, 1160, 1160, 1160, 1156, 1152
.short 1152, 1152, 1148, 1144, 1144, 1144, 1140, 1136, 1136, 1136, 1132, 1128, 1128, 1128, 1124, 1120
.short 1120, 1120, 1116, 1112, 1112, 1112, 1108, 1104, 1104, 1104, 1100, 1096, 1096, 1096, 1092, 1088
.short 1088, 1088, 1084, 1080, 1080, 1080, 1076, 1072, 1072, 1072, 1068, 1064, 1064, 1064, 1060, 1056
.short 1056, 1056, 1052, 1048, 1048, 1048, 1044, 1040, 1040, 1040, 1036, 1032, 1032, 1032, 1028, 1024
.short 1024, 1020, 1016, 1012, 1008, 764, 760, 756, 752, 1004, 1000, 996, 992, 748, 744, 740
.short 736, 988, 984, 980, 976, 732, 728, 724, 720, 972, 968, 964, 960, 716, 712, 708
.short 704, 956, 952, 948, 944, 700, 696, 692, 688, 940, 936, 932, 928, 684, 680, 676
.short 672, 924, 920, 916, 912, 668, 664, 660, 656, 908, 904, 900, 896, 652, 648, 644
.short 640, 892, 888, 884, 880, 636, 632, 628, 624, 876, 872, 868, 864, 620, 616, 612
.short 608, 860, 856, 852, 848, 604, 600, 596, 592, 844, 840, 836, 832, 588, 584, 580
.short 576, 828, 824, 820, 816, 572, 568, 564, 560, 812, 808, 804, 800, 556, 552, 548
.short 544, 796, 792, 788, 784, 540, 536, 532, 528, 780, 776, 772, 768, 524, 520, 516
.short 512, 508, 504, 500, 496, 252, 248, 244, 240, 492, 488, 484, 480, 236, 232, 228
.short 224, 476, 472, 468, 464, 220, 216, 212, 208, 460, 456, 452, 448, 204, 200, 196
.short 192, 444, 440, 436, 432, 188, 184, 180, 176, 428, 424, 420, 416, 172, 168, 164
.short 160, 412, 408, 404, 400, 156, 152, 148, 144, 396, 392, 388, 384, 140, 136, 132
.short 128, 380, 376, 372, 368, 124, 120, 116, 112, 364, 360, 356, 352, 108, 104, 100
.short 96, 348, 344, 340, 336, 92, 88, 84, 80, 332, 328, 324, 320, 76, 72, 68
.short 64, 316, 312, 308, 304, 60, 56, 52, 48, 300, 296, 292, 288, 44, 40, 36
.short 32, 284, 280, 276, 272, 28, 24, 20, 16, 268, 264, 260, 256, 12, 8, 4
.short 0, 3072, 3072, 3072, 3072, 3072, 3072, 3072, 3072, 3072, 3072, 3072, 3072, 3072, 3072, 3072
.short 3072, 3072, 3072, 3072, 3072, 3072, 3072, 3072, 3072, 2560, 2540, 2508, 2476, 2444, 2412, 2380
.short 2348, 2316, 2536, 2504, 2472, 2440, 2408, 2376, 2344, 2312, 2532, 2500, 2468, 2436, 2404, 2372
.short 2340, 2308, 2528, 2496, 2464, 2432, 2400, 2368, 2336, 2304, 2284, 2252, 2220, 2188, 2156, 2124
.short 2092, 2060, 2280, 2248, 2216, 2184, 2152, 2120, 2088, 2056, 2276, 2244, 2212, 2180, 2148, 2116
.short 2084, 2052, 2272, 2240, 2208, 2176, 2144, 2112, 2080, 3072, 3072, 3072, 3072, 3072, 3072, 3072
.short 3072, 3072, 3072, 3072, 3072, 3072, 3072, 3072, 3072, 3072, 3072, 3072, 3072, 3072, 3072, 3072
.short 3072, 3072, 3072, 3072, 3072, 3072, 3072, 3072, 3072, 3072, 3072, 3072, 3072, 3072, 3072, 3072
.short 3072, 2556, 2524, 2492, 2460, 2428, 2396, 2364, 2332, 2552, 2520, 2488, 2456, 2424, 2392, 2360
.short 2328, 2548, 2516, 2484, 2452, 2420, 2388, 2356, 2324, 2544, 2512, 2480, 2448, 2416, 2384, 2352
.short 2320, 2300, 2268, 2236, 2204, 2172, 2140, 2108, 2076, 2296, 2264, 2232, 2200, 2168, 2136, 2104
.short 2072, 2292, 2260, 2228, 2196, 2164, 2132, 2100, 2068, 2288, 2256, 2224, 2192, 2160, 2128, 2096
.short 2064, 3072, 3072, 3072, 3072, 3072, 3072, 3072, 3072, 3072, 3072, 3072, 3072, 3072, 3072, 3072
.short 3072, 3072, 3072, 3072, 3072, 3072, 3072, 3072, 3072, 3072, 3072, 3072, 3072, 3072, 3072, 3072
.short 3072, 3072, 3072, 3072, 3072, 3072, 3072, 3072, 3072, 3072, 3072, 3072, 3072, 3072, 3072, 3072
.short 3072, 3072, 3072, 3072, 3072, 3072, 3072, 3072, 3072, 3072, 3072, 3072, 3072, 3072, 3072, 3072
.short 3072, 3072, 3072, 3072, 3072, 3072, 3072, 3072, 3072, 3072, 2048, 2040, 2024, 2008, 1992, 1976
.short 1960, 1944, 1928, 1912, 1896, 1880, 1864, 1848, 1832, 1816, 1800, 2032, 2016, 2000, 1984, 1968
.short 1952, 1936, 1920, 1904, 1888, 1872, 1856, 1840, 1824, 1808, 1792, 1784, 1768, 1752, 1736, 1720
.short 1704, 1688, 1672, 1656, 1640, 1624, 1608, 1592, 1576, 1560, 1544, 1776, 1760, 1744, 1728, 1712
.short 1696, 1680, 1664, 1648, 1632, 1616, 1600, 1584, 1568, 1552, 3072, 3072, 3072, 3072, 3072, 3072
.short 3072, 3072, 3072, 3072, 3072, 3072, 3072, 3072, 3072, 3072, 3072, 3072, 3072, 3072, 3072, 3072
.short 3072, 3072, 3072, 3072, 3072, 3072, 3072, 3072, 3072, 3072, 3072, 3072, 3072, 3072, 3072, 3072
.short 3072, 3072, 3072, 3072, 3072, 3072, 3072, 3072, 3072, 3072, 3072, 3072, 3072, 3072, 3072, 3072
.short 3072, 3072, 3072, 3072, 3072, 3072, 3072, 3072, 3072, 3072, 3072, 3072, 3072, 3072, 3072, 3072
.short 3072, 3072, 2044, 2028, 2012, 1996, 1980, 1964, 1948, 1932, 1916, 1900, 1884, 1868, 1852, 1836
.short 1820, 1804, 2036, 2020, 2004, 1988, 1972, 1956, 1940, 1924, 1908, 1892, 1876, 1860, 1844, 1828
.short 1812, 1796, 1788, 1772, 1756, 1740, 1724, 1708, 1692, 1676, 1660, 1644, 1628, 1612, 1596, 1580
.short 1564, 1548, 1780, 1764, 1748, 1732, 1716, 1700, 1684, 1668, 1652, 1636, 1620, 1604, 1588, 1572
.short 1556, 1540, 3072, 3072, 3072, 3072, 3072, 3072, 3072, 3072, 3072, 3072, 3072, 3072, 3072, 3072
.short 3072, 3072, 3072, 3072, 3072, 3072, 3072, 3072, 3072, 3072, 3072, 3072, 3072, 3072, 3072, 3072
.short 3072, 3072, 3072, 3072, 3072, 3072, 3072, 3072, 3072, 3072, 3072, 3072, 3072, 3072, 3072, 3072
L_tab2:
.long 16, 1048608, 2097200, 3145792, 4194384, 5242976, 6291568, 7340160
.long 8388752, 9437344, 10485936, 11534528, 12583120, 13631712, 14680304, 15728896
.long 16777488, 17826080, 18874672, 19923264, 20971856, 22020448, 23069040, 24117632
.long 25166224, 26214816, 27263408, 28312000, 29360592, 30409184, 31457776, 32506368
.long 33554960, 34603552, 35652144, 36700736, 37749328, 38797920, 39846512, 40895104
.long 41943696, 42992288, 44040880, 45089472, 46138064, 47186656, 48235248, 49283840
.long 50332432, 51381024, 52429616, 53478208, 54526800, 55575392, 56623984, 57672576
.long 58721168, 59769760, 60818352, 61866944, 62915536, 63964128, 65012720, 66061312
.long 67109904, 68158496, 69207088, 70255680, 71304272, 72352864, 73401456, 74450048
.long 75498640, 76547264, 88081808, 77595856, 89130400, 78644448, 90178992, 79693040
.long 91227584, 80741632, 92276176, 81790224, 93324768, 82838816, 94373360, 83887408
.long 95421952, 84936000, 96470544, 85984592, 97519136, 87033184, 98567728, 104859920
.long 105908512, 106957104, 108005696, 109054288, 110102880, 111151472, 112200064, 113248656
.long 114297248, 115345840, 116394432, 117443024, 118491616, 119540208, 120588800, 121637392
.long 122685984, 123734576, 124783168, 125831760, 126880352, 127928944, 128977536, 130026128
.long 131074720, 132123312, 133171904, 134220496, 135269088, 136317680, 137366272, 138414864
.long 139463456, 140512048, 141560640, 142609232, 143657824, 144706416, 145755008, 146803600
.long 147852192, 148900784, 149949376, 150997968, 152046560, 153095152, 154143744, 155192336
.long 156240928, 157289520, 158338112, 159386704, 160435296, 161483888, 162532480, 163581072
.long 164629664, 165678256, 166726848, 167775440, 168824032, 169872624, 170921216, 171969808
.long 173018400, 174066992, 175115584, 176164176, 177212768, 178261360, 179309952, 180358544
.long 181407168, 192941712, 182455760, 193990304, 183504352, 195038896, 184552944, 196087488
.long 185601536, 197136080, 186650128, 198184672, 187698720, 199233264, 188747312, 200281856
.long 189795904, 201330448, 190844496, 202379040, 191893088, 203427632, 209715212, 210763804
.long 211812396, 212860988, 213909580, 214958172, 216006764, 217055356, 218103948, 219152540
.long 220201132, 221249724, 222298316, 223346908, 224395500, 225444092, 226492684, 227541276
.long 228589868, 229638460, 230687052, 231735644, 232784236, 233832828, 234881420, 235930012
.long 236978604, 238027196, 239075788, 240124380, 241172972, 242221564, 243270156, 244318748
.long 245367340, 246415932, 247464524, 248513116, 249561708, 250610300, 251658892, 252707484
.long 253756076, 254804668, 255853260, 256901852, 257950444, 258999036, 260047628, 261096220
.long 262144812, 263193404, 264241996, 265290588, 266339180, 267387772, 268436364, 269484956
.long 270533548, 271582140, 272630732, 273679324, 274727916, 275776508, 276825100, 277873692
.long 278922284, 279970876, 281019468, 282068060, 283116652, 284165244, 285213836, 286262460
.long 297797004, 287311052, 298845596, 288359644, 299894188, 289408236, 300942780, 290456828
.long 301991372, 291505420, 303039964, 292554012, 304088556, 293602604, 305137148, 294651196
.long 306185740, 295699788, 307234332, 296748380, 308282924, 314575116, 315623708, 316672300
.long 317720892, 318769484, 319818076, 320866668, 321915260, 322963852, 324012444, 325061036
.long 326109628, 327158220, 328206812, 329255404, 330303996, 331352588, 332401180, 333449772
.long 334498364, 335546956, 336595548, 337644140, 338692732, 339741324, 340789916, 341838508
.long 342887100, 343935692, 344984284, 346032876, 347081468, 348130060, 349178652, 350227244
.long 351275836, 352324428, 353373020, 354421612, 355470204, 356518796, 357567388, 358615980
.long 359664572, 360713164, 361761756, 362810348, 363858940, 364907532, 365956124, 367004716
.long 368053308, 369101900, 370150492, 371199084, 372247676, 373296268, 374344860, 375393452
.long 376442044, 377490636, 378539228, 379587820, 380636412, 381685004, 382733596, 383782188
.long 384830780, 385879372, 386927964, 387976556, 389025148, 390073740, 391122364, 402656908
.long 392170956, 403705500, 393219548, 404754092, 394268140, 405802684, 395316732, 406851276
.long 396365324, 407899868, 397413916, 408948460, 398462508, 409997052, 399511100, 411045644
.long 400559692, 412094236, 401608284, 413142828, 419430408, 420479000, 421527592, 422576184
.long 423624776, 424673368, 425721960, 426770552, 427819144, 428867736, 429916328, 430964920
.long 432013512, 433062104, 434110696, 435159288, 436207880, 437256472, 438305064, 439353656
.long 440402248, 441450840, 442499432, 443548024, 444596616, 445645208, 446693800, 447742392
.long 448790984, 449839576, 450888168, 451936760, 452985352, 454033944, 455082536, 456131128
.long 457179720, 458228312, 459276904, 460325496, 461374088, 462422680, 463471272, 464519864
.long 465568456, 466617048, 467665640, 468714232, 469762824, 470811416, 471860008, 472908600
.long 473957192, 475005784, 476054376, 477102968, 478151560, 479200152, 480248744, 481297336
.long 482345928, 483394520, 484443112, 485491704, 486540296, 487588888, 488637480, 489686072
.long 490734664, 491783256, 492831848, 493880440, 494929032, 495977656, 507512200, 497026248
.long 508560792, 498074840, 509609384, 499123432, 510657976, 500172024, 511706568, 501220616
.long 512755160, 502269208, 513803752, 503317800, 514852344, 504366392, 515900936, 505414984
.long 516949528, 506463576, 517998120, 524290312, 525338904, 526387496, 527436088, 528484680
.long 529533272, 530581864, 531630456, 532679048, 533727640, 534776232, 535824824, 536873416
.long 537922008, 538970600, 540019192, 541067784, 542116376, 543164968, 544213560, 545262152
.long 546310744, 547359336, 548407928, 549456520, 550505112, 551553704, 552602296, 553650888
.long 554699480, 555748072, 556796664, 557845256, 558893848, 559942440, 560991032, 562039624
.long 563088216, 564136808, 565185400, 566233992, 567282584, 568331176, 569379768, 570428360
.long 571476952, 572525544, 573574136, 574622728, 575671320, 576719912, 577768504, 578817096
.long 579865688, 580914280, 581962872, 583011464, 584060056, 585108648, 586157240, 587205832
.long 588254424, 589303016, 590351608, 591400200, 592448792, 593497384, 594545976, 595594568
.long 596643160, 597691752, 598740344, 599788936, 600837560, 612372104, 601886152, 613420696
.long 602934744, 614469288, 603983336, 615517880, 605031928, 616566472, 606080520, 617615064
.long 607129112, 618663656, 608177704, 619712248, 609226296, 620760840, 610274888, 621809432
.long 611323480, 622858024, 629145604, 630194196, 631242788, 632291380, 633339972, 634388564
.long 635437156, 636485748, 637534340, 638582932, 639631524, 640680116, 641728708, 642777300
.long 643825892, 644874484, 645923076, 646971668, 648020260, 649068852, 650117444, 651166036
.long 652214628, 653263220, 654311812, 655360404, 656408996, 657457588, 658506180, 659554772
.long 660603364, 661651956, 662700548, 663749140, 664797732, 665846324, 666894916, 667943508
.long 668992100, 670040692, 671089284, 672137876, 673186468, 674235060, 675283652, 676332244
.long 677380836, 678429428, 679478020, 680526612, 681575204, 682623796, 683672388, 684720980
.long 685769572, 686818164, 687866756, 688915348, 689963940, 691012532, 692061124, 693109716
.long 694158308, 695206900, 696255492, 697304084, 698352676, 699401268, 700449860, 701498452
.long 702547044, 703595636, 704644228, 705692852, 717227396, 706741444, 718275988, 707790036
.long 719324580, 708838628, 720373172, 709887220, 721421764, 710935812, 722470356, 711984404
.long 723518948, 713032996, 724567540, 714081588, 725616132, 715130180, 726664724, 716178772
.long 727713316, 734005508, 735054100, 736102692, 737151284, 738199876, 739248468, 740297060
.long 741345652, 742394244, 743442836, 744491428, 745540020, 746588612, 747637204, 748685796
.long 749734388, 750782980, 751831572, 752880164, 753928756, 754977348, 756025940, 757074532
.long 758123124, 759171716, 760220308, 761268900, 762317492, 763366084, 764414676, 765463268
.long 766511860, 767560452, 768609044, 769657636, 770706228, 771754820, 772803412, 773852004
.long 774900596, 775949188, 776997780, 778046372, 779094964, 780143556, 781192148, 782240740
.long 783289332, 784337924, 785386516, 786435108, 787483700, 788532292, 789580884, 790629476
.long 791678068, 792726660, 793775252, 794823844, 795872436, 796921028, 797969620, 799018212
.long 800066804, 801115396, 802163988, 803212580, 804261172, 805309764, 806358356, 807406948
.long 808455540, 809504132, 810552756, 822087300, 811601348, 823135892, 812649940, 824184484
.long 813698532, 825233076, 814747124, 826281668, 815795716, 827330260, 816844308, 828378852
.long 817892900, 829427444, 818941492, 830476036, 819990084, 831524628, 821038676, 832573220
.long 838862432, 854591344, 839911024, 855639936, 840959616, 856688528, 842008208, 857737120
.long 843056800, 858785712, 844105392, 859834304, 845153984, 860882896, 846202576, 861931488
.long 847251168, 862980080, 848299760, 864028672, 849348352, 865077264, 850396944, 866125856
.long 851445536, 867174448, 852494128, 868223040, 853542720, 869271632, 876611164, 892340076
.long 877659756, 893388668, 878708348, 894437260, 879756940, 895485852, 880805532, 896534444
.long 881854124, 897583036, 882902716, 898631628, 883951308, 899680220, 884999900, 900728812
.long 886048492, 901777404, 887097084, 902825996, 888145676, 903874588, 889194268, 904923180
.long 890242860, 905971772, 891291452, 907020364, 914359896, 930088808, 915408488, 931137400
.long 916457080, 932185992, 917505672, 933234584, 918554264, 934283176, 919602856, 935331768
.long 920651448, 936380360, 921700040, 937428952, 922748632, 938477544, 923797224, 939526136
.long 924845816, 940574728, 925894408, 941623320, 926943000, 942671912, 927991592, 943720504
.long 929040184, 944769096, 952108628, 967837540, 953157220, 968886132, 954205812, 969934724
.long 955254404, 970983316, 956302996, 972031908, 957351588, 973080500, 958400180, 974129092
.long 959448772, 975177684, 960497364, 976226276, 961545956, 977274868, 962594548, 978323460
.long 963643140, 979372052, 964691732, 980420644, 965740324, 981469236, 966788916, 982517828
.long 982517828, 982517828, 982517828, 982517828, 982517828, 982517828, 982517828, 982517828
.long 982517828, 982517828, 982517828, 982517828, 982517828, 982517828, 982517828, 982517828
.long 982517828, 982517828, 982517828, 982517828, 982517828, 982517828, 982517828, 982517828
.long 982517828, 982517828, 982517828, 982517828, 982517828, 982517828, 982517828, 982517828
.long 982517828, 982517828, 982517828, 982517828, 982517828, 982517828, 982517828, 982517828
.long 982517828, 982517828, 982517828, 982517828, 982517828, 982517828, 982517828, 982517828
.long 982517828, 982517828, 982517828, 982517828, 982517828, 982517828, 982517828, 982517828
.long 982517828, 982517828, 982517828, 982517828, 982517828, 982517828, 982517828, 982517828
.long 982517828, 982517828, 982517828, 982517828, 982517828, 982517828, 982517828, 982517828
.long 982517828, 982517828, 982517828, 982517828, 982517828, 982517828, 982517828, 982517828
.long 982517828, 982517828, 982517828, 982517828, 982517828, 982517828, 982517828, 982517828
.long 982517828, 982517828, 982517828, 982517828, 982517828, 982517828, 982517828, 982517828
.long 982517828, 982517828, 982517828, 982517828, 982517828, 982517828, 982517828, 982517828
.long 982517828, 982517828, 982517828, 982517828, 982517828, 982517828, 982517828, 982517828
.long 982517828, 982517828, 982517828, 982517828, 982517828, 982517828, 982517828, 982517828
.long 982517828, 982517828, 982517828, 982517828, 982517828, 982517828, 982517828, 982517828
.long 982517828, 982517828, 982517828, 982517828, 982517828, 982517828, 982517828, 982517828
.long 982517828, 982517828, 982517828, 982517828, 982517828, 982517828, 982517828, 982517828
.fill 32, 4, 0
L_code_end:
.section .rodata,"a"
.p2align 6
.amdhsa_kernel interleave_layers__sliding_local_dilated__ssm_conv_s4d__prompt_kernel
  .amdhsa_next_free_vgpr 256
  .amdhsa_next_free_sgpr 102
  .amdhsa_accum_offset 256
  .amdhsa_group_segment_fixed_size 0
  .amdhsa_kernarg_size 104
  .amdhsa_user_sgpr_count 2
  .amdhsa_user_sgpr_kernarg_segment_ptr 1
  .amdhsa_system_sgpr_workgroup_id_x 1
.end_amdhsa_kernel
```

```asm
; @launch grid=(256,1,1) block=(512,1,1) lds=163840
.amdgcn_target "amdgcn-amd-amdhsa--gfx950"
.text
.globl interleave_layers__sliding_local_dilated__ssm_conv_s4d__prompt_kernel
.p2align 8
.type interleave_layers__sliding_local_dilated__ssm_conv_s4d__prompt_kernel,@function
interleave_layers__sliding_local_dilated__ssm_conv_s4d__prompt_kernel:
    s_cmp_ge_u32 s2, 256
    s_cbranch_scc1 L_end
    s_load_dwordx16 s[8:23], s[0:1], 0
    s_load_dwordx8 s[24:31], s[0:1], 64
    s_load_dwordx2 s[32:33], s[0:1], 96
    v_lshrrev_b32 v2, 6, v0
    v_and_b32 v1, 63, v0
    v_readfirstlane_b32 s3, v2
    s_getpc_b64 s[50:51]
L_pcref:
    s_lshr_b32 s47, s2, 3
    s_cmp_eq_u32 s3, 7
    s_nop 0
    s_cbranch_scc0 L_nopf
    v_and_b32 v2, 31, v1
    v_lshl_add_u32 v2, v2, 5, s47
    v_lshlrev_b32 v2, 7, v2
    v_min_u32 v2, L_code_end-L_pcref-4, v2
    global_load_dword v251, v2, s[50:51]
L_nopf:
    s_and_b32 s42, s2, 7
    s_lshr_b32 s43, s2, 3
    s_and_b32 s6, s43, 3
    s_lshr_b32 s5, s42, 1
    s_lshl_b32 s5, s5, 3
    s_and_b32 s4, s43, 7
    s_add_u32 s5, s5, s4
    s_and_b32 s4, s42, 1
    s_lshl_b32 s4, s4, 2
    s_lshr_b32 s44, s43, 3
    s_add_u32 s4, s4, s44
    s_and_b32 s36, s43, 1
    s_lshr_b32 s43, s43, 1
    s_lshl_b32 s42, s42, 4
    s_add_u32 s42, s42, s43
    s_mul_i32 s42, s42, 5
    s_mul_i32 s43, s36, 3
    s_add_u32 s37, s42, s43
    s_add_u32 s38, s37, 1
    s_add_u32 s39, s42, 2
    s_mov_b32 s7, 0
    s_mov_b32 s40, 0
    s_mov_b32 s41, 0
    s_mul_i32 s42, s3, 11
    s_lshr_b32 s42, s42, 5
    s_mul_i32 s43, s42, 3
    s_sub_u32 s43, s3, s43
    s_cmp_eq_u32 s42, 1
    s_cselect_b32 s44, s38, s37
    s_cmp_eq_u32 s42, 2
    s_cselect_b32 s44, s39, s44
    s_cselect_b32 s45, s36, 0
    s_cmp_eq_u32 s45, 1
    s_cselect_b32 s43, 2, s43
    s_mul_i32 s52, s42, 3
    s_add_u32 s52, s52, s43
    v_mov_b32 v16, 0
    v_mov_b32 v17, 0
    v_mov_b32 v18, 0
    v_mov_b32 v19, 0
    s_mul_i32 s54, s44, 384
    s_lshl_b32 s55, s43, 7
    s_add_u32 s54, s54, s55
    v_lshl_add_u32 v2, v1, 1, s54
    s_lshl_b32 s55, s44, 1
    v_mov_b32 v3, s55
    s_cmp_ge_u32 s3, 4
    s_cbranch_scc1 L_st_x
    s_min_u32 s45, s2, 239
    s_mul_i32 s46, s45, 21846
    s_lshr_b32 s46, s46, 16
    s_mul_i32 s47, s46, 3
    s_sub_u32 s47, s45, s47
    s_mul_i32 s50, s46, 30720
    s_mul_i32 s48, s47, 1280
    s_add_u32 s50, s50, s48
    s_mul_i32 s48, s3, 320
    s_add_u32 s50, s50, s48
    v_min_u32 v4, 39, v1
    v_lshlrev_b32 v24, 2, v4
    v_add_u32 v25, 7680, v24
    v_add_u32 v26, 15360, v24
    v_add_u32 v27, 23040, v24
    s_cmp_eq_u32 s47, 1
    s_cselect_b32 s48, 32, 0
    v_add_u32 v4, s48, v4
    v_subrev_u32 v5, 40, v4
    v_min_u32 v4, v4, v5
    s_mul_i32 s48, s47, 12
    s_mov_b32 s54, 3396879904
    s_mov_b32 s55, 14
    s_lshr_b64 s[54:55], s[54:55], s48
    v_lshrrev_b32 v5, 4, v4
    v_lshlrev_b32 v6, 2, v5
    v_mov_b32 v7, s54
    v_bfe_u32 v6, v7, v6, 4
    v_mul_u32_u24 v6, 20480, v6
    v_and_b32 v4, 15, v4
    v_lshl_add_u32 v6, v4, 4, v6
    s_mul_i32 s48, s3, 614400
    s_lshl_b32 s49, s46, 8
    s_add_u32 s48, s48, s49
    s_add_u32 s48, s48, 1048576
    v_add_u32 v10, s48, v6
    v_cmp_eq_u32 vcc, 2, v5
    v_mov_b32 v6, 20480
    v_mov_b32 v7, 128
    v_cndmask_b32 v6, v6, v7, vcc
    v_add_u32 v11, v10, v6
    v_add_u32 v12, 307200, v10
    v_add_u32 v13, 307200, v11
    v_mov_b32 v246, 0
    v_mov_b32 v247, 0
    v_mov_b32 v248, 0
    v_mov_b32 v249, 0
    v_mov_b32 v250, 0
    v_add_u32 v32, 0, v1
    v_mul_u32_u24 v37, 205, v32
    v_lshrrev_b32 v37, 11, v37
    v_mul_u32_u24 v38, 10, v37
    v_sub_u32 v32, v32, v38
    v_and_b32 v38, 3, v37
    v_bfe_u32 v39, v37, 2, 2
    v_lshl_or_b32 v38, v39, 3, v38
    v_lshrrev_b32 v39, 4, v37
    v_lshl_or_b32 v38, v39, 2, v38
    v_mul_u32_u24 v38, 1280, v38
    v_lshl_add_u32 v32, v32, 4, v38
    v_add_u32 v33, 64, v1
    v_mul_u32_u24 v37, 205, v33
    v_lshrrev_b32 v37, 11, v37
    v_mul_u32_u24 v38, 10, v37
    v_sub_u32 v33, v33, v38
    v_and_b32 v38, 3, v37
    v_bfe_u32 v39, v37, 2, 2
    v_lshl_or_b32 v38, v39, 3, v38
    v_lshrrev_b32 v39, 4, v37
    v_lshl_or_b32 v38, v39, 2, v38
    v_mul_u32_u24 v38, 1280, v38
    v_lshl_add_u32 v33, v33, 4, v38
    v_add_u32 v34, 128, v1
    v_mul_u32_u24 v37, 205, v34
    v_lshrrev_b32 v37, 11, v37
    v_mul_u32_u24 v38, 10, v37
    v_sub_u32 v34, v34, v38
    v_and_b32 v38, 3, v37
    v_bfe_u32 v39, v37, 2, 2
    v_lshl_or_b32 v38, v39, 3, v38
    v_lshrrev_b32 v39, 4, v37
    v_lshl_or_b32 v38, v39, 2, v38
    v_mul_u32_u24 v38, 1280, v38
    v_lshl_add_u32 v34, v34, 4, v38
    v_add_u32 v35, 192, v1
    v_mul_u32_u24 v37, 205, v35
    v_lshrrev_b32 v37, 11, v37
    v_mul_u32_u24 v38, 10, v37
    v_sub_u32 v35, v35, v38
    v_and_b32 v38, 3, v37
    v_bfe_u32 v39, v37, 2, 2
    v_lshl_or_b32 v38, v39, 3, v38
    v_lshrrev_b32 v39, 4, v37
    v_lshl_or_b32 v38, v39, 2, v38
    v_mul_u32_u24 v38, 1280, v38
    v_lshl_add_u32 v35, v35, 4, v38
    v_add_u32 v36, 256, v1
    v_mul_u32_u24 v37, 205, v36
    v_lshrrev_b32 v37, 11, v37
    v_mul_u32_u24 v38, 10, v37
    v_sub_u32 v36, v36, v38
    v_and_b32 v38, 3, v37
    v_bfe_u32 v39, v37, 2, 2
    v_lshl_or_b32 v38, v39, 3, v38
    v_lshrrev_b32 v39, 4, v37
    v_lshl_or_b32 v38, v39, 2, v38
    v_mul_u32_u24 v38, 1280, v38
    v_lshl_add_u32 v36, v36, 4, v38
    s_mul_i32 s46, s2, 2185
    s_lshr_b32 s46, s46, 16
    s_mul_i32 s47, s46, 30
    s_sub_u32 s47, s2, s47
    s_cmp_lt_u32 s47, 20
    s_cselect_b32 s42, 1, 0
    s_cmp_lt_u32 s2, 240
    s_cselect_b32 s42, s42, 0
    s_cmp_eq_u32 s3, 3
    s_cselect_b32 s42, s42, 0
    s_mul_i32 s43, s47, 40960
    s_mul_i32 s48, s46, 160
    s_add_u32 s43, s43, s48
    s_mul_i32 s46, s46, 102400
    s_mul_i32 s47, s47, 5120
    s_add_u32 s46, s46, s47
    s_add_u32 s46, s46, 14681088
    v_lshl_add_u32 v189, v1, 4, s46
    v_add_u32 v184, s43, v32
    v_add_u32 v185, s43, v33
    v_add_u32 v186, s43, v34
    v_add_u32 v187, s43, v35
    v_add_u32 v188, s43, v36
    s_lshl_b32 s46, s5, 9
    s_add_u32 s46, s46, 393216
    v_and_b32 v6, 31, v1
    v_lshl_add_u32 v6, v6, 4, s46
    v_lshrrev_b32 v7, 5, v1
    v_lshl_add_u32 v6, v7, 14, v6
    v_and_b32 v8, 3, v1
    v_lshlrev_b32 v8, 4, v8
    v_add_u32 v8, 45312, v8
    v_mov_b32 v9, 46976
    ds_write_b128 v8, v[16:19]
    ds_write_b128 v9, v[16:19]
    s_waitcnt lgkmcnt(0)
    s_cmp_ge_u32 s2, 240
    s_cbranch_scc1 L_st_nopack
    s_add_u32 s54, s10, s50
    s_addc_u32 s55, s11, 0
    global_load_dword v192, v24, s[54:55] offset:0
    global_load_dword v193, v24, s[54:55] offset:3840
    global_load_dword v194, v25, s[54:55] offset:0
    global_load_dword v195, v25, s[54:55] offset:3840
    global_load_dword v196, v26, s[54:55] offset:0
    global_load_dword v197, v26, s[54:55] offset:3840
    global_load_dword v198, v27, s[54:55] offset:0
    global_load_dword v199, v27, s[54:55] offset:3840
    global_load_dword v208, v24, s[54:55] offset:160
    global_load_dword v209, v24, s[54:55] offset:4000
    global_load_dword v210, v25, s[54:55] offset:160
    global_load_dword v211, v25, s[54:55] offset:4000
    global_load_dword v212, v26, s[54:55] offset:160
    global_load_dword v213, v26, s[54:55] offset:4000
    global_load_dword v214, v27, s[54:55] offset:160
    global_load_dword v215, v27, s[54:55] offset:4000
L_st_nopack:
    global_load_ushort v240, v2, s[16:17]
    global_load_ushort v244, v3, s[24:25]
    global_load_ushort v241, v2, s[18:19]
    global_load_ushort v242, v2, s[20:21]
    global_load_ushort v243, v2, s[22:23]
    global_load_dwordx2 v[20:21], v16, s[32:33] sc1
    s_cmp_eq_u32 s3, 2
    s_cbranch_scc0 L_st_b0
    s_cmp_eq_u32 s4, 0
    s_cbranch_scc0 L_st_nz
    global_store_dwordx4 v6, v[16:19], s[32:33] sc1
L_st_nz:
    s_cmp_eq_u32 s2, 255
    s_cbranch_scc0 L_st_b0
    v_and_b32 v6, 7, v1
    v_lshlrev_b32 v6, 4, v6
    v_add_u32 v6, 19922816, v6
    s_mov_b64 exec, 0xff
    global_store_dwordx4 v6, v[16:19], s[32:33] sc1
    s_mov_b64 exec, -1
    v_lshlrev_b32 v6, 4, v1
    v_add_u32 v6, 458752, v6
    global_store_dwordx4 v6, v[16:19], s[32:33] sc1
    global_store_dwordx4 v6, v[16:19], s[32:33] offset:1024 sc1
L_st_b0:
    s_barrier
    s_waitcnt vmcnt(0)
    s_cmp_ge_u32 s2, 240
    s_cbranch_scc1 L_st_unit
    s_mov_b32 s50, 0x05040100
    s_mov_b32 s51, 0x07060302
    s_mov_b32 exec_hi, 0xff
    v_perm_b32 v200, v193, v192, s50
    v_perm_b32 v201, v195, v194, s50
    v_perm_b32 v202, v197, v196, s50
    v_perm_b32 v203, v199, v198, s50
    global_store_dwordx4 v10, v[200:203], s[32:33] sc1
    v_perm_b32 v204, v193, v192, s51
    v_perm_b32 v205, v195, v194, s51
    v_perm_b32 v206, v197, v196, s51
    v_perm_b32 v207, v199, v198, s51
    global_store_dwordx4 v11, v[204:207], s[32:33] sc1
    v_perm_b32 v216, v209, v208, s50
    v_perm_b32 v217, v211, v210, s50
    v_perm_b32 v218, v213, v212, s50
    v_perm_b32 v219, v215, v214, s50
    global_store_dwordx4 v12, v[216:219], s[32:33] sc1
    v_perm_b32 v220, v209, v208, s51
    v_perm_b32 v221, v211, v210, s51
    v_perm_b32 v222, v213, v212, s51
    v_perm_b32 v223, v215, v214, s51
    global_store_dwordx4 v13, v[220:223], s[32:33] sc1
    s_mov_b64 exec, -1
    s_branch L_st_unit
L_st_x:
    s_lshl_b32 s46, s6, 2
    s_mov_b32 s42, 0
    v_mov_b32 v184, 14681088
    v_mov_b32 v185, 14681088
    v_mov_b32 v186, 14681088
    v_mov_b32 v187, 14681088
    v_mov_b32 v188, 14681088
    v_mov_b32 v189, 14681088
    v_add_u32 v6, -256, v0
    v_mul_u32_u24 v7, 52429, v6
    v_lshrrev_b32 v7, 22, v7
    v_mul_u32_u24 v8, 80, v7
    v_sub_u32 v8, v6, v8
    v_xor_b32 v8, v8, v7
    v_xor_b32 v8, s46, v8
    v_mul_u32_u24 v7, 1280, v7
    v_lshl_add_u32 v246, v8, 4, v7
    v_add_u32 v6, 0, v0
    v_mul_u32_u24 v7, 52429, v6
    v_lshrrev_b32 v7, 22, v7
    v_mul_u32_u24 v8, 80, v7
    v_sub_u32 v8, v6, v8
    v_xor_b32 v8, v8, v7
    v_xor_b32 v8, s46, v8
    v_mul_u32_u24 v7, 1280, v7
    v_lshl_add_u32 v247, v8, 4, v7
    v_add_u32 v6, 256, v0
    v_mul_u32_u24 v7, 52429, v6
    v_lshrrev_b32 v7, 22, v7
    v_mul_u32_u24 v8, 80, v7
    v_sub_u32 v8, v6, v8
    v_xor_b32 v8, v8, v7
    v_xor_b32 v8, s46, v8
    v_mul_u32_u24 v7, 1280, v7
    v_lshl_add_u32 v248, v8, 4, v7
    v_add_u32 v6, 512, v0
    v_mul_u32_u24 v7, 52429, v6
    v_lshrrev_b32 v7, 22, v7
    v_mul_u32_u24 v8, 80, v7
    v_sub_u32 v8, v6, v8
    v_xor_b32 v8, v8, v7
    v_xor_b32 v8, s46, v8
    v_mul_u32_u24 v7, 1280, v7
    v_lshl_add_u32 v249, v8, 4, v7
    v_add_u32 v6, 768, v0
    v_mul_u32_u24 v7, 52429, v6
    v_lshrrev_b32 v7, 22, v7
    v_mul_u32_u24 v8, 80, v7
    v_sub_u32 v8, v6, v8
    v_xor_b32 v8, v8, v7
    v_xor_b32 v8, s46, v8
    v_mul_u32_u24 v7, 1280, v7
    v_lshl_add_u32 v250, v8, 4, v7
    s_waitcnt lgkmcnt(0)
    global_load_ushort v240, v2, s[16:17]
    global_load_ushort v244, v3, s[24:25]
    global_load_ushort v241, v2, s[18:19]
    global_load_ushort v242, v2, s[20:21]
    global_load_ushort v243, v2, s[22:23]
    global_load_dwordx2 v[20:21], v16, s[32:33] sc1
    s_barrier
    s_and_b32 s47, s4, 3
    s_add_u32 s47, s47, 0
    s_sub_u32 s48, s47, 5
    s_min_u32 s47, s47, s48
    s_lshl_b32 s48, s5, 2
    s_add_u32 s48, s48, s47
    s_max_u32 s48, s48, 1
    s_sub_u32 s48, s48, 1
    s_mul_i32 s48, s48, 20480
    s_mul_i32 s47, s47, 20480
    s_lshl_b32 s49, s3, 10
    s_add_u32 s47, s47, s49
    s_add_u32 s50, s8, s48
    s_addc_u32 s51, s9, 0
    s_add_u32 m0, s47, 57344
    s_nop 0
    global_load_lds_dwordx4 v246, s[50:51]
    s_add_u32 m0, s47, 61440
    s_nop 0
    global_load_lds_dwordx4 v247, s[50:51]
    s_add_u32 m0, s47, 65536
    s_nop 0
    global_load_lds_dwordx4 v248, s[50:51]
    s_add_u32 m0, s47, 69632
    s_nop 0
    global_load_lds_dwordx4 v249, s[50:51]
    s_add_u32 m0, s47, 73728
    s_nop 0
    global_load_lds_dwordx4 v250, s[50:51]
    s_waitcnt vmcnt(5)
L_st_unit:
    s_and_b32 s14, s2, 7
    s_lshl_b32 s14, s14, 5
    s_lshr_b32 s15, s2, 3
    s_add_u32 s14, s14, s15
    v_readfirstlane_b32 s34, v20
    v_readfirstlane_b32 s35, v21
    s_nop 0
    s_add_u32 s34, s34, 1
    s_addc_u32 s35, s35, 0
    s_cmp_eq_u32 s3, 7
    s_cselect_b32 s46, s36, 0
    s_sub_u32 s46, s52, s46
    s_mul_i32 s46, s46, 4608
    s_add_u32 s46, s46, 0
    v_lshlrev_b32 v52, 16, v240
    v_lshlrev_b32 v56, 16, v244
    v_mul_f32 v52, 1069066811, v52
    v_mul_f32 v56, 1069066811, v56
    v_exp_f32 v52, v52
    v_exp_f32 v56, v56
    v_lshlrev_b32 v53, 16, v241
    v_lshlrev_b32 v54, 16, v242
    v_lshlrev_b32 v55, 16, v243
    v_cvt_pk_bf16_f32 v52, v52, v56
    v_and_b32 v3, 15, v1
    v_mul_u32_u24 v3, 288, v3
    v_and_b32 v2, 0x30, v1
    v_add3_u32 v3, v3, v2, s46
    s_mov_b32 m0, s46
    v_and_b32 v56, 0xffff0000, v52
    v_lshlrev_b32 v52, 16, v52
    v_mul_f32 v52, v52, v56
    v_mul_f32 v53, v53, v56
    v_mul_f32 v84, v54, v56
    v_mul_f32 v85, v55, v56
    v_mul_f32 v52, 3216550459, v52
    v_mul_f32 v53, 1042479491, v53
    v_mul_f32 v84, 0x44000000, v84
    v_mul_f32 v85, 0x44000000, v85
    v_mul_f32 v54, 1065353216, v52
    v_mul_f32 v60, 1065353216, v53
    v_mul_f32 v55, 1090519040, v52
    v_mul_f32 v61, 1090519040, v53
    v_mul_f32 v56, 1124073472, v52
    v_mul_f32 v62, 1124073472, v53
    v_mul_f32 v57, 1132462080, v52
    v_mul_f32 v63, 1132462080, v53
    v_mul_f32 v58, 1140850688, v52
    v_mul_f32 v64, 1140850688, v53
    v_mul_f32 v59, 1149239296, v52
    v_mul_f32 v65, 1149239296, v53
    v_exp_f32 v54, v54
    v_fract_f32 v60, v60
    v_exp_f32 v55, v55
    v_fract_f32 v61, v61
    v_exp_f32 v56, v56
    v_fract_f32 v62, v62
    v_exp_f32 v57, v57
    v_fract_f32 v63, v63
    v_exp_f32 v58, v58
    v_fract_f32 v64, v64
    v_exp_f32 v59, v59
    v_fract_f32 v65, v65
    v_cos_f32 v4, v60
    v_sin_f32 v5, v60
    v_cos_f32 v6, v61
    v_sin_f32 v7, v61
    v_cos_f32 v8, v62
    v_sin_f32 v9, v62
    v_cos_f32 v10, v63
    v_sin_f32 v11, v63
    v_cos_f32 v12, v64
    v_sin_f32 v13, v64
    v_cos_f32 v14, v65
    v_sin_f32 v15, v65
    v_mul_f32 v4, v4, v54
    v_mul_f32 v5, v5, v54
    v_mul_f32 v6, v6, v55
    v_mul_f32 v7, v7, v55
    v_mul_f32 v8, v8, v56
    v_mul_f32 v9, v9, v56
    v_mul_f32 v10, v10, v57
    v_mul_f32 v11, v11, v57
    v_mul_f32 v12, v12, v58
    v_mul_f32 v13, v13, v58
    v_mul_f32 v14, v14, v59
    v_mul_f32 v15, v15, v59
    v_mov_b32 v16, 1.0
    v_mov_b32 v17, 0
    v_mov_b32 v18, v6
    v_mov_b32 v19, v7
    v_pk_mul_f32 v[20:21], v[6:7], v[6:7] op_sel:[0,0] op_sel_hi:[1,0]
    v_pk_mul_f32 v[48:49], v[4:5], v[4:5] op_sel:[0,0] op_sel_hi:[1,0]
    v_pk_fma_f32 v[20:21], v[6:7], v[6:7], v[20:21] op_sel:[1,1,0] op_sel_hi:[0,1,1] neg_lo:[1,0,0]
    v_pk_fma_f32 v[48:49], v[4:5], v[4:5], v[48:49] op_sel:[1,1,0] op_sel_hi:[0,1,1] neg_lo:[1,0,0]
    v_pk_mul_f32 v[22:23], v[20:21], v[6:7] op_sel:[0,0] op_sel_hi:[1,0]
    v_pk_mul_f32 v[24:25], v[20:21], v[20:21] op_sel:[0,0] op_sel_hi:[1,0]
    v_pk_mul_f32 v[50:51], v[48:49], v[48:49] op_sel:[0,0] op_sel_hi:[1,0]
    v_pk_fma_f32 v[22:23], v[20:21], v[6:7], v[22:23] op_sel:[1,1,0] op_sel_hi:[0,1,1] neg_lo:[1,0,0]
    v_pk_fma_f32 v[24:25], v[20:21], v[20:21], v[24:25] op_sel:[1,1,0] op_sel_hi:[0,1,1] neg_lo:[1,0,0]
    v_pk_fma_f32 v[50:51], v[48:49], v[48:49], v[50:51] op_sel:[1,1,0] op_sel_hi:[0,1,1] neg_lo:[1,0,0]
    v_pk_mul_f32 v[26:27], v[18:19], v[24:25] op_sel:[0,0] op_sel_hi:[1,0]
    v_pk_mul_f32 v[28:29], v[20:21], v[24:25] op_sel:[0,0] op_sel_hi:[1,0]
    v_pk_mul_f32 v[30:31], v[22:23], v[24:25] op_sel:[0,0] op_sel_hi:[1,0]
    v_pk_mul_f32 v[32:33], v[24:25], v[24:25] op_sel:[0,0] op_sel_hi:[1,0]
    v_pk_fma_f32 v[26:27], v[18:19], v[24:25], v[26:27] op_sel:[1,1,0] op_sel_hi:[0,1,1] neg_lo:[1,0,0]
    v_pk_fma_f32 v[28:29], v[20:21], v[24:25], v[28:29] op_sel:[1,1,0] op_sel_hi:[0,1,1] neg_lo:[1,0,0]
    v_pk_fma_f32 v[30:31], v[22:23], v[24:25], v[30:31] op_sel:[1,1,0] op_sel_hi:[0,1,1] neg_lo:[1,0,0]
    v_pk_fma_f32 v[32:33], v[24:25], v[24:25], v[32:33] op_sel:[1,1,0] op_sel_hi:[0,1,1] neg_lo:[1,0,0]
    v_pk_mul_f32 v[34:35], v[26:27], v[24:25] op_sel:[0,0] op_sel_hi:[1,0]
    v_pk_mul_f32 v[36:37], v[28:29], v[24:25] op_sel:[0,0] op_sel_hi:[1,0]
    v_pk_mul_f32 v[38:39], v[30:31], v[24:25] op_sel:[0,0] op_sel_hi:[1,0]
    v_pk_mul_f32 v[40:41], v[32:33], v[24:25] op_sel:[0,0] op_sel_hi:[1,0]
    v_pk_fma_f32 v[34:35], v[26:27], v[24:25], v[34:35] op_sel:[1,1,0] op_sel_hi:[0,1,1] neg_lo:[1,0,0]
    v_pk_fma_f32 v[36:37], v[28:29], v[24:25], v[36:37] op_sel:[1,1,0] op_sel_hi:[0,1,1] neg_lo:[1,0,0]
    v_pk_fma_f32 v[38:39], v[30:31], v[24:25], v[38:39] op_sel:[1,1,0] op_sel_hi:[0,1,1] neg_lo:[1,0,0]
    v_pk_fma_f32 v[40:41], v[32:33], v[24:25], v[40:41] op_sel:[1,1,0] op_sel_hi:[0,1,1] neg_lo:[1,0,0]
    v_pk_mul_f32 v[42:43], v[34:35], v[24:25] op_sel:[0,0] op_sel_hi:[1,0]
    v_pk_mul_f32 v[44:45], v[36:37], v[24:25] op_sel:[0,0] op_sel_hi:[1,0]
    v_pk_mul_f32 v[46:47], v[38:39], v[24:25] op_sel:[0,0] op_sel_hi:[1,0]
    v_pk_fma_f32 v[42:43], v[34:35], v[24:25], v[42:43] op_sel:[1,1,0] op_sel_hi:[0,1,1] neg_lo:[1,0,0]
    v_pk_fma_f32 v[44:45], v[36:37], v[24:25], v[44:45] op_sel:[1,1,0] op_sel_hi:[0,1,1] neg_lo:[1,0,0]
    v_pk_fma_f32 v[46:47], v[38:39], v[24:25], v[46:47] op_sel:[1,1,0] op_sel_hi:[0,1,1] neg_lo:[1,0,0]
    v_cvt_pk_f16_f32 v52, v16, -v17
    v_cvt_pk_f16_f32 v53, v18, -v19
    v_cvt_pk_f16_f32 v54, v20, -v21
    v_cvt_pk_f16_f32 v55, v22, -v23
    v_cvt_pk_f16_f32 v56, v24, -v25
    v_cvt_pk_f16_f32 v57, v26, -v27
    v_cvt_pk_f16_f32 v58, v28, -v29
    v_cvt_pk_f16_f32 v59, v30, -v31
    v_cvt_pk_f16_f32 v60, v32, -v33
    v_cvt_pk_f16_f32 v61, v34, -v35
    v_cvt_pk_f16_f32 v62, v36, -v37
    v_cvt_pk_f16_f32 v63, v38, -v39
    v_cvt_pk_f16_f32 v64, v40, -v41
    v_cvt_pk_f16_f32 v65, v42, -v43
    v_cvt_pk_f16_f32 v66, v44, -v45
    v_cvt_pk_f16_f32 v67, v46, -v47
    ds_write_addtid_b32 v52 offset:0
    ds_write_addtid_b32 v53 offset:288
    ds_write_addtid_b32 v54 offset:576
    ds_write_addtid_b32 v55 offset:864
    ds_write_addtid_b32 v56 offset:1152
    ds_write_addtid_b32 v57 offset:1440
    ds_write_addtid_b32 v58 offset:1728
    ds_write_addtid_b32 v59 offset:2016
    ds_write_addtid_b32 v60 offset:2304
    ds_write_addtid_b32 v61 offset:2592
    ds_write_addtid_b32 v62 offset:2880
    ds_write_addtid_b32 v63 offset:3168
    ds_write_addtid_b32 v64 offset:3456
    ds_write_addtid_b32 v65 offset:3744
    ds_write_addtid_b32 v66 offset:4032
    ds_write_addtid_b32 v67 offset:4320
    v_mov_b32 v16, v84
    v_mov_b32 v17, v85
    v_pk_mul_f32 v[18:19], v[16:17], v[4:5] op_sel:[0,0] op_sel_hi:[1,0]
    v_pk_mul_f32 v[20:21], v[16:17], v[48:49] op_sel:[0,0] op_sel_hi:[1,0]
    v_pk_mul_f32 v[24:25], v[16:17], v[50:51] op_sel:[0,0] op_sel_hi:[1,0]
    v_pk_mul_f32 v[32:33], v[16:17], v[8:9] op_sel:[0,0] op_sel_hi:[1,0]
    v_pk_fma_f32 v[18:19], v[16:17], v[4:5], v[18:19] op_sel:[1,1,0] op_sel_hi:[0,1,1] neg_lo:[1,0,0]
    v_pk_fma_f32 v[20:21], v[16:17], v[48:49], v[20:21] op_sel:[1,1,0] op_sel_hi:[0,1,1] neg_lo:[1,0,0]
    v_pk_fma_f32 v[24:25], v[16:17], v[50:51], v[24:25] op_sel:[1,1,0] op_sel_hi:[0,1,1] neg_lo:[1,0,0]
    v_pk_fma_f32 v[32:33], v[16:17], v[8:9], v[32:33] op_sel:[1,1,0] op_sel_hi:[0,1,1] neg_lo:[1,0,0]
    s_waitcnt lgkmcnt(0)
    ds_read_b128 v[68:71], v3 offset:0
    ds_read_b128 v[72:75], v3 offset:64
    ds_read_b128 v[76:79], v3 offset:128
    ds_read_b128 v[80:83], v3 offset:192
    v_pk_mul_f32 v[22:23], v[18:19], v[48:49] op_sel:[0,0] op_sel_hi:[1,0]
    v_pk_mul_f32 v[26:27], v[18:19], v[50:51] op_sel:[0,0] op_sel_hi:[1,0]
    v_pk_mul_f32 v[28:29], v[20:21], v[50:51] op_sel:[0,0] op_sel_hi:[1,0]
    v_pk_mul_f32 v[34:35], v[18:19], v[8:9] op_sel:[0,0] op_sel_hi:[1,0]
    v_pk_mul_f32 v[36:37], v[20:21], v[8:9] op_sel:[0,0] op_sel_hi:[1,0]
    v_pk_mul_f32 v[40:41], v[24:25], v[8:9] op_sel:[0,0] op_sel_hi:[1,0]
    v_pk_fma_f32 v[22:23], v[18:19], v[48:49], v[22:23] op_sel:[1,1,0] op_sel_hi:[0,1,1] neg_lo:[1,0,0]
    v_pk_fma_f32 v[26:27], v[18:19], v[50:51], v[26:27] op_sel:[1,1,0] op_sel_hi:[0,1,1] neg_lo:[1,0,0]
    v_pk_fma_f32 v[28:29], v[20:21], v[50:51], v[28:29] op_sel:[1,1,0] op_sel_hi:[0,1,1] neg_lo:[1,0,0]
    v_pk_fma_f32 v[34:35], v[18:19], v[8:9], v[34:35] op_sel:[1,1,0] op_sel_hi:[0,1,1] neg_lo:[1,0,0]
    v_pk_fma_f32 v[36:37], v[20:21], v[8:9], v[36:37] op_sel:[1,1,0] op_sel_hi:[0,1,1] neg_lo:[1,0,0]
    v_pk_fma_f32 v[40:41], v[24:25], v[8:9], v[40:41] op_sel:[1,1,0] op_sel_hi:[0,1,1] neg_lo:[1,0,0]
    v_pk_mul_f32 v[30:31], v[22:23], v[50:51] op_sel:[0,0] op_sel_hi:[1,0]
    v_pk_mul_f32 v[38:39], v[22:23], v[8:9] op_sel:[0,0] op_sel_hi:[1,0]
    v_pk_mul_f32 v[42:43], v[26:27], v[8:9] op_sel:[0,0] op_sel_hi:[1,0]
    v_pk_mul_f32 v[44:45], v[28:29], v[8:9] op_sel:[0,0] op_sel_hi:[1,0]
    v_pk_fma_f32 v[30:31], v[22:23], v[50:51], v[30:31] op_sel:[1,1,0] op_sel_hi:[0,1,1] neg_lo:[1,0,0]
    v_pk_fma_f32 v[38:39], v[22:23], v[8:9], v[38:39] op_sel:[1,1,0] op_sel_hi:[0,1,1] neg_lo:[1,0,0]
    v_pk_fma_f32 v[42:43], v[26:27], v[8:9], v[42:43] op_sel:[1,1,0] op_sel_hi:[0,1,1] neg_lo:[1,0,0]
    v_pk_fma_f32 v[44:45], v[28:29], v[8:9], v[44:45] op_sel:[1,1,0] op_sel_hi:[0,1,1] neg_lo:[1,0,0]
    v_pk_mul_f32 v[46:47], v[30:31], v[8:9] op_sel:[0,0] op_sel_hi:[1,0]
    v_pk_fma_f32 v[46:47], v[30:31], v[8:9], v[46:47] op_sel:[1,1,0] op_sel_hi:[0,1,1] neg_lo:[1,0,0]
    s_cmp_ge_u32 s3, 4
    s_cbranch_scc1 L_st_mid
    s_waitcnt vmcnt(0)
    v_mov_b32 v192, 45312
    v_mov_b32 v194, 1
    s_mov_b64 exec, 1
    ds_add_rtn_u32 v194, v192, v194
    s_waitcnt lgkmcnt(0)
    s_mov_b64 exec, -1
    v_readfirstlane_b32 s56, v194
    s_nop 1
    s_cmp_eq_u32 s56, 3
    s_nop 0
    s_cbranch_scc0 L_st_mid
    s_lshl_b32 s50, s2, 7
    s_add_u32 s50, s50, 4096
    v_lshl_add_u32 v192, v1, 4, s50
    v_mov_b32 v196, s34
    v_mov_b32 v197, s35
    v_mov_b32 v198, s34
    v_mov_b32 v199, s35
    s_mov_b64 exec, 0xff
    global_store_dwordx4 v192, v[196:199], s[32:33] sc1
    s_mov_b64 exec, -1
L_st_mid:
    s_cmp_eq_u32 s42, 0
    s_cbranch_scc1 L_st_mid2
    global_load_dwordx4 v[160:163], v184, s[12:13]
    global_load_dwordx4 v[164:167], v185, s[12:13]
    global_load_dwordx4 v[168:171], v186, s[12:13]
    global_load_dwordx4 v[172:175], v187, s[12:13]
    global_load_dwordx4 v[176:179], v188, s[12:13]
L_st_mid2:
    s_mov_b32 m0, s46
    s_waitcnt lgkmcnt(0)
    v_cvt_pk_f16_f32 v52, v16, v17
    v_cvt_pk_f16_f32 v53, v18, v19
    v_cvt_pk_f16_f32 v54, v20, v21
    v_cvt_pk_f16_f32 v55, v22, v23
    v_cvt_pk_f16_f32 v56, v24, v25
    v_cvt_pk_f16_f32 v57, v26, v27
    v_cvt_pk_f16_f32 v58, v28, v29
    v_cvt_pk_f16_f32 v59, v30, v31
    v_cvt_pk_f16_f32 v60, v32, v33
    v_cvt_pk_f16_f32 v61, v34, v35
    v_cvt_pk_f16_f32 v62, v36, v37
    v_cvt_pk_f16_f32 v63, v38, v39
    v_cvt_pk_f16_f32 v64, v40, v41
    v_cvt_pk_f16_f32 v65, v42, v43
    v_cvt_pk_f16_f32 v66, v44, v45
    v_cvt_pk_f16_f32 v67, v46, v47
    ds_write_addtid_b32 v52 offset:0
    ds_write_addtid_b32 v53 offset:288
    ds_write_addtid_b32 v54 offset:576
    ds_write_addtid_b32 v55 offset:864
    ds_write_addtid_b32 v56 offset:1152
    ds_write_addtid_b32 v57 offset:1440
    ds_write_addtid_b32 v58 offset:1728
    ds_write_addtid_b32 v59 offset:2016
    ds_write_addtid_b32 v60 offset:2304
    ds_write_addtid_b32 v61 offset:2592
    ds_write_addtid_b32 v62 offset:2880
    ds_write_addtid_b32 v63 offset:3168
    ds_write_addtid_b32 v64 offset:3456
    ds_write_addtid_b32 v65 offset:3744
    ds_write_addtid_b32 v66 offset:4032
    ds_write_addtid_b32 v67 offset:4320
    v_pk_mul_f32 v[18:19], v[16:17], v[10:11] op_sel:[0,0] op_sel_hi:[1,0]
    v_pk_mul_f32 v[22:23], v[20:21], v[10:11] op_sel:[0,0] op_sel_hi:[1,0]
    v_pk_mul_f32 v[26:27], v[24:25], v[10:11] op_sel:[0,0] op_sel_hi:[1,0]
    v_pk_mul_f32 v[30:31], v[28:29], v[10:11] op_sel:[0,0] op_sel_hi:[1,0]
    v_pk_mul_f32 v[34:35], v[32:33], v[10:11] op_sel:[0,0] op_sel_hi:[1,0]
    v_pk_mul_f32 v[38:39], v[36:37], v[10:11] op_sel:[0,0] op_sel_hi:[1,0]
    v_pk_mul_f32 v[42:43], v[40:41], v[10:11] op_sel:[0,0] op_sel_hi:[1,0]
    v_pk_mul_f32 v[46:47], v[44:45], v[10:11] op_sel:[0,0] op_sel_hi:[1,0]
    v_pk_fma_f32 v[18:19], v[16:17], v[10:11], v[18:19] op_sel:[1,1,0] op_sel_hi:[0,1,1] neg_lo:[1,0,0]
    v_pk_fma_f32 v[22:23], v[20:21], v[10:11], v[22:23] op_sel:[1,1,0] op_sel_hi:[0,1,1] neg_lo:[1,0,0]
    v_pk_fma_f32 v[26:27], v[24:25], v[10:11], v[26:27] op_sel:[1,1,0] op_sel_hi:[0,1,1] neg_lo:[1,0,0]
    v_pk_fma_f32 v[30:31], v[28:29], v[10:11], v[30:31] op_sel:[1,1,0] op_sel_hi:[0,1,1] neg_lo:[1,0,0]
    v_pk_fma_f32 v[34:35], v[32:33], v[10:11], v[34:35] op_sel:[1,1,0] op_sel_hi:[0,1,1] neg_lo:[1,0,0]
    v_pk_fma_f32 v[38:39], v[36:37], v[10:11], v[38:39] op_sel:[1,1,0] op_sel_hi:[0,1,1] neg_lo:[1,0,0]
    v_pk_fma_f32 v[42:43], v[40:41], v[10:11], v[42:43] op_sel:[1,1,0] op_sel_hi:[0,1,1] neg_lo:[1,0,0]
    v_pk_fma_f32 v[46:47], v[44:45], v[10:11], v[46:47] op_sel:[1,1,0] op_sel_hi:[0,1,1] neg_lo:[1,0,0]
    s_waitcnt lgkmcnt(0)
    ds_read_b128 v[52:55], v3 offset:0
    ds_read_b128 v[56:59], v3 offset:64
    ds_read_b128 v[60:63], v3 offset:128
    ds_read_b128 v[64:67], v3 offset:192
    v_pk_mul_f32 v[20:21], v[16:17], v[12:13] op_sel:[0,0] op_sel_hi:[1,0]
    v_pk_mul_f32 v[28:29], v[24:25], v[12:13] op_sel:[0,0] op_sel_hi:[1,0]
    v_pk_mul_f32 v[36:37], v[32:33], v[12:13] op_sel:[0,0] op_sel_hi:[1,0]
    v_pk_mul_f32 v[44:45], v[40:41], v[12:13] op_sel:[0,0] op_sel_hi:[1,0]
    v_pk_fma_f32 v[20:21], v[16:17], v[12:13], v[20:21] op_sel:[1,1,0] op_sel_hi:[0,1,1] neg_lo:[1,0,0]
    v_pk_fma_f32 v[28:29], v[24:25], v[12:13], v[28:29] op_sel:[1,1,0] op_sel_hi:[0,1,1] neg_lo:[1,0,0]
    v_pk_fma_f32 v[36:37], v[32:33], v[12:13], v[36:37] op_sel:[1,1,0] op_sel_hi:[0,1,1] neg_lo:[1,0,0]
    v_pk_fma_f32 v[44:45], v[40:41], v[12:13], v[44:45] op_sel:[1,1,0] op_sel_hi:[0,1,1] neg_lo:[1,0,0]
    v_pk_mul_f32 v[24:25], v[20:21], v[10:11] op_sel:[0,0] op_sel_hi:[1,0]
    v_pk_mul_f32 v[40:41], v[28:29], v[10:11] op_sel:[0,0] op_sel_hi:[1,0]
    v_pk_mul_f32 v[48:49], v[36:37], v[10:11] op_sel:[0,0] op_sel_hi:[1,0]
    v_pk_mul_f32 v[50:51], v[44:45], v[10:11] op_sel:[0,0] op_sel_hi:[1,0]
    v_pk_fma_f32 v[24:25], v[20:21], v[10:11], v[24:25] op_sel:[1,1,0] op_sel_hi:[0,1,1] neg_lo:[1,0,0]
    v_pk_fma_f32 v[40:41], v[28:29], v[10:11], v[40:41] op_sel:[1,1,0] op_sel_hi:[0,1,1] neg_lo:[1,0,0]
    v_pk_fma_f32 v[48:49], v[36:37], v[10:11], v[48:49] op_sel:[1,1,0] op_sel_hi:[0,1,1] neg_lo:[1,0,0]
    v_pk_fma_f32 v[50:51], v[44:45], v[10:11], v[50:51] op_sel:[1,1,0] op_sel_hi:[0,1,1] neg_lo:[1,0,0]
    s_cmp_lt_u32 s3, 4
    s_cbranch_scc1 L_xs1
    s_and_b32 s47, s4, 3
    s_add_u32 s47, s47, 1
    s_sub_u32 s48, s47, 5
    s_min_u32 s47, s47, s48
    s_lshl_b32 s48, s5, 2
    s_add_u32 s48, s48, s47
    s_max_u32 s48, s48, 1
    s_sub_u32 s48, s48, 1
    s_mul_i32 s48, s48, 20480
    s_mul_i32 s47, s47, 20480
    s_lshl_b32 s49, s3, 10
    s_add_u32 s47, s47, s49
    s_add_u32 s50, s8, s48
    s_addc_u32 s51, s9, 0
    s_add_u32 m0, s47, 57344
    s_nop 0
    global_load_lds_dwordx4 v246, s[50:51]
    s_add_u32 m0, s47, 61440
    s_nop 0
    global_load_lds_dwordx4 v247, s[50:51]
    s_add_u32 m0, s47, 65536
    s_nop 0
    global_load_lds_dwordx4 v248, s[50:51]
    s_add_u32 m0, s47, 69632
    s_nop 0
    global_load_lds_dwordx4 v249, s[50:51]
    s_add_u32 m0, s47, 73728
    s_nop 0
    global_load_lds_dwordx4 v250, s[50:51]
    s_and_b32 s47, s4, 3
    s_add_u32 s47, s47, 2
    s_sub_u32 s48, s47, 5
    s_min_u32 s47, s47, s48
    s_lshl_b32 s48, s5, 2
    s_add_u32 s48, s48, s47
    s_max_u32 s48, s48, 1
    s_sub_u32 s48, s48, 1
    s_mul_i32 s48, s48, 20480
    s_mul_i32 s47, s47, 20480
    s_lshl_b32 s49, s3, 10
    s_add_u32 s47, s47, s49
    s_add_u32 s50, s8, s48
    s_addc_u32 s51, s9, 0
    s_add_u32 m0, s47, 57344
    s_nop 0
    global_load_lds_dwordx4 v246, s[50:51]
    s_add_u32 m0, s47, 61440
    s_nop 0
    global_load_lds_dwordx4 v247, s[50:51]
    s_add_u32 m0, s47, 65536
    s_nop 0
    global_load_lds_dwordx4 v248, s[50:51]
    s_add_u32 m0, s47, 69632
    s_nop 0
    global_load_lds_dwordx4 v249, s[50:51]
    s_add_u32 m0, s47, 73728
    s_nop 0
    global_load_lds_dwordx4 v250, s[50:51]
L_xs1:
    s_mov_b32 m0, s46
    s_waitcnt lgkmcnt(0)
    v_mfma_f32_16x16x32_f16 v[84:87], v[52:55], v[68:71], 0
    v_mfma_f32_16x16x32_f16 v[84:87], v[56:59], v[72:75], v[84:87]
    v_mfma_f32_16x16x32_f16 v[84:87], v[60:63], v[76:79], v[84:87]
    v_mfma_f32_16x16x32_f16 v[84:87], v[64:67], v[80:83], v[84:87]
    v_cvt_pk_f16_f32 v52, v18, v19
    v_cvt_pk_f16_f32 v53, v22, v23
    v_cvt_pk_f16_f32 v54, v26, v27
    v_cvt_pk_f16_f32 v55, v30, v31
    v_cvt_pk_f16_f32 v56, v34, v35
    v_cvt_pk_f16_f32 v57, v38, v39
    v_cvt_pk_f16_f32 v58, v42, v43
    v_cvt_pk_f16_f32 v59, v46, v47
    v_cvt_pk_f16_f32 v60, v20, v21
    v_cvt_pk_f16_f32 v61, v28, v29
    v_cvt_pk_f16_f32 v62, v36, v37
    v_cvt_pk_f16_f32 v63, v44, v45
    v_cvt_pk_f16_f32 v64, v24, v25
    v_cvt_pk_f16_f32 v65, v40, v41
    v_cvt_pk_f16_f32 v66, v48, v49
    v_cvt_pk_f16_f32 v67, v50, v51
    ds_write_addtid_b32 v52 offset:0
    ds_write_addtid_b32 v53 offset:288
    ds_write_addtid_b32 v54 offset:576
    ds_write_addtid_b32 v55 offset:864
    ds_write_addtid_b32 v56 offset:1152
    ds_write_addtid_b32 v57 offset:1440
    ds_write_addtid_b32 v58 offset:1728
    ds_write_addtid_b32 v59 offset:2016
    ds_write_addtid_b32 v60 offset:2304
    ds_write_addtid_b32 v61 offset:2592
    ds_write_addtid_b32 v62 offset:2880
    ds_write_addtid_b32 v63 offset:3168
    ds_write_addtid_b32 v64 offset:3456
    ds_write_addtid_b32 v65 offset:3744
    ds_write_addtid_b32 v66 offset:4032
    ds_write_addtid_b32 v67 offset:4320
    v_pk_mul_f32 v[18:19], v[16:17], v[14:15] op_sel:[0,0] op_sel_hi:[1,0]
    v_pk_mul_f32 v[22:23], v[32:33], v[14:15] op_sel:[0,0] op_sel_hi:[1,0]
    v_pk_fma_f32 v[18:19], v[16:17], v[14:15], v[18:19] op_sel:[1,1,0] op_sel_hi:[0,1,1] neg_lo:[1,0,0]
    v_pk_fma_f32 v[22:23], v[32:33], v[14:15], v[22:23] op_sel:[1,1,0] op_sel_hi:[0,1,1] neg_lo:[1,0,0]
    s_waitcnt lgkmcnt(0)
    ds_read_b128 v[52:55], v3 offset:0
    ds_read_b128 v[56:59], v3 offset:64
    ds_read_b128 v[60:63], v3 offset:128
    ds_read_b128 v[64:67], v3 offset:192
    v_pk_mul_f32 v[26:27], v[18:19], v[10:11] op_sel:[0,0] op_sel_hi:[1,0]
    v_pk_mul_f32 v[30:31], v[22:23], v[10:11] op_sel:[0,0] op_sel_hi:[1,0]
    v_pk_mul_f32 v[34:35], v[18:19], v[12:13] op_sel:[0,0] op_sel_hi:[1,0]
    v_pk_mul_f32 v[38:39], v[22:23], v[12:13] op_sel:[0,0] op_sel_hi:[1,0]
    v_pk_mul_f32 v[20:21], v[18:19], v[14:15] op_sel:[0,0] op_sel_hi:[1,0]
    v_pk_fma_f32 v[26:27], v[18:19], v[10:11], v[26:27] op_sel:[1,1,0] op_sel_hi:[0,1,1] neg_lo:[1,0,0]
    v_pk_fma_f32 v[30:31], v[22:23], v[10:11], v[30:31] op_sel:[1,1,0] op_sel_hi:[0,1,1] neg_lo:[1,0,0]
    v_pk_fma_f32 v[34:35], v[18:19], v[12:13], v[34:35] op_sel:[1,1,0] op_sel_hi:[0,1,1] neg_lo:[1,0,0]
    v_pk_fma_f32 v[38:39], v[22:23], v[12:13], v[38:39] op_sel:[1,1,0] op_sel_hi:[0,1,1] neg_lo:[1,0,0]
    v_pk_fma_f32 v[20:21], v[18:19], v[14:15], v[20:21] op_sel:[1,1,0] op_sel_hi:[0,1,1] neg_lo:[1,0,0]
    v_pk_mul_f32 v[42:43], v[34:35], v[10:11] op_sel:[0,0] op_sel_hi:[1,0]
    v_pk_mul_f32 v[46:47], v[38:39], v[10:11] op_sel:[0,0] op_sel_hi:[1,0]
    v_pk_fma_f32 v[42:43], v[34:35], v[10:11], v[42:43] op_sel:[1,1,0] op_sel_hi:[0,1,1] neg_lo:[1,0,0]
    v_pk_fma_f32 v[46:47], v[38:39], v[10:11], v[46:47] op_sel:[1,1,0] op_sel_hi:[0,1,1] neg_lo:[1,0,0]
    s_cmp_lt_u32 s3, 4
    s_cbranch_scc1 L_xs2
    s_and_b32 s47, s4, 3
    s_add_u32 s47, s47, 3
    s_sub_u32 s48, s47, 5
    s_min_u32 s47, s47, s48
    s_lshl_b32 s48, s5, 2
    s_add_u32 s48, s48, s47
    s_max_u32 s48, s48, 1
    s_sub_u32 s48, s48, 1
    s_mul_i32 s48, s48, 20480
    s_mul_i32 s47, s47, 20480
    s_lshl_b32 s49, s3, 10
    s_add_u32 s47, s47, s49
    s_add_u32 s50, s8, s48
    s_addc_u32 s51, s9, 0
    s_add_u32 m0, s47, 57344
    s_nop 0
    global_load_lds_dwordx4 v246, s[50:51]
    s_add_u32 m0, s47, 61440
    s_nop 0
    global_load_lds_dwordx4 v247, s[50:51]
    s_add_u32 m0, s47, 65536
    s_nop 0
    global_load_lds_dwordx4 v248, s[50:51]
    s_add_u32 m0, s47, 69632
    s_nop 0
    global_load_lds_dwordx4 v249, s[50:51]
    s_add_u32 m0, s47, 73728
    s_nop 0
    global_load_lds_dwordx4 v250, s[50:51]
    s_and_b32 s47, s4, 3
    s_add_u32 s47, s47, 4
    s_sub_u32 s48, s47, 5
    s_min_u32 s47, s47, s48
    s_lshl_b32 s48, s5, 2
    s_add_u32 s48, s48, s47
    s_max_u32 s48, s48, 1
    s_sub_u32 s48, s48, 1
    s_mul_i32 s48, s48, 20480
    s_mul_i32 s47, s47, 20480
    s_lshl_b32 s49, s3, 10
    s_add_u32 s47, s47, s49
    s_add_u32 s50, s8, s48
    s_addc_u32 s51, s9, 0
    s_add_u32 m0, s47, 57344
    s_nop 0
    global_load_lds_dwordx4 v246, s[50:51]
    s_add_u32 m0, s47, 61440
    s_nop 0
    global_load_lds_dwordx4 v247, s[50:51]
    s_add_u32 m0, s47, 65536
    s_nop 0
    global_load_lds_dwordx4 v248, s[50:51]
    s_add_u32 m0, s47, 69632
    s_nop 0
    global_load_lds_dwordx4 v249, s[50:51]
    s_add_u32 m0, s47, 73728
    s_nop 0
    global_load_lds_dwordx4 v250, s[50:51]
L_xs2:
    s_mov_b32 m0, s46
    s_waitcnt lgkmcnt(0)
    v_mfma_f32_16x16x32_f16 v[88:91], v[52:55], v[68:71], 0
    v_mfma_f32_16x16x32_f16 v[88:91], v[56:59], v[72:75], v[88:91]
    v_mfma_f32_16x16x32_f16 v[88:91], v[60:63], v[76:79], v[88:91]
    v_mfma_f32_16x16x32_f16 v[88:91], v[64:67], v[80:83], v[88:91]
    v_cvt_pk_f16_f32 v52, v18, v19
    v_cvt_pk_f16_f32 v53, v22, v23
    v_cvt_pk_f16_f32 v54, v26, v27
    v_cvt_pk_f16_f32 v55, v30, v31
    v_cvt_pk_f16_f32 v56, v34, v35
    v_cvt_pk_f16_f32 v57, v38, v39
    v_cvt_pk_f16_f32 v58, v42, v43
    v_cvt_pk_f16_f32 v59, v46, v47
    v_cvt_pk_f16_f32 v60, v20, v21
    ds_write_addtid_b32 v52 offset:0
    ds_write_addtid_b32 v53 offset:288
    ds_write_addtid_b32 v54 offset:576
    ds_write_addtid_b32 v55 offset:864
    ds_write_addtid_b32 v56 offset:1152
    ds_write_addtid_b32 v57 offset:1440
    ds_write_addtid_b32 v58 offset:1728
    ds_write_addtid_b32 v59 offset:2016
    ds_write_addtid_b32 v60 offset:2304
    s_waitcnt lgkmcnt(0)
    ds_read_b128 v[52:55], v3 offset:0
    ds_read_b128 v[56:59], v3 offset:64
    ds_read_b128 v[60:63], v3 offset:128
    ds_read_b128 v[64:67], v3 offset:192
    v_lshl_add_u32 v2, v1, 4, s46
    v_mov_b32 v4, 0
    s_waitcnt lgkmcnt(0)
    v_mfma_f32_16x16x32_f16 v[92:95], v[52:55], v[68:71], 0
    v_mfma_f32_16x16x32_f16 v[92:95], v[56:59], v[72:75], v[92:95]
    v_mfma_f32_16x16x32_f16 v[92:95], v[60:63], v[76:79], v[92:95]
    v_mfma_f32_16x16x32_f16 v[92:95], v[64:67], v[80:83], v[92:95]
    ds_write_b128 v2, v[84:87]
    ds_write_b128 v2, v[88:91] offset:1024
    ds_write_addtid_b32 v4 offset:3072
    s_nop 4
    ds_write_b128 v2, v[92:95] offset:2048
    s_cmp_lt_u32 s3, 6
    s_cbranch_scc1 L_st_npx
    s_cmp_eq_u32 s3, 7
    s_cselect_b32 s46, s36, 0
    s_cmp_eq_u32 s46, 1
    s_cbranch_scc1 L_st_npx
    s_lshr_b32 s46, s14, 1
    s_mul_i32 s46, s46, 3
    s_add_u32 s46, s46, s52
    s_mul_i32 s46, s46, 3072
    s_add_u32 s46, s46, 15710208
    v_lshl_add_u32 v2, v1, 4, s46
    global_store_dwordx4 v2, v[84:87], s[32:33] sc1
    global_store_dwordx4 v2, v[88:91], s[32:33] offset:1024 sc1
    global_store_dwordx4 v2, v[92:95], s[32:33] offset:2048 sc1
L_st_npx:
    s_cmp_eq_u32 s42, 0
    s_cbranch_scc1 L_st_nwo
    s_waitcnt vmcnt(0)
    global_store_dwordx4 v189, v[160:163], s[32:33] offset:-1024 sc1
    global_store_dwordx4 v189, v[164:167], s[32:33] offset:0 sc1
    global_store_dwordx4 v189, v[168:171], s[32:33] offset:1024 sc1
    global_store_dwordx4 v189, v[172:175], s[32:33] offset:2048 sc1
    global_store_dwordx4 v189, v[176:179], s[32:33] offset:3072 sc1
L_st_nwo:
    s_mov_b32 s53, s42
    v_and_b32 v16, 15, v1
    v_lshrrev_b32 v17, 4, v1
    v_lshrrev_b32 v18, 2, v16
    v_and_b32 v19, 3, v1
    s_and_b32 s42, s3, 3
    s_lshr_b32 s43, s3, 2
    s_mul_i32 s43, s43, 48
    s_mul_i32 s44, s4, 80
    s_add_u32 s43, s43, s44
    v_mov_b32 v10, 0x3f803f80
    v_mov_b32 v11, 0x3f803f80
    v_mov_b32 v12, 0x3f803f80
    v_mov_b32 v13, 0x3f803f80
    s_mul_i32 s46, s4, 15
    s_lshl_b32 s47, s3, 1
    s_add_u32 s46, s46, s47
    s_mul_i32 s46, s46, 20480
    s_add_u32 s46, s46, 1048576
    s_add_u32 s48, s32, s46
    s_addc_u32 s49, s33, 0
    s_add_u32 s50, s48, 20480
    s_addc_u32 s51, s49, 0
    s_xor_b32 s46, s6, 0
    s_lshl_b32 s46, s46, 10
    v_lshl_add_u32 v44, v1, 4, s46
    s_xor_b32 s46, s6, 1
    s_lshl_b32 s46, s46, 10
    v_lshl_add_u32 v45, v1, 4, s46
    s_xor_b32 s46, s6, 2
    s_lshl_b32 s46, s46, 10
    v_lshl_add_u32 v46, v1, 4, s46
    s_xor_b32 s46, s6, 3
    s_lshl_b32 s46, s46, 10
    v_lshl_add_u32 v47, v1, 4, s46
    v_mul_u32_u24 v20, 1280, v16
    v_add_u32 v20, 61440, v20
    v_add_u32 v21, 0, v17
    v_xor_b32 v21, v21, v16
    v_lshl_add_u32 v2, v21, 4, v20
    v_add_u32 v21, 4, v17
    v_xor_b32 v21, v21, v16
    v_lshl_add_u32 v3, v21, 4, v20
    v_add_u32 v21, 8, v17
    v_xor_b32 v21, v21, v16
    v_lshl_add_u32 v4, v21, 4, v20
    v_add_u32 v21, 12, v17
    v_xor_b32 v21, v21, v16
    v_lshl_add_u32 v5, v21, 4, v20
    v_lshl_add_u32 v20, v17, 2, v18
    s_lshl_b32 s44, s6, 2
    v_xor_b32 v21, s44, v20
    s_lshl_b32 s44, s42, 4
    s_add_u32 s44, s44, 16
    v_add_u32 v20, s44, v20
    v_mul_u32_u24 v20, 1280, v20
    v_add_u32 v20, 61440, v20
    v_and_b32 v22, 1, v19
    v_lshl_add_u32 v20, v22, 3, v20
    v_lshrrev_b32 v22, 1, v19
    s_lshr_b32 s44, s43, 3
    v_add_u32 v22, s44, v22
    v_add_u32 v23, 0, v22
    v_min_u32 v23, 79, v23
    v_xor_b32 v23, v23, v21
    v_lshl_add_u32 v7, v23, 4, v20
    v_add_u32 v23, 2, v22
    v_min_u32 v23, 79, v23
    v_xor_b32 v23, v23, v21
    v_lshl_add_u32 v8, v23, 4, v20
    v_add_u32 v23, 4, v22
    v_min_u32 v23, 79, v23
    v_xor_b32 v23, v23, v21
    v_lshl_add_u32 v9, v23, 4, v20
    s_waitcnt vmcnt(0)
    s_sub_u32 s46, s3, 4
    s_cmp_lt_u32 s46, 2
    s_cbranch_scc0 L_st_n1
    s_lshl_b32 s46, s46, 10
    s_add_u32 s46, s46, 61440
    v_lshl_add_u32 v24, v1, 4, s46
    v_min_u32 v24, 62704, v24
    ds_write_b128 v24, v[10:13]
L_st_n1:
    s_cmp_eq_u32 s53, 0
    s_cbranch_scc1 L_st_n2
    s_lshl_b32 s46, s2, 7
    s_add_u32 s46, s46, 233472
    v_lshl_add_u32 v24, v1, 4, s46
    v_mov_b32 v28, s34
    v_mov_b32 v29, s35
    v_mov_b32 v30, s34
    v_mov_b32 v31, s35
    s_mov_b64 exec, 0xff
    global_store_dwordx4 v24, v[28:31], s[32:33] sc1
    s_mov_b64 exec, -1
L_st_n2:
    s_cmp_lt_u32 s3, 6
    s_cbranch_scc1 L_st_w
    s_lshr_b32 s46, s14, 1
    s_lshl_b32 s46, s46, 2
    s_add_u32 s46, s46, s52
    s_lshl_b32 s46, s46, 7
    s_add_u32 s46, s46, 265472
    s_cmp_eq_u32 s3, 7
    s_cselect_b32 s47, s36, 0
    s_cmp_eq_u32 s47, 1
    s_cbranch_scc1 L_st_w
    v_lshl_add_u32 v24, v1, 4, s46
    v_mov_b32 v28, s34
    v_mov_b32 v29, s35
    v_mov_b32 v30, s34
    v_mov_b32 v31, s35
    s_mov_b64 exec, 0xff
    global_store_dwordx4 v24, v[28:31], s[32:33] sc1
    s_mov_b64 exec, -1
L_st_w:
    s_waitcnt lgkmcnt(0)
    s_barrier
    s_cmp_ge_u32 s3, 5
    s_cbranch_scc1 L_sp_done
    s_mul_i32 s42, s3, 20480
    v_add_u32 v56, s42, v2
    v_add_u32 v57, s42, v3
    v_add_u32 v58, s42, v4
    v_add_u32 v59, s42, v5
    ds_read_b128 v[16:19], v56 offset:0
    ds_read_b128 v[20:23], v57 offset:0
    ds_read_b128 v[24:27], v58 offset:0
    ds_read_b128 v[28:31], v59 offset:0
    ds_read_b128 v[32:35], v56 offset:256
    ds_read_b128 v[36:39], v57 offset:256
    ds_read_b128 v[40:43], v58 offset:256
    s_waitcnt lgkmcnt(6)
    v_mfma_f32_16x16x32_bf16 v[48:51], v[16:19], v[16:19], 0
    v_mfma_f32_16x16x32_bf16 v[52:55], v[10:13], v[16:19], 0
    ds_read_b128 v[16:19], v59 offset:256
    s_waitcnt lgkmcnt(6)
    v_mfma_f32_16x16x32_bf16 v[48:51], v[20:23], v[20:23], v[48:51]
    v_mfma_f32_16x16x32_bf16 v[52:55], v[10:13], v[20:23], v[52:55]
    ds_read_b128 v[20:23], v56 offset:512
    s_waitcnt lgkmcnt(6)
    v_mfma_f32_16x16x32_bf16 v[48:51], v[24:27], v[24:27], v[48:51]
    v_mfma_f32_16x16x32_bf16 v[52:55], v[10:13], v[24:27], v[52:55]
    ds_read_b128 v[24:27], v57 offset:512
    s_waitcnt lgkmcnt(6)
    v_mfma_f32_16x16x32_bf16 v[48:51], v[28:31], v[28:31], v[48:51]
    v_mfma_f32_16x16x32_bf16 v[52:55], v[10:13], v[28:31], v[52:55]
    ds_read_b128 v[28:31], v58 offset:512
    s_waitcnt lgkmcnt(6)
    v_mfma_f32_16x16x32_bf16 v[48:51], v[32:35], v[32:35], v[48:51]
    v_mfma_f32_16x16x32_bf16 v[52:55], v[10:13], v[32:35], v[52:55]
    ds_read_b128 v[32:35], v59 offset:512
    s_waitcnt lgkmcnt(6)
    v_mfma_f32_16x16x32_bf16 v[48:51], v[36:39], v[36:39], v[48:51]
    v_mfma_f32_16x16x32_bf16 v[52:55], v[10:13], v[36:39], v[52:55]
    ds_read_b128 v[36:39], v56 offset:768
    s_waitcnt lgkmcnt(6)
    v_mfma_f32_16x16x32_bf16 v[48:51], v[40:43], v[40:43], v[48:51]
    v_mfma_f32_16x16x32_bf16 v[52:55], v[10:13], v[40:43], v[52:55]
    ds_read_b128 v[40:43], v57 offset:768
    s_waitcnt lgkmcnt(6)
    v_mfma_f32_16x16x32_bf16 v[48:51], v[16:19], v[16:19], v[48:51]
    v_mfma_f32_16x16x32_bf16 v[52:55], v[10:13], v[16:19], v[52:55]
    ds_read_b128 v[16:19], v58 offset:768
    s_waitcnt lgkmcnt(6)
    v_mfma_f32_16x16x32_bf16 v[48:51], v[20:23], v[20:23], v[48:51]
    v_mfma_f32_16x16x32_bf16 v[52:55], v[10:13], v[20:23], v[52:55]
    ds_read_b128 v[20:23], v59 offset:768
    s_waitcnt lgkmcnt(6)
    v_mfma_f32_16x16x32_bf16 v[48:51], v[24:27], v[24:27], v[48:51]
    v_mfma_f32_16x16x32_bf16 v[52:55], v[10:13], v[24:27], v[52:55]
    ds_read_b128 v[24:27], v56 offset:1024
    s_waitcnt lgkmcnt(6)
    v_mfma_f32_16x16x32_bf16 v[48:51], v[28:31], v[28:31], v[48:51]
    v_mfma_f32_16x16x32_bf16 v[52:55], v[10:13], v[28:31], v[52:55]
    ds_read_b128 v[28:31], v57 offset:1024
    s_waitcnt lgkmcnt(6)
    v_mfma_f32_16x16x32_bf16 v[48:51], v[32:35], v[32:35], v[48:51]
    v_mfma_f32_16x16x32_bf16 v[52:55], v[10:13], v[32:35], v[52:55]
    ds_read_b128 v[32:35], v58 offset:1024
    s_waitcnt lgkmcnt(6)
    v_mfma_f32_16x16x32_bf16 v[48:51], v[36:39], v[36:39], v[48:51]
    v_mfma_f32_16x16x32_bf16 v[52:55], v[10:13], v[36:39], v[52:55]
    ds_read_b128 v[36:39], v59 offset:1024
    s_waitcnt lgkmcnt(6)
    v_mfma_f32_16x16x32_bf16 v[48:51], v[40:43], v[40:43], v[48:51]
    v_mfma_f32_16x16x32_bf16 v[52:55], v[10:13], v[40:43], v[52:55]
    s_waitcnt lgkmcnt(5)
    v_mfma_f32_16x16x32_bf16 v[48:51], v[16:19], v[16:19], v[48:51]
    v_mfma_f32_16x16x32_bf16 v[52:55], v[10:13], v[16:19], v[52:55]
    s_waitcnt lgkmcnt(4)
    v_mfma_f32_16x16x32_bf16 v[48:51], v[20:23], v[20:23], v[48:51]
    v_mfma_f32_16x16x32_bf16 v[52:55], v[10:13], v[20:23], v[52:55]
    s_waitcnt lgkmcnt(3)
    v_mfma_f32_16x16x32_bf16 v[48:51], v[24:27], v[24:27], v[48:51]
    v_mfma_f32_16x16x32_bf16 v[52:55], v[10:13], v[24:27], v[52:55]
    s_waitcnt lgkmcnt(2)
    v_mfma_f32_16x16x32_bf16 v[48:51], v[28:31], v[28:31], v[48:51]
    v_mfma_f32_16x16x32_bf16 v[52:55], v[10:13], v[28:31], v[52:55]
    s_waitcnt lgkmcnt(1)
    v_mfma_f32_16x16x32_bf16 v[48:51], v[32:35], v[32:35], v[48:51]
    v_mfma_f32_16x16x32_bf16 v[52:55], v[10:13], v[32:35], v[52:55]
    s_waitcnt lgkmcnt(0)
    v_mfma_f32_16x16x32_bf16 v[48:51], v[36:39], v[36:39], v[48:51]
    v_mfma_f32_16x16x32_bf16 v[52:55], v[10:13], v[36:39], v[52:55]
    v_and_b32 v16, 15, v1
    v_lshrrev_b32 v17, 4, v1
    v_and_b32 v18, 3, v1
    v_lshrrev_b32 v19, 2, v16
    v_cmp_eq_u32 s[42:43], 1, v18
    v_cmp_eq_u32 s[44:45], 2, v18
    v_cmp_eq_u32 s[46:47], 3, v18
    v_cmp_eq_u32 s[54:55], v19, v17
    v_lshlrev_b32 v18, 3, v16
    v_add_u32 v18, 45376, v18
    s_lshl_b32 s56, s3, 7
    v_add_u32 v18, s56, v18
    v_cndmask_b32 v48, v48, v49, s[42:43]
    v_cndmask_b32 v48, v48, v50, s[44:45]
    v_cndmask_b32 v48, v48, v51, s[46:47]
    v_mul_f32 v52, 0x3acccccd, v52
    v_mul_f32 v48, 0x3acccccd, v48
    v_fma_f32 v48, -v52, v52, v48
    v_max_f32 v48, 0, v48
    v_cvt_pk_bf16_f32 v52, v52, v48
    v_and_b32 v48, 0xffff0000, v52
    v_lshlrev_b32 v52, 16, v52
    v_add_f32 v48, 0x3727c5ac, v48
    v_cvt_pk_bf16_f32 v48, v48, v48
    v_lshlrev_b32 v48, 16, v48
    v_sqrt_f32 v48, v48
    s_nop 0
    v_cvt_pk_bf16_f32 v48, v48, v48
    v_lshlrev_b32 v48, 16, v48
    v_rcp_f32 v53, v48
    s_mov_b64 exec, s[54:55]
    ds_write_b64 v18, v[52:53] offset:0
    s_mov_b64 exec, -1
L_sp_done:
    s_cmp_eq_u32 s3, 7
    s_cbranch_scc0 L_st_np
    v_min_u32 v24, 59, v1
    v_lshlrev_b32 v24, 7, v24
    v_add_u32 v24, 4096, v24
    v_add_u32 v25, 7680, v24
    v_add_u32 v26, 15360, v24
    v_add_u32 v27, 23040, v24
    s_mov_b32 s57, 0
L_poll3:
    global_load_dwordx2 v[28:29], v24, s[32:33] sc1
    global_load_dwordx2 v[30:31], v25, s[32:33] sc1
    global_load_dwordx2 v[32:33], v26, s[32:33] sc1
    global_load_dwordx2 v[34:35], v27, s[32:33] sc1
    s_add_u32 s57, s57, 1
    s_waitcnt vmcnt(0)
    v_cmp_ne_u64 vcc, s[34:35], v[28:29]
    v_cmp_ne_u64 s[54:55], s[34:35], v[30:31]
    s_nop 1
    s_or_b64 vcc, vcc, s[54:55]
    v_cmp_ne_u64 s[54:55], s[34:35], v[32:33]
    s_nop 1
    s_or_b64 vcc, vcc, s[54:55]
    v_cmp_ne_u64 s[54:55], s[34:35], v[34:35]
    s_nop 1
    s_or_b64 vcc, vcc, s[54:55]
    s_cmp_gt_u32 s57, 200000
    s_cbranch_scc1 L_end
    s_cbranch_vccnz L_poll3
    v_mov_b32 v24, 45316
    v_mov_b32 v25, 1
    ds_write_b32 v24, v25
L_st_np:
    v_mov_b32 v24, 45316
    s_mov_b32 s57, 0
L_sp4:
    ds_read_b32 v25, v24
    s_add_u32 s57, s57, 1
    s_waitcnt lgkmcnt(0)
    v_readfirstlane_b32 s56, v25
    s_cmp_gt_u32 s57, 2000000
    s_nop 2
    s_cbranch_scc1 L_end
    s_cmp_lt_u32 s56, 1
    s_cbranch_scc1 L_sp4
    s_cmp_eq_u32 s3, 0
    s_cbranch_scc1 L_g1A
    s_cmp_eq_u32 s3, 1
    s_cbranch_scc1 L_g1B
    s_cmp_eq_u32 s3, 3
    s_cbranch_scc1 L_g1D
    s_cmp_eq_u32 s3, 7
    s_cbranch_scc1 L_g1E
    global_load_dwordx4 v[96:99], v44, s[48:49] sc1
    global_load_dwordx4 v[176:179], v44, s[50:51] sc1
    global_load_dwordx4 v[100:103], v45, s[48:49] sc1
    global_load_dwordx4 v[180:183], v45, s[50:51] sc1
    global_load_dwordx4 v[104:107], v46, s[48:49] sc1
    global_load_dwordx4 v[184:187], v46, s[50:51] sc1
    s_barrier
    global_load_dwordx4 v[108:111], v47, s[48:49] sc1
    s_add_u32 s48, s48, 4096
    s_addc_u32 s49, s49, 0
    global_load_dwordx4 v[188:191], v47, s[50:51] sc1
    s_add_u32 s50, s50, 4096
    s_addc_u32 s51, s51, 0
    global_load_dwordx4 v[112:115], v44, s[48:49] sc1
    global_load_dwordx4 v[192:195], v44, s[50:51] sc1
    global_load_dwordx4 v[116:119], v45, s[48:49] sc1
    global_load_dwordx4 v[196:199], v45, s[50:51] sc1
    s_barrier
    global_load_dwordx4 v[120:123], v46, s[48:49] sc1
    global_load_dwordx4 v[200:203], v46, s[50:51] sc1
    global_load_dwordx4 v[124:127], v47, s[48:49] sc1
    s_add_u32 s48, s48, 4096
    s_addc_u32 s49, s49, 0
    global_load_dwordx4 v[204:207], v47, s[50:51] sc1
    s_add_u32 s50, s50, 4096
    s_addc_u32 s51, s51, 0
    ds_read_b128 v[16:19], v2 offset:0
    ds_read_b128 v[20:23], v2 offset:20480
    ds_read_b128 v[24:27], v2 offset:40960
    ds_read_b128 v[28:31], v2 offset:61440
    v_add_u32 v6, 81920, v2
    ds_read_b128 v[32:35], v6 offset:0
    ds_read_b128 v[36:39], v3 offset:0
    s_waitcnt vmcnt(14) lgkmcnt(5)
    v_mfma_f32_16x16x32_bf16 v[48:51], v[96:99], v[16:19], 0
    ds_read_b128 v[40:43], v3 offset:20480
    global_load_dwordx4 v[128:131], v44, s[48:49] sc1
    v_mfma_f32_16x16x32_bf16 v[52:55], v[176:179], v[16:19], 0
    global_load_dwordx4 v[208:211], v44, s[50:51] sc1
    s_waitcnt lgkmcnt(5)
    v_mfma_f32_16x16x32_bf16 v[56:59], v[96:99], v[20:23], 0
    ds_read_b128 v[16:19], v3 offset:40960
    v_mfma_f32_16x16x32_bf16 v[60:63], v[176:179], v[20:23], 0
    s_waitcnt lgkmcnt(5)
    v_mfma_f32_16x16x32_bf16 v[64:67], v[96:99], v[24:27], 0
    ds_read_b128 v[20:23], v3 offset:61440
    v_mfma_f32_16x16x32_bf16 v[68:71], v[176:179], v[24:27], 0
    s_waitcnt lgkmcnt(5)
    v_mfma_f32_16x16x32_bf16 v[72:75], v[96:99], v[28:31], 0
    v_add_u32 v6, 81920, v3
    v_mfma_f32_16x16x32_bf16 v[76:79], v[176:179], v[28:31], 0
    ds_read_b128 v[24:27], v6 offset:0
    s_waitcnt lgkmcnt(5)
    v_mfma_f32_16x16x32_bf16 v[80:83], v[96:99], v[32:35], 0
    ds_read_b128 v[28:31], v4 offset:0
    v_mfma_f32_16x16x32_bf16 v[84:87], v[176:179], v[32:35], 0
    s_waitcnt vmcnt(14) lgkmcnt(5)
    v_mfma_f32_16x16x32_bf16 v[48:51], v[100:103], v[36:39], v[48:51]
    ds_read_b128 v[32:35], v4 offset:20480
    global_load_dwordx4 v[132:135], v45, s[48:49] sc1
    v_mfma_f32_16x16x32_bf16 v[52:55], v[180:183], v[36:39], v[52:55]
    global_load_dwordx4 v[212:215], v45, s[50:51] sc1
    s_waitcnt lgkmcnt(5)
    v_mfma_f32_16x16x32_bf16 v[56:59], v[100:103], v[40:43], v[56:59]
    ds_read_b128 v[36:39], v4 offset:40960
    v_mfma_f32_16x16x32_bf16 v[60:63], v[180:183], v[40:43], v[60:63]
    s_waitcnt lgkmcnt(5)
    v_mfma_f32_16x16x32_bf16 v[64:67], v[100:103], v[16:19], v[64:67]
    ds_read_b128 v[40:43], v4 offset:61440
    v_mfma_f32_16x16x32_bf16 v[68:71], v[180:183], v[16:19], v[68:71]
    s_waitcnt lgkmcnt(5)
    v_mfma_f32_16x16x32_bf16 v[72:75], v[100:103], v[20:23], v[72:75]
    v_add_u32 v6, 81920, v4
    v_mfma_f32_16x16x32_bf16 v[76:79], v[180:183], v[20:23], v[76:79]
    ds_read_b128 v[16:19], v6 offset:0
    s_waitcnt lgkmcnt(5)
    v_mfma_f32_16x16x32_bf16 v[80:83], v[100:103], v[24:27], v[80:83]
    ds_read_b128 v[20:23], v5 offset:0
    v_mfma_f32_16x16x32_bf16 v[84:87], v[180:183], v[24:27], v[84:87]
    s_waitcnt vmcnt(14) lgkmcnt(5)
    v_mfma_f32_16x16x32_bf16 v[48:51], v[104:107], v[28:31], v[48:51]
    ds_read_b128 v[24:27], v5 offset:20480
    s_barrier
    v_mfma_f32_16x16x32_bf16 v[52:55], v[184:187], v[28:31], v[52:55]
    global_load_dwordx4 v[136:139], v46, s[48:49] sc1
    global_load_dwordx4 v[216:219], v46, s[50:51] sc1
    s_waitcnt lgkmcnt(5)
    v_mfma_f32_16x16x32_bf16 v[56:59], v[104:107], v[32:35], v[56:59]
    ds_read_b128 v[28:31], v5 offset:40960
    v_mfma_f32_16x16x32_bf16 v[60:63], v[184:187], v[32:35], v[60:63]
    s_waitcnt lgkmcnt(5)
    v_mfma_f32_16x16x32_bf16 v[64:67], v[104:107], v[36:39], v[64:67]
    ds_read_b128 v[32:35], v5 offset:61440
    v_mfma_f32_16x16x32_bf16 v[68:71], v[184:187], v[36:39], v[68:71]
    s_waitcnt lgkmcnt(5)
    v_mfma_f32_16x16x32_bf16 v[72:75], v[104:107], v[40:43], v[72:75]
    v_add_u32 v6, 81920, v5
    v_mfma_f32_16x16x32_bf16 v[76:79], v[184:187], v[40:43], v[76:79]
    ds_read_b128 v[36:39], v6 offset:0
    s_waitcnt lgkmcnt(5)
    v_mfma_f32_16x16x32_bf16 v[80:83], v[104:107], v[16:19], v[80:83]
    ds_read_b128 v[40:43], v2 offset:256
    v_mfma_f32_16x16x32_bf16 v[84:87], v[184:187], v[16:19], v[84:87]
    s_waitcnt vmcnt(14) lgkmcnt(5)
    v_mfma_f32_16x16x32_bf16 v[48:51], v[108:111], v[20:23], v[48:51]
    ds_read_b128 v[16:19], v2 offset:20736
    global_load_dwordx4 v[140:143], v47, s[48:49] sc1
    v_mfma_f32_16x16x32_bf16 v[52:55], v[188:191], v[20:23], v[52:55]
    s_add_u32 s48, s48, 4096
    s_addc_u32 s49, s49, 0
    global_load_dwordx4 v[220:223], v47, s[50:51] sc1
    s_waitcnt lgkmcnt(5)
    v_mfma_f32_16x16x32_bf16 v[56:59], v[108:111], v[24:27], v[56:59]
    s_add_u32 s50, s50, 4096
    s_addc_u32 s51, s51, 0
    v_mfma_f32_16x16x32_bf16 v[60:63], v[188:191], v[24:27], v[60:63]
    ds_read_b128 v[20:23], v2 offset:41216
    s_waitcnt lgkmcnt(5)
    v_mfma_f32_16x16x32_bf16 v[64:67], v[108:111], v[28:31], v[64:67]
    ds_read_b128 v[24:27], v2 offset:61696
    v_mfma_f32_16x16x32_bf16 v[68:71], v[188:191], v[28:31], v[68:71]
    s_waitcnt lgkmcnt(5)
    v_mfma_f32_16x16x32_bf16 v[72:75], v[108:111], v[32:35], v[72:75]
    v_add_u32 v6, 81920, v2
    v_mfma_f32_16x16x32_bf16 v[76:79], v[188:191], v[32:35], v[76:79]
    ds_read_b128 v[28:31], v6 offset:256
    s_waitcnt lgkmcnt(5)
    v_mfma_f32_16x16x32_bf16 v[80:83], v[108:111], v[36:39], v[80:83]
    ds_read_b128 v[32:35], v3 offset:256
    v_mfma_f32_16x16x32_bf16 v[84:87], v[188:191], v[36:39], v[84:87]
    s_waitcnt vmcnt(14) lgkmcnt(5)
    v_mfma_f32_16x16x32_bf16 v[48:51], v[112:115], v[40:43], v[48:51]
    ds_read_b128 v[36:39], v3 offset:20736
    global_load_dwordx4 v[144:147], v44, s[48:49] sc1
    v_mfma_f32_16x16x32_bf16 v[52:55], v[192:195], v[40:43], v[52:55]
    global_load_dwordx4 v[224:227], v44, s[50:51] sc1
    s_waitcnt lgkmcnt(5)
    v_mfma_f32_16x16x32_bf16 v[56:59], v[112:115], v[16:19], v[56:59]
    ds_read_b128 v[40:43], v3 offset:41216
    v_mfma_f32_16x16x32_bf16 v[60:63], v[192:195], v[16:19], v[60:63]
    s_waitcnt lgkmcnt(5)
    v_mfma_f32_16x16x32_bf16 v[64:67], v[112:115], v[20:23], v[64:67]
    ds_read_b128 v[16:19], v3 offset:61696
    v_mfma_f32_16x16x32_bf16 v[68:71], v[192:195], v[20:23], v[68:71]
    s_waitcnt lgkmcnt(5)
    v_mfma_f32_16x16x32_bf16 v[72:75], v[112:115], v[24:27], v[72:75]
    v_add_u32 v6, 81920, v3
    v_mfma_f32_16x16x32_bf16 v[76:79], v[192:195], v[24:27], v[76:79]
    ds_read_b128 v[20:23], v6 offset:256
    s_waitcnt lgkmcnt(5)
    v_mfma_f32_16x16x32_bf16 v[80:83], v[112:115], v[28:31], v[80:83]
    ds_read_b128 v[24:27], v4 offset:256
    v_mfma_f32_16x16x32_bf16 v[84:87], v[192:195], v[28:31], v[84:87]
    s_waitcnt vmcnt(14) lgkmcnt(5)
    v_mfma_f32_16x16x32_bf16 v[48:51], v[116:119], v[32:35], v[48:51]
    ds_read_b128 v[28:31], v4 offset:20736
    s_barrier
    v_mfma_f32_16x16x32_bf16 v[52:55], v[196:199], v[32:35], v[52:55]
    global_load_dwordx4 v[148:151], v45, s[48:49] sc1
    global_load_dwordx4 v[228:231], v45, s[50:51] sc1
    s_waitcnt lgkmcnt(5)
    v_mfma_f32_16x16x32_bf16 v[56:59], v[116:119], v[36:39], v[56:59]
    ds_read_b128 v[32:35], v4 offset:41216
    v_mfma_f32_16x16x32_bf16 v[60:63], v[196:199], v[36:39], v[60:63]
    s_waitcnt lgkmcnt(5)
    v_mfma_f32_16x16x32_bf16 v[64:67], v[116:119], v[40:43], v[64:67]
    ds_read_b128 v[36:39], v4 offset:61696
    v_mfma_f32_16x16x32_bf16 v[68:71], v[196:199], v[40:43], v[68:71]
    s_waitcnt lgkmcnt(5)
    v_mfma_f32_16x16x32_bf16 v[72:75], v[116:119], v[16:19], v[72:75]
    v_add_u32 v6, 81920, v4
    v_mfma_f32_16x16x32_bf16 v[76:79], v[196:199], v[16:19], v[76:79]
    ds_read_b128 v[40:43], v6 offset:256
    s_waitcnt lgkmcnt(5)
    v_mfma_f32_16x16x32_bf16 v[80:83], v[116:119], v[20:23], v[80:83]
    ds_read_b128 v[16:19], v5 offset:256
    v_mfma_f32_16x16x32_bf16 v[84:87], v[196:199], v[20:23], v[84:87]
    s_waitcnt vmcnt(14) lgkmcnt(5)
    v_mfma_f32_16x16x32_bf16 v[48:51], v[120:123], v[24:27], v[48:51]
    ds_read_b128 v[20:23], v5 offset:20736
    global_load_dwordx4 v[152:155], v46, s[48:49] sc1
    v_mfma_f32_16x16x32_bf16 v[52:55], v[200:203], v[24:27], v[52:55]
    global_load_dwordx4 v[232:235], v46, s[50:51] sc1
    s_waitcnt lgkmcnt(5)
    v_mfma_f32_16x16x32_bf16 v[56:59], v[120:123], v[28:31], v[56:59]
    ds_read_b128 v[24:27], v5 offset:41216
    v_mfma_f32_16x16x32_bf16 v[60:63], v[200:203], v[28:31], v[60:63]
    s_waitcnt lgkmcnt(5)
    v_mfma_f32_16x16x32_bf16 v[64:67], v[120:123], v[32:35], v[64:67]
    ds_read_b128 v[28:31], v5 offset:61696
    v_mfma_f32_16x16x32_bf16 v[68:71], v[200:203], v[32:35], v[68:71]
    s_waitcnt lgkmcnt(5)
    v_mfma_f32_16x16x32_bf16 v[72:75], v[120:123], v[36:39], v[72:75]
    v_add_u32 v6, 81920, v5
    v_mfma_f32_16x16x32_bf16 v[76:79], v[200:203], v[36:39], v[76:79]
    ds_read_b128 v[32:35], v6 offset:256
    s_waitcnt lgkmcnt(5)
    v_mfma_f32_16x16x32_bf16 v[80:83], v[120:123], v[40:43], v[80:83]
    ds_read_b128 v[36:39], v2 offset:512
    v_mfma_f32_16x16x32_bf16 v[84:87], v[200:203], v[40:43], v[84:87]
    s_waitcnt vmcnt(14) lgkmcnt(5)
    v_mfma_f32_16x16x32_bf16 v[48:51], v[124:127], v[16:19], v[48:51]
    ds_read_b128 v[40:43], v2 offset:20992
    global_load_dwordx4 v[156:159], v47, s[48:49] sc1
    v_mfma_f32_16x16x32_bf16 v[52:55], v[204:207], v[16:19], v[52:55]
    s_add_u32 s48, s48, 4096
    s_addc_u32 s49, s49, 0
    global_load_dwordx4 v[236:239], v47, s[50:51] sc1
    s_waitcnt lgkmcnt(5)
    v_mfma_f32_16x16x32_bf16 v[56:59], v[124:127], v[20:23], v[56:59]
    s_add_u32 s50, s50, 4096
    s_addc_u32 s51, s51, 0
    v_mfma_f32_16x16x32_bf16 v[60:63], v[204:207], v[20:23], v[60:63]
    ds_read_b128 v[16:19], v2 offset:41472
    s_waitcnt lgkmcnt(5)
    v_mfma_f32_16x16x32_bf16 v[64:67], v[124:127], v[24:27], v[64:67]
    ds_read_b128 v[20:23], v2 offset:61952
    v_mfma_f32_16x16x32_bf16 v[68:71], v[204:207], v[24:27], v[68:71]
    s_waitcnt lgkmcnt(5)
    v_mfma_f32_16x16x32_bf16 v[72:75], v[124:127], v[28:31], v[72:75]
    v_add_u32 v6, 81920, v2
    v_mfma_f32_16x16x32_bf16 v[76:79], v[204:207], v[28:31], v[76:79]
    ds_read_b128 v[24:27], v6 offset:512
    s_waitcnt lgkmcnt(5)
    v_mfma_f32_16x16x32_bf16 v[80:83], v[124:127], v[32:35], v[80:83]
    ds_read_b128 v[28:31], v3 offset:512
    v_mfma_f32_16x16x32_bf16 v[84:87], v[204:207], v[32:35], v[84:87]
    s_waitcnt vmcnt(14) lgkmcnt(5)
    v_mfma_f32_16x16x32_bf16 v[48:51], v[128:131], v[36:39], v[48:51]
    ds_read_b128 v[32:35], v3 offset:20992
    s_barrier
    v_mfma_f32_16x16x32_bf16 v[52:55], v[208:211], v[36:39], v[52:55]
    global_load_dwordx4 v[160:163], v44, s[48:49] sc1
    global_load_dwordx4 v[240:243], v44, s[50:51] sc1
    s_waitcnt lgkmcnt(5)
    v_mfma_f32_16x16x32_bf16 v[56:59], v[128:131], v[40:43], v[56:59]
    ds_read_b128 v[36:39], v3 offset:41472
    v_mfma_f32_16x16x32_bf16 v[60:63], v[208:211], v[40:43], v[60:63]
    s_waitcnt lgkmcnt(5)
    v_mfma_f32_16x16x32_bf16 v[64:67], v[128:131], v[16:19], v[64:67]
    ds_read_b128 v[40:43], v3 offset:61952
    v_mfma_f32_16x16x32_bf16 v[68:71], v[208:211], v[16:19], v[68:71]
    s_waitcnt lgkmcnt(5)
    v_mfma_f32_16x16x32_bf16 v[72:75], v[128:131], v[20:23], v[72:75]
    v_add_u32 v6, 81920, v3
    v_mfma_f32_16x16x32_bf16 v[76:79], v[208:211], v[20:23], v[76:79]
    ds_read_b128 v[16:19], v6 offset:512
    s_waitcnt lgkmcnt(5)
    v_mfma_f32_16x16x32_bf16 v[80:83], v[128:131], v[24:27], v[80:83]
    ds_read_b128 v[20:23], v4 offset:512
    v_mfma_f32_16x16x32_bf16 v[84:87], v[208:211], v[24:27], v[84:87]
    s_waitcnt vmcnt(14) lgkmcnt(5)
    v_mfma_f32_16x16x32_bf16 v[48:51], v[132:135], v[28:31], v[48:51]
    ds_read_b128 v[24:27], v4 offset:20992
    global_load_dwordx4 v[164:167], v45, s[48:49] sc1
    v_mfma_f32_16x16x32_bf16 v[52:55], v[212:215], v[28:31], v[52:55]
    global_load_dwordx4 v[244:247], v45, s[50:51] sc1
    s_waitcnt lgkmcnt(5)
    v_mfma_f32_16x16x32_bf16 v[56:59], v[132:135], v[32:35], v[56:59]
    ds_read_b128 v[28:31], v4 offset:41472
    v_mfma_f32_16x16x32_bf16 v[60:63], v[212:215], v[32:35], v[60:63]
    s_waitcnt lgkmcnt(5)
    v_mfma_f32_16x16x32_bf16 v[64:67], v[132:135], v[36:39], v[64:67]
    ds_read_b128 v[32:35], v4 offset:61952
    v_mfma_f32_16x16x32_bf16 v[68:71], v[212:215], v[36:39], v[68:71]
    s_waitcnt lgkmcnt(5)
    v_mfma_f32_16x16x32_bf16 v[72:75], v[132:135], v[40:43], v[72:75]
    v_add_u32 v6, 81920, v4
    v_mfma_f32_16x16x32_bf16 v[76:79], v[212:215], v[40:43], v[76:79]
    ds_read_b128 v[36:39], v6 offset:512
    s_waitcnt lgkmcnt(5)
    v_mfma_f32_16x16x32_bf16 v[80:83], v[132:135], v[16:19], v[80:83]
    ds_read_b128 v[40:43], v5 offset:512
    v_mfma_f32_16x16x32_bf16 v[84:87], v[212:215], v[16:19], v[84:87]
    s_waitcnt vmcnt(14) lgkmcnt(5)
    v_mfma_f32_16x16x32_bf16 v[48:51], v[136:139], v[20:23], v[48:51]
    ds_read_b128 v[16:19], v5 offset:20992
    global_load_dwordx4 v[168:171], v46, s[48:49] sc1
    v_mfma_f32_16x16x32_bf16 v[52:55], v[216:219], v[20:23], v[52:55]
    global_load_dwordx4 v[248:251], v46, s[50:51] sc1
    s_waitcnt lgkmcnt(5)
    v_mfma_f32_16x16x32_bf16 v[56:59], v[136:139], v[24:27], v[56:59]
    ds_read_b128 v[20:23], v5 offset:41472
    v_mfma_f32_16x16x32_bf16 v[60:63], v[216:219], v[24:27], v[60:63]
    s_waitcnt lgkmcnt(5)
    v_mfma_f32_16x16x32_bf16 v[64:67], v[136:139], v[28:31], v[64:67]
    ds_read_b128 v[24:27], v5 offset:61952
    v_mfma_f32_16x16x32_bf16 v[68:71], v[216:219], v[28:31], v[68:71]
    s_waitcnt lgkmcnt(5)
    v_mfma_f32_16x16x32_bf16 v[72:75], v[136:139], v[32:35], v[72:75]
    v_add_u32 v6, 81920, v5
    v_mfma_f32_16x16x32_bf16 v[76:79], v[216:219], v[32:35], v[76:79]
    ds_read_b128 v[28:31], v6 offset:512
    s_waitcnt lgkmcnt(5)
    v_mfma_f32_16x16x32_bf16 v[80:83], v[136:139], v[36:39], v[80:83]
    ds_read_b128 v[32:35], v2 offset:768
    v_mfma_f32_16x16x32_bf16 v[84:87], v[216:219], v[36:39], v[84:87]
    s_waitcnt vmcnt(14) lgkmcnt(5)
    v_mfma_f32_16x16x32_bf16 v[48:51], v[140:143], v[40:43], v[48:51]
    ds_read_b128 v[36:39], v2 offset:21248
    s_barrier
    v_mfma_f32_16x16x32_bf16 v[52:55], v[220:223], v[40:43], v[52:55]
    global_load_dwordx4 v[172:175], v47, s[48:49] sc1
    global_load_dwordx4 v[252:255], v47, s[50:51] sc1
    s_waitcnt lgkmcnt(5)
    v_mfma_f32_16x16x32_bf16 v[56:59], v[140:143], v[16:19], v[56:59]
    ds_read_b128 v[40:43], v2 offset:41728
    v_mfma_f32_16x16x32_bf16 v[60:63], v[220:223], v[16:19], v[60:63]
    s_waitcnt lgkmcnt(5)
    v_mfma_f32_16x16x32_bf16 v[64:67], v[140:143], v[20:23], v[64:67]
    ds_read_b128 v[16:19], v2 offset:62208
    v_mfma_f32_16x16x32_bf16 v[68:71], v[220:223], v[20:23], v[68:71]
    s_waitcnt lgkmcnt(5)
    v_mfma_f32_16x16x32_bf16 v[72:75], v[140:143], v[24:27], v[72:75]
    v_add_u32 v6, 81920, v2
    v_mfma_f32_16x16x32_bf16 v[76:79], v[220:223], v[24:27], v[76:79]
    ds_read_b128 v[20:23], v6 offset:768
    s_waitcnt lgkmcnt(5)
    v_mfma_f32_16x16x32_bf16 v[80:83], v[140:143], v[28:31], v[80:83]
    ds_read_b128 v[24:27], v3 offset:768
    v_mfma_f32_16x16x32_bf16 v[84:87], v[220:223], v[28:31], v[84:87]
    s_waitcnt vmcnt(14) lgkmcnt(5)
    v_mfma_f32_16x16x32_bf16 v[48:51], v[144:147], v[32:35], v[48:51]
    ds_read_b128 v[28:31], v3 offset:21248
    s_mul_i32 s42, s4, 3840
    v_mfma_f32_16x16x32_bf16 v[52:55], v[224:227], v[32:35], v[52:55]
    s_add_u32 s42, s42, 233472
    v_lshl_add_u32 v44, v1, 7, s42
    s_waitcnt lgkmcnt(5)
    v_mfma_f32_16x16x32_bf16 v[56:59], v[144:147], v[36:39], v[56:59]
    s_lshr_b32 s42, s14, 1
    s_lshl_b32 s42, s42, 9
    v_mfma_f32_16x16x32_bf16 v[60:63], v[224:227], v[36:39], v[60:63]
    s_add_u32 s42, s42, 266240
    s_lshl_b32 s43, s36, 7
    s_waitcnt lgkmcnt(4)
    v_mfma_f32_16x16x32_bf16 v[64:67], v[144:147], v[40:43], v[64:67]
    v_and_b32 v45, s43, v44
    s_xor_b32 s43, s36, 1
    v_mfma_f32_16x16x32_bf16 v[68:71], v[224:227], v[40:43], v[68:71]
    s_lshl_b32 s43, s43, 8
    s_add_u32 s42, s42, s43
    s_waitcnt lgkmcnt(3)
    v_mfma_f32_16x16x32_bf16 v[72:75], v[144:147], v[16:19], v[72:75]
    v_add_u32 v45, s42, v45
    v_cmp_gt_u32 vcc, 20, v1
    v_mfma_f32_16x16x32_bf16 v[76:79], v[224:227], v[16:19], v[76:79]
    s_nop 1
    v_cndmask_b32 v44, v45, v44, vcc
    s_waitcnt lgkmcnt(2)
    v_mfma_f32_16x16x32_bf16 v[80:83], v[144:147], v[20:23], v[80:83]
    global_load_dwordx2 v[46:47], v44, s[32:33] sc1
    ds_read_b128 v[32:35], v3 offset:41728
    v_mfma_f32_16x16x32_bf16 v[84:87], v[224:227], v[20:23], v[84:87]
    ds_read_b128 v[36:39], v3 offset:62208
    v_add_u32 v6, 81920, v3
    s_waitcnt vmcnt(13) lgkmcnt(3)
    v_mfma_f32_16x16x32_bf16 v[48:51], v[148:151], v[24:27], v[48:51]
    ds_read_b128 v[40:43], v6 offset:768
    ds_read_b128 v[16:19], v4 offset:768
    v_mfma_f32_16x16x32_bf16 v[52:55], v[228:231], v[24:27], v[52:55]
    ds_read_b128 v[20:23], v4 offset:21248
    s_waitcnt lgkmcnt(5)
    v_mfma_f32_16x16x32_bf16 v[56:59], v[148:151], v[28:31], v[56:59]
    ds_read_b128 v[24:27], v4 offset:41728
    v_mfma_f32_16x16x32_bf16 v[60:63], v[228:231], v[28:31], v[60:63]
    s_waitcnt lgkmcnt(5)
    v_mfma_f32_16x16x32_bf16 v[64:67], v[148:151], v[32:35], v[64:67]
    ds_read_b128 v[28:31], v4 offset:62208
    v_mfma_f32_16x16x32_bf16 v[68:71], v[228:231], v[32:35], v[68:71]
    s_waitcnt lgkmcnt(5)
    v_mfma_f32_16x16x32_bf16 v[72:75], v[148:151], v[36:39], v[72:75]
    v_add_u32 v6, 81920, v4
    v_mfma_f32_16x16x32_bf16 v[76:79], v[228:231], v[36:39], v[76:79]
    ds_read_b128 v[32:35], v6 offset:768
    s_waitcnt lgkmcnt(5)
    v_mfma_f32_16x16x32_bf16 v[80:83], v[148:151], v[40:43], v[80:83]
    ds_read_b128 v[36:39], v5 offset:768
    v_mfma_f32_16x16x32_bf16 v[84:87], v[228:231], v[40:43], v[84:87]
    s_waitcnt vmcnt(11) lgkmcnt(5)
    v_mfma_f32_16x16x32_bf16 v[48:51], v[152:155], v[16:19], v[48:51]
    ds_read_b128 v[40:43], v5 offset:21248
    v_mfma_f32_16x16x32_bf16 v[52:55], v[232:235], v[16:19], v[52:55]
    s_waitcnt lgkmcnt(5)
    v_mfma_f32_16x16x32_bf16 v[56:59], v[152:155], v[20:23], v[56:59]
    ds_read_b128 v[16:19], v5 offset:41728
    v_mfma_f32_16x16x32_bf16 v[60:63], v[232:235], v[20:23], v[60:63]
    s_waitcnt lgkmcnt(5)
    v_mfma_f32_16x16x32_bf16 v[64:67], v[152:155], v[24:27], v[64:67]
    ds_read_b128 v[20:23], v5 offset:62208
    v_mfma_f32_16x16x32_bf16 v[68:71], v[232:235], v[24:27], v[68:71]
    s_waitcnt lgkmcnt(5)
    v_mfma_f32_16x16x32_bf16 v[72:75], v[152:155], v[28:31], v[72:75]
    v_add_u32 v6, 81920, v5
    v_mfma_f32_16x16x32_bf16 v[76:79], v[232:235], v[28:31], v[76:79]
    ds_read_b128 v[24:27], v6 offset:768
    s_waitcnt lgkmcnt(5)
    v_mfma_f32_16x16x32_bf16 v[80:83], v[152:155], v[32:35], v[80:83]
    ds_read_b128 v[28:31], v2 offset:1024
    v_mfma_f32_16x16x32_bf16 v[84:87], v[232:235], v[32:35], v[84:87]
    s_waitcnt vmcnt(9) lgkmcnt(5)
    v_mfma_f32_16x16x32_bf16 v[48:51], v[156:159], v[36:39], v[48:51]
    ds_read_b128 v[32:35], v2 offset:21504
    v_mfma_f32_16x16x32_bf16 v[52:55], v[236:239], v[36:39], v[52:55]
    s_waitcnt lgkmcnt(5)
    v_mfma_f32_16x16x32_bf16 v[56:59], v[156:159], v[40:43], v[56:59]
    ds_read_b128 v[36:39], v2 offset:41984
    v_mfma_f32_16x16x32_bf16 v[60:63], v[236:239], v[40:43], v[60:63]
    s_waitcnt lgkmcnt(5)
    v_mfma_f32_16x16x32_bf16 v[64:67], v[156:159], v[16:19], v[64:67]
    ds_read_b128 v[40:43], v2 offset:62464
    v_mfma_f32_16x16x32_bf16 v[68:71], v[236:239], v[16:19], v[68:71]
    s_waitcnt lgkmcnt(5)
    v_mfma_f32_16x16x32_bf16 v[72:75], v[156:159], v[20:23], v[72:75]
    v_add_u32 v6, 81920, v2
    v_mfma_f32_16x16x32_bf16 v[76:79], v[236:239], v[20:23], v[76:79]
    ds_read_b128 v[16:19], v6 offset:1024
    s_waitcnt lgkmcnt(5)
    v_mfma_f32_16x16x32_bf16 v[80:83], v[156:159], v[24:27], v[80:83]
    ds_read_b128 v[20:23], v3 offset:1024
    v_mfma_f32_16x16x32_bf16 v[84:87], v[236:239], v[24:27], v[84:87]
    s_waitcnt vmcnt(7) lgkmcnt(5)
    v_mfma_f32_16x16x32_bf16 v[48:51], v[160:163], v[28:31], v[48:51]
    ds_read_b128 v[24:27], v3 offset:21504
    v_mfma_f32_16x16x32_bf16 v[52:55], v[240:243], v[28:31], v[52:55]
    s_waitcnt lgkmcnt(5)
    v_mfma_f32_16x16x32_bf16 v[56:59], v[160:163], v[32:35], v[56:59]
    ds_read_b128 v[28:31], v3 offset:41984
    v_mfma_f32_16x16x32_bf16 v[60:63], v[240:243], v[32:35], v[60:63]
    s_waitcnt lgkmcnt(5)
    v_mfma_f32_16x16x32_bf16 v[64:67], v[160:163], v[36:39], v[64:67]
    ds_read_b128 v[32:35], v3 offset:62464
    v_mfma_f32_16x16x32_bf16 v[68:71], v[240:243], v[36:39], v[68:71]
    s_waitcnt lgkmcnt(5)
    v_mfma_f32_16x16x32_bf16 v[72:75], v[160:163], v[40:43], v[72:75]
    v_add_u32 v6, 81920, v3
    v_mfma_f32_16x16x32_bf16 v[76:79], v[240:243], v[40:43], v[76:79]
    ds_read_b128 v[36:39], v6 offset:1024
    s_waitcnt lgkmcnt(5)
    v_mfma_f32_16x16x32_bf16 v[80:83], v[160:163], v[16:19], v[80:83]
    ds_read_b128 v[40:43], v4 offset:1024
    v_mfma_f32_16x16x32_bf16 v[84:87], v[240:243], v[16:19], v[84:87]
    s_waitcnt vmcnt(5) lgkmcnt(5)
    v_mfma_f32_16x16x32_bf16 v[48:51], v[164:167], v[20:23], v[48:51]
    ds_read_b128 v[16:19], v4 offset:21504
    v_mfma_f32_16x16x32_bf16 v[52:55], v[244:247], v[20:23], v[52:55]
    s_waitcnt lgkmcnt(5)
    v_mfma_f32_16x16x32_bf16 v[56:59], v[164:167], v[24:27], v[56:59]
    ds_read_b128 v[20:23], v4 offset:41984
    v_mfma_f32_16x16x32_bf16 v[60:63], v[244:247], v[24:27], v[60:63]
    s_waitcnt lgkmcnt(5)
    v_mfma_f32_16x16x32_bf16 v[64:67], v[164:167], v[28:31], v[64:67]
    ds_read_b128 v[24:27], v4 offset:62464
    v_mfma_f32_16x16x32_bf16 v[68:71], v[244:247], v[28:31], v[68:71]
    s_waitcnt lgkmcnt(5)
    v_mfma_f32_16x16x32_bf16 v[72:75], v[164:167], v[32:35], v[72:75]
    v_add_u32 v6, 81920, v4
    v_mfma_f32_16x16x32_bf16 v[76:79], v[244:247], v[32:35], v[76:79]
    ds_read_b128 v[28:31], v6 offset:1024
    s_waitcnt lgkmcnt(5)
    v_mfma_f32_16x16x32_bf16 v[80:83], v[164:167], v[36:39], v[80:83]
    ds_read_b128 v[32:35], v5 offset:1024
    v_mfma_f32_16x16x32_bf16 v[84:87], v[244:247], v[36:39], v[84:87]
    s_waitcnt vmcnt(3) lgkmcnt(5)
    v_mfma_f32_16x16x32_bf16 v[48:51], v[168:171], v[40:43], v[48:51]
    ds_read_b128 v[36:39], v5 offset:21504
    v_mfma_f32_16x16x32_bf16 v[52:55], v[248:251], v[40:43], v[52:55]
    s_waitcnt lgkmcnt(5)
    v_mfma_f32_16x16x32_bf16 v[56:59], v[168:171], v[16:19], v[56:59]
    ds_read_b128 v[40:43], v5 offset:41984
    v_mfma_f32_16x16x32_bf16 v[60:63], v[248:251], v[16:19], v[60:63]
    s_waitcnt lgkmcnt(5)
    v_mfma_f32_16x16x32_bf16 v[64:67], v[168:171], v[20:23], v[64:67]
    ds_read_b128 v[16:19], v5 offset:62464
    v_mfma_f32_16x16x32_bf16 v[68:71], v[248:251], v[20:23], v[68:71]
    s_waitcnt lgkmcnt(5)
    v_mfma_f32_16x16x32_bf16 v[72:75], v[168:171], v[24:27], v[72:75]
    v_add_u32 v6, 81920, v5
    v_mfma_f32_16x16x32_bf16 v[76:79], v[248:251], v[24:27], v[76:79]
    ds_read_b128 v[20:23], v6 offset:1024
    s_waitcnt lgkmcnt(5)
    v_mfma_f32_16x16x32_bf16 v[80:83], v[168:171], v[28:31], v[80:83]
    v_mfma_f32_16x16x32_bf16 v[84:87], v[248:251], v[28:31], v[84:87]
    s_waitcnt vmcnt(1) lgkmcnt(4)
    v_mfma_f32_16x16x32_bf16 v[48:51], v[172:175], v[32:35], v[48:51]
    v_mfma_f32_16x16x32_bf16 v[52:55], v[252:255], v[32:35], v[52:55]
    s_waitcnt lgkmcnt(3)
    v_mfma_f32_16x16x32_bf16 v[56:59], v[172:175], v[36:39], v[56:59]
    v_mfma_f32_16x16x32_bf16 v[60:63], v[252:255], v[36:39], v[60:63]
    s_waitcnt lgkmcnt(2)
    v_mfma_f32_16x16x32_bf16 v[64:67], v[172:175], v[40:43], v[64:67]
    v_mfma_f32_16x16x32_bf16 v[68:71], v[252:255], v[40:43], v[68:71]
    s_waitcnt lgkmcnt(1)
    v_mfma_f32_16x16x32_bf16 v[72:75], v[172:175], v[16:19], v[72:75]
    v_mfma_f32_16x16x32_bf16 v[76:79], v[252:255], v[16:19], v[76:79]
    s_waitcnt lgkmcnt(0)
    v_mfma_f32_16x16x32_bf16 v[80:83], v[172:175], v[20:23], v[80:83]
    v_mfma_f32_16x16x32_bf16 v[84:87], v[252:255], v[20:23], v[84:87]
    s_mov_b32 s57, 0
    s_nop 5
    s_branch L_poll6_c
L_poll6:
    global_load_dwordx2 v[46:47], v44, s[32:33] sc1
L_poll6_c:
    s_add_u32 s57, s57, 1
    s_waitcnt vmcnt(0)
    v_cmp_ne_u64 vcc, s[34:35], v[46:47]
    s_cmp_gt_u32 s57, 200000
    s_nop 2
    s_cbranch_scc1 L_end
    s_cbranch_vccnz L_poll6
    s_sub_u32 s42, s3, 4
    s_cmp_le_u32 s42, s36
    s_cbranch_scc0 L_px5
    s_cmp_eq_u32 s36, 0
    s_cselect_b32 s42, 2, s42
    s_lshr_b32 s46, s14, 1
    s_mul_i32 s46, s46, 3
    s_add_u32 s46, s46, s42
    s_mul_i32 s46, s46, 3072
    s_add_u32 s46, s46, 15728640
    v_lshl_add_u32 v44, v1, 4, s46
    s_mul_i32 s42, s42, 4608
    s_add_u32 m0, s42, 27648
    v_mov_b32 v45, 0
    global_load_lds_dwordx4 v44, s[32:33] sc1
    global_load_lds_dwordx4 v44, s[32:33] offset:1024 sc1
    global_load_lds_dwordx4 v44, s[32:33] offset:2048 sc1
    ds_write_addtid_b32 v45 offset:3072
L_px5:
    ds_read_b64_tr_b16 v[10:11], v7
    ds_read_b64_tr_b16 v[12:13], v8
    ds_read_b64_tr_b16 v[14:15], v9
    v_and_b32 v16, 15, v1
    v_lshrrev_b32 v17, 4, v1
    s_lshl_b32 s42, s3, 7
    s_add_u32 s42, s42, 46016
    v_lshl_add_u32 v19, v17, 4, s42
    s_mov_b64 exec, 0x10001
    s_mov_b32 exec_hi, 0x10001
    ds_write_b128 v19, v[48:51] offset:0
    ds_write_b128 v19, v[52:55] offset:64
    s_mov_b64 exec, -1
    s_lshl_b32 s42, s3, 6
    s_cmp_eq_u32 s3, 2
    s_cselect_b32 s42, 192, s42
    s_cmp_eq_u32 s3, 3
    s_cselect_b32 s42, 128, s42
    s_add_u32 s42, s42, 61440
    v_mul_u32_u24 v20, 496, v16
    v_lshl_add_u32 v20, v17, 4, v20
    v_add_u32 v20, s42, v20
    v_lshlrev_b32 v18, 3, v16
    v_add_u32 v18, 45376, v18
    s_waitcnt lgkmcnt(0)
    s_barrier
    ds_read_b64 v[24:25], v18 offset:0
    ds_read_b64 v[26:27], v18 offset:128
    ds_read_b64 v[28:29], v18 offset:256
    ds_read_b64 v[30:31], v18 offset:384
    ds_read_b64 v[32:33], v18 offset:512
    ds_read_b128 v[36:39], v19 offset:0
    ds_read_b128 v[40:43], v19 offset:64
    s_waitcnt lgkmcnt(0)
    v_fma_f32 v48, -v24, v36, v48
    v_fma_f32 v49, -v24, v37, v49
    v_fma_f32 v50, -v24, v38, v50
    v_fma_f32 v51, -v24, v39, v51
    v_fma_f32 v52, -v24, v40, v52
    v_fma_f32 v53, -v24, v41, v53
    v_fma_f32 v54, -v24, v42, v54
    v_fma_f32 v55, -v24, v43, v55
    v_fma_f32 v56, -v26, v36, v56
    v_fma_f32 v57, -v26, v37, v57
    v_fma_f32 v58, -v26, v38, v58
    v_fma_f32 v59, -v26, v39, v59
    v_fma_f32 v60, -v26, v40, v60
    v_fma_f32 v61, -v26, v41, v61
    v_fma_f32 v62, -v26, v42, v62
    v_fma_f32 v63, -v26, v43, v63
    v_fma_f32 v64, -v28, v36, v64
    v_fma_f32 v65, -v28, v37, v65
    v_fma_f32 v66, -v28, v38, v66
    v_fma_f32 v67, -v28, v39, v67
    v_fma_f32 v68, -v28, v40, v68
    v_fma_f32 v69, -v28, v41, v69
    v_fma_f32 v70, -v28, v42, v70
    v_fma_f32 v71, -v28, v43, v71
    v_fma_f32 v72, -v30, v36, v72
    v_fma_f32 v73, -v30, v37, v73
    v_fma_f32 v74, -v30, v38, v74
    v_fma_f32 v75, -v30, v39, v75
    v_fma_f32 v76, -v30, v40, v76
    v_fma_f32 v77, -v30, v41, v77
    v_fma_f32 v78, -v30, v42, v78
    v_fma_f32 v79, -v30, v43, v79
    v_fma_f32 v80, -v32, v36, v80
    v_fma_f32 v81, -v32, v37, v81
    v_fma_f32 v82, -v32, v38, v82
    v_fma_f32 v83, -v32, v39, v83
    v_fma_f32 v84, -v32, v40, v84
    v_fma_f32 v85, -v32, v41, v85
    v_fma_f32 v86, -v32, v42, v86
    v_fma_f32 v87, -v32, v43, v87
    v_mul_f32 v48, v48, v25
    v_mul_f32 v49, v49, v25
    v_mul_f32 v50, v50, v25
    v_mul_f32 v51, v51, v25
    v_mul_f32 v52, v52, v25
    v_mul_f32 v53, v53, v25
    v_mul_f32 v54, v54, v25
    v_mul_f32 v55, v55, v25
    v_mul_f32 v56, v56, v27
    v_mul_f32 v57, v57, v27
    v_mul_f32 v58, v58, v27
    v_mul_f32 v59, v59, v27
    v_mul_f32 v60, v60, v27
    v_mul_f32 v61, v61, v27
    v_mul_f32 v62, v62, v27
    v_mul_f32 v63, v63, v27
    v_mul_f32 v64, v64, v29
    v_mul_f32 v65, v65, v29
    v_mul_f32 v66, v66, v29
    v_mul_f32 v67, v67, v29
    v_mul_f32 v68, v68, v29
    v_mul_f32 v69, v69, v29
    v_mul_f32 v70, v70, v29
    v_mul_f32 v71, v71, v29
    v_mul_f32 v72, v72, v31
    v_mul_f32 v73, v73, v31
    v_mul_f32 v74, v74, v31
    v_mul_f32 v75, v75, v31
    v_mul_f32 v76, v76, v31
    v_mul_f32 v77, v77, v31
    v_mul_f32 v78, v78, v31
    v_mul_f32 v79, v79, v31
    v_mul_f32 v80, v80, v33
    v_mul_f32 v81, v81, v33
    v_mul_f32 v82, v82, v33
    v_mul_f32 v83, v83, v33
    v_mul_f32 v84, v84, v33
    v_mul_f32 v85, v85, v33
    v_mul_f32 v86, v86, v33
    v_mul_f32 v87, v87, v33
    v_cvt_pk_bf16_f32 v48, v48, v52
    v_cvt_pk_bf16_f32 v49, v49, v53
    v_cvt_pk_bf16_f32 v50, v50, v54
    v_cvt_pk_bf16_f32 v51, v51, v55
    ds_write_b128 v20, v[48:51] offset:0
    v_cvt_pk_bf16_f32 v56, v56, v60
    v_cvt_pk_bf16_f32 v57, v57, v61
    v_cvt_pk_bf16_f32 v58, v58, v62
    v_cvt_pk_bf16_f32 v59, v59, v63
    ds_write_b128 v20, v[56:59] offset:7936
    v_cvt_pk_bf16_f32 v64, v64, v68
    v_cvt_pk_bf16_f32 v65, v65, v69
    v_cvt_pk_bf16_f32 v66, v66, v70
    v_cvt_pk_bf16_f32 v67, v67, v71
    ds_write_b128 v20, v[64:67] offset:15872
    v_cvt_pk_bf16_f32 v72, v72, v76
    v_cvt_pk_bf16_f32 v73, v73, v77
    v_cvt_pk_bf16_f32 v74, v74, v78
    v_cvt_pk_bf16_f32 v75, v75, v79
    ds_write_b128 v20, v[72:75] offset:23808
    v_cvt_pk_bf16_f32 v80, v80, v84
    v_cvt_pk_bf16_f32 v81, v81, v85
    v_cvt_pk_bf16_f32 v82, v82, v86
    v_cvt_pk_bf16_f32 v83, v83, v87
    ds_write_b128 v20, v[80:83] offset:31744
    s_branch L_a1_post
L_g1A:
    global_load_dwordx4 v[96:99], v44, s[48:49] sc1
    global_load_dwordx4 v[176:179], v44, s[50:51] sc1
    global_load_dwordx4 v[100:103], v45, s[48:49] sc1
    global_load_dwordx4 v[180:183], v45, s[50:51] sc1
    global_load_dwordx4 v[104:107], v46, s[48:49] sc1
    global_load_dwordx4 v[184:187], v46, s[50:51] sc1
    s_barrier
    global_load_dwordx4 v[108:111], v47, s[48:49] sc1
    s_add_u32 s48, s48, 4096
    s_addc_u32 s49, s49, 0
    global_load_dwordx4 v[188:191], v47, s[50:51] sc1
    s_add_u32 s50, s50, 4096
    s_addc_u32 s51, s51, 0
    global_load_dwordx4 v[112:115], v44, s[48:49] sc1
    global_load_dwordx4 v[192:195], v44, s[50:51] sc1
    global_load_dwordx4 v[116:119], v45, s[48:49] sc1
    global_load_dwordx4 v[196:199], v45, s[50:51] sc1
    s_barrier
    global_load_dwordx4 v[120:123], v46, s[48:49] sc1
    global_load_dwordx4 v[200:203], v46, s[50:51] sc1
    global_load_dwordx4 v[124:127], v47, s[48:49] sc1
    s_add_u32 s48, s48, 4096
    s_addc_u32 s49, s49, 0
    global_load_dwordx4 v[204:207], v47, s[50:51] sc1
    s_add_u32 s50, s50, 4096
    s_addc_u32 s51, s51, 0
    ds_read_b128 v[16:19], v2 offset:0
    ds_read_b128 v[20:23], v2 offset:20480
    ds_read_b128 v[24:27], v2 offset:40960
    ds_read_b128 v[28:31], v2 offset:61440
    v_add_u32 v6, 81920, v2
    ds_read_b128 v[32:35], v6 offset:0
    ds_read_b128 v[36:39], v3 offset:0
    s_waitcnt vmcnt(14) lgkmcnt(5)
    v_mfma_f32_16x16x32_bf16 v[48:51], v[96:99], v[16:19], 0
    ds_read_b128 v[40:43], v3 offset:20480
    global_load_dwordx4 v[128:131], v44, s[48:49] sc1
    v_mfma_f32_16x16x32_bf16 v[52:55], v[176:179], v[16:19], 0
    global_load_dwordx4 v[208:211], v44, s[50:51] sc1
    s_waitcnt lgkmcnt(5)
    v_mfma_f32_16x16x32_bf16 v[56:59], v[96:99], v[20:23], 0
    ds_read_b128 v[16:19], v3 offset:40960
    v_mfma_f32_16x16x32_bf16 v[60:63], v[176:179], v[20:23], 0
    s_waitcnt lgkmcnt(5)
    v_mfma_f32_16x16x32_bf16 v[64:67], v[96:99], v[24:27], 0
    ds_read_b128 v[20:23], v3 offset:61440
    v_mfma_f32_16x16x32_bf16 v[68:71], v[176:179], v[24:27], 0
    s_waitcnt lgkmcnt(5)
    v_mfma_f32_16x16x32_bf16 v[72:75], v[96:99], v[28:31], 0
    v_add_u32 v6, 81920, v3
    v_mfma_f32_16x16x32_bf16 v[76:79], v[176:179], v[28:31], 0
    ds_read_b128 v[24:27], v6 offset:0
    s_waitcnt lgkmcnt(5)
    v_mfma_f32_16x16x32_bf16 v[80:83], v[96:99], v[32:35], 0
    ds_read_b128 v[28:31], v4 offset:0
    v_mfma_f32_16x16x32_bf16 v[84:87], v[176:179], v[32:35], 0
    s_waitcnt vmcnt(14) lgkmcnt(5)
    v_mfma_f32_16x16x32_bf16 v[48:51], v[100:103], v[36:39], v[48:51]
    ds_read_b128 v[32:35], v4 offset:20480
    global_load_dwordx4 v[132:135], v45, s[48:49] sc1
    v_mfma_f32_16x16x32_bf16 v[52:55], v[180:183], v[36:39], v[52:55]
    global_load_dwordx4 v[212:215], v45, s[50:51] sc1
    s_waitcnt lgkmcnt(5)
    v_mfma_f32_16x16x32_bf16 v[56:59], v[100:103], v[40:43], v[56:59]
    ds_read_b128 v[36:39], v4 offset:40960
    v_mfma_f32_16x16x32_bf16 v[60:63], v[180:183], v[40:43], v[60:63]
    s_waitcnt lgkmcnt(5)
    v_mfma_f32_16x16x32_bf16 v[64:67], v[100:103], v[16:19], v[64:67]
    ds_read_b128 v[40:43], v4 offset:61440
    v_mfma_f32_16x16x32_bf16 v[68:71], v[180:183], v[16:19], v[68:71]
    s_waitcnt lgkmcnt(5)
    v_mfma_f32_16x16x32_bf16 v[72:75], v[100:103], v[20:23], v[72:75]
    v_add_u32 v6, 81920, v4
    v_mfma_f32_16x16x32_bf16 v[76:79], v[180:183], v[20:23], v[76:79]
    ds_read_b128 v[16:19], v6 offset:0
    s_waitcnt lgkmcnt(5)
    v_mfma_f32_16x16x32_bf16 v[80:83], v[100:103], v[24:27], v[80:83]
    ds_read_b128 v[20:23], v5 offset:0
    v_mfma_f32_16x16x32_bf16 v[84:87], v[180:183], v[24:27], v[84:87]
    s_waitcnt vmcnt(14) lgkmcnt(5)
    v_mfma_f32_16x16x32_bf16 v[48:51], v[104:107], v[28:31], v[48:51]
    ds_read_b128 v[24:27], v5 offset:20480
    s_barrier
    v_mfma_f32_16x16x32_bf16 v[52:55], v[184:187], v[28:31], v[52:55]
    global_load_dwordx4 v[136:139], v46, s[48:49] sc1
    global_load_dwordx4 v[216:219], v46, s[50:51] sc1
    s_waitcnt lgkmcnt(5)
    v_mfma_f32_16x16x32_bf16 v[56:59], v[104:107], v[32:35], v[56:59]
    ds_read_b128 v[28:31], v5 offset:40960
    v_mfma_f32_16x16x32_bf16 v[60:63], v[184:187], v[32:35], v[60:63]
    s_waitcnt lgkmcnt(5)
    v_mfma_f32_16x16x32_bf16 v[64:67], v[104:107], v[36:39], v[64:67]
    ds_read_b128 v[32:35], v5 offset:61440
    v_mfma_f32_16x16x32_bf16 v[68:71], v[184:187], v[36:39], v[68:71]
    s_waitcnt lgkmcnt(5)
    v_mfma_f32_16x16x32_bf16 v[72:75], v[104:107], v[40:43], v[72:75]
    v_add_u32 v6, 81920, v5
    v_mfma_f32_16x16x32_bf16 v[76:79], v[184:187], v[40:43], v[76:79]
    ds_read_b128 v[36:39], v6 offset:0
    s_waitcnt lgkmcnt(5)
    v_mfma_f32_16x16x32_bf16 v[80:83], v[104:107], v[16:19], v[80:83]
    ds_read_b128 v[40:43], v2 offset:256
    v_mfma_f32_16x16x32_bf16 v[84:87], v[184:187], v[16:19], v[84:87]
    s_waitcnt vmcnt(14) lgkmcnt(5)
    v_mfma_f32_16x16x32_bf16 v[48:51], v[108:111], v[20:23], v[48:51]
    ds_read_b128 v[16:19], v2 offset:20736
    global_load_dwordx4 v[140:143], v47, s[48:49] sc1
    v_mfma_f32_16x16x32_bf16 v[52:55], v[188:191], v[20:23], v[52:55]
    s_add_u32 s48, s48, 4096
    s_addc_u32 s49, s49, 0
    global_load_dwordx4 v[220:223], v47, s[50:51] sc1
    s_waitcnt lgkmcnt(5)
    v_mfma_f32_16x16x32_bf16 v[56:59], v[108:111], v[24:27], v[56:59]
    s_add_u32 s50, s50, 4096
    s_addc_u32 s51, s51, 0
    v_mfma_f32_16x16x32_bf16 v[60:63], v[188:191], v[24:27], v[60:63]
    ds_read_b128 v[20:23], v2 offset:41216
    s_waitcnt lgkmcnt(5)
    v_mfma_f32_16x16x32_bf16 v[64:67], v[108:111], v[28:31], v[64:67]
    ds_read_b128 v[24:27], v2 offset:61696
    v_mfma_f32_16x16x32_bf16 v[68:71], v[188:191], v[28:31], v[68:71]
    s_waitcnt lgkmcnt(5)
    v_mfma_f32_16x16x32_bf16 v[72:75], v[108:111], v[32:35], v[72:75]
    v_add_u32 v6, 81920, v2
    v_mfma_f32_16x16x32_bf16 v[76:79], v[188:191], v[32:35], v[76:79]
    ds_read_b128 v[28:31], v6 offset:256
    s_waitcnt lgkmcnt(5)
    v_mfma_f32_16x16x32_bf16 v[80:83], v[108:111], v[36:39], v[80:83]
    ds_read_b128 v[32:35], v3 offset:256
    v_mfma_f32_16x16x32_bf16 v[84:87], v[188:191], v[36:39], v[84:87]
    s_waitcnt vmcnt(14) lgkmcnt(5)
    v_mfma_f32_16x16x32_bf16 v[48:51], v[112:115], v[40:43], v[48:51]
    ds_read_b128 v[36:39], v3 offset:20736
    global_load_dwordx4 v[144:147], v44, s[48:49] sc1
    v_mfma_f32_16x16x32_bf16 v[52:55], v[192:195], v[40:43], v[52:55]
    global_load_dwordx4 v[224:227], v44, s[50:51] sc1
    s_waitcnt lgkmcnt(5)
    v_mfma_f32_16x16x32_bf16 v[56:59], v[112:115], v[16:19], v[56:59]
    ds_read_b128 v[40:43], v3 offset:41216
    v_mfma_f32_16x16x32_bf16 v[60:63], v[192:195], v[16:19], v[60:63]
    s_waitcnt lgkmcnt(5)
    v_mfma_f32_16x16x32_bf16 v[64:67], v[112:115], v[20:23], v[64:67]
    ds_read_b128 v[16:19], v3 offset:61696
    v_mfma_f32_16x16x32_bf16 v[68:71], v[192:195], v[20:23], v[68:71]
    s_waitcnt lgkmcnt(5)
    v_mfma_f32_16x16x32_bf16 v[72:75], v[112:115], v[24:27], v[72:75]
    v_add_u32 v6, 81920, v3
    v_mfma_f32_16x16x32_bf16 v[76:79], v[192:195], v[24:27], v[76:79]
    ds_read_b128 v[20:23], v6 offset:256
    s_waitcnt lgkmcnt(5)
    v_mfma_f32_16x16x32_bf16 v[80:83], v[112:115], v[28:31], v[80:83]
    ds_read_b128 v[24:27], v4 offset:256
    v_mfma_f32_16x16x32_bf16 v[84:87], v[192:195], v[28:31], v[84:87]
    s_waitcnt vmcnt(14) lgkmcnt(5)
    v_mfma_f32_16x16x32_bf16 v[48:51], v[116:119], v[32:35], v[48:51]
    ds_read_b128 v[28:31], v4 offset:20736
    s_barrier
    v_mfma_f32_16x16x32_bf16 v[52:55], v[196:199], v[32:35], v[52:55]
    global_load_dwordx4 v[148:151], v45, s[48:49] sc1
    global_load_dwordx4 v[228:231], v45, s[50:51] sc1
    s_waitcnt lgkmcnt(5)
    v_mfma_f32_16x16x32_bf16 v[56:59], v[116:119], v[36:39], v[56:59]
    ds_read_b128 v[32:35], v4 offset:41216
    v_mfma_f32_16x16x32_bf16 v[60:63], v[196:199], v[36:39], v[60:63]
    s_waitcnt lgkmcnt(5)
    v_mfma_f32_16x16x32_bf16 v[64:67], v[116:119], v[40:43], v[64:67]
    ds_read_b128 v[36:39], v4 offset:61696
    v_mfma_f32_16x16x32_bf16 v[68:71], v[196:199], v[40:43], v[68:71]
    s_waitcnt lgkmcnt(5)
    v_mfma_f32_16x16x32_bf16 v[72:75], v[116:119], v[16:19], v[72:75]
    v_add_u32 v6, 81920, v4
    v_mfma_f32_16x16x32_bf16 v[76:79], v[196:199], v[16:19], v[76:79]
    ds_read_b128 v[40:43], v6 offset:256
    s_waitcnt lgkmcnt(5)
    v_mfma_f32_16x16x32_bf16 v[80:83], v[116:119], v[20:23], v[80:83]
    ds_read_b128 v[16:19], v5 offset:256
    v_mfma_f32_16x16x32_bf16 v[84:87], v[196:199], v[20:23], v[84:87]
    s_waitcnt vmcnt(14) lgkmcnt(5)
    v_mfma_f32_16x16x32_bf16 v[48:51], v[120:123], v[24:27], v[48:51]
    ds_read_b128 v[20:23], v5 offset:20736
    global_load_dwordx4 v[152:155], v46, s[48:49] sc1
    v_mfma_f32_16x16x32_bf16 v[52:55], v[200:203], v[24:27], v[52:55]
    global_load_dwordx4 v[232:235], v46, s[50:51] sc1
    s_waitcnt lgkmcnt(5)
    v_mfma_f32_16x16x32_bf16 v[56:59], v[120:123], v[28:31], v[56:59]
    ds_read_b128 v[24:27], v5 offset:41216
    v_mfma_f32_16x16x32_bf16 v[60:63], v[200:203], v[28:31], v[60:63]
    s_waitcnt lgkmcnt(5)
    v_mfma_f32_16x16x32_bf16 v[64:67], v[120:123], v[32:35], v[64:67]
    ds_read_b128 v[28:31], v5 offset:61696
    v_mfma_f32_16x16x32_bf16 v[68:71], v[200:203], v[32:35], v[68:71]
    s_waitcnt lgkmcnt(5)
    v_mfma_f32_16x16x32_bf16 v[72:75], v[120:123], v[36:39], v[72:75]
    v_add_u32 v6, 81920, v5
    v_mfma_f32_16x16x32_bf16 v[76:79], v[200:203], v[36:39], v[76:79]
    ds_read_b128 v[32:35], v6 offset:256
    s_waitcnt lgkmcnt(5)
    v_mfma_f32_16x16x32_bf16 v[80:83], v[120:123], v[40:43], v[80:83]
    ds_read_b128 v[36:39], v2 offset:512
    v_mfma_f32_16x16x32_bf16 v[84:87], v[200:203], v[40:43], v[84:87]
    s_waitcnt vmcnt(14) lgkmcnt(5)
    v_mfma_f32_16x16x32_bf16 v[48:51], v[124:127], v[16:19], v[48:51]
    ds_read_b128 v[40:43], v2 offset:20992
    global_load_dwordx4 v[156:159], v47, s[48:49] sc1
    v_mfma_f32_16x16x32_bf16 v[52:55], v[204:207], v[16:19], v[52:55]
    s_add_u32 s48, s48, 4096
    s_addc_u32 s49, s49, 0
    global_load_dwordx4 v[236:239], v47, s[50:51] sc1
    s_waitcnt lgkmcnt(5)
    v_mfma_f32_16x16x32_bf16 v[56:59], v[124:127], v[20:23], v[56:59]
    s_add_u32 s50, s50, 4096
    s_addc_u32 s51, s51, 0
    v_mfma_f32_16x16x32_bf16 v[60:63], v[204:207], v[20:23], v[60:63]
    ds_read_b128 v[16:19], v2 offset:41472
    s_waitcnt lgkmcnt(5)
    v_mfma_f32_16x16x32_bf16 v[64:67], v[124:127], v[24:27], v[64:67]
    ds_read_b128 v[20:23], v2 offset:61952
    v_mfma_f32_16x16x32_bf16 v[68:71], v[204:207], v[24:27], v[68:71]
    s_waitcnt lgkmcnt(5)
    v_mfma_f32_16x16x32_bf16 v[72:75], v[124:127], v[28:31], v[72:75]
    v_add_u32 v6, 81920, v2
    v_mfma_f32_16x16x32_bf16 v[76:79], v[204:207], v[28:31], v[76:79]
    ds_read_b128 v[24:27], v6 offset:512
    s_waitcnt lgkmcnt(5)
    v_mfma_f32_16x16x32_bf16 v[80:83], v[124:127], v[32:35], v[80:83]
    ds_read_b128 v[28:31], v3 offset:512
    v_mfma_f32_16x16x32_bf16 v[84:87], v[204:207], v[32:35], v[84:87]
    s_waitcnt vmcnt(14) lgkmcnt(5)
    v_mfma_f32_16x16x32_bf16 v[48:51], v[128:131], v[36:39], v[48:51]
    ds_read_b128 v[32:35], v3 offset:20992
    s_barrier
    v_mfma_f32_16x16x32_bf16 v[52:55], v[208:211], v[36:39], v[52:55]
    global_load_dwordx4 v[160:163], v44, s[48:49] sc1
    global_load_dwordx4 v[240:243], v44, s[50:51] sc1
    s_waitcnt lgkmcnt(5)
    v_mfma_f32_16x16x32_bf16 v[56:59], v[128:131], v[40:43], v[56:59]
    ds_read_b128 v[36:39], v3 offset:41472
    v_mfma_f32_16x16x32_bf16 v[60:63], v[208:211], v[40:43], v[60:63]
    s_waitcnt lgkmcnt(5)
    v_mfma_f32_16x16x32_bf16 v[64:67], v[128:131], v[16:19], v[64:67]
    ds_read_b128 v[40:43], v3 offset:61952
    v_mfma_f32_16x16x32_bf16 v[68:71], v[208:211], v[16:19], v[68:71]
    s_waitcnt lgkmcnt(5)
    v_mfma_f32_16x16x32_bf16 v[72:75], v[128:131], v[20:23], v[72:75]
    v_add_u32 v6, 81920, v3
    v_mfma_f32_16x16x32_bf16 v[76:79], v[208:211], v[20:23], v[76:79]
    ds_read_b128 v[16:19], v6 offset:512
    s_waitcnt lgkmcnt(5)
    v_mfma_f32_16x16x32_bf16 v[80:83], v[128:131], v[24:27], v[80:83]
    ds_read_b128 v[20:23], v4 offset:512
    v_mfma_f32_16x16x32_bf16 v[84:87], v[208:211], v[24:27], v[84:87]
    s_waitcnt vmcnt(14) lgkmcnt(5)
    v_mfma_f32_16x16x32_bf16 v[48:51], v[132:135], v[28:31], v[48:51]
    ds_read_b128 v[24:27], v4 offset:20992
    global_load_dwordx4 v[164:167], v45, s[48:49] sc1
    v_mfma_f32_16x16x32_bf16 v[52:55], v[212:215], v[28:31], v[52:55]
    global_load_dwordx4 v[244:247], v45, s[50:51] sc1
    s_waitcnt lgkmcnt(5)
    v_mfma_f32_16x16x32_bf16 v[56:59], v[132:135], v[32:35], v[56:59]
    ds_read_b128 v[28:31], v4 offset:41472
    v_mfma_f32_16x16x32_bf16 v[60:63], v[212:215], v[32:35], v[60:63]
    s_waitcnt lgkmcnt(5)
    v_mfma_f32_16x16x32_bf16 v[64:67], v[132:135], v[36:39], v[64:67]
    ds_read_b128 v[32:35], v4 offset:61952
    v_mfma_f32_16x16x32_bf16 v[68:71], v[212:215], v[36:39], v[68:71]
    s_waitcnt lgkmcnt(5)
    v_mfma_f32_16x16x32_bf16 v[72:75], v[132:135], v[40:43], v[72:75]
    v_add_u32 v6, 81920, v4
    v_mfma_f32_16x16x32_bf16 v[76:79], v[212:215], v[40:43], v[76:79]
    ds_read_b128 v[36:39], v6 offset:512
    s_waitcnt lgkmcnt(5)
    v_mfma_f32_16x16x32_bf16 v[80:83], v[132:135], v[16:19], v[80:83]
    ds_read_b128 v[40:43], v5 offset:512
    v_mfma_f32_16x16x32_bf16 v[84:87], v[212:215], v[16:19], v[84:87]
    s_waitcnt vmcnt(14) lgkmcnt(5)
    v_mfma_f32_16x16x32_bf16 v[48:51], v[136:139], v[20:23], v[48:51]
    ds_read_b128 v[16:19], v5 offset:20992
    global_load_dwordx4 v[168:171], v46, s[48:49] sc1
    v_mfma_f32_16x16x32_bf16 v[52:55], v[216:219], v[20:23], v[52:55]
    global_load_dwordx4 v[248:251], v46, s[50:51] sc1
    s_waitcnt lgkmcnt(5)
    v_mfma_f32_16x16x32_bf16 v[56:59], v[136:139], v[24:27], v[56:59]
    ds_read_b128 v[20:23], v5 offset:41472
    v_mfma_f32_16x16x32_bf16 v[60:63], v[216:219], v[24:27], v[60:63]
    s_waitcnt lgkmcnt(5)
    v_mfma_f32_16x16x32_bf16 v[64:67], v[136:139], v[28:31], v[64:67]
    ds_read_b128 v[24:27], v5 offset:61952
    v_mfma_f32_16x16x32_bf16 v[68:71], v[216:219], v[28:31], v[68:71]
    s_waitcnt lgkmcnt(5)
    v_mfma_f32_16x16x32_bf16 v[72:75], v[136:139], v[32:35], v[72:75]
    v_add_u32 v6, 81920, v5
    v_mfma_f32_16x16x32_bf16 v[76:79], v[216:219], v[32:35], v[76:79]
    ds_read_b128 v[28:31], v6 offset:512
    s_waitcnt lgkmcnt(5)
    v_mfma_f32_16x16x32_bf16 v[80:83], v[136:139], v[36:39], v[80:83]
    ds_read_b128 v[32:35], v2 offset:768
    v_mfma_f32_16x16x32_bf16 v[84:87], v[216:219], v[36:39], v[84:87]
    s_waitcnt vmcnt(14) lgkmcnt(5)
    v_mfma_f32_16x16x32_bf16 v[48:51], v[140:143], v[40:43], v[48:51]
    ds_read_b128 v[36:39], v2 offset:21248
    s_barrier
    v_mfma_f32_16x16x32_bf16 v[52:55], v[220:223], v[40:43], v[52:55]
    global_load_dwordx4 v[172:175], v47, s[48:49] sc1
    global_load_dwordx4 v[252:255], v47, s[50:51] sc1
    s_waitcnt lgkmcnt(5)
    v_mfma_f32_16x16x32_bf16 v[56:59], v[140:143], v[16:19], v[56:59]
    ds_read_b128 v[40:43], v2 offset:41728
    v_mfma_f32_16x16x32_bf16 v[60:63], v[220:223], v[16:19], v[60:63]
    s_waitcnt lgkmcnt(5)
    v_mfma_f32_16x16x32_bf16 v[64:67], v[140:143], v[20:23], v[64:67]
    ds_read_b128 v[16:19], v2 offset:62208
    v_mfma_f32_16x16x32_bf16 v[68:71], v[220:223], v[20:23], v[68:71]
    s_waitcnt lgkmcnt(5)
    v_mfma_f32_16x16x32_bf16 v[72:75], v[140:143], v[24:27], v[72:75]
    v_add_u32 v6, 81920, v2
    v_mfma_f32_16x16x32_bf16 v[76:79], v[220:223], v[24:27], v[76:79]
    ds_read_b128 v[20:23], v6 offset:768
    s_waitcnt lgkmcnt(5)
    v_mfma_f32_16x16x32_bf16 v[80:83], v[140:143], v[28:31], v[80:83]
    ds_read_b128 v[24:27], v3 offset:768
    v_mfma_f32_16x16x32_bf16 v[84:87], v[220:223], v[28:31], v[84:87]
    s_waitcnt vmcnt(14) lgkmcnt(5)
    v_mfma_f32_16x16x32_bf16 v[48:51], v[144:147], v[32:35], v[48:51]
    ds_read_b128 v[28:31], v3 offset:21248
    v_mfma_f32_16x16x32_bf16 v[52:55], v[224:227], v[32:35], v[52:55]
    s_waitcnt lgkmcnt(5)
    v_mfma_f32_16x16x32_bf16 v[56:59], v[144:147], v[36:39], v[56:59]
    ds_read_b128 v[32:35], v3 offset:41728
    v_mfma_f32_16x16x32_bf16 v[60:63], v[224:227], v[36:39], v[60:63]
    s_waitcnt lgkmcnt(5)
    v_mfma_f32_16x16x32_bf16 v[64:67], v[144:147], v[40:43], v[64:67]
    ds_read_b128 v[36:39], v3 offset:62208
    v_mfma_f32_16x16x32_bf16 v[68:71], v[224:227], v[40:43], v[68:71]
    s_waitcnt lgkmcnt(5)
    v_mfma_f32_16x16x32_bf16 v[72:75], v[144:147], v[16:19], v[72:75]
    v_add_u32 v6, 81920, v3
    v_mfma_f32_16x16x32_bf16 v[76:79], v[224:227], v[16:19], v[76:79]
    ds_read_b128 v[40:43], v6 offset:768
    s_waitcnt lgkmcnt(5)
    v_mfma_f32_16x16x32_bf16 v[80:83], v[144:147], v[20:23], v[80:83]
    ds_read_b128 v[16:19], v4 offset:768
    v_mfma_f32_16x16x32_bf16 v[84:87], v[224:227], v[20:23], v[84:87]
    s_waitcnt vmcnt(12) lgkmcnt(5)
    v_mfma_f32_16x16x32_bf16 v[48:51], v[148:151], v[24:27], v[48:51]
    ds_read_b128 v[20:23], v4 offset:21248
    v_mfma_f32_16x16x32_bf16 v[52:55], v[228:231], v[24:27], v[52:55]
    s_waitcnt lgkmcnt(5)
    v_mfma_f32_16x16x32_bf16 v[56:59], v[148:151], v[28:31], v[56:59]
    ds_read_b128 v[24:27], v4 offset:41728
    v_mfma_f32_16x16x32_bf16 v[60:63], v[228:231], v[28:31], v[60:63]
    s_waitcnt lgkmcnt(5)
    v_mfma_f32_16x16x32_bf16 v[64:67], v[148:151], v[32:35], v[64:67]
    ds_read_b128 v[28:31], v4 offset:62208
    v_mfma_f32_16x16x32_bf16 v[68:71], v[228:231], v[32:35], v[68:71]
    s_waitcnt lgkmcnt(5)
    v_mfma_f32_16x16x32_bf16 v[72:75], v[148:151], v[36:39], v[72:75]
    v_add_u32 v6, 81920, v4
    v_mfma_f32_16x16x32_bf16 v[76:79], v[228:231], v[36:39], v[76:79]
    ds_read_b128 v[32:35], v6 offset:768
    s_waitcnt lgkmcnt(5)
    v_mfma_f32_16x16x32_bf16 v[80:83], v[148:151], v[40:43], v[80:83]
    ds_read_b128 v[36:39], v5 offset:768
    v_mfma_f32_16x16x32_bf16 v[84:87], v[228:231], v[40:43], v[84:87]
    s_waitcnt vmcnt(10) lgkmcnt(5)
    v_mfma_f32_16x16x32_bf16 v[48:51], v[152:155], v[16:19], v[48:51]
    ds_read_b128 v[40:43], v5 offset:21248
    v_mfma_f32_16x16x32_bf16 v[52:55], v[232:235], v[16:19], v[52:55]
    s_waitcnt lgkmcnt(5)
    v_mfma_f32_16x16x32_bf16 v[56:59], v[152:155], v[20:23], v[56:59]
    ds_read_b128 v[16:19], v5 offset:41728
    v_mfma_f32_16x16x32_bf16 v[60:63], v[232:235], v[20:23], v[60:63]
    s_waitcnt lgkmcnt(5)
    v_mfma_f32_16x16x32_bf16 v[64:67], v[152:155], v[24:27], v[64:67]
    ds_read_b128 v[20:23], v5 offset:62208
    v_mfma_f32_16x16x32_bf16 v[68:71], v[232:235], v[24:27], v[68:71]
    s_waitcnt lgkmcnt(5)
    v_mfma_f32_16x16x32_bf16 v[72:75], v[152:155], v[28:31], v[72:75]
    v_add_u32 v6, 81920, v5
    v_mfma_f32_16x16x32_bf16 v[76:79], v[232:235], v[28:31], v[76:79]
    ds_read_b128 v[24:27], v6 offset:768
    s_waitcnt lgkmcnt(5)
    v_mfma_f32_16x16x32_bf16 v[80:83], v[152:155], v[32:35], v[80:83]
    ds_read_b128 v[28:31], v2 offset:1024
    v_mfma_f32_16x16x32_bf16 v[84:87], v[232:235], v[32:35], v[84:87]
    s_waitcnt vmcnt(8) lgkmcnt(5)
    v_mfma_f32_16x16x32_bf16 v[48:51], v[156:159], v[36:39], v[48:51]
    ds_read_b128 v[32:35], v2 offset:21504
    v_mfma_f32_16x16x32_bf16 v[52:55], v[236:239], v[36:39], v[52:55]
    s_waitcnt lgkmcnt(5)
    v_mfma_f32_16x16x32_bf16 v[56:59], v[156:159], v[40:43], v[56:59]
    ds_read_b128 v[36:39], v2 offset:41984
    v_mfma_f32_16x16x32_bf16 v[60:63], v[236:239], v[40:43], v[60:63]
    s_waitcnt lgkmcnt(5)
    v_mfma_f32_16x16x32_bf16 v[64:67], v[156:159], v[16:19], v[64:67]
    ds_read_b128 v[40:43], v2 offset:62464
    v_mfma_f32_16x16x32_bf16 v[68:71], v[236:239], v[16:19], v[68:71]
    s_waitcnt lgkmcnt(5)
    v_mfma_f32_16x16x32_bf16 v[72:75], v[156:159], v[20:23], v[72:75]
    v_add_u32 v6, 81920, v2
    v_mfma_f32_16x16x32_bf16 v[76:79], v[236:239], v[20:23], v[76:79]
    ds_read_b128 v[16:19], v6 offset:1024
    s_waitcnt lgkmcnt(5)
    v_mfma_f32_16x16x32_bf16 v[80:83], v[156:159], v[24:27], v[80:83]
    ds_read_b128 v[20:23], v3 offset:1024
    v_mfma_f32_16x16x32_bf16 v[84:87], v[236:239], v[24:27], v[84:87]
    s_waitcnt vmcnt(6) lgkmcnt(5)
    v_mfma_f32_16x16x32_bf16 v[48:51], v[160:163], v[28:31], v[48:51]
    ds_read_b128 v[24:27], v3 offset:21504
    v_mfma_f32_16x16x32_bf16 v[52:55], v[240:243], v[28:31], v[52:55]
    s_waitcnt lgkmcnt(5)
    v_mfma_f32_16x16x32_bf16 v[56:59], v[160:163], v[32:35], v[56:59]
    ds_read_b128 v[28:31], v3 offset:41984
    v_mfma_f32_16x16x32_bf16 v[60:63], v[240:243], v[32:35], v[60:63]
    s_waitcnt lgkmcnt(5)
    v_mfma_f32_16x16x32_bf16 v[64:67], v[160:163], v[36:39], v[64:67]
    ds_read_b128 v[32:35], v3 offset:62464
    v_mfma_f32_16x16x32_bf16 v[68:71], v[240:243], v[36:39], v[68:71]
    s_waitcnt lgkmcnt(5)
    v_mfma_f32_16x16x32_bf16 v[72:75], v[160:163], v[40:43], v[72:75]
    v_add_u32 v6, 81920, v3
    v_mfma_f32_16x16x32_bf16 v[76:79], v[240:243], v[40:43], v[76:79]
    ds_read_b128 v[36:39], v6 offset:1024
    s_waitcnt lgkmcnt(5)
    v_mfma_f32_16x16x32_bf16 v[80:83], v[160:163], v[16:19], v[80:83]
    ds_read_b128 v[40:43], v4 offset:1024
    v_mfma_f32_16x16x32_bf16 v[84:87], v[240:243], v[16:19], v[84:87]
    s_waitcnt vmcnt(4) lgkmcnt(5)
    v_mfma_f32_16x16x32_bf16 v[48:51], v[164:167], v[20:23], v[48:51]
    ds_read_b128 v[16:19], v4 offset:21504
    v_mfma_f32_16x16x32_bf16 v[52:55], v[244:247], v[20:23], v[52:55]
    s_waitcnt lgkmcnt(5)
    v_mfma_f32_16x16x32_bf16 v[56:59], v[164:167], v[24:27], v[56:59]
    ds_read_b128 v[20:23], v4 offset:41984
    v_mfma_f32_16x16x32_bf16 v[60:63], v[244:247], v[24:27], v[60:63]
    s_waitcnt lgkmcnt(5)
    v_mfma_f32_16x16x32_bf16 v[64:67], v[164:167], v[28:31], v[64:67]
    ds_read_b128 v[24:27], v4 offset:62464
    v_mfma_f32_16x16x32_bf16 v[68:71], v[244:247], v[28:31], v[68:71]
    s_waitcnt lgkmcnt(5)
    v_mfma_f32_16x16x32_bf16 v[72:75], v[164:167], v[32:35], v[72:75]
    v_add_u32 v6, 81920, v4
    v_mfma_f32_16x16x32_bf16 v[76:79], v[244:247], v[32:35], v[76:79]
    ds_read_b128 v[28:31], v6 offset:1024
    s_waitcnt lgkmcnt(5)
    v_mfma_f32_16x16x32_bf16 v[80:83], v[164:167], v[36:39], v[80:83]
    ds_read_b128 v[32:35], v5 offset:1024
    v_mfma_f32_16x16x32_bf16 v[84:87], v[244:247], v[36:39], v[84:87]
    s_waitcnt vmcnt(2) lgkmcnt(5)
    v_mfma_f32_16x16x32_bf16 v[48:51], v[168:171], v[40:43], v[48:51]
    ds_read_b128 v[36:39], v5 offset:21504
    v_mfma_f32_16x16x32_bf16 v[52:55], v[248:251], v[40:43], v[52:55]
    s_waitcnt lgkmcnt(5)
    v_mfma_f32_16x16x32_bf16 v[56:59], v[168:171], v[16:19], v[56:59]
    ds_read_b128 v[40:43], v5 offset:41984
    v_mfma_f32_16x16x32_bf16 v[60:63], v[248:251], v[16:19], v[60:63]
    s_waitcnt lgkmcnt(5)
    v_mfma_f32_16x16x32_bf16 v[64:67], v[168:171], v[20:23], v[64:67]
    ds_read_b128 v[16:19], v5 offset:62464
    v_mfma_f32_16x16x32_bf16 v[68:71], v[248:251], v[20:23], v[68:71]
    s_waitcnt lgkmcnt(5)
    v_mfma_f32_16x16x32_bf16 v[72:75], v[168:171], v[24:27], v[72:75]
    v_add_u32 v6, 81920, v5
    v_mfma_f32_16x16x32_bf16 v[76:79], v[248:251], v[24:27], v[76:79]
    ds_read_b128 v[20:23], v6 offset:1024
    s_waitcnt lgkmcnt(5)
    v_mfma_f32_16x16x32_bf16 v[80:83], v[168:171], v[28:31], v[80:83]
    v_mfma_f32_16x16x32_bf16 v[84:87], v[248:251], v[28:31], v[84:87]
    s_waitcnt vmcnt(0) lgkmcnt(4)
    v_mfma_f32_16x16x32_bf16 v[48:51], v[172:175], v[32:35], v[48:51]
    v_mfma_f32_16x16x32_bf16 v[52:55], v[252:255], v[32:35], v[52:55]
    s_waitcnt lgkmcnt(3)
    v_mfma_f32_16x16x32_bf16 v[56:59], v[172:175], v[36:39], v[56:59]
    v_mfma_f32_16x16x32_bf16 v[60:63], v[252:255], v[36:39], v[60:63]
    s_waitcnt lgkmcnt(2)
    v_mfma_f32_16x16x32_bf16 v[64:67], v[172:175], v[40:43], v[64:67]
    v_mfma_f32_16x16x32_bf16 v[68:71], v[252:255], v[40:43], v[68:71]
    s_waitcnt lgkmcnt(1)
    v_mfma_f32_16x16x32_bf16 v[72:75], v[172:175], v[16:19], v[72:75]
    v_mfma_f32_16x16x32_bf16 v[76:79], v[252:255], v[16:19], v[76:79]
    s_waitcnt lgkmcnt(0)
    v_mfma_f32_16x16x32_bf16 v[80:83], v[172:175], v[20:23], v[80:83]
    v_mfma_f32_16x16x32_bf16 v[84:87], v[252:255], v[20:23], v[84:87]
    ds_read_b64_tr_b16 v[10:11], v7
    ds_read_b64_tr_b16 v[12:13], v8
    ds_read_b64_tr_b16 v[14:15], v9
    v_and_b32 v16, 15, v1
    v_lshrrev_b32 v17, 4, v1
    s_lshl_b32 s42, s3, 7
    s_add_u32 s42, s42, 46016
    v_lshl_add_u32 v19, v17, 4, s42
    s_mov_b64 exec, 0x10001
    s_mov_b32 exec_hi, 0x10001
    ds_write_b128 v19, v[48:51] offset:0
    ds_write_b128 v19, v[52:55] offset:64
    s_mov_b64 exec, -1
    s_lshl_b32 s42, s3, 6
    s_cmp_eq_u32 s3, 2
    s_cselect_b32 s42, 192, s42
    s_cmp_eq_u32 s3, 3
    s_cselect_b32 s42, 128, s42
    s_add_u32 s42, s42, 61440
    v_mul_u32_u24 v20, 496, v16
    v_lshl_add_u32 v20, v17, 4, v20
    v_add_u32 v20, s42, v20
    v_lshlrev_b32 v18, 3, v16
    v_add_u32 v18, 45376, v18
    s_waitcnt lgkmcnt(0)
    s_barrier
    ds_read_b64 v[26:27], v18 offset:128
    ds_read_b64 v[28:29], v18 offset:256
    ds_read_b64 v[30:31], v18 offset:384
    ds_read_b64 v[32:33], v18 offset:512
    ds_read_b128 v[36:39], v19 offset:0
    ds_read_b128 v[40:43], v19 offset:64
    s_waitcnt lgkmcnt(0)
    v_fma_f32 v56, -v26, v36, v56
    v_fma_f32 v57, -v26, v37, v57
    v_fma_f32 v58, -v26, v38, v58
    v_fma_f32 v59, -v26, v39, v59
    v_fma_f32 v60, -v26, v40, v60
    v_fma_f32 v61, -v26, v41, v61
    v_fma_f32 v62, -v26, v42, v62
    v_fma_f32 v63, -v26, v43, v63
    v_fma_f32 v64, -v28, v36, v64
    v_fma_f32 v65, -v28, v37, v65
    v_fma_f32 v66, -v28, v38, v66
    v_fma_f32 v67, -v28, v39, v67
    v_fma_f32 v68, -v28, v40, v68
    v_fma_f32 v69, -v28, v41, v69
    v_fma_f32 v70, -v28, v42, v70
    v_fma_f32 v71, -v28, v43, v71
    v_fma_f32 v72, -v30, v36, v72
    v_fma_f32 v73, -v30, v37, v73
    v_fma_f32 v74, -v30, v38, v74
    v_fma_f32 v75, -v30, v39, v75
    v_fma_f32 v76, -v30, v40, v76
    v_fma_f32 v77, -v30, v41, v77
    v_fma_f32 v78, -v30, v42, v78
    v_fma_f32 v79, -v30, v43, v79
    v_fma_f32 v80, -v32, v36, v80
    v_fma_f32 v81, -v32, v37, v81
    v_fma_f32 v82, -v32, v38, v82
    v_fma_f32 v83, -v32, v39, v83
    v_fma_f32 v84, -v32, v40, v84
    v_fma_f32 v85, -v32, v41, v85
    v_fma_f32 v86, -v32, v42, v86
    v_fma_f32 v87, -v32, v43, v87
    v_mul_f32 v56, v56, v27
    v_mul_f32 v57, v57, v27
    v_mul_f32 v58, v58, v27
    v_mul_f32 v59, v59, v27
    v_mul_f32 v60, v60, v27
    v_mul_f32 v61, v61, v27
    v_mul_f32 v62, v62, v27
    v_mul_f32 v63, v63, v27
    v_mul_f32 v64, v64, v29
    v_mul_f32 v65, v65, v29
    v_mul_f32 v66, v66, v29
    v_mul_f32 v67, v67, v29
    v_mul_f32 v68, v68, v29
    v_mul_f32 v69, v69, v29
    v_mul_f32 v70, v70, v29
    v_mul_f32 v71, v71, v29
    v_mul_f32 v72, v72, v31
    v_mul_f32 v73, v73, v31
    v_mul_f32 v74, v74, v31
    v_mul_f32 v75, v75, v31
    v_mul_f32 v76, v76, v31
    v_mul_f32 v77, v77, v31
    v_mul_f32 v78, v78, v31
    v_mul_f32 v79, v79, v31
    v_mul_f32 v80, v80, v33
    v_mul_f32 v81, v81, v33
    v_mul_f32 v82, v82, v33
    v_mul_f32 v83, v83, v33
    v_mul_f32 v84, v84, v33
    v_mul_f32 v85, v85, v33
    v_mul_f32 v86, v86, v33
    v_mul_f32 v87, v87, v33
    v_cvt_pk_bf16_f32 v56, v56, v60
    v_cvt_pk_bf16_f32 v57, v57, v61
    v_cvt_pk_bf16_f32 v58, v58, v62
    v_cvt_pk_bf16_f32 v59, v59, v63
    ds_write_b128 v20, v[56:59] offset:7936
    v_cvt_pk_bf16_f32 v64, v64, v68
    v_cvt_pk_bf16_f32 v65, v65, v69
    v_cvt_pk_bf16_f32 v66, v66, v70
    v_cvt_pk_bf16_f32 v67, v67, v71
    ds_write_b128 v20, v[64:67] offset:15872
    v_cvt_pk_bf16_f32 v72, v72, v76
    v_cvt_pk_bf16_f32 v73, v73, v77
    v_cvt_pk_bf16_f32 v74, v74, v78
    v_cvt_pk_bf16_f32 v75, v75, v79
    ds_write_b128 v20, v[72:75] offset:23808
    v_cvt_pk_bf16_f32 v80, v80, v84
    v_cvt_pk_bf16_f32 v81, v81, v85
    v_cvt_pk_bf16_f32 v82, v82, v86
    v_cvt_pk_bf16_f32 v83, v83, v87
    ds_write_b128 v20, v[80:83] offset:31744
    s_branch L_a1_post
L_g1B:
    global_load_dwordx4 v[96:99], v44, s[48:49] sc1
    global_load_dwordx4 v[176:179], v44, s[50:51] sc1
    global_load_dwordx4 v[100:103], v45, s[48:49] sc1
    global_load_dwordx4 v[180:183], v45, s[50:51] sc1
    global_load_dwordx4 v[104:107], v46, s[48:49] sc1
    global_load_dwordx4 v[184:187], v46, s[50:51] sc1
    s_barrier
    global_load_dwordx4 v[108:111], v47, s[48:49] sc1
    s_add_u32 s48, s48, 4096
    s_addc_u32 s49, s49, 0
    global_load_dwordx4 v[188:191], v47, s[50:51] sc1
    s_add_u32 s50, s50, 4096
    s_addc_u32 s51, s51, 0
    global_load_dwordx4 v[112:115], v44, s[48:49] sc1
    global_load_dwordx4 v[192:195], v44, s[50:51] sc1
    global_load_dwordx4 v[116:119], v45, s[48:49] sc1
    global_load_dwordx4 v[196:199], v45, s[50:51] sc1
    s_barrier
    global_load_dwordx4 v[120:123], v46, s[48:49] sc1
    global_load_dwordx4 v[200:203], v46, s[50:51] sc1
    global_load_dwordx4 v[124:127], v47, s[48:49] sc1
    s_add_u32 s48, s48, 4096
    s_addc_u32 s49, s49, 0
    global_load_dwordx4 v[204:207], v47, s[50:51] sc1
    s_add_u32 s50, s50, 4096
    s_addc_u32 s51, s51, 0
    ds_read_b128 v[16:19], v2 offset:0
    ds_read_b128 v[20:23], v2 offset:20480
    ds_read_b128 v[24:27], v2 offset:40960
    ds_read_b128 v[28:31], v2 offset:61440
    v_add_u32 v6, 81920, v2
    ds_read_b128 v[32:35], v6 offset:0
    ds_read_b128 v[36:39], v3 offset:0
    s_waitcnt vmcnt(14) lgkmcnt(5)
    v_mfma_f32_16x16x32_bf16 v[48:51], v[96:99], v[16:19], 0
    ds_read_b128 v[40:43], v3 offset:20480
    global_load_dwordx4 v[128:131], v44, s[48:49] sc1
    v_mfma_f32_16x16x32_bf16 v[52:55], v[176:179], v[16:19], 0
    global_load_dwordx4 v[208:211], v44, s[50:51] sc1
    s_waitcnt lgkmcnt(5)
    v_mfma_f32_16x16x32_bf16 v[56:59], v[96:99], v[20:23], 0
    ds_read_b128 v[16:19], v3 offset:40960
    v_mfma_f32_16x16x32_bf16 v[60:63], v[176:179], v[20:23], 0
    s_waitcnt lgkmcnt(5)
    v_mfma_f32_16x16x32_bf16 v[64:67], v[96:99], v[24:27], 0
    ds_read_b128 v[20:23], v3 offset:61440
    v_mfma_f32_16x16x32_bf16 v[68:71], v[176:179], v[24:27], 0
    s_waitcnt lgkmcnt(5)
    v_mfma_f32_16x16x32_bf16 v[72:75], v[96:99], v[28:31], 0
    v_add_u32 v6, 81920, v3
    v_mfma_f32_16x16x32_bf16 v[76:79], v[176:179], v[28:31], 0
    ds_read_b128 v[24:27], v6 offset:0
    s_waitcnt lgkmcnt(5)
    v_mfma_f32_16x16x32_bf16 v[80:83], v[96:99], v[32:35], 0
    ds_read_b128 v[28:31], v4 offset:0
    v_mfma_f32_16x16x32_bf16 v[84:87], v[176:179], v[32:35], 0
    s_waitcnt vmcnt(14) lgkmcnt(5)
    v_mfma_f32_16x16x32_bf16 v[48:51], v[100:103], v[36:39], v[48:51]
    ds_read_b128 v[32:35], v4 offset:20480
    global_load_dwordx4 v[132:135], v45, s[48:49] sc1
    v_mfma_f32_16x16x32_bf16 v[52:55], v[180:183], v[36:39], v[52:55]
    global_load_dwordx4 v[212:215], v45, s[50:51] sc1
    s_waitcnt lgkmcnt(5)
    v_mfma_f32_16x16x32_bf16 v[56:59], v[100:103], v[40:43], v[56:59]
    ds_read_b128 v[36:39], v4 offset:40960
    v_mfma_f32_16x16x32_bf16 v[60:63], v[180:183], v[40:43], v[60:63]
    s_waitcnt lgkmcnt(5)
    v_mfma_f32_16x16x32_bf16 v[64:67], v[100:103], v[16:19], v[64:67]
    ds_read_b128 v[40:43], v4 offset:61440
    v_mfma_f32_16x16x32_bf16 v[68:71], v[180:183], v[16:19], v[68:71]
    s_waitcnt lgkmcnt(5)
    v_mfma_f32_16x16x32_bf16 v[72:75], v[100:103], v[20:23], v[72:75]
    v_add_u32 v6, 81920, v4
    v_mfma_f32_16x16x32_bf16 v[76:79], v[180:183], v[20:23], v[76:79]
    ds_read_b128 v[16:19], v6 offset:0
    s_waitcnt lgkmcnt(5)
    v_mfma_f32_16x16x32_bf16 v[80:83], v[100:103], v[24:27], v[80:83]
    ds_read_b128 v[20:23], v5 offset:0
    v_mfma_f32_16x16x32_bf16 v[84:87], v[180:183], v[24:27], v[84:87]
    s_waitcnt vmcnt(14) lgkmcnt(5)
    v_mfma_f32_16x16x32_bf16 v[48:51], v[104:107], v[28:31], v[48:51]
    ds_read_b128 v[24:27], v5 offset:20480
    s_barrier
    v_mfma_f32_16x16x32_bf16 v[52:55], v[184:187], v[28:31], v[52:55]
    global_load_dwordx4 v[136:139], v46, s[48:49] sc1
    global_load_dwordx4 v[216:219], v46, s[50:51] sc1
    s_waitcnt lgkmcnt(5)
    v_mfma_f32_16x16x32_bf16 v[56:59], v[104:107], v[32:35], v[56:59]
    ds_read_b128 v[28:31], v5 offset:40960
    v_mfma_f32_16x16x32_bf16 v[60:63], v[184:187], v[32:35], v[60:63]
    s_waitcnt lgkmcnt(5)
    v_mfma_f32_16x16x32_bf16 v[64:67], v[104:107], v[36:39], v[64:67]
    ds_read_b128 v[32:35], v5 offset:61440
    v_mfma_f32_16x16x32_bf16 v[68:71], v[184:187], v[36:39], v[68:71]
    s_waitcnt lgkmcnt(5)
    v_mfma_f32_16x16x32_bf16 v[72:75], v[104:107], v[40:43], v[72:75]
    v_add_u32 v6, 81920, v5
    v_mfma_f32_16x16x32_bf16 v[76:79], v[184:187], v[40:43], v[76:79]
    ds_read_b128 v[36:39], v6 offset:0
    s_waitcnt lgkmcnt(5)
    v_mfma_f32_16x16x32_bf16 v[80:83], v[104:107], v[16:19], v[80:83]
    ds_read_b128 v[40:43], v2 offset:256
    v_mfma_f32_16x16x32_bf16 v[84:87], v[184:187], v[16:19], v[84:87]
    s_waitcnt vmcnt(14) lgkmcnt(5)
    v_mfma_f32_16x16x32_bf16 v[48:51], v[108:111], v[20:23], v[48:51]
    ds_read_b128 v[16:19], v2 offset:20736
    global_load_dwordx4 v[140:143], v47, s[48:49] sc1
    v_mfma_f32_16x16x32_bf16 v[52:55], v[188:191], v[20:23], v[52:55]
    s_add_u32 s48, s48, 4096
    s_addc_u32 s49, s49, 0
    global_load_dwordx4 v[220:223], v47, s[50:51] sc1
    s_waitcnt lgkmcnt(5)
    v_mfma_f32_16x16x32_bf16 v[56:59], v[108:111], v[24:27], v[56:59]
    s_add_u32 s50, s50, 4096
    s_addc_u32 s51, s51, 0
    v_mfma_f32_16x16x32_bf16 v[60:63], v[188:191], v[24:27], v[60:63]
    ds_read_b128 v[20:23], v2 offset:41216
    s_waitcnt lgkmcnt(5)
    v_mfma_f32_16x16x32_bf16 v[64:67], v[108:111], v[28:31], v[64:67]
    ds_read_b128 v[24:27], v2 offset:61696
    v_mfma_f32_16x16x32_bf16 v[68:71], v[188:191], v[28:31], v[68:71]
    s_waitcnt lgkmcnt(5)
    v_mfma_f32_16x16x32_bf16 v[72:75], v[108:111], v[32:35], v[72:75]
    v_add_u32 v6, 81920, v2
    v_mfma_f32_16x16x32_bf16 v[76:79], v[188:191], v[32:35], v[76:79]
    ds_read_b128 v[28:31], v6 offset:256
    s_waitcnt lgkmcnt(5)
    v_mfma_f32_16x16x32_bf16 v[80:83], v[108:111], v[36:39], v[80:83]
    ds_read_b128 v[32:35], v3 offset:256
    v_mfma_f32_16x16x32_bf16 v[84:87], v[188:191], v[36:39], v[84:87]
    s_waitcnt vmcnt(14) lgkmcnt(5)
    v_mfma_f32_16x16x32_bf16 v[48:51], v[112:115], v[40:43], v[48:51]
    ds_read_b128 v[36:39], v3 offset:20736
    global_load_dwordx4 v[144:147], v44, s[48:49] sc1
    v_mfma_f32_16x16x32_bf16 v[52:55], v[192:195], v[40:43], v[52:55]
    global_load_dwordx4 v[224:227], v44, s[50:51] sc1
    s_waitcnt lgkmcnt(5)
    v_mfma_f32_16x16x32_bf16 v[56:59], v[112:115], v[16:19], v[56:59]
    ds_read_b128 v[40:43], v3 offset:41216
    v_mfma_f32_16x16x32_bf16 v[60:63], v[192:195], v[16:19], v[60:63]
    s_waitcnt lgkmcnt(5)
    v_mfma_f32_16x16x32_bf16 v[64:67], v[112:115], v[20:23], v[64:67]
    ds_read_b128 v[16:19], v3 offset:61696
    v_mfma_f32_16x16x32_bf16 v[68:71], v[192:195], v[20:23], v[68:71]
    s_waitcnt lgkmcnt(5)
    v_mfma_f32_16x16x32_bf16 v[72:75], v[112:115], v[24:27], v[72:75]
    v_add_u32 v6, 81920, v3
    v_mfma_f32_16x16x32_bf16 v[76:79], v[192:195], v[24:27], v[76:79]
    ds_read_b128 v[20:23], v6 offset:256
    s_waitcnt lgkmcnt(5)
    v_mfma_f32_16x16x32_bf16 v[80:83], v[112:115], v[28:31], v[80:83]
    ds_read_b128 v[24:27], v4 offset:256
    v_mfma_f32_16x16x32_bf16 v[84:87], v[192:195], v[28:31], v[84:87]
    s_waitcnt vmcnt(14) lgkmcnt(5)
    v_mfma_f32_16x16x32_bf16 v[48:51], v[116:119], v[32:35], v[48:51]
    ds_read_b128 v[28:31], v4 offset:20736
    s_barrier
    v_mfma_f32_16x16x32_bf16 v[52:55], v[196:199], v[32:35], v[52:55]
    global_load_dwordx4 v[148:151], v45, s[48:49] sc1
    global_load_dwordx4 v[228:231], v45, s[50:51] sc1
    s_waitcnt lgkmcnt(5)
    v_mfma_f32_16x16x32_bf16 v[56:59], v[116:119], v[36:39], v[56:59]
    ds_read_b128 v[32:35], v4 offset:41216
    v_mfma_f32_16x16x32_bf16 v[60:63], v[196:199], v[36:39], v[60:63]
    s_waitcnt lgkmcnt(5)
    v_mfma_f32_16x16x32_bf16 v[64:67], v[116:119], v[40:43], v[64:67]
    ds_read_b128 v[36:39], v4 offset:61696
    v_mfma_f32_16x16x32_bf16 v[68:71], v[196:199], v[40:43], v[68:71]
    s_waitcnt lgkmcnt(5)
    v_mfma_f32_16x16x32_bf16 v[72:75], v[116:119], v[16:19], v[72:75]
    v_add_u32 v6, 81920, v4
    v_mfma_f32_16x16x32_bf16 v[76:79], v[196:199], v[16:19], v[76:79]
    ds_read_b128 v[40:43], v6 offset:256
    s_waitcnt lgkmcnt(5)
    v_mfma_f32_16x16x32_bf16 v[80:83], v[116:119], v[20:23], v[80:83]
    ds_read_b128 v[16:19], v5 offset:256
    v_mfma_f32_16x16x32_bf16 v[84:87], v[196:199], v[20:23], v[84:87]
    s_waitcnt vmcnt(14) lgkmcnt(5)
    v_mfma_f32_16x16x32_bf16 v[48:51], v[120:123], v[24:27], v[48:51]
    ds_read_b128 v[20:23], v5 offset:20736
    global_load_dwordx4 v[152:155], v46, s[48:49] sc1
    v_mfma_f32_16x16x32_bf16 v[52:55], v[200:203], v[24:27], v[52:55]
    global_load_dwordx4 v[232:235], v46, s[50:51] sc1
    s_waitcnt lgkmcnt(5)
    v_mfma_f32_16x16x32_bf16 v[56:59], v[120:123], v[28:31], v[56:59]
    ds_read_b128 v[24:27], v5 offset:41216
    v_mfma_f32_16x16x32_bf16 v[60:63], v[200:203], v[28:31], v[60:63]
    s_waitcnt lgkmcnt(5)
    v_mfma_f32_16x16x32_bf16 v[64:67], v[120:123], v[32:35], v[64:67]
    ds_read_b128 v[28:31], v5 offset:61696
    v_mfma_f32_16x16x32_bf16 v[68:71], v[200:203], v[32:35], v[68:71]
    s_waitcnt lgkmcnt(5)
    v_mfma_f32_16x16x32_bf16 v[72:75], v[120:123], v[36:39], v[72:75]
    v_add_u32 v6, 81920, v5
    v_mfma_f32_16x16x32_bf16 v[76:79], v[200:203], v[36:39], v[76:79]
    ds_read_b128 v[32:35], v6 offset:256
    s_waitcnt lgkmcnt(5)
    v_mfma_f32_16x16x32_bf16 v[80:83], v[120:123], v[40:43], v[80:83]
    ds_read_b128 v[36:39], v2 offset:512
    v_mfma_f32_16x16x32_bf16 v[84:87], v[200:203], v[40:43], v[84:87]
    s_waitcnt vmcnt(14) lgkmcnt(5)
    v_mfma_f32_16x16x32_bf16 v[48:51], v[124:127], v[16:19], v[48:51]
    ds_read_b128 v[40:43], v2 offset:20992
    global_load_dwordx4 v[156:159], v47, s[48:49] sc1
    v_mfma_f32_16x16x32_bf16 v[52:55], v[204:207], v[16:19], v[52:55]
    s_add_u32 s48, s48, 4096
    s_addc_u32 s49, s49, 0
    global_load_dwordx4 v[236:239], v47, s[50:51] sc1
    s_waitcnt lgkmcnt(5)
    v_mfma_f32_16x16x32_bf16 v[56:59], v[124:127], v[20:23], v[56:59]
    s_add_u32 s50, s50, 4096
    s_addc_u32 s51, s51, 0
    v_mfma_f32_16x16x32_bf16 v[60:63], v[204:207], v[20:23], v[60:63]
    ds_read_b128 v[16:19], v2 offset:41472
    s_waitcnt lgkmcnt(5)
    v_mfma_f32_16x16x32_bf16 v[64:67], v[124:127], v[24:27], v[64:67]
    ds_read_b128 v[20:23], v2 offset:61952
    v_mfma_f32_16x16x32_bf16 v[68:71], v[204:207], v[24:27], v[68:71]
    s_waitcnt lgkmcnt(5)
    v_mfma_f32_16x16x32_bf16 v[72:75], v[124:127], v[28:31], v[72:75]
    v_add_u32 v6, 81920, v2
    v_mfma_f32_16x16x32_bf16 v[76:79], v[204:207], v[28:31], v[76:79]
    ds_read_b128 v[24:27], v6 offset:512
    s_waitcnt lgkmcnt(5)
    v_mfma_f32_16x16x32_bf16 v[80:83], v[124:127], v[32:35], v[80:83]
    ds_read_b128 v[28:31], v3 offset:512
    v_mfma_f32_16x16x32_bf16 v[84:87], v[204:207], v[32:35], v[84:87]
    s_waitcnt vmcnt(14) lgkmcnt(5)
    v_mfma_f32_16x16x32_bf16 v[48:51], v[128:131], v[36:39], v[48:51]
    ds_read_b128 v[32:35], v3 offset:20992
    s_barrier
    v_mfma_f32_16x16x32_bf16 v[52:55], v[208:211], v[36:39], v[52:55]
    global_load_dwordx4 v[160:163], v44, s[48:49] sc1
    global_load_dwordx4 v[240:243], v44, s[50:51] sc1
    s_waitcnt lgkmcnt(5)
    v_mfma_f32_16x16x32_bf16 v[56:59], v[128:131], v[40:43], v[56:59]
    ds_read_b128 v[36:39], v3 offset:41472
    v_mfma_f32_16x16x32_bf16 v[60:63], v[208:211], v[40:43], v[60:63]
    s_waitcnt lgkmcnt(5)
    v_mfma_f32_16x16x32_bf16 v[64:67], v[128:131], v[16:19], v[64:67]
    ds_read_b128 v[40:43], v3 offset:61952
    v_mfma_f32_16x16x32_bf16 v[68:71], v[208:211], v[16:19], v[68:71]
    s_waitcnt lgkmcnt(5)
    v_mfma_f32_16x16x32_bf16 v[72:75], v[128:131], v[20:23], v[72:75]
    v_add_u32 v6, 81920, v3
    v_mfma_f32_16x16x32_bf16 v[76:79], v[208:211], v[20:23], v[76:79]
    ds_read_b128 v[16:19], v6 offset:512
    s_waitcnt lgkmcnt(5)
    v_mfma_f32_16x16x32_bf16 v[80:83], v[128:131], v[24:27], v[80:83]
    ds_read_b128 v[20:23], v4 offset:512
    v_mfma_f32_16x16x32_bf16 v[84:87], v[208:211], v[24:27], v[84:87]
    s_waitcnt vmcnt(14) lgkmcnt(5)
    v_mfma_f32_16x16x32_bf16 v[48:51], v[132:135], v[28:31], v[48:51]
    ds_read_b128 v[24:27], v4 offset:20992
    global_load_dwordx4 v[164:167], v45, s[48:49] sc1
    v_mfma_f32_16x16x32_bf16 v[52:55], v[212:215], v[28:31], v[52:55]
    global_load_dwordx4 v[244:247], v45, s[50:51] sc1
    s_waitcnt lgkmcnt(5)
    v_mfma_f32_16x16x32_bf16 v[56:59], v[132:135], v[32:35], v[56:59]
    ds_read_b128 v[28:31], v4 offset:41472
    v_mfma_f32_16x16x32_bf16 v[60:63], v[212:215], v[32:35], v[60:63]
    s_waitcnt lgkmcnt(5)
    v_mfma_f32_16x16x32_bf16 v[64:67], v[132:135], v[36:39], v[64:67]
    ds_read_b128 v[32:35], v4 offset:61952
    v_mfma_f32_16x16x32_bf16 v[68:71], v[212:215], v[36:39], v[68:71]
    s_waitcnt lgkmcnt(5)
    v_mfma_f32_16x16x32_bf16 v[72:75], v[132:135], v[40:43], v[72:75]
    v_add_u32 v6, 81920, v4
    v_mfma_f32_16x16x32_bf16 v[76:79], v[212:215], v[40:43], v[76:79]
    ds_read_b128 v[36:39], v6 offset:512
    s_waitcnt lgkmcnt(5)
    v_mfma_f32_16x16x32_bf16 v[80:83], v[132:135], v[16:19], v[80:83]
    ds_read_b128 v[40:43], v5 offset:512
    v_mfma_f32_16x16x32_bf16 v[84:87], v[212:215], v[16:19], v[84:87]
    s_waitcnt vmcnt(14) lgkmcnt(5)
    v_mfma_f32_16x16x32_bf16 v[48:51], v[136:139], v[20:23], v[48:51]
    ds_read_b128 v[16:19], v5 offset:20992
    global_load_dwordx4 v[168:171], v46, s[48:49] sc1
    v_mfma_f32_16x16x32_bf16 v[52:55], v[216:219], v[20:23], v[52:55]
    global_load_dwordx4 v[248:251], v46, s[50:51] sc1
    s_waitcnt lgkmcnt(5)
    v_mfma_f32_16x16x32_bf16 v[56:59], v[136:139], v[24:27], v[56:59]
    ds_read_b128 v[20:23], v5 offset:41472
    v_mfma_f32_16x16x32_bf16 v[60:63], v[216:219], v[24:27], v[60:63]
    s_waitcnt lgkmcnt(5)
    v_mfma_f32_16x16x32_bf16 v[64:67], v[136:139], v[28:31], v[64:67]
    ds_read_b128 v[24:27], v5 offset:61952
    v_mfma_f32_16x16x32_bf16 v[68:71], v[216:219], v[28:31], v[68:71]
    s_waitcnt lgkmcnt(5)
    v_mfma_f32_16x16x32_bf16 v[72:75], v[136:139], v[32:35], v[72:75]
    v_add_u32 v6, 81920, v5
    v_mfma_f32_16x16x32_bf16 v[76:79], v[216:219], v[32:35], v[76:79]
    ds_read_b128 v[28:31], v6 offset:512
    s_waitcnt lgkmcnt(5)
    v_mfma_f32_16x16x32_bf16 v[80:83], v[136:139], v[36:39], v[80:83]
    ds_read_b128 v[32:35], v2 offset:768
    v_mfma_f32_16x16x32_bf16 v[84:87], v[216:219], v[36:39], v[84:87]
    s_waitcnt vmcnt(14) lgkmcnt(5)
    v_mfma_f32_16x16x32_bf16 v[48:51], v[140:143], v[40:43], v[48:51]
    ds_read_b128 v[36:39], v2 offset:21248
    s_barrier
    v_mfma_f32_16x16x32_bf16 v[52:55], v[220:223], v[40:43], v[52:55]
    global_load_dwordx4 v[172:175], v47, s[48:49] sc1
    global_load_dwordx4 v[252:255], v47, s[50:51] sc1
    s_waitcnt lgkmcnt(5)
    v_mfma_f32_16x16x32_bf16 v[56:59], v[140:143], v[16:19], v[56:59]
    ds_read_b128 v[40:43], v2 offset:41728
    v_mfma_f32_16x16x32_bf16 v[60:63], v[220:223], v[16:19], v[60:63]
    s_waitcnt lgkmcnt(5)
    v_mfma_f32_16x16x32_bf16 v[64:67], v[140:143], v[20:23], v[64:67]
    ds_read_b128 v[16:19], v2 offset:62208
    v_mfma_f32_16x16x32_bf16 v[68:71], v[220:223], v[20:23], v[68:71]
    s_waitcnt lgkmcnt(5)
    v_mfma_f32_16x16x32_bf16 v[72:75], v[140:143], v[24:27], v[72:75]
    v_add_u32 v6, 81920, v2
    v_mfma_f32_16x16x32_bf16 v[76:79], v[220:223], v[24:27], v[76:79]
    ds_read_b128 v[20:23], v6 offset:768
    s_waitcnt lgkmcnt(5)
    v_mfma_f32_16x16x32_bf16 v[80:83], v[140:143], v[28:31], v[80:83]
    ds_read_b128 v[24:27], v3 offset:768
    v_mfma_f32_16x16x32_bf16 v[84:87], v[220:223], v[28:31], v[84:87]
    s_waitcnt vmcnt(14) lgkmcnt(5)
    v_mfma_f32_16x16x32_bf16 v[48:51], v[144:147], v[32:35], v[48:51]
    ds_read_b128 v[28:31], v3 offset:21248
    v_mfma_f32_16x16x32_bf16 v[52:55], v[224:227], v[32:35], v[52:55]
    s_waitcnt lgkmcnt(5)
    v_mfma_f32_16x16x32_bf16 v[56:59], v[144:147], v[36:39], v[56:59]
    ds_read_b128 v[32:35], v3 offset:41728
    v_mfma_f32_16x16x32_bf16 v[60:63], v[224:227], v[36:39], v[60:63]
    s_waitcnt lgkmcnt(5)
    v_mfma_f32_16x16x32_bf16 v[64:67], v[144:147], v[40:43], v[64:67]
    ds_read_b128 v[36:39], v3 offset:62208
    v_mfma_f32_16x16x32_bf16 v[68:71], v[224:227], v[40:43], v[68:71]
    s_waitcnt lgkmcnt(5)
    v_mfma_f32_16x16x32_bf16 v[72:75], v[144:147], v[16:19], v[72:75]
    v_add_u32 v6, 81920, v3
    v_mfma_f32_16x16x32_bf16 v[76:79], v[224:227], v[16:19], v[76:79]
    ds_read_b128 v[40:43], v6 offset:768
    s_waitcnt lgkmcnt(5)
    v_mfma_f32_16x16x32_bf16 v[80:83], v[144:147], v[20:23], v[80:83]
    ds_read_b128 v[16:19], v4 offset:768
    v_mfma_f32_16x16x32_bf16 v[84:87], v[224:227], v[20:23], v[84:87]
    s_waitcnt vmcnt(12) lgkmcnt(5)
    v_mfma_f32_16x16x32_bf16 v[48:51], v[148:151], v[24:27], v[48:51]
    ds_read_b128 v[20:23], v4 offset:21248
    v_mfma_f32_16x16x32_bf16 v[52:55], v[228:231], v[24:27], v[52:55]
    s_waitcnt lgkmcnt(5)
    v_mfma_f32_16x16x32_bf16 v[56:59], v[148:151], v[28:31], v[56:59]
    ds_read_b128 v[24:27], v4 offset:41728
    v_mfma_f32_16x16x32_bf16 v[60:63], v[228:231], v[28:31], v[60:63]
    s_waitcnt lgkmcnt(5)
    v_mfma_f32_16x16x32_bf16 v[64:67], v[148:151], v[32:35], v[64:67]
    ds_read_b128 v[28:31], v4 offset:62208
    v_mfma_f32_16x16x32_bf16 v[68:71], v[228:231], v[32:35], v[68:71]
    s_waitcnt lgkmcnt(5)
    v_mfma_f32_16x16x32_bf16 v[72:75], v[148:151], v[36:39], v[72:75]
    v_add_u32 v6, 81920, v4
    v_mfma_f32_16x16x32_bf16 v[76:79], v[228:231], v[36:39], v[76:79]
    ds_read_b128 v[32:35], v6 offset:768
    s_waitcnt lgkmcnt(5)
    v_mfma_f32_16x16x32_bf16 v[80:83], v[148:151], v[40:43], v[80:83]
    ds_read_b128 v[36:39], v5 offset:768
    v_mfma_f32_16x16x32_bf16 v[84:87], v[228:231], v[40:43], v[84:87]
    s_waitcnt vmcnt(10) lgkmcnt(5)
    v_mfma_f32_16x16x32_bf16 v[48:51], v[152:155], v[16:19], v[48:51]
    ds_read_b128 v[40:43], v5 offset:21248
    v_mfma_f32_16x16x32_bf16 v[52:55], v[232:235], v[16:19], v[52:55]
    s_waitcnt lgkmcnt(5)
    v_mfma_f32_16x16x32_bf16 v[56:59], v[152:155], v[20:23], v[56:59]
    ds_read_b128 v[16:19], v5 offset:41728
    v_mfma_f32_16x16x32_bf16 v[60:63], v[232:235], v[20:23], v[60:63]
    s_waitcnt lgkmcnt(5)
    v_mfma_f32_16x16x32_bf16 v[64:67], v[152:155], v[24:27], v[64:67]
    ds_read_b128 v[20:23], v5 offset:62208
    v_mfma_f32_16x16x32_bf16 v[68:71], v[232:235], v[24:27], v[68:71]
    s_waitcnt lgkmcnt(5)
    v_mfma_f32_16x16x32_bf16 v[72:75], v[152:155], v[28:31], v[72:75]
    v_add_u32 v6, 81920, v5
    v_mfma_f32_16x16x32_bf16 v[76:79], v[232:235], v[28:31], v[76:79]
    ds_read_b128 v[24:27], v6 offset:768
    s_waitcnt lgkmcnt(5)
    v_mfma_f32_16x16x32_bf16 v[80:83], v[152:155], v[32:35], v[80:83]
    ds_read_b128 v[28:31], v2 offset:1024
    v_mfma_f32_16x16x32_bf16 v[84:87], v[232:235], v[32:35], v[84:87]
    s_waitcnt vmcnt(8) lgkmcnt(5)
    v_mfma_f32_16x16x32_bf16 v[48:51], v[156:159], v[36:39], v[48:51]
    ds_read_b128 v[32:35], v2 offset:21504
    v_mfma_f32_16x16x32_bf16 v[52:55], v[236:239], v[36:39], v[52:55]
    s_waitcnt lgkmcnt(5)
    v_mfma_f32_16x16x32_bf16 v[56:59], v[156:159], v[40:43], v[56:59]
    ds_read_b128 v[36:39], v2 offset:41984
    v_mfma_f32_16x16x32_bf16 v[60:63], v[236:239], v[40:43], v[60:63]
    s_waitcnt lgkmcnt(5)
    v_mfma_f32_16x16x32_bf16 v[64:67], v[156:159], v[16:19], v[64:67]
    ds_read_b128 v[40:43], v2 offset:62464
    v_mfma_f32_16x16x32_bf16 v[68:71], v[236:239], v[16:19], v[68:71]
    s_waitcnt lgkmcnt(5)
    v_mfma_f32_16x16x32_bf16 v[72:75], v[156:159], v[20:23], v[72:75]
    v_add_u32 v6, 81920, v2
    v_mfma_f32_16x16x32_bf16 v[76:79], v[236:239], v[20:23], v[76:79]
    ds_read_b128 v[16:19], v6 offset:1024
    s_waitcnt lgkmcnt(5)
    v_mfma_f32_16x16x32_bf16 v[80:83], v[156:159], v[24:27], v[80:83]
    ds_read_b128 v[20:23], v3 offset:1024
    v_mfma_f32_16x16x32_bf16 v[84:87], v[236:239], v[24:27], v[84:87]
    s_waitcnt vmcnt(6) lgkmcnt(5)
    v_mfma_f32_16x16x32_bf16 v[48:51], v[160:163], v[28:31], v[48:51]
    ds_read_b128 v[24:27], v3 offset:21504
    v_mfma_f32_16x16x32_bf16 v[52:55], v[240:243], v[28:31], v[52:55]
    s_waitcnt lgkmcnt(5)
    v_mfma_f32_16x16x32_bf16 v[56:59], v[160:163], v[32:35], v[56:59]
    ds_read_b128 v[28:31], v3 offset:41984
    v_mfma_f32_16x16x32_bf16 v[60:63], v[240:243], v[32:35], v[60:63]
    s_waitcnt lgkmcnt(5)
    v_mfma_f32_16x16x32_bf16 v[64:67], v[160:163], v[36:39], v[64:67]
    ds_read_b128 v[32:35], v3 offset:62464
    v_mfma_f32_16x16x32_bf16 v[68:71], v[240:243], v[36:39], v[68:71]
    s_waitcnt lgkmcnt(5)
    v_mfma_f32_16x16x32_bf16 v[72:75], v[160:163], v[40:43], v[72:75]
    v_add_u32 v6, 81920, v3
    v_mfma_f32_16x16x32_bf16 v[76:79], v[240:243], v[40:43], v[76:79]
    ds_read_b128 v[36:39], v6 offset:1024
    s_waitcnt lgkmcnt(5)
    v_mfma_f32_16x16x32_bf16 v[80:83], v[160:163], v[16:19], v[80:83]
    ds_read_b128 v[40:43], v4 offset:1024
    v_mfma_f32_16x16x32_bf16 v[84:87], v[240:243], v[16:19], v[84:87]
    s_waitcnt vmcnt(4) lgkmcnt(5)
    v_mfma_f32_16x16x32_bf16 v[48:51], v[164:167], v[20:23], v[48:51]
    ds_read_b128 v[16:19], v4 offset:21504
    v_mfma_f32_16x16x32_bf16 v[52:55], v[244:247], v[20:23], v[52:55]
    s_waitcnt lgkmcnt(5)
    v_mfma_f32_16x16x32_bf16 v[56:59], v[164:167], v[24:27], v[56:59]
    ds_read_b128 v[20:23], v4 offset:41984
    v_mfma_f32_16x16x32_bf16 v[60:63], v[244:247], v[24:27], v[60:63]
    s_waitcnt lgkmcnt(5)
    v_mfma_f32_16x16x32_bf16 v[64:67], v[164:167], v[28:31], v[64:67]
    ds_read_b128 v[24:27], v4 offset:62464
    v_mfma_f32_16x16x32_bf16 v[68:71], v[244:247], v[28:31], v[68:71]
    s_waitcnt lgkmcnt(5)
    v_mfma_f32_16x16x32_bf16 v[72:75], v[164:167], v[32:35], v[72:75]
    v_add_u32 v6, 81920, v4
    v_mfma_f32_16x16x32_bf16 v[76:79], v[244:247], v[32:35], v[76:79]
    ds_read_b128 v[28:31], v6 offset:1024
    s_waitcnt lgkmcnt(5)
    v_mfma_f32_16x16x32_bf16 v[80:83], v[164:167], v[36:39], v[80:83]
    ds_read_b128 v[32:35], v5 offset:1024
    v_mfma_f32_16x16x32_bf16 v[84:87], v[244:247], v[36:39], v[84:87]
    s_waitcnt vmcnt(2) lgkmcnt(5)
    v_mfma_f32_16x16x32_bf16 v[48:51], v[168:171], v[40:43], v[48:51]
    ds_read_b128 v[36:39], v5 offset:21504
    v_mfma_f32_16x16x32_bf16 v[52:55], v[248:251], v[40:43], v[52:55]
    s_waitcnt lgkmcnt(5)
    v_mfma_f32_16x16x32_bf16 v[56:59], v[168:171], v[16:19], v[56:59]
    ds_read_b128 v[40:43], v5 offset:41984
    v_mfma_f32_16x16x32_bf16 v[60:63], v[248:251], v[16:19], v[60:63]
    s_waitcnt lgkmcnt(5)
    v_mfma_f32_16x16x32_bf16 v[64:67], v[168:171], v[20:23], v[64:67]
    ds_read_b128 v[16:19], v5 offset:62464
    v_mfma_f32_16x16x32_bf16 v[68:71], v[248:251], v[20:23], v[68:71]
    s_waitcnt lgkmcnt(5)
    v_mfma_f32_16x16x32_bf16 v[72:75], v[168:171], v[24:27], v[72:75]
    v_add_u32 v6, 81920, v5
    v_mfma_f32_16x16x32_bf16 v[76:79], v[248:251], v[24:27], v[76:79]
    ds_read_b128 v[20:23], v6 offset:1024
    s_waitcnt lgkmcnt(5)
    v_mfma_f32_16x16x32_bf16 v[80:83], v[168:171], v[28:31], v[80:83]
    v_mfma_f32_16x16x32_bf16 v[84:87], v[248:251], v[28:31], v[84:87]
    s_waitcnt vmcnt(0) lgkmcnt(4)
    v_mfma_f32_16x16x32_bf16 v[48:51], v[172:175], v[32:35], v[48:51]
    v_mfma_f32_16x16x32_bf16 v[52:55], v[252:255], v[32:35], v[52:55]
    s_waitcnt lgkmcnt(3)
    v_mfma_f32_16x16x32_bf16 v[56:59], v[172:175], v[36:39], v[56:59]
    v_mfma_f32_16x16x32_bf16 v[60:63], v[252:255], v[36:39], v[60:63]
    s_waitcnt lgkmcnt(2)
    v_mfma_f32_16x16x32_bf16 v[64:67], v[172:175], v[40:43], v[64:67]
    v_mfma_f32_16x16x32_bf16 v[68:71], v[252:255], v[40:43], v[68:71]
    s_waitcnt lgkmcnt(1)
    v_mfma_f32_16x16x32_bf16 v[72:75], v[172:175], v[16:19], v[72:75]
    v_mfma_f32_16x16x32_bf16 v[76:79], v[252:255], v[16:19], v[76:79]
    s_waitcnt lgkmcnt(0)
    v_mfma_f32_16x16x32_bf16 v[80:83], v[172:175], v[20:23], v[80:83]
    v_mfma_f32_16x16x32_bf16 v[84:87], v[252:255], v[20:23], v[84:87]
    ds_read_b64_tr_b16 v[10:11], v7
    ds_read_b64_tr_b16 v[12:13], v8
    ds_read_b64_tr_b16 v[14:15], v9
    v_and_b32 v16, 15, v1
    v_lshrrev_b32 v17, 4, v1
    s_lshl_b32 s42, s3, 7
    s_add_u32 s42, s42, 46016
    v_lshl_add_u32 v19, v17, 4, s42
    s_mov_b64 exec, 0x10001
    s_mov_b32 exec_hi, 0x10001
    ds_write_b128 v19, v[48:51] offset:0
    ds_write_b128 v19, v[52:55] offset:64
    s_mov_b64 exec, -1
    s_lshl_b32 s42, s3, 6
    s_cmp_eq_u32 s3, 2
    s_cselect_b32 s42, 192, s42
    s_cmp_eq_u32 s3, 3
    s_cselect_b32 s42, 128, s42
    s_add_u32 s42, s42, 61440
    v_mul_u32_u24 v20, 496, v16
    v_lshl_add_u32 v20, v17, 4, v20
    v_add_u32 v20, s42, v20
    v_lshlrev_b32 v18, 3, v16
    v_add_u32 v18, 45376, v18
    s_waitcnt lgkmcnt(0)
    s_barrier
    ds_read_b64 v[26:27], v18 offset:128
    ds_read_b64 v[28:29], v18 offset:256
    ds_read_b64 v[30:31], v18 offset:384
    ds_read_b64 v[32:33], v18 offset:512
    ds_read_b128 v[36:39], v19 offset:0
    ds_read_b128 v[40:43], v19 offset:64
    s_waitcnt lgkmcnt(0)
    v_fma_f32 v56, -v26, v36, v56
    v_fma_f32 v57, -v26, v37, v57
    v_fma_f32 v58, -v26, v38, v58
    v_fma_f32 v59, -v26, v39, v59
    v_fma_f32 v60, -v26, v40, v60
    v_fma_f32 v61, -v26, v41, v61
    v_fma_f32 v62, -v26, v42, v62
    v_fma_f32 v63, -v26, v43, v63
    v_fma_f32 v64, -v28, v36, v64
    v_fma_f32 v65, -v28, v37, v65
    v_fma_f32 v66, -v28, v38, v66
    v_fma_f32 v67, -v28, v39, v67
    v_fma_f32 v68, -v28, v40, v68
    v_fma_f32 v69, -v28, v41, v69
    v_fma_f32 v70, -v28, v42, v70
    v_fma_f32 v71, -v28, v43, v71
    v_fma_f32 v72, -v30, v36, v72
    v_fma_f32 v73, -v30, v37, v73
    v_fma_f32 v74, -v30, v38, v74
    v_fma_f32 v75, -v30, v39, v75
    v_fma_f32 v76, -v30, v40, v76
    v_fma_f32 v77, -v30, v41, v77
    v_fma_f32 v78, -v30, v42, v78
    v_fma_f32 v79, -v30, v43, v79
    v_fma_f32 v80, -v32, v36, v80
    v_fma_f32 v81, -v32, v37, v81
    v_fma_f32 v82, -v32, v38, v82
    v_fma_f32 v83, -v32, v39, v83
    v_fma_f32 v84, -v32, v40, v84
    v_fma_f32 v85, -v32, v41, v85
    v_fma_f32 v86, -v32, v42, v86
    v_fma_f32 v87, -v32, v43, v87
    v_mul_f32 v56, v56, v27
    v_mul_f32 v57, v57, v27
    v_mul_f32 v58, v58, v27
    v_mul_f32 v59, v59, v27
    v_mul_f32 v60, v60, v27
    v_mul_f32 v61, v61, v27
    v_mul_f32 v62, v62, v27
    v_mul_f32 v63, v63, v27
    v_mul_f32 v64, v64, v29
    v_mul_f32 v65, v65, v29
    v_mul_f32 v66, v66, v29
    v_mul_f32 v67, v67, v29
    v_mul_f32 v68, v68, v29
    v_mul_f32 v69, v69, v29
    v_mul_f32 v70, v70, v29
    v_mul_f32 v71, v71, v29
    v_mul_f32 v72, v72, v31
    v_mul_f32 v73, v73, v31
    v_mul_f32 v74, v74, v31
    v_mul_f32 v75, v75, v31
    v_mul_f32 v76, v76, v31
    v_mul_f32 v77, v77, v31
    v_mul_f32 v78, v78, v31
    v_mul_f32 v79, v79, v31
    v_mul_f32 v80, v80, v33
    v_mul_f32 v81, v81, v33
    v_mul_f32 v82, v82, v33
    v_mul_f32 v83, v83, v33
    v_mul_f32 v84, v84, v33
    v_mul_f32 v85, v85, v33
    v_mul_f32 v86, v86, v33
    v_mul_f32 v87, v87, v33
    v_cvt_pk_bf16_f32 v56, v56, v60
    v_cvt_pk_bf16_f32 v57, v57, v61
    v_cvt_pk_bf16_f32 v58, v58, v62
    v_cvt_pk_bf16_f32 v59, v59, v63
    ds_write_b128 v20, v[56:59] offset:7936
    v_cvt_pk_bf16_f32 v64, v64, v68
    v_cvt_pk_bf16_f32 v65, v65, v69
    v_cvt_pk_bf16_f32 v66, v66, v70
    v_cvt_pk_bf16_f32 v67, v67, v71
    ds_write_b128 v20, v[64:67] offset:15872
    v_cvt_pk_bf16_f32 v72, v72, v76
    v_cvt_pk_bf16_f32 v73, v73, v77
    v_cvt_pk_bf16_f32 v74, v74, v78
    v_cvt_pk_bf16_f32 v75, v75, v79
    ds_write_b128 v20, v[72:75] offset:23808
    v_cvt_pk_bf16_f32 v80, v80, v84
    v_cvt_pk_bf16_f32 v81, v81, v85
    v_cvt_pk_bf16_f32 v82, v82, v86
    v_cvt_pk_bf16_f32 v83, v83, v87
    ds_write_b128 v20, v[80:83] offset:31744
    s_branch L_a1_post
L_g1D:
    global_load_dwordx4 v[96:99], v44, s[48:49] sc1
    global_load_dwordx4 v[176:179], v44, s[50:51] sc1
    global_load_dwordx4 v[100:103], v45, s[48:49] sc1
    global_load_dwordx4 v[180:183], v45, s[50:51] sc1
    global_load_dwordx4 v[104:107], v46, s[48:49] sc1
    global_load_dwordx4 v[184:187], v46, s[50:51] sc1
    s_barrier
    global_load_dwordx4 v[108:111], v47, s[48:49] sc1
    s_add_u32 s48, s48, 4096
    s_addc_u32 s49, s49, 0
    global_load_dwordx4 v[188:191], v47, s[50:51] sc1
    s_add_u32 s50, s50, 4096
    s_addc_u32 s51, s51, 0
    global_load_dwordx4 v[112:115], v44, s[48:49] sc1
    global_load_dwordx4 v[192:195], v44, s[50:51] sc1
    global_load_dwordx4 v[116:119], v45, s[48:49] sc1
    global_load_dwordx4 v[196:199], v45, s[50:51] sc1
    s_barrier
    global_load_dwordx4 v[120:123], v46, s[48:49] sc1
    global_load_dwordx4 v[200:203], v46, s[50:51] sc1
    global_load_dwordx4 v[124:127], v47, s[48:49] sc1
    s_add_u32 s48, s48, 4096
    s_addc_u32 s49, s49, 0
    global_load_dwordx4 v[204:207], v47, s[50:51] sc1
    s_add_u32 s50, s50, 4096
    s_addc_u32 s51, s51, 0
    ds_read_b128 v[16:19], v2 offset:0
    ds_read_b128 v[20:23], v2 offset:20480
    ds_read_b128 v[24:27], v2 offset:40960
    ds_read_b128 v[28:31], v2 offset:61440
    v_add_u32 v6, 81920, v2
    ds_read_b128 v[32:35], v6 offset:0
    ds_read_b128 v[36:39], v3 offset:0
    s_waitcnt vmcnt(14) lgkmcnt(5)
    v_mfma_f32_16x16x32_bf16 v[48:51], v[96:99], v[16:19], 0
    ds_read_b128 v[40:43], v3 offset:20480
    global_load_dwordx4 v[128:131], v44, s[48:49] sc1
    v_mfma_f32_16x16x32_bf16 v[52:55], v[176:179], v[16:19], 0
    global_load_dwordx4 v[208:211], v44, s[50:51] sc1
    s_waitcnt lgkmcnt(5)
    v_mfma_f32_16x16x32_bf16 v[56:59], v[96:99], v[20:23], 0
    ds_read_b128 v[16:19], v3 offset:40960
    v_mfma_f32_16x16x32_bf16 v[60:63], v[176:179], v[20:23], 0
    s_waitcnt lgkmcnt(5)
    v_mfma_f32_16x16x32_bf16 v[64:67], v[96:99], v[24:27], 0
    ds_read_b128 v[20:23], v3 offset:61440
    v_mfma_f32_16x16x32_bf16 v[68:71], v[176:179], v[24:27], 0
    s_waitcnt lgkmcnt(5)
    v_mfma_f32_16x16x32_bf16 v[72:75], v[96:99], v[28:31], 0
    v_add_u32 v6, 81920, v3
    v_mfma_f32_16x16x32_bf16 v[76:79], v[176:179], v[28:31], 0
    ds_read_b128 v[24:27], v6 offset:0
    s_waitcnt lgkmcnt(5)
    v_mfma_f32_16x16x32_bf16 v[80:83], v[96:99], v[32:35], 0
    ds_read_b128 v[28:31], v4 offset:0
    v_mfma_f32_16x16x32_bf16 v[84:87], v[176:179], v[32:35], 0
    s_waitcnt vmcnt(14) lgkmcnt(5)
    v_mfma_f32_16x16x32_bf16 v[48:51], v[100:103], v[36:39], v[48:51]
    ds_read_b128 v[32:35], v4 offset:20480
    global_load_dwordx4 v[132:135], v45, s[48:49] sc1
    v_mfma_f32_16x16x32_bf16 v[52:55], v[180:183], v[36:39], v[52:55]
    global_load_dwordx4 v[212:215], v45, s[50:51] sc1
    s_waitcnt lgkmcnt(5)
    v_mfma_f32_16x16x32_bf16 v[56:59], v[100:103], v[40:43], v[56:59]
    ds_read_b128 v[36:39], v4 offset:40960
    v_mfma_f32_16x16x32_bf16 v[60:63], v[180:183], v[40:43], v[60:63]
    s_waitcnt lgkmcnt(5)
    v_mfma_f32_16x16x32_bf16 v[64:67], v[100:103], v[16:19], v[64:67]
    ds_read_b128 v[40:43], v4 offset:61440
    v_mfma_f32_16x16x32_bf16 v[68:71], v[180:183], v[16:19], v[68:71]
    s_waitcnt lgkmcnt(5)
    v_mfma_f32_16x16x32_bf16 v[72:75], v[100:103], v[20:23], v[72:75]
    v_add_u32 v6, 81920, v4
    v_mfma_f32_16x16x32_bf16 v[76:79], v[180:183], v[20:23], v[76:79]
    ds_read_b128 v[16:19], v6 offset:0
    s_waitcnt lgkmcnt(5)
    v_mfma_f32_16x16x32_bf16 v[80:83], v[100:103], v[24:27], v[80:83]
    ds_read_b128 v[20:23], v5 offset:0
    v_mfma_f32_16x16x32_bf16 v[84:87], v[180:183], v[24:27], v[84:87]
    s_waitcnt vmcnt(14) lgkmcnt(5)
    v_mfma_f32_16x16x32_bf16 v[48:51], v[104:107], v[28:31], v[48:51]
    ds_read_b128 v[24:27], v5 offset:20480
    s_barrier
    v_mfma_f32_16x16x32_bf16 v[52:55], v[184:187], v[28:31], v[52:55]
    global_load_dwordx4 v[136:139], v46, s[48:49] sc1
    global_load_dwordx4 v[216:219], v46, s[50:51] sc1
    s_waitcnt lgkmcnt(5)
    v_mfma_f32_16x16x32_bf16 v[56:59], v[104:107], v[32:35], v[56:59]
    ds_read_b128 v[28:31], v5 offset:40960
    v_mfma_f32_16x16x32_bf16 v[60:63], v[184:187], v[32:35], v[60:63]
    s_waitcnt lgkmcnt(5)
    v_mfma_f32_16x16x32_bf16 v[64:67], v[104:107], v[36:39], v[64:67]
    ds_read_b128 v[32:35], v5 offset:61440
    v_mfma_f32_16x16x32_bf16 v[68:71], v[184:187], v[36:39], v[68:71]
    s_waitcnt lgkmcnt(5)
    v_mfma_f32_16x16x32_bf16 v[72:75], v[104:107], v[40:43], v[72:75]
    v_add_u32 v6, 81920, v5
    v_mfma_f32_16x16x32_bf16 v[76:79], v[184:187], v[40:43], v[76:79]
    ds_read_b128 v[36:39], v6 offset:0
    s_waitcnt lgkmcnt(5)
    v_mfma_f32_16x16x32_bf16 v[80:83], v[104:107], v[16:19], v[80:83]
    ds_read_b128 v[40:43], v2 offset:256
    v_mfma_f32_16x16x32_bf16 v[84:87], v[184:187], v[16:19], v[84:87]
    s_waitcnt vmcnt(14) lgkmcnt(5)
    v_mfma_f32_16x16x32_bf16 v[48:51], v[108:111], v[20:23], v[48:51]
    ds_read_b128 v[16:19], v2 offset:20736
    global_load_dwordx4 v[140:143], v47, s[48:49] sc1
    v_mfma_f32_16x16x32_bf16 v[52:55], v[188:191], v[20:23], v[52:55]
    s_add_u32 s48, s48, 4096
    s_addc_u32 s49, s49, 0
    global_load_dwordx4 v[220:223], v47, s[50:51] sc1
    s_waitcnt lgkmcnt(5)
    v_mfma_f32_16x16x32_bf16 v[56:59], v[108:111], v[24:27], v[56:59]
    s_add_u32 s50, s50, 4096
    s_addc_u32 s51, s51, 0
    v_mfma_f32_16x16x32_bf16 v[60:63], v[188:191], v[24:27], v[60:63]
    ds_read_b128 v[20:23], v2 offset:41216
    s_waitcnt lgkmcnt(5)
    v_mfma_f32_16x16x32_bf16 v[64:67], v[108:111], v[28:31], v[64:67]
    ds_read_b128 v[24:27], v2 offset:61696
    v_mfma_f32_16x16x32_bf16 v[68:71], v[188:191], v[28:31], v[68:71]
    s_waitcnt lgkmcnt(5)
    v_mfma_f32_16x16x32_bf16 v[72:75], v[108:111], v[32:35], v[72:75]
    v_add_u32 v6, 81920, v2
    v_mfma_f32_16x16x32_bf16 v[76:79], v[188:191], v[32:35], v[76:79]
    ds_read_b128 v[28:31], v6 offset:256
    s_waitcnt lgkmcnt(5)
    v_mfma_f32_16x16x32_bf16 v[80:83], v[108:111], v[36:39], v[80:83]
    ds_read_b128 v[32:35], v3 offset:256
    v_mfma_f32_16x16x32_bf16 v[84:87], v[188:191], v[36:39], v[84:87]
    s_waitcnt vmcnt(14) lgkmcnt(5)
    v_mfma_f32_16x16x32_bf16 v[48:51], v[112:115], v[40:43], v[48:51]
    ds_read_b128 v[36:39], v3 offset:20736
    global_load_dwordx4 v[144:147], v44, s[48:49] sc1
    v_mfma_f32_16x16x32_bf16 v[52:55], v[192:195], v[40:43], v[52:55]
    global_load_dwordx4 v[224:227], v44, s[50:51] sc1
    s_waitcnt lgkmcnt(5)
    v_mfma_f32_16x16x32_bf16 v[56:59], v[112:115], v[16:19], v[56:59]
    ds_read_b128 v[40:43], v3 offset:41216
    v_mfma_f32_16x16x32_bf16 v[60:63], v[192:195], v[16:19], v[60:63]
    s_waitcnt lgkmcnt(5)
    v_mfma_f32_16x16x32_bf16 v[64:67], v[112:115], v[20:23], v[64:67]
    ds_read_b128 v[16:19], v3 offset:61696
    v_mfma_f32_16x16x32_bf16 v[68:71], v[192:195], v[20:23], v[68:71]
    s_waitcnt lgkmcnt(5)
    v_mfma_f32_16x16x32_bf16 v[72:75], v[112:115], v[24:27], v[72:75]
    v_add_u32 v6, 81920, v3
    v_mfma_f32_16x16x32_bf16 v[76:79], v[192:195], v[24:27], v[76:79]
    ds_read_b128 v[20:23], v6 offset:256
    s_waitcnt lgkmcnt(5)
    v_mfma_f32_16x16x32_bf16 v[80:83], v[112:115], v[28:31], v[80:83]
    ds_read_b128 v[24:27], v4 offset:256
    v_mfma_f32_16x16x32_bf16 v[84:87], v[192:195], v[28:31], v[84:87]
    s_waitcnt vmcnt(14) lgkmcnt(5)
    v_mfma_f32_16x16x32_bf16 v[48:51], v[116:119], v[32:35], v[48:51]
    ds_read_b128 v[28:31], v4 offset:20736
    s_barrier
    v_mfma_f32_16x16x32_bf16 v[52:55], v[196:199], v[32:35], v[52:55]
    global_load_dwordx4 v[148:151], v45, s[48:49] sc1
    global_load_dwordx4 v[228:231], v45, s[50:51] sc1
    s_waitcnt lgkmcnt(5)
    v_mfma_f32_16x16x32_bf16 v[56:59], v[116:119], v[36:39], v[56:59]
    ds_read_b128 v[32:35], v4 offset:41216
    v_mfma_f32_16x16x32_bf16 v[60:63], v[196:199], v[36:39], v[60:63]
    s_waitcnt lgkmcnt(5)
    v_mfma_f32_16x16x32_bf16 v[64:67], v[116:119], v[40:43], v[64:67]
    ds_read_b128 v[36:39], v4 offset:61696
    v_mfma_f32_16x16x32_bf16 v[68:71], v[196:199], v[40:43], v[68:71]
    s_waitcnt lgkmcnt(5)
    v_mfma_f32_16x16x32_bf16 v[72:75], v[116:119], v[16:19], v[72:75]
    v_add_u32 v6, 81920, v4
    v_mfma_f32_16x16x32_bf16 v[76:79], v[196:199], v[16:19], v[76:79]
    ds_read_b128 v[40:43], v6 offset:256
    s_waitcnt lgkmcnt(5)
    v_mfma_f32_16x16x32_bf16 v[80:83], v[116:119], v[20:23], v[80:83]
    ds_read_b128 v[16:19], v5 offset:256
    v_mfma_f32_16x16x32_bf16 v[84:87], v[196:199], v[20:23], v[84:87]
    s_waitcnt vmcnt(14) lgkmcnt(5)
    v_mfma_f32_16x16x32_bf16 v[48:51], v[120:123], v[24:27], v[48:51]
    ds_read_b128 v[20:23], v5 offset:20736
    global_load_dwordx4 v[152:155], v46, s[48:49] sc1
    v_mfma_f32_16x16x32_bf16 v[52:55], v[200:203], v[24:27], v[52:55]
    global_load_dwordx4 v[232:235], v46, s[50:51] sc1
    s_waitcnt lgkmcnt(5)
    v_mfma_f32_16x16x32_bf16 v[56:59], v[120:123], v[28:31], v[56:59]
    ds_read_b128 v[24:27], v5 offset:41216
    v_mfma_f32_16x16x32_bf16 v[60:63], v[200:203], v[28:31], v[60:63]
    s_waitcnt lgkmcnt(5)
    v_mfma_f32_16x16x32_bf16 v[64:67], v[120:123], v[32:35], v[64:67]
    ds_read_b128 v[28:31], v5 offset:61696
    v_mfma_f32_16x16x32_bf16 v[68:71], v[200:203], v[32:35], v[68:71]
    s_waitcnt lgkmcnt(5)
    v_mfma_f32_16x16x32_bf16 v[72:75], v[120:123], v[36:39], v[72:75]
    v_add_u32 v6, 81920, v5
    v_mfma_f32_16x16x32_bf16 v[76:79], v[200:203], v[36:39], v[76:79]
    ds_read_b128 v[32:35], v6 offset:256
    s_waitcnt lgkmcnt(5)
    v_mfma_f32_16x16x32_bf16 v[80:83], v[120:123], v[40:43], v[80:83]
    ds_read_b128 v[36:39], v2 offset:512
    v_mfma_f32_16x16x32_bf16 v[84:87], v[200:203], v[40:43], v[84:87]
    s_waitcnt vmcnt(14) lgkmcnt(5)
    v_mfma_f32_16x16x32_bf16 v[48:51], v[124:127], v[16:19], v[48:51]
    ds_read_b128 v[40:43], v2 offset:20992
    global_load_dwordx4 v[156:159], v47, s[48:49] sc1
    v_mfma_f32_16x16x32_bf16 v[52:55], v[204:207], v[16:19], v[52:55]
    s_add_u32 s48, s48, 4096
    s_addc_u32 s49, s49, 0
    global_load_dwordx4 v[236:239], v47, s[50:51] sc1
    s_waitcnt lgkmcnt(5)
    v_mfma_f32_16x16x32_bf16 v[56:59], v[124:127], v[20:23], v[56:59]
    s_add_u32 s50, s50, 4096
    s_addc_u32 s51, s51, 0
    v_mfma_f32_16x16x32_bf16 v[60:63], v[204:207], v[20:23], v[60:63]
    ds_read_b128 v[16:19], v2 offset:41472
    s_waitcnt lgkmcnt(5)
    v_mfma_f32_16x16x32_bf16 v[64:67], v[124:127], v[24:27], v[64:67]
    ds_read_b128 v[20:23], v2 offset:61952
    v_mfma_f32_16x16x32_bf16 v[68:71], v[204:207], v[24:27], v[68:71]
    s_waitcnt lgkmcnt(5)
    v_mfma_f32_16x16x32_bf16 v[72:75], v[124:127], v[28:31], v[72:75]
    v_add_u32 v6, 81920, v2
    v_mfma_f32_16x16x32_bf16 v[76:79], v[204:207], v[28:31], v[76:79]
    ds_read_b128 v[24:27], v6 offset:512
    s_waitcnt lgkmcnt(5)
    v_mfma_f32_16x16x32_bf16 v[80:83], v[124:127], v[32:35], v[80:83]
    ds_read_b128 v[28:31], v3 offset:512
    v_mfma_f32_16x16x32_bf16 v[84:87], v[204:207], v[32:35], v[84:87]
    s_waitcnt vmcnt(14) lgkmcnt(5)
    v_mfma_f32_16x16x32_bf16 v[48:51], v[128:131], v[36:39], v[48:51]
    ds_read_b128 v[32:35], v3 offset:20992
    s_barrier
    v_mfma_f32_16x16x32_bf16 v[52:55], v[208:211], v[36:39], v[52:55]
    global_load_dwordx4 v[160:163], v44, s[48:49] sc1
    global_load_dwordx4 v[240:243], v44, s[50:51] sc1
    s_waitcnt lgkmcnt(5)
    v_mfma_f32_16x16x32_bf16 v[56:59], v[128:131], v[40:43], v[56:59]
    ds_read_b128 v[36:39], v3 offset:41472
    v_mfma_f32_16x16x32_bf16 v[60:63], v[208:211], v[40:43], v[60:63]
    s_waitcnt lgkmcnt(5)
    v_mfma_f32_16x16x32_bf16 v[64:67], v[128:131], v[16:19], v[64:67]
    ds_read_b128 v[40:43], v3 offset:61952
    v_mfma_f32_16x16x32_bf16 v[68:71], v[208:211], v[16:19], v[68:71]
    s_waitcnt lgkmcnt(5)
    v_mfma_f32_16x16x32_bf16 v[72:75], v[128:131], v[20:23], v[72:75]
    v_add_u32 v6, 81920, v3
    v_mfma_f32_16x16x32_bf16 v[76:79], v[208:211], v[20:23], v[76:79]
    ds_read_b128 v[16:19], v6 offset:512
    s_waitcnt lgkmcnt(5)
    v_mfma_f32_16x16x32_bf16 v[80:83], v[128:131], v[24:27], v[80:83]
    ds_read_b128 v[20:23], v4 offset:512
    v_mfma_f32_16x16x32_bf16 v[84:87], v[208:211], v[24:27], v[84:87]
    s_waitcnt vmcnt(14) lgkmcnt(5)
    v_mfma_f32_16x16x32_bf16 v[48:51], v[132:135], v[28:31], v[48:51]
    ds_read_b128 v[24:27], v4 offset:20992
    global_load_dwordx4 v[164:167], v45, s[48:49] sc1
    v_mfma_f32_16x16x32_bf16 v[52:55], v[212:215], v[28:31], v[52:55]
    global_load_dwordx4 v[244:247], v45, s[50:51] sc1
    s_waitcnt lgkmcnt(5)
    v_mfma_f32_16x16x32_bf16 v[56:59], v[132:135], v[32:35], v[56:59]
    ds_read_b128 v[28:31], v4 offset:41472
    v_mfma_f32_16x16x32_bf16 v[60:63], v[212:215], v[32:35], v[60:63]
    s_waitcnt lgkmcnt(5)
    v_mfma_f32_16x16x32_bf16 v[64:67], v[132:135], v[36:39], v[64:67]
    ds_read_b128 v[32:35], v4 offset:61952
    v_mfma_f32_16x16x32_bf16 v[68:71], v[212:215], v[36:39], v[68:71]
    s_waitcnt lgkmcnt(5)
    v_mfma_f32_16x16x32_bf16 v[72:75], v[132:135], v[40:43], v[72:75]
    v_add_u32 v6, 81920, v4
    v_mfma_f32_16x16x32_bf16 v[76:79], v[212:215], v[40:43], v[76:79]
    ds_read_b128 v[36:39], v6 offset:512
    s_waitcnt lgkmcnt(5)
    v_mfma_f32_16x16x32_bf16 v[80:83], v[132:135], v[16:19], v[80:83]
    ds_read_b128 v[40:43], v5 offset:512
    v_mfma_f32_16x16x32_bf16 v[84:87], v[212:215], v[16:19], v[84:87]
    s_waitcnt vmcnt(14) lgkmcnt(5)
    v_mfma_f32_16x16x32_bf16 v[48:51], v[136:139], v[20:23], v[48:51]
    ds_read_b128 v[16:19], v5 offset:20992
    global_load_dwordx4 v[168:171], v46, s[48:49] sc1
    v_mfma_f32_16x16x32_bf16 v[52:55], v[216:219], v[20:23], v[52:55]
    global_load_dwordx4 v[248:251], v46, s[50:51] sc1
    s_waitcnt lgkmcnt(5)
    v_mfma_f32_16x16x32_bf16 v[56:59], v[136:139], v[24:27], v[56:59]
    ds_read_b128 v[20:23], v5 offset:41472
    v_mfma_f32_16x16x32_bf16 v[60:63], v[216:219], v[24:27], v[60:63]
    s_waitcnt lgkmcnt(5)
    v_mfma_f32_16x16x32_bf16 v[64:67], v[136:139], v[28:31], v[64:67]
    ds_read_b128 v[24:27], v5 offset:61952
    v_mfma_f32_16x16x32_bf16 v[68:71], v[216:219], v[28:31], v[68:71]
    s_waitcnt lgkmcnt(5)
    v_mfma_f32_16x16x32_bf16 v[72:75], v[136:139], v[32:35], v[72:75]
    v_add_u32 v6, 81920, v5
    v_mfma_f32_16x16x32_bf16 v[76:79], v[216:219], v[32:35], v[76:79]
    ds_read_b128 v[28:31], v6 offset:512
    s_waitcnt lgkmcnt(5)
    v_mfma_f32_16x16x32_bf16 v[80:83], v[136:139], v[36:39], v[80:83]
    ds_read_b128 v[32:35], v2 offset:768
    v_mfma_f32_16x16x32_bf16 v[84:87], v[216:219], v[36:39], v[84:87]
    s_waitcnt vmcnt(14) lgkmcnt(5)
    v_mfma_f32_16x16x32_bf16 v[48:51], v[140:143], v[40:43], v[48:51]
    ds_read_b128 v[36:39], v2 offset:21248
    s_barrier
    v_mfma_f32_16x16x32_bf16 v[52:55], v[220:223], v[40:43], v[52:55]
    global_load_dwordx4 v[172:175], v47, s[48:49] sc1
    global_load_dwordx4 v[252:255], v47, s[50:51] sc1
    s_waitcnt lgkmcnt(5)
    v_mfma_f32_16x16x32_bf16 v[56:59], v[140:143], v[16:19], v[56:59]
    ds_read_b128 v[40:43], v2 offset:41728
    v_mfma_f32_16x16x32_bf16 v[60:63], v[220:223], v[16:19], v[60:63]
    s_waitcnt lgkmcnt(5)
    v_mfma_f32_16x16x32_bf16 v[64:67], v[140:143], v[20:23], v[64:67]
    ds_read_b128 v[16:19], v2 offset:62208
    v_mfma_f32_16x16x32_bf16 v[68:71], v[220:223], v[20:23], v[68:71]
    s_waitcnt lgkmcnt(5)
    v_mfma_f32_16x16x32_bf16 v[72:75], v[140:143], v[24:27], v[72:75]
    v_add_u32 v6, 81920, v2
    v_mfma_f32_16x16x32_bf16 v[76:79], v[220:223], v[24:27], v[76:79]
    ds_read_b128 v[20:23], v6 offset:768
    s_waitcnt lgkmcnt(5)
    v_mfma_f32_16x16x32_bf16 v[80:83], v[140:143], v[28:31], v[80:83]
    ds_read_b128 v[24:27], v3 offset:768
    v_mfma_f32_16x16x32_bf16 v[84:87], v[220:223], v[28:31], v[84:87]
    s_waitcnt vmcnt(14) lgkmcnt(5)
    v_mfma_f32_16x16x32_bf16 v[48:51], v[144:147], v[32:35], v[48:51]
    ds_read_b128 v[28:31], v3 offset:21248
    v_mfma_f32_16x16x32_bf16 v[52:55], v[224:227], v[32:35], v[52:55]
    s_waitcnt lgkmcnt(5)
    v_mfma_f32_16x16x32_bf16 v[56:59], v[144:147], v[36:39], v[56:59]
    ds_read_b128 v[32:35], v3 offset:41728
    v_mfma_f32_16x16x32_bf16 v[60:63], v[224:227], v[36:39], v[60:63]
    s_waitcnt lgkmcnt(5)
    v_mfma_f32_16x16x32_bf16 v[64:67], v[144:147], v[40:43], v[64:67]
    ds_read_b128 v[36:39], v3 offset:62208
    v_mfma_f32_16x16x32_bf16 v[68:71], v[224:227], v[40:43], v[68:71]
    s_waitcnt lgkmcnt(5)
    v_mfma_f32_16x16x32_bf16 v[72:75], v[144:147], v[16:19], v[72:75]
    v_add_u32 v6, 81920, v3
    v_mfma_f32_16x16x32_bf16 v[76:79], v[224:227], v[16:19], v[76:79]
    ds_read_b128 v[40:43], v6 offset:768
    s_waitcnt lgkmcnt(5)
    v_mfma_f32_16x16x32_bf16 v[80:83], v[144:147], v[20:23], v[80:83]
    ds_read_b128 v[16:19], v4 offset:768
    v_mfma_f32_16x16x32_bf16 v[84:87], v[224:227], v[20:23], v[84:87]
    s_waitcnt vmcnt(12) lgkmcnt(5)
    v_mfma_f32_16x16x32_bf16 v[48:51], v[148:151], v[24:27], v[48:51]
    ds_read_b128 v[20:23], v4 offset:21248
    v_mfma_f32_16x16x32_bf16 v[52:55], v[228:231], v[24:27], v[52:55]
    s_waitcnt lgkmcnt(5)
    v_mfma_f32_16x16x32_bf16 v[56:59], v[148:151], v[28:31], v[56:59]
    ds_read_b128 v[24:27], v4 offset:41728
    v_mfma_f32_16x16x32_bf16 v[60:63], v[228:231], v[28:31], v[60:63]
    s_waitcnt lgkmcnt(5)
    v_mfma_f32_16x16x32_bf16 v[64:67], v[148:151], v[32:35], v[64:67]
    ds_read_b128 v[28:31], v4 offset:62208
    v_mfma_f32_16x16x32_bf16 v[68:71], v[228:231], v[32:35], v[68:71]
    s_waitcnt lgkmcnt(5)
    v_mfma_f32_16x16x32_bf16 v[72:75], v[148:151], v[36:39], v[72:75]
    v_add_u32 v6, 81920, v4
    v_mfma_f32_16x16x32_bf16 v[76:79], v[228:231], v[36:39], v[76:79]
    ds_read_b128 v[32:35], v6 offset:768
    s_waitcnt lgkmcnt(5)
    v_mfma_f32_16x16x32_bf16 v[80:83], v[148:151], v[40:43], v[80:83]
    ds_read_b128 v[36:39], v5 offset:768
    v_mfma_f32_16x16x32_bf16 v[84:87], v[228:231], v[40:43], v[84:87]
    s_waitcnt vmcnt(10) lgkmcnt(5)
    v_mfma_f32_16x16x32_bf16 v[48:51], v[152:155], v[16:19], v[48:51]
    ds_read_b128 v[40:43], v5 offset:21248
    v_mfma_f32_16x16x32_bf16 v[52:55], v[232:235], v[16:19], v[52:55]
    s_waitcnt lgkmcnt(5)
    v_mfma_f32_16x16x32_bf16 v[56:59], v[152:155], v[20:23], v[56:59]
    ds_read_b128 v[16:19], v5 offset:41728
    v_mfma_f32_16x16x32_bf16 v[60:63], v[232:235], v[20:23], v[60:63]
    s_waitcnt lgkmcnt(5)
    v_mfma_f32_16x16x32_bf16 v[64:67], v[152:155], v[24:27], v[64:67]
    ds_read_b128 v[20:23], v5 offset:62208
    v_mfma_f32_16x16x32_bf16 v[68:71], v[232:235], v[24:27], v[68:71]
    s_waitcnt lgkmcnt(5)
    v_mfma_f32_16x16x32_bf16 v[72:75], v[152:155], v[28:31], v[72:75]
    v_add_u32 v6, 81920, v5
    v_mfma_f32_16x16x32_bf16 v[76:79], v[232:235], v[28:31], v[76:79]
    ds_read_b128 v[24:27], v6 offset:768
    s_waitcnt lgkmcnt(5)
    v_mfma_f32_16x16x32_bf16 v[80:83], v[152:155], v[32:35], v[80:83]
    ds_read_b128 v[28:31], v2 offset:1024
    v_mfma_f32_16x16x32_bf16 v[84:87], v[232:235], v[32:35], v[84:87]
    s_waitcnt vmcnt(8) lgkmcnt(5)
    v_mfma_f32_16x16x32_bf16 v[48:51], v[156:159], v[36:39], v[48:51]
    ds_read_b128 v[32:35], v2 offset:21504
    v_mfma_f32_16x16x32_bf16 v[52:55], v[236:239], v[36:39], v[52:55]
    s_waitcnt lgkmcnt(5)
    v_mfma_f32_16x16x32_bf16 v[56:59], v[156:159], v[40:43], v[56:59]
    ds_read_b128 v[36:39], v2 offset:41984
    v_mfma_f32_16x16x32_bf16 v[60:63], v[236:239], v[40:43], v[60:63]
    s_waitcnt lgkmcnt(5)
    v_mfma_f32_16x16x32_bf16 v[64:67], v[156:159], v[16:19], v[64:67]
    ds_read_b128 v[40:43], v2 offset:62464
    v_mfma_f32_16x16x32_bf16 v[68:71], v[236:239], v[16:19], v[68:71]
    s_waitcnt lgkmcnt(5)
    v_mfma_f32_16x16x32_bf16 v[72:75], v[156:159], v[20:23], v[72:75]
    v_add_u32 v6, 81920, v2
    v_mfma_f32_16x16x32_bf16 v[76:79], v[236:239], v[20:23], v[76:79]
    ds_read_b128 v[16:19], v6 offset:1024
    s_waitcnt lgkmcnt(5)
    v_mfma_f32_16x16x32_bf16 v[80:83], v[156:159], v[24:27], v[80:83]
    ds_read_b128 v[20:23], v3 offset:1024
    v_mfma_f32_16x16x32_bf16 v[84:87], v[236:239], v[24:27], v[84:87]
    s_waitcnt vmcnt(6) lgkmcnt(5)
    v_mfma_f32_16x16x32_bf16 v[48:51], v[160:163], v[28:31], v[48:51]
    ds_read_b128 v[24:27], v3 offset:21504
    v_mfma_f32_16x16x32_bf16 v[52:55], v[240:243], v[28:31], v[52:55]
    s_waitcnt lgkmcnt(5)
    v_mfma_f32_16x16x32_bf16 v[56:59], v[160:163], v[32:35], v[56:59]
    ds_read_b128 v[28:31], v3 offset:41984
    v_mfma_f32_16x16x32_bf16 v[60:63], v[240:243], v[32:35], v[60:63]
    s_waitcnt lgkmcnt(5)
    v_mfma_f32_16x16x32_bf16 v[64:67], v[160:163], v[36:39], v[64:67]
    ds_read_b128 v[32:35], v3 offset:62464
    v_mfma_f32_16x16x32_bf16 v[68:71], v[240:243], v[36:39], v[68:71]
    s_waitcnt lgkmcnt(5)
    v_mfma_f32_16x16x32_bf16 v[72:75], v[160:163], v[40:43], v[72:75]
    v_add_u32 v6, 81920, v3
    v_mfma_f32_16x16x32_bf16 v[76:79], v[240:243], v[40:43], v[76:79]
    ds_read_b128 v[36:39], v6 offset:1024
    s_waitcnt lgkmcnt(5)
    v_mfma_f32_16x16x32_bf16 v[80:83], v[160:163], v[16:19], v[80:83]
    ds_read_b128 v[40:43], v4 offset:1024
    v_mfma_f32_16x16x32_bf16 v[84:87], v[240:243], v[16:19], v[84:87]
    s_waitcnt vmcnt(4) lgkmcnt(5)
    v_mfma_f32_16x16x32_bf16 v[48:51], v[164:167], v[20:23], v[48:51]
    ds_read_b128 v[16:19], v4 offset:21504
    v_mfma_f32_16x16x32_bf16 v[52:55], v[244:247], v[20:23], v[52:55]
    s_waitcnt lgkmcnt(5)
    v_mfma_f32_16x16x32_bf16 v[56:59], v[164:167], v[24:27], v[56:59]
    ds_read_b128 v[20:23], v4 offset:41984
    v_mfma_f32_16x16x32_bf16 v[60:63], v[244:247], v[24:27], v[60:63]
    s_waitcnt lgkmcnt(5)
    v_mfma_f32_16x16x32_bf16 v[64:67], v[164:167], v[28:31], v[64:67]
    ds_read_b128 v[24:27], v4 offset:62464
    v_mfma_f32_16x16x32_bf16 v[68:71], v[244:247], v[28:31], v[68:71]
    s_waitcnt lgkmcnt(5)
    v_mfma_f32_16x16x32_bf16 v[72:75], v[164:167], v[32:35], v[72:75]
    v_add_u32 v6, 81920, v4
    v_mfma_f32_16x16x32_bf16 v[76:79], v[244:247], v[32:35], v[76:79]
    ds_read_b128 v[28:31], v6 offset:1024
    s_waitcnt lgkmcnt(5)
    v_mfma_f32_16x16x32_bf16 v[80:83], v[164:167], v[36:39], v[80:83]
    ds_read_b128 v[32:35], v5 offset:1024
    v_mfma_f32_16x16x32_bf16 v[84:87], v[244:247], v[36:39], v[84:87]
    s_waitcnt vmcnt(2) lgkmcnt(5)
    v_mfma_f32_16x16x32_bf16 v[48:51], v[168:171], v[40:43], v[48:51]
    ds_read_b128 v[36:39], v5 offset:21504
    v_mfma_f32_16x16x32_bf16 v[52:55], v[248:251], v[40:43], v[52:55]
    s_waitcnt lgkmcnt(5)
    v_mfma_f32_16x16x32_bf16 v[56:59], v[168:171], v[16:19], v[56:59]
    ds_read_b128 v[40:43], v5 offset:41984
    v_mfma_f32_16x16x32_bf16 v[60:63], v[248:251], v[16:19], v[60:63]
    s_waitcnt lgkmcnt(5)
    v_mfma_f32_16x16x32_bf16 v[64:67], v[168:171], v[20:23], v[64:67]
    ds_read_b128 v[16:19], v5 offset:62464
    v_mfma_f32_16x16x32_bf16 v[68:71], v[248:251], v[20:23], v[68:71]
    s_waitcnt lgkmcnt(5)
    v_mfma_f32_16x16x32_bf16 v[72:75], v[168:171], v[24:27], v[72:75]
    v_add_u32 v6, 81920, v5
    v_mfma_f32_16x16x32_bf16 v[76:79], v[248:251], v[24:27], v[76:79]
    ds_read_b128 v[20:23], v6 offset:1024
    s_waitcnt lgkmcnt(5)
    v_mfma_f32_16x16x32_bf16 v[80:83], v[168:171], v[28:31], v[80:83]
    v_mfma_f32_16x16x32_bf16 v[84:87], v[248:251], v[28:31], v[84:87]
    s_waitcnt vmcnt(0) lgkmcnt(4)
    v_mfma_f32_16x16x32_bf16 v[48:51], v[172:175], v[32:35], v[48:51]
    v_mfma_f32_16x16x32_bf16 v[52:55], v[252:255], v[32:35], v[52:55]
    s_waitcnt lgkmcnt(3)
    v_mfma_f32_16x16x32_bf16 v[56:59], v[172:175], v[36:39], v[56:59]
    v_mfma_f32_16x16x32_bf16 v[60:63], v[252:255], v[36:39], v[60:63]
    s_waitcnt lgkmcnt(2)
    v_mfma_f32_16x16x32_bf16 v[64:67], v[172:175], v[40:43], v[64:67]
    v_mfma_f32_16x16x32_bf16 v[68:71], v[252:255], v[40:43], v[68:71]
    s_waitcnt lgkmcnt(1)
    v_mfma_f32_16x16x32_bf16 v[72:75], v[172:175], v[16:19], v[72:75]
    v_mfma_f32_16x16x32_bf16 v[76:79], v[252:255], v[16:19], v[76:79]
    s_waitcnt lgkmcnt(0)
    v_mfma_f32_16x16x32_bf16 v[80:83], v[172:175], v[20:23], v[80:83]
    v_mfma_f32_16x16x32_bf16 v[84:87], v[252:255], v[20:23], v[84:87]
    ds_read_b64_tr_b16 v[10:11], v7
    ds_read_b64_tr_b16 v[12:13], v8
    ds_read_b64_tr_b16 v[14:15], v9
    v_and_b32 v16, 15, v1
    v_lshrrev_b32 v17, 4, v1
    s_lshl_b32 s42, s3, 7
    s_add_u32 s42, s42, 46016
    v_lshl_add_u32 v19, v17, 4, s42
    s_mov_b64 exec, 0x10001
    s_mov_b32 exec_hi, 0x10001
    ds_write_b128 v19, v[48:51] offset:0
    ds_write_b128 v19, v[52:55] offset:64
    s_mov_b64 exec, -1
    s_lshl_b32 s42, s3, 6
    s_cmp_eq_u32 s3, 2
    s_cselect_b32 s42, 192, s42
    s_cmp_eq_u32 s3, 3
    s_cselect_b32 s42, 128, s42
    s_add_u32 s42, s42, 61440
    v_mul_u32_u24 v20, 496, v16
    v_and_b32 v21, 1, v17
    v_lshl_add_u32 v20, v21, 4, v20
    v_lshrrev_b32 v21, 1, v17
    v_lshl_add_u32 v20, v21, 3, v20
    v_add_u32 v20, s42, v20
    v_lshlrev_b32 v18, 3, v16
    v_add_u32 v18, 45376, v18
    s_waitcnt lgkmcnt(0)
    s_barrier
    ds_read_b64 v[24:25], v18 offset:0
    ds_read_b64 v[26:27], v18 offset:128
    ds_read_b64 v[28:29], v18 offset:256
    ds_read_b64 v[30:31], v18 offset:384
    ds_read_b64 v[32:33], v18 offset:512
    ds_read_b128 v[36:39], v19 offset:0
    ds_read_b128 v[40:43], v19 offset:64
    s_waitcnt lgkmcnt(0)
    v_fma_f32 v52, -v24, v40, v52
    v_fma_f32 v53, -v24, v41, v53
    v_fma_f32 v54, -v24, v42, v54
    v_fma_f32 v55, -v24, v43, v55
    v_fma_f32 v56, -v26, v36, v56
    v_fma_f32 v57, -v26, v37, v57
    v_fma_f32 v58, -v26, v38, v58
    v_fma_f32 v59, -v26, v39, v59
    v_fma_f32 v60, -v26, v40, v60
    v_fma_f32 v61, -v26, v41, v61
    v_fma_f32 v62, -v26, v42, v62
    v_fma_f32 v63, -v26, v43, v63
    v_fma_f32 v64, -v28, v36, v64
    v_fma_f32 v65, -v28, v37, v65
    v_fma_f32 v66, -v28, v38, v66
    v_fma_f32 v67, -v28, v39, v67
    v_fma_f32 v68, -v28, v40, v68
    v_fma_f32 v69, -v28, v41, v69
    v_fma_f32 v70, -v28, v42, v70
    v_fma_f32 v71, -v28, v43, v71
    v_fma_f32 v72, -v30, v36, v72
    v_fma_f32 v73, -v30, v37, v73
    v_fma_f32 v74, -v30, v38, v74
    v_fma_f32 v75, -v30, v39, v75
    v_fma_f32 v76, -v30, v40, v76
    v_fma_f32 v77, -v30, v41, v77
    v_fma_f32 v78, -v30, v42, v78
    v_fma_f32 v79, -v30, v43, v79
    v_fma_f32 v80, -v32, v36, v80
    v_fma_f32 v81, -v32, v37, v81
    v_fma_f32 v82, -v32, v38, v82
    v_fma_f32 v83, -v32, v39, v83
    v_fma_f32 v84, -v32, v40, v84
    v_fma_f32 v85, -v32, v41, v85
    v_fma_f32 v86, -v32, v42, v86
    v_fma_f32 v87, -v32, v43, v87
    v_mul_f32 v52, v52, v25
    v_mul_f32 v53, v53, v25
    v_mul_f32 v54, v54, v25
    v_mul_f32 v55, v55, v25
    v_mul_f32 v56, v56, v27
    v_mul_f32 v57, v57, v27
    v_mul_f32 v58, v58, v27
    v_mul_f32 v59, v59, v27
    v_mul_f32 v60, v60, v27
    v_mul_f32 v61, v61, v27
    v_mul_f32 v62, v62, v27
    v_mul_f32 v63, v63, v27
    v_mul_f32 v64, v64, v29
    v_mul_f32 v65, v65, v29
    v_mul_f32 v66, v66, v29
    v_mul_f32 v67, v67, v29
    v_mul_f32 v68, v68, v29
    v_mul_f32 v69, v69, v29
    v_mul_f32 v70, v70, v29
    v_mul_f32 v71, v71, v29
    v_mul_f32 v72, v72, v31
    v_mul_f32 v73, v73, v31
    v_mul_f32 v74, v74, v31
    v_mul_f32 v75, v75, v31
    v_mul_f32 v76, v76, v31
    v_mul_f32 v77, v77, v31
    v_mul_f32 v78, v78, v31
    v_mul_f32 v79, v79, v31
    v_mul_f32 v80, v80, v33
    v_mul_f32 v81, v81, v33
    v_mul_f32 v82, v82, v33
    v_mul_f32 v83, v83, v33
    v_mul_f32 v84, v84, v33
    v_mul_f32 v85, v85, v33
    v_mul_f32 v86, v86, v33
    v_mul_f32 v87, v87, v33
    v_permlane32_swap_b32 v52, v54
    v_permlane32_swap_b32 v53, v55
    v_permlane32_swap_b32 v56, v58
    v_permlane32_swap_b32 v57, v59
    v_permlane32_swap_b32 v60, v62
    v_permlane32_swap_b32 v61, v63
    v_permlane32_swap_b32 v64, v66
    v_permlane32_swap_b32 v65, v67
    v_permlane32_swap_b32 v68, v70
    v_permlane32_swap_b32 v69, v71
    v_permlane32_swap_b32 v72, v74
    v_permlane32_swap_b32 v73, v75
    v_permlane32_swap_b32 v76, v78
    v_permlane32_swap_b32 v77, v79
    v_permlane32_swap_b32 v80, v82
    v_permlane32_swap_b32 v81, v83
    v_permlane32_swap_b32 v84, v86
    v_permlane32_swap_b32 v85, v87
    v_cvt_pk_bf16_f32 v52, v52, v54
    v_cvt_pk_bf16_f32 v53, v53, v55
    ds_write_b64 v20, v[52:53] offset:32
    v_cvt_pk_bf16_f32 v56, v56, v58
    v_cvt_pk_bf16_f32 v57, v57, v59
    ds_write_b64 v20, v[56:57] offset:7936
    v_cvt_pk_bf16_f32 v60, v60, v62
    v_cvt_pk_bf16_f32 v61, v61, v63
    ds_write_b64 v20, v[60:61] offset:7968
    v_cvt_pk_bf16_f32 v64, v64, v66
    v_cvt_pk_bf16_f32 v65, v65, v67
    ds_write_b64 v20, v[64:65] offset:15872
    v_cvt_pk_bf16_f32 v68, v68, v70
    v_cvt_pk_bf16_f32 v69, v69, v71
    ds_write_b64 v20, v[68:69] offset:15904
    v_cvt_pk_bf16_f32 v72, v72, v74
    v_cvt_pk_bf16_f32 v73, v73, v75
    ds_write_b64 v20, v[72:73] offset:23808
    v_cvt_pk_bf16_f32 v76, v76, v78
    v_cvt_pk_bf16_f32 v77, v77, v79
    ds_write_b64 v20, v[76:77] offset:23840
    v_cvt_pk_bf16_f32 v80, v80, v82
    v_cvt_pk_bf16_f32 v81, v81, v83
    ds_write_b64 v20, v[80:81] offset:31744
    v_cvt_pk_bf16_f32 v84, v84, v86
    v_cvt_pk_bf16_f32 v85, v85, v87
    ds_write_b64 v20, v[84:85] offset:31776
    s_branch L_a1_post
L_g1E:
    global_load_dwordx4 v[96:99], v44, s[48:49] sc1
    global_load_dwordx4 v[100:103], v45, s[48:49] sc1
    global_load_dwordx4 v[104:107], v46, s[48:49] sc1
    s_barrier
    global_load_dwordx4 v[108:111], v47, s[48:49] sc1
    s_add_u32 s48, s48, 4096
    s_addc_u32 s49, s49, 0
    global_load_dwordx4 v[112:115], v44, s[48:49] sc1
    global_load_dwordx4 v[116:119], v45, s[48:49] sc1
    s_barrier
    global_load_dwordx4 v[120:123], v46, s[48:49] sc1
    global_load_dwordx4 v[124:127], v47, s[48:49] sc1
    s_add_u32 s48, s48, 4096
    s_addc_u32 s49, s49, 0
    ds_read_b128 v[16:19], v2 offset:0
    ds_read_b128 v[20:23], v2 offset:20480
    ds_read_b128 v[24:27], v2 offset:40960
    ds_read_b128 v[28:31], v2 offset:61440
    v_add_u32 v6, 81920, v2
    ds_read_b128 v[32:35], v6 offset:0
    ds_read_b128 v[36:39], v3 offset:0
    s_waitcnt vmcnt(7) lgkmcnt(5)
    v_mfma_f32_16x16x32_bf16 v[48:51], v[96:99], v[16:19], 0
    ds_read_b128 v[40:43], v3 offset:20480
    global_load_dwordx4 v[128:131], v44, s[48:49] sc1
    s_waitcnt lgkmcnt(5)
    v_mfma_f32_16x16x32_bf16 v[52:55], v[96:99], v[20:23], 0
    ds_read_b128 v[16:19], v3 offset:40960
    s_waitcnt lgkmcnt(5)
    v_mfma_f32_16x16x32_bf16 v[56:59], v[96:99], v[24:27], 0
    ds_read_b128 v[20:23], v3 offset:61440
    s_waitcnt lgkmcnt(5)
    v_mfma_f32_16x16x32_bf16 v[60:63], v[96:99], v[28:31], 0
    v_add_u32 v6, 81920, v3
    ds_read_b128 v[24:27], v6 offset:0
    s_waitcnt lgkmcnt(5)
    v_mfma_f32_16x16x32_bf16 v[64:67], v[96:99], v[32:35], 0
    ds_read_b128 v[28:31], v4 offset:0
    s_waitcnt vmcnt(7) lgkmcnt(5)
    v_mfma_f32_16x16x32_bf16 v[48:51], v[100:103], v[36:39], v[48:51]
    ds_read_b128 v[32:35], v4 offset:20480
    global_load_dwordx4 v[132:135], v45, s[48:49] sc1
    s_waitcnt lgkmcnt(5)
    v_mfma_f32_16x16x32_bf16 v[52:55], v[100:103], v[40:43], v[52:55]
    ds_read_b128 v[36:39], v4 offset:40960
    s_waitcnt lgkmcnt(5)
    v_mfma_f32_16x16x32_bf16 v[56:59], v[100:103], v[16:19], v[56:59]
    ds_read_b128 v[40:43], v4 offset:61440
    s_waitcnt lgkmcnt(5)
    v_mfma_f32_16x16x32_bf16 v[60:63], v[100:103], v[20:23], v[60:63]
    v_add_u32 v6, 81920, v4
    ds_read_b128 v[16:19], v6 offset:0
    s_waitcnt lgkmcnt(5)
    v_mfma_f32_16x16x32_bf16 v[64:67], v[100:103], v[24:27], v[64:67]
    ds_read_b128 v[20:23], v5 offset:0
    s_waitcnt vmcnt(7) lgkmcnt(5)
    v_mfma_f32_16x16x32_bf16 v[48:51], v[104:107], v[28:31], v[48:51]
    ds_read_b128 v[24:27], v5 offset:20480
    s_barrier
    s_waitcnt lgkmcnt(5)
    v_mfma_f32_16x16x32_bf16 v[52:55], v[104:107], v[32:35], v[52:55]
    global_load_dwordx4 v[136:139], v46, s[48:49] sc1
    ds_read_b128 v[28:31], v5 offset:40960
    s_waitcnt lgkmcnt(5)
    v_mfma_f32_16x16x32_bf16 v[56:59], v[104:107], v[36:39], v[56:59]
    ds_read_b128 v[32:35], v5 offset:61440
    s_waitcnt lgkmcnt(5)
    v_mfma_f32_16x16x32_bf16 v[60:63], v[104:107], v[40:43], v[60:63]
    v_add_u32 v6, 81920, v5
    ds_read_b128 v[36:39], v6 offset:0
    s_waitcnt lgkmcnt(5)
    v_mfma_f32_16x16x32_bf16 v[64:67], v[104:107], v[16:19], v[64:67]
    ds_read_b128 v[40:43], v2 offset:256
    s_waitcnt vmcnt(7) lgkmcnt(5)
    v_mfma_f32_16x16x32_bf16 v[48:51], v[108:111], v[20:23], v[48:51]
    ds_read_b128 v[16:19], v2 offset:20736
    global_load_dwordx4 v[140:143], v47, s[48:49] sc1
    s_waitcnt lgkmcnt(5)
    v_mfma_f32_16x16x32_bf16 v[52:55], v[108:111], v[24:27], v[52:55]
    s_add_u32 s48, s48, 4096
    s_addc_u32 s49, s49, 0
    ds_read_b128 v[20:23], v2 offset:41216
    s_waitcnt lgkmcnt(5)
    v_mfma_f32_16x16x32_bf16 v[56:59], v[108:111], v[28:31], v[56:59]
    ds_read_b128 v[24:27], v2 offset:61696
    s_waitcnt lgkmcnt(5)
    v_mfma_f32_16x16x32_bf16 v[60:63], v[108:111], v[32:35], v[60:63]
    v_add_u32 v6, 81920, v2
    ds_read_b128 v[28:31], v6 offset:256
    s_waitcnt lgkmcnt(5)
    v_mfma_f32_16x16x32_bf16 v[64:67], v[108:111], v[36:39], v[64:67]
    ds_read_b128 v[32:35], v3 offset:256
    s_waitcnt vmcnt(7) lgkmcnt(5)
    v_mfma_f32_16x16x32_bf16 v[48:51], v[112:115], v[40:43], v[48:51]
    ds_read_b128 v[36:39], v3 offset:20736
    global_load_dwordx4 v[144:147], v44, s[48:49] sc1
    s_waitcnt lgkmcnt(5)
    v_mfma_f32_16x16x32_bf16 v[52:55], v[112:115], v[16:19], v[52:55]
    ds_read_b128 v[40:43], v3 offset:41216
    s_waitcnt lgkmcnt(5)
    v_mfma_f32_16x16x32_bf16 v[56:59], v[112:115], v[20:23], v[56:59]
    ds_read_b128 v[16:19], v3 offset:61696
    s_waitcnt lgkmcnt(5)
    v_mfma_f32_16x16x32_bf16 v[60:63], v[112:115], v[24:27], v[60:63]
    v_add_u32 v6, 81920, v3
    ds_read_b128 v[20:23], v6 offset:256
    s_waitcnt lgkmcnt(5)
    v_mfma_f32_16x16x32_bf16 v[64:67], v[112:115], v[28:31], v[64:67]
    ds_read_b128 v[24:27], v4 offset:256
    s_waitcnt vmcnt(7) lgkmcnt(5)
    v_mfma_f32_16x16x32_bf16 v[48:51], v[116:119], v[32:35], v[48:51]
    ds_read_b128 v[28:31], v4 offset:20736
    s_barrier
    s_waitcnt lgkmcnt(5)
    v_mfma_f32_16x16x32_bf16 v[52:55], v[116:119], v[36:39], v[52:55]
    global_load_dwordx4 v[148:151], v45, s[48:49] sc1
    ds_read_b128 v[32:35], v4 offset:41216
    s_waitcnt lgkmcnt(5)
    v_mfma_f32_16x16x32_bf16 v[56:59], v[116:119], v[40:43], v[56:59]
    ds_read_b128 v[36:39], v4 offset:61696
    s_waitcnt lgkmcnt(5)
    v_mfma_f32_16x16x32_bf16 v[60:63], v[116:119], v[16:19], v[60:63]
    v_add_u32 v6, 81920, v4
    ds_read_b128 v[40:43], v6 offset:256
    s_waitcnt lgkmcnt(5)
    v_mfma_f32_16x16x32_bf16 v[64:67], v[116:119], v[20:23], v[64:67]
    ds_read_b128 v[16:19], v5 offset:256
    s_waitcnt vmcnt(7) lgkmcnt(5)
    v_mfma_f32_16x16x32_bf16 v[48:51], v[120:123], v[24:27], v[48:51]
    ds_read_b128 v[20:23], v5 offset:20736
    global_load_dwordx4 v[152:155], v46, s[48:49] sc1
    s_waitcnt lgkmcnt(5)
    v_mfma_f32_16x16x32_bf16 v[52:55], v[120:123], v[28:31], v[52:55]
    ds_read_b128 v[24:27], v5 offset:41216
    s_waitcnt lgkmcnt(5)
    v_mfma_f32_16x16x32_bf16 v[56:59], v[120:123], v[32:35], v[56:59]
    ds_read_b128 v[28:31], v5 offset:61696
    s_waitcnt lgkmcnt(5)
    v_mfma_f32_16x16x32_bf16 v[60:63], v[120:123], v[36:39], v[60:63]
    v_add_u32 v6, 81920, v5
    ds_read_b128 v[32:35], v6 offset:256
    s_waitcnt lgkmcnt(5)
    v_mfma_f32_16x16x32_bf16 v[64:67], v[120:123], v[40:43], v[64:67]
    ds_read_b128 v[36:39], v2 offset:512
    s_waitcnt vmcnt(7) lgkmcnt(5)
    v_mfma_f32_16x16x32_bf16 v[48:51], v[124:127], v[16:19], v[48:51]
    ds_read_b128 v[40:43], v2 offset:20992
    global_load_dwordx4 v[156:159], v47, s[48:49] sc1
    s_waitcnt lgkmcnt(5)
    v_mfma_f32_16x16x32_bf16 v[52:55], v[124:127], v[20:23], v[52:55]
    s_add_u32 s48, s48, 4096
    s_addc_u32 s49, s49, 0
    ds_read_b128 v[16:19], v2 offset:41472
    s_waitcnt lgkmcnt(5)
    v_mfma_f32_16x16x32_bf16 v[56:59], v[124:127], v[24:27], v[56:59]
    ds_read_b128 v[20:23], v2 offset:61952
    s_waitcnt lgkmcnt(5)
    v_mfma_f32_16x16x32_bf16 v[60:63], v[124:127], v[28:31], v[60:63]
    v_add_u32 v6, 81920, v2
    ds_read_b128 v[24:27], v6 offset:512
    s_waitcnt lgkmcnt(5)
    v_mfma_f32_16x16x32_bf16 v[64:67], v[124:127], v[32:35], v[64:67]
    ds_read_b128 v[28:31], v3 offset:512
    s_waitcnt vmcnt(7) lgkmcnt(5)
    v_mfma_f32_16x16x32_bf16 v[48:51], v[128:131], v[36:39], v[48:51]
    ds_read_b128 v[32:35], v3 offset:20992
    s_barrier
    s_waitcnt lgkmcnt(5)
    v_mfma_f32_16x16x32_bf16 v[52:55], v[128:131], v[40:43], v[52:55]
    global_load_dwordx4 v[160:163], v44, s[48:49] sc1
    ds_read_b128 v[36:39], v3 offset:41472
    s_waitcnt lgkmcnt(5)
    v_mfma_f32_16x16x32_bf16 v[56:59], v[128:131], v[16:19], v[56:59]
    ds_read_b128 v[40:43], v3 offset:61952
    s_waitcnt lgkmcnt(5)
    v_mfma_f32_16x16x32_bf16 v[60:63], v[128:131], v[20:23], v[60:63]
    v_add_u32 v6, 81920, v3
    ds_read_b128 v[16:19], v6 offset:512
    s_waitcnt lgkmcnt(5)
    v_mfma_f32_16x16x32_bf16 v[64:67], v[128:131], v[24:27], v[64:67]
    ds_read_b128 v[20:23], v4 offset:512
    s_waitcnt vmcnt(7) lgkmcnt(5)
    v_mfma_f32_16x16x32_bf16 v[48:51], v[132:135], v[28:31], v[48:51]
    ds_read_b128 v[24:27], v4 offset:20992
    global_load_dwordx4 v[164:167], v45, s[48:49] sc1
    s_waitcnt lgkmcnt(5)
    v_mfma_f32_16x16x32_bf16 v[52:55], v[132:135], v[32:35], v[52:55]
    ds_read_b128 v[28:31], v4 offset:41472
    s_waitcnt lgkmcnt(5)
    v_mfma_f32_16x16x32_bf16 v[56:59], v[132:135], v[36:39], v[56:59]
    ds_read_b128 v[32:35], v4 offset:61952
    s_waitcnt lgkmcnt(5)
    v_mfma_f32_16x16x32_bf16 v[60:63], v[132:135], v[40:43], v[60:63]
    v_add_u32 v6, 81920, v4
    ds_read_b128 v[36:39], v6 offset:512
    s_waitcnt lgkmcnt(5)
    v_mfma_f32_16x16x32_bf16 v[64:67], v[132:135], v[16:19], v[64:67]
    ds_read_b128 v[40:43], v5 offset:512
    s_waitcnt vmcnt(7) lgkmcnt(5)
    v_mfma_f32_16x16x32_bf16 v[48:51], v[136:139], v[20:23], v[48:51]
    ds_read_b128 v[16:19], v5 offset:20992
    global_load_dwordx4 v[168:171], v46, s[48:49] sc1
    s_waitcnt lgkmcnt(5)
    v_mfma_f32_16x16x32_bf16 v[52:55], v[136:139], v[24:27], v[52:55]
    ds_read_b128 v[20:23], v5 offset:41472
    s_waitcnt lgkmcnt(5)
    v_mfma_f32_16x16x32_bf16 v[56:59], v[136:139], v[28:31], v[56:59]
    ds_read_b128 v[24:27], v5 offset:61952
    s_waitcnt lgkmcnt(5)
    v_mfma_f32_16x16x32_bf16 v[60:63], v[136:139], v[32:35], v[60:63]
    v_add_u32 v6, 81920, v5
    ds_read_b128 v[28:31], v6 offset:512
    s_waitcnt lgkmcnt(5)
    v_mfma_f32_16x16x32_bf16 v[64:67], v[136:139], v[36:39], v[64:67]
    ds_read_b128 v[32:35], v2 offset:768
    s_waitcnt vmcnt(7) lgkmcnt(5)
    v_mfma_f32_16x16x32_bf16 v[48:51], v[140:143], v[40:43], v[48:51]
    ds_read_b128 v[36:39], v2 offset:21248
    s_barrier
    s_waitcnt lgkmcnt(5)
    v_mfma_f32_16x16x32_bf16 v[52:55], v[140:143], v[16:19], v[52:55]
    global_load_dwordx4 v[172:175], v47, s[48:49] sc1
    ds_read_b128 v[40:43], v2 offset:41728
    s_waitcnt lgkmcnt(5)
    v_mfma_f32_16x16x32_bf16 v[56:59], v[140:143], v[20:23], v[56:59]
    ds_read_b128 v[16:19], v2 offset:62208
    s_waitcnt lgkmcnt(5)
    v_mfma_f32_16x16x32_bf16 v[60:63], v[140:143], v[24:27], v[60:63]
    v_add_u32 v6, 81920, v2
    ds_read_b128 v[20:23], v6 offset:768
    s_waitcnt lgkmcnt(5)
    v_mfma_f32_16x16x32_bf16 v[64:67], v[140:143], v[28:31], v[64:67]
    ds_read_b128 v[24:27], v3 offset:768
    s_waitcnt vmcnt(7) lgkmcnt(5)
    v_mfma_f32_16x16x32_bf16 v[48:51], v[144:147], v[32:35], v[48:51]
    ds_read_b128 v[28:31], v3 offset:21248
    s_mul_i32 s42, s4, 3840
    s_waitcnt lgkmcnt(5)
    v_mfma_f32_16x16x32_bf16 v[52:55], v[144:147], v[36:39], v[52:55]
    s_add_u32 s42, s42, 233472
    v_lshl_add_u32 v44, v1, 7, s42
    s_waitcnt lgkmcnt(4)
    v_mfma_f32_16x16x32_bf16 v[56:59], v[144:147], v[40:43], v[56:59]
    s_lshr_b32 s42, s14, 1
    s_lshl_b32 s42, s42, 9
    s_waitcnt lgkmcnt(3)
    v_mfma_f32_16x16x32_bf16 v[60:63], v[144:147], v[16:19], v[60:63]
    s_add_u32 s42, s42, 266240
    s_lshl_b32 s43, s36, 7
    s_waitcnt lgkmcnt(2)
    v_mfma_f32_16x16x32_bf16 v[64:67], v[144:147], v[20:23], v[64:67]
    v_and_b32 v45, s43, v44
    s_xor_b32 s43, s36, 1
    s_waitcnt vmcnt(6) lgkmcnt(1)
    v_mfma_f32_16x16x32_bf16 v[48:51], v[148:151], v[24:27], v[48:51]
    s_lshl_b32 s43, s43, 8
    s_add_u32 s42, s42, s43
    s_waitcnt lgkmcnt(0)
    v_mfma_f32_16x16x32_bf16 v[52:55], v[148:151], v[28:31], v[52:55]
    v_add_u32 v45, s42, v45
    v_cmp_gt_u32 vcc, 20, v1
    s_nop 1
    v_cndmask_b32 v44, v45, v44, vcc
    global_load_dwordx2 v[46:47], v44, s[32:33] sc1
    ds_read_b128 v[32:35], v3 offset:41728
    s_waitcnt lgkmcnt(0)
    v_mfma_f32_16x16x32_bf16 v[56:59], v[148:151], v[32:35], v[56:59]
    ds_read_b128 v[36:39], v3 offset:62208
    v_add_u32 v6, 81920, v3
    s_waitcnt lgkmcnt(0)
    v_mfma_f32_16x16x32_bf16 v[60:63], v[148:151], v[36:39], v[60:63]
    ds_read_b128 v[40:43], v6 offset:768
    ds_read_b128 v[16:19], v4 offset:768
    s_waitcnt lgkmcnt(1)
    v_mfma_f32_16x16x32_bf16 v[64:67], v[148:151], v[40:43], v[64:67]
    ds_read_b128 v[20:23], v4 offset:21248
    ds_read_b128 v[24:27], v4 offset:41728
    s_waitcnt vmcnt(6) lgkmcnt(2)
    v_mfma_f32_16x16x32_bf16 v[48:51], v[152:155], v[16:19], v[48:51]
    ds_read_b128 v[28:31], v4 offset:62208
    v_add_u32 v6, 81920, v4
    s_waitcnt lgkmcnt(2)
    v_mfma_f32_16x16x32_bf16 v[52:55], v[152:155], v[20:23], v[52:55]
    ds_read_b128 v[32:35], v6 offset:768
    ds_read_b128 v[36:39], v5 offset:768
    s_waitcnt lgkmcnt(3)
    v_mfma_f32_16x16x32_bf16 v[56:59], v[152:155], v[24:27], v[56:59]
    ds_read_b128 v[40:43], v5 offset:21248
    ds_read_b128 v[16:19], v5 offset:41728
    s_waitcnt lgkmcnt(4)
    v_mfma_f32_16x16x32_bf16 v[60:63], v[152:155], v[28:31], v[60:63]
    ds_read_b128 v[20:23], v5 offset:62208
    v_add_u32 v6, 81920, v5
    s_waitcnt lgkmcnt(4)
    v_mfma_f32_16x16x32_bf16 v[64:67], v[152:155], v[32:35], v[64:67]
    ds_read_b128 v[24:27], v6 offset:768
    ds_read_b128 v[28:31], v2 offset:1024
    s_waitcnt vmcnt(5) lgkmcnt(5)
    v_mfma_f32_16x16x32_bf16 v[48:51], v[156:159], v[36:39], v[48:51]
    ds_read_b128 v[32:35], v2 offset:21504
    s_waitcnt lgkmcnt(5)
    v_mfma_f32_16x16x32_bf16 v[52:55], v[156:159], v[40:43], v[52:55]
    ds_read_b128 v[36:39], v2 offset:41984
    s_waitcnt lgkmcnt(5)
    v_mfma_f32_16x16x32_bf16 v[56:59], v[156:159], v[16:19], v[56:59]
    ds_read_b128 v[40:43], v2 offset:62464
    s_waitcnt lgkmcnt(5)
    v_mfma_f32_16x16x32_bf16 v[60:63], v[156:159], v[20:23], v[60:63]
    v_add_u32 v6, 81920, v2
    ds_read_b128 v[16:19], v6 offset:1024
    s_waitcnt lgkmcnt(5)
    v_mfma_f32_16x16x32_bf16 v[64:67], v[156:159], v[24:27], v[64:67]
    ds_read_b128 v[20:23], v3 offset:1024
    s_waitcnt vmcnt(4) lgkmcnt(5)
    v_mfma_f32_16x16x32_bf16 v[48:51], v[160:163], v[28:31], v[48:51]
    ds_read_b128 v[24:27], v3 offset:21504
    s_waitcnt lgkmcnt(5)
    v_mfma_f32_16x16x32_bf16 v[52:55], v[160:163], v[32:35], v[52:55]
    ds_read_b128 v[28:31], v3 offset:41984
    s_waitcnt lgkmcnt(5)
    v_mfma_f32_16x16x32_bf16 v[56:59], v[160:163], v[36:39], v[56:59]
    ds_read_b128 v[32:35], v3 offset:62464
    s_waitcnt lgkmcnt(5)
    v_mfma_f32_16x16x32_bf16 v[60:63], v[160:163], v[40:43], v[60:63]
    v_add_u32 v6, 81920, v3
    ds_read_b128 v[36:39], v6 offset:1024
    s_waitcnt lgkmcnt(5)
    v_mfma_f32_16x16x32_bf16 v[64:67], v[160:163], v[16:19], v[64:67]
    ds_read_b128 v[40:43], v4 offset:1024
    s_waitcnt vmcnt(3) lgkmcnt(5)
    v_mfma_f32_16x16x32_bf16 v[48:51], v[164:167], v[20:23], v[48:51]
    ds_read_b128 v[16:19], v4 offset:21504
    s_waitcnt lgkmcnt(5)
    v_mfma_f32_16x16x32_bf16 v[52:55], v[164:167], v[24:27], v[52:55]
    ds_read_b128 v[20:23], v4 offset:41984
    s_waitcnt lgkmcnt(5)
    v_mfma_f32_16x16x32_bf16 v[56:59], v[164:167], v[28:31], v[56:59]
    ds_read_b128 v[24:27], v4 offset:62464
    s_waitcnt lgkmcnt(5)
    v_mfma_f32_16x16x32_bf16 v[60:63], v[164:167], v[32:35], v[60:63]
    v_add_u32 v6, 81920, v4
    ds_read_b128 v[28:31], v6 offset:1024
    s_waitcnt lgkmcnt(5)
    v_mfma_f32_16x16x32_bf16 v[64:67], v[164:167], v[36:39], v[64:67]
    ds_read_b128 v[32:35], v5 offset:1024
    s_waitcnt vmcnt(2) lgkmcnt(5)
    v_mfma_f32_16x16x32_bf16 v[48:51], v[168:171], v[40:43], v[48:51]
    ds_read_b128 v[36:39], v5 offset:21504
    s_waitcnt lgkmcnt(5)
    v_mfma_f32_16x16x32_bf16 v[52:55], v[168:171], v[16:19], v[52:55]
    ds_read_b128 v[40:43], v5 offset:41984
    s_waitcnt lgkmcnt(5)
    v_mfma_f32_16x16x32_bf16 v[56:59], v[168:171], v[20:23], v[56:59]
    ds_read_b128 v[16:19], v5 offset:62464
    s_waitcnt lgkmcnt(5)
    v_mfma_f32_16x16x32_bf16 v[60:63], v[168:171], v[24:27], v[60:63]
    v_add_u32 v6, 81920, v5
    ds_read_b128 v[20:23], v6 offset:1024
    s_waitcnt lgkmcnt(5)
    v_mfma_f32_16x16x32_bf16 v[64:67], v[168:171], v[28:31], v[64:67]
    s_waitcnt vmcnt(1) lgkmcnt(4)
    v_mfma_f32_16x16x32_bf16 v[48:51], v[172:175], v[32:35], v[48:51]
    s_waitcnt lgkmcnt(3)
    v_mfma_f32_16x16x32_bf16 v[52:55], v[172:175], v[36:39], v[52:55]
    s_waitcnt lgkmcnt(2)
    v_mfma_f32_16x16x32_bf16 v[56:59], v[172:175], v[40:43], v[56:59]
    s_waitcnt lgkmcnt(1)
    v_mfma_f32_16x16x32_bf16 v[60:63], v[172:175], v[16:19], v[60:63]
    s_waitcnt lgkmcnt(0)
    v_mfma_f32_16x16x32_bf16 v[64:67], v[172:175], v[20:23], v[64:67]
    s_mov_b32 s57, 0
    s_nop 5
    s_branch L_poll8_c
L_poll8:
    global_load_dwordx2 v[46:47], v44, s[32:33] sc1
L_poll8_c:
    s_add_u32 s57, s57, 1
    s_waitcnt vmcnt(0)
    v_cmp_ne_u64 vcc, s[34:35], v[46:47]
    s_cmp_gt_u32 s57, 200000
    s_nop 2
    s_cbranch_scc1 L_end
    s_cbranch_vccnz L_poll8
    s_sub_u32 s42, s3, 4
    s_cmp_le_u32 s42, s36
    s_cbranch_scc0 L_px7
    s_cmp_eq_u32 s36, 0
    s_cselect_b32 s42, 2, s42
    s_lshr_b32 s46, s14, 1
    s_mul_i32 s46, s46, 3
    s_add_u32 s46, s46, s42
    s_mul_i32 s46, s46, 3072
    s_add_u32 s46, s46, 15728640
    v_lshl_add_u32 v44, v1, 4, s46
    s_mul_i32 s42, s42, 4608
    s_add_u32 m0, s42, 27648
    v_mov_b32 v45, 0
    global_load_lds_dwordx4 v44, s[32:33] sc1
    global_load_lds_dwordx4 v44, s[32:33] offset:1024 sc1
    global_load_lds_dwordx4 v44, s[32:33] offset:2048 sc1
    ds_write_addtid_b32 v45 offset:3072
L_px7:
    ds_read_b64_tr_b16 v[10:11], v7
    ds_read_b64_tr_b16 v[12:13], v8
    ds_read_b64_tr_b16 v[14:15], v9
    v_and_b32 v16, 15, v1
    v_lshrrev_b32 v17, 4, v1
    s_lshl_b32 s42, s3, 7
    s_add_u32 s42, s42, 46016
    v_lshl_add_u32 v19, v17, 4, s42
    s_mov_b64 exec, 0x10001
    s_mov_b32 exec_hi, 0x10001
    ds_write_b128 v19, v[48:51] offset:0
    s_mov_b64 exec, -1
    s_lshl_b32 s42, s3, 6
    s_cmp_eq_u32 s3, 2
    s_cselect_b32 s42, 192, s42
    s_cmp_eq_u32 s3, 3
    s_cselect_b32 s42, 128, s42
    s_add_u32 s42, s42, 61440
    v_mul_u32_u24 v20, 496, v16
    v_and_b32 v21, 1, v17
    v_lshl_add_u32 v20, v21, 4, v20
    v_lshrrev_b32 v21, 1, v17
    v_lshl_add_u32 v20, v21, 3, v20
    v_add_u32 v20, s42, v20
    v_lshlrev_b32 v18, 3, v16
    v_add_u32 v18, 45376, v18
    s_waitcnt lgkmcnt(0)
    s_barrier
    ds_read_b64 v[24:25], v18 offset:0
    ds_read_b64 v[26:27], v18 offset:128
    ds_read_b64 v[28:29], v18 offset:256
    ds_read_b64 v[30:31], v18 offset:384
    ds_read_b64 v[32:33], v18 offset:512
    ds_read_b128 v[36:39], v19 offset:0
    s_waitcnt lgkmcnt(0)
    v_fma_f32 v48, -v24, v36, v48
    v_fma_f32 v49, -v24, v37, v49
    v_fma_f32 v50, -v24, v38, v50
    v_fma_f32 v51, -v24, v39, v51
    v_fma_f32 v52, -v26, v36, v52
    v_fma_f32 v53, -v26, v37, v53
    v_fma_f32 v54, -v26, v38, v54
    v_fma_f32 v55, -v26, v39, v55
    v_fma_f32 v56, -v28, v36, v56
    v_fma_f32 v57, -v28, v37, v57
    v_fma_f32 v58, -v28, v38, v58
    v_fma_f32 v59, -v28, v39, v59
    v_fma_f32 v60, -v30, v36, v60
    v_fma_f32 v61, -v30, v37, v61
    v_fma_f32 v62, -v30, v38, v62
    v_fma_f32 v63, -v30, v39, v63
    v_fma_f32 v64, -v32, v36, v64
    v_fma_f32 v65, -v32, v37, v65
    v_fma_f32 v66, -v32, v38, v66
    v_fma_f32 v67, -v32, v39, v67
    v_mul_f32 v48, v48, v25
    v_mul_f32 v49, v49, v25
    v_mul_f32 v50, v50, v25
    v_mul_f32 v51, v51, v25
    v_mul_f32 v52, v52, v27
    v_mul_f32 v53, v53, v27
    v_mul_f32 v54, v54, v27
    v_mul_f32 v55, v55, v27
    v_mul_f32 v56, v56, v29
    v_mul_f32 v57, v57, v29
    v_mul_f32 v58, v58, v29
    v_mul_f32 v59, v59, v29
    v_mul_f32 v60, v60, v31
    v_mul_f32 v61, v61, v31
    v_mul_f32 v62, v62, v31
    v_mul_f32 v63, v63, v31
    v_mul_f32 v64, v64, v33
    v_mul_f32 v65, v65, v33
    v_mul_f32 v66, v66, v33
    v_mul_f32 v67, v67, v33
    v_permlane32_swap_b32 v48, v50
    v_permlane32_swap_b32 v49, v51
    v_permlane32_swap_b32 v52, v54
    v_permlane32_swap_b32 v53, v55
    v_permlane32_swap_b32 v56, v58
    v_permlane32_swap_b32 v57, v59
    v_permlane32_swap_b32 v60, v62
    v_permlane32_swap_b32 v61, v63
    v_permlane32_swap_b32 v64, v66
    v_permlane32_swap_b32 v65, v67
    v_cvt_pk_bf16_f32 v48, v48, v50
    v_cvt_pk_bf16_f32 v49, v49, v51
    ds_write_b64 v20, v[48:49] offset:0
    v_cvt_pk_bf16_f32 v52, v52, v54
    v_cvt_pk_bf16_f32 v53, v53, v55
    ds_write_b64 v20, v[52:53] offset:7936
    v_cvt_pk_bf16_f32 v56, v56, v58
    v_cvt_pk_bf16_f32 v57, v57, v59
    ds_write_b64 v20, v[56:57] offset:15872
    v_cvt_pk_bf16_f32 v60, v60, v62
    v_cvt_pk_bf16_f32 v61, v61, v63
    ds_write_b64 v20, v[60:61] offset:23808
    v_cvt_pk_bf16_f32 v64, v64, v66
    v_cvt_pk_bf16_f32 v65, v65, v67
    ds_write_b64 v20, v[64:65] offset:31744
    s_branch L_a1_post
L_a1_post:
    s_setprio 0
    s_cmp_lt_u32 s3, 4
    s_cbranch_scc1 L_pg_lo
    s_waitcnt lgkmcnt(0)
    s_barrier
    s_cmp_eq_u32 s7, 0
    s_cbranch_scc1 L_pg_l0
    s_sub_u32 s42, s3, 4
    s_mul_i32 s42, s42, 15360
    s_add_u32 s42, s42, 40960
    s_mul_i32 s43, s4, 102400
    s_add_u32 s43, s43, s42
    s_add_u32 s43, s43, 14680064
    v_lshlrev_b32 v24, 4, v1
    s_add_u32 s44, s32, s43
    s_addc_u32 s45, s33, 0
    s_add_u32 m0, s42, 61440
    s_nop 0
    global_load_lds_dwordx4 v24, s[44:45] offset:0 sc1
    global_load_lds_dwordx4 v24, s[44:45] offset:1024 sc1
    global_load_lds_dwordx4 v24, s[44:45] offset:2048 sc1
    global_load_lds_dwordx4 v24, s[44:45] offset:3072 sc1
    s_add_u32 m0, s42, 65536
    s_add_u32 s44, s44, 4096
    s_addc_u32 s45, s45, 0
    global_load_lds_dwordx4 v24, s[44:45] offset:0 sc1
    global_load_lds_dwordx4 v24, s[44:45] offset:1024 sc1
    global_load_lds_dwordx4 v24, s[44:45] offset:2048 sc1
    global_load_lds_dwordx4 v24, s[44:45] offset:3072 sc1
    s_add_u32 m0, s42, 69632
    s_add_u32 s44, s44, 4096
    s_addc_u32 s45, s45, 0
    global_load_lds_dwordx4 v24, s[44:45] offset:0 sc1
    global_load_lds_dwordx4 v24, s[44:45] offset:1024 sc1
    global_load_lds_dwordx4 v24, s[44:45] offset:2048 sc1
    global_load_lds_dwordx4 v24, s[44:45] offset:3072 sc1
    s_add_u32 m0, s42, 73728
    s_add_u32 s44, s44, 4096
    s_addc_u32 s45, s45, 0
    global_load_lds_dwordx4 v24, s[44:45] offset:0 sc1
    global_load_lds_dwordx4 v24, s[44:45] offset:1024 sc1
    global_load_lds_dwordx4 v24, s[44:45] offset:2048 sc1
    s_branch L_pg_join
L_pg_l0:
    s_getpc_b64 s[50:51]
L_tbref:
    s_add_u32 s50, s50, L_tab1-L_tbref
    s_addc_u32 s51, s51, 0
    v_and_b32 v70, 255, v0
    v_lshlrev_b32 v70, 1, v70
    v_and_b32 v72, 0x7e, v70
    global_load_ushort v76, v70, s[50:51] offset:0
    global_load_ushort v77, v70, s[50:51] offset:512
    global_load_ushort v78, v70, s[50:51] offset:1024
    global_load_ushort v79, v70, s[50:51] offset:1536
    global_load_ushort v80, v72, s[50:51] offset:2048
    v_lshlrev_b32 v71, 1, v70
    v_add_u32 v71, 2176, v71
    global_load_dword v81, v71, s[50:51] offset:0
    global_load_dword v82, v71, s[50:51] offset:1024
    global_load_dword v83, v71, s[50:51] offset:2048
    global_load_dword v84, v71, s[50:51] offset:3072
    s_sub_u32 s42, s3, 4
    s_mul_i32 s42, s42, 15360
    s_add_u32 s42, s42, 40960
    s_mul_i32 s43, s4, 102400
    s_add_u32 s43, s43, s42
    s_add_u32 s43, s43, 14680064
    v_lshlrev_b32 v24, 4, v1
    s_add_u32 s44, s32, s43
    s_addc_u32 s45, s33, 0
    s_add_u32 m0, s42, 61440
    s_nop 0
    global_load_lds_dwordx4 v24, s[44:45] offset:0 sc1
    global_load_lds_dwordx4 v24, s[44:45] offset:1024 sc1
    global_load_lds_dwordx4 v24, s[44:45] offset:2048 sc1
    global_load_lds_dwordx4 v24, s[44:45] offset:3072 sc1
    s_add_u32 m0, s42, 65536
    s_add_u32 s44, s44, 4096
    s_addc_u32 s45, s45, 0
    global_load_lds_dwordx4 v24, s[44:45] offset:0 sc1
    global_load_lds_dwordx4 v24, s[44:45] offset:1024 sc1
    global_load_lds_dwordx4 v24, s[44:45] offset:2048 sc1
    global_load_lds_dwordx4 v24, s[44:45] offset:3072 sc1
    s_add_u32 m0, s42, 69632
    s_add_u32 s44, s44, 4096
    s_addc_u32 s45, s45, 0
    global_load_lds_dwordx4 v24, s[44:45] offset:0 sc1
    global_load_lds_dwordx4 v24, s[44:45] offset:1024 sc1
    global_load_lds_dwordx4 v24, s[44:45] offset:2048 sc1
    global_load_lds_dwordx4 v24, s[44:45] offset:3072 sc1
    s_add_u32 m0, s42, 73728
    s_add_u32 s44, s44, 4096
    s_addc_u32 s45, s45, 0
    global_load_lds_dwordx4 v24, s[44:45] offset:0 sc1
    global_load_lds_dwordx4 v24, s[44:45] offset:1024 sc1
    global_load_lds_dwordx4 v24, s[44:45] offset:2048 sc1
    s_waitcnt vmcnt(15)
    v_mov_b32 v74, 45344
    v_mov_b32 v75, 1
    s_waitcnt lgkmcnt(0)
    s_mov_b64 exec, 1
    ds_add_u32 v74, v75
    s_mov_b64 exec, -1
    v_mov_b32 v74, 45344
    s_mov_b32 s57, 0
L_sp9:
    ds_read_b32 v75, v74
    s_add_u32 s57, s57, 1
    s_waitcnt lgkmcnt(0)
    v_readfirstlane_b32 s56, v75
    s_cmp_gt_u32 s57, 2000000
    s_nop 2
    s_cbranch_scc1 L_end
    s_cmp_lt_u32 s56, 4
    s_cbranch_scc1 L_sp9
    ds_read_b32 v16, v76 offset:0
    ds_read_b32 v17, v76 offset:4608
    ds_read_b32 v18, v76 offset:9216
    ds_read_b32 v19, v76 offset:13824
    ds_read_b32 v20, v76 offset:18432
    ds_read_b32 v21, v76 offset:23040
    ds_read_b32 v22, v76 offset:27648
    ds_read_b32 v23, v76 offset:32256
    ds_read_b32 v24, v76 offset:36864
    s_waitcnt lgkmcnt(6)
    ds_read_b32 v25, v77 offset:0
    ds_read_b32 v26, v77 offset:4608
    ds_read_b32 v27, v77 offset:9216
    ds_read_b32 v28, v77 offset:13824
    ds_read_b32 v29, v77 offset:18432
    ds_read_b32 v30, v77 offset:23040
    ds_read_b32 v31, v77 offset:27648
    ds_read_b32 v32, v77 offset:32256
    ds_read_b32 v33, v77 offset:36864
    s_waitcnt lgkmcnt(6)
    ds_read_b32 v34, v78 offset:0
    ds_read_b32 v35, v78 offset:4608
    ds_read_b32 v36, v78 offset:9216
    ds_read_b32 v37, v78 offset:13824
    ds_read_b32 v38, v78 offset:18432
    ds_read_b32 v39, v78 offset:23040
    ds_read_b32 v40, v78 offset:27648
    ds_read_b32 v41, v78 offset:32256
    ds_read_b32 v42, v78 offset:36864
    s_waitcnt lgkmcnt(6)
    ds_read_b32 v43, v79 offset:0
    ds_read_b32 v44, v79 offset:4608
    ds_read_b32 v45, v79 offset:9216
    ds_read_b32 v46, v79 offset:13824
    ds_read_b32 v47, v79 offset:18432
    ds_read_b32 v48, v79 offset:23040
    ds_read_b32 v49, v79 offset:27648
    ds_read_b32 v50, v79 offset:32256
    ds_read_b32 v51, v79 offset:36864
    s_waitcnt lgkmcnt(6)
    ds_read_b32 v52, v80 offset:0
    ds_read_b32 v53, v80 offset:4608
    ds_read_b32 v54, v80 offset:9216
    ds_read_b32 v55, v80 offset:13824
    ds_read_b32 v56, v80 offset:18432
    ds_read_b32 v57, v80 offset:23040
    ds_read_b32 v58, v80 offset:27648
    ds_read_b32 v59, v80 offset:32256
    ds_read_b32 v60, v80 offset:36864
    v_add_u32 v70, 47040, v70
    v_add_u32 v72, 49088, v72
    v_mov_b32 v73, 46976
    s_waitcnt lgkmcnt(0)
    v_add_f32 v16, v16, v17
    v_add_f32 v19, v19, v20
    v_add_f32 v22, v22, v23
    v_add_f32 v25, v25, v26
    v_add_f32 v28, v28, v29
    v_add_f32 v31, v31, v32
    v_add_f32 v34, v34, v35
    v_add_f32 v37, v37, v38
    v_add_f32 v40, v40, v41
    v_add_f32 v43, v43, v44
    v_add_f32 v46, v46, v47
    v_add_f32 v49, v49, v50
    v_add_f32 v52, v52, v53
    v_add_f32 v55, v55, v56
    v_add_f32 v58, v58, v59
    v_add_f32 v16, v16, v18
    v_add_f32 v19, v19, v21
    v_add_f32 v22, v22, v24
    v_add_f32 v25, v25, v27
    v_add_f32 v28, v28, v30
    v_add_f32 v31, v31, v33
    v_add_f32 v34, v34, v36
    v_add_f32 v37, v37, v39
    v_add_f32 v40, v40, v42
    v_add_f32 v43, v43, v45
    v_add_f32 v46, v46, v48
    v_add_f32 v49, v49, v51
    v_add_f32 v52, v52, v54
    v_add_f32 v55, v55, v57
    v_add_f32 v58, v58, v60
    v_max3_f32 v62, abs(v16), abs(v25), abs(v34)
    v_max3_f32 v63, abs(v19), abs(v28), abs(v37)
    v_max3_f32 v64, abs(v22), abs(v31), abs(v40)
    v_max3_f32 v62, v62, abs(v43), abs(v52)
    v_max3_f32 v63, v63, abs(v46), abs(v55)
    v_max3_f32 v64, v64, abs(v49), abs(v58)
    v_max_f32_dpp v62, v62, v62 row_ror:1 row_mask:0xf bank_mask:0xf
    v_max_f32_dpp v63, v63, v63 row_ror:1 row_mask:0xf bank_mask:0xf
    v_max_f32_dpp v64, v64, v64 row_ror:1 row_mask:0xf bank_mask:0xf
    v_max_f32_dpp v62, v62, v62 row_ror:2 row_mask:0xf bank_mask:0xf
    v_max_f32_dpp v63, v63, v63 row_ror:2 row_mask:0xf bank_mask:0xf
    v_max_f32_dpp v64, v64, v64 row_ror:2 row_mask:0xf bank_mask:0xf
    v_max_f32_dpp v62, v62, v62 row_ror:4 row_mask:0xf bank_mask:0xf
    v_max_f32_dpp v63, v63, v63 row_ror:4 row_mask:0xf bank_mask:0xf
    v_max_f32_dpp v64, v64, v64 row_ror:4 row_mask:0xf bank_mask:0xf
    v_max_f32_dpp v62, v62, v62 row_ror:8 row_mask:0xf bank_mask:0xf
    v_max_f32_dpp v63, v63, v63 row_ror:8 row_mask:0xf bank_mask:0xf
    v_max_f32_dpp v64, v64, v64 row_ror:8 row_mask:0xf bank_mask:0xf
    s_mov_b32 exec_lo, 0x00010001
    s_mov_b32 exec_hi, 0x00010001
    ds_max_f32 v73, v62 offset:0
    ds_max_f32 v73, v63 offset:4
    ds_max_f32 v73, v64 offset:8
    s_mov_b64 exec, -1
    v_mov_b32 v74, 45344
    v_mov_b32 v75, 1
    s_waitcnt lgkmcnt(0)
    s_mov_b64 exec, 1
    ds_add_u32 v74, v75
    s_mov_b64 exec, -1
    v_mov_b32 v74, 45344
    s_mov_b32 s57, 0
L_sp10:
    ds_read_b32 v75, v74
    s_add_u32 s57, s57, 1
    s_waitcnt lgkmcnt(0)
    v_readfirstlane_b32 s56, v75
    s_cmp_gt_u32 s57, 2000000
    s_nop 2
    s_cbranch_scc1 L_end
    s_cmp_lt_u32 s56, 8
    s_cbranch_scc1 L_sp10
    ds_read_b128 v[66:69], v73
    s_waitcnt lgkmcnt(0)
    v_frexp_exp_i32_f32 v66, v66
    v_frexp_exp_i32_f32 v67, v67
    v_frexp_exp_i32_f32 v68, v68
    v_sub_u32 v62, 14, v66
    v_subrev_u32 v66, 22, v66
    v_sub_u32 v63, 14, v67
    v_subrev_u32 v67, 22, v67
    v_sub_u32 v64, 14, v68
    v_subrev_u32 v68, 22, v68
    v_ldexp_f32 v66, 1.0, v66
    v_ldexp_f32 v67, 1.0, v67
    v_ldexp_f32 v68, 1.0, v68
    v_ldexp_f32 v16, v16, v62
    v_ldexp_f32 v19, v19, v63
    v_ldexp_f32 v22, v22, v64
    v_ldexp_f32 v25, v25, v62
    v_ldexp_f32 v28, v28, v63
    v_ldexp_f32 v31, v31, v64
    v_ldexp_f32 v34, v34, v62
    v_ldexp_f32 v37, v37, v63
    v_ldexp_f32 v40, v40, v64
    v_ldexp_f32 v43, v43, v62
    v_ldexp_f32 v46, v46, v63
    v_ldexp_f32 v49, v49, v64
    v_ldexp_f32 v52, v52, v62
    v_ldexp_f32 v55, v55, v63
    v_ldexp_f32 v58, v58, v64
    v_cvt_f16_f32 v16, v16
    v_cvt_f16_f32 v19, v19
    v_cvt_f16_f32 v22, v22
    v_cvt_f16_f32 v25, v25
    v_cvt_f16_f32 v28, v28
    v_cvt_f16_f32 v31, v31
    v_cvt_f16_f32 v34, v34
    v_cvt_f16_f32 v37, v37
    v_cvt_f16_f32 v40, v40
    v_cvt_f16_f32 v43, v43
    v_cvt_f16_f32 v46, v46
    v_cvt_f16_f32 v49, v49
    v_cvt_f16_f32 v52, v52
    v_cvt_f16_f32 v55, v55
    v_cvt_f16_f32 v58, v58
    ds_write_b128 v73, v[66:69] offset:16
    ds_write_b16 v70, v16 offset:0
    ds_write_b16 v70, v16 offset:2306
    ds_write_b16 v70, v19 offset:4608
    ds_write_b16 v70, v19 offset:6914
    ds_write_b16 v70, v22 offset:9216
    ds_write_b16 v70, v22 offset:11522
    ds_write_b16 v70, v25 offset:512
    ds_write_b16 v70, v25 offset:2818
    ds_write_b16 v70, v28 offset:5120
    ds_write_b16 v70, v28 offset:7426
    ds_write_b16 v70, v31 offset:9728
    ds_write_b16 v70, v31 offset:12034
    s_waitcnt lgkmcnt(2)
    ds_write_b16 v70, v34 offset:1024
    ds_write_b16 v70, v34 offset:3330
    ds_write_b16 v70, v37 offset:5632
    ds_write_b16 v70, v37 offset:7938
    ds_write_b16 v70, v40 offset:10240
    ds_write_b16 v70, v40 offset:12546
    ds_write_b16 v70, v43 offset:1536
    ds_write_b16 v70, v43 offset:3842
    ds_write_b16 v70, v46 offset:6144
    ds_write_b16 v70, v46 offset:8450
    ds_write_b16 v70, v49 offset:10752
    ds_write_b16 v70, v49 offset:13058
    s_waitcnt lgkmcnt(2)
    ds_write_b16 v72, v52 offset:0
    ds_write_b16 v72, v52 offset:2306
    ds_write_b16 v72, v55 offset:4608
    ds_write_b16 v72, v55 offset:6914
    ds_write_b16 v72, v58 offset:9216
    ds_write_b16 v72, v58 offset:11522
    v_mov_b32 v74, 45344
    v_mov_b32 v75, 1
    s_waitcnt lgkmcnt(0)
    s_mov_b64 exec, 1
    ds_add_u32 v74, v75
    s_mov_b64 exec, -1
    v_mov_b32 v74, 45344
    s_mov_b32 s57, 0
L_sp11:
    ds_read_b32 v75, v74
    s_add_u32 s57, s57, 1
    s_waitcnt lgkmcnt(0)
    v_readfirstlane_b32 s56, v75
    s_cmp_gt_u32 s57, 2000000
    s_nop 2
    s_cbranch_scc1 L_end
    s_cmp_lt_u32 s56, 12
    s_cbranch_scc1 L_sp11
    v_lshrrev_b32 v85, 16, v81
    v_and_b32 v81, 0xffff, v81
    v_add_u32 v81, 47040, v81
    v_lshrrev_b32 v86, 16, v82
    v_and_b32 v82, 0xffff, v82
    v_add_u32 v82, 47040, v82
    v_lshrrev_b32 v87, 16, v83
    v_and_b32 v83, 0xffff, v83
    v_add_u32 v83, 47040, v83
    v_lshrrev_b32 v88, 16, v84
    v_and_b32 v84, 0xffff, v84
    v_add_u32 v84, 47040, v84
    ds_read2_b32 v[16:17], v81 offset0:0 offset1:1
    ds_read2_b32 v[18:19], v81 offset0:2 offset1:3
    ds_read2_b32 v[20:21], v82 offset0:0 offset1:1
    ds_read2_b32 v[22:23], v82 offset0:2 offset1:3
    ds_read2_b32 v[24:25], v83 offset0:0 offset1:1
    ds_read2_b32 v[26:27], v83 offset0:2 offset1:3
    ds_read2_b32 v[28:29], v84 offset0:0 offset1:1
    ds_read2_b32 v[30:31], v84 offset0:2 offset1:3
    v_add_u32 v81, 4608, v81
    v_add_u32 v82, 4608, v82
    v_add_u32 v83, 4608, v83
    v_add_u32 v84, 4608, v84
    s_waitcnt lgkmcnt(4)
    ds_read2_b32 v[32:33], v81 offset0:0 offset1:1
    ds_read2_b32 v[34:35], v81 offset0:2 offset1:3
    ds_read2_b32 v[36:37], v82 offset0:0 offset1:1
    ds_read2_b32 v[38:39], v82 offset0:2 offset1:3
    ds_read2_b32 v[40:41], v83 offset0:0 offset1:1
    ds_read2_b32 v[42:43], v83 offset0:2 offset1:3
    ds_read2_b32 v[44:45], v84 offset0:0 offset1:1
    ds_read2_b32 v[46:47], v84 offset0:2 offset1:3
    s_waitcnt lgkmcnt(8)
    ds_write_b128 v85, v[16:19] offset:0
    ds_write_b128 v86, v[20:23] offset:0
    ds_write_b128 v87, v[24:27] offset:0
    ds_write_b128 v88, v[28:31] offset:0
    v_add_u32 v81, 4608, v81
    v_add_u32 v82, 4608, v82
    v_add_u32 v83, 4608, v83
    v_add_u32 v84, 4608, v84
    s_waitcnt lgkmcnt(4)
    ds_read2_b32 v[48:49], v81 offset0:0 offset1:1
    ds_read2_b32 v[50:51], v81 offset0:2 offset1:3
    ds_read2_b32 v[52:53], v82 offset0:0 offset1:1
    ds_read2_b32 v[54:55], v82 offset0:2 offset1:3
    ds_read2_b32 v[56:57], v83 offset0:0 offset1:1
    ds_read2_b32 v[58:59], v83 offset0:2 offset1:3
    ds_read2_b32 v[60:61], v84 offset0:0 offset1:1
    ds_read2_b32 v[62:63], v84 offset0:2 offset1:3
    s_waitcnt lgkmcnt(8)
    ds_write_b128 v85, v[32:35] offset:15104
    ds_write_b128 v86, v[36:39] offset:15104
    ds_write_b128 v87, v[40:43] offset:15104
    ds_write_b128 v88, v[44:47] offset:15104
    s_waitcnt lgkmcnt(0)
    ds_write_b128 v85, v[48:51] offset:30208
    ds_write_b128 v86, v[52:55] offset:30208
    ds_write_b128 v87, v[56:59] offset:30208
    ds_write_b128 v88, v[60:63] offset:30208
    s_branch L_pg_join
L_pg_lo:
    s_waitcnt lgkmcnt(0)
    s_barrier
    v_bfe_u32 v2, v1, 2, 1
    v_lshrrev_b32 v3, 5, v1
    v_bfe_u32 v4, v1, 2, 2
    v_and_b32 v5, 3, v1
    s_and_b32 s43, s3, 1
    s_lshl_b32 s43, s43, 2
    v_bfe_u32 v6, v1, 3, 2
    v_add_u32 v6, s43, v6
    v_lshl_add_u32 v7, v6, 2, v5
    v_lshl_add_u32 v7, v7, 1, v2
    s_lshr_b32 s42, s3, 1
    s_mul_i32 s42, s42, 80
    s_add_u32 s42, s42, 61440
    v_mul_u32_u24 v94, 40, v3
    v_add_u32 v94, s42, v94
    v_mul_u32_u24 v8, 496, v7
    v_add_u32 v8, v94, v8
    v_bfe_u32 v9, v1, 4, 1
    v_lshl_add_u32 v9, v9, 1, s43
    v_bfe_u32 v2, v1, 1, 1
    v_add_u32 v9, v9, v2
    v_lshl_add_u32 v9, v9, 2, v4
    v_and_b32 v2, 1, v1
    v_lshl_add_u32 v9, v9, 1, v2
    v_mul_u32_u24 v9, 496, v9
    v_add_u32 v9, v94, v9
    v_mul_u32_u24 v2, 40, v3
    v_lshl_add_u32 v9, v3, 3, v9
    v_sub_u32 v94, v9, v2
    ds_read_b64 v[16:17], v8 offset:7936
    ds_read_b64 v[18:19], v8 offset:7944
    ds_read_b64 v[20:21], v8 offset:7952
    ds_read_b64 v[22:23], v8 offset:7960
    ds_read_b64 v[24:25], v8 offset:7968
    ds_read_b64 v[36:37], v8 offset:4128
    ds_read_b64 v[38:39], v8 offset:4136
    ds_read_b64 v[40:41], v8 offset:4144
    ds_read_b64 v[42:43], v8 offset:4152
    ds_read_b64 v[44:45], v8 offset:4160
    ds_read_b64 v[26:27], v8 offset:8096
    ds_read_b64 v[28:29], v8 offset:8104
    ds_read_b64 v[30:31], v8 offset:8112
    ds_read_b64 v[32:33], v8 offset:8120
    ds_read_b64 v[34:35], v8 offset:8128
    s_waitcnt lgkmcnt(10)
    ds_read_b64 v[46:47], v8 offset:160
    ds_read_b64 v[48:49], v8 offset:168
    ds_read_b64 v[50:51], v8 offset:176
    ds_read_b64 v[52:53], v8 offset:184
    ds_read_b64 v[54:55], v8 offset:192
    s_mul_i32 s42, s4, 10
    s_lshr_b32 s43, s3, 1
    s_mul_i32 s43, s43, 5
    s_add_u32 s42, s42, s43
    s_lshl_b32 s42, s42, 8
    s_mul_i32 s43, s5, 81920
    s_add_u32 s42, s42, s43
    s_add_u32 s42, s42, s41
    s_add_u32 s42, s42, 4194304
    v_mul_u32_u24 v4, 768, v3
    v_lshrrev_b32 v2, 4, v7
    v_mul_u32_u24 v2, 20480, v2
    v_and_b32 v3, 15, v7
    v_lshl_add_u32 v2, v3, 4, v2
    v_add_u32 v2, v2, v4
    v_add_u32 v2, s42, v2
    v_cmp_le_u32 s[44:45], 1, v5
    v_cmp_le_u32 s[46:47], 2, v5
    v_cmp_le_u32 s[48:49], 3, v5
    v_mov_b32 v3, 0xffff
    v_cndmask_b32 v4, 0, v3, s[46:47]
    v_cndmask_b32 v3, v3, -1, s[44:45]
    v_cndmask_b32 v4, v4, -1, s[48:49]
    s_waitcnt lgkmcnt(5)
    v_mfma_f32_4x4x4_16b_bf16 v[60:63], v[36:37], v[16:17], 0
    v_mfma_f32_4x4x4_16b_bf16 v[56:59], v[26:27], v[16:17], 0
    s_nop 0
    v_mfma_f32_4x4x4_16b_bf16 v[60:63], v[38:39], v[18:19], v[60:63]
    v_mfma_f32_4x4x4_16b_bf16 v[56:59], v[28:29], v[18:19], v[56:59]
    s_nop 0
    v_mfma_f32_4x4x4_16b_bf16 v[60:63], v[40:41], v[20:21], v[60:63]
    v_mfma_f32_4x4x4_16b_bf16 v[56:59], v[30:31], v[20:21], v[56:59]
    s_nop 0
    v_mfma_f32_4x4x4_16b_bf16 v[60:63], v[42:43], v[22:23], v[60:63]
    v_mfma_f32_4x4x4_16b_bf16 v[56:59], v[32:33], v[22:23], v[56:59]
    s_nop 0
    v_mfma_f32_4x4x4_16b_bf16 v[60:63], v[44:45], v[24:25], v[60:63]
    v_mfma_f32_4x4x4_16b_bf16 v[56:59], v[34:35], v[24:25], v[56:59]
    s_waitcnt lgkmcnt(0)
    v_mfma_f32_4x4x4_16b_bf16 v[64:67], v[46:47], v[16:17], 0
    s_nop 1
    v_mfma_f32_4x4x4_16b_bf16 v[64:67], v[48:49], v[18:19], v[64:67]
    s_nop 1
    v_mfma_f32_4x4x4_16b_bf16 v[64:67], v[50:51], v[20:21], v[64:67]
    s_nop 1
    v_mfma_f32_4x4x4_16b_bf16 v[64:67], v[52:53], v[22:23], v[64:67]
    s_nop 1
    v_mfma_f32_4x4x4_16b_bf16 v[64:67], v[54:55], v[24:25], v[64:67]
    ds_read_b64_tr_b16 v[26:27], v9 offset:8256
    ds_read_b64_tr_b16 v[28:29], v9 offset:8264
    ds_read_b64_tr_b16 v[30:31], v9 offset:8272
    ds_read_b64_tr_b16 v[32:33], v9 offset:8280
    ds_read_b64_tr_b16 v[34:35], v94 offset:8288
    ds_read_b64_tr_b16 v[36:37], v9 offset:4288
    ds_read_b64_tr_b16 v[38:39], v9 offset:4296
    ds_read_b64_tr_b16 v[40:41], v9 offset:4304
    ds_read_b64_tr_b16 v[42:43], v9 offset:4312
    ds_read_b64_tr_b16 v[44:45], v94 offset:4320
    ds_read_b64_tr_b16 v[46:47], v9 offset:320
    ds_read_b64_tr_b16 v[48:49], v9 offset:328
    ds_read_b64_tr_b16 v[50:51], v9 offset:336
    ds_read_b64_tr_b16 v[52:53], v9 offset:344
    ds_read_b64_tr_b16 v[54:55], v94 offset:352
    s_cmp_lg_u32 s5, 0
    s_cbranch_scc1 L_at_nomask
    v_mov_b32 v88, 0xce6e6b28
    v_cmp_eq_u32 vcc, 0, v6
    v_cmp_ge_u32 s[50:51], 1, v6
    s_nop 0
    v_cndmask_b32 v60, v60, v88, vcc
    v_cndmask_b32 v61, v61, v88, vcc
    v_cndmask_b32 v62, v62, v88, vcc
    v_cndmask_b32 v63, v63, v88, vcc
    v_cndmask_b32 v65, v65, v88, s[50:51]
    v_cndmask_b32 v66, v66, v88, s[50:51]
    v_cndmask_b32 v67, v67, v88, s[50:51]
L_at_nomask:
    v_cndmask_b32 v57, v65, v57, s[44:45]
    v_cndmask_b32 v58, v66, v58, s[46:47]
    v_cndmask_b32 v59, v67, v59, s[48:49]
    v_cvt_pk_bf16_f32 v88, v56, v57
    v_cvt_pk_bf16_f32 v89, v58, v59
    v_cvt_pk_bf16_f32 v90, v60, v61
    v_cvt_pk_bf16_f32 v91, v62, v63
    v_lshlrev_b32 v56, 16, v88
    v_and_b32 v57, 0xffff0000, v88
    v_lshlrev_b32 v58, 16, v89
    v_and_b32 v59, 0xffff0000, v89
    v_lshlrev_b32 v60, 16, v90
    v_and_b32 v61, 0xffff0000, v90
    v_lshlrev_b32 v62, 16, v91
    v_and_b32 v63, 0xffff0000, v91
    s_mov_b32 s50, 1046804782
    s_mov_b32 s51, 1046804782
    v_pk_mul_f32 v[56:57], v[56:57], s[50:51]
    v_pk_mul_f32 v[58:59], v[58:59], s[50:51]
    v_pk_mul_f32 v[60:61], v[60:61], s[50:51]
    v_pk_mul_f32 v[62:63], v[62:63], s[50:51]
    v_cvt_pk_bf16_f32 v88, v56, v57
    v_cvt_pk_bf16_f32 v89, v58, v59
    v_cvt_pk_bf16_f32 v90, v60, v61
    v_cvt_pk_bf16_f32 v91, v62, v63
    v_lshlrev_b32 v56, 16, v88
    v_and_b32 v57, 0xffff0000, v88
    v_lshlrev_b32 v58, 16, v89
    v_and_b32 v59, 0xffff0000, v89
    v_lshlrev_b32 v60, 16, v90
    v_and_b32 v61, 0xffff0000, v90
    v_lshlrev_b32 v62, 16, v91
    v_and_b32 v63, 0xffff0000, v91
    v_max3_f32 v88, v56, v57, v58
    v_max3_f32 v89, v59, v60, v61
    v_max3_f32 v88, v88, v62, v63
    v_max_f32 v88, v88, v89
    s_mov_b32 s50, 1069066811
    s_mov_b32 s51, 1069066811
    v_mov_b32 v89, v88
    v_pk_add_f32 v[56:57], v[56:57], v[88:89] neg_lo:[0,1] neg_hi:[0,1]
    v_pk_add_f32 v[58:59], v[58:59], v[88:89] neg_lo:[0,1] neg_hi:[0,1]
    v_pk_add_f32 v[60:61], v[60:61], v[88:89] neg_lo:[0,1] neg_hi:[0,1]
    v_pk_add_f32 v[62:63], v[62:63], v[88:89] neg_lo:[0,1] neg_hi:[0,1]
    v_pk_mul_f32 v[56:57], v[56:57], s[50:51]
    v_pk_mul_f32 v[58:59], v[58:59], s[50:51]
    v_pk_mul_f32 v[60:61], v[60:61], s[50:51]
    v_pk_mul_f32 v[62:63], v[62:63], s[50:51]
    v_exp_f32 v56, v56
    v_exp_f32 v57, v57
    v_exp_f32 v58, v58
    v_exp_f32 v59, v59
    v_exp_f32 v60, v60
    v_exp_f32 v61, v61
    v_exp_f32 v62, v62
    v_exp_f32 v63, v63
    v_add_f32 v88, v56, v57
    v_add_f32 v89, v58, v59
    v_add_f32 v90, v60, v61
    v_add_f32 v91, v62, v63
    v_add_f32 v88, v88, v89
    v_add_f32 v90, v90, v91
    v_add_f32 v88, v88, v90
    v_rcp_f32 v88, v88
    s_nop 0
    v_mul_f32 v56, v56, v88
    v_mul_f32 v57, v57, v88
    v_mul_f32 v58, v58, v88
    v_mul_f32 v59, v59, v88
    v_mul_f32 v60, v60, v88
    v_mul_f32 v61, v61, v88
    v_mul_f32 v62, v62, v88
    v_mul_f32 v63, v63, v88
    v_cvt_pk_bf16_f32 v92, v56, v57
    v_cvt_pk_bf16_f32 v93, v58, v59
    v_cvt_pk_bf16_f32 v90, v60, v61
    v_cvt_pk_bf16_f32 v91, v62, v63
    v_and_b32 v88, v3, v92
    v_and_b32 v89, v4, v93
    v_xor_b32 v92, v88, v92
    v_xor_b32 v93, v89, v93
    s_waitcnt lgkmcnt(0)
    v_mfma_f32_4x4x4_16b_bf16 v[68:71], v[36:37], v[90:91], 0
    v_mfma_f32_4x4x4_16b_bf16 v[72:75], v[38:39], v[90:91], 0
    v_mfma_f32_4x4x4_16b_bf16 v[76:79], v[40:41], v[90:91], 0
    v_mfma_f32_4x4x4_16b_bf16 v[80:83], v[42:43], v[90:91], 0
    v_mfma_f32_4x4x4_16b_bf16 v[84:87], v[44:45], v[90:91], 0
    v_mfma_f32_4x4x4_16b_bf16 v[68:71], v[26:27], v[88:89], v[68:71]
    v_mfma_f32_4x4x4_16b_bf16 v[72:75], v[28:29], v[88:89], v[72:75]
    v_mfma_f32_4x4x4_16b_bf16 v[76:79], v[30:31], v[88:89], v[76:79]
    v_mfma_f32_4x4x4_16b_bf16 v[80:83], v[32:33], v[88:89], v[80:83]
    v_mfma_f32_4x4x4_16b_bf16 v[84:87], v[34:35], v[88:89], v[84:87]
    v_mfma_f32_4x4x4_16b_bf16 v[68:71], v[46:47], v[92:93], v[68:71]
    v_mfma_f32_4x4x4_16b_bf16 v[72:75], v[48:49], v[92:93], v[72:75]
    v_mfma_f32_4x4x4_16b_bf16 v[76:79], v[50:51], v[92:93], v[76:79]
    v_mfma_f32_4x4x4_16b_bf16 v[80:83], v[52:53], v[92:93], v[80:83]
    v_mfma_f32_4x4x4_16b_bf16 v[84:87], v[54:55], v[92:93], v[84:87]
    s_nop 0
    v_cvt_pk_bf16_f32 v16, v68, v69
    v_cvt_pk_bf16_f32 v17, v70, v71
    v_cvt_pk_bf16_f32 v18, v72, v73
    v_cvt_pk_bf16_f32 v19, v74, v75
    v_cvt_pk_bf16_f32 v20, v76, v77
    v_cvt_pk_bf16_f32 v21, v78, v79
    v_cvt_pk_bf16_f32 v22, v80, v81
    v_cvt_pk_bf16_f32 v23, v82, v83
    v_cvt_pk_bf16_f32 v24, v84, v85
    v_cvt_pk_bf16_f32 v25, v86, v87
    global_store_dwordx4 v2, v[16:19], s[32:33] sc1
    global_store_dwordx4 v2, v[20:23], s[32:33] offset:256 sc1
    v_mov_b32 v26, v24
    v_mov_b32 v27, v25
    s_nop 0
    v_permlane32_swap_b32 v24, v26
    v_permlane32_swap_b32 v25, v27
    s_mov_b32 exec_hi, 0
    global_store_dwordx4 v2, v[24:27], s[32:33] offset:512 sc1
    s_mov_b64 exec, -1
    s_lshl_b32 s42, s7, 2
    s_add_u32 s42, s42, 45328
    s_waitcnt vmcnt(0)
    v_mov_b32 v2, s42
    v_mov_b32 v4, 1
    s_mov_b64 exec, 1
    ds_add_rtn_u32 v4, v2, v4
    s_waitcnt lgkmcnt(0)
    s_mov_b64 exec, -1
    v_readfirstlane_b32 s56, v4
    s_nop 1
    s_cmp_eq_u32 s56, 3
    s_nop 0
    s_cbranch_scc0 L_pg_np
    s_lshl_b32 s43, s5, 3
    s_add_u32 s43, s43, s4
    s_lshl_b32 s43, s43, 7
    s_add_u32 s43, s43, s40
    s_add_u32 s43, s43, 36864
    v_lshl_add_u32 v3, v1, 4, s43
    v_mov_b32 v4, s34
    v_mov_b32 v5, s35
    v_mov_b32 v6, s34
    v_mov_b32 v7, s35
    s_mov_b64 exec, 0xff
    global_store_dwordx4 v3, v[4:7], s[32:33] sc1
    s_mov_b64 exec, -1
    v_mov_b32 v3, 1
    s_mov_b64 exec, 1
    ds_add_u32 v2, v3
    s_mov_b64 exec, -1
L_pg_np:
    v_mov_b32 v2, s42
    s_mov_b32 s57, 0
L_sp12:
    ds_read_b32 v3, v2
    s_add_u32 s57, s57, 1
    s_waitcnt lgkmcnt(0)
    v_readfirstlane_b32 s56, v3
    s_cmp_gt_u32 s57, 2000000
    s_nop 2
    s_cbranch_scc1 L_end
    s_cmp_lt_u32 s56, 5
    s_cbranch_scc1 L_sp12
    s_sub_u32 s42, s3, 0
    s_mul_i32 s42, s42, 10240
    s_add_u32 s42, s42, 0
    s_mul_i32 s43, s4, 102400
    s_add_u32 s43, s43, s42
    s_add_u32 s43, s43, 14680064
    v_lshlrev_b32 v24, 4, v1
    s_add_u32 s44, s32, s43
    s_addc_u32 s45, s33, 0
    s_add_u32 m0, s42, 61440
    s_nop 0
    global_load_lds_dwordx4 v24, s[44:45] offset:0 sc1
    global_load_lds_dwordx4 v24, s[44:45] offset:1024 sc1
    global_load_lds_dwordx4 v24, s[44:45] offset:2048 sc1
    global_load_lds_dwordx4 v24, s[44:45] offset:3072 sc1
    s_add_u32 m0, s42, 65536
    s_add_u32 s44, s44, 4096
    s_addc_u32 s45, s45, 0
    global_load_lds_dwordx4 v24, s[44:45] offset:0 sc1
    global_load_lds_dwordx4 v24, s[44:45] offset:1024 sc1
    global_load_lds_dwordx4 v24, s[44:45] offset:2048 sc1
    global_load_lds_dwordx4 v24, s[44:45] offset:3072 sc1
    s_add_u32 m0, s42, 69632
    s_add_u32 s44, s44, 4096
    s_addc_u32 s45, s45, 0
    global_load_lds_dwordx4 v24, s[44:45] offset:0 sc1
    global_load_lds_dwordx4 v24, s[44:45] offset:1024 sc1
    s_cmp_eq_u32 s3, 0
    s_cbranch_scc0 L_pg_join
    s_lshl_b32 s42, s5, 10
    s_add_u32 s42, s42, s40
    s_add_u32 s42, s42, 36864
    v_and_b32 v2, 7, v1
    v_lshl_add_u32 v2, v2, 7, s42
    s_mov_b32 s57, 0
L_poll13:
    global_load_dwordx2 v[4:5], v2, s[32:33] sc1
    s_add_u32 s57, s57, 1
    s_waitcnt vmcnt(0)
    v_cmp_ne_u64 vcc, s[34:35], v[4:5]
    s_cmp_gt_u32 s57, 200000
    s_nop 2
    s_cbranch_scc1 L_end
    s_cbranch_vccnz L_poll13
L_pg_join:
    v_and_b32 v6, 15, v1
    v_lshrrev_b32 v7, 4, v1
    s_and_b32 s42, s3, 3
    s_lshr_b32 s43, s3, 2
    s_lshl_b32 s44, s5, 2
    s_add_u32 s44, s44, s42
    s_mul_i32 s44, s44, 20480
    s_mul_i32 s45, s43, 10240
    s_add_u32 s44, s44, s45
    s_add_u32 s44, s44, s41
    s_add_u32 s44, s44, 4194304
    v_lshl_add_u32 v2, v1, 4, s44
    v_add_u32 v3, 4096, v2
    v_add_u32 v4, 8192, v2
    s_mul_i32 s45, s43, 51200
    s_add_u32 s45, s45, 61440
    v_lshrrev_b32 v5, 2, v1
    v_mul_u32_u24 v5, 160, v5
    v_and_b32 v8, 3, v1
    v_lshl_add_u32 v5, v8, 3, v5
    v_add_u32 v5, s45, v5
    s_waitcnt vmcnt(0) lgkmcnt(0)
    s_barrier
    global_load_dwordx4 v[16:19], v2, s[32:33] offset:0 sc1
    global_load_dwordx4 v[20:23], v2, s[32:33] offset:1024 sc1
    global_load_dwordx4 v[24:27], v2, s[32:33] offset:2048 sc1
    global_load_dwordx4 v[28:31], v2, s[32:33] offset:3072 sc1
    global_load_dwordx4 v[32:35], v3, s[32:33] offset:0 sc1
    global_load_dwordx4 v[36:39], v3, s[32:33] offset:1024 sc1
    global_load_dwordx4 v[40:43], v3, s[32:33] offset:2048 sc1
    global_load_dwordx4 v[44:47], v3, s[32:33] offset:3072 sc1
    global_load_dwordx4 v[48:51], v4, s[32:33] offset:0 sc1
    global_load_dwordx4 v[52:55], v4, s[32:33] offset:1024 sc1
    ds_read_b64_tr_b16 v[76:77], v5 offset:0
    ds_read_b64_tr_b16 v[78:79], v5 offset:2560
    ds_read_b64_tr_b16 v[80:81], v5 offset:32
    ds_read_b64_tr_b16 v[82:83], v5 offset:2592
    ds_read_b64_tr_b16 v[84:85], v5 offset:64
    ds_read_b64_tr_b16 v[86:87], v5 offset:2624
    ds_read_b64_tr_b16 v[88:89], v5 offset:96
    ds_read_b64_tr_b16 v[90:91], v5 offset:2656
    ds_read_b64_tr_b16 v[92:93], v5 offset:128
    ds_read_b64_tr_b16 v[94:95], v5 offset:2688
    s_mul_i32 s44, s42, 5120
    s_add_u32 s44, s44, 61440
    v_lshl_add_u32 v2, v1, 4, s44
    s_mul_i32 s44, s43, 6912
    s_lshl_b32 s45, s42, 5
    s_add_u32 s44, s44, s45
    s_add_u32 s44, s44, 118784
    v_mul_u32_u24 v3, 144, v6
    v_lshl_add_u32 v3, v7, 3, v3
    v_add_u32 v3, s44, v3
    s_mul_i32 s44, s7, 16384
    s_lshl_b32 s45, s5, 9
    s_add_u32 s44, s44, s45
    s_lshl_b32 s45, s42, 7
    s_add_u32 s44, s44, s45
    s_add_u32 s44, s44, 393216
    v_lshl_add_u32 v9, v7, 2, v8
    v_lshl_add_u32 v9, v9, 3, s44
    v_and_b32 v8, 4, v1
    v_add_u32 v9, v9, v8
    v_cmp_eq_u32 s[50:51], 0, v8
    v_and_b32 v8, 1, v1
    v_cmp_eq_u32 s[46:47], 0, v8
    v_and_b32 v8, 2, v1
    v_cmp_eq_u32 s[48:49], 0, v8
    s_waitcnt vmcnt(9) lgkmcnt(6)
    v_mfma_f32_16x16x32_bf16 v[56:59], v[16:19], v[76:79], 0
    ds_read_b64_tr_b16 v[76:77], v5 offset:5120
    ds_read_b64_tr_b16 v[78:79], v5 offset:7680
    v_mfma_f32_16x16x32_bf16 v[60:63], v[16:19], v[80:83], 0
    ds_read_b64_tr_b16 v[80:81], v5 offset:5152
    ds_read_b64_tr_b16 v[82:83], v5 offset:7712
    s_waitcnt lgkmcnt(6)
    v_mfma_f32_16x16x32_bf16 v[64:67], v[16:19], v[84:87], 0
    ds_read_b64_tr_b16 v[84:85], v5 offset:5184
    ds_read_b64_tr_b16 v[86:87], v5 offset:7744
    v_mfma_f32_16x16x32_bf16 v[68:71], v[16:19], v[88:91], 0
    ds_read_b64_tr_b16 v[88:89], v5 offset:5216
    ds_read_b64_tr_b16 v[90:91], v5 offset:7776
    s_waitcnt lgkmcnt(6)
    v_mfma_f32_16x16x32_bf16 v[72:75], v[16:19], v[92:95], 0
    ds_read_b64_tr_b16 v[92:93], v5 offset:5248
    ds_read_b64_tr_b16 v[94:95], v5 offset:7808
    ds_read_b64_tr_b16 v[16:17], v5 offset:10240
    s_waitcnt vmcnt(8)
    v_mfma_f32_16x16x32_bf16 v[56:59], v[20:23], v[76:79], v[56:59]
    ds_read_b64_tr_b16 v[18:19], v5 offset:12800
    ds_read_b64_tr_b16 v[76:77], v5 offset:10272
    ds_read_b64_tr_b16 v[78:79], v5 offset:12832
    s_waitcnt lgkmcnt(8)
    v_mfma_f32_16x16x32_bf16 v[60:63], v[20:23], v[80:83], v[60:63]
    ds_read_b64_tr_b16 v[80:81], v5 offset:10304
    ds_read_b64_tr_b16 v[82:83], v5 offset:12864
    v_mfma_f32_16x16x32_bf16 v[64:67], v[20:23], v[84:87], v[64:67]
    ds_read_b64_tr_b16 v[84:85], v5 offset:10336
    ds_read_b64_tr_b16 v[86:87], v5 offset:12896
    s_waitcnt lgkmcnt(8)
    v_mfma_f32_16x16x32_bf16 v[68:71], v[20:23], v[88:91], v[68:71]
    ds_read_b64_tr_b16 v[88:89], v5 offset:10368
    ds_read_b64_tr_b16 v[90:91], v5 offset:12928
    v_mfma_f32_16x16x32_bf16 v[72:75], v[20:23], v[92:95], v[72:75]
    ds_read_b64_tr_b16 v[92:93], v5 offset:15360
    ds_read_b64_tr_b16 v[94:95], v5 offset:17920
    ds_read_b64_tr_b16 v[20:21], v5 offset:15392
    s_waitcnt vmcnt(7) lgkmcnt(9)
    v_mfma_f32_16x16x32_bf16 v[56:59], v[24:27], v[16:19], v[56:59]
    ds_read_b64_tr_b16 v[22:23], v5 offset:17952
    ds_read_b64_tr_b16 v[16:17], v5 offset:15424
    ds_read_b64_tr_b16 v[18:19], v5 offset:17984
    v_mfma_f32_16x16x32_bf16 v[60:63], v[24:27], v[76:79], v[60:63]
    ds_read_b64_tr_b16 v[76:77], v5 offset:15456
    ds_read_b64_tr_b16 v[78:79], v5 offset:18016
    s_waitcnt lgkmcnt(10)
    v_mfma_f32_16x16x32_bf16 v[64:67], v[24:27], v[80:83], v[64:67]
    ds_read_b64_tr_b16 v[80:81], v5 offset:15488
    ds_read_b64_tr_b16 v[82:83], v5 offset:18048
    v_mfma_f32_16x16x32_bf16 v[68:71], v[24:27], v[84:87], v[68:71]
    ds_read_b64_tr_b16 v[84:85], v5 offset:20480
    ds_read_b64_tr_b16 v[86:87], v5 offset:23040
    s_waitcnt lgkmcnt(10)
    v_mfma_f32_16x16x32_bf16 v[72:75], v[24:27], v[88:91], v[72:75]
    ds_read_b64_tr_b16 v[88:89], v5 offset:20512
    ds_read_b64_tr_b16 v[90:91], v5 offset:23072
    s_waitcnt vmcnt(6)
    v_mfma_f32_16x16x32_bf16 v[56:59], v[28:31], v[92:95], v[56:59]
    ds_read_b64_tr_b16 v[24:25], v5 offset:20544
    ds_read_b64_tr_b16 v[26:27], v5 offset:23104
    s_waitcnt lgkmcnt(10)
    v_mfma_f32_16x16x32_bf16 v[60:63], v[28:31], v[20:23], v[60:63]
    ds_read_b64_tr_b16 v[92:93], v5 offset:20576
    ds_read_b64_tr_b16 v[94:95], v5 offset:23136
    v_mfma_f32_16x16x32_bf16 v[64:67], v[28:31], v[16:19], v[64:67]
    ds_read_b64_tr_b16 v[20:21], v5 offset:20608
    ds_read_b64_tr_b16 v[22:23], v5 offset:23168
    s_waitcnt lgkmcnt(10)
    v_mfma_f32_16x16x32_bf16 v[68:71], v[28:31], v[76:79], v[68:71]
    ds_read_b64_tr_b16 v[16:17], v5 offset:25600
    ds_read_b64_tr_b16 v[18:19], v5 offset:28160
    v_mfma_f32_16x16x32_bf16 v[72:75], v[28:31], v[80:83], v[72:75]
    ds_read_b64_tr_b16 v[76:77], v5 offset:25632
    ds_read_b64_tr_b16 v[78:79], v5 offset:28192
    s_waitcnt vmcnt(5) lgkmcnt(10)
    v_mfma_f32_16x16x32_bf16 v[56:59], v[32:35], v[84:87], v[56:59]
    ds_read_b64_tr_b16 v[80:81], v5 offset:25664
    ds_read_b64_tr_b16 v[82:83], v5 offset:28224
    v_mfma_f32_16x16x32_bf16 v[60:63], v[32:35], v[88:91], v[60:63]
    ds_read_b64_tr_b16 v[28:29], v5 offset:25696
    ds_read_b64_tr_b16 v[30:31], v5 offset:28256
    s_waitcnt lgkmcnt(10)
    v_mfma_f32_16x16x32_bf16 v[64:67], v[32:35], v[24:27], v[64:67]
    ds_read_b64_tr_b16 v[84:85], v5 offset:25728
    ds_read_b64_tr_b16 v[86:87], v5 offset:28288
    v_mfma_f32_16x16x32_bf16 v[68:71], v[32:35], v[92:95], v[68:71]
    ds_read_b64_tr_b16 v[88:89], v5 offset:30720
    ds_read_b64_tr_b16 v[90:91], v5 offset:33280
    s_waitcnt lgkmcnt(10)
    v_mfma_f32_16x16x32_bf16 v[72:75], v[32:35], v[20:23], v[72:75]
    ds_read_b64_tr_b16 v[24:25], v5 offset:30752
    ds_read_b64_tr_b16 v[26:27], v5 offset:33312
    s_waitcnt vmcnt(4)
    v_mfma_f32_16x16x32_bf16 v[56:59], v[36:39], v[16:19], v[56:59]
    ds_read_b64_tr_b16 v[92:93], v5 offset:30784
    ds_read_b64_tr_b16 v[94:95], v5 offset:33344
    s_waitcnt lgkmcnt(10)
    v_mfma_f32_16x16x32_bf16 v[60:63], v[36:39], v[76:79], v[60:63]
    ds_read_b64_tr_b16 v[20:21], v5 offset:30816
    ds_read_b64_tr_b16 v[22:23], v5 offset:33376
    v_mfma_f32_16x16x32_bf16 v[64:67], v[36:39], v[80:83], v[64:67]
    ds_read_b64_tr_b16 v[32:33], v5 offset:30848
    ds_read_b64_tr_b16 v[34:35], v5 offset:33408
    s_waitcnt lgkmcnt(10)
    v_mfma_f32_16x16x32_bf16 v[68:71], v[36:39], v[28:31], v[68:71]
    ds_read_b64_tr_b16 v[16:17], v5 offset:35840
    ds_read_b64_tr_b16 v[18:19], v5 offset:38400
    v_mfma_f32_16x16x32_bf16 v[72:75], v[36:39], v[84:87], v[72:75]
    ds_read_b64_tr_b16 v[76:77], v5 offset:35872
    ds_read_b64_tr_b16 v[78:79], v5 offset:38432
    s_waitcnt vmcnt(3) lgkmcnt(10)
    v_mfma_f32_16x16x32_bf16 v[56:59], v[40:43], v[88:91], v[56:59]
    ds_read_b64_tr_b16 v[80:81], v5 offset:35904
    ds_read_b64_tr_b16 v[82:83], v5 offset:38464
    v_mfma_f32_16x16x32_bf16 v[60:63], v[40:43], v[24:27], v[60:63]
    ds_read_b64_tr_b16 v[28:29], v5 offset:35936
    ds_read_b64_tr_b16 v[30:31], v5 offset:38496
    s_waitcnt lgkmcnt(10)
    v_mfma_f32_16x16x32_bf16 v[64:67], v[40:43], v[92:95], v[64:67]
    ds_read_b64_tr_b16 v[84:85], v5 offset:35968
    ds_read_b64_tr_b16 v[86:87], v5 offset:38528
    v_mfma_f32_16x16x32_bf16 v[68:71], v[40:43], v[20:23], v[68:71]
    ds_read_b64_tr_b16 v[36:37], v5 offset:40960
    ds_read_b64_tr_b16 v[38:39], v5 offset:43520
    s_waitcnt lgkmcnt(10)
    v_mfma_f32_16x16x32_bf16 v[72:75], v[40:43], v[32:35], v[72:75]
    ds_read_b64_tr_b16 v[88:89], v5 offset:40992
    ds_read_b64_tr_b16 v[90:91], v5 offset:43552
    s_waitcnt vmcnt(2)
    v_mfma_f32_16x16x32_bf16 v[56:59], v[44:47], v[16:19], v[56:59]
    ds_read_b64_tr_b16 v[24:25], v5 offset:41024
    ds_read_b64_tr_b16 v[26:27], v5 offset:43584
    s_waitcnt lgkmcnt(10)
    v_mfma_f32_16x16x32_bf16 v[60:63], v[44:47], v[76:79], v[60:63]
    ds_read_b64_tr_b16 v[92:93], v5 offset:41056
    ds_read_b64_tr_b16 v[94:95], v5 offset:43616
    v_mfma_f32_16x16x32_bf16 v[64:67], v[44:47], v[80:83], v[64:67]
    ds_read_b64_tr_b16 v[20:21], v5 offset:41088
    ds_read_b64_tr_b16 v[22:23], v5 offset:43648
    s_waitcnt lgkmcnt(10)
    v_mfma_f32_16x16x32_bf16 v[68:71], v[44:47], v[28:31], v[68:71]
    ds_read_b64_tr_b16 v[32:33], v5 offset:46080
    ds_read_b64_tr_b16 v[34:35], v5 offset:48640
    v_mfma_f32_16x16x32_bf16 v[72:75], v[44:47], v[84:87], v[72:75]
    ds_read_b64_tr_b16 v[40:41], v5 offset:46112
    ds_read_b64_tr_b16 v[42:43], v5 offset:48672
    s_waitcnt vmcnt(1) lgkmcnt(10)
    v_mfma_f32_16x16x32_bf16 v[56:59], v[48:51], v[36:39], v[56:59]
    ds_read_b64_tr_b16 v[16:17], v5 offset:46144
    ds_read_b64_tr_b16 v[18:19], v5 offset:48704
    v_mfma_f32_16x16x32_bf16 v[60:63], v[48:51], v[88:91], v[60:63]
    ds_read_b64_tr_b16 v[76:77], v5 offset:46176
    ds_read_b64_tr_b16 v[78:79], v5 offset:48736
    s_waitcnt lgkmcnt(10)
    v_mfma_f32_16x16x32_bf16 v[64:67], v[48:51], v[24:27], v[64:67]
    ds_read_b64_tr_b16 v[80:81], v5 offset:46208
    ds_read_b64_tr_b16 v[82:83], v5 offset:48768
    v_mfma_f32_16x16x32_bf16 v[68:71], v[48:51], v[92:95], v[68:71]
    s_waitcnt lgkmcnt(8)
    v_mfma_f32_16x16x32_bf16 v[72:75], v[48:51], v[20:23], v[72:75]
    s_waitcnt vmcnt(0)
    v_mfma_f32_16x16x32_bf16 v[56:59], v[52:55], v[32:35], v[56:59]
    s_waitcnt lgkmcnt(4)
    v_mfma_f32_16x16x32_bf16 v[60:63], v[52:55], v[40:43], v[60:63]
    v_mfma_f32_16x16x32_bf16 v[64:67], v[52:55], v[16:19], v[64:67]
    s_waitcnt lgkmcnt(2)
    v_mfma_f32_16x16x32_bf16 v[68:71], v[52:55], v[76:79], v[68:71]
    s_waitcnt lgkmcnt(0)
    v_mfma_f32_16x16x32_bf16 v[72:75], v[52:55], v[80:83], v[72:75]
    s_barrier
    s_cmp_ge_u32 s3, 4
    s_nop 4
    s_cbranch_scc1 L_a2_k1
    ds_write_b128 v2, v[68:71] offset:3072
    ds_write_b128 v2, v[72:75] offset:4096
    s_waitcnt lgkmcnt(0)
    s_barrier
    ds_read_b128 v[16:19], v2 offset:0
    ds_read_b128 v[20:23], v2 offset:1024
    ds_read_b128 v[24:27], v2 offset:2048
    v_lshlrev_b32 v28, 16, v10
    v_and_b32 v29, 0xffff0000, v10
    v_lshlrev_b32 v30, 16, v11
    v_and_b32 v31, 0xffff0000, v11
    v_lshlrev_b32 v32, 16, v12
    v_and_b32 v33, 0xffff0000, v12
    v_lshlrev_b32 v34, 16, v13
    v_and_b32 v35, 0xffff0000, v13
    v_lshlrev_b32 v36, 16, v14
    v_and_b32 v37, 0xffff0000, v14
    v_lshlrev_b32 v38, 16, v15
    v_and_b32 v39, 0xffff0000, v15
    s_waitcnt lgkmcnt(0)
    v_add_f32 v16, v16, v56
    v_add_f32 v17, v17, v57
    v_add_f32 v18, v18, v58
    v_add_f32 v19, v19, v59
    v_add_f32 v20, v20, v60
    v_add_f32 v21, v21, v61
    v_add_f32 v22, v22, v62
    v_add_f32 v23, v23, v63
    v_add_f32 v24, v24, v64
    v_add_f32 v25, v25, v65
    v_add_f32 v26, v26, v66
    v_add_f32 v27, v27, v67
    v_cvt_pk_bf16_f32 v40, v16, v17
    v_cvt_pk_bf16_f32 v41, v18, v19
    v_cvt_pk_bf16_f32 v42, v20, v21
    v_cvt_pk_bf16_f32 v43, v22, v23
    v_cvt_pk_bf16_f32 v44, v24, v25
    v_cvt_pk_bf16_f32 v45, v26, v27
    v_lshlrev_b32 v16, 16, v40
    v_and_b32 v17, 0xffff0000, v40
    v_lshlrev_b32 v18, 16, v41
    v_and_b32 v19, 0xffff0000, v41
    v_lshlrev_b32 v20, 16, v42
    v_and_b32 v21, 0xffff0000, v42
    v_lshlrev_b32 v22, 16, v43
    v_and_b32 v23, 0xffff0000, v43
    v_lshlrev_b32 v24, 16, v44
    v_and_b32 v25, 0xffff0000, v44
    v_lshlrev_b32 v26, 16, v45
    v_and_b32 v27, 0xffff0000, v45
    v_add_f32 v28, v28, v16
    v_add_f32 v29, v29, v17
    v_add_f32 v30, v30, v18
    v_add_f32 v31, v31, v19
    v_add_f32 v32, v32, v20
    v_add_f32 v33, v33, v21
    v_add_f32 v34, v34, v22
    v_add_f32 v35, v35, v23
    v_add_f32 v36, v36, v24
    v_add_f32 v37, v37, v25
    v_add_f32 v38, v38, v26
    v_add_f32 v39, v39, v27
    v_cvt_pk_bf16_f32 v40, v28, v29
    v_cvt_pk_bf16_f32 v41, v30, v31
    v_cvt_pk_bf16_f32 v42, v32, v33
    v_cvt_pk_bf16_f32 v43, v34, v35
    v_cvt_pk_bf16_f32 v44, v36, v37
    v_cvt_pk_bf16_f32 v45, v38, v39
    ds_write_b64 v3, v[40:41] offset:0
    ds_write_b64 v3, v[42:43] offset:2304
    ds_write_b64 v3, v[44:45] offset:4608
    v_lshlrev_b32 v28, 16, v40
    v_and_b32 v29, 0xffff0000, v40
    v_lshlrev_b32 v30, 16, v41
    v_and_b32 v31, 0xffff0000, v41
    v_lshlrev_b32 v32, 16, v42
    v_and_b32 v33, 0xffff0000, v42
    v_lshlrev_b32 v34, 16, v43
    v_and_b32 v35, 0xffff0000, v43
    v_lshlrev_b32 v36, 16, v44
    v_and_b32 v37, 0xffff0000, v44
    v_lshlrev_b32 v38, 16, v45
    v_and_b32 v39, 0xffff0000, v45
    v_add_f32 v56, v28, v32
    v_mul_f32 v60, v28, v28
    v_add_f32 v57, v29, v33
    v_mul_f32 v61, v29, v29
    v_add_f32 v58, v30, v34
    v_mul_f32 v62, v30, v30
    v_add_f32 v59, v31, v35
    v_mul_f32 v63, v31, v31
    v_fmac_f32 v60, v32, v32
    v_fmac_f32 v61, v33, v33
    v_fmac_f32 v62, v34, v34
    v_fmac_f32 v63, v35, v35
    v_add_f32 v56, v56, v36
    v_fmac_f32 v60, v36, v36
    v_add_f32 v57, v57, v37
    v_fmac_f32 v61, v37, v37
    v_add_f32 v58, v58, v38
    v_fmac_f32 v62, v38, v38
    v_add_f32 v59, v59, v39
    v_fmac_f32 v63, v39, v39
    v_cndmask_b32 v64, v57, v56, s[46:47]
    v_cndmask_b32 v68, v56, v57, s[46:47]
    v_cndmask_b32 v65, v61, v60, s[46:47]
    v_cndmask_b32 v69, v60, v61, s[46:47]
    v_cndmask_b32 v66, v59, v58, s[46:47]
    v_cndmask_b32 v70, v58, v59, s[46:47]
    v_cndmask_b32 v67, v63, v62, s[46:47]
    v_cndmask_b32 v71, v62, v63, s[46:47]
    v_add_f32_dpp v64, v68, v64 quad_perm:[1,0,3,2] row_mask:0xf bank_mask:0xf
    v_add_f32_dpp v65, v69, v65 quad_perm:[1,0,3,2] row_mask:0xf bank_mask:0xf
    v_add_f32_dpp v66, v70, v66 quad_perm:[1,0,3,2] row_mask:0xf bank_mask:0xf
    v_add_f32_dpp v67, v71, v67 quad_perm:[1,0,3,2] row_mask:0xf bank_mask:0xf
    v_cndmask_b32 v68, v64, v66, s[48:49]
    v_cndmask_b32 v64, v66, v64, s[48:49]
    v_cndmask_b32 v69, v65, v67, s[48:49]
    v_cndmask_b32 v65, v67, v65, s[48:49]
    v_add_f32_dpp v64, v68, v64 quad_perm:[2,3,0,1] row_mask:0xf bank_mask:0xf
    s_nop 0
    v_add_f32_dpp v65, v69, v65 quad_perm:[2,3,0,1] row_mask:0xf bank_mask:0xf
    v_add_f32_dpp v64, v64, v64 row_ror:4 row_mask:0xf bank_mask:0xf
    s_nop 0
    v_add_f32_dpp v65, v65, v65 row_ror:4 row_mask:0xf bank_mask:0xf
    v_add_f32_dpp v64, v64, v64 row_ror:8 row_mask:0xf bank_mask:0xf
    s_nop 0
    v_add_f32_dpp v65, v65, v65 row_ror:8 row_mask:0xf bank_mask:0xf
    v_cndmask_b32 v64, v65, v64, s[50:51]
    s_mov_b32 exec_lo, 0x00ff00ff
    s_mov_b32 exec_hi, 0x00ff00ff
    global_atomic_add_f32 v9, v64, s[32:33]
    s_mov_b64 exec, -1
    s_branch L_a2_done
L_a2_k1:
    ds_write_b128 v2, v[56:59] offset:0
    ds_write_b128 v2, v[60:63] offset:1024
    ds_write_b128 v2, v[64:67] offset:2048
    s_waitcnt lgkmcnt(0)
    s_barrier
    ds_read_b128 v[16:19], v2 offset:3072
    ds_read_b128 v[20:23], v2 offset:4096
    v_lshlrev_b32 v28, 16, v10
    v_and_b32 v29, 0xffff0000, v10
    v_lshlrev_b32 v30, 16, v11
    v_and_b32 v31, 0xffff0000, v11
    v_lshlrev_b32 v32, 16, v12
    v_and_b32 v33, 0xffff0000, v12
    v_lshlrev_b32 v34, 16, v13
    v_and_b32 v35, 0xffff0000, v13
    s_waitcnt lgkmcnt(0)
    v_add_f32 v16, v16, v68
    v_add_f32 v17, v17, v69
    v_add_f32 v18, v18, v70
    v_add_f32 v19, v19, v71
    v_add_f32 v20, v20, v72
    v_add_f32 v21, v21, v73
    v_add_f32 v22, v22, v74
    v_add_f32 v23, v23, v75
    v_cvt_pk_bf16_f32 v40, v16, v17
    v_cvt_pk_bf16_f32 v41, v18, v19
    v_cvt_pk_bf16_f32 v42, v20, v21
    v_cvt_pk_bf16_f32 v43, v22, v23
    v_lshlrev_b32 v16, 16, v40
    v_and_b32 v17, 0xffff0000, v40
    v_lshlrev_b32 v18, 16, v41
    v_and_b32 v19, 0xffff0000, v41
    v_lshlrev_b32 v20, 16, v42
    v_and_b32 v21, 0xffff0000, v42
    v_lshlrev_b32 v22, 16, v43
    v_and_b32 v23, 0xffff0000, v43
    v_add_f32 v28, v28, v16
    v_add_f32 v29, v29, v17
    v_add_f32 v30, v30, v18
    v_add_f32 v31, v31, v19
    v_add_f32 v32, v32, v20
    v_add_f32 v33, v33, v21
    v_add_f32 v34, v34, v22
    v_add_f32 v35, v35, v23
    v_cvt_pk_bf16_f32 v40, v28, v29
    v_cvt_pk_bf16_f32 v41, v30, v31
    v_cvt_pk_bf16_f32 v42, v32, v33
    v_cvt_pk_bf16_f32 v43, v34, v35
    ds_write_b64 v3, v[40:41] offset:0
    ds_write_b64 v3, v[42:43] offset:2304
    v_lshlrev_b32 v28, 16, v40
    v_and_b32 v29, 0xffff0000, v40
    v_lshlrev_b32 v30, 16, v41
    v_and_b32 v31, 0xffff0000, v41
    v_lshlrev_b32 v32, 16, v42
    v_and_b32 v33, 0xffff0000, v42
    v_lshlrev_b32 v34, 16, v43
    v_and_b32 v35, 0xffff0000, v43
    v_add_f32 v56, v28, v32
    v_mul_f32 v60, v28, v28
    v_add_f32 v57, v29, v33
    v_mul_f32 v61, v29, v29
    v_add_f32 v58, v30, v34
    v_mul_f32 v62, v30, v30
    v_add_f32 v59, v31, v35
    v_mul_f32 v63, v31, v31
    v_fmac_f32 v60, v32, v32
    v_fmac_f32 v61, v33, v33
    v_fmac_f32 v62, v34, v34
    v_fmac_f32 v63, v35, v35
    v_cndmask_b32 v64, v57, v56, s[46:47]
    v_cndmask_b32 v68, v56, v57, s[46:47]
    v_cndmask_b32 v65, v61, v60, s[46:47]
    v_cndmask_b32 v69, v60, v61, s[46:47]
    v_cndmask_b32 v66, v59, v58, s[46:47]
    v_cndmask_b32 v70, v58, v59, s[46:47]
    v_cndmask_b32 v67, v63, v62, s[46:47]
    v_cndmask_b32 v71, v62, v63, s[46:47]
    v_add_f32_dpp v64, v68, v64 quad_perm:[1,0,3,2] row_mask:0xf bank_mask:0xf
    v_add_f32_dpp v65, v69, v65 quad_perm:[1,0,3,2] row_mask:0xf bank_mask:0xf
    v_add_f32_dpp v66, v70, v66 quad_perm:[1,0,3,2] row_mask:0xf bank_mask:0xf
    v_add_f32_dpp v67, v71, v67 quad_perm:[1,0,3,2] row_mask:0xf bank_mask:0xf
    v_cndmask_b32 v68, v64, v66, s[48:49]
    v_cndmask_b32 v64, v66, v64, s[48:49]
    v_cndmask_b32 v69, v65, v67, s[48:49]
    v_cndmask_b32 v65, v67, v65, s[48:49]
    v_add_f32_dpp v64, v68, v64 quad_perm:[2,3,0,1] row_mask:0xf bank_mask:0xf
    s_nop 0
    v_add_f32_dpp v65, v69, v65 quad_perm:[2,3,0,1] row_mask:0xf bank_mask:0xf
    v_add_f32_dpp v64, v64, v64 row_ror:4 row_mask:0xf bank_mask:0xf
    s_nop 0
    v_add_f32_dpp v65, v65, v65 row_ror:4 row_mask:0xf bank_mask:0xf
    v_add_f32_dpp v64, v64, v64 row_ror:8 row_mask:0xf bank_mask:0xf
    s_nop 0
    v_add_f32_dpp v65, v65, v65 row_ror:8 row_mask:0xf bank_mask:0xf
    v_cndmask_b32 v64, v65, v64, s[50:51]
    s_mov_b32 exec_lo, 0x00ff00ff
    s_mov_b32 exec_hi, 0x00ff00ff
    global_atomic_add_f32 v9, v64, s[32:33]
    s_mov_b64 exec, -1
L_a2_done:
    v_lshrrev_b32 v2, 3, v0
    v_and_b32 v3, 7, v0
    v_mul_u32_u24 v4, 144, v2
    v_lshl_add_u32 v4, v3, 4, v4
    v_add_u32 v4, 118784, v4
    s_mul_i32 s44, s4, 327680
    s_lshl_b32 s45, s5, 7
    s_add_u32 s44, s44, s45
    s_add_u32 s44, s44, s41
    s_add_u32 s44, s44, 9437184
    v_lshl_add_u32 v5, v2, 12, s44
    v_lshl_add_u32 v5, v3, 4, v5
    v_add_u32 v8, 262144, v5
    s_waitcnt lgkmcnt(0)
    s_barrier
    ds_read_b128 v[20:23], v4
    ds_read_b128 v[24:27], v4 offset:9216
    s_waitcnt lgkmcnt(1)
    global_store_dwordx4 v5, v[20:23], s[32:33] sc1
    s_cmp_ge_u32 s3, 2
    s_cbranch_scc1 L_a2_st
    s_waitcnt lgkmcnt(0)
    global_store_dwordx4 v8, v[24:27], s[32:33] sc1
L_a2_st:
    s_and_b32 s44, s3, 3
    s_lshr_b32 s45, s3, 2
    s_cmp_eq_u32 s44, 3
    s_cselect_b32 s42, s45, s44
    s_add_u32 s43, s45, 1
    s_cmp_eq_u32 s44, 3
    s_cselect_b32 s43, 3, s43
    s_cmp_eq_u32 s44, 2
    s_cbranch_scc0 L_b_role
    s_add_u32 s43, s43, s36
    s_cmp_eq_u32 s43, 2
    s_cselect_b32 s46, 1, 0
    s_andn2_b32 s46, s46, s36
    s_cmp_eq_u32 s46, 1
    s_cselect_b32 s43, 0, s43
L_b_role:
    s_cmp_eq_u32 s42, 1
    s_cselect_b32 s44, s38, s37
    s_cmp_eq_u32 s42, 2
    s_cselect_b32 s44, s39, s44
    s_mul_i32 s45, s42, 15104
    s_mul_i32 s46, s42, 14976
    s_add_u32 s46, s46, 61440
    v_and_b32 v14, 15, v1
    v_lshrrev_b32 v15, 4, v1
    v_and_b32 v16, 7, v1
    v_mul_u32_u24 v16, 100, v16
    v_bfe_u32 v17, v1, 3, 1
    v_sub_u32 v16, v16, v17
    v_add3_u32 v3, v16, v15, 1
    v_lshl_add_u32 v3, v3, 4, s45
    v_and_b32 v17, 1, v15
    v_add3_u32 v16, v16, v17, 3
    v_and_b32 v18, 2, v15
    v_sub_u32 v16, v16, v18
    v_lshl_add_u32 v2, v16, 4, s45
    v_and_b32 v16, 3, v1
    v_mul_u32_u24 v16, 36, v16
    v_lshrrev_b32 v19, 2, v14
    v_sub_u32 v16, v16, v19
    v_add3_u32 v16, v16, v15, 3
    s_add_u32 s47, s45, 12800
    v_lshl_add_u32 v4, v16, 4, s47
    v_lshlrev_b32 v16, 5, v14
    v_lshl_add_u32 v5, v17, 4, v16
    v_lshlrev_b32 v18, 4, v18
    v_sub_u32 v5, v5, v18
    s_add_u32 s47, s46, 64
    v_add_u32 v5, s47, v5
    v_and_b32 v17, 3, v1
    v_lshl_add_u32 v17, v17, 3, s46
    v_lshl_add_u32 v6, v15, 7, v17
    v_lshl_add_u32 v6, v19, 4, v6
    v_lshl_add_u32 v7, v15, 8, v17
    v_lshl_add_u32 v7, v19, 5, v7
    v_lshl_add_u32 v16, v15, 3, v16
    s_add_u32 s47, s46, 512
    v_add_u32 v8, s47, v16
    s_lshl_b32 s47, s44, 12
    s_add_u32 s47, s47, s41
    s_add_u32 s47, s47, 9437184
    v_add_u32 v9, s47, v16
    s_lshl_b32 s47, s44, 1
    v_mov_b32 v12, s47
    global_load_ushort v11, v12, s[26:27]
    s_lshl_b32 s47, s42, 2
    s_add_u32 s47, s47, 46992
    v_mov_b32 v12, s47
    ds_read_b32 v10, v12
    v_and_b32 v16, 255, v0
    v_lshlrev_b32 v17, 4, v16
    s_cmp_ge_u32 s3, 4
    s_cselect_b32 s47, s38, s37
    s_cselect_b32 s48, 14976, 0
    s_add_u32 s48, s48, 61440
    s_lshl_b32 s47, s47, 12
    s_add_u32 s49, s41, 9437184
    s_add_u32 s47, s47, s49
    v_add_u32 v20, s47, v17
    s_lshl_b32 s47, s39, 12
    s_add_u32 s47, s47, s49
    v_add_u32 v22, s47, v17
    s_mul_i32 s47, s7, 16384
    s_add_u32 s47, s47, 393216
    v_lshl_add_u32 v21, v0, 4, s47
    v_add_u32 v23, 8192, v21
    v_lshlrev_b32 v26, 2, v0
    v_add_u32 v26, 106368, v26
    v_lshlrev_b32 v27, 3, v0
    v_add_u32 v27, 110464, v27
    v_add_u32 v14, 106368, v17
    v_lshlrev_b32 v15, 5, v16
    v_add_u32 v15, 110464, v15
    v_add_u32 v24, s48, v17
    v_add_u32 v25, 91392, v17
    s_cmp_ge_u32 s3, 3
    s_cbranch_scc1 L_b_nz
    v_mov_b32 v28, 0
    v_mov_b32 v29, 0
    v_mov_b32 v30, 0
    v_mov_b32 v31, 0
    s_mul_i32 s47, s3, 14976
    s_add_u32 s47, s47, 61440
    v_and_b32 v16, 31, v1
    v_lshl_add_u32 v16, v16, 4, s47
    ds_write_b128 v16, v[28:31] offset:0
    v_bfe_u32 v16, v1, 1, 2
    v_mul_u32_u24 v17, 3104, v16
    v_cmp_eq_u32 vcc, 3, v16
    v_subrev_u32 v18, 1024, v17
    s_nop 0
    v_cndmask_b32 v17, v17, v18, vcc
    v_and_b32 v16, 1, v1
    v_lshl_add_u32 v17, v16, 4, v17
    v_add_u32 v17, s47, v17
    ds_write_b128 v17, v[28:31] offset:4608
L_b_nz:
    s_and_b32 s47, s2, 7
    s_lshl_b32 s47, s47, 12
    s_add_u32 s47, s47, s40
    s_add_u32 s47, s47, 69632
    v_and_b32 v16, 31, v1
    v_lshl_add_u32 v16, v16, 7, s47
    s_lshl_b32 s44, s4, 5
    s_add_u32 s44, s44, s5
    s_lshl_b32 s44, s44, 7
    s_add_u32 s44, s44, s40
    s_add_u32 s44, s44, 69632
    s_waitcnt vmcnt(0)
    s_barrier
    s_cmp_eq_u32 s3, 0
    s_cbranch_scc0 L_u_np
    v_lshl_add_u32 v17, v1, 4, s44
    v_mov_b32 v28, s34
    v_mov_b32 v29, s35
    v_mov_b32 v30, s34
    v_mov_b32 v31, s35
    s_mov_b64 exec, 0xff
    global_store_dwordx4 v17, v[28:31], s[32:33] sc1
    s_mov_b64 exec, -1
L_u_np:
    s_cmp_eq_u32 s3, 0
    s_cbranch_scc0 L_b_np
    s_mov_b32 s57, 0
L_poll14:
    s_sleep 4
    global_load_dwordx2 v[18:19], v16, s[32:33] sc1
    s_add_u32 s57, s57, 1
    s_waitcnt vmcnt(0)
    v_cmp_ne_u64 vcc, s[34:35], v[18:19]
    s_cmp_gt_u32 s57, 200000
    s_nop 2
    s_cbranch_scc1 L_end
    s_cbranch_vccnz L_poll14
L_b_np:
    s_waitcnt vmcnt(0) lgkmcnt(0)
    v_lshlrev_b32 v11, 16, v11
    s_barrier
    global_load_dwordx4 v[48:51], v21, s[32:33] sc1
    global_load_dwordx4 v[52:55], v23, s[32:33] sc1
    global_load_dwordx4 v[40:43], v20, s[32:33] sc1
    s_cmp_ge_u32 s3, 4
    s_cbranch_scc1 L_b_l1
    global_load_dwordx4 v[44:47], v22, s[32:33] sc1
L_b_l1:
    s_max_u32 s47, s43, 1
    s_lshl_b32 s47, s47, 10
    s_cmp_gt_u32 s47, 1024
    s_cselect_b32 s47, s47, 0
    v_add_u32 v12, s47, v9
    global_load_dwordx2 v[32:33], v12, s[32:33] sc1
    global_load_dwordx2 v[34:35], v12, s[32:33] offset:512 sc1
    s_cbranch_scc1 L_b_l2
    global_load_dwordx2 v[36:37], v12, s[32:33] offset:1024 sc1
    global_load_dwordx2 v[38:39], v12, s[32:33] offset:1536 sc1
L_b_l2:
    s_waitcnt vmcnt(0)
    v_mul_f32 v48, 0x3acccccd, v48
    v_mul_f32 v49, 0x3acccccd, v49
    v_mul_f32 v50, 0x3acccccd, v50
    v_mul_f32 v51, 0x3acccccd, v51
    v_mul_f32 v52, 0x3acccccd, v52
    v_mul_f32 v53, 0x3acccccd, v53
    v_mul_f32 v54, 0x3acccccd, v54
    v_mul_f32 v55, 0x3acccccd, v55
    v_fma_f32 v49, -v48, v48, v49
    v_fma_f32 v51, -v50, v50, v51
    v_fma_f32 v53, -v52, v52, v53
    v_fma_f32 v55, -v54, v54, v55
    v_max_f32 v49, 0, v49
    v_max_f32 v51, 0, v51
    v_max_f32 v53, 0, v53
    v_max_f32 v55, 0, v55
    v_cvt_pk_bf16_f32 v56, v48, v50
    v_cvt_pk_bf16_f32 v57, v52, v54
    ds_write_b32 v26, v56
    ds_write_b32 v26, v57 offset:2048
    v_cvt_pk_bf16_f32 v58, v49, v51
    v_cvt_pk_bf16_f32 v59, v53, v55
    v_lshlrev_b32 v60, 16, v58
    v_and_b32 v61, 0xffff0000, v58
    v_lshlrev_b32 v62, 16, v59
    v_and_b32 v63, 0xffff0000, v59
    v_add_f32 v60, 0x3727c5ac, v60
    v_add_f32 v61, 0x3727c5ac, v61
    v_add_f32 v62, 0x3727c5ac, v62
    v_add_f32 v63, 0x3727c5ac, v63
    v_cvt_pk_bf16_f32 v58, v60, v61
    v_cvt_pk_bf16_f32 v59, v62, v63
    v_lshlrev_b32 v60, 16, v58
    v_and_b32 v61, 0xffff0000, v58
    v_lshlrev_b32 v62, 16, v59
    v_and_b32 v63, 0xffff0000, v59
    v_sqrt_f32 v60, v60
    v_sqrt_f32 v61, v61
    v_sqrt_f32 v62, v62
    v_sqrt_f32 v63, v63
    v_cvt_pk_bf16_f32 v58, v60, v61
    v_cvt_pk_bf16_f32 v59, v62, v63
    v_lshlrev_b32 v60, 16, v58
    v_and_b32 v61, 0xffff0000, v58
    v_lshlrev_b32 v62, 16, v59
    v_and_b32 v63, 0xffff0000, v59
    v_rcp_f32 v60, v60
    v_rcp_f32 v61, v61
    v_rcp_f32 v62, v62
    v_rcp_f32 v63, v63
    ds_write_b64 v27, v[60:61]
    ds_write_b64 v27, v[62:63] offset:4096
    s_waitcnt lgkmcnt(0)
    s_barrier
    ds_read_b128 v[76:79], v14
    ds_read_b128 v[56:59], v15
    ds_read_b128 v[60:63], v15 offset:16
    s_waitcnt lgkmcnt(2)
    v_lshlrev_b32 v48, 16, v76
    v_and_b32 v49, 0xffff0000, v76
    v_lshlrev_b32 v50, 16, v77
    v_and_b32 v51, 0xffff0000, v77
    v_lshlrev_b32 v52, 16, v78
    v_and_b32 v53, 0xffff0000, v78
    v_lshlrev_b32 v54, 16, v79
    v_and_b32 v55, 0xffff0000, v79
    v_lshlrev_b32 v64, 16, v40
    v_and_b32 v65, 0xffff0000, v40
    v_lshlrev_b32 v66, 16, v41
    v_and_b32 v67, 0xffff0000, v41
    v_lshlrev_b32 v68, 16, v42
    v_and_b32 v69, 0xffff0000, v42
    v_lshlrev_b32 v70, 16, v43
    v_and_b32 v71, 0xffff0000, v43
    v_sub_f32 v64, v64, v48
    v_sub_f32 v65, v65, v49
    v_sub_f32 v66, v66, v50
    v_sub_f32 v67, v67, v51
    v_sub_f32 v68, v68, v52
    v_sub_f32 v69, v69, v53
    v_sub_f32 v70, v70, v54
    v_sub_f32 v71, v71, v55
    v_cvt_pk_bf16_f32 v72, v64, v65
    v_cvt_pk_bf16_f32 v73, v66, v67
    v_cvt_pk_bf16_f32 v74, v68, v69
    v_cvt_pk_bf16_f32 v75, v70, v71
    v_lshlrev_b32 v64, 16, v72
    v_and_b32 v65, 0xffff0000, v72
    v_lshlrev_b32 v66, 16, v73
    v_and_b32 v67, 0xffff0000, v73
    v_lshlrev_b32 v68, 16, v74
    v_and_b32 v69, 0xffff0000, v74
    v_lshlrev_b32 v70, 16, v75
    v_and_b32 v71, 0xffff0000, v75
    s_waitcnt lgkmcnt(0)
    v_mul_f32 v64, v64, v56
    v_mul_f32 v65, v65, v57
    v_mul_f32 v66, v66, v58
    v_mul_f32 v67, v67, v59
    v_mul_f32 v68, v68, v60
    v_mul_f32 v69, v69, v61
    v_mul_f32 v70, v70, v62
    v_mul_f32 v71, v71, v63
    v_cvt_pk_bf16_f32 v72, v64, v65
    v_cvt_pk_bf16_f32 v73, v66, v67
    v_cvt_pk_bf16_f32 v74, v68, v69
    v_cvt_pk_bf16_f32 v75, v70, v71
    v_lshlrev_b32 v64, 16, v72
    v_and_b32 v65, 0xffff0000, v72
    v_lshlrev_b32 v66, 16, v73
    v_and_b32 v67, 0xffff0000, v73
    v_lshlrev_b32 v68, 16, v74
    v_and_b32 v69, 0xffff0000, v74
    v_lshlrev_b32 v70, 16, v75
    v_and_b32 v71, 0xffff0000, v75
    v_cvt_pk_f16_f32 v80, v64, v65
    v_cvt_pk_f16_f32 v81, v66, v67
    v_cvt_pk_f16_f32 v82, v68, v69
    v_cvt_pk_f16_f32 v83, v70, v71
    ds_write_b128 v24, v[80:83] offset:512
    s_cmp_ge_u32 s3, 4
    s_cbranch_scc1 L_b_u
    v_lshlrev_b32 v64, 16, v44
    v_and_b32 v65, 0xffff0000, v44
    v_lshlrev_b32 v66, 16, v45
    v_and_b32 v67, 0xffff0000, v45
    v_lshlrev_b32 v68, 16, v46
    v_and_b32 v69, 0xffff0000, v46
    v_lshlrev_b32 v70, 16, v47
    v_and_b32 v71, 0xffff0000, v47
    v_sub_f32 v64, v64, v48
    v_sub_f32 v65, v65, v49
    v_sub_f32 v66, v66, v50
    v_sub_f32 v67, v67, v51
    v_sub_f32 v68, v68, v52
    v_sub_f32 v69, v69, v53
    v_sub_f32 v70, v70, v54
    v_sub_f32 v71, v71, v55
    v_cvt_pk_bf16_f32 v72, v64, v65
    v_cvt_pk_bf16_f32 v73, v66, v67
    v_cvt_pk_bf16_f32 v74, v68, v69
    v_cvt_pk_bf16_f32 v75, v70, v71
    v_lshlrev_b32 v64, 16, v72
    v_and_b32 v65, 0xffff0000, v72
    v_lshlrev_b32 v66, 16, v73
    v_and_b32 v67, 0xffff0000, v73
    v_lshlrev_b32 v68, 16, v74
    v_and_b32 v69, 0xffff0000, v74
    v_lshlrev_b32 v70, 16, v75
    v_and_b32 v71, 0xffff0000, v75
    s_waitcnt lgkmcnt(0)
    v_mul_f32 v64, v64, v56
    v_mul_f32 v65, v65, v57
    v_mul_f32 v66, v66, v58
    v_mul_f32 v67, v67, v59
    v_mul_f32 v68, v68, v60
    v_mul_f32 v69, v69, v61
    v_mul_f32 v70, v70, v62
    v_mul_f32 v71, v71, v63
    v_cvt_pk_bf16_f32 v72, v64, v65
    v_cvt_pk_bf16_f32 v73, v66, v67
    v_cvt_pk_bf16_f32 v74, v68, v69
    v_cvt_pk_bf16_f32 v75, v70, v71
    v_lshlrev_b32 v64, 16, v72
    v_and_b32 v65, 0xffff0000, v72
    v_lshlrev_b32 v66, 16, v73
    v_and_b32 v67, 0xffff0000, v73
    v_lshlrev_b32 v68, 16, v74
    v_and_b32 v69, 0xffff0000, v74
    v_lshlrev_b32 v70, 16, v75
    v_and_b32 v71, 0xffff0000, v75
    v_cvt_pk_f16_f32 v88, v64, v65
    v_cvt_pk_f16_f32 v89, v66, v67
    v_cvt_pk_f16_f32 v90, v68, v69
    v_cvt_pk_f16_f32 v91, v70, v71
    ds_write_b128 v25, v[88:91] offset:512
L_b_u:
    s_and_b32 s50, s3, 3
    s_waitcnt lgkmcnt(0)
    s_barrier
    s_cmp_eq_u32 s50, 3
    s_cbranch_scc1 L_b_go
    ds_read_b128 v[76:79], v24 offset:496
    ds_read_b128 v[84:87], v25 offset:496
    s_waitcnt lgkmcnt(1)
    v_alignbyte_b32 v48, v77, v76, 2
    v_alignbyte_b32 v49, v78, v77, 2
    v_alignbyte_b32 v50, v79, v78, 2
    v_alignbyte_b32 v51, v80, v79, 2
    v_alignbyte_b32 v52, v81, v80, 2
    v_alignbyte_b32 v53, v82, v81, 2
    v_alignbyte_b32 v54, v83, v82, 2
    v_pk_add_f16 v72, v49, v50
    v_pk_add_f16 v60, v77, v79
    v_pk_add_f16 v73, v50, v51
    v_pk_add_f16 v61, v78, v80
    v_pk_add_f16 v74, v51, v52
    v_pk_add_f16 v62, v79, v81
    v_pk_add_f16 v75, v52, v53
    v_pk_add_f16 v63, v80, v82
    v_pk_add_f16 v56, v78, v72
    v_pk_add_f16 v57, v79, v73
    v_pk_add_f16 v58, v80, v74
    v_pk_add_f16 v59, v81, v75
    v_pk_add_f16 v60, v60, v56
    v_pk_add_f16 v61, v61, v57
    v_pk_add_f16 v62, v62, v58
    v_pk_add_f16 v63, v63, v59
    ds_write_b128 v24, v[56:59] offset:7744
    ds_write_b128 v24, v[60:63] offset:4640
    s_cmp_ge_u32 s50, 2
    s_cbranch_scc1 L_bx15
    v_pk_add_f16 v64, v48, v51
    v_pk_add_f16 v68, v76, v80
    v_pk_add_f16 v65, v49, v52
    v_pk_add_f16 v69, v77, v81
    v_pk_add_f16 v66, v50, v53
    v_pk_add_f16 v70, v78, v82
    v_pk_add_f16 v67, v51, v54
    v_pk_add_f16 v71, v79, v83
    v_pk_add_f16 v64, v64, v60
    v_pk_add_f16 v65, v65, v61
    v_pk_add_f16 v66, v66, v62
    v_pk_add_f16 v67, v67, v63
    v_pk_add_f16 v68, v68, v64
    v_pk_add_f16 v69, v69, v65
    v_pk_add_f16 v70, v70, v66
    v_pk_add_f16 v71, v71, v67
    ds_write_b128 v24, v[64:67] offset:12928
    ds_write_b128 v24, v[68:71] offset:10848
L_bx15:
    s_cmp_ge_u32 s3, 4
    s_cbranch_scc1 L_b_go
    s_waitcnt lgkmcnt(0)
    v_alignbyte_b32 v48, v85, v84, 2
    v_alignbyte_b32 v49, v86, v85, 2
    v_alignbyte_b32 v50, v87, v86, 2
    v_alignbyte_b32 v51, v88, v87, 2
    v_alignbyte_b32 v52, v89, v88, 2
    v_alignbyte_b32 v53, v90, v89, 2
    v_alignbyte_b32 v54, v91, v90, 2
    v_pk_add_f16 v72, v49, v50
    v_pk_add_f16 v60, v85, v87
    v_pk_add_f16 v73, v50, v51
    v_pk_add_f16 v61, v86, v88
    v_pk_add_f16 v74, v51, v52
    v_pk_add_f16 v62, v87, v89
    v_pk_add_f16 v75, v52, v53
    v_pk_add_f16 v63, v88, v90
    v_pk_add_f16 v56, v86, v72
    v_pk_add_f16 v57, v87, v73
    v_pk_add_f16 v58, v88, v74
    v_pk_add_f16 v59, v89, v75
    v_pk_add_f16 v60, v60, v56
    v_pk_add_f16 v61, v61, v57
    v_pk_add_f16 v62, v62, v58
    v_pk_add_f16 v63, v63, v59
    ds_write_b128 v25, v[56:59] offset:7744
    ds_write_b128 v25, v[60:63] offset:4640
    s_cmp_ge_u32 s50, 2
    s_cbranch_scc1 L_bx16
    v_pk_add_f16 v64, v48, v51
    v_pk_add_f16 v68, v84, v88
    v_pk_add_f16 v65, v49, v52
    v_pk_add_f16 v69, v85, v89
    v_pk_add_f16 v66, v50, v53
    v_pk_add_f16 v70, v86, v90
    v_pk_add_f16 v67, v51, v54
    v_pk_add_f16 v71, v87, v91
    v_pk_add_f16 v64, v64, v60
    v_pk_add_f16 v65, v65, v61
    v_pk_add_f16 v66, v66, v62
    v_pk_add_f16 v67, v67, v63
    v_pk_add_f16 v68, v68, v64
    v_pk_add_f16 v69, v69, v65
    v_pk_add_f16 v70, v70, v66
    v_pk_add_f16 v71, v71, v67
    ds_write_b128 v25, v[64:67] offset:12928
    ds_write_b128 v25, v[68:71] offset:10848
L_bx16:
L_b_go:
    s_waitcnt lgkmcnt(0)
    s_barrier
    s_cmp_eq_u32 s43, 0
    s_cbranch_scc1 L_b_done
    s_cmp_eq_u32 s43, 2
    s_cbranch_scc1 L_b_p2
    s_cmp_eq_u32 s43, 3
    s_cbranch_scc1 L_b_p3
    ds_read_b128 v[40:43], v2 offset:1088
    ds_read_b128 v[44:47], v5 offset:448
    ds_read_b128 v[48:51], v5 offset:960
    ds_read_b128 v[52:55], v5 offset:1472
    ds_read_b128 v[56:59], v5 offset:1984
    ds_read_b128 v[60:63], v2 offset:1024
    ds_read_b128 v[64:67], v5 offset:384
    ds_read_b128 v[68:71], v5 offset:896
    ds_read_b128 v[72:75], v5 offset:1408
    ds_read_b128 v[76:79], v5 offset:1920
    ds_read_b128 v[80:83], v2 offset:960
    s_waitcnt lgkmcnt(8)
    v_mfma_f32_16x16x32_f16 v[16:19], v[40:43], v[44:47], 0
    ds_read_b128 v[84:87], v5 offset:320
    v_mfma_f32_16x16x32_f16 v[20:23], v[40:43], v[48:51], 0
    s_waitcnt lgkmcnt(7)
    v_mfma_f32_16x16x32_f16 v[24:27], v[40:43], v[52:55], 0
    v_mfma_f32_16x16x32_f16 v[28:31], v[40:43], v[56:59], 0
    ds_read_b128 v[40:43], v5 offset:832
    ds_read_b128 v[44:47], v5 offset:1344
    s_waitcnt lgkmcnt(6)
    v_mfma_f32_16x16x32_f16 v[16:19], v[60:63], v[64:67], v[16:19]
    ds_read_b128 v[48:51], v5 offset:1856
    ds_read_b128 v[52:55], v2 offset:896
    v_mfma_f32_16x16x32_f16 v[20:23], v[60:63], v[68:71], v[20:23]
    ds_read_b128 v[56:59], v5 offset:256
    s_waitcnt lgkmcnt(7)
    v_mfma_f32_16x16x32_f16 v[24:27], v[60:63], v[72:75], v[24:27]
    v_mfma_f32_16x16x32_f16 v[28:31], v[60:63], v[76:79], v[28:31]
    ds_read_b128 v[60:63], v5 offset:768
    ds_read_b128 v[64:67], v5 offset:1280
    s_waitcnt lgkmcnt(6)
    v_mfma_f32_16x16x32_f16 v[16:19], v[80:83], v[84:87], v[16:19]
    ds_read_b128 v[68:71], v5 offset:1792
    ds_read_b128 v[72:75], v2 offset:832
    v_mfma_f32_16x16x32_f16 v[20:23], v[80:83], v[40:43], v[20:23]
    ds_read_b128 v[76:79], v5 offset:192
    s_waitcnt lgkmcnt(7)
    v_mfma_f32_16x16x32_f16 v[24:27], v[80:83], v[44:47], v[24:27]
    v_mfma_f32_16x16x32_f16 v[28:31], v[80:83], v[48:51], v[28:31]
    ds_read_b128 v[80:83], v5 offset:704
    ds_read_b128 v[84:87], v5 offset:1216
    s_waitcnt lgkmcnt(6)
    v_mfma_f32_16x16x32_f16 v[16:19], v[52:55], v[56:59], v[16:19]
    ds_read_b128 v[40:43], v5 offset:1728
    ds_read_b128 v[44:47], v2 offset:768
    v_mfma_f32_16x16x32_f16 v[20:23], v[52:55], v[60:63], v[20:23]
    ds_read_b128 v[48:51], v5 offset:128
    s_waitcnt lgkmcnt(7)
    v_mfma_f32_16x16x32_f16 v[24:27], v[52:55], v[64:67], v[24:27]
    v_mfma_f32_16x16x32_f16 v[28:31], v[52:55], v[68:71], v[28:31]
    ds_read_b128 v[52:55], v5 offset:640
    ds_read_b128 v[56:59], v5 offset:1152
    s_waitcnt lgkmcnt(6)
    v_mfma_f32_16x16x32_f16 v[16:19], v[72:75], v[76:79], v[16:19]
    ds_read_b128 v[60:63], v5 offset:1664
    ds_read_b128 v[64:67], v2 offset:704
    v_mfma_f32_16x16x32_f16 v[20:23], v[72:75], v[80:83], v[20:23]
    ds_read_b128 v[68:71], v5 offset:64
    s_waitcnt lgkmcnt(7)
    v_mfma_f32_16x16x32_f16 v[24:27], v[72:75], v[84:87], v[24:27]
    v_mfma_f32_16x16x32_f16 v[28:31], v[72:75], v[40:43], v[28:31]
    ds_read_b128 v[72:75], v5 offset:576
    ds_read_b128 v[76:79], v5 offset:1088
    s_waitcnt lgkmcnt(6)
    v_mfma_f32_16x16x32_f16 v[16:19], v[44:47], v[48:51], v[16:19]
    ds_read_b128 v[80:83], v5 offset:1600
    ds_read_b128 v[84:87], v2 offset:640
    v_mfma_f32_16x16x32_f16 v[20:23], v[44:47], v[52:55], v[20:23]
    ds_read_b128 v[40:43], v5 offset:0
    s_waitcnt lgkmcnt(7)
    v_mfma_f32_16x16x32_f16 v[24:27], v[44:47], v[56:59], v[24:27]
    v_mfma_f32_16x16x32_f16 v[28:31], v[44:47], v[60:63], v[28:31]
    ds_read_b128 v[44:47], v5 offset:512
    ds_read_b128 v[48:51], v5 offset:1024
    s_waitcnt lgkmcnt(6)
    v_mfma_f32_16x16x32_f16 v[16:19], v[64:67], v[68:71], v[16:19]
    ds_read_b128 v[52:55], v5 offset:1536
    ds_read_b128 v[56:59], v2 offset:576
    v_mfma_f32_16x16x32_f16 v[20:23], v[64:67], v[72:75], v[20:23]
    ds_read_b128 v[60:63], v5 offset:448
    s_waitcnt lgkmcnt(7)
    v_mfma_f32_16x16x32_f16 v[24:27], v[64:67], v[76:79], v[24:27]
    v_mfma_f32_16x16x32_f16 v[28:31], v[64:67], v[80:83], v[28:31]
    ds_read_b128 v[64:67], v5 offset:960
    ds_read_b128 v[68:71], v5 offset:1472
    s_waitcnt lgkmcnt(6)
    v_mfma_f32_16x16x32_f16 v[16:19], v[84:87], v[40:43], v[16:19]
    ds_read_b128 v[72:75], v2 offset:512
    ds_read_b128 v[76:79], v5 offset:384
    v_mfma_f32_16x16x32_f16 v[20:23], v[84:87], v[44:47], v[20:23]
    ds_read_b128 v[80:83], v5 offset:896
    s_waitcnt lgkmcnt(7)
    v_mfma_f32_16x16x32_f16 v[24:27], v[84:87], v[48:51], v[24:27]
    v_mfma_f32_16x16x32_f16 v[28:31], v[84:87], v[52:55], v[28:31]
    ds_read_b128 v[84:87], v5 offset:1408
    ds_read_b128 v[40:43], v2 offset:448
    s_waitcnt lgkmcnt(6)
    v_mfma_f32_16x16x32_f16 v[20:23], v[56:59], v[60:63], v[20:23]
    ds_read_b128 v[44:47], v5 offset:320
    ds_read_b128 v[48:51], v5 offset:832
    v_mfma_f32_16x16x32_f16 v[24:27], v[56:59], v[64:67], v[24:27]
    ds_read_b128 v[52:55], v5 offset:1344
    s_waitcnt lgkmcnt(6)
    v_mfma_f32_16x16x32_f16 v[28:31], v[56:59], v[68:71], v[28:31]
    ds_read_b128 v[56:59], v2 offset:384
    ds_read_b128 v[60:63], v5 offset:256
    v_mfma_f32_16x16x32_f16 v[20:23], v[72:75], v[76:79], v[20:23]
    ds_read_b128 v[64:67], v5 offset:768
    ds_read_b128 v[68:71], v5 offset:1280
    s_waitcnt lgkmcnt(8)
    v_mfma_f32_16x16x32_f16 v[24:27], v[72:75], v[80:83], v[24:27]
    v_mfma_f32_16x16x32_f16 v[28:31], v[72:75], v[84:87], v[28:31]
    ds_read_b128 v[72:75], v2 offset:320
    ds_read_b128 v[76:79], v5 offset:192
    s_waitcnt lgkmcnt(7)
    v_mfma_f32_16x16x32_f16 v[20:23], v[40:43], v[44:47], v[20:23]
    ds_read_b128 v[80:83], v5 offset:704
    ds_read_b128 v[84:87], v5 offset:1216
    v_mfma_f32_16x16x32_f16 v[24:27], v[40:43], v[48:51], v[24:27]
    s_waitcnt lgkmcnt(6)
    v_mfma_f32_16x16x32_f16 v[28:31], v[40:43], v[52:55], v[28:31]
    ds_read_b128 v[40:43], v2 offset:256
    ds_read_b128 v[44:47], v5 offset:128
    v_mfma_f32_16x16x32_f16 v[20:23], v[56:59], v[60:63], v[20:23]
    ds_read_b128 v[48:51], v5 offset:640
    ds_read_b128 v[52:55], v5 offset:1152
    s_waitcnt lgkmcnt(8)
    v_mfma_f32_16x16x32_f16 v[24:27], v[56:59], v[64:67], v[24:27]
    v_mfma_f32_16x16x32_f16 v[28:31], v[56:59], v[68:71], v[28:31]
    ds_read_b128 v[56:59], v2 offset:192
    ds_read_b128 v[60:63], v5 offset:64
    s_waitcnt lgkmcnt(7)
    v_mfma_f32_16x16x32_f16 v[20:23], v[72:75], v[76:79], v[20:23]
    ds_read_b128 v[64:67], v5 offset:576
    ds_read_b128 v[68:71], v5 offset:1088
    v_mfma_f32_16x16x32_f16 v[24:27], v[72:75], v[80:83], v[24:27]
    s_waitcnt lgkmcnt(6)
    v_mfma_f32_16x16x32_f16 v[28:31], v[72:75], v[84:87], v[28:31]
    ds_read_b128 v[72:75], v2 offset:128
    ds_read_b128 v[76:79], v5 offset:0
    v_mfma_f32_16x16x32_f16 v[20:23], v[40:43], v[44:47], v[20:23]
    ds_read_b128 v[80:83], v5 offset:512
    ds_read_b128 v[84:87], v5 offset:1024
    s_waitcnt lgkmcnt(8)
    v_mfma_f32_16x16x32_f16 v[24:27], v[40:43], v[48:51], v[24:27]
    v_mfma_f32_16x16x32_f16 v[28:31], v[40:43], v[52:55], v[28:31]
    ds_read_b128 v[40:43], v2 offset:64
    ds_read_b128 v[44:47], v5 offset:448
    s_waitcnt lgkmcnt(7)
    v_mfma_f32_16x16x32_f16 v[20:23], v[56:59], v[60:63], v[20:23]
    ds_read_b128 v[48:51], v5 offset:960
    ds_read_b128 v[52:55], v4 offset:128
    v_mfma_f32_16x16x32_f16 v[24:27], v[56:59], v[64:67], v[24:27]
    s_waitcnt lgkmcnt(6)
    v_mfma_f32_16x16x32_f16 v[28:31], v[56:59], v[68:71], v[28:31]
    ds_read_b64_tr_b16 v[56:57], v6 offset:4616
    ds_read_b64_tr_b16 v[58:59], v6 offset:4680
    v_mfma_f32_16x16x32_f16 v[20:23], v[72:75], v[76:79], v[20:23]
    ds_read_b64_tr_b16 v[60:61], v6 offset:5128
    ds_read_b64_tr_b16 v[62:63], v6 offset:5192
    s_waitcnt lgkmcnt(8)
    v_mfma_f32_16x16x32_f16 v[24:27], v[72:75], v[80:83], v[24:27]
    ds_read_b128 v[64:67], v4 offset:64
    ds_read_b64_tr_b16 v[68:69], v6 offset:4616
    v_mfma_f32_16x16x32_f16 v[28:31], v[72:75], v[84:87], v[28:31]
    ds_read_b64_tr_b16 v[70:71], v6 offset:4680
    ds_read_b128 v[72:75], v4 offset:368
    s_waitcnt lgkmcnt(9)
    v_mfma_f32_16x16x32_f16 v[24:27], v[40:43], v[44:47], v[24:27]
    ds_read_b64_tr_b16 v[76:77], v6 offset:7728
    ds_read_b64_tr_b16 v[78:79], v6 offset:7792
    v_mfma_f32_16x16x32_f16 v[28:31], v[40:43], v[48:51], v[28:31]
    ds_read_b64_tr_b16 v[80:81], v6 offset:8240
    ds_read_b64_tr_b16 v[82:83], v6 offset:8304
    s_waitcnt lgkmcnt(8)
    v_mfma_f32_16x16x32_f16 v[24:27], v[56:59], v[52:55], v[24:27]
    ds_read_b128 v[84:87], v4 offset:304
    ds_read_b64_tr_b16 v[40:41], v6 offset:7728
    v_mfma_f32_16x16x32_f16 v[28:31], v[60:63], v[52:55], v[28:31]
    ds_read_b64_tr_b16 v[42:43], v6 offset:7792
    s_waitcnt lgkmcnt(5)
    v_mfma_f32_16x16x32_f16 v[28:31], v[68:71], v[64:67], v[28:31]
    v_mfma_f32_16x16x32_f16 v[24:27], v[76:79], v[72:75], v[24:27]
    s_waitcnt lgkmcnt(3)
    v_mfma_f32_16x16x32_f16 v[28:31], v[80:83], v[72:75], v[28:31]
    s_waitcnt lgkmcnt(0)
    v_mfma_f32_16x16x32_f16 v[28:31], v[40:43], v[84:87], v[28:31]
    ds_read_b64 v[88:89], v8 offset:0
    ds_read_b64 v[90:91], v8 offset:512
    ds_read_b64 v[92:93], v8 offset:1024
    ds_read_b64 v[94:95], v8 offset:1536
    v_mul_f32 v40, v16, v10
    v_mul_f32 v41, v17, v10
    v_mul_f32 v42, v18, v10
    v_mul_f32 v43, v19, v10
    v_mul_f32 v44, v20, v10
    v_mul_f32 v45, v21, v10
    v_mul_f32 v46, v22, v10
    v_mul_f32 v47, v23, v10
    v_mul_f32 v48, v24, v10
    v_mul_f32 v49, v25, v10
    v_mul_f32 v50, v26, v10
    v_mul_f32 v51, v27, v10
    v_mul_f32 v52, v28, v10
    v_mul_f32 v53, v29, v10
    v_mul_f32 v54, v30, v10
    v_mul_f32 v55, v31, v10
    v_cvt_pk_bf16_f32 v72, v40, v41
    v_cvt_pk_bf16_f32 v73, v42, v43
    v_cvt_pk_bf16_f32 v74, v44, v45
    v_cvt_pk_bf16_f32 v75, v46, v47
    v_cvt_pk_bf16_f32 v76, v48, v49
    v_cvt_pk_bf16_f32 v77, v50, v51
    v_cvt_pk_bf16_f32 v78, v52, v53
    v_cvt_pk_bf16_f32 v79, v54, v55
    v_lshlrev_b32 v40, 16, v72
    v_and_b32 v41, 0xffff0000, v72
    v_lshlrev_b32 v42, 16, v73
    v_and_b32 v43, 0xffff0000, v73
    v_lshlrev_b32 v44, 16, v74
    v_and_b32 v45, 0xffff0000, v74
    v_lshlrev_b32 v46, 16, v75
    v_and_b32 v47, 0xffff0000, v75
    v_lshlrev_b32 v48, 16, v76
    v_and_b32 v49, 0xffff0000, v76
    v_lshlrev_b32 v50, 16, v77
    v_and_b32 v51, 0xffff0000, v77
    v_lshlrev_b32 v52, 16, v78
    v_and_b32 v53, 0xffff0000, v78
    v_lshlrev_b32 v54, 16, v79
    v_and_b32 v55, 0xffff0000, v79
    s_waitcnt vmcnt(0) lgkmcnt(0)
    v_fma_mix_f32 v56, v88, v11, 0 op_sel:[0,0,0] op_sel_hi:[1,0,0]
    v_fma_mix_f32 v57, v88, v11, 0 op_sel:[1,0,0] op_sel_hi:[1,0,0]
    v_fma_mix_f32 v58, v89, v11, 0 op_sel:[0,0,0] op_sel_hi:[1,0,0]
    v_fma_mix_f32 v59, v89, v11, 0 op_sel:[1,0,0] op_sel_hi:[1,0,0]
    v_fma_mix_f32 v60, v90, v11, 0 op_sel:[0,0,0] op_sel_hi:[1,0,0]
    v_fma_mix_f32 v61, v90, v11, 0 op_sel:[1,0,0] op_sel_hi:[1,0,0]
    v_fma_mix_f32 v62, v91, v11, 0 op_sel:[0,0,0] op_sel_hi:[1,0,0]
    v_fma_mix_f32 v63, v91, v11, 0 op_sel:[1,0,0] op_sel_hi:[1,0,0]
    v_fma_mix_f32 v64, v92, v11, 0 op_sel:[0,0,0] op_sel_hi:[1,0,0]
    v_fma_mix_f32 v65, v92, v11, 0 op_sel:[1,0,0] op_sel_hi:[1,0,0]
    v_fma_mix_f32 v66, v93, v11, 0 op_sel:[0,0,0] op_sel_hi:[1,0,0]
    v_fma_mix_f32 v67, v93, v11, 0 op_sel:[1,0,0] op_sel_hi:[1,0,0]
    v_fma_mix_f32 v68, v94, v11, 0 op_sel:[0,0,0] op_sel_hi:[1,0,0]
    v_fma_mix_f32 v69, v94, v11, 0 op_sel:[1,0,0] op_sel_hi:[1,0,0]
    v_fma_mix_f32 v70, v95, v11, 0 op_sel:[0,0,0] op_sel_hi:[1,0,0]
    v_fma_mix_f32 v71, v95, v11, 0 op_sel:[1,0,0] op_sel_hi:[1,0,0]
    v_cvt_pk_bf16_f32 v72, v56, v57
    v_cvt_pk_bf16_f32 v73, v58, v59
    v_cvt_pk_bf16_f32 v74, v60, v61
    v_cvt_pk_bf16_f32 v75, v62, v63
    v_cvt_pk_bf16_f32 v76, v64, v65
    v_cvt_pk_bf16_f32 v77, v66, v67
    v_cvt_pk_bf16_f32 v78, v68, v69
    v_cvt_pk_bf16_f32 v79, v70, v71
    v_lshlrev_b32 v56, 16, v72
    v_and_b32 v57, 0xffff0000, v72
    v_lshlrev_b32 v58, 16, v73
    v_and_b32 v59, 0xffff0000, v73
    v_lshlrev_b32 v60, 16, v74
    v_and_b32 v61, 0xffff0000, v74
    v_lshlrev_b32 v62, 16, v75
    v_and_b32 v63, 0xffff0000, v75
    v_lshlrev_b32 v64, 16, v76
    v_and_b32 v65, 0xffff0000, v76
    v_lshlrev_b32 v66, 16, v77
    v_and_b32 v67, 0xffff0000, v77
    v_lshlrev_b32 v68, 16, v78
    v_and_b32 v69, 0xffff0000, v78
    v_lshlrev_b32 v70, 16, v79
    v_and_b32 v71, 0xffff0000, v79
    v_add_f32 v40, v40, v56
    v_add_f32 v41, v41, v57
    v_add_f32 v42, v42, v58
    v_add_f32 v43, v43, v59
    v_add_f32 v44, v44, v60
    v_add_f32 v45, v45, v61
    v_add_f32 v46, v46, v62
    v_add_f32 v47, v47, v63
    v_add_f32 v48, v48, v64
    v_add_f32 v49, v49, v65
    v_add_f32 v50, v50, v66
    v_add_f32 v51, v51, v67
    v_add_f32 v52, v52, v68
    v_add_f32 v53, v53, v69
    v_add_f32 v54, v54, v70
    v_add_f32 v55, v55, v71
    v_cvt_pk_bf16_f32 v72, v40, v41
    v_cvt_pk_bf16_f32 v73, v42, v43
    v_cvt_pk_bf16_f32 v74, v44, v45
    v_cvt_pk_bf16_f32 v75, v46, v47
    v_cvt_pk_bf16_f32 v76, v48, v49
    v_cvt_pk_bf16_f32 v77, v50, v51
    v_cvt_pk_bf16_f32 v78, v52, v53
    v_cvt_pk_bf16_f32 v79, v54, v55
    v_lshlrev_b32 v40, 16, v72
    v_and_b32 v41, 0xffff0000, v72
    v_lshlrev_b32 v42, 16, v73
    v_and_b32 v43, 0xffff0000, v73
    v_lshlrev_b32 v56, 16, v32
    v_and_b32 v57, 0xffff0000, v32
    v_lshlrev_b32 v58, 16, v33
    v_and_b32 v59, 0xffff0000, v33
    v_lshlrev_b32 v44, 16, v74
    v_and_b32 v45, 0xffff0000, v74
    v_lshlrev_b32 v46, 16, v75
    v_and_b32 v47, 0xffff0000, v75
    v_lshlrev_b32 v60, 16, v34
    v_and_b32 v61, 0xffff0000, v34
    v_lshlrev_b32 v62, 16, v35
    v_and_b32 v63, 0xffff0000, v35
    v_lshlrev_b32 v48, 16, v76
    v_and_b32 v49, 0xffff0000, v76
    v_lshlrev_b32 v50, 16, v77
    v_and_b32 v51, 0xffff0000, v77
    v_lshlrev_b32 v64, 16, v36
    v_and_b32 v65, 0xffff0000, v36
    v_lshlrev_b32 v66, 16, v37
    v_and_b32 v67, 0xffff0000, v37
    v_lshlrev_b32 v52, 16, v78
    v_and_b32 v53, 0xffff0000, v78
    v_lshlrev_b32 v54, 16, v79
    v_and_b32 v55, 0xffff0000, v79
    v_lshlrev_b32 v68, 16, v38
    v_and_b32 v69, 0xffff0000, v38
    v_lshlrev_b32 v70, 16, v39
    v_and_b32 v71, 0xffff0000, v39
    v_add_f32 v40, v40, v56
    v_add_f32 v41, v41, v57
    v_add_f32 v42, v42, v58
    v_add_f32 v43, v43, v59
    v_add_f32 v44, v44, v60
    v_add_f32 v45, v45, v61
    v_add_f32 v46, v46, v62
    v_add_f32 v47, v47, v63
    v_add_f32 v48, v48, v64
    v_add_f32 v49, v49, v65
    v_add_f32 v50, v50, v66
    v_add_f32 v51, v51, v67
    v_add_f32 v52, v52, v68
    v_add_f32 v53, v53, v69
    v_add_f32 v54, v54, v70
    v_add_f32 v55, v55, v71
    v_cvt_pk_bf16_f32 v72, v40, v41
    v_cvt_pk_bf16_f32 v73, v42, v43
    v_cvt_pk_bf16_f32 v74, v44, v45
    v_cvt_pk_bf16_f32 v75, v46, v47
    v_cvt_pk_bf16_f32 v76, v48, v49
    v_cvt_pk_bf16_f32 v77, v50, v51
    v_cvt_pk_bf16_f32 v78, v52, v53
    v_cvt_pk_bf16_f32 v79, v54, v55
    s_add_u32 s50, s32, 10485760
    s_addc_u32 s51, s33, 0
    global_store_dwordx2 v9, v[72:73], s[50:51] offset:0 sc1
    global_store_dwordx2 v9, v[74:75], s[50:51] offset:512 sc1
    global_store_dwordx2 v9, v[76:77], s[50:51] offset:1024 sc1
    global_store_dwordx2 v9, v[78:79], s[50:51] offset:1536 sc1
    s_branch L_b_done
L_b_p2:
    ds_read_b128 v[40:43], v2 offset:1088
    ds_read_b128 v[44:47], v5 offset:2496
    ds_read_b128 v[48:51], v5 offset:3008
    ds_read_b128 v[52:55], v2 offset:1024
    ds_read_b128 v[56:59], v5 offset:2432
    ds_read_b128 v[60:63], v5 offset:2944
    ds_read_b128 v[64:67], v2 offset:960
    ds_read_b128 v[68:71], v5 offset:2368
    ds_read_b128 v[72:75], v5 offset:2880
    ds_read_b128 v[76:79], v2 offset:896
    ds_read_b128 v[80:83], v5 offset:2304
    s_waitcnt lgkmcnt(8)
    v_mfma_f32_16x16x32_f16 v[16:19], v[40:43], v[44:47], 0
    ds_read_b128 v[84:87], v5 offset:2816
    v_mfma_f32_16x16x32_f16 v[20:23], v[40:43], v[48:51], 0
    ds_read_b128 v[40:43], v2 offset:832
    ds_read_b128 v[44:47], v5 offset:2240
    s_waitcnt lgkmcnt(8)
    v_mfma_f32_16x16x32_f16 v[16:19], v[52:55], v[56:59], v[16:19]
    ds_read_b128 v[48:51], v5 offset:2752
    v_mfma_f32_16x16x32_f16 v[20:23], v[52:55], v[60:63], v[20:23]
    ds_read_b128 v[52:55], v2 offset:768
    ds_read_b128 v[56:59], v5 offset:2176
    s_waitcnt lgkmcnt(8)
    v_mfma_f32_16x16x32_f16 v[16:19], v[64:67], v[68:71], v[16:19]
    ds_read_b128 v[60:63], v5 offset:2688
    v_mfma_f32_16x16x32_f16 v[20:23], v[64:67], v[72:75], v[20:23]
    ds_read_b128 v[64:67], v2 offset:704
    ds_read_b128 v[68:71], v5 offset:2112
    s_waitcnt lgkmcnt(8)
    v_mfma_f32_16x16x32_f16 v[16:19], v[76:79], v[80:83], v[16:19]
    ds_read_b128 v[72:75], v5 offset:2624
    v_mfma_f32_16x16x32_f16 v[20:23], v[76:79], v[84:87], v[20:23]
    ds_read_b128 v[76:79], v2 offset:640
    ds_read_b128 v[80:83], v5 offset:2048
    s_waitcnt lgkmcnt(8)
    v_mfma_f32_16x16x32_f16 v[16:19], v[40:43], v[44:47], v[16:19]
    ds_read_b128 v[84:87], v5 offset:2560
    v_mfma_f32_16x16x32_f16 v[20:23], v[40:43], v[48:51], v[20:23]
    ds_read_b128 v[40:43], v2 offset:576
    ds_read_b128 v[44:47], v5 offset:1984
    s_waitcnt lgkmcnt(8)
    v_mfma_f32_16x16x32_f16 v[16:19], v[52:55], v[56:59], v[16:19]
    ds_read_b128 v[48:51], v5 offset:2496
    v_mfma_f32_16x16x32_f16 v[20:23], v[52:55], v[60:63], v[20:23]
    ds_read_b128 v[52:55], v2 offset:512
    ds_read_b128 v[56:59], v5 offset:1920
    s_waitcnt lgkmcnt(8)
    v_mfma_f32_16x16x32_f16 v[16:19], v[64:67], v[68:71], v[16:19]
    ds_read_b128 v[60:63], v5 offset:2432
    v_mfma_f32_16x16x32_f16 v[20:23], v[64:67], v[72:75], v[20:23]
    ds_read_b128 v[64:67], v2 offset:448
    ds_read_b128 v[68:71], v5 offset:1856
    s_waitcnt lgkmcnt(8)
    v_mfma_f32_16x16x32_f16 v[16:19], v[76:79], v[80:83], v[16:19]
    ds_read_b128 v[72:75], v5 offset:2368
    v_mfma_f32_16x16x32_f16 v[20:23], v[76:79], v[84:87], v[20:23]
    ds_read_b128 v[76:79], v2 offset:384
    ds_read_b128 v[80:83], v5 offset:1792
    s_waitcnt lgkmcnt(8)
    v_mfma_f32_16x16x32_f16 v[16:19], v[40:43], v[44:47], v[16:19]
    ds_read_b128 v[84:87], v5 offset:2304
    v_mfma_f32_16x16x32_f16 v[20:23], v[40:43], v[48:51], v[20:23]
    ds_read_b128 v[40:43], v2 offset:320
    ds_read_b128 v[44:47], v5 offset:1728
    s_waitcnt lgkmcnt(8)
    v_mfma_f32_16x16x32_f16 v[16:19], v[52:55], v[56:59], v[16:19]
    ds_read_b128 v[48:51], v5 offset:2240
    v_mfma_f32_16x16x32_f16 v[20:23], v[52:55], v[60:63], v[20:23]
    ds_read_b128 v[52:55], v2 offset:256
    ds_read_b128 v[56:59], v5 offset:1664
    s_waitcnt lgkmcnt(8)
    v_mfma_f32_16x16x32_f16 v[16:19], v[64:67], v[68:71], v[16:19]
    ds_read_b128 v[60:63], v5 offset:2176
    v_mfma_f32_16x16x32_f16 v[20:23], v[64:67], v[72:75], v[20:23]
    ds_read_b128 v[64:67], v2 offset:192
    ds_read_b128 v[68:71], v5 offset:1600
    s_waitcnt lgkmcnt(8)
    v_mfma_f32_16x16x32_f16 v[16:19], v[76:79], v[80:83], v[16:19]
    ds_read_b128 v[72:75], v5 offset:2112
    v_mfma_f32_16x16x32_f16 v[20:23], v[76:79], v[84:87], v[20:23]
    ds_read_b128 v[76:79], v2 offset:128
    ds_read_b128 v[80:83], v5 offset:1536
    s_waitcnt lgkmcnt(8)
    v_mfma_f32_16x16x32_f16 v[16:19], v[40:43], v[44:47], v[16:19]
    ds_read_b128 v[84:87], v5 offset:2048
    v_mfma_f32_16x16x32_f16 v[20:23], v[40:43], v[48:51], v[20:23]
    ds_read_b128 v[40:43], v2 offset:64
    ds_read_b128 v[44:47], v5 offset:1472
    s_waitcnt lgkmcnt(8)
    v_mfma_f32_16x16x32_f16 v[16:19], v[52:55], v[56:59], v[16:19]
    ds_read_b128 v[48:51], v5 offset:1984
    v_mfma_f32_16x16x32_f16 v[20:23], v[52:55], v[60:63], v[20:23]
    ds_read_b128 v[52:55], v2 offset:0
    ds_read_b128 v[56:59], v5 offset:448
    s_waitcnt lgkmcnt(8)
    v_mfma_f32_16x16x32_f16 v[16:19], v[64:67], v[68:71], v[16:19]
    ds_read_b128 v[60:63], v5 offset:960
    v_mfma_f32_16x16x32_f16 v[20:23], v[64:67], v[72:75], v[20:23]
    ds_read_b128 v[64:67], v4 offset:128
    ds_read_b64_tr_b16 v[68:69], v6 offset:5640
    s_waitcnt lgkmcnt(8)
    v_mfma_f32_16x16x32_f16 v[16:19], v[76:79], v[80:83], v[16:19]
    ds_read_b64_tr_b16 v[70:71], v6 offset:5704
    ds_read_b64_tr_b16 v[72:73], v6 offset:6152
    v_mfma_f32_16x16x32_f16 v[20:23], v[76:79], v[84:87], v[20:23]
    ds_read_b64_tr_b16 v[74:75], v6 offset:6216
    ds_read_b128 v[76:79], v4 offset:64
    s_waitcnt lgkmcnt(9)
    v_mfma_f32_16x16x32_f16 v[16:19], v[40:43], v[44:47], v[16:19]
    ds_read_b64_tr_b16 v[80:81], v6 offset:5128
    ds_read_b64_tr_b16 v[82:83], v6 offset:5192
    v_mfma_f32_16x16x32_f16 v[20:23], v[40:43], v[48:51], v[20:23]
    ds_read_b64_tr_b16 v[84:85], v6 offset:5640
    ds_read_b64_tr_b16 v[86:87], v6 offset:5704
    s_waitcnt lgkmcnt(10)
    v_mfma_f32_16x16x32_f16 v[16:19], v[52:55], v[56:59], v[16:19]
    ds_read_b128 v[40:43], v4 offset:0
    v_mfma_f32_16x16x32_f16 v[20:23], v[52:55], v[60:63], v[20:23]
    ds_read_b64_tr_b16 v[44:45], v6 offset:4616
    ds_read_b64_tr_b16 v[46:47], v6 offset:4680
    s_waitcnt lgkmcnt(8)
    v_mfma_f32_16x16x32_f16 v[16:19], v[68:71], v[64:67], v[16:19]
    ds_read_b64_tr_b16 v[48:49], v6 offset:5128
    ds_read_b64_tr_b16 v[50:51], v6 offset:5192
    v_mfma_f32_16x16x32_f16 v[20:23], v[72:75], v[64:67], v[20:23]
    ds_read_b128 v[52:55], v4 offset:368
    ds_read_b64_tr_b16 v[56:57], v6 offset:8752
    s_waitcnt lgkmcnt(7)
    v_mfma_f32_16x16x32_f16 v[16:19], v[80:83], v[76:79], v[16:19]
    ds_read_b64_tr_b16 v[58:59], v6 offset:8816
    ds_read_b64_tr_b16 v[60:61], v6 offset:9264
    v_mfma_f32_16x16x32_f16 v[20:23], v[84:87], v[76:79], v[20:23]
    ds_read_b64_tr_b16 v[62:63], v6 offset:9328
    ds_read_b128 v[64:67], v4 offset:304
    s_waitcnt lgkmcnt(6)
    v_mfma_f32_16x16x32_f16 v[16:19], v[44:47], v[40:43], v[16:19]
    ds_read_b64_tr_b16 v[68:69], v6 offset:8240
    ds_read_b64_tr_b16 v[70:71], v6 offset:8304
    v_mfma_f32_16x16x32_f16 v[20:23], v[48:51], v[40:43], v[20:23]
    ds_read_b64_tr_b16 v[72:73], v6 offset:8752
    ds_read_b64_tr_b16 v[74:75], v6 offset:8816
    s_waitcnt lgkmcnt(5)
    v_mfma_f32_16x16x32_f16 v[16:19], v[56:59], v[52:55], v[16:19]
    ds_read_b128 v[76:79], v4 offset:240
    ds_read_b64_tr_b16 v[80:81], v6 offset:7728
    v_mfma_f32_16x16x32_f16 v[20:23], v[60:63], v[52:55], v[20:23]
    ds_read_b64_tr_b16 v[82:83], v6 offset:7792
    ds_read_b64_tr_b16 v[84:85], v6 offset:8240
    s_waitcnt lgkmcnt(4)
    v_mfma_f32_16x16x32_f16 v[16:19], v[68:71], v[64:67], v[16:19]
    ds_read_b64_tr_b16 v[86:87], v6 offset:8304
    ds_read_b128 v[40:43], v3 offset:1264
    v_mfma_f32_16x16x32_f16 v[20:23], v[72:75], v[64:67], v[20:23]
    ds_read_b64_tr_b16 v[44:45], v7 offset:10824
    ds_read_b64_tr_b16 v[46:47], v7 offset:10952
    s_waitcnt lgkmcnt(3)
    v_mfma_f32_16x16x32_f16 v[16:19], v[80:83], v[76:79], v[16:19]
    ds_read_b128 v[48:51], v3 offset:1232
    ds_read_b64_tr_b16 v[52:53], v7 offset:10824
    v_mfma_f32_16x16x32_f16 v[20:23], v[84:87], v[76:79], v[20:23]
    ds_read_b64_tr_b16 v[54:55], v7 offset:10952
    ds_read_b128 v[56:59], v3 offset:1440
    s_waitcnt lgkmcnt(1)
    v_mfma_f32_16x16x32_f16 v[16:19], v[44:47], v[40:43], v[16:19]
    ds_read_b64_tr_b16 v[60:61], v7 offset:12920
    ds_read_b64_tr_b16 v[62:63], v7 offset:13048
    v_mfma_f32_16x16x32_f16 v[20:23], v[52:55], v[48:51], v[20:23]
    ds_read_b128 v[64:67], v3 offset:1408
    ds_read_b64_tr_b16 v[68:69], v7 offset:12920
    s_waitcnt lgkmcnt(2)
    v_mfma_f32_16x16x32_f16 v[16:19], v[60:63], v[56:59], v[16:19]
    ds_read_b64_tr_b16 v[70:71], v7 offset:13048
    s_waitcnt lgkmcnt(0)
    v_mfma_f32_16x16x32_f16 v[20:23], v[68:71], v[64:67], v[20:23]
    ds_read_b64 v[88:89], v8 offset:2048
    ds_read_b64 v[90:91], v8 offset:2560
    s_nop 2
    v_mul_f32 v40, v16, v10
    v_mul_f32 v41, v17, v10
    v_mul_f32 v42, v18, v10
    v_mul_f32 v43, v19, v10
    v_mul_f32 v44, v20, v10
    v_mul_f32 v45, v21, v10
    v_mul_f32 v46, v22, v10
    v_mul_f32 v47, v23, v10
    v_cvt_pk_bf16_f32 v72, v40, v41
    v_cvt_pk_bf16_f32 v73, v42, v43
    v_cvt_pk_bf16_f32 v74, v44, v45
    v_cvt_pk_bf16_f32 v75, v46, v47
    v_lshlrev_b32 v40, 16, v72
    v_and_b32 v41, 0xffff0000, v72
    v_lshlrev_b32 v42, 16, v73
    v_and_b32 v43, 0xffff0000, v73
    v_lshlrev_b32 v44, 16, v74
    v_and_b32 v45, 0xffff0000, v74
    v_lshlrev_b32 v46, 16, v75
    v_and_b32 v47, 0xffff0000, v75
    s_waitcnt vmcnt(0) lgkmcnt(0)
    v_fma_mix_f32 v56, v88, v11, 0 op_sel:[0,0,0] op_sel_hi:[1,0,0]
    v_fma_mix_f32 v57, v88, v11, 0 op_sel:[1,0,0] op_sel_hi:[1,0,0]
    v_fma_mix_f32 v58, v89, v11, 0 op_sel:[0,0,0] op_sel_hi:[1,0,0]
    v_fma_mix_f32 v59, v89, v11, 0 op_sel:[1,0,0] op_sel_hi:[1,0,0]
    v_fma_mix_f32 v60, v90, v11, 0 op_sel:[0,0,0] op_sel_hi:[1,0,0]
    v_fma_mix_f32 v61, v90, v11, 0 op_sel:[1,0,0] op_sel_hi:[1,0,0]
    v_fma_mix_f32 v62, v91, v11, 0 op_sel:[0,0,0] op_sel_hi:[1,0,0]
    v_fma_mix_f32 v63, v91, v11, 0 op_sel:[1,0,0] op_sel_hi:[1,0,0]
    v_cvt_pk_bf16_f32 v72, v56, v57
    v_cvt_pk_bf16_f32 v73, v58, v59
    v_cvt_pk_bf16_f32 v74, v60, v61
    v_cvt_pk_bf16_f32 v75, v62, v63
    v_lshlrev_b32 v56, 16, v72
    v_and_b32 v57, 0xffff0000, v72
    v_lshlrev_b32 v58, 16, v73
    v_and_b32 v59, 0xffff0000, v73
    v_lshlrev_b32 v60, 16, v74
    v_and_b32 v61, 0xffff0000, v74
    v_lshlrev_b32 v62, 16, v75
    v_and_b32 v63, 0xffff0000, v75
    v_add_f32 v40, v40, v56
    v_add_f32 v41, v41, v57
    v_add_f32 v42, v42, v58
    v_add_f32 v43, v43, v59
    v_add_f32 v44, v44, v60
    v_add_f32 v45, v45, v61
    v_add_f32 v46, v46, v62
    v_add_f32 v47, v47, v63
    v_cvt_pk_bf16_f32 v72, v40, v41
    v_cvt_pk_bf16_f32 v73, v42, v43
    v_cvt_pk_bf16_f32 v74, v44, v45
    v_cvt_pk_bf16_f32 v75, v46, v47
    v_lshlrev_b32 v40, 16, v72
    v_and_b32 v41, 0xffff0000, v72
    v_lshlrev_b32 v42, 16, v73
    v_and_b32 v43, 0xffff0000, v73
    v_lshlrev_b32 v56, 16, v32
    v_and_b32 v57, 0xffff0000, v32
    v_lshlrev_b32 v58, 16, v33
    v_and_b32 v59, 0xffff0000, v33
    v_lshlrev_b32 v44, 16, v74
    v_and_b32 v45, 0xffff0000, v74
    v_lshlrev_b32 v46, 16, v75
    v_and_b32 v47, 0xffff0000, v75
    v_lshlrev_b32 v60, 16, v34
    v_and_b32 v61, 0xffff0000, v34
    v_lshlrev_b32 v62, 16, v35
    v_and_b32 v63, 0xffff0000, v35
    v_add_f32 v40, v40, v56
    v_add_f32 v41, v41, v57
    v_add_f32 v42, v42, v58
    v_add_f32 v43, v43, v59
    v_add_f32 v44, v44, v60
    v_add_f32 v45, v45, v61
    v_add_f32 v46, v46, v62
    v_add_f32 v47, v47, v63
    v_cvt_pk_bf16_f32 v72, v40, v41
    v_cvt_pk_bf16_f32 v73, v42, v43
    v_cvt_pk_bf16_f32 v74, v44, v45
    v_cvt_pk_bf16_f32 v75, v46, v47
    s_add_u32 s50, s32, 10485760
    s_addc_u32 s51, s33, 0
    global_store_dwordx2 v9, v[72:73], s[50:51] offset:2048 sc1
    global_store_dwordx2 v9, v[74:75], s[50:51] offset:2560 sc1
    s_branch L_b_done
L_b_p3:
    ds_read_b128 v[40:43], v2 offset:1088
    ds_read_b128 v[44:47], v5 offset:3520
    ds_read_b128 v[48:51], v5 offset:4032
    ds_read_b128 v[52:55], v2 offset:1024
    ds_read_b128 v[56:59], v5 offset:3456
    ds_read_b128 v[60:63], v5 offset:3968
    ds_read_b128 v[64:67], v2 offset:960
    ds_read_b128 v[68:71], v5 offset:3392
    ds_read_b128 v[72:75], v5 offset:3904
    ds_read_b128 v[76:79], v2 offset:896
    ds_read_b128 v[80:83], v5 offset:3328
    s_waitcnt lgkmcnt(8)
    v_mfma_f32_16x16x32_f16 v[16:19], v[40:43], v[44:47], 0
    ds_read_b128 v[84:87], v5 offset:3840
    v_mfma_f32_16x16x32_f16 v[20:23], v[40:43], v[48:51], 0
    ds_read_b128 v[40:43], v2 offset:832
    ds_read_b128 v[44:47], v5 offset:3264
    s_waitcnt lgkmcnt(8)
    v_mfma_f32_16x16x32_f16 v[16:19], v[52:55], v[56:59], v[16:19]
    ds_read_b128 v[48:51], v5 offset:3776
    v_mfma_f32_16x16x32_f16 v[20:23], v[52:55], v[60:63], v[20:23]
    ds_read_b128 v[52:55], v2 offset:768
    ds_read_b128 v[56:59], v5 offset:3200
    s_waitcnt lgkmcnt(8)
    v_mfma_f32_16x16x32_f16 v[16:19], v[64:67], v[68:71], v[16:19]
    ds_read_b128 v[60:63], v5 offset:3712
    v_mfma_f32_16x16x32_f16 v[20:23], v[64:67], v[72:75], v[20:23]
    ds_read_b128 v[64:67], v2 offset:704
    ds_read_b128 v[68:71], v5 offset:3136
    s_waitcnt lgkmcnt(8)
    v_mfma_f32_16x16x32_f16 v[16:19], v[76:79], v[80:83], v[16:19]
    ds_read_b128 v[72:75], v5 offset:3648
    v_mfma_f32_16x16x32_f16 v[20:23], v[76:79], v[84:87], v[20:23]
    ds_read_b128 v[76:79], v2 offset:640
    ds_read_b128 v[80:83], v5 offset:3072
    s_waitcnt lgkmcnt(8)
    v_mfma_f32_16x16x32_f16 v[16:19], v[40:43], v[44:47], v[16:19]
    ds_read_b128 v[84:87], v5 offset:3584
    v_mfma_f32_16x16x32_f16 v[20:23], v[40:43], v[48:51], v[20:23]
    ds_read_b128 v[40:43], v2 offset:576
    ds_read_b128 v[44:47], v5 offset:3008
    s_waitcnt lgkmcnt(8)
    v_mfma_f32_16x16x32_f16 v[16:19], v[52:55], v[56:59], v[16:19]
    ds_read_b128 v[48:51], v5 offset:3520
    v_mfma_f32_16x16x32_f16 v[20:23], v[52:55], v[60:63], v[20:23]
    ds_read_b128 v[52:55], v2 offset:512
    ds_read_b128 v[56:59], v5 offset:2944
    s_waitcnt lgkmcnt(8)
    v_mfma_f32_16x16x32_f16 v[16:19], v[64:67], v[68:71], v[16:19]
    ds_read_b128 v[60:63], v5 offset:3456
    v_mfma_f32_16x16x32_f16 v[20:23], v[64:67], v[72:75], v[20:23]
    ds_read_b128 v[64:67], v2 offset:448
    ds_read_b128 v[68:71], v5 offset:2880
    s_waitcnt lgkmcnt(8)
    v_mfma_f32_16x16x32_f16 v[16:19], v[76:79], v[80:83], v[16:19]
    ds_read_b128 v[72:75], v5 offset:3392
    v_mfma_f32_16x16x32_f16 v[20:23], v[76:79], v[84:87], v[20:23]
    ds_read_b128 v[76:79], v2 offset:384
    ds_read_b128 v[80:83], v5 offset:2816
    s_waitcnt lgkmcnt(8)
    v_mfma_f32_16x16x32_f16 v[16:19], v[40:43], v[44:47], v[16:19]
    ds_read_b128 v[84:87], v5 offset:3328
    v_mfma_f32_16x16x32_f16 v[20:23], v[40:43], v[48:51], v[20:23]
    ds_read_b128 v[40:43], v2 offset:320
    ds_read_b128 v[44:47], v5 offset:2752
    s_waitcnt lgkmcnt(8)
    v_mfma_f32_16x16x32_f16 v[16:19], v[52:55], v[56:59], v[16:19]
    ds_read_b128 v[48:51], v5 offset:3264
    v_mfma_f32_16x16x32_f16 v[20:23], v[52:55], v[60:63], v[20:23]
    ds_read_b128 v[52:55], v2 offset:256
    ds_read_b128 v[56:59], v5 offset:2688
    s_waitcnt lgkmcnt(8)
    v_mfma_f32_16x16x32_f16 v[16:19], v[64:67], v[68:71], v[16:19]
    ds_read_b128 v[60:63], v5 offset:3200
    v_mfma_f32_16x16x32_f16 v[20:23], v[64:67], v[72:75], v[20:23]
    ds_read_b128 v[64:67], v2 offset:192
    ds_read_b128 v[68:71], v5 offset:2624
    s_waitcnt lgkmcnt(8)
    v_mfma_f32_16x16x32_f16 v[16:19], v[76:79], v[80:83], v[16:19]
    ds_read_b128 v[72:75], v5 offset:3136
    v_mfma_f32_16x16x32_f16 v[20:23], v[76:79], v[84:87], v[20:23]
    ds_read_b128 v[76:79], v2 offset:128
    ds_read_b128 v[80:83], v5 offset:2560
    s_waitcnt lgkmcnt(8)
    v_mfma_f32_16x16x32_f16 v[16:19], v[40:43], v[44:47], v[16:19]
    ds_read_b128 v[84:87], v5 offset:3072
    v_mfma_f32_16x16x32_f16 v[20:23], v[40:43], v[48:51], v[20:23]
    ds_read_b128 v[40:43], v2 offset:64
    ds_read_b128 v[44:47], v5 offset:2496
    s_waitcnt lgkmcnt(8)
    v_mfma_f32_16x16x32_f16 v[16:19], v[52:55], v[56:59], v[16:19]
    ds_read_b128 v[48:51], v5 offset:3008
    v_mfma_f32_16x16x32_f16 v[20:23], v[52:55], v[60:63], v[20:23]
    ds_read_b128 v[52:55], v2 offset:0
    ds_read_b128 v[56:59], v5 offset:1472
    s_waitcnt lgkmcnt(8)
    v_mfma_f32_16x16x32_f16 v[16:19], v[64:67], v[68:71], v[16:19]
    ds_read_b128 v[60:63], v5 offset:1984
    v_mfma_f32_16x16x32_f16 v[20:23], v[64:67], v[72:75], v[20:23]
    ds_read_b128 v[64:67], v4 offset:128
    ds_read_b64_tr_b16 v[68:69], v6 offset:6664
    s_waitcnt lgkmcnt(8)
    v_mfma_f32_16x16x32_f16 v[16:19], v[76:79], v[80:83], v[16:19]
    ds_read_b64_tr_b16 v[70:71], v6 offset:6728
    ds_read_b64_tr_b16 v[72:73], v6 offset:7176
    v_mfma_f32_16x16x32_f16 v[20:23], v[76:79], v[84:87], v[20:23]
    ds_read_b64_tr_b16 v[74:75], v6 offset:7240
    ds_read_b128 v[76:79], v4 offset:64
    s_waitcnt lgkmcnt(9)
    v_mfma_f32_16x16x32_f16 v[16:19], v[40:43], v[44:47], v[16:19]
    ds_read_b64_tr_b16 v[80:81], v6 offset:6152
    ds_read_b64_tr_b16 v[82:83], v6 offset:6216
    v_mfma_f32_16x16x32_f16 v[20:23], v[40:43], v[48:51], v[20:23]
    ds_read_b64_tr_b16 v[84:85], v6 offset:6664
    ds_read_b64_tr_b16 v[86:87], v6 offset:6728
    s_waitcnt lgkmcnt(10)
    v_mfma_f32_16x16x32_f16 v[16:19], v[52:55], v[56:59], v[16:19]
    ds_read_b128 v[40:43], v4 offset:0
    v_mfma_f32_16x16x32_f16 v[20:23], v[52:55], v[60:63], v[20:23]
    ds_read_b64_tr_b16 v[44:45], v6 offset:5640
    ds_read_b64_tr_b16 v[46:47], v6 offset:5704
    s_waitcnt lgkmcnt(8)
    v_mfma_f32_16x16x32_f16 v[16:19], v[68:71], v[64:67], v[16:19]
    ds_read_b64_tr_b16 v[48:49], v6 offset:6152
    ds_read_b64_tr_b16 v[50:51], v6 offset:6216
    v_mfma_f32_16x16x32_f16 v[20:23], v[72:75], v[64:67], v[20:23]
    ds_read_b128 v[52:55], v4 offset:368
    ds_read_b64_tr_b16 v[56:57], v6 offset:9776
    s_waitcnt lgkmcnt(7)
    v_mfma_f32_16x16x32_f16 v[16:19], v[80:83], v[76:79], v[16:19]
    ds_read_b64_tr_b16 v[58:59], v6 offset:9840
    ds_read_b64_tr_b16 v[60:61], v6 offset:10288
    v_mfma_f32_16x16x32_f16 v[20:23], v[84:87], v[76:79], v[20:23]
    ds_read_b64_tr_b16 v[62:63], v6 offset:10352
    ds_read_b128 v[64:67], v4 offset:304
    s_waitcnt lgkmcnt(6)
    v_mfma_f32_16x16x32_f16 v[16:19], v[44:47], v[40:43], v[16:19]
    ds_read_b64_tr_b16 v[68:69], v6 offset:9264
    ds_read_b64_tr_b16 v[70:71], v6 offset:9328
    v_mfma_f32_16x16x32_f16 v[20:23], v[48:51], v[40:43], v[20:23]
    ds_read_b64_tr_b16 v[72:73], v6 offset:9776
    ds_read_b64_tr_b16 v[74:75], v6 offset:9840
    s_waitcnt lgkmcnt(5)
    v_mfma_f32_16x16x32_f16 v[16:19], v[56:59], v[52:55], v[16:19]
    ds_read_b128 v[76:79], v4 offset:240
    ds_read_b64_tr_b16 v[80:81], v6 offset:8752
    v_mfma_f32_16x16x32_f16 v[20:23], v[60:63], v[52:55], v[20:23]
    ds_read_b64_tr_b16 v[82:83], v6 offset:8816
    ds_read_b64_tr_b16 v[84:85], v6 offset:9264
    s_waitcnt lgkmcnt(4)
    v_mfma_f32_16x16x32_f16 v[16:19], v[68:71], v[64:67], v[16:19]
    ds_read_b64_tr_b16 v[86:87], v6 offset:9328
    ds_read_b128 v[40:43], v3 offset:1264
    v_mfma_f32_16x16x32_f16 v[20:23], v[72:75], v[64:67], v[20:23]
    ds_read_b64_tr_b16 v[44:45], v7 offset:11848
    ds_read_b64_tr_b16 v[46:47], v7 offset:11976
    s_waitcnt lgkmcnt(3)
    v_mfma_f32_16x16x32_f16 v[16:19], v[80:83], v[76:79], v[16:19]
    ds_read_b128 v[48:51], v3 offset:1232
    ds_read_b64_tr_b16 v[52:53], v7 offset:11848
    v_mfma_f32_16x16x32_f16 v[20:23], v[84:87], v[76:79], v[20:23]
    ds_read_b64_tr_b16 v[54:55], v7 offset:11976
    ds_read_b128 v[56:59], v3 offset:1200
    s_waitcnt lgkmcnt(1)
    v_mfma_f32_16x16x32_f16 v[16:19], v[44:47], v[40:43], v[16:19]
    ds_read_b64_tr_b16 v[60:61], v7 offset:10824
    ds_read_b64_tr_b16 v[62:63], v7 offset:10952
    v_mfma_f32_16x16x32_f16 v[20:23], v[52:55], v[48:51], v[20:23]
    ds_read_b128 v[64:67], v3 offset:1168
    ds_read_b64_tr_b16 v[68:69], v7 offset:10824
    ds_read_b64_tr_b16 v[70:71], v7 offset:10952
    s_waitcnt lgkmcnt(0)
    v_mfma_f32_16x16x32_f16 v[16:19], v[60:63], v[56:59], v[16:19]
    ds_read_b128 v[72:75], v3 offset:1440
    ds_read_b64_tr_b16 v[76:77], v7 offset:13944
    v_mfma_f32_16x16x32_f16 v[20:23], v[68:71], v[64:67], v[20:23]
    ds_read_b64_tr_b16 v[78:79], v7 offset:14072
    ds_read_b128 v[80:83], v3 offset:1408
    ds_read_b64_tr_b16 v[84:85], v7 offset:13944
    ds_read_b64_tr_b16 v[86:87], v7 offset:14072
    s_waitcnt lgkmcnt(0)
    v_mfma_f32_16x16x32_f16 v[16:19], v[76:79], v[72:75], v[16:19]
    ds_read_b128 v[40:43], v3 offset:1376
    ds_read_b64_tr_b16 v[44:45], v7 offset:12920
    v_mfma_f32_16x16x32_f16 v[20:23], v[84:87], v[80:83], v[20:23]
    ds_read_b64_tr_b16 v[46:47], v7 offset:13048
    ds_read_b128 v[48:51], v3 offset:1344
    s_waitcnt lgkmcnt(1)
    v_mfma_f32_16x16x32_f16 v[16:19], v[44:47], v[40:43], v[16:19]
    ds_read_b64_tr_b16 v[52:53], v7 offset:12920
    ds_read_b64_tr_b16 v[54:55], v7 offset:13048
    s_waitcnt lgkmcnt(0)
    v_mfma_f32_16x16x32_f16 v[20:23], v[52:55], v[48:51], v[20:23]
    ds_read_b64 v[88:89], v8 offset:3072
    ds_read_b64 v[90:91], v8 offset:3584
    s_nop 1
    v_mul_f32 v40, v16, v10
    v_mul_f32 v41, v17, v10
    v_mul_f32 v42, v18, v10
    v_mul_f32 v43, v19, v10
    v_mul_f32 v44, v20, v10
    v_mul_f32 v45, v21, v10
    v_mul_f32 v46, v22, v10
    v_mul_f32 v47, v23, v10
    v_cvt_pk_bf16_f32 v72, v40, v41
    v_cvt_pk_bf16_f32 v73, v42, v43
    v_cvt_pk_bf16_f32 v74, v44, v45
    v_cvt_pk_bf16_f32 v75, v46, v47
    v_lshlrev_b32 v40, 16, v72
    v_and_b32 v41, 0xffff0000, v72
    v_lshlrev_b32 v42, 16, v73
    v_and_b32 v43, 0xffff0000, v73
    v_lshlrev_b32 v44, 16, v74
    v_and_b32 v45, 0xffff0000, v74
    v_lshlrev_b32 v46, 16, v75
    v_and_b32 v47, 0xffff0000, v75
    s_waitcnt vmcnt(0) lgkmcnt(0)
    v_fma_mix_f32 v56, v88, v11, 0 op_sel:[0,0,0] op_sel_hi:[1,0,0]
    v_fma_mix_f32 v57, v88, v11, 0 op_sel:[1,0,0] op_sel_hi:[1,0,0]
    v_fma_mix_f32 v58, v89, v11, 0 op_sel:[0,0,0] op_sel_hi:[1,0,0]
    v_fma_mix_f32 v59, v89, v11, 0 op_sel:[1,0,0] op_sel_hi:[1,0,0]
    v_fma_mix_f32 v60, v90, v11, 0 op_sel:[0,0,0] op_sel_hi:[1,0,0]
    v_fma_mix_f32 v61, v90, v11, 0 op_sel:[1,0,0] op_sel_hi:[1,0,0]
    v_fma_mix_f32 v62, v91, v11, 0 op_sel:[0,0,0] op_sel_hi:[1,0,0]
    v_fma_mix_f32 v63, v91, v11, 0 op_sel:[1,0,0] op_sel_hi:[1,0,0]
    v_cvt_pk_bf16_f32 v72, v56, v57
    v_cvt_pk_bf16_f32 v73, v58, v59
    v_cvt_pk_bf16_f32 v74, v60, v61
    v_cvt_pk_bf16_f32 v75, v62, v63
    v_lshlrev_b32 v56, 16, v72
    v_and_b32 v57, 0xffff0000, v72
    v_lshlrev_b32 v58, 16, v73
    v_and_b32 v59, 0xffff0000, v73
    v_lshlrev_b32 v60, 16, v74
    v_and_b32 v61, 0xffff0000, v74
    v_lshlrev_b32 v62, 16, v75
    v_and_b32 v63, 0xffff0000, v75
    v_add_f32 v40, v40, v56
    v_add_f32 v41, v41, v57
    v_add_f32 v42, v42, v58
    v_add_f32 v43, v43, v59
    v_add_f32 v44, v44, v60
    v_add_f32 v45, v45, v61
    v_add_f32 v46, v46, v62
    v_add_f32 v47, v47, v63
    v_cvt_pk_bf16_f32 v72, v40, v41
    v_cvt_pk_bf16_f32 v73, v42, v43
    v_cvt_pk_bf16_f32 v74, v44, v45
    v_cvt_pk_bf16_f32 v75, v46, v47
    v_lshlrev_b32 v40, 16, v72
    v_and_b32 v41, 0xffff0000, v72
    v_lshlrev_b32 v42, 16, v73
    v_and_b32 v43, 0xffff0000, v73
    v_lshlrev_b32 v56, 16, v32
    v_and_b32 v57, 0xffff0000, v32
    v_lshlrev_b32 v58, 16, v33
    v_and_b32 v59, 0xffff0000, v33
    v_lshlrev_b32 v44, 16, v74
    v_and_b32 v45, 0xffff0000, v74
    v_lshlrev_b32 v46, 16, v75
    v_and_b32 v47, 0xffff0000, v75
    v_lshlrev_b32 v60, 16, v34
    v_and_b32 v61, 0xffff0000, v34
    v_lshlrev_b32 v62, 16, v35
    v_and_b32 v63, 0xffff0000, v35
    v_add_f32 v40, v40, v56
    v_add_f32 v41, v41, v57
    v_add_f32 v42, v42, v58
    v_add_f32 v43, v43, v59
    v_add_f32 v44, v44, v60
    v_add_f32 v45, v45, v61
    v_add_f32 v46, v46, v62
    v_add_f32 v47, v47, v63
    v_cvt_pk_bf16_f32 v72, v40, v41
    v_cvt_pk_bf16_f32 v73, v42, v43
    v_cvt_pk_bf16_f32 v74, v44, v45
    v_cvt_pk_bf16_f32 v75, v46, v47
    s_add_u32 s50, s32, 10485760
    s_addc_u32 s51, s33, 0
    global_store_dwordx2 v9, v[72:73], s[50:51] offset:3072 sc1
    global_store_dwordx2 v9, v[74:75], s[50:51] offset:3584 sc1
    s_branch L_b_done
L_b_done:
    s_cmp_eq_u32 s7, 1
    s_cbranch_scc1 L_final
    v_and_b32 v16, 15, v1
    v_lshrrev_b32 v17, 4, v1
    v_lshrrev_b32 v18, 2, v16
    v_and_b32 v19, 3, v1
    s_and_b32 s42, s3, 3
    s_lshr_b32 s43, s3, 2
    s_mul_i32 s43, s43, 48
    s_mul_i32 s44, s4, 80
    s_add_u32 s43, s43, s44
    v_mov_b32 v10, 0x3f803f80
    v_mov_b32 v11, 0x3f803f80
    v_mov_b32 v12, 0x3f803f80
    v_mov_b32 v13, 0x3f803f80
    v_lshl_add_u32 v20, v17, 2, v18
    v_mul_u32_u24 v20, 160, v20
    v_add_u32 v20, 61440, v20
    v_lshl_add_u32 v2, v19, 3, v20
    v_add_u32 v3, 61440, v2
    s_lshl_b32 s44, s42, 5
    s_add_u32 s44, s44, 61472
    v_lshl_add_u32 v20, v17, 3, s44
    s_lshl_b32 s44, s6, 5
    v_add_u32 v21, 0, v16
    v_add_u32 v21, s43, v21
    v_min_u32 v21, 639, v21
    v_xor_b32 v21, s44, v21
    v_and_b32 v22, 0x3e3, v21
    v_bfe_u32 v23, v21, 3, 2
    v_lshl_or_b32 v22, v23, 2, v22
    v_and_b32 v22, 0x3ef, v22
    v_bfe_u32 v23, v21, 2, 1
    v_lshl_or_b32 v22, v23, 4, v22
    v_mul_u32_u24 v22, 160, v22
    v_add_u32 v7, v22, v20
    v_add_u32 v21, 16, v16
    v_add_u32 v21, s43, v21
    v_min_u32 v21, 639, v21
    v_xor_b32 v21, s44, v21
    v_and_b32 v22, 0x3e3, v21
    v_bfe_u32 v23, v21, 3, 2
    v_lshl_or_b32 v22, v23, 2, v22
    v_and_b32 v22, 0x3ef, v22
    v_bfe_u32 v23, v21, 2, 1
    v_lshl_or_b32 v22, v23, 4, v22
    v_mul_u32_u24 v22, 160, v22
    v_add_u32 v8, v22, v20
    v_add_u32 v21, 32, v16
    v_add_u32 v21, s43, v21
    v_min_u32 v21, 639, v21
    v_xor_b32 v21, s44, v21
    v_and_b32 v22, 0x3e3, v21
    v_bfe_u32 v23, v21, 3, 2
    v_lshl_or_b32 v22, v23, 2, v22
    v_and_b32 v22, 0x3ef, v22
    v_bfe_u32 v23, v21, 2, 1
    v_lshl_or_b32 v22, v23, 4, v22
    v_mul_u32_u24 v22, 160, v22
    v_add_u32 v9, v22, v20
    s_lshl_b32 s44, s6, 5
    s_mov_b32 s45, 52429
    v_and_b32 v27, 255, v0
    v_add_u32 v4, 0, v27
    v_mul_u32_u24 v24, s45, v4
    v_lshrrev_b32 v24, 19, v24
    v_mul_u32_u24 v25, 10, v24
    v_sub_u32 v4, v4, v25
    v_xor_b32 v24, s44, v24
    v_and_b32 v25, 0xe3, v24
    v_bfe_u32 v26, v24, 2, 2
    v_lshl_or_b32 v25, v26, 3, v25
    v_bfe_u32 v26, v24, 4, 1
    v_lshl_or_b32 v25, v26, 2, v25
    v_lshlrev_b32 v25, 12, v25
    v_lshl_add_u32 v4, v4, 4, v25
    v_add_u32 v5, 256, v27
    v_mul_u32_u24 v24, s45, v5
    v_lshrrev_b32 v24, 19, v24
    v_mul_u32_u24 v25, 10, v24
    v_sub_u32 v5, v5, v25
    v_xor_b32 v24, s44, v24
    v_and_b32 v25, 0xe3, v24
    v_bfe_u32 v26, v24, 2, 2
    v_lshl_or_b32 v25, v26, 3, v25
    v_bfe_u32 v26, v24, 4, 1
    v_lshl_or_b32 v25, v26, 2, v25
    v_lshlrev_b32 v25, 12, v25
    v_lshl_add_u32 v5, v5, 4, v25
    v_add_u32 v6, 512, v27
    v_mul_u32_u24 v24, s45, v6
    v_lshrrev_b32 v24, 19, v24
    v_mul_u32_u24 v25, 10, v24
    v_sub_u32 v6, v6, v25
    v_xor_b32 v24, s44, v24
    v_and_b32 v25, 0xe3, v24
    v_bfe_u32 v26, v24, 2, 2
    v_lshl_or_b32 v25, v26, 3, v25
    v_bfe_u32 v26, v24, 4, 1
    v_lshl_or_b32 v25, v26, 2, v25
    v_lshlrev_b32 v25, 12, v25
    v_lshl_add_u32 v6, v6, 4, v25
    v_add_u32 v14, 768, v27
    v_mul_u32_u24 v24, s45, v14
    v_lshrrev_b32 v24, 19, v24
    v_mul_u32_u24 v25, 10, v24
    v_sub_u32 v14, v14, v25
    v_xor_b32 v24, s44, v24
    v_and_b32 v25, 0xe3, v24
    v_bfe_u32 v26, v24, 2, 2
    v_lshl_or_b32 v25, v26, 3, v25
    v_bfe_u32 v26, v24, 4, 1
    v_lshl_or_b32 v25, v26, 2, v25
    v_lshlrev_b32 v25, 12, v25
    v_lshl_add_u32 v14, v14, 4, v25
    v_add_u32 v15, 1024, v27
    v_mul_u32_u24 v24, s45, v15
    v_lshrrev_b32 v24, 19, v24
    v_mul_u32_u24 v25, 10, v24
    v_sub_u32 v15, v15, v25
    v_xor_b32 v24, s44, v24
    v_and_b32 v25, 0xe3, v24
    v_bfe_u32 v26, v24, 2, 2
    v_lshl_or_b32 v25, v26, 3, v25
    v_bfe_u32 v26, v24, 4, 1
    v_lshl_or_b32 v25, v26, 2, v25
    v_lshlrev_b32 v25, 12, v25
    v_lshl_add_u32 v15, v15, 4, v25
    s_lshl_b32 s42, s5, 7
    s_add_u32 s42, s42, 19922912
    s_and_b32 s52, s3, 3
    s_lshl_b32 s52, s52, 10
    s_add_u32 s50, s32, s42
    s_addc_u32 s51, s33, 0
    v_lshlrev_b32 v32, 7, v1
    v_add_u32 v32, 102400, v32
    v_add_u32 v33, 8192, v32
    v_add_u32 v34, 16384, v32
    v_add_u32 v35, 24576, v32
    s_mov_b32 s7, 1
    s_mov_b32 s40, 98304
    s_mov_b32 s41, 2621440
    s_lshl_b32 s44, s14, 7
    s_add_u32 s44, s44, 102400
    s_waitcnt vmcnt(0)
    s_barrier
    s_cmp_eq_u32 s3, 0
    s_cbranch_scc0 L_x_np
    v_lshl_add_u32 v24, v1, 4, s44
    v_mov_b32 v28, s34
    v_mov_b32 v29, s35
    v_mov_b32 v30, s34
    v_mov_b32 v31, s35
    s_mov_b64 exec, 0xff
    global_store_dwordx4 v24, v[28:31], s[32:33] sc1
    s_mov_b64 exec, -1
L_x_np:
    s_cmp_eq_u32 s3, 0
    s_cbranch_scc0 L_x_go
    s_mov_b32 s57, 0
    s_sleep 12
    s_branch L_poll17_i
L_poll17:
    s_sleep 6
L_poll17_i:
    global_load_dwordx2 v[36:37], v32, s[32:33] sc1
    global_load_dwordx2 v[38:39], v33, s[32:33] sc1
    global_load_dwordx2 v[40:41], v34, s[32:33] sc1
    global_load_dwordx2 v[42:43], v35, s[32:33] sc1
    s_add_u32 s57, s57, 1
    s_waitcnt vmcnt(0)
    v_cmp_ne_u64 vcc, s[34:35], v[36:37]
    v_cmp_ne_u64 s[54:55], s[34:35], v[38:39]
    s_nop 1
    s_or_b64 vcc, vcc, s[54:55]
    v_cmp_ne_u64 s[54:55], s[34:35], v[40:41]
    s_nop 1
    s_or_b64 vcc, vcc, s[54:55]
    v_cmp_ne_u64 s[54:55], s[34:35], v[42:43]
    s_nop 1
    s_or_b64 vcc, vcc, s[54:55]
    s_cmp_gt_u32 s57, 200000
    s_cbranch_scc1 L_end
    s_cbranch_vccnz L_poll17
L_x_go:
    s_barrier
    s_cmp_lt_u32 s3, 4
    s_cbranch_scc1 L_x2lo
    s_add_u32 m0, s52, 61440
    s_nop 0
    global_load_lds_dwordx4 v4, s[50:51] sc1
    s_add_u32 m0, s52, 69632
    s_nop 0
    global_load_lds_dwordx4 v6, s[50:51] sc1
    s_add_u32 m0, s52, 77824
    s_nop 0
    global_load_lds_dwordx4 v15, s[50:51] sc1
    s_add_u32 m0, s52, 86016
    s_add_u32 s50, s50, 524288
    s_addc_u32 s51, s51, 0
    global_load_lds_dwordx4 v5, s[50:51] sc1
    s_branch L_x2j
L_x2lo:
    s_add_u32 m0, s52, 65536
    s_nop 0
    global_load_lds_dwordx4 v5, s[50:51] sc1
    s_add_u32 m0, s52, 73728
    s_nop 0
    global_load_lds_dwordx4 v14, s[50:51] sc1
    s_add_u32 m0, s52, 81920
    s_add_u32 s50, s50, 524288
    s_addc_u32 s51, s51, 0
    global_load_lds_dwordx4 v4, s[50:51] sc1
    s_add_u32 m0, s52, 90112
    s_nop 0
    global_load_lds_dwordx4 v6, s[50:51] sc1
L_x2j:
    s_cmp_lt_u32 s3, 4
    s_cbranch_scc1 L_g2_np
    s_setprio 1
L_g2_np:
    s_cmp_eq_u32 s3, 0
    s_cbranch_scc1 L_g2A
    s_cmp_eq_u32 s3, 1
    s_cbranch_scc1 L_g2B
    s_cmp_eq_u32 s3, 3
    s_cbranch_scc1 L_g2D
    s_cmp_eq_u32 s3, 7
    s_cbranch_scc1 L_g2E
    s_cmp_eq_u32 s3, 2
    s_cbranch_scc1 L_g2c
    s_waitcnt vmcnt(3)
    s_barrier
    ds_read_b64_tr_b16 v[16:17], v2 offset:0
    ds_read_b64_tr_b16 v[18:19], v2 offset:2560
    ds_read_b64_tr_b16 v[20:21], v2 offset:32
    ds_read_b64_tr_b16 v[22:23], v2 offset:2592
    ds_read_b64_tr_b16 v[24:25], v2 offset:64
    ds_read_b64_tr_b16 v[26:27], v2 offset:2624
    ds_read_b64_tr_b16 v[28:29], v2 offset:96
    ds_read_b64_tr_b16 v[30:31], v2 offset:2656
    ds_read_b64_tr_b16 v[32:33], v2 offset:128
    ds_read_b64_tr_b16 v[34:35], v2 offset:2688
    s_waitcnt vmcnt(2)
    s_barrier
    ds_read_b64_tr_b16 v[36:37], v2 offset:5120
    ds_read_b64_tr_b16 v[38:39], v2 offset:7680
    ds_read_b64_tr_b16 v[40:41], v2 offset:5152
    ds_read_b64_tr_b16 v[42:43], v2 offset:7712
    s_waitcnt lgkmcnt(12)
    v_mfma_f32_16x16x32_bf16 v[48:51], v[96:99], v[16:19], 0
    ds_read_b64_tr_b16 v[44:45], v2 offset:5184
    v_mfma_f32_16x16x32_bf16 v[52:55], v[176:179], v[16:19], 0
    ds_read_b64_tr_b16 v[46:47], v2 offset:7744
    s_waitcnt lgkmcnt(12)
    v_mfma_f32_16x16x32_bf16 v[56:59], v[96:99], v[20:23], 0
    ds_read_b64_tr_b16 v[16:17], v2 offset:5216
    ds_read_b64_tr_b16 v[18:19], v2 offset:7776
    v_mfma_f32_16x16x32_bf16 v[60:63], v[176:179], v[20:23], 0
    s_add_u32 m0, s52, 94208
    s_nop 0
    global_load_lds_dwordx4 v14, s[50:51] sc1
    s_waitcnt lgkmcnt(12)
    v_mfma_f32_16x16x32_bf16 v[64:67], v[96:99], v[24:27], 0
    ds_read_b64_tr_b16 v[20:21], v2 offset:5248
    ds_read_b64_tr_b16 v[22:23], v2 offset:7808
    v_mfma_f32_16x16x32_bf16 v[68:71], v[176:179], v[24:27], 0
    s_add_u32 m0, s52, 98304
    s_nop 0
    global_load_lds_dwordx4 v15, s[50:51] sc1
    s_waitcnt lgkmcnt(12)
    v_mfma_f32_16x16x32_bf16 v[72:75], v[96:99], v[28:31], 0
    ds_read_b64_tr_b16 v[24:25], v2 offset:10240
    v_mfma_f32_16x16x32_bf16 v[76:79], v[176:179], v[28:31], 0
    ds_read_b64_tr_b16 v[26:27], v2 offset:12800
    s_waitcnt lgkmcnt(12)
    v_mfma_f32_16x16x32_bf16 v[80:83], v[96:99], v[32:35], 0
    ds_read_b64_tr_b16 v[28:29], v2 offset:10272
    v_mfma_f32_16x16x32_bf16 v[84:87], v[176:179], v[32:35], 0
    ds_read_b64_tr_b16 v[30:31], v2 offset:12832
    s_waitcnt lgkmcnt(12)
    v_mfma_f32_16x16x32_bf16 v[48:51], v[100:103], v[36:39], v[48:51]
    ds_read_b64_tr_b16 v[32:33], v2 offset:10304
    v_mfma_f32_16x16x32_bf16 v[52:55], v[180:183], v[36:39], v[52:55]
    ds_read_b64_tr_b16 v[34:35], v2 offset:12864
    s_waitcnt lgkmcnt(12)
    v_mfma_f32_16x16x32_bf16 v[56:59], v[100:103], v[40:43], v[56:59]
    ds_read_b64_tr_b16 v[36:37], v2 offset:10336
    ds_read_b64_tr_b16 v[38:39], v2 offset:12896
    v_mfma_f32_16x16x32_bf16 v[60:63], v[180:183], v[40:43], v[60:63]
    s_add_u32 m0, s52, 102400
    s_add_u32 s50, s50, 524288
    s_addc_u32 s51, s51, 0
    global_load_lds_dwordx4 v4, s[50:51] sc1
    s_waitcnt lgkmcnt(12)
    v_mfma_f32_16x16x32_bf16 v[64:67], v[100:103], v[44:47], v[64:67]
    ds_read_b64_tr_b16 v[40:41], v2 offset:10368
    ds_read_b64_tr_b16 v[42:43], v2 offset:12928
    v_mfma_f32_16x16x32_bf16 v[68:71], v[180:183], v[44:47], v[68:71]
    s_add_u32 m0, s52, 106496
    s_nop 0
    global_load_lds_dwordx4 v5, s[50:51] sc1
    s_waitcnt lgkmcnt(12)
    v_mfma_f32_16x16x32_bf16 v[72:75], v[100:103], v[16:19], v[72:75]
    s_waitcnt vmcnt(4)
    s_barrier
    ds_read_b64_tr_b16 v[44:45], v2 offset:15360
    v_mfma_f32_16x16x32_bf16 v[76:79], v[180:183], v[16:19], v[76:79]
    ds_read_b64_tr_b16 v[46:47], v2 offset:17920
    s_waitcnt lgkmcnt(12)
    v_mfma_f32_16x16x32_bf16 v[80:83], v[100:103], v[20:23], v[80:83]
    ds_read_b64_tr_b16 v[16:17], v2 offset:15392
    v_mfma_f32_16x16x32_bf16 v[84:87], v[180:183], v[20:23], v[84:87]
    ds_read_b64_tr_b16 v[18:19], v2 offset:17952
    s_waitcnt lgkmcnt(12)
    v_mfma_f32_16x16x32_bf16 v[48:51], v[104:107], v[24:27], v[48:51]
    ds_read_b64_tr_b16 v[20:21], v2 offset:15424
    v_mfma_f32_16x16x32_bf16 v[52:55], v[184:187], v[24:27], v[52:55]
    ds_read_b64_tr_b16 v[22:23], v2 offset:17984
    s_waitcnt lgkmcnt(12)
    v_mfma_f32_16x16x32_bf16 v[56:59], v[104:107], v[28:31], v[56:59]
    ds_read_b64_tr_b16 v[24:25], v2 offset:15456
    ds_read_b64_tr_b16 v[26:27], v2 offset:18016
    v_mfma_f32_16x16x32_bf16 v[60:63], v[184:187], v[28:31], v[60:63]
    s_add_u32 m0, s52, 110592
    s_nop 0
    global_load_lds_dwordx4 v6, s[50:51] sc1
    s_waitcnt lgkmcnt(12)
    v_mfma_f32_16x16x32_bf16 v[64:67], v[104:107], v[32:35], v[64:67]
    ds_read_b64_tr_b16 v[28:29], v2 offset:15488
    ds_read_b64_tr_b16 v[30:31], v2 offset:18048
    v_mfma_f32_16x16x32_bf16 v[68:71], v[184:187], v[32:35], v[68:71]
    s_add_u32 m0, s52, 114688
    s_nop 0
    global_load_lds_dwordx4 v14, s[50:51] sc1
    s_waitcnt lgkmcnt(12)
    v_mfma_f32_16x16x32_bf16 v[72:75], v[104:107], v[36:39], v[72:75]
    ds_read_b64_tr_b16 v[32:33], v2 offset:20480
    v_mfma_f32_16x16x32_bf16 v[76:79], v[184:187], v[36:39], v[76:79]
    ds_read_b64_tr_b16 v[34:35], v2 offset:23040
    s_waitcnt lgkmcnt(12)
    v_mfma_f32_16x16x32_bf16 v[80:83], v[104:107], v[40:43], v[80:83]
    ds_read_b64_tr_b16 v[36:37], v2 offset:20512
    v_mfma_f32_16x16x32_bf16 v[84:87], v[184:187], v[40:43], v[84:87]
    ds_read_b64_tr_b16 v[38:39], v2 offset:23072
    s_waitcnt lgkmcnt(12)
    v_mfma_f32_16x16x32_bf16 v[48:51], v[108:111], v[44:47], v[48:51]
    ds_read_b64_tr_b16 v[40:41], v2 offset:20544
    v_mfma_f32_16x16x32_bf16 v[52:55], v[188:191], v[44:47], v[52:55]
    ds_read_b64_tr_b16 v[42:43], v2 offset:23104
    s_waitcnt lgkmcnt(12)
    v_mfma_f32_16x16x32_bf16 v[56:59], v[108:111], v[16:19], v[56:59]
    ds_read_b64_tr_b16 v[44:45], v2 offset:20576
    ds_read_b64_tr_b16 v[46:47], v2 offset:23136
    v_mfma_f32_16x16x32_bf16 v[60:63], v[188:191], v[16:19], v[60:63]
    s_add_u32 m0, s52, 118784
    s_nop 0
    global_load_lds_dwordx4 v15, s[50:51] sc1
    s_waitcnt lgkmcnt(12)
    v_mfma_f32_16x16x32_bf16 v[64:67], v[108:111], v[20:23], v[64:67]
    ds_read_b64_tr_b16 v[16:17], v2 offset:20608
    ds_read_b64_tr_b16 v[18:19], v2 offset:23168
    v_mfma_f32_16x16x32_bf16 v[68:71], v[188:191], v[20:23], v[68:71]
    s_add_u32 m0, s52, 122880
    s_add_u32 s50, s50, 524288
    s_addc_u32 s51, s51, 0
    global_load_lds_dwordx4 v4, s[50:51] sc1
    s_waitcnt lgkmcnt(12)
    v_mfma_f32_16x16x32_bf16 v[72:75], v[108:111], v[24:27], v[72:75]
    ds_read_b64_tr_b16 v[20:21], v2 offset:25600
    v_mfma_f32_16x16x32_bf16 v[76:79], v[188:191], v[24:27], v[76:79]
    ds_read_b64_tr_b16 v[22:23], v2 offset:28160
    s_waitcnt lgkmcnt(12)
    v_mfma_f32_16x16x32_bf16 v[80:83], v[108:111], v[28:31], v[80:83]
    ds_read_b64_tr_b16 v[24:25], v2 offset:25632
    v_mfma_f32_16x16x32_bf16 v[84:87], v[188:191], v[28:31], v[84:87]
    ds_read_b64_tr_b16 v[26:27], v2 offset:28192
    s_waitcnt lgkmcnt(12)
    v_mfma_f32_16x16x32_bf16 v[48:51], v[112:115], v[32:35], v[48:51]
    ds_read_b64_tr_b16 v[28:29], v2 offset:25664
    v_mfma_f32_16x16x32_bf16 v[52:55], v[192:195], v[32:35], v[52:55]
    ds_read_b64_tr_b16 v[30:31], v2 offset:28224
    s_waitcnt lgkmcnt(12)
    v_mfma_f32_16x16x32_bf16 v[56:59], v[112:115], v[36:39], v[56:59]
    ds_read_b64_tr_b16 v[32:33], v2 offset:25696
    ds_read_b64_tr_b16 v[34:35], v2 offset:28256
    v_mfma_f32_16x16x32_bf16 v[60:63], v[192:195], v[36:39], v[60:63]
    s_add_u32 m0, s52, 126976
    s_nop 0
    global_load_lds_dwordx4 v5, s[50:51] sc1
    s_waitcnt lgkmcnt(12)
    v_mfma_f32_16x16x32_bf16 v[64:67], v[112:115], v[40:43], v[64:67]
    ds_read_b64_tr_b16 v[36:37], v2 offset:25728
    ds_read_b64_tr_b16 v[38:39], v2 offset:28288
    v_mfma_f32_16x16x32_bf16 v[68:71], v[192:195], v[40:43], v[68:71]
    s_add_u32 m0, s52, 131072
    s_nop 0
    global_load_lds_dwordx4 v6, s[50:51] sc1
    s_waitcnt lgkmcnt(12)
    v_mfma_f32_16x16x32_bf16 v[72:75], v[112:115], v[44:47], v[72:75]
    s_waitcnt vmcnt(4)
    s_barrier
    ds_read_b64_tr_b16 v[40:41], v2 offset:30720
    v_mfma_f32_16x16x32_bf16 v[76:79], v[192:195], v[44:47], v[76:79]
    ds_read_b64_tr_b16 v[42:43], v2 offset:33280
    s_waitcnt lgkmcnt(12)
    v_mfma_f32_16x16x32_bf16 v[80:83], v[112:115], v[16:19], v[80:83]
    ds_read_b64_tr_b16 v[44:45], v2 offset:30752
    v_mfma_f32_16x16x32_bf16 v[84:87], v[192:195], v[16:19], v[84:87]
    ds_read_b64_tr_b16 v[46:47], v2 offset:33312
    s_waitcnt lgkmcnt(12)
    v_mfma_f32_16x16x32_bf16 v[48:51], v[116:119], v[20:23], v[48:51]
    ds_read_b64_tr_b16 v[16:17], v2 offset:30784
    v_mfma_f32_16x16x32_bf16 v[52:55], v[196:199], v[20:23], v[52:55]
    ds_read_b64_tr_b16 v[18:19], v2 offset:33344
    s_waitcnt lgkmcnt(12)
    v_mfma_f32_16x16x32_bf16 v[56:59], v[116:119], v[24:27], v[56:59]
    ds_read_b64_tr_b16 v[20:21], v2 offset:30816
    ds_read_b64_tr_b16 v[22:23], v2 offset:33376
    v_mfma_f32_16x16x32_bf16 v[60:63], v[196:199], v[24:27], v[60:63]
    s_add_u32 m0, s52, 135168
    s_nop 0
    global_load_lds_dwordx4 v14, s[50:51] sc1
    s_waitcnt lgkmcnt(12)
    v_mfma_f32_16x16x32_bf16 v[64:67], v[116:119], v[28:31], v[64:67]
    ds_read_b64_tr_b16 v[24:25], v2 offset:30848
    ds_read_b64_tr_b16 v[26:27], v2 offset:33408
    v_mfma_f32_16x16x32_bf16 v[68:71], v[196:199], v[28:31], v[68:71]
    s_add_u32 m0, s52, 139264
    s_nop 0
    global_load_lds_dwordx4 v15, s[50:51] sc1
    s_waitcnt lgkmcnt(12)
    v_mfma_f32_16x16x32_bf16 v[72:75], v[116:119], v[32:35], v[72:75]
    ds_read_b64_tr_b16 v[28:29], v2 offset:35840
    v_mfma_f32_16x16x32_bf16 v[76:79], v[196:199], v[32:35], v[76:79]
    ds_read_b64_tr_b16 v[30:31], v2 offset:38400
    s_waitcnt lgkmcnt(12)
    v_mfma_f32_16x16x32_bf16 v[80:83], v[116:119], v[36:39], v[80:83]
    ds_read_b64_tr_b16 v[32:33], v2 offset:35872
    v_mfma_f32_16x16x32_bf16 v[84:87], v[196:199], v[36:39], v[84:87]
    ds_read_b64_tr_b16 v[34:35], v2 offset:38432
    s_waitcnt lgkmcnt(12)
    v_mfma_f32_16x16x32_bf16 v[48:51], v[120:123], v[40:43], v[48:51]
    ds_read_b64_tr_b16 v[36:37], v2 offset:35904
    v_mfma_f32_16x16x32_bf16 v[52:55], v[200:203], v[40:43], v[52:55]
    ds_read_b64_tr_b16 v[38:39], v2 offset:38464
    s_waitcnt lgkmcnt(12)
    v_mfma_f32_16x16x32_bf16 v[56:59], v[120:123], v[44:47], v[56:59]
    ds_read_b64_tr_b16 v[40:41], v2 offset:35936
    ds_read_b64_tr_b16 v[42:43], v2 offset:38496
    v_mfma_f32_16x16x32_bf16 v[60:63], v[200:203], v[44:47], v[60:63]
    s_add_u32 m0, s52, 143360
    s_add_u32 s50, s50, 524288
    s_addc_u32 s51, s51, 0
    global_load_lds_dwordx4 v4, s[50:51] sc1
    s_waitcnt lgkmcnt(12)
    v_mfma_f32_16x16x32_bf16 v[64:67], v[120:123], v[16:19], v[64:67]
    ds_read_b64_tr_b16 v[44:45], v2 offset:35968
    ds_read_b64_tr_b16 v[46:47], v2 offset:38528
    v_mfma_f32_16x16x32_bf16 v[68:71], v[200:203], v[16:19], v[68:71]
    s_add_u32 m0, s52, 147456
    s_nop 0
    global_load_lds_dwordx4 v5, s[50:51] sc1
    s_waitcnt lgkmcnt(12)
    v_mfma_f32_16x16x32_bf16 v[72:75], v[120:123], v[20:23], v[72:75]
    ds_read_b64_tr_b16 v[16:17], v2 offset:40960
    v_mfma_f32_16x16x32_bf16 v[76:79], v[200:203], v[20:23], v[76:79]
    ds_read_b64_tr_b16 v[18:19], v2 offset:43520
    s_waitcnt lgkmcnt(12)
    v_mfma_f32_16x16x32_bf16 v[80:83], v[120:123], v[24:27], v[80:83]
    ds_read_b64_tr_b16 v[20:21], v2 offset:40992
    v_mfma_f32_16x16x32_bf16 v[84:87], v[200:203], v[24:27], v[84:87]
    ds_read_b64_tr_b16 v[22:23], v2 offset:43552
    s_waitcnt lgkmcnt(12)
    v_mfma_f32_16x16x32_bf16 v[48:51], v[124:127], v[28:31], v[48:51]
    ds_read_b64_tr_b16 v[24:25], v2 offset:41024
    v_mfma_f32_16x16x32_bf16 v[52:55], v[204:207], v[28:31], v[52:55]
    ds_read_b64_tr_b16 v[26:27], v2 offset:43584
    s_waitcnt lgkmcnt(12)
    v_mfma_f32_16x16x32_bf16 v[56:59], v[124:127], v[32:35], v[56:59]
    ds_read_b64_tr_b16 v[28:29], v2 offset:41056
    ds_read_b64_tr_b16 v[30:31], v2 offset:43616
    v_mfma_f32_16x16x32_bf16 v[60:63], v[204:207], v[32:35], v[60:63]
    s_add_u32 m0, s52, 151552
    s_nop 0
    global_load_lds_dwordx4 v6, s[50:51] sc1
    s_waitcnt lgkmcnt(12)
    v_mfma_f32_16x16x32_bf16 v[64:67], v[124:127], v[36:39], v[64:67]
    ds_read_b64_tr_b16 v[32:33], v2 offset:41088
    ds_read_b64_tr_b16 v[34:35], v2 offset:43648
    v_mfma_f32_16x16x32_bf16 v[68:71], v[204:207], v[36:39], v[68:71]
    s_add_u32 m0, s52, 155648
    s_nop 0
    global_load_lds_dwordx4 v14, s[50:51] sc1
    s_waitcnt lgkmcnt(12)
    v_mfma_f32_16x16x32_bf16 v[72:75], v[124:127], v[40:43], v[72:75]
    ds_read_b64_tr_b16 v[36:37], v2 offset:46080
    v_mfma_f32_16x16x32_bf16 v[76:79], v[204:207], v[40:43], v[76:79]
    ds_read_b64_tr_b16 v[38:39], v2 offset:48640
    s_waitcnt lgkmcnt(12)
    v_mfma_f32_16x16x32_bf16 v[80:83], v[124:127], v[44:47], v[80:83]
    ds_read_b64_tr_b16 v[40:41], v2 offset:46112
    v_mfma_f32_16x16x32_bf16 v[84:87], v[204:207], v[44:47], v[84:87]
    ds_read_b64_tr_b16 v[42:43], v2 offset:48672
    s_waitcnt lgkmcnt(12)
    v_mfma_f32_16x16x32_bf16 v[48:51], v[128:131], v[16:19], v[48:51]
    ds_read_b64_tr_b16 v[44:45], v2 offset:46144
    v_mfma_f32_16x16x32_bf16 v[52:55], v[208:211], v[16:19], v[52:55]
    ds_read_b64_tr_b16 v[46:47], v2 offset:48704
    s_waitcnt lgkmcnt(12)
    v_mfma_f32_16x16x32_bf16 v[56:59], v[128:131], v[20:23], v[56:59]
    ds_read_b64_tr_b16 v[16:17], v2 offset:46176
    ds_read_b64_tr_b16 v[18:19], v2 offset:48736
    v_mfma_f32_16x16x32_bf16 v[60:63], v[208:211], v[20:23], v[60:63]
    s_add_u32 m0, s52, 159744
    s_nop 0
    global_load_lds_dwordx4 v15, s[50:51] sc1
    s_waitcnt lgkmcnt(12)
    v_mfma_f32_16x16x32_bf16 v[64:67], v[128:131], v[24:27], v[64:67]
    ds_read_b64_tr_b16 v[20:21], v2 offset:46208
    v_mfma_f32_16x16x32_bf16 v[68:71], v[208:211], v[24:27], v[68:71]
    ds_read_b64_tr_b16 v[22:23], v2 offset:48768
    s_waitcnt lgkmcnt(12)
    v_mfma_f32_16x16x32_bf16 v[72:75], v[128:131], v[28:31], v[72:75]
    ds_read_b64_tr_b16 v[24:25], v2 offset:51200
    v_mfma_f32_16x16x32_bf16 v[76:79], v[208:211], v[28:31], v[76:79]
    ds_read_b64_tr_b16 v[26:27], v2 offset:53760
    s_waitcnt lgkmcnt(12)
    v_mfma_f32_16x16x32_bf16 v[80:83], v[128:131], v[32:35], v[80:83]
    ds_read_b64_tr_b16 v[28:29], v2 offset:51232
    v_mfma_f32_16x16x32_bf16 v[84:87], v[208:211], v[32:35], v[84:87]
    ds_read_b64_tr_b16 v[30:31], v2 offset:53792
    s_waitcnt lgkmcnt(12)
    v_mfma_f32_16x16x32_bf16 v[48:51], v[132:135], v[36:39], v[48:51]
    ds_read_b64_tr_b16 v[32:33], v2 offset:51264
    v_mfma_f32_16x16x32_bf16 v[52:55], v[212:215], v[36:39], v[52:55]
    ds_read_b64_tr_b16 v[34:35], v2 offset:53824
    s_waitcnt lgkmcnt(12)
    v_mfma_f32_16x16x32_bf16 v[56:59], v[132:135], v[40:43], v[56:59]
    ds_read_b64_tr_b16 v[36:37], v2 offset:51296
    v_mfma_f32_16x16x32_bf16 v[60:63], v[212:215], v[40:43], v[60:63]
    ds_read_b64_tr_b16 v[38:39], v2 offset:53856
    s_waitcnt lgkmcnt(12)
    v_mfma_f32_16x16x32_bf16 v[64:67], v[132:135], v[44:47], v[64:67]
    ds_read_b64_tr_b16 v[40:41], v2 offset:51328
    v_mfma_f32_16x16x32_bf16 v[68:71], v[212:215], v[44:47], v[68:71]
    ds_read_b64_tr_b16 v[42:43], v2 offset:53888
    s_waitcnt lgkmcnt(12)
    v_mfma_f32_16x16x32_bf16 v[72:75], v[132:135], v[16:19], v[72:75]
    s_waitcnt vmcnt(0)
    s_barrier
    ds_read_b64_tr_b16 v[44:45], v2 offset:56320
    v_mfma_f32_16x16x32_bf16 v[76:79], v[212:215], v[16:19], v[76:79]
    ds_read_b64_tr_b16 v[46:47], v2 offset:58880
    s_waitcnt lgkmcnt(12)
    v_mfma_f32_16x16x32_bf16 v[80:83], v[132:135], v[20:23], v[80:83]
    ds_read_b64_tr_b16 v[16:17], v2 offset:56352
    v_mfma_f32_16x16x32_bf16 v[84:87], v[212:215], v[20:23], v[84:87]
    ds_read_b64_tr_b16 v[18:19], v2 offset:58912
    s_waitcnt lgkmcnt(12)
    v_mfma_f32_16x16x32_bf16 v[48:51], v[136:139], v[24:27], v[48:51]
    ds_read_b64_tr_b16 v[20:21], v2 offset:56384
    v_mfma_f32_16x16x32_bf16 v[52:55], v[216:219], v[24:27], v[52:55]
    ds_read_b64_tr_b16 v[22:23], v2 offset:58944
    s_waitcnt lgkmcnt(12)
    v_mfma_f32_16x16x32_bf16 v[56:59], v[136:139], v[28:31], v[56:59]
    ds_read_b64_tr_b16 v[24:25], v2 offset:56416
    v_mfma_f32_16x16x32_bf16 v[60:63], v[216:219], v[28:31], v[60:63]
    ds_read_b64_tr_b16 v[26:27], v2 offset:58976
    s_waitcnt lgkmcnt(12)
    v_mfma_f32_16x16x32_bf16 v[64:67], v[136:139], v[32:35], v[64:67]
    ds_read_b64_tr_b16 v[28:29], v2 offset:56448
    v_mfma_f32_16x16x32_bf16 v[68:71], v[216:219], v[32:35], v[68:71]
    ds_read_b64_tr_b16 v[30:31], v2 offset:59008
    s_waitcnt lgkmcnt(12)
    v_mfma_f32_16x16x32_bf16 v[72:75], v[136:139], v[36:39], v[72:75]
    ds_read_b64_tr_b16 v[32:33], v3 offset:0
    v_mfma_f32_16x16x32_bf16 v[76:79], v[216:219], v[36:39], v[76:79]
    ds_read_b64_tr_b16 v[34:35], v3 offset:2560
    s_waitcnt lgkmcnt(12)
    v_mfma_f32_16x16x32_bf16 v[80:83], v[136:139], v[40:43], v[80:83]
    ds_read_b64_tr_b16 v[36:37], v3 offset:32
    v_mfma_f32_16x16x32_bf16 v[84:87], v[216:219], v[40:43], v[84:87]
    ds_read_b64_tr_b16 v[38:39], v3 offset:2592
    s_waitcnt lgkmcnt(12)
    v_mfma_f32_16x16x32_bf16 v[48:51], v[140:143], v[44:47], v[48:51]
    ds_read_b64_tr_b16 v[40:41], v3 offset:64
    v_mfma_f32_16x16x32_bf16 v[52:55], v[220:223], v[44:47], v[52:55]
    ds_read_b64_tr_b16 v[42:43], v3 offset:2624
    s_waitcnt lgkmcnt(12)
    v_mfma_f32_16x16x32_bf16 v[56:59], v[140:143], v[16:19], v[56:59]
    ds_read_b64_tr_b16 v[44:45], v3 offset:96
    v_mfma_f32_16x16x32_bf16 v[60:63], v[220:223], v[16:19], v[60:63]
    ds_read_b64_tr_b16 v[46:47], v3 offset:2656
    s_waitcnt lgkmcnt(12)
    v_mfma_f32_16x16x32_bf16 v[64:67], v[140:143], v[20:23], v[64:67]
    ds_read_b64_tr_b16 v[16:17], v3 offset:128
    v_mfma_f32_16x16x32_bf16 v[68:71], v[220:223], v[20:23], v[68:71]
    ds_read_b64_tr_b16 v[18:19], v3 offset:2688
    s_waitcnt lgkmcnt(12)
    v_mfma_f32_16x16x32_bf16 v[72:75], v[140:143], v[24:27], v[72:75]
    ds_read_b64_tr_b16 v[20:21], v3 offset:5120
    v_mfma_f32_16x16x32_bf16 v[76:79], v[220:223], v[24:27], v[76:79]
    ds_read_b64_tr_b16 v[22:23], v3 offset:7680
    s_waitcnt lgkmcnt(12)
    v_mfma_f32_16x16x32_bf16 v[80:83], v[140:143], v[28:31], v[80:83]
    ds_read_b64_tr_b16 v[24:25], v3 offset:5152
    v_mfma_f32_16x16x32_bf16 v[84:87], v[220:223], v[28:31], v[84:87]
    ds_read_b64_tr_b16 v[26:27], v3 offset:7712
    s_waitcnt lgkmcnt(12)
    v_mfma_f32_16x16x32_bf16 v[48:51], v[144:147], v[32:35], v[48:51]
    ds_read_b64_tr_b16 v[28:29], v3 offset:5184
    v_mfma_f32_16x16x32_bf16 v[52:55], v[224:227], v[32:35], v[52:55]
    ds_read_b64_tr_b16 v[30:31], v3 offset:7744
    s_waitcnt lgkmcnt(12)
    v_mfma_f32_16x16x32_bf16 v[56:59], v[144:147], v[36:39], v[56:59]
    ds_read_b64_tr_b16 v[32:33], v3 offset:5216
    v_mfma_f32_16x16x32_bf16 v[60:63], v[224:227], v[36:39], v[60:63]
    ds_read_b64_tr_b16 v[34:35], v3 offset:7776
    s_waitcnt lgkmcnt(12)
    v_mfma_f32_16x16x32_bf16 v[64:67], v[144:147], v[40:43], v[64:67]
    ds_read_b64_tr_b16 v[36:37], v3 offset:5248
    v_mfma_f32_16x16x32_bf16 v[68:71], v[224:227], v[40:43], v[68:71]
    ds_read_b64_tr_b16 v[38:39], v3 offset:7808
    s_waitcnt lgkmcnt(12)
    v_mfma_f32_16x16x32_bf16 v[72:75], v[144:147], v[44:47], v[72:75]
    ds_read_b64_tr_b16 v[40:41], v3 offset:10240
    v_mfma_f32_16x16x32_bf16 v[76:79], v[224:227], v[44:47], v[76:79]
    ds_read_b64_tr_b16 v[42:43], v3 offset:12800
    s_waitcnt lgkmcnt(12)
    v_mfma_f32_16x16x32_bf16 v[80:83], v[144:147], v[16:19], v[80:83]
    ds_read_b64_tr_b16 v[44:45], v3 offset:10272
    v_mfma_f32_16x16x32_bf16 v[84:87], v[224:227], v[16:19], v[84:87]
    ds_read_b64_tr_b16 v[46:47], v3 offset:12832
    s_waitcnt lgkmcnt(12)
    v_mfma_f32_16x16x32_bf16 v[48:51], v[148:151], v[20:23], v[48:51]
    ds_read_b64_tr_b16 v[16:17], v3 offset:10304
    v_mfma_f32_16x16x32_bf16 v[52:55], v[228:231], v[20:23], v[52:55]
    ds_read_b64_tr_b16 v[18:19], v3 offset:12864
    s_waitcnt lgkmcnt(12)
    v_mfma_f32_16x16x32_bf16 v[56:59], v[148:151], v[24:27], v[56:59]
    ds_read_b64_tr_b16 v[20:21], v3 offset:10336
    v_mfma_f32_16x16x32_bf16 v[60:63], v[228:231], v[24:27], v[60:63]
    ds_read_b64_tr_b16 v[22:23], v3 offset:12896
    s_waitcnt lgkmcnt(12)
    v_mfma_f32_16x16x32_bf16 v[64:67], v[148:151], v[28:31], v[64:67]
    ds_read_b64_tr_b16 v[24:25], v3 offset:10368
    v_mfma_f32_16x16x32_bf16 v[68:71], v[228:231], v[28:31], v[68:71]
    ds_read_b64_tr_b16 v[26:27], v3 offset:12928
    s_waitcnt lgkmcnt(12)
    v_mfma_f32_16x16x32_bf16 v[72:75], v[148:151], v[32:35], v[72:75]
    ds_read_b64_tr_b16 v[28:29], v3 offset:15360
    v_mfma_f32_16x16x32_bf16 v[76:79], v[228:231], v[32:35], v[76:79]
    ds_read_b64_tr_b16 v[30:31], v3 offset:17920
    s_waitcnt lgkmcnt(12)
    v_mfma_f32_16x16x32_bf16 v[80:83], v[148:151], v[36:39], v[80:83]
    ds_read_b64_tr_b16 v[32:33], v3 offset:15392
    v_mfma_f32_16x16x32_bf16 v[84:87], v[228:231], v[36:39], v[84:87]
    ds_read_b64_tr_b16 v[34:35], v3 offset:17952
    s_waitcnt lgkmcnt(12)
    v_mfma_f32_16x16x32_bf16 v[48:51], v[152:155], v[40:43], v[48:51]
    ds_read_b64_tr_b16 v[36:37], v3 offset:15424
    v_mfma_f32_16x16x32_bf16 v[52:55], v[232:235], v[40:43], v[52:55]
    ds_read_b64_tr_b16 v[38:39], v3 offset:17984
    s_waitcnt lgkmcnt(12)
    v_mfma_f32_16x16x32_bf16 v[56:59], v[152:155], v[44:47], v[56:59]
    ds_read_b64_tr_b16 v[40:41], v3 offset:15456
    v_mfma_f32_16x16x32_bf16 v[60:63], v[232:235], v[44:47], v[60:63]
    ds_read_b64_tr_b16 v[42:43], v3 offset:18016
    s_waitcnt lgkmcnt(12)
    v_mfma_f32_16x16x32_bf16 v[64:67], v[152:155], v[16:19], v[64:67]
    ds_read_b64_tr_b16 v[44:45], v3 offset:15488
    v_mfma_f32_16x16x32_bf16 v[68:71], v[232:235], v[16:19], v[68:71]
    ds_read_b64_tr_b16 v[46:47], v3 offset:18048
    s_waitcnt lgkmcnt(12)
    v_mfma_f32_16x16x32_bf16 v[72:75], v[152:155], v[20:23], v[72:75]
    ds_read_b64_tr_b16 v[16:17], v3 offset:20480
    v_mfma_f32_16x16x32_bf16 v[76:79], v[232:235], v[20:23], v[76:79]
    ds_read_b64_tr_b16 v[18:19], v3 offset:23040
    s_waitcnt lgkmcnt(12)
    v_mfma_f32_16x16x32_bf16 v[80:83], v[152:155], v[24:27], v[80:83]
    ds_read_b64_tr_b16 v[20:21], v3 offset:20512
    v_mfma_f32_16x16x32_bf16 v[84:87], v[232:235], v[24:27], v[84:87]
    ds_read_b64_tr_b16 v[22:23], v3 offset:23072
    s_waitcnt lgkmcnt(12)
    v_mfma_f32_16x16x32_bf16 v[48:51], v[156:159], v[28:31], v[48:51]
    ds_read_b64_tr_b16 v[24:25], v3 offset:20544
    v_mfma_f32_16x16x32_bf16 v[52:55], v[236:239], v[28:31], v[52:55]
    ds_read_b64_tr_b16 v[26:27], v3 offset:23104
    s_waitcnt lgkmcnt(12)
    v_mfma_f32_16x16x32_bf16 v[56:59], v[156:159], v[32:35], v[56:59]
    ds_read_b64_tr_b16 v[28:29], v3 offset:20576
    v_mfma_f32_16x16x32_bf16 v[60:63], v[236:239], v[32:35], v[60:63]
    ds_read_b64_tr_b16 v[30:31], v3 offset:23136
    s_waitcnt lgkmcnt(12)
    v_mfma_f32_16x16x32_bf16 v[64:67], v[156:159], v[36:39], v[64:67]
    ds_read_b64_tr_b16 v[32:33], v3 offset:20608
    v_mfma_f32_16x16x32_bf16 v[68:71], v[236:239], v[36:39], v[68:71]
    ds_read_b64_tr_b16 v[34:35], v3 offset:23168
    s_waitcnt lgkmcnt(12)
    v_mfma_f32_16x16x32_bf16 v[72:75], v[156:159], v[40:43], v[72:75]
    ds_read_b64_tr_b16 v[36:37], v3 offset:25600
    v_mfma_f32_16x16x32_bf16 v[76:79], v[236:239], v[40:43], v[76:79]
    ds_read_b64_tr_b16 v[38:39], v3 offset:28160
    s_waitcnt lgkmcnt(12)
    v_mfma_f32_16x16x32_bf16 v[80:83], v[156:159], v[44:47], v[80:83]
    ds_read_b64_tr_b16 v[40:41], v3 offset:25632
    v_mfma_f32_16x16x32_bf16 v[84:87], v[236:239], v[44:47], v[84:87]
    ds_read_b64_tr_b16 v[42:43], v3 offset:28192
    s_waitcnt lgkmcnt(12)
    v_mfma_f32_16x16x32_bf16 v[48:51], v[160:163], v[16:19], v[48:51]
    ds_read_b64_tr_b16 v[44:45], v3 offset:25664
    v_mfma_f32_16x16x32_bf16 v[52:55], v[240:243], v[16:19], v[52:55]
    ds_read_b64_tr_b16 v[46:47], v3 offset:28224
    s_waitcnt lgkmcnt(12)
    v_mfma_f32_16x16x32_bf16 v[56:59], v[160:163], v[20:23], v[56:59]
    ds_read_b64_tr_b16 v[16:17], v3 offset:25696
    v_mfma_f32_16x16x32_bf16 v[60:63], v[240:243], v[20:23], v[60:63]
    ds_read_b64_tr_b16 v[18:19], v3 offset:28256
    s_waitcnt lgkmcnt(12)
    v_mfma_f32_16x16x32_bf16 v[64:67], v[160:163], v[24:27], v[64:67]
    ds_read_b64_tr_b16 v[20:21], v3 offset:25728
    v_mfma_f32_16x16x32_bf16 v[68:71], v[240:243], v[24:27], v[68:71]
    ds_read_b64_tr_b16 v[22:23], v3 offset:28288
    s_waitcnt lgkmcnt(12)
    v_mfma_f32_16x16x32_bf16 v[72:75], v[160:163], v[28:31], v[72:75]
    ds_read_b64_tr_b16 v[24:25], v3 offset:30720
    v_mfma_f32_16x16x32_bf16 v[76:79], v[240:243], v[28:31], v[76:79]
    ds_read_b64_tr_b16 v[26:27], v3 offset:33280
    s_waitcnt lgkmcnt(12)
    v_mfma_f32_16x16x32_bf16 v[80:83], v[160:163], v[32:35], v[80:83]
    ds_read_b64_tr_b16 v[28:29], v3 offset:30752
    v_mfma_f32_16x16x32_bf16 v[84:87], v[240:243], v[32:35], v[84:87]
    ds_read_b64_tr_b16 v[30:31], v3 offset:33312
    s_waitcnt lgkmcnt(12)
    v_mfma_f32_16x16x32_bf16 v[48:51], v[164:167], v[36:39], v[48:51]
    ds_read_b64_tr_b16 v[32:33], v3 offset:30784
    v_mfma_f32_16x16x32_bf16 v[52:55], v[244:247], v[36:39], v[52:55]
    ds_read_b64_tr_b16 v[34:35], v3 offset:33344
    s_waitcnt lgkmcnt(12)
    v_mfma_f32_16x16x32_bf16 v[56:59], v[164:167], v[40:43], v[56:59]
    ds_read_b64_tr_b16 v[36:37], v3 offset:30816
    v_mfma_f32_16x16x32_bf16 v[60:63], v[244:247], v[40:43], v[60:63]
    ds_read_b64_tr_b16 v[38:39], v3 offset:33376
    s_waitcnt lgkmcnt(12)
    v_mfma_f32_16x16x32_bf16 v[64:67], v[164:167], v[44:47], v[64:67]
    ds_read_b64_tr_b16 v[40:41], v3 offset:30848
    v_mfma_f32_16x16x32_bf16 v[68:71], v[244:247], v[44:47], v[68:71]
    ds_read_b64_tr_b16 v[42:43], v3 offset:33408
    s_waitcnt lgkmcnt(12)
    v_mfma_f32_16x16x32_bf16 v[72:75], v[164:167], v[16:19], v[72:75]
    ds_read_b64_tr_b16 v[44:45], v3 offset:35840
    v_mfma_f32_16x16x32_bf16 v[76:79], v[244:247], v[16:19], v[76:79]
    ds_read_b64_tr_b16 v[46:47], v3 offset:38400
    s_waitcnt lgkmcnt(12)
    v_mfma_f32_16x16x32_bf16 v[80:83], v[164:167], v[20:23], v[80:83]
    ds_read_b64_tr_b16 v[16:17], v3 offset:35872
    v_mfma_f32_16x16x32_bf16 v[84:87], v[244:247], v[20:23], v[84:87]
    ds_read_b64_tr_b16 v[18:19], v3 offset:38432
    s_waitcnt lgkmcnt(12)
    v_mfma_f32_16x16x32_bf16 v[48:51], v[168:171], v[24:27], v[48:51]
    ds_read_b64_tr_b16 v[20:21], v3 offset:35904
    v_mfma_f32_16x16x32_bf16 v[52:55], v[248:251], v[24:27], v[52:55]
    ds_read_b64_tr_b16 v[22:23], v3 offset:38464
    s_waitcnt lgkmcnt(12)
    v_mfma_f32_16x16x32_bf16 v[56:59], v[168:171], v[28:31], v[56:59]
    ds_read_b64_tr_b16 v[24:25], v3 offset:35936
    v_mfma_f32_16x16x32_bf16 v[60:63], v[248:251], v[28:31], v[60:63]
    ds_read_b64_tr_b16 v[26:27], v3 offset:38496
    s_waitcnt lgkmcnt(12)
    v_mfma_f32_16x16x32_bf16 v[64:67], v[168:171], v[32:35], v[64:67]
    ds_read_b64_tr_b16 v[28:29], v3 offset:35968
    v_mfma_f32_16x16x32_bf16 v[68:71], v[248:251], v[32:35], v[68:71]
    ds_read_b64_tr_b16 v[30:31], v3 offset:38528
    s_waitcnt lgkmcnt(12)
    v_mfma_f32_16x16x32_bf16 v[72:75], v[168:171], v[36:39], v[72:75]
    v_mfma_f32_16x16x32_bf16 v[76:79], v[248:251], v[36:39], v[76:79]
    s_waitcnt lgkmcnt(10)
    v_mfma_f32_16x16x32_bf16 v[80:83], v[168:171], v[40:43], v[80:83]
    v_mfma_f32_16x16x32_bf16 v[84:87], v[248:251], v[40:43], v[84:87]
    s_waitcnt lgkmcnt(8)
    v_mfma_f32_16x16x32_bf16 v[48:51], v[172:175], v[44:47], v[48:51]
    v_mfma_f32_16x16x32_bf16 v[52:55], v[252:255], v[44:47], v[52:55]
    s_waitcnt lgkmcnt(6)
    v_mfma_f32_16x16x32_bf16 v[56:59], v[172:175], v[16:19], v[56:59]
    v_mfma_f32_16x16x32_bf16 v[60:63], v[252:255], v[16:19], v[60:63]
    s_waitcnt lgkmcnt(4)
    v_mfma_f32_16x16x32_bf16 v[64:67], v[172:175], v[20:23], v[64:67]
    v_mfma_f32_16x16x32_bf16 v[68:71], v[252:255], v[20:23], v[68:71]
    s_waitcnt lgkmcnt(2)
    v_mfma_f32_16x16x32_bf16 v[72:75], v[172:175], v[24:27], v[72:75]
    v_mfma_f32_16x16x32_bf16 v[76:79], v[252:255], v[24:27], v[76:79]
    s_waitcnt lgkmcnt(0)
    v_mfma_f32_16x16x32_bf16 v[80:83], v[172:175], v[28:31], v[80:83]
    v_mfma_f32_16x16x32_bf16 v[84:87], v[252:255], v[28:31], v[84:87]
    ds_read_b64 v[10:11], v7
    ds_read_b64 v[12:13], v8
    ds_read_b64 v[14:15], v9
    v_and_b32 v16, 15, v1
    v_lshrrev_b32 v17, 4, v1
    s_lshl_b32 s42, s3, 7
    s_add_u32 s42, s42, 46016
    v_lshl_add_u32 v19, v17, 4, s42
    s_lshl_b32 s42, s3, 6
    s_cmp_eq_u32 s3, 2
    s_cselect_b32 s42, 192, s42
    s_cmp_eq_u32 s3, 3
    s_cselect_b32 s42, 128, s42
    s_add_u32 s42, s42, 61440
    v_mul_u32_u24 v20, 496, v16
    v_lshl_add_u32 v20, v17, 4, v20
    v_add_u32 v20, s42, v20
    v_lshlrev_b32 v18, 3, v16
    v_add_u32 v18, 45376, v18
    s_waitcnt lgkmcnt(0)
    s_barrier
    ds_read_b64 v[24:25], v18 offset:0
    ds_read_b64 v[26:27], v18 offset:128
    ds_read_b64 v[28:29], v18 offset:256
    ds_read_b64 v[30:31], v18 offset:384
    ds_read_b64 v[32:33], v18 offset:512
    ds_read_b128 v[36:39], v19 offset:0
    ds_read_b128 v[40:43], v19 offset:64
    s_waitcnt lgkmcnt(0)
    v_fma_f32 v48, -v24, v36, v48
    v_fma_f32 v49, -v24, v37, v49
    v_fma_f32 v50, -v24, v38, v50
    v_fma_f32 v51, -v24, v39, v51
    v_fma_f32 v52, -v24, v40, v52
    v_fma_f32 v53, -v24, v41, v53
    v_fma_f32 v54, -v24, v42, v54
    v_fma_f32 v55, -v24, v43, v55
    v_fma_f32 v56, -v26, v36, v56
    v_fma_f32 v57, -v26, v37, v57
    v_fma_f32 v58, -v26, v38, v58
    v_fma_f32 v59, -v26, v39, v59
    v_fma_f32 v60, -v26, v40, v60
    v_fma_f32 v61, -v26, v41, v61
    v_fma_f32 v62, -v26, v42, v62
    v_fma_f32 v63, -v26, v43, v63
    v_fma_f32 v64, -v28, v36, v64
    v_fma_f32 v65, -v28, v37, v65
    v_fma_f32 v66, -v28, v38, v66
    v_fma_f32 v67, -v28, v39, v67
    v_fma_f32 v68, -v28, v40, v68
    v_fma_f32 v69, -v28, v41, v69
    v_fma_f32 v70, -v28, v42, v70
    v_fma_f32 v71, -v28, v43, v71
    v_fma_f32 v72, -v30, v36, v72
    v_fma_f32 v73, -v30, v37, v73
    v_fma_f32 v74, -v30, v38, v74
    v_fma_f32 v75, -v30, v39, v75
    v_fma_f32 v76, -v30, v40, v76
    v_fma_f32 v77, -v30, v41, v77
    v_fma_f32 v78, -v30, v42, v78
    v_fma_f32 v79, -v30, v43, v79
    v_fma_f32 v80, -v32, v36, v80
    v_fma_f32 v81, -v32, v37, v81
    v_fma_f32 v82, -v32, v38, v82
    v_fma_f32 v83, -v32, v39, v83
    v_fma_f32 v84, -v32, v40, v84
    v_fma_f32 v85, -v32, v41, v85
    v_fma_f32 v86, -v32, v42, v86
    v_fma_f32 v87, -v32, v43, v87
    v_mul_f32 v48, v48, v25
    v_mul_f32 v49, v49, v25
    v_mul_f32 v50, v50, v25
    v_mul_f32 v51, v51, v25
    v_mul_f32 v52, v52, v25
    v_mul_f32 v53, v53, v25
    v_mul_f32 v54, v54, v25
    v_mul_f32 v55, v55, v25
    v_mul_f32 v56, v56, v27
    v_mul_f32 v57, v57, v27
    v_mul_f32 v58, v58, v27
    v_mul_f32 v59, v59, v27
    v_mul_f32 v60, v60, v27
    v_mul_f32 v61, v61, v27
    v_mul_f32 v62, v62, v27
    v_mul_f32 v63, v63, v27
    v_mul_f32 v64, v64, v29
    v_mul_f32 v65, v65, v29
    v_mul_f32 v66, v66, v29
    v_mul_f32 v67, v67, v29
    v_mul_f32 v68, v68, v29
    v_mul_f32 v69, v69, v29
    v_mul_f32 v70, v70, v29
    v_mul_f32 v71, v71, v29
    v_mul_f32 v72, v72, v31
    v_mul_f32 v73, v73, v31
    v_mul_f32 v74, v74, v31
    v_mul_f32 v75, v75, v31
    v_mul_f32 v76, v76, v31
    v_mul_f32 v77, v77, v31
    v_mul_f32 v78, v78, v31
    v_mul_f32 v79, v79, v31
    v_mul_f32 v80, v80, v33
    v_mul_f32 v81, v81, v33
    v_mul_f32 v82, v82, v33
    v_mul_f32 v83, v83, v33
    v_mul_f32 v84, v84, v33
    v_mul_f32 v85, v85, v33
    v_mul_f32 v86, v86, v33
    v_mul_f32 v87, v87, v33
    v_cvt_pk_bf16_f32 v48, v48, v52
    v_cvt_pk_bf16_f32 v49, v49, v53
    v_cvt_pk_bf16_f32 v50, v50, v54
    v_cvt_pk_bf16_f32 v51, v51, v55
    ds_write_b128 v20, v[48:51] offset:0
    v_cvt_pk_bf16_f32 v56, v56, v60
    v_cvt_pk_bf16_f32 v57, v57, v61
    v_cvt_pk_bf16_f32 v58, v58, v62
    v_cvt_pk_bf16_f32 v59, v59, v63
    ds_write_b128 v20, v[56:59] offset:7936
    v_cvt_pk_bf16_f32 v64, v64, v68
    v_cvt_pk_bf16_f32 v65, v65, v69
    v_cvt_pk_bf16_f32 v66, v66, v70
    v_cvt_pk_bf16_f32 v67, v67, v71
    ds_write_b128 v20, v[64:67] offset:15872
    v_cvt_pk_bf16_f32 v72, v72, v76
    v_cvt_pk_bf16_f32 v73, v73, v77
    v_cvt_pk_bf16_f32 v74, v74, v78
    v_cvt_pk_bf16_f32 v75, v75, v79
    ds_write_b128 v20, v[72:75] offset:23808
    v_cvt_pk_bf16_f32 v80, v80, v84
    v_cvt_pk_bf16_f32 v81, v81, v85
    v_cvt_pk_bf16_f32 v82, v82, v86
    v_cvt_pk_bf16_f32 v83, v83, v87
    ds_write_b128 v20, v[80:83] offset:31744
    s_branch L_a1_post
L_g2c:
    s_waitcnt vmcnt(3)
    s_barrier
    ds_read_b64_tr_b16 v[16:17], v2 offset:0
    ds_read_b64_tr_b16 v[18:19], v2 offset:2560
    ds_read_b64_tr_b16 v[20:21], v2 offset:32
    ds_read_b64_tr_b16 v[22:23], v2 offset:2592
    ds_read_b64_tr_b16 v[24:25], v2 offset:64
    ds_read_b64_tr_b16 v[26:27], v2 offset:2624
    ds_read_b64_tr_b16 v[28:29], v2 offset:96
    ds_read_b64_tr_b16 v[30:31], v2 offset:2656
    ds_read_b64_tr_b16 v[32:33], v2 offset:128
    ds_read_b64_tr_b16 v[34:35], v2 offset:2688
    s_waitcnt vmcnt(2)
    s_barrier
    ds_read_b64_tr_b16 v[36:37], v2 offset:5120
    ds_read_b64_tr_b16 v[38:39], v2 offset:7680
    ds_read_b64_tr_b16 v[40:41], v2 offset:5152
    ds_read_b64_tr_b16 v[42:43], v2 offset:7712
    s_waitcnt lgkmcnt(12)
    v_mfma_f32_16x16x32_bf16 v[48:51], v[96:99], v[16:19], 0
    ds_read_b64_tr_b16 v[44:45], v2 offset:5184
    v_mfma_f32_16x16x32_bf16 v[52:55], v[176:179], v[16:19], 0
    ds_read_b64_tr_b16 v[46:47], v2 offset:7744
    s_waitcnt lgkmcnt(12)
    v_mfma_f32_16x16x32_bf16 v[56:59], v[96:99], v[20:23], 0
    ds_read_b64_tr_b16 v[16:17], v2 offset:5216
    v_mfma_f32_16x16x32_bf16 v[60:63], v[176:179], v[20:23], 0
    ds_read_b64_tr_b16 v[18:19], v2 offset:7776
    s_waitcnt lgkmcnt(12)
    v_mfma_f32_16x16x32_bf16 v[64:67], v[96:99], v[24:27], 0
    ds_read_b64_tr_b16 v[20:21], v2 offset:5248
    v_mfma_f32_16x16x32_bf16 v[68:71], v[176:179], v[24:27], 0
    ds_read_b64_tr_b16 v[22:23], v2 offset:7808
    s_waitcnt lgkmcnt(12)
    v_mfma_f32_16x16x32_bf16 v[72:75], v[96:99], v[28:31], 0
    ds_read_b64_tr_b16 v[24:25], v2 offset:10240
    v_mfma_f32_16x16x32_bf16 v[76:79], v[176:179], v[28:31], 0
    ds_read_b64_tr_b16 v[26:27], v2 offset:12800
    s_waitcnt lgkmcnt(12)
    v_mfma_f32_16x16x32_bf16 v[80:83], v[96:99], v[32:35], 0
    ds_read_b64_tr_b16 v[28:29], v2 offset:10272
    v_mfma_f32_16x16x32_bf16 v[84:87], v[176:179], v[32:35], 0
    ds_read_b64_tr_b16 v[30:31], v2 offset:12832
    s_waitcnt lgkmcnt(12)
    v_mfma_f32_16x16x32_bf16 v[48:51], v[100:103], v[36:39], v[48:51]
    ds_read_b64_tr_b16 v[32:33], v2 offset:10304
    v_mfma_f32_16x16x32_bf16 v[52:55], v[180:183], v[36:39], v[52:55]
    ds_read_b64_tr_b16 v[34:35], v2 offset:12864
    s_waitcnt lgkmcnt(12)
    v_mfma_f32_16x16x32_bf16 v[56:59], v[100:103], v[40:43], v[56:59]
    ds_read_b64_tr_b16 v[36:37], v2 offset:10336
    v_mfma_f32_16x16x32_bf16 v[60:63], v[180:183], v[40:43], v[60:63]
    ds_read_b64_tr_b16 v[38:39], v2 offset:12896
    s_waitcnt lgkmcnt(12)
    v_mfma_f32_16x16x32_bf16 v[64:67], v[100:103], v[44:47], v[64:67]
    ds_read_b64_tr_b16 v[40:41], v2 offset:10368
    v_mfma_f32_16x16x32_bf16 v[68:71], v[180:183], v[44:47], v[68:71]
    ds_read_b64_tr_b16 v[42:43], v2 offset:12928
    s_waitcnt lgkmcnt(12)
    v_mfma_f32_16x16x32_bf16 v[72:75], v[100:103], v[16:19], v[72:75]
    s_waitcnt vmcnt(0)
    s_barrier
    ds_read_b64_tr_b16 v[44:45], v2 offset:15360
    v_mfma_f32_16x16x32_bf16 v[76:79], v[180:183], v[16:19], v[76:79]
    ds_read_b64_tr_b16 v[46:47], v2 offset:17920
    s_waitcnt lgkmcnt(12)
    v_mfma_f32_16x16x32_bf16 v[80:83], v[100:103], v[20:23], v[80:83]
    ds_read_b64_tr_b16 v[16:17], v2 offset:15392
    v_mfma_f32_16x16x32_bf16 v[84:87], v[180:183], v[20:23], v[84:87]
    ds_read_b64_tr_b16 v[18:19], v2 offset:17952
    s_waitcnt lgkmcnt(12)
    v_mfma_f32_16x16x32_bf16 v[48:51], v[104:107], v[24:27], v[48:51]
    ds_read_b64_tr_b16 v[20:21], v2 offset:15424
    v_mfma_f32_16x16x32_bf16 v[52:55], v[184:187], v[24:27], v[52:55]
    ds_read_b64_tr_b16 v[22:23], v2 offset:17984
    s_waitcnt lgkmcnt(12)
    v_mfma_f32_16x16x32_bf16 v[56:59], v[104:107], v[28:31], v[56:59]
    ds_read_b64_tr_b16 v[24:25], v2 offset:15456
    v_mfma_f32_16x16x32_bf16 v[60:63], v[184:187], v[28:31], v[60:63]
    ds_read_b64_tr_b16 v[26:27], v2 offset:18016
    s_waitcnt lgkmcnt(12)
    v_mfma_f32_16x16x32_bf16 v[64:67], v[104:107], v[32:35], v[64:67]
    ds_read_b64_tr_b16 v[28:29], v2 offset:15488
    v_mfma_f32_16x16x32_bf16 v[68:71], v[184:187], v[32:35], v[68:71]
    ds_read_b64_tr_b16 v[30:31], v2 offset:18048
    s_waitcnt lgkmcnt(12)
    v_mfma_f32_16x16x32_bf16 v[72:75], v[104:107], v[36:39], v[72:75]
    ds_read_b64_tr_b16 v[32:33], v2 offset:20480
    v_mfma_f32_16x16x32_bf16 v[76:79], v[184:187], v[36:39], v[76:79]
    ds_read_b64_tr_b16 v[34:35], v2 offset:23040
    s_waitcnt lgkmcnt(12)
    v_mfma_f32_16x16x32_bf16 v[80:83], v[104:107], v[40:43], v[80:83]
    ds_read_b64_tr_b16 v[36:37], v2 offset:20512
    v_mfma_f32_16x16x32_bf16 v[84:87], v[184:187], v[40:43], v[84:87]
    ds_read_b64_tr_b16 v[38:39], v2 offset:23072
    s_waitcnt lgkmcnt(12)
    v_mfma_f32_16x16x32_bf16 v[48:51], v[108:111], v[44:47], v[48:51]
    ds_read_b64_tr_b16 v[40:41], v2 offset:20544
    v_mfma_f32_16x16x32_bf16 v[52:55], v[188:191], v[44:47], v[52:55]
    ds_read_b64_tr_b16 v[42:43], v2 offset:23104
    s_waitcnt lgkmcnt(12)
    v_mfma_f32_16x16x32_bf16 v[56:59], v[108:111], v[16:19], v[56:59]
    ds_read_b64_tr_b16 v[44:45], v2 offset:20576
    v_mfma_f32_16x16x32_bf16 v[60:63], v[188:191], v[16:19], v[60:63]
    ds_read_b64_tr_b16 v[46:47], v2 offset:23136
    s_waitcnt lgkmcnt(12)
    v_mfma_f32_16x16x32_bf16 v[64:67], v[108:111], v[20:23], v[64:67]
    ds_read_b64_tr_b16 v[16:17], v2 offset:20608
    v_mfma_f32_16x16x32_bf16 v[68:71], v[188:191], v[20:23], v[68:71]
    ds_read_b64_tr_b16 v[18:19], v2 offset:23168
    s_waitcnt lgkmcnt(12)
    v_mfma_f32_16x16x32_bf16 v[72:75], v[108:111], v[24:27], v[72:75]
    ds_read_b64_tr_b16 v[20:21], v2 offset:25600
    v_mfma_f32_16x16x32_bf16 v[76:79], v[188:191], v[24:27], v[76:79]
    ds_read_b64_tr_b16 v[22:23], v2 offset:28160
    s_waitcnt lgkmcnt(12)
    v_mfma_f32_16x16x32_bf16 v[80:83], v[108:111], v[28:31], v[80:83]
    ds_read_b64_tr_b16 v[24:25], v2 offset:25632
    v_mfma_f32_16x16x32_bf16 v[84:87], v[188:191], v[28:31], v[84:87]
    ds_read_b64_tr_b16 v[26:27], v2 offset:28192
    s_waitcnt lgkmcnt(12)
    v_mfma_f32_16x16x32_bf16 v[48:51], v[112:115], v[32:35], v[48:51]
    ds_read_b64_tr_b16 v[28:29], v2 offset:25664
    v_mfma_f32_16x16x32_bf16 v[52:55], v[192:195], v[32:35], v[52:55]
    ds_read_b64_tr_b16 v[30:31], v2 offset:28224
    s_waitcnt lgkmcnt(12)
    v_mfma_f32_16x16x32_bf16 v[56:59], v[112:115], v[36:39], v[56:59]
    ds_read_b64_tr_b16 v[32:33], v2 offset:25696
    v_mfma_f32_16x16x32_bf16 v[60:63], v[192:195], v[36:39], v[60:63]
    ds_read_b64_tr_b16 v[34:35], v2 offset:28256
    s_waitcnt lgkmcnt(12)
    v_mfma_f32_16x16x32_bf16 v[64:67], v[112:115], v[40:43], v[64:67]
    ds_read_b64_tr_b16 v[36:37], v2 offset:25728
    v_mfma_f32_16x16x32_bf16 v[68:71], v[192:195], v[40:43], v[68:71]
    ds_read_b64_tr_b16 v[38:39], v2 offset:28288
    s_waitcnt lgkmcnt(12)
    v_mfma_f32_16x16x32_bf16 v[72:75], v[112:115], v[44:47], v[72:75]
    s_barrier
    ds_read_b64_tr_b16 v[40:41], v2 offset:30720
    v_mfma_f32_16x16x32_bf16 v[76:79], v[192:195], v[44:47], v[76:79]
    ds_read_b64_tr_b16 v[42:43], v2 offset:33280
    s_waitcnt lgkmcnt(12)
    v_mfma_f32_16x16x32_bf16 v[80:83], v[112:115], v[16:19], v[80:83]
    ds_read_b64_tr_b16 v[44:45], v2 offset:30752
    v_mfma_f32_16x16x32_bf16 v[84:87], v[192:195], v[16:19], v[84:87]
    ds_read_b64_tr_b16 v[46:47], v2 offset:33312
    s_waitcnt lgkmcnt(12)
    v_mfma_f32_16x16x32_bf16 v[48:51], v[116:119], v[20:23], v[48:51]
    ds_read_b64_tr_b16 v[16:17], v2 offset:30784
    v_mfma_f32_16x16x32_bf16 v[52:55], v[196:199], v[20:23], v[52:55]
    ds_read_b64_tr_b16 v[18:19], v2 offset:33344
    s_waitcnt lgkmcnt(12)
    v_mfma_f32_16x16x32_bf16 v[56:59], v[116:119], v[24:27], v[56:59]
    ds_read_b64_tr_b16 v[20:21], v2 offset:30816
    v_mfma_f32_16x16x32_bf16 v[60:63], v[196:199], v[24:27], v[60:63]
    ds_read_b64_tr_b16 v[22:23], v2 offset:33376
    s_waitcnt lgkmcnt(12)
    v_mfma_f32_16x16x32_bf16 v[64:67], v[116:119], v[28:31], v[64:67]
    ds_read_b64_tr_b16 v[24:25], v2 offset:30848
    v_mfma_f32_16x16x32_bf16 v[68:71], v[196:199], v[28:31], v[68:71]
    ds_read_b64_tr_b16 v[26:27], v2 offset:33408
    s_waitcnt lgkmcnt(12)
    v_mfma_f32_16x16x32_bf16 v[72:75], v[116:119], v[32:35], v[72:75]
    ds_read_b64_tr_b16 v[28:29], v2 offset:35840
    v_mfma_f32_16x16x32_bf16 v[76:79], v[196:199], v[32:35], v[76:79]
    ds_read_b64_tr_b16 v[30:31], v2 offset:38400
    s_waitcnt lgkmcnt(12)
    v_mfma_f32_16x16x32_bf16 v[80:83], v[116:119], v[36:39], v[80:83]
    ds_read_b64_tr_b16 v[32:33], v2 offset:35872
    v_mfma_f32_16x16x32_bf16 v[84:87], v[196:199], v[36:39], v[84:87]
    ds_read_b64_tr_b16 v[34:35], v2 offset:38432
    s_waitcnt lgkmcnt(12)
    v_mfma_f32_16x16x32_bf16 v[48:51], v[120:123], v[40:43], v[48:51]
    ds_read_b64_tr_b16 v[36:37], v2 offset:35904
    v_mfma_f32_16x16x32_bf16 v[52:55], v[200:203], v[40:43], v[52:55]
    ds_read_b64_tr_b16 v[38:39], v2 offset:38464
    s_waitcnt lgkmcnt(12)
    v_mfma_f32_16x16x32_bf16 v[56:59], v[120:123], v[44:47], v[56:59]
    ds_read_b64_tr_b16 v[40:41], v2 offset:35936
    v_mfma_f32_16x16x32_bf16 v[60:63], v[200:203], v[44:47], v[60:63]
    ds_read_b64_tr_b16 v[42:43], v2 offset:38496
    s_waitcnt lgkmcnt(12)
    v_mfma_f32_16x16x32_bf16 v[64:67], v[120:123], v[16:19], v[64:67]
    ds_read_b64_tr_b16 v[44:45], v2 offset:35968
    v_mfma_f32_16x16x32_bf16 v[68:71], v[200:203], v[16:19], v[68:71]
    ds_read_b64_tr_b16 v[46:47], v2 offset:38528
    s_waitcnt lgkmcnt(12)
    v_mfma_f32_16x16x32_bf16 v[72:75], v[120:123], v[20:23], v[72:75]
    ds_read_b64_tr_b16 v[16:17], v2 offset:40960
    v_mfma_f32_16x16x32_bf16 v[76:79], v[200:203], v[20:23], v[76:79]
    ds_read_b64_tr_b16 v[18:19], v2 offset:43520
    s_waitcnt lgkmcnt(12)
    v_mfma_f32_16x16x32_bf16 v[80:83], v[120:123], v[24:27], v[80:83]
    ds_read_b64_tr_b16 v[20:21], v2 offset:40992
    v_mfma_f32_16x16x32_bf16 v[84:87], v[200:203], v[24:27], v[84:87]
    ds_read_b64_tr_b16 v[22:23], v2 offset:43552
    s_waitcnt lgkmcnt(12)
    v_mfma_f32_16x16x32_bf16 v[48:51], v[124:127], v[28:31], v[48:51]
    ds_read_b64_tr_b16 v[24:25], v2 offset:41024
    v_mfma_f32_16x16x32_bf16 v[52:55], v[204:207], v[28:31], v[52:55]
    ds_read_b64_tr_b16 v[26:27], v2 offset:43584
    s_waitcnt lgkmcnt(12)
    v_mfma_f32_16x16x32_bf16 v[56:59], v[124:127], v[32:35], v[56:59]
    ds_read_b64_tr_b16 v[28:29], v2 offset:41056
    v_mfma_f32_16x16x32_bf16 v[60:63], v[204:207], v[32:35], v[60:63]
    ds_read_b64_tr_b16 v[30:31], v2 offset:43616
    s_waitcnt lgkmcnt(12)
    v_mfma_f32_16x16x32_bf16 v[64:67], v[124:127], v[36:39], v[64:67]
    ds_read_b64_tr_b16 v[32:33], v2 offset:41088
    v_mfma_f32_16x16x32_bf16 v[68:71], v[204:207], v[36:39], v[68:71]
    ds_read_b64_tr_b16 v[34:35], v2 offset:43648
    s_waitcnt lgkmcnt(12)
    v_mfma_f32_16x16x32_bf16 v[72:75], v[124:127], v[40:43], v[72:75]
    ds_read_b64_tr_b16 v[36:37], v2 offset:46080
    v_mfma_f32_16x16x32_bf16 v[76:79], v[204:207], v[40:43], v[76:79]
    ds_read_b64_tr_b16 v[38:39], v2 offset:48640
    s_waitcnt lgkmcnt(12)
    v_mfma_f32_16x16x32_bf16 v[80:83], v[124:127], v[44:47], v[80:83]
    ds_read_b64_tr_b16 v[40:41], v2 offset:46112
    v_mfma_f32_16x16x32_bf16 v[84:87], v[204:207], v[44:47], v[84:87]
    ds_read_b64_tr_b16 v[42:43], v2 offset:48672
    s_waitcnt lgkmcnt(12)
    v_mfma_f32_16x16x32_bf16 v[48:51], v[128:131], v[16:19], v[48:51]
    ds_read_b64_tr_b16 v[44:45], v2 offset:46144
    v_mfma_f32_16x16x32_bf16 v[52:55], v[208:211], v[16:19], v[52:55]
    ds_read_b64_tr_b16 v[46:47], v2 offset:48704
    s_waitcnt lgkmcnt(12)
    v_mfma_f32_16x16x32_bf16 v[56:59], v[128:131], v[20:23], v[56:59]
    ds_read_b64_tr_b16 v[16:17], v2 offset:46176
    v_mfma_f32_16x16x32_bf16 v[60:63], v[208:211], v[20:23], v[60:63]
    ds_read_b64_tr_b16 v[18:19], v2 offset:48736
    s_waitcnt lgkmcnt(12)
    v_mfma_f32_16x16x32_bf16 v[64:67], v[128:131], v[24:27], v[64:67]
    ds_read_b64_tr_b16 v[20:21], v2 offset:46208
    v_mfma_f32_16x16x32_bf16 v[68:71], v[208:211], v[24:27], v[68:71]
    ds_read_b64_tr_b16 v[22:23], v2 offset:48768
    s_waitcnt lgkmcnt(12)
    v_mfma_f32_16x16x32_bf16 v[72:75], v[128:131], v[28:31], v[72:75]
    ds_read_b64_tr_b16 v[24:25], v2 offset:51200
    v_mfma_f32_16x16x32_bf16 v[76:79], v[208:211], v[28:31], v[76:79]
    ds_read_b64_tr_b16 v[26:27], v2 offset:53760
    s_waitcnt lgkmcnt(12)
    v_mfma_f32_16x16x32_bf16 v[80:83], v[128:131], v[32:35], v[80:83]
    ds_read_b64_tr_b16 v[28:29], v2 offset:51232
    v_mfma_f32_16x16x32_bf16 v[84:87], v[208:211], v[32:35], v[84:87]
    ds_read_b64_tr_b16 v[30:31], v2 offset:53792
    s_waitcnt lgkmcnt(12)
    v_mfma_f32_16x16x32_bf16 v[48:51], v[132:135], v[36:39], v[48:51]
    ds_read_b64_tr_b16 v[32:33], v2 offset:51264
    v_mfma_f32_16x16x32_bf16 v[52:55], v[212:215], v[36:39], v[52:55]
    ds_read_b64_tr_b16 v[34:35], v2 offset:53824
    s_waitcnt lgkmcnt(12)
    v_mfma_f32_16x16x32_bf16 v[56:59], v[132:135], v[40:43], v[56:59]
    ds_read_b64_tr_b16 v[36:37], v2 offset:51296
    v_mfma_f32_16x16x32_bf16 v[60:63], v[212:215], v[40:43], v[60:63]
    ds_read_b64_tr_b16 v[38:39], v2 offset:53856
    s_waitcnt lgkmcnt(12)
    v_mfma_f32_16x16x32_bf16 v[64:67], v[132:135], v[44:47], v[64:67]
    ds_read_b64_tr_b16 v[40:41], v2 offset:51328
    v_mfma_f32_16x16x32_bf16 v[68:71], v[212:215], v[44:47], v[68:71]
    ds_read_b64_tr_b16 v[42:43], v2 offset:53888
    s_waitcnt lgkmcnt(12)
    v_mfma_f32_16x16x32_bf16 v[72:75], v[132:135], v[16:19], v[72:75]
    s_barrier
    ds_read_b64_tr_b16 v[44:45], v2 offset:56320
    v_mfma_f32_16x16x32_bf16 v[76:79], v[212:215], v[16:19], v[76:79]
    ds_read_b64_tr_b16 v[46:47], v2 offset:58880
    s_waitcnt lgkmcnt(12)
    v_mfma_f32_16x16x32_bf16 v[80:83], v[132:135], v[20:23], v[80:83]
    ds_read_b64_tr_b16 v[16:17], v2 offset:56352
    v_mfma_f32_16x16x32_bf16 v[84:87], v[212:215], v[20:23], v[84:87]
    ds_read_b64_tr_b16 v[18:19], v2 offset:58912
    s_waitcnt lgkmcnt(12)
    v_mfma_f32_16x16x32_bf16 v[48:51], v[136:139], v[24:27], v[48:51]
    ds_read_b64_tr_b16 v[20:21], v2 offset:56384
    v_mfma_f32_16x16x32_bf16 v[52:55], v[216:219], v[24:27], v[52:55]
    ds_read_b64_tr_b16 v[22:23], v2 offset:58944
    s_waitcnt lgkmcnt(12)
    v_mfma_f32_16x16x32_bf16 v[56:59], v[136:139], v[28:31], v[56:59]
    ds_read_b64_tr_b16 v[24:25], v2 offset:56416
    v_mfma_f32_16x16x32_bf16 v[60:63], v[216:219], v[28:31], v[60:63]
    ds_read_b64_tr_b16 v[26:27], v2 offset:58976
    s_waitcnt lgkmcnt(12)
    v_mfma_f32_16x16x32_bf16 v[64:67], v[136:139], v[32:35], v[64:67]
    ds_read_b64_tr_b16 v[28:29], v2 offset:56448
    v_mfma_f32_16x16x32_bf16 v[68:71], v[216:219], v[32:35], v[68:71]
    ds_read_b64_tr_b16 v[30:31], v2 offset:59008
    s_waitcnt lgkmcnt(12)
    v_mfma_f32_16x16x32_bf16 v[72:75], v[136:139], v[36:39], v[72:75]
    ds_read_b64_tr_b16 v[32:33], v3 offset:0
    v_mfma_f32_16x16x32_bf16 v[76:79], v[216:219], v[36:39], v[76:79]
    ds_read_b64_tr_b16 v[34:35], v3 offset:2560
    s_waitcnt lgkmcnt(12)
    v_mfma_f32_16x16x32_bf16 v[80:83], v[136:139], v[40:43], v[80:83]
    ds_read_b64_tr_b16 v[36:37], v3 offset:32
    v_mfma_f32_16x16x32_bf16 v[84:87], v[216:219], v[40:43], v[84:87]
    ds_read_b64_tr_b16 v[38:39], v3 offset:2592
    s_waitcnt lgkmcnt(12)
    v_mfma_f32_16x16x32_bf16 v[48:51], v[140:143], v[44:47], v[48:51]
    ds_read_b64_tr_b16 v[40:41], v3 offset:64
    v_mfma_f32_16x16x32_bf16 v[52:55], v[220:223], v[44:47], v[52:55]
    ds_read_b64_tr_b16 v[42:43], v3 offset:2624
    s_waitcnt lgkmcnt(12)
    v_mfma_f32_16x16x32_bf16 v[56:59], v[140:143], v[16:19], v[56:59]
    ds_read_b64_tr_b16 v[44:45], v3 offset:96
    v_mfma_f32_16x16x32_bf16 v[60:63], v[220:223], v[16:19], v[60:63]
    ds_read_b64_tr_b16 v[46:47], v3 offset:2656
    s_waitcnt lgkmcnt(12)
    v_mfma_f32_16x16x32_bf16 v[64:67], v[140:143], v[20:23], v[64:67]
    ds_read_b64_tr_b16 v[16:17], v3 offset:128
    v_mfma_f32_16x16x32_bf16 v[68:71], v[220:223], v[20:23], v[68:71]
    ds_read_b64_tr_b16 v[18:19], v3 offset:2688
    s_waitcnt lgkmcnt(12)
    v_mfma_f32_16x16x32_bf16 v[72:75], v[140:143], v[24:27], v[72:75]
    ds_read_b64_tr_b16 v[20:21], v3 offset:5120
    v_mfma_f32_16x16x32_bf16 v[76:79], v[220:223], v[24:27], v[76:79]
    ds_read_b64_tr_b16 v[22:23], v3 offset:7680
    s_waitcnt lgkmcnt(12)
    v_mfma_f32_16x16x32_bf16 v[80:83], v[140:143], v[28:31], v[80:83]
    ds_read_b64_tr_b16 v[24:25], v3 offset:5152
    v_mfma_f32_16x16x32_bf16 v[84:87], v[220:223], v[28:31], v[84:87]
    ds_read_b64_tr_b16 v[26:27], v3 offset:7712
    s_waitcnt lgkmcnt(12)
    v_mfma_f32_16x16x32_bf16 v[48:51], v[144:147], v[32:35], v[48:51]
    ds_read_b64_tr_b16 v[28:29], v3 offset:5184
    v_mfma_f32_16x16x32_bf16 v[52:55], v[224:227], v[32:35], v[52:55]
    ds_read_b64_tr_b16 v[30:31], v3 offset:7744
    s_waitcnt lgkmcnt(12)
    v_mfma_f32_16x16x32_bf16 v[56:59], v[144:147], v[36:39], v[56:59]
    ds_read_b64_tr_b16 v[32:33], v3 offset:5216
    v_mfma_f32_16x16x32_bf16 v[60:63], v[224:227], v[36:39], v[60:63]
    ds_read_b64_tr_b16 v[34:35], v3 offset:7776
    s_waitcnt lgkmcnt(12)
    v_mfma_f32_16x16x32_bf16 v[64:67], v[144:147], v[40:43], v[64:67]
    ds_read_b64_tr_b16 v[36:37], v3 offset:5248
    v_mfma_f32_16x16x32_bf16 v[68:71], v[224:227], v[40:43], v[68:71]
    ds_read_b64_tr_b16 v[38:39], v3 offset:7808
    s_waitcnt lgkmcnt(12)
    v_mfma_f32_16x16x32_bf16 v[72:75], v[144:147], v[44:47], v[72:75]
    ds_read_b64_tr_b16 v[40:41], v3 offset:10240
    v_mfma_f32_16x16x32_bf16 v[76:79], v[224:227], v[44:47], v[76:79]
    ds_read_b64_tr_b16 v[42:43], v3 offset:12800
    s_waitcnt lgkmcnt(12)
    v_mfma_f32_16x16x32_bf16 v[80:83], v[144:147], v[16:19], v[80:83]
    ds_read_b64_tr_b16 v[44:45], v3 offset:10272
    v_mfma_f32_16x16x32_bf16 v[84:87], v[224:227], v[16:19], v[84:87]
    ds_read_b64_tr_b16 v[46:47], v3 offset:12832
    s_waitcnt lgkmcnt(12)
    v_mfma_f32_16x16x32_bf16 v[48:51], v[148:151], v[20:23], v[48:51]
    ds_read_b64_tr_b16 v[16:17], v3 offset:10304
    v_mfma_f32_16x16x32_bf16 v[52:55], v[228:231], v[20:23], v[52:55]
    ds_read_b64_tr_b16 v[18:19], v3 offset:12864
    s_waitcnt lgkmcnt(12)
    v_mfma_f32_16x16x32_bf16 v[56:59], v[148:151], v[24:27], v[56:59]
    ds_read_b64_tr_b16 v[20:21], v3 offset:10336
    v_mfma_f32_16x16x32_bf16 v[60:63], v[228:231], v[24:27], v[60:63]
    ds_read_b64_tr_b16 v[22:23], v3 offset:12896
    s_waitcnt lgkmcnt(12)
    v_mfma_f32_16x16x32_bf16 v[64:67], v[148:151], v[28:31], v[64:67]
    ds_read_b64_tr_b16 v[24:25], v3 offset:10368
    v_mfma_f32_16x16x32_bf16 v[68:71], v[228:231], v[28:31], v[68:71]
    ds_read_b64_tr_b16 v[26:27], v3 offset:12928
    s_waitcnt lgkmcnt(12)
    v_mfma_f32_16x16x32_bf16 v[72:75], v[148:151], v[32:35], v[72:75]
    ds_read_b64_tr_b16 v[28:29], v3 offset:15360
    v_mfma_f32_16x16x32_bf16 v[76:79], v[228:231], v[32:35], v[76:79]
    ds_read_b64_tr_b16 v[30:31], v3 offset:17920
    s_waitcnt lgkmcnt(12)
    v_mfma_f32_16x16x32_bf16 v[80:83], v[148:151], v[36:39], v[80:83]
    ds_read_b64_tr_b16 v[32:33], v3 offset:15392
    v_mfma_f32_16x16x32_bf16 v[84:87], v[228:231], v[36:39], v[84:87]
    ds_read_b64_tr_b16 v[34:35], v3 offset:17952
    s_waitcnt lgkmcnt(12)
    v_mfma_f32_16x16x32_bf16 v[48:51], v[152:155], v[40:43], v[48:51]
    ds_read_b64_tr_b16 v[36:37], v3 offset:15424
    v_mfma_f32_16x16x32_bf16 v[52:55], v[232:235], v[40:43], v[52:55]
    ds_read_b64_tr_b16 v[38:39], v3 offset:17984
    s_waitcnt lgkmcnt(12)
    v_mfma_f32_16x16x32_bf16 v[56:59], v[152:155], v[44:47], v[56:59]
    ds_read_b64_tr_b16 v[40:41], v3 offset:15456
    v_mfma_f32_16x16x32_bf16 v[60:63], v[232:235], v[44:47], v[60:63]
    ds_read_b64_tr_b16 v[42:43], v3 offset:18016
    s_waitcnt lgkmcnt(12)
    v_mfma_f32_16x16x32_bf16 v[64:67], v[152:155], v[16:19], v[64:67]
    ds_read_b64_tr_b16 v[44:45], v3 offset:15488
    v_mfma_f32_16x16x32_bf16 v[68:71], v[232:235], v[16:19], v[68:71]
    ds_read_b64_tr_b16 v[46:47], v3 offset:18048
    s_waitcnt lgkmcnt(12)
    v_mfma_f32_16x16x32_bf16 v[72:75], v[152:155], v[20:23], v[72:75]
    ds_read_b64_tr_b16 v[16:17], v3 offset:20480
    v_mfma_f32_16x16x32_bf16 v[76:79], v[232:235], v[20:23], v[76:79]
    ds_read_b64_tr_b16 v[18:19], v3 offset:23040
    s_waitcnt lgkmcnt(12)
    v_mfma_f32_16x16x32_bf16 v[80:83], v[152:155], v[24:27], v[80:83]
    ds_read_b64_tr_b16 v[20:21], v3 offset:20512
    v_mfma_f32_16x16x32_bf16 v[84:87], v[232:235], v[24:27], v[84:87]
    ds_read_b64_tr_b16 v[22:23], v3 offset:23072
    s_waitcnt lgkmcnt(12)
    v_mfma_f32_16x16x32_bf16 v[48:51], v[156:159], v[28:31], v[48:51]
    ds_read_b64_tr_b16 v[24:25], v3 offset:20544
    v_mfma_f32_16x16x32_bf16 v[52:55], v[236:239], v[28:31], v[52:55]
    ds_read_b64_tr_b16 v[26:27], v3 offset:23104
    s_waitcnt lgkmcnt(12)
    v_mfma_f32_16x16x32_bf16 v[56:59], v[156:159], v[32:35], v[56:59]
    ds_read_b64_tr_b16 v[28:29], v3 offset:20576
    v_mfma_f32_16x16x32_bf16 v[60:63], v[236:239], v[32:35], v[60:63]
    ds_read_b64_tr_b16 v[30:31], v3 offset:23136
    s_waitcnt lgkmcnt(12)
    v_mfma_f32_16x16x32_bf16 v[64:67], v[156:159], v[36:39], v[64:67]
    ds_read_b64_tr_b16 v[32:33], v3 offset:20608
    v_mfma_f32_16x16x32_bf16 v[68:71], v[236:239], v[36:39], v[68:71]
    ds_read_b64_tr_b16 v[34:35], v3 offset:23168
    s_waitcnt lgkmcnt(12)
    v_mfma_f32_16x16x32_bf16 v[72:75], v[156:159], v[40:43], v[72:75]
    ds_read_b64_tr_b16 v[36:37], v3 offset:25600
    v_mfma_f32_16x16x32_bf16 v[76:79], v[236:239], v[40:43], v[76:79]
    ds_read_b64_tr_b16 v[38:39], v3 offset:28160
    s_waitcnt lgkmcnt(12)
    v_mfma_f32_16x16x32_bf16 v[80:83], v[156:159], v[44:47], v[80:83]
    ds_read_b64_tr_b16 v[40:41], v3 offset:25632
    v_mfma_f32_16x16x32_bf16 v[84:87], v[236:239], v[44:47], v[84:87]
    ds_read_b64_tr_b16 v[42:43], v3 offset:28192
    s_waitcnt lgkmcnt(12)
    v_mfma_f32_16x16x32_bf16 v[48:51], v[160:163], v[16:19], v[48:51]
    ds_read_b64_tr_b16 v[44:45], v3 offset:25664
    v_mfma_f32_16x16x32_bf16 v[52:55], v[240:243], v[16:19], v[52:55]
    ds_read_b64_tr_b16 v[46:47], v3 offset:28224
    s_waitcnt lgkmcnt(12)
    v_mfma_f32_16x16x32_bf16 v[56:59], v[160:163], v[20:23], v[56:59]
    ds_read_b64_tr_b16 v[16:17], v3 offset:25696
    v_mfma_f32_16x16x32_bf16 v[60:63], v[240:243], v[20:23], v[60:63]
    ds_read_b64_tr_b16 v[18:19], v3 offset:28256
    s_waitcnt lgkmcnt(12)
    v_mfma_f32_16x16x32_bf16 v[64:67], v[160:163], v[24:27], v[64:67]
    ds_read_b64_tr_b16 v[20:21], v3 offset:25728
    v_mfma_f32_16x16x32_bf16 v[68:71], v[240:243], v[24:27], v[68:71]
    ds_read_b64_tr_b16 v[22:23], v3 offset:28288
    s_waitcnt lgkmcnt(12)
    v_mfma_f32_16x16x32_bf16 v[72:75], v[160:163], v[28:31], v[72:75]
    ds_read_b64_tr_b16 v[24:25], v3 offset:30720
    v_mfma_f32_16x16x32_bf16 v[76:79], v[240:243], v[28:31], v[76:79]
    ds_read_b64_tr_b16 v[26:27], v3 offset:33280
    s_waitcnt lgkmcnt(12)
    v_mfma_f32_16x16x32_bf16 v[80:83], v[160:163], v[32:35], v[80:83]
    ds_read_b64_tr_b16 v[28:29], v3 offset:30752
    v_mfma_f32_16x16x32_bf16 v[84:87], v[240:243], v[32:35], v[84:87]
    ds_read_b64_tr_b16 v[30:31], v3 offset:33312
    s_waitcnt lgkmcnt(12)
    v_mfma_f32_16x16x32_bf16 v[48:51], v[164:167], v[36:39], v[48:51]
    ds_read_b64_tr_b16 v[32:33], v3 offset:30784
    v_mfma_f32_16x16x32_bf16 v[52:55], v[244:247], v[36:39], v[52:55]
    ds_read_b64_tr_b16 v[34:35], v3 offset:33344
    s_waitcnt lgkmcnt(12)
    v_mfma_f32_16x16x32_bf16 v[56:59], v[164:167], v[40:43], v[56:59]
    ds_read_b64_tr_b16 v[36:37], v3 offset:30816
    v_mfma_f32_16x16x32_bf16 v[60:63], v[244:247], v[40:43], v[60:63]
    ds_read_b64_tr_b16 v[38:39], v3 offset:33376
    s_waitcnt lgkmcnt(12)
    v_mfma_f32_16x16x32_bf16 v[64:67], v[164:167], v[44:47], v[64:67]
    ds_read_b64_tr_b16 v[40:41], v3 offset:30848
    v_mfma_f32_16x16x32_bf16 v[68:71], v[244:247], v[44:47], v[68:71]
    ds_read_b64_tr_b16 v[42:43], v3 offset:33408
    s_waitcnt lgkmcnt(12)
    v_mfma_f32_16x16x32_bf16 v[72:75], v[164:167], v[16:19], v[72:75]
    ds_read_b64_tr_b16 v[44:45], v3 offset:35840
    v_mfma_f32_16x16x32_bf16 v[76:79], v[244:247], v[16:19], v[76:79]
    ds_read_b64_tr_b16 v[46:47], v3 offset:38400
    s_waitcnt lgkmcnt(12)
    v_mfma_f32_16x16x32_bf16 v[80:83], v[164:167], v[20:23], v[80:83]
    ds_read_b64_tr_b16 v[16:17], v3 offset:35872
    v_mfma_f32_16x16x32_bf16 v[84:87], v[244:247], v[20:23], v[84:87]
    ds_read_b64_tr_b16 v[18:19], v3 offset:38432
    s_waitcnt lgkmcnt(12)
    v_mfma_f32_16x16x32_bf16 v[48:51], v[168:171], v[24:27], v[48:51]
    ds_read_b64_tr_b16 v[20:21], v3 offset:35904
    v_mfma_f32_16x16x32_bf16 v[52:55], v[248:251], v[24:27], v[52:55]
    ds_read_b64_tr_b16 v[22:23], v3 offset:38464
    s_waitcnt lgkmcnt(12)
    v_mfma_f32_16x16x32_bf16 v[56:59], v[168:171], v[28:31], v[56:59]
    ds_read_b64_tr_b16 v[24:25], v3 offset:35936
    v_mfma_f32_16x16x32_bf16 v[60:63], v[248:251], v[28:31], v[60:63]
    ds_read_b64_tr_b16 v[26:27], v3 offset:38496
    s_waitcnt lgkmcnt(12)
    v_mfma_f32_16x16x32_bf16 v[64:67], v[168:171], v[32:35], v[64:67]
    ds_read_b64_tr_b16 v[28:29], v3 offset:35968
    v_mfma_f32_16x16x32_bf16 v[68:71], v[248:251], v[32:35], v[68:71]
    ds_read_b64_tr_b16 v[30:31], v3 offset:38528
    s_waitcnt lgkmcnt(12)
    v_mfma_f32_16x16x32_bf16 v[72:75], v[168:171], v[36:39], v[72:75]
    v_mfma_f32_16x16x32_bf16 v[76:79], v[248:251], v[36:39], v[76:79]
    s_waitcnt lgkmcnt(10)
    v_mfma_f32_16x16x32_bf16 v[80:83], v[168:171], v[40:43], v[80:83]
    v_mfma_f32_16x16x32_bf16 v[84:87], v[248:251], v[40:43], v[84:87]
    s_waitcnt lgkmcnt(8)
    v_mfma_f32_16x16x32_bf16 v[48:51], v[172:175], v[44:47], v[48:51]
    v_mfma_f32_16x16x32_bf16 v[52:55], v[252:255], v[44:47], v[52:55]
    s_waitcnt lgkmcnt(6)
    v_mfma_f32_16x16x32_bf16 v[56:59], v[172:175], v[16:19], v[56:59]
    v_mfma_f32_16x16x32_bf16 v[60:63], v[252:255], v[16:19], v[60:63]
    s_waitcnt lgkmcnt(4)
    v_mfma_f32_16x16x32_bf16 v[64:67], v[172:175], v[20:23], v[64:67]
    v_mfma_f32_16x16x32_bf16 v[68:71], v[252:255], v[20:23], v[68:71]
    s_waitcnt lgkmcnt(2)
    v_mfma_f32_16x16x32_bf16 v[72:75], v[172:175], v[24:27], v[72:75]
    v_mfma_f32_16x16x32_bf16 v[76:79], v[252:255], v[24:27], v[76:79]
    s_waitcnt lgkmcnt(0)
    v_mfma_f32_16x16x32_bf16 v[80:83], v[172:175], v[28:31], v[80:83]
    v_mfma_f32_16x16x32_bf16 v[84:87], v[252:255], v[28:31], v[84:87]
    ds_read_b64 v[10:11], v7
    ds_read_b64 v[12:13], v8
    ds_read_b64 v[14:15], v9
    v_and_b32 v16, 15, v1
    v_lshrrev_b32 v17, 4, v1
    s_lshl_b32 s42, s3, 7
    s_add_u32 s42, s42, 46016
    v_lshl_add_u32 v19, v17, 4, s42
    s_lshl_b32 s42, s3, 6
    s_cmp_eq_u32 s3, 2
    s_cselect_b32 s42, 192, s42
    s_cmp_eq_u32 s3, 3
    s_cselect_b32 s42, 128, s42
    s_add_u32 s42, s42, 61440
    v_mul_u32_u24 v20, 496, v16
    v_lshl_add_u32 v20, v17, 4, v20
    v_add_u32 v20, s42, v20
    v_lshlrev_b32 v18, 3, v16
    v_add_u32 v18, 45376, v18
    s_waitcnt lgkmcnt(0)
    s_barrier
    ds_read_b64 v[24:25], v18 offset:0
    ds_read_b64 v[26:27], v18 offset:128
    ds_read_b64 v[28:29], v18 offset:256
    ds_read_b64 v[30:31], v18 offset:384
    ds_read_b64 v[32:33], v18 offset:512
    ds_read_b128 v[36:39], v19 offset:0
    ds_read_b128 v[40:43], v19 offset:64
    s_waitcnt lgkmcnt(0)
    v_fma_f32 v48, -v24, v36, v48
    v_fma_f32 v49, -v24, v37, v49
    v_fma_f32 v50, -v24, v38, v50
    v_fma_f32 v51, -v24, v39, v51
    v_fma_f32 v52, -v24, v40, v52
    v_fma_f32 v53, -v24, v41, v53
    v_fma_f32 v54, -v24, v42, v54
    v_fma_f32 v55, -v24, v43, v55
    v_fma_f32 v56, -v26, v36, v56
    v_fma_f32 v57, -v26, v37, v57
    v_fma_f32 v58, -v26, v38, v58
    v_fma_f32 v59, -v26, v39, v59
    v_fma_f32 v60, -v26, v40, v60
    v_fma_f32 v61, -v26, v41, v61
    v_fma_f32 v62, -v26, v42, v62
    v_fma_f32 v63, -v26, v43, v63
    v_fma_f32 v64, -v28, v36, v64
    v_fma_f32 v65, -v28, v37, v65
    v_fma_f32 v66, -v28, v38, v66
    v_fma_f32 v67, -v28, v39, v67
    v_fma_f32 v68, -v28, v40, v68
    v_fma_f32 v69, -v28, v41, v69
    v_fma_f32 v70, -v28, v42, v70
    v_fma_f32 v71, -v28, v43, v71
    v_fma_f32 v72, -v30, v36, v72
    v_fma_f32 v73, -v30, v37, v73
    v_fma_f32 v74, -v30, v38, v74
    v_fma_f32 v75, -v30, v39, v75
    v_fma_f32 v76, -v30, v40, v76
    v_fma_f32 v77, -v30, v41, v77
    v_fma_f32 v78, -v30, v42, v78
    v_fma_f32 v79, -v30, v43, v79
    v_fma_f32 v80, -v32, v36, v80
    v_fma_f32 v81, -v32, v37, v81
    v_fma_f32 v82, -v32, v38, v82
    v_fma_f32 v83, -v32, v39, v83
    v_fma_f32 v84, -v32, v40, v84
    v_fma_f32 v85, -v32, v41, v85
    v_fma_f32 v86, -v32, v42, v86
    v_fma_f32 v87, -v32, v43, v87
    v_mul_f32 v48, v48, v25
    v_mul_f32 v49, v49, v25
    v_mul_f32 v50, v50, v25
    v_mul_f32 v51, v51, v25
    v_mul_f32 v52, v52, v25
    v_mul_f32 v53, v53, v25
    v_mul_f32 v54, v54, v25
    v_mul_f32 v55, v55, v25
    v_mul_f32 v56, v56, v27
    v_mul_f32 v57, v57, v27
    v_mul_f32 v58, v58, v27
    v_mul_f32 v59, v59, v27
    v_mul_f32 v60, v60, v27
    v_mul_f32 v61, v61, v27
    v_mul_f32 v62, v62, v27
    v_mul_f32 v63, v63, v27
    v_mul_f32 v64, v64, v29
    v_mul_f32 v65, v65, v29
    v_mul_f32 v66, v66, v29
    v_mul_f32 v67, v67, v29
    v_mul_f32 v68, v68, v29
    v_mul_f32 v69, v69, v29
    v_mul_f32 v70, v70, v29
    v_mul_f32 v71, v71, v29
    v_mul_f32 v72, v72, v31
    v_mul_f32 v73, v73, v31
    v_mul_f32 v74, v74, v31
    v_mul_f32 v75, v75, v31
    v_mul_f32 v76, v76, v31
    v_mul_f32 v77, v77, v31
    v_mul_f32 v78, v78, v31
    v_mul_f32 v79, v79, v31
    v_mul_f32 v80, v80, v33
    v_mul_f32 v81, v81, v33
    v_mul_f32 v82, v82, v33
    v_mul_f32 v83, v83, v33
    v_mul_f32 v84, v84, v33
    v_mul_f32 v85, v85, v33
    v_mul_f32 v86, v86, v33
    v_mul_f32 v87, v87, v33
    v_cvt_pk_bf16_f32 v48, v48, v52
    v_cvt_pk_bf16_f32 v49, v49, v53
    v_cvt_pk_bf16_f32 v50, v50, v54
    v_cvt_pk_bf16_f32 v51, v51, v55
    ds_write_b128 v20, v[48:51] offset:0
    v_cvt_pk_bf16_f32 v56, v56, v60
    v_cvt_pk_bf16_f32 v57, v57, v61
    v_cvt_pk_bf16_f32 v58, v58, v62
    v_cvt_pk_bf16_f32 v59, v59, v63
    ds_write_b128 v20, v[56:59] offset:7936
    v_cvt_pk_bf16_f32 v64, v64, v68
    v_cvt_pk_bf16_f32 v65, v65, v69
    v_cvt_pk_bf16_f32 v66, v66, v70
    v_cvt_pk_bf16_f32 v67, v67, v71
    ds_write_b128 v20, v[64:67] offset:15872
    v_cvt_pk_bf16_f32 v72, v72, v76
    v_cvt_pk_bf16_f32 v73, v73, v77
    v_cvt_pk_bf16_f32 v74, v74, v78
    v_cvt_pk_bf16_f32 v75, v75, v79
    ds_write_b128 v20, v[72:75] offset:23808
    v_cvt_pk_bf16_f32 v80, v80, v84
    v_cvt_pk_bf16_f32 v81, v81, v85
    v_cvt_pk_bf16_f32 v82, v82, v86
    v_cvt_pk_bf16_f32 v83, v83, v87
    ds_write_b128 v20, v[80:83] offset:31744
    s_branch L_a1_post
L_g2A:
    s_waitcnt vmcnt(3)
    s_barrier
    ds_read_b64_tr_b16 v[16:17], v2 offset:32
    ds_read_b64_tr_b16 v[18:19], v2 offset:2592
    ds_read_b64_tr_b16 v[20:21], v2 offset:64
    ds_read_b64_tr_b16 v[22:23], v2 offset:2624
    ds_read_b64_tr_b16 v[24:25], v2 offset:96
    ds_read_b64_tr_b16 v[26:27], v2 offset:2656
    ds_read_b64_tr_b16 v[28:29], v2 offset:128
    ds_read_b64_tr_b16 v[30:31], v2 offset:2688
    s_waitcnt vmcnt(2)
    s_barrier
    ds_read_b64_tr_b16 v[32:33], v2 offset:5152
    ds_read_b64_tr_b16 v[34:35], v2 offset:7712
    ds_read_b64_tr_b16 v[36:37], v2 offset:5184
    ds_read_b64_tr_b16 v[38:39], v2 offset:7744
    ds_read_b64_tr_b16 v[40:41], v2 offset:5216
    ds_read_b64_tr_b16 v[42:43], v2 offset:7776
    s_waitcnt lgkmcnt(12)
    v_mfma_f32_16x16x32_bf16 v[48:51], v[96:99], v[16:19], 0
    ds_read_b64_tr_b16 v[44:45], v2 offset:5248
    v_mfma_f32_16x16x32_bf16 v[52:55], v[176:179], v[16:19], 0
    ds_read_b64_tr_b16 v[46:47], v2 offset:7808
    v_mfma_f32_16x16x32_bf16 v[56:59], v[16:19], v[16:19], 0
    v_mfma_f32_16x16x32_bf16 v[60:63], v[10:13], v[16:19], 0
    s_waitcnt lgkmcnt(12)
    v_mfma_f32_16x16x32_bf16 v[64:67], v[96:99], v[20:23], 0
    ds_read_b64_tr_b16 v[16:17], v2 offset:10272
    v_mfma_f32_16x16x32_bf16 v[68:71], v[176:179], v[20:23], 0
    ds_read_b64_tr_b16 v[18:19], v2 offset:12832
    s_waitcnt lgkmcnt(12)
    v_mfma_f32_16x16x32_bf16 v[72:75], v[96:99], v[24:27], 0
    ds_read_b64_tr_b16 v[20:21], v2 offset:10304
    v_mfma_f32_16x16x32_bf16 v[76:79], v[176:179], v[24:27], 0
    ds_read_b64_tr_b16 v[22:23], v2 offset:12864
    s_waitcnt lgkmcnt(12)
    v_mfma_f32_16x16x32_bf16 v[80:83], v[96:99], v[28:31], 0
    ds_read_b64_tr_b16 v[24:25], v2 offset:10336
    v_mfma_f32_16x16x32_bf16 v[84:87], v[176:179], v[28:31], 0
    ds_read_b64_tr_b16 v[26:27], v2 offset:12896
    s_waitcnt lgkmcnt(12)
    v_mfma_f32_16x16x32_bf16 v[48:51], v[100:103], v[32:35], v[48:51]
    ds_read_b64_tr_b16 v[28:29], v2 offset:10368
    v_mfma_f32_16x16x32_bf16 v[52:55], v[180:183], v[32:35], v[52:55]
    ds_read_b64_tr_b16 v[30:31], v2 offset:12928
    v_mfma_f32_16x16x32_bf16 v[56:59], v[32:35], v[32:35], v[56:59]
    v_mfma_f32_16x16x32_bf16 v[60:63], v[10:13], v[32:35], v[60:63]
    s_waitcnt lgkmcnt(12)
    v_mfma_f32_16x16x32_bf16 v[64:67], v[100:103], v[36:39], v[64:67]
    s_waitcnt vmcnt(0)
    s_barrier
    ds_read_b64_tr_b16 v[32:33], v2 offset:15392
    v_mfma_f32_16x16x32_bf16 v[68:71], v[180:183], v[36:39], v[68:71]
    ds_read_b64_tr_b16 v[34:35], v2 offset:17952
    s_waitcnt lgkmcnt(12)
    v_mfma_f32_16x16x32_bf16 v[72:75], v[100:103], v[40:43], v[72:75]
    ds_read_b64_tr_b16 v[36:37], v2 offset:15424
    v_mfma_f32_16x16x32_bf16 v[76:79], v[180:183], v[40:43], v[76:79]
    ds_read_b64_tr_b16 v[38:39], v2 offset:17984
    s_waitcnt lgkmcnt(12)
    v_mfma_f32_16x16x32_bf16 v[80:83], v[100:103], v[44:47], v[80:83]
    ds_read_b64_tr_b16 v[40:41], v2 offset:15456
    v_mfma_f32_16x16x32_bf16 v[84:87], v[180:183], v[44:47], v[84:87]
    ds_read_b64_tr_b16 v[42:43], v2 offset:18016
    s_waitcnt lgkmcnt(12)
    v_mfma_f32_16x16x32_bf16 v[48:51], v[104:107], v[16:19], v[48:51]
    ds_read_b64_tr_b16 v[44:45], v2 offset:15488
    v_mfma_f32_16x16x32_bf16 v[52:55], v[184:187], v[16:19], v[52:55]
    ds_read_b64_tr_b16 v[46:47], v2 offset:18048
    v_mfma_f32_16x16x32_bf16 v[56:59], v[16:19], v[16:19], v[56:59]
    v_mfma_f32_16x16x32_bf16 v[60:63], v[10:13], v[16:19], v[60:63]
    s_waitcnt lgkmcnt(12)
    v_mfma_f32_16x16x32_bf16 v[64:67], v[104:107], v[20:23], v[64:67]
    ds_read_b64_tr_b16 v[16:17], v2 offset:20512
    v_mfma_f32_16x16x32_bf16 v[68:71], v[184:187], v[20:23], v[68:71]
    ds_read_b64_tr_b16 v[18:19], v2 offset:23072
    s_waitcnt lgkmcnt(12)
    v_mfma_f32_16x16x32_bf16 v[72:75], v[104:107], v[24:27], v[72:75]
    ds_read_b64_tr_b16 v[20:21], v2 offset:20544
    v_mfma_f32_16x16x32_bf16 v[76:79], v[184:187], v[24:27], v[76:79]
    ds_read_b64_tr_b16 v[22:23], v2 offset:23104
    s_waitcnt lgkmcnt(12)
    v_mfma_f32_16x16x32_bf16 v[80:83], v[104:107], v[28:31], v[80:83]
    ds_read_b64_tr_b16 v[24:25], v2 offset:20576
    v_mfma_f32_16x16x32_bf16 v[84:87], v[184:187], v[28:31], v[84:87]
    ds_read_b64_tr_b16 v[26:27], v2 offset:23136
    s_waitcnt lgkmcnt(12)
    v_mfma_f32_16x16x32_bf16 v[48:51], v[108:111], v[32:35], v[48:51]
    ds_read_b64_tr_b16 v[28:29], v2 offset:20608
    v_mfma_f32_16x16x32_bf16 v[52:55], v[188:191], v[32:35], v[52:55]
    ds_read_b64_tr_b16 v[30:31], v2 offset:23168
    v_mfma_f32_16x16x32_bf16 v[56:59], v[32:35], v[32:35], v[56:59]
    v_mfma_f32_16x16x32_bf16 v[60:63], v[10:13], v[32:35], v[60:63]
    s_waitcnt lgkmcnt(12)
    v_mfma_f32_16x16x32_bf16 v[64:67], v[108:111], v[36:39], v[64:67]
    ds_read_b64_tr_b16 v[32:33], v2 offset:25632
    v_mfma_f32_16x16x32_bf16 v[68:71], v[188:191], v[36:39], v[68:71]
    ds_read_b64_tr_b16 v[34:35], v2 offset:28192
    s_waitcnt lgkmcnt(12)
    v_mfma_f32_16x16x32_bf16 v[72:75], v[108:111], v[40:43], v[72:75]
    ds_read_b64_tr_b16 v[36:37], v2 offset:25664
    v_mfma_f32_16x16x32_bf16 v[76:79], v[188:191], v[40:43], v[76:79]
    ds_read_b64_tr_b16 v[38:39], v2 offset:28224
    s_waitcnt lgkmcnt(12)
    v_mfma_f32_16x16x32_bf16 v[80:83], v[108:111], v[44:47], v[80:83]
    ds_read_b64_tr_b16 v[40:41], v2 offset:25696
    v_mfma_f32_16x16x32_bf16 v[84:87], v[188:191], v[44:47], v[84:87]
    ds_read_b64_tr_b16 v[42:43], v2 offset:28256
    s_waitcnt lgkmcnt(12)
    v_mfma_f32_16x16x32_bf16 v[48:51], v[112:115], v[16:19], v[48:51]
    ds_read_b64_tr_b16 v[44:45], v2 offset:25728
    v_mfma_f32_16x16x32_bf16 v[52:55], v[192:195], v[16:19], v[52:55]
    ds_read_b64_tr_b16 v[46:47], v2 offset:28288
    v_mfma_f32_16x16x32_bf16 v[56:59], v[16:19], v[16:19], v[56:59]
    v_mfma_f32_16x16x32_bf16 v[60:63], v[10:13], v[16:19], v[60:63]
    s_waitcnt lgkmcnt(12)
    v_mfma_f32_16x16x32_bf16 v[64:67], v[112:115], v[20:23], v[64:67]
    s_barrier
    ds_read_b64_tr_b16 v[16:17], v2 offset:30752
    v_mfma_f32_16x16x32_bf16 v[68:71], v[192:195], v[20:23], v[68:71]
    ds_read_b64_tr_b16 v[18:19], v2 offset:33312
    s_waitcnt lgkmcnt(12)
    v_mfma_f32_16x16x32_bf16 v[72:75], v[112:115], v[24:27], v[72:75]
    ds_read_b64_tr_b16 v[20:21], v2 offset:30784
    v_mfma_f32_16x16x32_bf16 v[76:79], v[192:195], v[24:27], v[76:79]
    ds_read_b64_tr_b16 v[22:23], v2 offset:33344
    s_waitcnt lgkmcnt(12)
    v_mfma_f32_16x16x32_bf16 v[80:83], v[112:115], v[28:31], v[80:83]
    ds_read_b64_tr_b16 v[24:25], v2 offset:30816
    v_mfma_f32_16x16x32_bf16 v[84:87], v[192:195], v[28:31], v[84:87]
    ds_read_b64_tr_b16 v[26:27], v2 offset:33376
    s_waitcnt lgkmcnt(12)
    v_mfma_f32_16x16x32_bf16 v[48:51], v[116:119], v[32:35], v[48:51]
    ds_read_b64_tr_b16 v[28:29], v2 offset:30848
    v_mfma_f32_16x16x32_bf16 v[52:55], v[196:199], v[32:35], v[52:55]
    ds_read_b64_tr_b16 v[30:31], v2 offset:33408
    v_mfma_f32_16x16x32_bf16 v[56:59], v[32:35], v[32:35], v[56:59]
    v_mfma_f32_16x16x32_bf16 v[60:63], v[10:13], v[32:35], v[60:63]
    s_waitcnt lgkmcnt(12)
    v_mfma_f32_16x16x32_bf16 v[64:67], v[116:119], v[36:39], v[64:67]
    ds_read_b64_tr_b16 v[32:33], v2 offset:35872
    v_mfma_f32_16x16x32_bf16 v[68:71], v[196:199], v[36:39], v[68:71]
    ds_read_b64_tr_b16 v[34:35], v2 offset:38432
    s_waitcnt lgkmcnt(12)
    v_mfma_f32_16x16x32_bf16 v[72:75], v[116:119], v[40:43], v[72:75]
    ds_read_b64_tr_b16 v[36:37], v2 offset:35904
    v_mfma_f32_16x16x32_bf16 v[76:79], v[196:199], v[40:43], v[76:79]
    ds_read_b64_tr_b16 v[38:39], v2 offset:38464
    s_waitcnt lgkmcnt(12)
    v_mfma_f32_16x16x32_bf16 v[80:83], v[116:119], v[44:47], v[80:83]
    ds_read_b64_tr_b16 v[40:41], v2 offset:35936
    v_mfma_f32_16x16x32_bf16 v[84:87], v[196:199], v[44:47], v[84:87]
    ds_read_b64_tr_b16 v[42:43], v2 offset:38496
    s_waitcnt lgkmcnt(12)
    v_mfma_f32_16x16x32_bf16 v[48:51], v[120:123], v[16:19], v[48:51]
    ds_read_b64_tr_b16 v[44:45], v2 offset:35968
    v_mfma_f32_16x16x32_bf16 v[52:55], v[200:203], v[16:19], v[52:55]
    ds_read_b64_tr_b16 v[46:47], v2 offset:38528
    v_mfma_f32_16x16x32_bf16 v[56:59], v[16:19], v[16:19], v[56:59]
    v_mfma_f32_16x16x32_bf16 v[60:63], v[10:13], v[16:19], v[60:63]
    s_waitcnt lgkmcnt(12)
    v_mfma_f32_16x16x32_bf16 v[64:67], v[120:123], v[20:23], v[64:67]
    ds_read_b64_tr_b16 v[16:17], v2 offset:40992
    v_mfma_f32_16x16x32_bf16 v[68:71], v[200:203], v[20:23], v[68:71]
    ds_read_b64_tr_b16 v[18:19], v2 offset:43552
    s_waitcnt lgkmcnt(12)
    v_mfma_f32_16x16x32_bf16 v[72:75], v[120:123], v[24:27], v[72:75]
    ds_read_b64_tr_b16 v[20:21], v2 offset:41024
    v_mfma_f32_16x16x32_bf16 v[76:79], v[200:203], v[24:27], v[76:79]
    ds_read_b64_tr_b16 v[22:23], v2 offset:43584
    s_waitcnt lgkmcnt(12)
    v_mfma_f32_16x16x32_bf16 v[80:83], v[120:123], v[28:31], v[80:83]
    ds_read_b64_tr_b16 v[24:25], v2 offset:41056
    v_mfma_f32_16x16x32_bf16 v[84:87], v[200:203], v[28:31], v[84:87]
    ds_read_b64_tr_b16 v[26:27], v2 offset:43616
    s_waitcnt lgkmcnt(12)
    v_mfma_f32_16x16x32_bf16 v[48:51], v[124:127], v[32:35], v[48:51]
    ds_read_b64_tr_b16 v[28:29], v2 offset:41088
    v_mfma_f32_16x16x32_bf16 v[52:55], v[204:207], v[32:35], v[52:55]
    ds_read_b64_tr_b16 v[30:31], v2 offset:43648
    v_mfma_f32_16x16x32_bf16 v[56:59], v[32:35], v[32:35], v[56:59]
    v_mfma_f32_16x16x32_bf16 v[60:63], v[10:13], v[32:35], v[60:63]
    s_waitcnt lgkmcnt(12)
    v_mfma_f32_16x16x32_bf16 v[64:67], v[124:127], v[36:39], v[64:67]
    ds_read_b64_tr_b16 v[32:33], v2 offset:46112
    v_mfma_f32_16x16x32_bf16 v[68:71], v[204:207], v[36:39], v[68:71]
    ds_read_b64_tr_b16 v[34:35], v2 offset:48672
    s_waitcnt lgkmcnt(12)
    v_mfma_f32_16x16x32_bf16 v[72:75], v[124:127], v[40:43], v[72:75]
    ds_read_b64_tr_b16 v[36:37], v2 offset:46144
    v_mfma_f32_16x16x32_bf16 v[76:79], v[204:207], v[40:43], v[76:79]
    ds_read_b64_tr_b16 v[38:39], v2 offset:48704
    s_waitcnt lgkmcnt(12)
    v_mfma_f32_16x16x32_bf16 v[80:83], v[124:127], v[44:47], v[80:83]
    ds_read_b64_tr_b16 v[40:41], v2 offset:46176
    v_mfma_f32_16x16x32_bf16 v[84:87], v[204:207], v[44:47], v[84:87]
    ds_read_b64_tr_b16 v[42:43], v2 offset:48736
    s_waitcnt lgkmcnt(12)
    v_mfma_f32_16x16x32_bf16 v[48:51], v[128:131], v[16:19], v[48:51]
    ds_read_b64_tr_b16 v[44:45], v2 offset:46208
    v_mfma_f32_16x16x32_bf16 v[52:55], v[208:211], v[16:19], v[52:55]
    ds_read_b64_tr_b16 v[46:47], v2 offset:48768
    v_mfma_f32_16x16x32_bf16 v[56:59], v[16:19], v[16:19], v[56:59]
    v_mfma_f32_16x16x32_bf16 v[60:63], v[10:13], v[16:19], v[60:63]
    s_waitcnt lgkmcnt(12)
    v_mfma_f32_16x16x32_bf16 v[64:67], v[128:131], v[20:23], v[64:67]
    ds_read_b64_tr_b16 v[16:17], v2 offset:51232
    v_mfma_f32_16x16x32_bf16 v[68:71], v[208:211], v[20:23], v[68:71]
    ds_read_b64_tr_b16 v[18:19], v2 offset:53792
    s_waitcnt lgkmcnt(12)
    v_mfma_f32_16x16x32_bf16 v[72:75], v[128:131], v[24:27], v[72:75]
    ds_read_b64_tr_b16 v[20:21], v2 offset:51264
    v_mfma_f32_16x16x32_bf16 v[76:79], v[208:211], v[24:27], v[76:79]
    ds_read_b64_tr_b16 v[22:23], v2 offset:53824
    s_waitcnt lgkmcnt(12)
    v_mfma_f32_16x16x32_bf16 v[80:83], v[128:131], v[28:31], v[80:83]
    ds_read_b64_tr_b16 v[24:25], v2 offset:51296
    v_mfma_f32_16x16x32_bf16 v[84:87], v[208:211], v[28:31], v[84:87]
    ds_read_b64_tr_b16 v[26:27], v2 offset:53856
    s_waitcnt lgkmcnt(12)
    v_mfma_f32_16x16x32_bf16 v[48:51], v[132:135], v[32:35], v[48:51]
    ds_read_b64_tr_b16 v[28:29], v2 offset:51328
    v_mfma_f32_16x16x32_bf16 v[52:55], v[212:215], v[32:35], v[52:55]
    ds_read_b64_tr_b16 v[30:31], v2 offset:53888
    v_mfma_f32_16x16x32_bf16 v[56:59], v[32:35], v[32:35], v[56:59]
    v_mfma_f32_16x16x32_bf16 v[60:63], v[10:13], v[32:35], v[60:63]
    s_waitcnt lgkmcnt(12)
    v_mfma_f32_16x16x32_bf16 v[64:67], v[132:135], v[36:39], v[64:67]
    s_barrier
    ds_read_b64_tr_b16 v[32:33], v2 offset:56352
    v_mfma_f32_16x16x32_bf16 v[68:71], v[212:215], v[36:39], v[68:71]
    ds_read_b64_tr_b16 v[34:35], v2 offset:58912
    s_waitcnt lgkmcnt(12)
    v_mfma_f32_16x16x32_bf16 v[72:75], v[132:135], v[40:43], v[72:75]
    ds_read_b64_tr_b16 v[36:37], v2 offset:56384
    v_mfma_f32_16x16x32_bf16 v[76:79], v[212:215], v[40:43], v[76:79]
    ds_read_b64_tr_b16 v[38:39], v2 offset:58944
    s_waitcnt lgkmcnt(12)
    v_mfma_f32_16x16x32_bf16 v[80:83], v[132:135], v[44:47], v[80:83]
    ds_read_b64_tr_b16 v[40:41], v2 offset:56416
    v_mfma_f32_16x16x32_bf16 v[84:87], v[212:215], v[44:47], v[84:87]
    ds_read_b64_tr_b16 v[42:43], v2 offset:58976
    s_waitcnt lgkmcnt(12)
    v_mfma_f32_16x16x32_bf16 v[48:51], v[136:139], v[16:19], v[48:51]
    ds_read_b64_tr_b16 v[44:45], v2 offset:56448
    v_mfma_f32_16x16x32_bf16 v[52:55], v[216:219], v[16:19], v[52:55]
    ds_read_b64_tr_b16 v[46:47], v2 offset:59008
    v_mfma_f32_16x16x32_bf16 v[56:59], v[16:19], v[16:19], v[56:59]
    v_mfma_f32_16x16x32_bf16 v[60:63], v[10:13], v[16:19], v[60:63]
    s_waitcnt lgkmcnt(12)
    v_mfma_f32_16x16x32_bf16 v[64:67], v[136:139], v[20:23], v[64:67]
    ds_read_b64_tr_b16 v[16:17], v3 offset:32
    v_mfma_f32_16x16x32_bf16 v[68:71], v[216:219], v[20:23], v[68:71]
    ds_read_b64_tr_b16 v[18:19], v3 offset:2592
    s_waitcnt lgkmcnt(12)
    v_mfma_f32_16x16x32_bf16 v[72:75], v[136:139], v[24:27], v[72:75]
    ds_read_b64_tr_b16 v[20:21], v3 offset:64
    v_mfma_f32_16x16x32_bf16 v[76:79], v[216:219], v[24:27], v[76:79]
    ds_read_b64_tr_b16 v[22:23], v3 offset:2624
    s_waitcnt lgkmcnt(12)
    v_mfma_f32_16x16x32_bf16 v[80:83], v[136:139], v[28:31], v[80:83]
    ds_read_b64_tr_b16 v[24:25], v3 offset:96
    v_mfma_f32_16x16x32_bf16 v[84:87], v[216:219], v[28:31], v[84:87]
    ds_read_b64_tr_b16 v[26:27], v3 offset:2656
    s_waitcnt lgkmcnt(12)
    v_mfma_f32_16x16x32_bf16 v[48:51], v[140:143], v[32:35], v[48:51]
    ds_read_b64_tr_b16 v[28:29], v3 offset:128
    v_mfma_f32_16x16x32_bf16 v[52:55], v[220:223], v[32:35], v[52:55]
    ds_read_b64_tr_b16 v[30:31], v3 offset:2688
    v_mfma_f32_16x16x32_bf16 v[56:59], v[32:35], v[32:35], v[56:59]
    v_mfma_f32_16x16x32_bf16 v[60:63], v[10:13], v[32:35], v[60:63]
    s_waitcnt lgkmcnt(12)
    v_mfma_f32_16x16x32_bf16 v[64:67], v[140:143], v[36:39], v[64:67]
    ds_read_b64_tr_b16 v[32:33], v3 offset:5152
    v_mfma_f32_16x16x32_bf16 v[68:71], v[220:223], v[36:39], v[68:71]
    ds_read_b64_tr_b16 v[34:35], v3 offset:7712
    s_waitcnt lgkmcnt(12)
    v_mfma_f32_16x16x32_bf16 v[72:75], v[140:143], v[40:43], v[72:75]
    ds_read_b64_tr_b16 v[36:37], v3 offset:5184
    v_mfma_f32_16x16x32_bf16 v[76:79], v[220:223], v[40:43], v[76:79]
    ds_read_b64_tr_b16 v[38:39], v3 offset:7744
    s_waitcnt lgkmcnt(12)
    v_mfma_f32_16x16x32_bf16 v[80:83], v[140:143], v[44:47], v[80:83]
    ds_read_b64_tr_b16 v[40:41], v3 offset:5216
    v_mfma_f32_16x16x32_bf16 v[84:87], v[220:223], v[44:47], v[84:87]
    ds_read_b64_tr_b16 v[42:43], v3 offset:7776
    s_waitcnt lgkmcnt(12)
    v_mfma_f32_16x16x32_bf16 v[48:51], v[144:147], v[16:19], v[48:51]
    ds_read_b64_tr_b16 v[44:45], v3 offset:5248
    v_mfma_f32_16x16x32_bf16 v[52:55], v[224:227], v[16:19], v[52:55]
    ds_read_b64_tr_b16 v[46:47], v3 offset:7808
    v_mfma_f32_16x16x32_bf16 v[56:59], v[16:19], v[16:19], v[56:59]
    v_mfma_f32_16x16x32_bf16 v[60:63], v[10:13], v[16:19], v[60:63]
    s_waitcnt lgkmcnt(12)
    v_mfma_f32_16x16x32_bf16 v[64:67], v[144:147], v[20:23], v[64:67]
    ds_read_b64_tr_b16 v[16:17], v3 offset:10272
    v_mfma_f32_16x16x32_bf16 v[68:71], v[224:227], v[20:23], v[68:71]
    ds_read_b64_tr_b16 v[18:19], v3 offset:12832
    s_waitcnt lgkmcnt(12)
    v_mfma_f32_16x16x32_bf16 v[72:75], v[144:147], v[24:27], v[72:75]
    ds_read_b64_tr_b16 v[20:21], v3 offset:10304
    v_mfma_f32_16x16x32_bf16 v[76:79], v[224:227], v[24:27], v[76:79]
    ds_read_b64_tr_b16 v[22:23], v3 offset:12864
    s_waitcnt lgkmcnt(12)
    v_mfma_f32_16x16x32_bf16 v[80:83], v[144:147], v[28:31], v[80:83]
    ds_read_b64_tr_b16 v[24:25], v3 offset:10336
    v_mfma_f32_16x16x32_bf16 v[84:87], v[224:227], v[28:31], v[84:87]
    ds_read_b64_tr_b16 v[26:27], v3 offset:12896
    s_waitcnt lgkmcnt(12)
    v_mfma_f32_16x16x32_bf16 v[48:51], v[148:151], v[32:35], v[48:51]
    ds_read_b64_tr_b16 v[28:29], v3 offset:10368
    v_mfma_f32_16x16x32_bf16 v[52:55], v[228:231], v[32:35], v[52:55]
    ds_read_b64_tr_b16 v[30:31], v3 offset:12928
    v_mfma_f32_16x16x32_bf16 v[56:59], v[32:35], v[32:35], v[56:59]
    v_mfma_f32_16x16x32_bf16 v[60:63], v[10:13], v[32:35], v[60:63]
    s_waitcnt lgkmcnt(12)
    v_mfma_f32_16x16x32_bf16 v[64:67], v[148:151], v[36:39], v[64:67]
    ds_read_b64_tr_b16 v[32:33], v3 offset:15392
    v_mfma_f32_16x16x32_bf16 v[68:71], v[228:231], v[36:39], v[68:71]
    ds_read_b64_tr_b16 v[34:35], v3 offset:17952
    s_waitcnt lgkmcnt(12)
    v_mfma_f32_16x16x32_bf16 v[72:75], v[148:151], v[40:43], v[72:75]
    ds_read_b64_tr_b16 v[36:37], v3 offset:15424
    v_mfma_f32_16x16x32_bf16 v[76:79], v[228:231], v[40:43], v[76:79]
    ds_read_b64_tr_b16 v[38:39], v3 offset:17984
    s_waitcnt lgkmcnt(12)
    v_mfma_f32_16x16x32_bf16 v[80:83], v[148:151], v[44:47], v[80:83]
    ds_read_b64_tr_b16 v[40:41], v3 offset:15456
    v_mfma_f32_16x16x32_bf16 v[84:87], v[228:231], v[44:47], v[84:87]
    ds_read_b64_tr_b16 v[42:43], v3 offset:18016
    s_waitcnt lgkmcnt(12)
    v_mfma_f32_16x16x32_bf16 v[48:51], v[152:155], v[16:19], v[48:51]
    ds_read_b64_tr_b16 v[44:45], v3 offset:15488
    v_mfma_f32_16x16x32_bf16 v[52:55], v[232:235], v[16:19], v[52:55]
    ds_read_b64_tr_b16 v[46:47], v3 offset:18048
    v_mfma_f32_16x16x32_bf16 v[56:59], v[16:19], v[16:19], v[56:59]
    v_mfma_f32_16x16x32_bf16 v[60:63], v[10:13], v[16:19], v[60:63]
    s_waitcnt lgkmcnt(12)
    v_mfma_f32_16x16x32_bf16 v[64:67], v[152:155], v[20:23], v[64:67]
    ds_read_b64_tr_b16 v[16:17], v3 offset:20512
    v_mfma_f32_16x16x32_bf16 v[68:71], v[232:235], v[20:23], v[68:71]
    ds_read_b64_tr_b16 v[18:19], v3 offset:23072
    s_waitcnt lgkmcnt(12)
    v_mfma_f32_16x16x32_bf16 v[72:75], v[152:155], v[24:27], v[72:75]
    ds_read_b64_tr_b16 v[20:21], v3 offset:20544
    v_mfma_f32_16x16x32_bf16 v[76:79], v[232:235], v[24:27], v[76:79]
    ds_read_b64_tr_b16 v[22:23], v3 offset:23104
    s_waitcnt lgkmcnt(12)
    v_mfma_f32_16x16x32_bf16 v[80:83], v[152:155], v[28:31], v[80:83]
    ds_read_b64_tr_b16 v[24:25], v3 offset:20576
    v_mfma_f32_16x16x32_bf16 v[84:87], v[232:235], v[28:31], v[84:87]
    ds_read_b64_tr_b16 v[26:27], v3 offset:23136
    s_waitcnt lgkmcnt(12)
    v_mfma_f32_16x16x32_bf16 v[48:51], v[156:159], v[32:35], v[48:51]
    ds_read_b64_tr_b16 v[28:29], v3 offset:20608
    v_mfma_f32_16x16x32_bf16 v[52:55], v[236:239], v[32:35], v[52:55]
    ds_read_b64_tr_b16 v[30:31], v3 offset:23168
    v_mfma_f32_16x16x32_bf16 v[56:59], v[32:35], v[32:35], v[56:59]
    v_mfma_f32_16x16x32_bf16 v[60:63], v[10:13], v[32:35], v[60:63]
    s_waitcnt lgkmcnt(12)
    v_mfma_f32_16x16x32_bf16 v[64:67], v[156:159], v[36:39], v[64:67]
    ds_read_b64_tr_b16 v[32:33], v3 offset:25632
    v_mfma_f32_16x16x32_bf16 v[68:71], v[236:239], v[36:39], v[68:71]
    ds_read_b64_tr_b16 v[34:35], v3 offset:28192
    s_waitcnt lgkmcnt(12)
    v_mfma_f32_16x16x32_bf16 v[72:75], v[156:159], v[40:43], v[72:75]
    ds_read_b64_tr_b16 v[36:37], v3 offset:25664
    v_mfma_f32_16x16x32_bf16 v[76:79], v[236:239], v[40:43], v[76:79]
    ds_read_b64_tr_b16 v[38:39], v3 offset:28224
    s_waitcnt lgkmcnt(12)
    v_mfma_f32_16x16x32_bf16 v[80:83], v[156:159], v[44:47], v[80:83]
    ds_read_b64_tr_b16 v[40:41], v3 offset:25696
    v_mfma_f32_16x16x32_bf16 v[84:87], v[236:239], v[44:47], v[84:87]
    ds_read_b64_tr_b16 v[42:43], v3 offset:28256
    s_waitcnt lgkmcnt(12)
    v_mfma_f32_16x16x32_bf16 v[48:51], v[160:163], v[16:19], v[48:51]
    ds_read_b64_tr_b16 v[44:45], v3 offset:25728
    v_mfma_f32_16x16x32_bf16 v[52:55], v[240:243], v[16:19], v[52:55]
    ds_read_b64_tr_b16 v[46:47], v3 offset:28288
    v_mfma_f32_16x16x32_bf16 v[56:59], v[16:19], v[16:19], v[56:59]
    v_mfma_f32_16x16x32_bf16 v[60:63], v[10:13], v[16:19], v[60:63]
    s_waitcnt lgkmcnt(12)
    v_mfma_f32_16x16x32_bf16 v[64:67], v[160:163], v[20:23], v[64:67]
    ds_read_b64_tr_b16 v[16:17], v3 offset:30752
    v_mfma_f32_16x16x32_bf16 v[68:71], v[240:243], v[20:23], v[68:71]
    ds_read_b64_tr_b16 v[18:19], v3 offset:33312
    s_waitcnt lgkmcnt(12)
    v_mfma_f32_16x16x32_bf16 v[72:75], v[160:163], v[24:27], v[72:75]
    ds_read_b64_tr_b16 v[20:21], v3 offset:30784
    v_mfma_f32_16x16x32_bf16 v[76:79], v[240:243], v[24:27], v[76:79]
    ds_read_b64_tr_b16 v[22:23], v3 offset:33344
    s_waitcnt lgkmcnt(12)
    v_mfma_f32_16x16x32_bf16 v[80:83], v[160:163], v[28:31], v[80:83]
    ds_read_b64_tr_b16 v[24:25], v3 offset:30816
    v_mfma_f32_16x16x32_bf16 v[84:87], v[240:243], v[28:31], v[84:87]
    ds_read_b64_tr_b16 v[26:27], v3 offset:33376
    s_waitcnt lgkmcnt(12)
    v_mfma_f32_16x16x32_bf16 v[48:51], v[164:167], v[32:35], v[48:51]
    ds_read_b64_tr_b16 v[28:29], v3 offset:30848
    v_mfma_f32_16x16x32_bf16 v[52:55], v[244:247], v[32:35], v[52:55]
    ds_read_b64_tr_b16 v[30:31], v3 offset:33408
    v_mfma_f32_16x16x32_bf16 v[56:59], v[32:35], v[32:35], v[56:59]
    v_mfma_f32_16x16x32_bf16 v[60:63], v[10:13], v[32:35], v[60:63]
    s_waitcnt lgkmcnt(12)
    v_mfma_f32_16x16x32_bf16 v[64:67], v[164:167], v[36:39], v[64:67]
    ds_read_b64_tr_b16 v[32:33], v3 offset:35872
    v_mfma_f32_16x16x32_bf16 v[68:71], v[244:247], v[36:39], v[68:71]
    ds_read_b64_tr_b16 v[34:35], v3 offset:38432
    s_waitcnt lgkmcnt(12)
    v_mfma_f32_16x16x32_bf16 v[72:75], v[164:167], v[40:43], v[72:75]
    ds_read_b64_tr_b16 v[36:37], v3 offset:35904
    v_mfma_f32_16x16x32_bf16 v[76:79], v[244:247], v[40:43], v[76:79]
    ds_read_b64_tr_b16 v[38:39], v3 offset:38464
    s_waitcnt lgkmcnt(12)
    v_mfma_f32_16x16x32_bf16 v[80:83], v[164:167], v[44:47], v[80:83]
    ds_read_b64_tr_b16 v[40:41], v3 offset:35936
    v_mfma_f32_16x16x32_bf16 v[84:87], v[244:247], v[44:47], v[84:87]
    ds_read_b64_tr_b16 v[42:43], v3 offset:38496
    s_waitcnt lgkmcnt(12)
    v_mfma_f32_16x16x32_bf16 v[48:51], v[168:171], v[16:19], v[48:51]
    ds_read_b64_tr_b16 v[44:45], v3 offset:35968
    v_mfma_f32_16x16x32_bf16 v[52:55], v[248:251], v[16:19], v[52:55]
    ds_read_b64_tr_b16 v[46:47], v3 offset:38528
    v_mfma_f32_16x16x32_bf16 v[56:59], v[16:19], v[16:19], v[56:59]
    v_mfma_f32_16x16x32_bf16 v[60:63], v[10:13], v[16:19], v[60:63]
    s_waitcnt lgkmcnt(12)
    v_mfma_f32_16x16x32_bf16 v[64:67], v[168:171], v[20:23], v[64:67]
    v_mfma_f32_16x16x32_bf16 v[68:71], v[248:251], v[20:23], v[68:71]
    s_waitcnt lgkmcnt(10)
    v_mfma_f32_16x16x32_bf16 v[72:75], v[168:171], v[24:27], v[72:75]
    v_mfma_f32_16x16x32_bf16 v[76:79], v[248:251], v[24:27], v[76:79]
    s_waitcnt lgkmcnt(8)
    v_mfma_f32_16x16x32_bf16 v[80:83], v[168:171], v[28:31], v[80:83]
    v_mfma_f32_16x16x32_bf16 v[84:87], v[248:251], v[28:31], v[84:87]
    s_waitcnt lgkmcnt(6)
    v_mfma_f32_16x16x32_bf16 v[48:51], v[172:175], v[32:35], v[48:51]
    v_mfma_f32_16x16x32_bf16 v[52:55], v[252:255], v[32:35], v[52:55]
    v_mfma_f32_16x16x32_bf16 v[56:59], v[32:35], v[32:35], v[56:59]
    v_mfma_f32_16x16x32_bf16 v[60:63], v[10:13], v[32:35], v[60:63]
    s_waitcnt lgkmcnt(4)
    v_mfma_f32_16x16x32_bf16 v[64:67], v[172:175], v[36:39], v[64:67]
    v_mfma_f32_16x16x32_bf16 v[68:71], v[252:255], v[36:39], v[68:71]
    s_waitcnt lgkmcnt(2)
    v_mfma_f32_16x16x32_bf16 v[72:75], v[172:175], v[40:43], v[72:75]
    v_mfma_f32_16x16x32_bf16 v[76:79], v[252:255], v[40:43], v[76:79]
    s_waitcnt lgkmcnt(0)
    v_mfma_f32_16x16x32_bf16 v[80:83], v[172:175], v[44:47], v[80:83]
    v_mfma_f32_16x16x32_bf16 v[84:87], v[252:255], v[44:47], v[84:87]
    ds_read_b64 v[10:11], v7
    ds_read_b64 v[12:13], v8
    ds_read_b64 v[14:15], v9
    v_and_b32 v16, 15, v1
    v_lshrrev_b32 v17, 4, v1
    v_and_b32 v18, 3, v1
    v_lshrrev_b32 v19, 2, v16
    v_cmp_eq_u32 s[42:43], 1, v18
    v_cmp_eq_u32 s[44:45], 2, v18
    v_cmp_eq_u32 s[46:47], 3, v18
    v_cmp_eq_u32 s[54:55], v19, v17
    v_lshlrev_b32 v18, 3, v16
    v_add_u32 v18, 45376, v18
    v_cndmask_b32 v56, v56, v57, s[42:43]
    v_cndmask_b32 v56, v56, v58, s[44:45]
    v_cndmask_b32 v56, v56, v59, s[46:47]
    v_mul_f32 v60, 0x3acccccd, v60
    v_mul_f32 v56, 0x3acccccd, v56
    v_fma_f32 v56, -v60, v60, v56
    v_max_f32 v56, 0, v56
    v_cvt_pk_bf16_f32 v60, v60, v56
    v_and_b32 v56, 0xffff0000, v60
    v_lshlrev_b32 v60, 16, v60
    v_add_f32 v56, 0x3727c5ac, v56
    v_cvt_pk_bf16_f32 v56, v56, v56
    v_lshlrev_b32 v56, 16, v56
    v_sqrt_f32 v56, v56
    s_nop 0
    v_cvt_pk_bf16_f32 v56, v56, v56
    v_lshlrev_b32 v56, 16, v56
    v_rcp_f32 v61, v56
    s_mov_b64 exec, s[54:55]
    ds_write_b64 v18, v[60:61] offset:128
    s_mov_b64 exec, -1
    s_lshl_b32 s42, s3, 7
    s_add_u32 s42, s42, 46016
    v_lshl_add_u32 v19, v17, 4, s42
    s_lshl_b32 s42, s3, 6
    s_cmp_eq_u32 s3, 2
    s_cselect_b32 s42, 192, s42
    s_cmp_eq_u32 s3, 3
    s_cselect_b32 s42, 128, s42
    s_add_u32 s42, s42, 61440
    v_mul_u32_u24 v20, 496, v16
    v_lshl_add_u32 v20, v17, 4, v20
    v_add_u32 v20, s42, v20
    v_lshlrev_b32 v18, 3, v16
    v_add_u32 v18, 45376, v18
    s_waitcnt lgkmcnt(0)
    s_barrier
    ds_read_b64 v[26:27], v18 offset:128
    ds_read_b64 v[28:29], v18 offset:256
    ds_read_b64 v[30:31], v18 offset:384
    ds_read_b64 v[32:33], v18 offset:512
    ds_read_b128 v[36:39], v19 offset:0
    ds_read_b128 v[40:43], v19 offset:64
    s_waitcnt lgkmcnt(0)
    v_fma_f32 v48, -v26, v36, v48
    v_fma_f32 v49, -v26, v37, v49
    v_fma_f32 v50, -v26, v38, v50
    v_fma_f32 v51, -v26, v39, v51
    v_fma_f32 v52, -v26, v40, v52
    v_fma_f32 v53, -v26, v41, v53
    v_fma_f32 v54, -v26, v42, v54
    v_fma_f32 v55, -v26, v43, v55
    v_fma_f32 v64, -v28, v36, v64
    v_fma_f32 v65, -v28, v37, v65
    v_fma_f32 v66, -v28, v38, v66
    v_fma_f32 v67, -v28, v39, v67
    v_fma_f32 v68, -v28, v40, v68
    v_fma_f32 v69, -v28, v41, v69
    v_fma_f32 v70, -v28, v42, v70
    v_fma_f32 v71, -v28, v43, v71
    v_fma_f32 v72, -v30, v36, v72
    v_fma_f32 v73, -v30, v37, v73
    v_fma_f32 v74, -v30, v38, v74
    v_fma_f32 v75, -v30, v39, v75
    v_fma_f32 v76, -v30, v40, v76
    v_fma_f32 v77, -v30, v41, v77
    v_fma_f32 v78, -v30, v42, v78
    v_fma_f32 v79, -v30, v43, v79
    v_fma_f32 v80, -v32, v36, v80
    v_fma_f32 v81, -v32, v37, v81
    v_fma_f32 v82, -v32, v38, v82
    v_fma_f32 v83, -v32, v39, v83
    v_fma_f32 v84, -v32, v40, v84
    v_fma_f32 v85, -v32, v41, v85
    v_fma_f32 v86, -v32, v42, v86
    v_fma_f32 v87, -v32, v43, v87
    v_mul_f32 v48, v48, v27
    v_mul_f32 v49, v49, v27
    v_mul_f32 v50, v50, v27
    v_mul_f32 v51, v51, v27
    v_mul_f32 v52, v52, v27
    v_mul_f32 v53, v53, v27
    v_mul_f32 v54, v54, v27
    v_mul_f32 v55, v55, v27
    v_mul_f32 v64, v64, v29
    v_mul_f32 v65, v65, v29
    v_mul_f32 v66, v66, v29
    v_mul_f32 v67, v67, v29
    v_mul_f32 v68, v68, v29
    v_mul_f32 v69, v69, v29
    v_mul_f32 v70, v70, v29
    v_mul_f32 v71, v71, v29
    v_mul_f32 v72, v72, v31
    v_mul_f32 v73, v73, v31
    v_mul_f32 v74, v74, v31
    v_mul_f32 v75, v75, v31
    v_mul_f32 v76, v76, v31
    v_mul_f32 v77, v77, v31
    v_mul_f32 v78, v78, v31
    v_mul_f32 v79, v79, v31
    v_mul_f32 v80, v80, v33
    v_mul_f32 v81, v81, v33
    v_mul_f32 v82, v82, v33
    v_mul_f32 v83, v83, v33
    v_mul_f32 v84, v84, v33
    v_mul_f32 v85, v85, v33
    v_mul_f32 v86, v86, v33
    v_mul_f32 v87, v87, v33
    v_cvt_pk_bf16_f32 v48, v48, v52
    v_cvt_pk_bf16_f32 v49, v49, v53
    v_cvt_pk_bf16_f32 v50, v50, v54
    v_cvt_pk_bf16_f32 v51, v51, v55
    ds_write_b128 v20, v[48:51] offset:7936
    v_cvt_pk_bf16_f32 v64, v64, v68
    v_cvt_pk_bf16_f32 v65, v65, v69
    v_cvt_pk_bf16_f32 v66, v66, v70
    v_cvt_pk_bf16_f32 v67, v67, v71
    ds_write_b128 v20, v[64:67] offset:15872
    v_cvt_pk_bf16_f32 v72, v72, v76
    v_cvt_pk_bf16_f32 v73, v73, v77
    v_cvt_pk_bf16_f32 v74, v74, v78
    v_cvt_pk_bf16_f32 v75, v75, v79
    ds_write_b128 v20, v[72:75] offset:23808
    v_cvt_pk_bf16_f32 v80, v80, v84
    v_cvt_pk_bf16_f32 v81, v81, v85
    v_cvt_pk_bf16_f32 v82, v82, v86
    v_cvt_pk_bf16_f32 v83, v83, v87
    ds_write_b128 v20, v[80:83] offset:31744
    s_branch L_a1_post
L_g2B:
    s_waitcnt vmcnt(3)
    s_barrier
    ds_read_b64_tr_b16 v[16:17], v2 offset:32
    ds_read_b64_tr_b16 v[18:19], v2 offset:2592
    ds_read_b64_tr_b16 v[20:21], v2 offset:64
    ds_read_b64_tr_b16 v[22:23], v2 offset:2624
    ds_read_b64_tr_b16 v[24:25], v2 offset:96
    ds_read_b64_tr_b16 v[26:27], v2 offset:2656
    ds_read_b64_tr_b16 v[28:29], v2 offset:128
    ds_read_b64_tr_b16 v[30:31], v2 offset:2688
    s_waitcnt vmcnt(2)
    s_barrier
    ds_read_b64_tr_b16 v[32:33], v2 offset:5152
    ds_read_b64_tr_b16 v[34:35], v2 offset:7712
    ds_read_b64_tr_b16 v[36:37], v2 offset:5184
    ds_read_b64_tr_b16 v[38:39], v2 offset:7744
    ds_read_b64_tr_b16 v[40:41], v2 offset:5216
    ds_read_b64_tr_b16 v[42:43], v2 offset:7776
    s_waitcnt lgkmcnt(12)
    v_mfma_f32_16x16x32_bf16 v[48:51], v[96:99], v[16:19], 0
    ds_read_b64_tr_b16 v[44:45], v2 offset:5248
    v_mfma_f32_16x16x32_bf16 v[52:55], v[176:179], v[16:19], 0
    ds_read_b64_tr_b16 v[46:47], v2 offset:7808
    s_waitcnt lgkmcnt(12)
    v_mfma_f32_16x16x32_bf16 v[56:59], v[96:99], v[20:23], 0
    ds_read_b64_tr_b16 v[16:17], v2 offset:10272
    v_mfma_f32_16x16x32_bf16 v[60:63], v[176:179], v[20:23], 0
    ds_read_b64_tr_b16 v[18:19], v2 offset:12832
    v_mfma_f32_16x16x32_bf16 v[64:67], v[20:23], v[20:23], 0
    v_mfma_f32_16x16x32_bf16 v[68:71], v[10:13], v[20:23], 0
    s_waitcnt lgkmcnt(12)
    v_mfma_f32_16x16x32_bf16 v[72:75], v[96:99], v[24:27], 0
    ds_read_b64_tr_b16 v[20:21], v2 offset:10304
    v_mfma_f32_16x16x32_bf16 v[76:79], v[176:179], v[24:27], 0
    ds_read_b64_tr_b16 v[22:23], v2 offset:12864
    s_waitcnt lgkmcnt(12)
    v_mfma_f32_16x16x32_bf16 v[80:83], v[96:99], v[28:31], 0
    ds_read_b64_tr_b16 v[24:25], v2 offset:10336
    v_mfma_f32_16x16x32_bf16 v[84:87], v[176:179], v[28:31], 0
    ds_read_b64_tr_b16 v[26:27], v2 offset:12896
    s_waitcnt lgkmcnt(12)
    v_mfma_f32_16x16x32_bf16 v[48:51], v[100:103], v[32:35], v[48:51]
    ds_read_b64_tr_b16 v[28:29], v2 offset:10368
    v_mfma_f32_16x16x32_bf16 v[52:55], v[180:183], v[32:35], v[52:55]
    ds_read_b64_tr_b16 v[30:31], v2 offset:12928
    s_waitcnt lgkmcnt(12)
    v_mfma_f32_16x16x32_bf16 v[56:59], v[100:103], v[36:39], v[56:59]
    s_waitcnt vmcnt(0)
    s_barrier
    v_mfma_f32_16x16x32_bf16 v[60:63], v[180:183], v[36:39], v[60:63]
    ds_read_b64_tr_b16 v[32:33], v2 offset:15392
    v_mfma_f32_16x16x32_bf16 v[64:67], v[36:39], v[36:39], v[64:67]
    ds_read_b64_tr_b16 v[34:35], v2 offset:17952
    v_mfma_f32_16x16x32_bf16 v[68:71], v[10:13], v[36:39], v[68:71]
    s_waitcnt lgkmcnt(12)
    v_mfma_f32_16x16x32_bf16 v[72:75], v[100:103], v[40:43], v[72:75]
    ds_read_b64_tr_b16 v[36:37], v2 offset:15424
    v_mfma_f32_16x16x32_bf16 v[76:79], v[180:183], v[40:43], v[76:79]
    ds_read_b64_tr_b16 v[38:39], v2 offset:17984
    s_waitcnt lgkmcnt(12)
    v_mfma_f32_16x16x32_bf16 v[80:83], v[100:103], v[44:47], v[80:83]
    ds_read_b64_tr_b16 v[40:41], v2 offset:15456
    v_mfma_f32_16x16x32_bf16 v[84:87], v[180:183], v[44:47], v[84:87]
    ds_read_b64_tr_b16 v[42:43], v2 offset:18016
    s_waitcnt lgkmcnt(12)
    v_mfma_f32_16x16x32_bf16 v[48:51], v[104:107], v[16:19], v[48:51]
    ds_read_b64_tr_b16 v[44:45], v2 offset:15488
    v_mfma_f32_16x16x32_bf16 v[52:55], v[184:187], v[16:19], v[52:55]
    ds_read_b64_tr_b16 v[46:47], v2 offset:18048
    s_waitcnt lgkmcnt(12)
    v_mfma_f32_16x16x32_bf16 v[56:59], v[104:107], v[20:23], v[56:59]
    ds_read_b64_tr_b16 v[16:17], v2 offset:20512
    v_mfma_f32_16x16x32_bf16 v[60:63], v[184:187], v[20:23], v[60:63]
    ds_read_b64_tr_b16 v[18:19], v2 offset:23072
    v_mfma_f32_16x16x32_bf16 v[64:67], v[20:23], v[20:23], v[64:67]
    v_mfma_f32_16x16x32_bf16 v[68:71], v[10:13], v[20:23], v[68:71]
    s_waitcnt lgkmcnt(12)
    v_mfma_f32_16x16x32_bf16 v[72:75], v[104:107], v[24:27], v[72:75]
    ds_read_b64_tr_b16 v[20:21], v2 offset:20544
    v_mfma_f32_16x16x32_bf16 v[76:79], v[184:187], v[24:27], v[76:79]
    ds_read_b64_tr_b16 v[22:23], v2 offset:23104
    s_waitcnt lgkmcnt(12)
    v_mfma_f32_16x16x32_bf16 v[80:83], v[104:107], v[28:31], v[80:83]
    ds_read_b64_tr_b16 v[24:25], v2 offset:20576
    v_mfma_f32_16x16x32_bf16 v[84:87], v[184:187], v[28:31], v[84:87]
    ds_read_b64_tr_b16 v[26:27], v2 offset:23136
    s_waitcnt lgkmcnt(12)
    v_mfma_f32_16x16x32_bf16 v[48:51], v[108:111], v[32:35], v[48:51]
    ds_read_b64_tr_b16 v[28:29], v2 offset:20608
    v_mfma_f32_16x16x32_bf16 v[52:55], v[188:191], v[32:35], v[52:55]
    ds_read_b64_tr_b16 v[30:31], v2 offset:23168
    s_waitcnt lgkmcnt(12)
    v_mfma_f32_16x16x32_bf16 v[56:59], v[108:111], v[36:39], v[56:59]
    ds_read_b64_tr_b16 v[32:33], v2 offset:25632
    v_mfma_f32_16x16x32_bf16 v[60:63], v[188:191], v[36:39], v[60:63]
    ds_read_b64_tr_b16 v[34:35], v2 offset:28192
    v_mfma_f32_16x16x32_bf16 v[64:67], v[36:39], v[36:39], v[64:67]
    v_mfma_f32_16x16x32_bf16 v[68:71], v[10:13], v[36:39], v[68:71]
    s_waitcnt lgkmcnt(12)
    v_mfma_f32_16x16x32_bf16 v[72:75], v[108:111], v[40:43], v[72:75]
    ds_read_b64_tr_b16 v[36:37], v2 offset:25664
    v_mfma_f32_16x16x32_bf16 v[76:79], v[188:191], v[40:43], v[76:79]
    ds_read_b64_tr_b16 v[38:39], v2 offset:28224
    s_waitcnt lgkmcnt(12)
    v_mfma_f32_16x16x32_bf16 v[80:83], v[108:111], v[44:47], v[80:83]
    ds_read_b64_tr_b16 v[40:41], v2 offset:25696
    v_mfma_f32_16x16x32_bf16 v[84:87], v[188:191], v[44:47], v[84:87]
    ds_read_b64_tr_b16 v[42:43], v2 offset:28256
    s_waitcnt lgkmcnt(12)
    v_mfma_f32_16x16x32_bf16 v[48:51], v[112:115], v[16:19], v[48:51]
    ds_read_b64_tr_b16 v[44:45], v2 offset:25728
    v_mfma_f32_16x16x32_bf16 v[52:55], v[192:195], v[16:19], v[52:55]
    ds_read_b64_tr_b16 v[46:47], v2 offset:28288
    s_waitcnt lgkmcnt(12)
    v_mfma_f32_16x16x32_bf16 v[56:59], v[112:115], v[20:23], v[56:59]
    s_barrier
    v_mfma_f32_16x16x32_bf16 v[60:63], v[192:195], v[20:23], v[60:63]
    ds_read_b64_tr_b16 v[16:17], v2 offset:30752
    v_mfma_f32_16x16x32_bf16 v[64:67], v[20:23], v[20:23], v[64:67]
    ds_read_b64_tr_b16 v[18:19], v2 offset:33312
    v_mfma_f32_16x16x32_bf16 v[68:71], v[10:13], v[20:23], v[68:71]
    s_waitcnt lgkmcnt(12)
    v_mfma_f32_16x16x32_bf16 v[72:75], v[112:115], v[24:27], v[72:75]
    ds_read_b64_tr_b16 v[20:21], v2 offset:30784
    v_mfma_f32_16x16x32_bf16 v[76:79], v[192:195], v[24:27], v[76:79]
    ds_read_b64_tr_b16 v[22:23], v2 offset:33344
    s_waitcnt lgkmcnt(12)
    v_mfma_f32_16x16x32_bf16 v[80:83], v[112:115], v[28:31], v[80:83]
    ds_read_b64_tr_b16 v[24:25], v2 offset:30816
    v_mfma_f32_16x16x32_bf16 v[84:87], v[192:195], v[28:31], v[84:87]
    ds_read_b64_tr_b16 v[26:27], v2 offset:33376
    s_waitcnt lgkmcnt(12)
    v_mfma_f32_16x16x32_bf16 v[48:51], v[116:119], v[32:35], v[48:51]
    ds_read_b64_tr_b16 v[28:29], v2 offset:30848
    v_mfma_f32_16x16x32_bf16 v[52:55], v[196:199], v[32:35], v[52:55]
    ds_read_b64_tr_b16 v[30:31], v2 offset:33408
    s_waitcnt lgkmcnt(12)
    v_mfma_f32_16x16x32_bf16 v[56:59], v[116:119], v[36:39], v[56:59]
    ds_read_b64_tr_b16 v[32:33], v2 offset:35872
    v_mfma_f32_16x16x32_bf16 v[60:63], v[196:199], v[36:39], v[60:63]
    ds_read_b64_tr_b16 v[34:35], v2 offset:38432
    v_mfma_f32_16x16x32_bf16 v[64:67], v[36:39], v[36:39], v[64:67]
    v_mfma_f32_16x16x32_bf16 v[68:71], v[10:13], v[36:39], v[68:71]
    s_waitcnt lgkmcnt(12)
    v_mfma_f32_16x16x32_bf16 v[72:75], v[116:119], v[40:43], v[72:75]
    ds_read_b64_tr_b16 v[36:37], v2 offset:35904
    v_mfma_f32_16x16x32_bf16 v[76:79], v[196:199], v[40:43], v[76:79]
    ds_read_b64_tr_b16 v[38:39], v2 offset:38464
    s_waitcnt lgkmcnt(12)
    v_mfma_f32_16x16x32_bf16 v[80:83], v[116:119], v[44:47], v[80:83]
    ds_read_b64_tr_b16 v[40:41], v2 offset:35936
    v_mfma_f32_16x16x32_bf16 v[84:87], v[196:199], v[44:47], v[84:87]
    ds_read_b64_tr_b16 v[42:43], v2 offset:38496
    s_waitcnt lgkmcnt(12)
    v_mfma_f32_16x16x32_bf16 v[48:51], v[120:123], v[16:19], v[48:51]
    ds_read_b64_tr_b16 v[44:45], v2 offset:35968
    v_mfma_f32_16x16x32_bf16 v[52:55], v[200:203], v[16:19], v[52:55]
    ds_read_b64_tr_b16 v[46:47], v2 offset:38528
    s_waitcnt lgkmcnt(12)
    v_mfma_f32_16x16x32_bf16 v[56:59], v[120:123], v[20:23], v[56:59]
    ds_read_b64_tr_b16 v[16:17], v2 offset:40992
    v_mfma_f32_16x16x32_bf16 v[60:63], v[200:203], v[20:23], v[60:63]
    ds_read_b64_tr_b16 v[18:19], v2 offset:43552
    v_mfma_f32_16x16x32_bf16 v[64:67], v[20:23], v[20:23], v[64:67]
    v_mfma_f32_16x16x32_bf16 v[68:71], v[10:13], v[20:23], v[68:71]
    s_waitcnt lgkmcnt(12)
    v_mfma_f32_16x16x32_bf16 v[72:75], v[120:123], v[24:27], v[72:75]
    ds_read_b64_tr_b16 v[20:21], v2 offset:41024
    v_mfma_f32_16x16x32_bf16 v[76:79], v[200:203], v[24:27], v[76:79]
    ds_read_b64_tr_b16 v[22:23], v2 offset:43584
    s_waitcnt lgkmcnt(12)
    v_mfma_f32_16x16x32_bf16 v[80:83], v[120:123], v[28:31], v[80:83]
    ds_read_b64_tr_b16 v[24:25], v2 offset:41056
    v_mfma_f32_16x16x32_bf16 v[84:87], v[200:203], v[28:31], v[84:87]
    ds_read_b64_tr_b16 v[26:27], v2 offset:43616
    s_waitcnt lgkmcnt(12)
    v_mfma_f32_16x16x32_bf16 v[48:51], v[124:127], v[32:35], v[48:51]
    ds_read_b64_tr_b16 v[28:29], v2 offset:41088
    v_mfma_f32_16x16x32_bf16 v[52:55], v[204:207], v[32:35], v[52:55]
    ds_read_b64_tr_b16 v[30:31], v2 offset:43648
    s_waitcnt lgkmcnt(12)
    v_mfma_f32_16x16x32_bf16 v[56:59], v[124:127], v[36:39], v[56:59]
    ds_read_b64_tr_b16 v[32:33], v2 offset:46112
    v_mfma_f32_16x16x32_bf16 v[60:63], v[204:207], v[36:39], v[60:63]
    ds_read_b64_tr_b16 v[34:35], v2 offset:48672
    v_mfma_f32_16x16x32_bf16 v[64:67], v[36:39], v[36:39], v[64:67]
    v_mfma_f32_16x16x32_bf16 v[68:71], v[10:13], v[36:39], v[68:71]
    s_waitcnt lgkmcnt(12)
    v_mfma_f32_16x16x32_bf16 v[72:75], v[124:127], v[40:43], v[72:75]
    ds_read_b64_tr_b16 v[36:37], v2 offset:46144
    v_mfma_f32_16x16x32_bf16 v[76:79], v[204:207], v[40:43], v[76:79]
    ds_read_b64_tr_b16 v[38:39], v2 offset:48704
    s_waitcnt lgkmcnt(12)
    v_mfma_f32_16x16x32_bf16 v[80:83], v[124:127], v[44:47], v[80:83]
    ds_read_b64_tr_b16 v[40:41], v2 offset:46176
    v_mfma_f32_16x16x32_bf16 v[84:87], v[204:207], v[44:47], v[84:87]
    ds_read_b64_tr_b16 v[42:43], v2 offset:48736
    s_waitcnt lgkmcnt(12)
    v_mfma_f32_16x16x32_bf16 v[48:51], v[128:131], v[16:19], v[48:51]
    ds_read_b64_tr_b16 v[44:45], v2 offset:46208
    v_mfma_f32_16x16x32_bf16 v[52:55], v[208:211], v[16:19], v[52:55]
    ds_read_b64_tr_b16 v[46:47], v2 offset:48768
    s_waitcnt lgkmcnt(12)
    v_mfma_f32_16x16x32_bf16 v[56:59], v[128:131], v[20:23], v[56:59]
    ds_read_b64_tr_b16 v[16:17], v2 offset:51232
    v_mfma_f32_16x16x32_bf16 v[60:63], v[208:211], v[20:23], v[60:63]
    ds_read_b64_tr_b16 v[18:19], v2 offset:53792
    v_mfma_f32_16x16x32_bf16 v[64:67], v[20:23], v[20:23], v[64:67]
    v_mfma_f32_16x16x32_bf16 v[68:71], v[10:13], v[20:23], v[68:71]
    s_waitcnt lgkmcnt(12)
    v_mfma_f32_16x16x32_bf16 v[72:75], v[128:131], v[24:27], v[72:75]
    ds_read_b64_tr_b16 v[20:21], v2 offset:51264
    v_mfma_f32_16x16x32_bf16 v[76:79], v[208:211], v[24:27], v[76:79]
    ds_read_b64_tr_b16 v[22:23], v2 offset:53824
    s_waitcnt lgkmcnt(12)
    v_mfma_f32_16x16x32_bf16 v[80:83], v[128:131], v[28:31], v[80:83]
    ds_read_b64_tr_b16 v[24:25], v2 offset:51296
    v_mfma_f32_16x16x32_bf16 v[84:87], v[208:211], v[28:31], v[84:87]
    ds_read_b64_tr_b16 v[26:27], v2 offset:53856
    s_waitcnt lgkmcnt(12)
    v_mfma_f32_16x16x32_bf16 v[48:51], v[132:135], v[32:35], v[48:51]
    ds_read_b64_tr_b16 v[28:29], v2 offset:51328
    v_mfma_f32_16x16x32_bf16 v[52:55], v[212:215], v[32:35], v[52:55]
    ds_read_b64_tr_b16 v[30:31], v2 offset:53888
    s_waitcnt lgkmcnt(12)
    v_mfma_f32_16x16x32_bf16 v[56:59], v[132:135], v[36:39], v[56:59]
    s_barrier
    v_mfma_f32_16x16x32_bf16 v[60:63], v[212:215], v[36:39], v[60:63]
    ds_read_b64_tr_b16 v[32:33], v2 offset:56352
    v_mfma_f32_16x16x32_bf16 v[64:67], v[36:39], v[36:39], v[64:67]
    ds_read_b64_tr_b16 v[34:35], v2 offset:58912
    v_mfma_f32_16x16x32_bf16 v[68:71], v[10:13], v[36:39], v[68:71]
    s_waitcnt lgkmcnt(12)
    v_mfma_f32_16x16x32_bf16 v[72:75], v[132:135], v[40:43], v[72:75]
    ds_read_b64_tr_b16 v[36:37], v2 offset:56384
    v_mfma_f32_16x16x32_bf16 v[76:79], v[212:215], v[40:43], v[76:79]
    ds_read_b64_tr_b16 v[38:39], v2 offset:58944
    s_waitcnt lgkmcnt(12)
    v_mfma_f32_16x16x32_bf16 v[80:83], v[132:135], v[44:47], v[80:83]
    ds_read_b64_tr_b16 v[40:41], v2 offset:56416
    v_mfma_f32_16x16x32_bf16 v[84:87], v[212:215], v[44:47], v[84:87]
    ds_read_b64_tr_b16 v[42:43], v2 offset:58976
    s_waitcnt lgkmcnt(12)
    v_mfma_f32_16x16x32_bf16 v[48:51], v[136:139], v[16:19], v[48:51]
    ds_read_b64_tr_b16 v[44:45], v2 offset:56448
    v_mfma_f32_16x16x32_bf16 v[52:55], v[216:219], v[16:19], v[52:55]
    ds_read_b64_tr_b16 v[46:47], v2 offset:59008
    s_waitcnt lgkmcnt(12)
    v_mfma_f32_16x16x32_bf16 v[56:59], v[136:139], v[20:23], v[56:59]
    ds_read_b64_tr_b16 v[16:17], v3 offset:32
    v_mfma_f32_16x16x32_bf16 v[60:63], v[216:219], v[20:23], v[60:63]
    ds_read_b64_tr_b16 v[18:19], v3 offset:2592
    v_mfma_f32_16x16x32_bf16 v[64:67], v[20:23], v[20:23], v[64:67]
    v_mfma_f32_16x16x32_bf16 v[68:71], v[10:13], v[20:23], v[68:71]
    s_waitcnt lgkmcnt(12)
    v_mfma_f32_16x16x32_bf16 v[72:75], v[136:139], v[24:27], v[72:75]
    ds_read_b64_tr_b16 v[20:21], v3 offset:64
    v_mfma_f32_16x16x32_bf16 v[76:79], v[216:219], v[24:27], v[76:79]
    ds_read_b64_tr_b16 v[22:23], v3 offset:2624
    s_waitcnt lgkmcnt(12)
    v_mfma_f32_16x16x32_bf16 v[80:83], v[136:139], v[28:31], v[80:83]
    ds_read_b64_tr_b16 v[24:25], v3 offset:96
    v_mfma_f32_16x16x32_bf16 v[84:87], v[216:219], v[28:31], v[84:87]
    ds_read_b64_tr_b16 v[26:27], v3 offset:2656
    s_waitcnt lgkmcnt(12)
    v_mfma_f32_16x16x32_bf16 v[48:51], v[140:143], v[32:35], v[48:51]
    ds_read_b64_tr_b16 v[28:29], v3 offset:128
    v_mfma_f32_16x16x32_bf16 v[52:55], v[220:223], v[32:35], v[52:55]
    ds_read_b64_tr_b16 v[30:31], v3 offset:2688
    s_waitcnt lgkmcnt(12)
    v_mfma_f32_16x16x32_bf16 v[56:59], v[140:143], v[36:39], v[56:59]
    ds_read_b64_tr_b16 v[32:33], v3 offset:5152
    v_mfma_f32_16x16x32_bf16 v[60:63], v[220:223], v[36:39], v[60:63]
    ds_read_b64_tr_b16 v[34:35], v3 offset:7712
    v_mfma_f32_16x16x32_bf16 v[64:67], v[36:39], v[36:39], v[64:67]
    v_mfma_f32_16x16x32_bf16 v[68:71], v[10:13], v[36:39], v[68:71]
    s_waitcnt lgkmcnt(12)
    v_mfma_f32_16x16x32_bf16 v[72:75], v[140:143], v[40:43], v[72:75]
    ds_read_b64_tr_b16 v[36:37], v3 offset:5184
    v_mfma_f32_16x16x32_bf16 v[76:79], v[220:223], v[40:43], v[76:79]
    ds_read_b64_tr_b16 v[38:39], v3 offset:7744
    s_waitcnt lgkmcnt(12)
    v_mfma_f32_16x16x32_bf16 v[80:83], v[140:143], v[44:47], v[80:83]
    ds_read_b64_tr_b16 v[40:41], v3 offset:5216
    v_mfma_f32_16x16x32_bf16 v[84:87], v[220:223], v[44:47], v[84:87]
    ds_read_b64_tr_b16 v[42:43], v3 offset:7776
    s_waitcnt lgkmcnt(12)
    v_mfma_f32_16x16x32_bf16 v[48:51], v[144:147], v[16:19], v[48:51]
    ds_read_b64_tr_b16 v[44:45], v3 offset:5248
    v_mfma_f32_16x16x32_bf16 v[52:55], v[224:227], v[16:19], v[52:55]
    ds_read_b64_tr_b16 v[46:47], v3 offset:7808
    s_waitcnt lgkmcnt(12)
    v_mfma_f32_16x16x32_bf16 v[56:59], v[144:147], v[20:23], v[56:59]
    ds_read_b64_tr_b16 v[16:17], v3 offset:10272
    v_mfma_f32_16x16x32_bf16 v[60:63], v[224:227], v[20:23], v[60:63]
    ds_read_b64_tr_b16 v[18:19], v3 offset:12832
    v_mfma_f32_16x16x32_bf16 v[64:67], v[20:23], v[20:23], v[64:67]
    v_mfma_f32_16x16x32_bf16 v[68:71], v[10:13], v[20:23], v[68:71]
    s_waitcnt lgkmcnt(12)
    v_mfma_f32_16x16x32_bf16 v[72:75], v[144:147], v[24:27], v[72:75]
    ds_read_b64_tr_b16 v[20:21], v3 offset:10304
    v_mfma_f32_16x16x32_bf16 v[76:79], v[224:227], v[24:27], v[76:79]
    ds_read_b64_tr_b16 v[22:23], v3 offset:12864
    s_waitcnt lgkmcnt(12)
    v_mfma_f32_16x16x32_bf16 v[80:83], v[144:147], v[28:31], v[80:83]
    ds_read_b64_tr_b16 v[24:25], v3 offset:10336
    v_mfma_f32_16x16x32_bf16 v[84:87], v[224:227], v[28:31], v[84:87]
    ds_read_b64_tr_b16 v[26:27], v3 offset:12896
    s_waitcnt lgkmcnt(12)
    v_mfma_f32_16x16x32_bf16 v[48:51], v[148:151], v[32:35], v[48:51]
    ds_read_b64_tr_b16 v[28:29], v3 offset:10368
    v_mfma_f32_16x16x32_bf16 v[52:55], v[228:231], v[32:35], v[52:55]
    ds_read_b64_tr_b16 v[30:31], v3 offset:12928
    s_waitcnt lgkmcnt(12)
    v_mfma_f32_16x16x32_bf16 v[56:59], v[148:151], v[36:39], v[56:59]
    ds_read_b64_tr_b16 v[32:33], v3 offset:15392
    v_mfma_f32_16x16x32_bf16 v[60:63], v[228:231], v[36:39], v[60:63]
    ds_read_b64_tr_b16 v[34:35], v3 offset:17952
    v_mfma_f32_16x16x32_bf16 v[64:67], v[36:39], v[36:39], v[64:67]
    v_mfma_f32_16x16x32_bf16 v[68:71], v[10:13], v[36:39], v[68:71]
    s_waitcnt lgkmcnt(12)
    v_mfma_f32_16x16x32_bf16 v[72:75], v[148:151], v[40:43], v[72:75]
    ds_read_b64_tr_b16 v[36:37], v3 offset:15424
    v_mfma_f32_16x16x32_bf16 v[76:79], v[228:231], v[40:43], v[76:79]
    ds_read_b64_tr_b16 v[38:39], v3 offset:17984
    s_waitcnt lgkmcnt(12)
    v_mfma_f32_16x16x32_bf16 v[80:83], v[148:151], v[44:47], v[80:83]
    ds_read_b64_tr_b16 v[40:41], v3 offset:15456
    v_mfma_f32_16x16x32_bf16 v[84:87], v[228:231], v[44:47], v[84:87]
    ds_read_b64_tr_b16 v[42:43], v3 offset:18016
    s_waitcnt lgkmcnt(12)
    v_mfma_f32_16x16x32_bf16 v[48:51], v[152:155], v[16:19], v[48:51]
    ds_read_b64_tr_b16 v[44:45], v3 offset:15488
    v_mfma_f32_16x16x32_bf16 v[52:55], v[232:235], v[16:19], v[52:55]
    ds_read_b64_tr_b16 v[46:47], v3 offset:18048
    s_waitcnt lgkmcnt(12)
    v_mfma_f32_16x16x32_bf16 v[56:59], v[152:155], v[20:23], v[56:59]
    ds_read_b64_tr_b16 v[16:17], v3 offset:20512
    v_mfma_f32_16x16x32_bf16 v[60:63], v[232:235], v[20:23], v[60:63]
    ds_read_b64_tr_b16 v[18:19], v3 offset:23072
    v_mfma_f32_16x16x32_bf16 v[64:67], v[20:23], v[20:23], v[64:67]
    v_mfma_f32_16x16x32_bf16 v[68:71], v[10:13], v[20:23], v[68:71]
    s_waitcnt lgkmcnt(12)
    v_mfma_f32_16x16x32_bf16 v[72:75], v[152:155], v[24:27], v[72:75]
    ds_read_b64_tr_b16 v[20:21], v3 offset:20544
    v_mfma_f32_16x16x32_bf16 v[76:79], v[232:235], v[24:27], v[76:79]
    ds_read_b64_tr_b16 v[22:23], v3 offset:23104
    s_waitcnt lgkmcnt(12)
    v_mfma_f32_16x16x32_bf16 v[80:83], v[152:155], v[28:31], v[80:83]
    ds_read_b64_tr_b16 v[24:25], v3 offset:20576
    v_mfma_f32_16x16x32_bf16 v[84:87], v[232:235], v[28:31], v[84:87]
    ds_read_b64_tr_b16 v[26:27], v3 offset:23136
    s_waitcnt lgkmcnt(12)
    v_mfma_f32_16x16x32_bf16 v[48:51], v[156:159], v[32:35], v[48:51]
    ds_read_b64_tr_b16 v[28:29], v3 offset:20608
    v_mfma_f32_16x16x32_bf16 v[52:55], v[236:239], v[32:35], v[52:55]
    ds_read_b64_tr_b16 v[30:31], v3 offset:23168
    s_waitcnt lgkmcnt(12)
    v_mfma_f32_16x16x32_bf16 v[56:59], v[156:159], v[36:39], v[56:59]
    ds_read_b64_tr_b16 v[32:33], v3 offset:25632
    v_mfma_f32_16x16x32_bf16 v[60:63], v[236:239], v[36:39], v[60:63]
    ds_read_b64_tr_b16 v[34:35], v3 offset:28192
    v_mfma_f32_16x16x32_bf16 v[64:67], v[36:39], v[36:39], v[64:67]
    v_mfma_f32_16x16x32_bf16 v[68:71], v[10:13], v[36:39], v[68:71]
    s_waitcnt lgkmcnt(12)
    v_mfma_f32_16x16x32_bf16 v[72:75], v[156:159], v[40:43], v[72:75]
    ds_read_b64_tr_b16 v[36:37], v3 offset:25664
    v_mfma_f32_16x16x32_bf16 v[76:79], v[236:239], v[40:43], v[76:79]
    ds_read_b64_tr_b16 v[38:39], v3 offset:28224
    s_waitcnt lgkmcnt(12)
    v_mfma_f32_16x16x32_bf16 v[80:83], v[156:159], v[44:47], v[80:83]
    ds_read_b64_tr_b16 v[40:41], v3 offset:25696
    v_mfma_f32_16x16x32_bf16 v[84:87], v[236:239], v[44:47], v[84:87]
    ds_read_b64_tr_b16 v[42:43], v3 offset:28256
    s_waitcnt lgkmcnt(12)
    v_mfma_f32_16x16x32_bf16 v[48:51], v[160:163], v[16:19], v[48:51]
    ds_read_b64_tr_b16 v[44:45], v3 offset:25728
    v_mfma_f32_16x16x32_bf16 v[52:55], v[240:243], v[16:19], v[52:55]
    ds_read_b64_tr_b16 v[46:47], v3 offset:28288
    s_waitcnt lgkmcnt(12)
    v_mfma_f32_16x16x32_bf16 v[56:59], v[160:163], v[20:23], v[56:59]
    ds_read_b64_tr_b16 v[16:17], v3 offset:30752
    v_mfma_f32_16x16x32_bf16 v[60:63], v[240:243], v[20:23], v[60:63]
    ds_read_b64_tr_b16 v[18:19], v3 offset:33312
    v_mfma_f32_16x16x32_bf16 v[64:67], v[20:23], v[20:23], v[64:67]
    v_mfma_f32_16x16x32_bf16 v[68:71], v[10:13], v[20:23], v[68:71]
    s_waitcnt lgkmcnt(12)
    v_mfma_f32_16x16x32_bf16 v[72:75], v[160:163], v[24:27], v[72:75]
    ds_read_b64_tr_b16 v[20:21], v3 offset:30784
    v_mfma_f32_16x16x32_bf16 v[76:79], v[240:243], v[24:27], v[76:79]
    ds_read_b64_tr_b16 v[22:23], v3 offset:33344
    s_waitcnt lgkmcnt(12)
    v_mfma_f32_16x16x32_bf16 v[80:83], v[160:163], v[28:31], v[80:83]
    ds_read_b64_tr_b16 v[24:25], v3 offset:30816
    v_mfma_f32_16x16x32_bf16 v[84:87], v[240:243], v[28:31], v[84:87]
    ds_read_b64_tr_b16 v[26:27], v3 offset:33376
    s_waitcnt lgkmcnt(12)
    v_mfma_f32_16x16x32_bf16 v[48:51], v[164:167], v[32:35], v[48:51]
    ds_read_b64_tr_b16 v[28:29], v3 offset:30848
    v_mfma_f32_16x16x32_bf16 v[52:55], v[244:247], v[32:35], v[52:55]
    ds_read_b64_tr_b16 v[30:31], v3 offset:33408
    s_waitcnt lgkmcnt(12)
    v_mfma_f32_16x16x32_bf16 v[56:59], v[164:167], v[36:39], v[56:59]
    ds_read_b64_tr_b16 v[32:33], v3 offset:35872
    v_mfma_f32_16x16x32_bf16 v[60:63], v[244:247], v[36:39], v[60:63]
    ds_read_b64_tr_b16 v[34:35], v3 offset:38432
    v_mfma_f32_16x16x32_bf16 v[64:67], v[36:39], v[36:39], v[64:67]
    v_mfma_f32_16x16x32_bf16 v[68:71], v[10:13], v[36:39], v[68:71]
    s_waitcnt lgkmcnt(12)
    v_mfma_f32_16x16x32_bf16 v[72:75], v[164:167], v[40:43], v[72:75]
    ds_read_b64_tr_b16 v[36:37], v3 offset:35904
    v_mfma_f32_16x16x32_bf16 v[76:79], v[244:247], v[40:43], v[76:79]
    ds_read_b64_tr_b16 v[38:39], v3 offset:38464
    s_waitcnt lgkmcnt(12)
    v_mfma_f32_16x16x32_bf16 v[80:83], v[164:167], v[44:47], v[80:83]
    ds_read_b64_tr_b16 v[40:41], v3 offset:35936
    v_mfma_f32_16x16x32_bf16 v[84:87], v[244:247], v[44:47], v[84:87]
    ds_read_b64_tr_b16 v[42:43], v3 offset:38496
    s_waitcnt lgkmcnt(12)
    v_mfma_f32_16x16x32_bf16 v[48:51], v[168:171], v[16:19], v[48:51]
    ds_read_b64_tr_b16 v[44:45], v3 offset:35968
    v_mfma_f32_16x16x32_bf16 v[52:55], v[248:251], v[16:19], v[52:55]
    ds_read_b64_tr_b16 v[46:47], v3 offset:38528
    s_waitcnt lgkmcnt(12)
    v_mfma_f32_16x16x32_bf16 v[56:59], v[168:171], v[20:23], v[56:59]
    v_mfma_f32_16x16x32_bf16 v[60:63], v[248:251], v[20:23], v[60:63]
    v_mfma_f32_16x16x32_bf16 v[64:67], v[20:23], v[20:23], v[64:67]
    v_mfma_f32_16x16x32_bf16 v[68:71], v[10:13], v[20:23], v[68:71]
    s_waitcnt lgkmcnt(10)
    v_mfma_f32_16x16x32_bf16 v[72:75], v[168:171], v[24:27], v[72:75]
    v_mfma_f32_16x16x32_bf16 v[76:79], v[248:251], v[24:27], v[76:79]
    s_waitcnt lgkmcnt(8)
    v_mfma_f32_16x16x32_bf16 v[80:83], v[168:171], v[28:31], v[80:83]
    v_mfma_f32_16x16x32_bf16 v[84:87], v[248:251], v[28:31], v[84:87]
    s_waitcnt lgkmcnt(6)
    v_mfma_f32_16x16x32_bf16 v[48:51], v[172:175], v[32:35], v[48:51]
    v_mfma_f32_16x16x32_bf16 v[52:55], v[252:255], v[32:35], v[52:55]
    s_waitcnt lgkmcnt(4)
    v_mfma_f32_16x16x32_bf16 v[56:59], v[172:175], v[36:39], v[56:59]
    v_mfma_f32_16x16x32_bf16 v[60:63], v[252:255], v[36:39], v[60:63]
    v_mfma_f32_16x16x32_bf16 v[64:67], v[36:39], v[36:39], v[64:67]
    v_mfma_f32_16x16x32_bf16 v[68:71], v[10:13], v[36:39], v[68:71]
    s_waitcnt lgkmcnt(2)
    v_mfma_f32_16x16x32_bf16 v[72:75], v[172:175], v[40:43], v[72:75]
    v_mfma_f32_16x16x32_bf16 v[76:79], v[252:255], v[40:43], v[76:79]
    s_waitcnt lgkmcnt(0)
    v_mfma_f32_16x16x32_bf16 v[80:83], v[172:175], v[44:47], v[80:83]
    v_mfma_f32_16x16x32_bf16 v[84:87], v[252:255], v[44:47], v[84:87]
    ds_read_b64 v[10:11], v7
    ds_read_b64 v[12:13], v8
    ds_read_b64 v[14:15], v9
    v_and_b32 v16, 15, v1
    v_lshrrev_b32 v17, 4, v1
    v_and_b32 v18, 3, v1
    v_lshrrev_b32 v19, 2, v16
    v_cmp_eq_u32 s[42:43], 1, v18
    v_cmp_eq_u32 s[44:45], 2, v18
    v_cmp_eq_u32 s[46:47], 3, v18
    v_cmp_eq_u32 s[54:55], v19, v17
    v_lshlrev_b32 v18, 3, v16
    v_add_u32 v18, 45376, v18
    v_cndmask_b32 v64, v64, v65, s[42:43]
    v_cndmask_b32 v64, v64, v66, s[44:45]
    v_cndmask_b32 v64, v64, v67, s[46:47]
    v_mul_f32 v68, 0x3acccccd, v68
    v_mul_f32 v64, 0x3acccccd, v64
    v_fma_f32 v64, -v68, v68, v64
    v_max_f32 v64, 0, v64
    v_cvt_pk_bf16_f32 v68, v68, v64
    v_and_b32 v64, 0xffff0000, v68
    v_lshlrev_b32 v68, 16, v68
    v_add_f32 v64, 0x3727c5ac, v64
    v_cvt_pk_bf16_f32 v64, v64, v64
    v_lshlrev_b32 v64, 16, v64
    v_sqrt_f32 v64, v64
    s_nop 0
    v_cvt_pk_bf16_f32 v64, v64, v64
    v_lshlrev_b32 v64, 16, v64
    v_rcp_f32 v69, v64
    s_mov_b64 exec, s[54:55]
    ds_write_b64 v18, v[68:69] offset:256
    s_mov_b64 exec, -1
    s_lshl_b32 s42, s3, 7
    s_add_u32 s42, s42, 46016
    v_lshl_add_u32 v19, v17, 4, s42
    s_lshl_b32 s42, s3, 6
    s_cmp_eq_u32 s3, 2
    s_cselect_b32 s42, 192, s42
    s_cmp_eq_u32 s3, 3
    s_cselect_b32 s42, 128, s42
    s_add_u32 s42, s42, 61440
    v_mul_u32_u24 v20, 496, v16
    v_lshl_add_u32 v20, v17, 4, v20
    v_add_u32 v20, s42, v20
    v_lshlrev_b32 v18, 3, v16
    v_add_u32 v18, 45376, v18
    s_waitcnt lgkmcnt(0)
    s_barrier
    ds_read_b64 v[26:27], v18 offset:128
    ds_read_b64 v[28:29], v18 offset:256
    ds_read_b64 v[30:31], v18 offset:384
    ds_read_b64 v[32:33], v18 offset:512
    ds_read_b128 v[36:39], v19 offset:0
    ds_read_b128 v[40:43], v19 offset:64
    s_waitcnt lgkmcnt(0)
    v_fma_f32 v48, -v26, v36, v48
    v_fma_f32 v49, -v26, v37, v49
    v_fma_f32 v50, -v26, v38, v50
    v_fma_f32 v51, -v26, v39, v51
    v_fma_f32 v52, -v26, v40, v52
    v_fma_f32 v53, -v26, v41, v53
    v_fma_f32 v54, -v26, v42, v54
    v_fma_f32 v55, -v26, v43, v55
    v_fma_f32 v56, -v28, v36, v56
    v_fma_f32 v57, -v28, v37, v57
    v_fma_f32 v58, -v28, v38, v58
    v_fma_f32 v59, -v28, v39, v59
    v_fma_f32 v60, -v28, v40, v60
    v_fma_f32 v61, -v28, v41, v61
    v_fma_f32 v62, -v28, v42, v62
    v_fma_f32 v63, -v28, v43, v63
    v_fma_f32 v72, -v30, v36, v72
    v_fma_f32 v73, -v30, v37, v73
    v_fma_f32 v74, -v30, v38, v74
    v_fma_f32 v75, -v30, v39, v75
    v_fma_f32 v76, -v30, v40, v76
    v_fma_f32 v77, -v30, v41, v77
    v_fma_f32 v78, -v30, v42, v78
    v_fma_f32 v79, -v30, v43, v79
    v_fma_f32 v80, -v32, v36, v80
    v_fma_f32 v81, -v32, v37, v81
    v_fma_f32 v82, -v32, v38, v82
    v_fma_f32 v83, -v32, v39, v83
    v_fma_f32 v84, -v32, v40, v84
    v_fma_f32 v85, -v32, v41, v85
    v_fma_f32 v86, -v32, v42, v86
    v_fma_f32 v87, -v32, v43, v87
    v_mul_f32 v48, v48, v27
    v_mul_f32 v49, v49, v27
    v_mul_f32 v50, v50, v27
    v_mul_f32 v51, v51, v27
    v_mul_f32 v52, v52, v27
    v_mul_f32 v53, v53, v27
    v_mul_f32 v54, v54, v27
    v_mul_f32 v55, v55, v27
    v_mul_f32 v56, v56, v29
    v_mul_f32 v57, v57, v29
    v_mul_f32 v58, v58, v29
    v_mul_f32 v59, v59, v29
    v_mul_f32 v60, v60, v29
    v_mul_f32 v61, v61, v29
    v_mul_f32 v62, v62, v29
    v_mul_f32 v63, v63, v29
    v_mul_f32 v72, v72, v31
    v_mul_f32 v73, v73, v31
    v_mul_f32 v74, v74, v31
    v_mul_f32 v75, v75, v31
    v_mul_f32 v76, v76, v31
    v_mul_f32 v77, v77, v31
    v_mul_f32 v78, v78, v31
    v_mul_f32 v79, v79, v31
    v_mul_f32 v80, v80, v33
    v_mul_f32 v81, v81, v33
    v_mul_f32 v82, v82, v33
    v_mul_f32 v83, v83, v33
    v_mul_f32 v84, v84, v33
    v_mul_f32 v85, v85, v33
    v_mul_f32 v86, v86, v33
    v_mul_f32 v87, v87, v33
    v_cvt_pk_bf16_f32 v48, v48, v52
    v_cvt_pk_bf16_f32 v49, v49, v53
    v_cvt_pk_bf16_f32 v50, v50, v54
    v_cvt_pk_bf16_f32 v51, v51, v55
    ds_write_b128 v20, v[48:51] offset:7936
    v_cvt_pk_bf16_f32 v56, v56, v60
    v_cvt_pk_bf16_f32 v57, v57, v61
    v_cvt_pk_bf16_f32 v58, v58, v62
    v_cvt_pk_bf16_f32 v59, v59, v63
    ds_write_b128 v20, v[56:59] offset:15872
    v_cvt_pk_bf16_f32 v72, v72, v76
    v_cvt_pk_bf16_f32 v73, v73, v77
    v_cvt_pk_bf16_f32 v74, v74, v78
    v_cvt_pk_bf16_f32 v75, v75, v79
    ds_write_b128 v20, v[72:75] offset:23808
    v_cvt_pk_bf16_f32 v80, v80, v84
    v_cvt_pk_bf16_f32 v81, v81, v85
    v_cvt_pk_bf16_f32 v82, v82, v86
    v_cvt_pk_bf16_f32 v83, v83, v87
    ds_write_b128 v20, v[80:83] offset:31744
    s_branch L_a1_post
L_g2D:
    s_waitcnt vmcnt(3)
    s_barrier
    ds_read_b64_tr_b16 v[16:17], v2 offset:0
    ds_read_b64_tr_b16 v[18:19], v2 offset:2560
    ds_read_b64_tr_b16 v[20:21], v2 offset:32
    ds_read_b64_tr_b16 v[22:23], v2 offset:2592
    ds_read_b64_tr_b16 v[24:25], v2 offset:64
    ds_read_b64_tr_b16 v[26:27], v2 offset:2624
    ds_read_b64_tr_b16 v[28:29], v2 offset:96
    ds_read_b64_tr_b16 v[30:31], v2 offset:2656
    ds_read_b64_tr_b16 v[32:33], v2 offset:128
    ds_read_b64_tr_b16 v[34:35], v2 offset:2688
    s_waitcnt vmcnt(2)
    s_barrier
    ds_read_b64_tr_b16 v[36:37], v2 offset:5120
    ds_read_b64_tr_b16 v[38:39], v2 offset:7680
    ds_read_b64_tr_b16 v[40:41], v2 offset:5152
    ds_read_b64_tr_b16 v[42:43], v2 offset:7712
    s_waitcnt lgkmcnt(12)
    v_mfma_f32_16x16x32_bf16 v[48:51], v[176:179], v[16:19], 0
    ds_read_b64_tr_b16 v[44:45], v2 offset:5184
    v_mfma_f32_16x16x32_bf16 v[52:55], v[16:19], v[16:19], 0
    ds_read_b64_tr_b16 v[46:47], v2 offset:7744
    v_mfma_f32_16x16x32_bf16 v[56:59], v[10:13], v[16:19], 0
    s_waitcnt lgkmcnt(12)
    v_mfma_f32_16x16x32_bf16 v[60:63], v[96:99], v[20:23], 0
    ds_read_b64_tr_b16 v[16:17], v2 offset:5216
    v_mfma_f32_16x16x32_bf16 v[64:67], v[176:179], v[20:23], 0
    ds_read_b64_tr_b16 v[18:19], v2 offset:7776
    s_waitcnt lgkmcnt(12)
    v_mfma_f32_16x16x32_bf16 v[68:71], v[96:99], v[24:27], 0
    ds_read_b64_tr_b16 v[20:21], v2 offset:5248
    v_mfma_f32_16x16x32_bf16 v[72:75], v[176:179], v[24:27], 0
    ds_read_b64_tr_b16 v[22:23], v2 offset:7808
    s_waitcnt lgkmcnt(12)
    v_mfma_f32_16x16x32_bf16 v[76:79], v[96:99], v[28:31], 0
    ds_read_b64_tr_b16 v[24:25], v2 offset:10240
    v_mfma_f32_16x16x32_bf16 v[80:83], v[176:179], v[28:31], 0
    ds_read_b64_tr_b16 v[26:27], v2 offset:12800
    s_waitcnt lgkmcnt(12)
    v_mfma_f32_16x16x32_bf16 v[84:87], v[96:99], v[32:35], 0
    ds_read_b64_tr_b16 v[28:29], v2 offset:10272
    v_mfma_f32_16x16x32_bf16 v[88:91], v[176:179], v[32:35], 0
    ds_read_b64_tr_b16 v[30:31], v2 offset:12832
    s_waitcnt lgkmcnt(12)
    v_mfma_f32_16x16x32_bf16 v[48:51], v[180:183], v[36:39], v[48:51]
    ds_read_b64_tr_b16 v[32:33], v2 offset:10304
    v_mfma_f32_16x16x32_bf16 v[52:55], v[36:39], v[36:39], v[52:55]
    ds_read_b64_tr_b16 v[34:35], v2 offset:12864
    v_mfma_f32_16x16x32_bf16 v[56:59], v[10:13], v[36:39], v[56:59]
    s_waitcnt lgkmcnt(12)
    v_mfma_f32_16x16x32_bf16 v[60:63], v[100:103], v[40:43], v[60:63]
    ds_read_b64_tr_b16 v[36:37], v2 offset:10336
    v_mfma_f32_16x16x32_bf16 v[64:67], v[180:183], v[40:43], v[64:67]
    ds_read_b64_tr_b16 v[38:39], v2 offset:12896
    s_waitcnt lgkmcnt(12)
    v_mfma_f32_16x16x32_bf16 v[68:71], v[100:103], v[44:47], v[68:71]
    ds_read_b64_tr_b16 v[40:41], v2 offset:10368
    v_mfma_f32_16x16x32_bf16 v[72:75], v[180:183], v[44:47], v[72:75]
    ds_read_b64_tr_b16 v[42:43], v2 offset:12928
    s_waitcnt lgkmcnt(12)
    v_mfma_f32_16x16x32_bf16 v[76:79], v[100:103], v[16:19], v[76:79]
    s_waitcnt vmcnt(0)
    s_barrier
    ds_read_b64_tr_b16 v[44:45], v2 offset:15360
    v_mfma_f32_16x16x32_bf16 v[80:83], v[180:183], v[16:19], v[80:83]
    ds_read_b64_tr_b16 v[46:47], v2 offset:17920
    s_waitcnt lgkmcnt(12)
    v_mfma_f32_16x16x32_bf16 v[84:87], v[100:103], v[20:23], v[84:87]
    ds_read_b64_tr_b16 v[16:17], v2 offset:15392
    v_mfma_f32_16x16x32_bf16 v[88:91], v[180:183], v[20:23], v[88:91]
    ds_read_b64_tr_b16 v[18:19], v2 offset:17952
    s_waitcnt lgkmcnt(12)
    v_mfma_f32_16x16x32_bf16 v[48:51], v[184:187], v[24:27], v[48:51]
    ds_read_b64_tr_b16 v[20:21], v2 offset:15424
    v_mfma_f32_16x16x32_bf16 v[52:55], v[24:27], v[24:27], v[52:55]
    ds_read_b64_tr_b16 v[22:23], v2 offset:17984
    v_mfma_f32_16x16x32_bf16 v[56:59], v[10:13], v[24:27], v[56:59]
    s_waitcnt lgkmcnt(12)
    v_mfma_f32_16x16x32_bf16 v[60:63], v[104:107], v[28:31], v[60:63]
    ds_read_b64_tr_b16 v[24:25], v2 offset:15456
    v_mfma_f32_16x16x32_bf16 v[64:67], v[184:187], v[28:31], v[64:67]
    ds_read_b64_tr_b16 v[26:27], v2 offset:18016
    s_waitcnt lgkmcnt(12)
    v_mfma_f32_16x16x32_bf16 v[68:71], v[104:107], v[32:35], v[68:71]
    ds_read_b64_tr_b16 v[28:29], v2 offset:15488
    v_mfma_f32_16x16x32_bf16 v[72:75], v[184:187], v[32:35], v[72:75]
    ds_read_b64_tr_b16 v[30:31], v2 offset:18048
    s_waitcnt lgkmcnt(12)
    v_mfma_f32_16x16x32_bf16 v[76:79], v[104:107], v[36:39], v[76:79]
    ds_read_b64_tr_b16 v[32:33], v2 offset:20480
    v_mfma_f32_16x16x32_bf16 v[80:83], v[184:187], v[36:39], v[80:83]
    ds_read_b64_tr_b16 v[34:35], v2 offset:23040
    s_waitcnt lgkmcnt(12)
    v_mfma_f32_16x16x32_bf16 v[84:87], v[104:107], v[40:43], v[84:87]
    ds_read_b64_tr_b16 v[36:37], v2 offset:20512
    v_mfma_f32_16x16x32_bf16 v[88:91], v[184:187], v[40:43], v[88:91]
    ds_read_b64_tr_b16 v[38:39], v2 offset:23072
    s_waitcnt lgkmcnt(12)
    v_mfma_f32_16x16x32_bf16 v[48:51], v[188:191], v[44:47], v[48:51]
    ds_read_b64_tr_b16 v[40:41], v2 offset:20544
    v_mfma_f32_16x16x32_bf16 v[52:55], v[44:47], v[44:47], v[52:55]
    ds_read_b64_tr_b16 v[42:43], v2 offset:23104
    v_mfma_f32_16x16x32_bf16 v[56:59], v[10:13], v[44:47], v[56:59]
    s_waitcnt lgkmcnt(12)
    v_mfma_f32_16x16x32_bf16 v[60:63], v[108:111], v[16:19], v[60:63]
    ds_read_b64_tr_b16 v[44:45], v2 offset:20576
    v_mfma_f32_16x16x32_bf16 v[64:67], v[188:191], v[16:19], v[64:67]
    ds_read_b64_tr_b16 v[46:47], v2 offset:23136
    s_waitcnt lgkmcnt(12)
    v_mfma_f32_16x16x32_bf16 v[68:71], v[108:111], v[20:23], v[68:71]
    ds_read_b64_tr_b16 v[16:17], v2 offset:20608
    v_mfma_f32_16x16x32_bf16 v[72:75], v[188:191], v[20:23], v[72:75]
    ds_read_b64_tr_b16 v[18:19], v2 offset:23168
    s_waitcnt lgkmcnt(12)
    v_mfma_f32_16x16x32_bf16 v[76:79], v[108:111], v[24:27], v[76:79]
    ds_read_b64_tr_b16 v[20:21], v2 offset:25600
    v_mfma_f32_16x16x32_bf16 v[80:83], v[188:191], v[24:27], v[80:83]
    ds_read_b64_tr_b16 v[22:23], v2 offset:28160
    s_waitcnt lgkmcnt(12)
    v_mfma_f32_16x16x32_bf16 v[84:87], v[108:111], v[28:31], v[84:87]
    ds_read_b64_tr_b16 v[24:25], v2 offset:25632
    v_mfma_f32_16x16x32_bf16 v[88:91], v[188:191], v[28:31], v[88:91]
    ds_read_b64_tr_b16 v[26:27], v2 offset:28192
    s_waitcnt lgkmcnt(12)
    v_mfma_f32_16x16x32_bf16 v[48:51], v[192:195], v[32:35], v[48:51]
    ds_read_b64_tr_b16 v[28:29], v2 offset:25664
    v_mfma_f32_16x16x32_bf16 v[52:55], v[32:35], v[32:35], v[52:55]
    ds_read_b64_tr_b16 v[30:31], v2 offset:28224
    v_mfma_f32_16x16x32_bf16 v[56:59], v[10:13], v[32:35], v[56:59]
    s_waitcnt lgkmcnt(12)
    v_mfma_f32_16x16x32_bf16 v[60:63], v[112:115], v[36:39], v[60:63]
    ds_read_b64_tr_b16 v[32:33], v2 offset:25696
    v_mfma_f32_16x16x32_bf16 v[64:67], v[192:195], v[36:39], v[64:67]
    ds_read_b64_tr_b16 v[34:35], v2 offset:28256
    s_waitcnt lgkmcnt(12)
    v_mfma_f32_16x16x32_bf16 v[68:71], v[112:115], v[40:43], v[68:71]
    ds_read_b64_tr_b16 v[36:37], v2 offset:25728
    v_mfma_f32_16x16x32_bf16 v[72:75], v[192:195], v[40:43], v[72:75]
    ds_read_b64_tr_b16 v[38:39], v2 offset:28288
    s_waitcnt lgkmcnt(12)
    v_mfma_f32_16x16x32_bf16 v[76:79], v[112:115], v[44:47], v[76:79]
    s_barrier
    ds_read_b64_tr_b16 v[40:41], v2 offset:30720
    v_mfma_f32_16x16x32_bf16 v[80:83], v[192:195], v[44:47], v[80:83]
    ds_read_b64_tr_b16 v[42:43], v2 offset:33280
    s_waitcnt lgkmcnt(12)
    v_mfma_f32_16x16x32_bf16 v[84:87], v[112:115], v[16:19], v[84:87]
    ds_read_b64_tr_b16 v[44:45], v2 offset:30752
    v_mfma_f32_16x16x32_bf16 v[88:91], v[192:195], v[16:19], v[88:91]
    ds_read_b64_tr_b16 v[46:47], v2 offset:33312
    s_waitcnt lgkmcnt(12)
    v_mfma_f32_16x16x32_bf16 v[48:51], v[196:199], v[20:23], v[48:51]
    ds_read_b64_tr_b16 v[16:17], v2 offset:30784
    v_mfma_f32_16x16x32_bf16 v[52:55], v[20:23], v[20:23], v[52:55]
    ds_read_b64_tr_b16 v[18:19], v2 offset:33344
    v_mfma_f32_16x16x32_bf16 v[56:59], v[10:13], v[20:23], v[56:59]
    s_waitcnt lgkmcnt(12)
    v_mfma_f32_16x16x32_bf16 v[60:63], v[116:119], v[24:27], v[60:63]
    ds_read_b64_tr_b16 v[20:21], v2 offset:30816
    v_mfma_f32_16x16x32_bf16 v[64:67], v[196:199], v[24:27], v[64:67]
    ds_read_b64_tr_b16 v[22:23], v2 offset:33376
    s_waitcnt lgkmcnt(12)
    v_mfma_f32_16x16x32_bf16 v[68:71], v[116:119], v[28:31], v[68:71]
    ds_read_b64_tr_b16 v[24:25], v2 offset:30848
    v_mfma_f32_16x16x32_bf16 v[72:75], v[196:199], v[28:31], v[72:75]
    ds_read_b64_tr_b16 v[26:27], v2 offset:33408
    s_waitcnt lgkmcnt(12)
    v_mfma_f32_16x16x32_bf16 v[76:79], v[116:119], v[32:35], v[76:79]
    ds_read_b64_tr_b16 v[28:29], v2 offset:35840
    v_mfma_f32_16x16x32_bf16 v[80:83], v[196:199], v[32:35], v[80:83]
    ds_read_b64_tr_b16 v[30:31], v2 offset:38400
    s_waitcnt lgkmcnt(12)
    v_mfma_f32_16x16x32_bf16 v[84:87], v[116:119], v[36:39], v[84:87]
    ds_read_b64_tr_b16 v[32:33], v2 offset:35872
    v_mfma_f32_16x16x32_bf16 v[88:91], v[196:199], v[36:39], v[88:91]
    ds_read_b64_tr_b16 v[34:35], v2 offset:38432
    s_waitcnt lgkmcnt(12)
    v_mfma_f32_16x16x32_bf16 v[48:51], v[200:203], v[40:43], v[48:51]
    ds_read_b64_tr_b16 v[36:37], v2 offset:35904
    v_mfma_f32_16x16x32_bf16 v[52:55], v[40:43], v[40:43], v[52:55]
    ds_read_b64_tr_b16 v[38:39], v2 offset:38464
    v_mfma_f32_16x16x32_bf16 v[56:59], v[10:13], v[40:43], v[56:59]
    s_waitcnt lgkmcnt(12)
    v_mfma_f32_16x16x32_bf16 v[60:63], v[120:123], v[44:47], v[60:63]
    ds_read_b64_tr_b16 v[40:41], v2 offset:35936
    v_mfma_f32_16x16x32_bf16 v[64:67], v[200:203], v[44:47], v[64:67]
    ds_read_b64_tr_b16 v[42:43], v2 offset:38496
    s_waitcnt lgkmcnt(12)
    v_mfma_f32_16x16x32_bf16 v[68:71], v[120:123], v[16:19], v[68:71]
    ds_read_b64_tr_b16 v[44:45], v2 offset:35968
    v_mfma_f32_16x16x32_bf16 v[72:75], v[200:203], v[16:19], v[72:75]
    ds_read_b64_tr_b16 v[46:47], v2 offset:38528
    s_waitcnt lgkmcnt(12)
    v_mfma_f32_16x16x32_bf16 v[76:79], v[120:123], v[20:23], v[76:79]
    ds_read_b64_tr_b16 v[16:17], v2 offset:40960
    v_mfma_f32_16x16x32_bf16 v[80:83], v[200:203], v[20:23], v[80:83]
    ds_read_b64_tr_b16 v[18:19], v2 offset:43520
    s_waitcnt lgkmcnt(12)
    v_mfma_f32_16x16x32_bf16 v[84:87], v[120:123], v[24:27], v[84:87]
    ds_read_b64_tr_b16 v[20:21], v2 offset:40992
    v_mfma_f32_16x16x32_bf16 v[88:91], v[200:203], v[24:27], v[88:91]
    ds_read_b64_tr_b16 v[22:23], v2 offset:43552
    s_waitcnt lgkmcnt(12)
    v_mfma_f32_16x16x32_bf16 v[48:51], v[204:207], v[28:31], v[48:51]
    ds_read_b64_tr_b16 v[24:25], v2 offset:41024
    v_mfma_f32_16x16x32_bf16 v[52:55], v[28:31], v[28:31], v[52:55]
    ds_read_b64_tr_b16 v[26:27], v2 offset:43584
    v_mfma_f32_16x16x32_bf16 v[56:59], v[10:13], v[28:31], v[56:59]
    s_waitcnt lgkmcnt(12)
    v_mfma_f32_16x16x32_bf16 v[60:63], v[124:127], v[32:35], v[60:63]
    ds_read_b64_tr_b16 v[28:29], v2 offset:41056
    v_mfma_f32_16x16x32_bf16 v[64:67], v[204:207], v[32:35], v[64:67]
    ds_read_b64_tr_b16 v[30:31], v2 offset:43616
    s_waitcnt lgkmcnt(12)
    v_mfma_f32_16x16x32_bf16 v[68:71], v[124:127], v[36:39], v[68:71]
    ds_read_b64_tr_b16 v[32:33], v2 offset:41088
    v_mfma_f32_16x16x32_bf16 v[72:75], v[204:207], v[36:39], v[72:75]
    ds_read_b64_tr_b16 v[34:35], v2 offset:43648
    s_waitcnt lgkmcnt(12)
    v_mfma_f32_16x16x32_bf16 v[76:79], v[124:127], v[40:43], v[76:79]
    ds_read_b64_tr_b16 v[36:37], v2 offset:46080
    v_mfma_f32_16x16x32_bf16 v[80:83], v[204:207], v[40:43], v[80:83]
    ds_read_b64_tr_b16 v[38:39], v2 offset:48640
    s_waitcnt lgkmcnt(12)
    v_mfma_f32_16x16x32_bf16 v[84:87], v[124:127], v[44:47], v[84:87]
    ds_read_b64_tr_b16 v[40:41], v2 offset:46112
    v_mfma_f32_16x16x32_bf16 v[88:91], v[204:207], v[44:47], v[88:91]
    ds_read_b64_tr_b16 v[42:43], v2 offset:48672
    s_waitcnt lgkmcnt(12)
    v_mfma_f32_16x16x32_bf16 v[48:51], v[208:211], v[16:19], v[48:51]
    ds_read_b64_tr_b16 v[44:45], v2 offset:46144
    v_mfma_f32_16x16x32_bf16 v[52:55], v[16:19], v[16:19], v[52:55]
    ds_read_b64_tr_b16 v[46:47], v2 offset:48704
    v_mfma_f32_16x16x32_bf16 v[56:59], v[10:13], v[16:19], v[56:59]
    s_waitcnt lgkmcnt(12)
    v_mfma_f32_16x16x32_bf16 v[60:63], v[128:131], v[20:23], v[60:63]
    ds_read_b64_tr_b16 v[16:17], v2 offset:46176
    v_mfma_f32_16x16x32_bf16 v[64:67], v[208:211], v[20:23], v[64:67]
    ds_read_b64_tr_b16 v[18:19], v2 offset:48736
    s_waitcnt lgkmcnt(12)
    v_mfma_f32_16x16x32_bf16 v[68:71], v[128:131], v[24:27], v[68:71]
    ds_read_b64_tr_b16 v[20:21], v2 offset:46208
    v_mfma_f32_16x16x32_bf16 v[72:75], v[208:211], v[24:27], v[72:75]
    ds_read_b64_tr_b16 v[22:23], v2 offset:48768
    s_waitcnt lgkmcnt(12)
    v_mfma_f32_16x16x32_bf16 v[76:79], v[128:131], v[28:31], v[76:79]
    ds_read_b64_tr_b16 v[24:25], v2 offset:51200
    v_mfma_f32_16x16x32_bf16 v[80:83], v[208:211], v[28:31], v[80:83]
    ds_read_b64_tr_b16 v[26:27], v2 offset:53760
    s_waitcnt lgkmcnt(12)
    v_mfma_f32_16x16x32_bf16 v[84:87], v[128:131], v[32:35], v[84:87]
    ds_read_b64_tr_b16 v[28:29], v2 offset:51232
    v_mfma_f32_16x16x32_bf16 v[88:91], v[208:211], v[32:35], v[88:91]
    ds_read_b64_tr_b16 v[30:31], v2 offset:53792
    s_waitcnt lgkmcnt(12)
    v_mfma_f32_16x16x32_bf16 v[48:51], v[212:215], v[36:39], v[48:51]
    ds_read_b64_tr_b16 v[32:33], v2 offset:51264
    v_mfma_f32_16x16x32_bf16 v[52:55], v[36:39], v[36:39], v[52:55]
    ds_read_b64_tr_b16 v[34:35], v2 offset:53824
    v_mfma_f32_16x16x32_bf16 v[56:59], v[10:13], v[36:39], v[56:59]
    s_waitcnt lgkmcnt(12)
    v_mfma_f32_16x16x32_bf16 v[60:63], v[132:135], v[40:43], v[60:63]
    ds_read_b64_tr_b16 v[36:37], v2 offset:51296
    v_mfma_f32_16x16x32_bf16 v[64:67], v[212:215], v[40:43], v[64:67]
    ds_read_b64_tr_b16 v[38:39], v2 offset:53856
    s_waitcnt lgkmcnt(12)
    v_mfma_f32_16x16x32_bf16 v[68:71], v[132:135], v[44:47], v[68:71]
    ds_read_b64_tr_b16 v[40:41], v2 offset:51328
    v_mfma_f32_16x16x32_bf16 v[72:75], v[212:215], v[44:47], v[72:75]
    ds_read_b64_tr_b16 v[42:43], v2 offset:53888
    s_waitcnt lgkmcnt(12)
    v_mfma_f32_16x16x32_bf16 v[76:79], v[132:135], v[16:19], v[76:79]
    s_barrier
    ds_read_b64_tr_b16 v[44:45], v2 offset:56320
    v_mfma_f32_16x16x32_bf16 v[80:83], v[212:215], v[16:19], v[80:83]
    ds_read_b64_tr_b16 v[46:47], v2 offset:58880
    s_waitcnt lgkmcnt(12)
    v_mfma_f32_16x16x32_bf16 v[84:87], v[132:135], v[20:23], v[84:87]
    ds_read_b64_tr_b16 v[16:17], v2 offset:56352
    v_mfma_f32_16x16x32_bf16 v[88:91], v[212:215], v[20:23], v[88:91]
    ds_read_b64_tr_b16 v[18:19], v2 offset:58912
    s_waitcnt lgkmcnt(12)
    v_mfma_f32_16x16x32_bf16 v[48:51], v[216:219], v[24:27], v[48:51]
    ds_read_b64_tr_b16 v[20:21], v2 offset:56384
    v_mfma_f32_16x16x32_bf16 v[52:55], v[24:27], v[24:27], v[52:55]
    ds_read_b64_tr_b16 v[22:23], v2 offset:58944
    v_mfma_f32_16x16x32_bf16 v[56:59], v[10:13], v[24:27], v[56:59]
    s_waitcnt lgkmcnt(12)
    v_mfma_f32_16x16x32_bf16 v[60:63], v[136:139], v[28:31], v[60:63]
    ds_read_b64_tr_b16 v[24:25], v2 offset:56416
    v_mfma_f32_16x16x32_bf16 v[64:67], v[216:219], v[28:31], v[64:67]
    ds_read_b64_tr_b16 v[26:27], v2 offset:58976
    s_waitcnt lgkmcnt(12)
    v_mfma_f32_16x16x32_bf16 v[68:71], v[136:139], v[32:35], v[68:71]
    ds_read_b64_tr_b16 v[28:29], v2 offset:56448
    v_mfma_f32_16x16x32_bf16 v[72:75], v[216:219], v[32:35], v[72:75]
    ds_read_b64_tr_b16 v[30:31], v2 offset:59008
    s_waitcnt lgkmcnt(12)
    v_mfma_f32_16x16x32_bf16 v[76:79], v[136:139], v[36:39], v[76:79]
    ds_read_b64_tr_b16 v[32:33], v3 offset:0
    v_mfma_f32_16x16x32_bf16 v[80:83], v[216:219], v[36:39], v[80:83]
    ds_read_b64_tr_b16 v[34:35], v3 offset:2560
    s_waitcnt lgkmcnt(12)
    v_mfma_f32_16x16x32_bf16 v[84:87], v[136:139], v[40:43], v[84:87]
    ds_read_b64_tr_b16 v[36:37], v3 offset:32
    v_mfma_f32_16x16x32_bf16 v[88:91], v[216:219], v[40:43], v[88:91]
    ds_read_b64_tr_b16 v[38:39], v3 offset:2592
    s_waitcnt lgkmcnt(12)
    v_mfma_f32_16x16x32_bf16 v[48:51], v[220:223], v[44:47], v[48:51]
    ds_read_b64_tr_b16 v[40:41], v3 offset:64
    v_mfma_f32_16x16x32_bf16 v[52:55], v[44:47], v[44:47], v[52:55]
    ds_read_b64_tr_b16 v[42:43], v3 offset:2624
    v_mfma_f32_16x16x32_bf16 v[56:59], v[10:13], v[44:47], v[56:59]
    s_waitcnt lgkmcnt(12)
    v_mfma_f32_16x16x32_bf16 v[60:63], v[140:143], v[16:19], v[60:63]
    ds_read_b64_tr_b16 v[44:45], v3 offset:96
    v_mfma_f32_16x16x32_bf16 v[64:67], v[220:223], v[16:19], v[64:67]
    ds_read_b64_tr_b16 v[46:47], v3 offset:2656
    s_waitcnt lgkmcnt(12)
    v_mfma_f32_16x16x32_bf16 v[68:71], v[140:143], v[20:23], v[68:71]
    ds_read_b64_tr_b16 v[16:17], v3 offset:128
    v_mfma_f32_16x16x32_bf16 v[72:75], v[220:223], v[20:23], v[72:75]
    ds_read_b64_tr_b16 v[18:19], v3 offset:2688
    s_waitcnt lgkmcnt(12)
    v_mfma_f32_16x16x32_bf16 v[76:79], v[140:143], v[24:27], v[76:79]
    ds_read_b64_tr_b16 v[20:21], v3 offset:5120
    v_mfma_f32_16x16x32_bf16 v[80:83], v[220:223], v[24:27], v[80:83]
    ds_read_b64_tr_b16 v[22:23], v3 offset:7680
    s_waitcnt lgkmcnt(12)
    v_mfma_f32_16x16x32_bf16 v[84:87], v[140:143], v[28:31], v[84:87]
    ds_read_b64_tr_b16 v[24:25], v3 offset:5152
    v_mfma_f32_16x16x32_bf16 v[88:91], v[220:223], v[28:31], v[88:91]
    ds_read_b64_tr_b16 v[26:27], v3 offset:7712
    s_waitcnt lgkmcnt(12)
    v_mfma_f32_16x16x32_bf16 v[48:51], v[224:227], v[32:35], v[48:51]
    ds_read_b64_tr_b16 v[28:29], v3 offset:5184
    v_mfma_f32_16x16x32_bf16 v[52:55], v[32:35], v[32:35], v[52:55]
    ds_read_b64_tr_b16 v[30:31], v3 offset:7744
    v_mfma_f32_16x16x32_bf16 v[56:59], v[10:13], v[32:35], v[56:59]
    s_waitcnt lgkmcnt(12)
    v_mfma_f32_16x16x32_bf16 v[60:63], v[144:147], v[36:39], v[60:63]
    ds_read_b64_tr_b16 v[32:33], v3 offset:5216
    v_mfma_f32_16x16x32_bf16 v[64:67], v[224:227], v[36:39], v[64:67]
    ds_read_b64_tr_b16 v[34:35], v3 offset:7776
    s_waitcnt lgkmcnt(12)
    v_mfma_f32_16x16x32_bf16 v[68:71], v[144:147], v[40:43], v[68:71]
    ds_read_b64_tr_b16 v[36:37], v3 offset:5248
    v_mfma_f32_16x16x32_bf16 v[72:75], v[224:227], v[40:43], v[72:75]
    ds_read_b64_tr_b16 v[38:39], v3 offset:7808
    s_waitcnt lgkmcnt(12)
    v_mfma_f32_16x16x32_bf16 v[76:79], v[144:147], v[44:47], v[76:79]
    ds_read_b64_tr_b16 v[40:41], v3 offset:10240
    v_mfma_f32_16x16x32_bf16 v[80:83], v[224:227], v[44:47], v[80:83]
    ds_read_b64_tr_b16 v[42:43], v3 offset:12800
    s_waitcnt lgkmcnt(12)
    v_mfma_f32_16x16x32_bf16 v[84:87], v[144:147], v[16:19], v[84:87]
    ds_read_b64_tr_b16 v[44:45], v3 offset:10272
    v_mfma_f32_16x16x32_bf16 v[88:91], v[224:227], v[16:19], v[88:91]
    ds_read_b64_tr_b16 v[46:47], v3 offset:12832
    s_waitcnt lgkmcnt(12)
    v_mfma_f32_16x16x32_bf16 v[48:51], v[228:231], v[20:23], v[48:51]
    ds_read_b64_tr_b16 v[16:17], v3 offset:10304
    v_mfma_f32_16x16x32_bf16 v[52:55], v[20:23], v[20:23], v[52:55]
    ds_read_b64_tr_b16 v[18:19], v3 offset:12864
    v_mfma_f32_16x16x32_bf16 v[56:59], v[10:13], v[20:23], v[56:59]
    s_waitcnt lgkmcnt(12)
    v_mfma_f32_16x16x32_bf16 v[60:63], v[148:151], v[24:27], v[60:63]
    ds_read_b64_tr_b16 v[20:21], v3 offset:10336
    v_mfma_f32_16x16x32_bf16 v[64:67], v[228:231], v[24:27], v[64:67]
    ds_read_b64_tr_b16 v[22:23], v3 offset:12896
    s_waitcnt lgkmcnt(12)
    v_mfma_f32_16x16x32_bf16 v[68:71], v[148:151], v[28:31], v[68:71]
    ds_read_b64_tr_b16 v[24:25], v3 offset:10368
    v_mfma_f32_16x16x32_bf16 v[72:75], v[228:231], v[28:31], v[72:75]
    ds_read_b64_tr_b16 v[26:27], v3 offset:12928
    s_waitcnt lgkmcnt(12)
    v_mfma_f32_16x16x32_bf16 v[76:79], v[148:151], v[32:35], v[76:79]
    ds_read_b64_tr_b16 v[28:29], v3 offset:15360
    v_mfma_f32_16x16x32_bf16 v[80:83], v[228:231], v[32:35], v[80:83]
    ds_read_b64_tr_b16 v[30:31], v3 offset:17920
    s_waitcnt lgkmcnt(12)
    v_mfma_f32_16x16x32_bf16 v[84:87], v[148:151], v[36:39], v[84:87]
    ds_read_b64_tr_b16 v[32:33], v3 offset:15392
    v_mfma_f32_16x16x32_bf16 v[88:91], v[228:231], v[36:39], v[88:91]
    ds_read_b64_tr_b16 v[34:35], v3 offset:17952
    s_waitcnt lgkmcnt(12)
    v_mfma_f32_16x16x32_bf16 v[48:51], v[232:235], v[40:43], v[48:51]
    ds_read_b64_tr_b16 v[36:37], v3 offset:15424
    v_mfma_f32_16x16x32_bf16 v[52:55], v[40:43], v[40:43], v[52:55]
    ds_read_b64_tr_b16 v[38:39], v3 offset:17984
    v_mfma_f32_16x16x32_bf16 v[56:59], v[10:13], v[40:43], v[56:59]
    s_waitcnt lgkmcnt(12)
    v_mfma_f32_16x16x32_bf16 v[60:63], v[152:155], v[44:47], v[60:63]
    ds_read_b64_tr_b16 v[40:41], v3 offset:15456
    v_mfma_f32_16x16x32_bf16 v[64:67], v[232:235], v[44:47], v[64:67]
    ds_read_b64_tr_b16 v[42:43], v3 offset:18016
    s_waitcnt lgkmcnt(12)
    v_mfma_f32_16x16x32_bf16 v[68:71], v[152:155], v[16:19], v[68:71]
    ds_read_b64_tr_b16 v[44:45], v3 offset:15488
    v_mfma_f32_16x16x32_bf16 v[72:75], v[232:235], v[16:19], v[72:75]
    ds_read_b64_tr_b16 v[46:47], v3 offset:18048
    s_waitcnt lgkmcnt(12)
    v_mfma_f32_16x16x32_bf16 v[76:79], v[152:155], v[20:23], v[76:79]
    ds_read_b64_tr_b16 v[16:17], v3 offset:20480
    v_mfma_f32_16x16x32_bf16 v[80:83], v[232:235], v[20:23], v[80:83]
    ds_read_b64_tr_b16 v[18:19], v3 offset:23040
    s_waitcnt lgkmcnt(12)
    v_mfma_f32_16x16x32_bf16 v[84:87], v[152:155], v[24:27], v[84:87]
    ds_read_b64_tr_b16 v[20:21], v3 offset:20512
    v_mfma_f32_16x16x32_bf16 v[88:91], v[232:235], v[24:27], v[88:91]
    ds_read_b64_tr_b16 v[22:23], v3 offset:23072
    s_waitcnt lgkmcnt(12)
    v_mfma_f32_16x16x32_bf16 v[48:51], v[236:239], v[28:31], v[48:51]
    ds_read_b64_tr_b16 v[24:25], v3 offset:20544
    v_mfma_f32_16x16x32_bf16 v[52:55], v[28:31], v[28:31], v[52:55]
    ds_read_b64_tr_b16 v[26:27], v3 offset:23104
    v_mfma_f32_16x16x32_bf16 v[56:59], v[10:13], v[28:31], v[56:59]
    s_waitcnt lgkmcnt(12)
    v_mfma_f32_16x16x32_bf16 v[60:63], v[156:159], v[32:35], v[60:63]
    ds_read_b64_tr_b16 v[28:29], v3 offset:20576
    v_mfma_f32_16x16x32_bf16 v[64:67], v[236:239], v[32:35], v[64:67]
    ds_read_b64_tr_b16 v[30:31], v3 offset:23136
    s_waitcnt lgkmcnt(12)
    v_mfma_f32_16x16x32_bf16 v[68:71], v[156:159], v[36:39], v[68:71]
    ds_read_b64_tr_b16 v[32:33], v3 offset:20608
    v_mfma_f32_16x16x32_bf16 v[72:75], v[236:239], v[36:39], v[72:75]
    ds_read_b64_tr_b16 v[34:35], v3 offset:23168
    s_waitcnt lgkmcnt(12)
    v_mfma_f32_16x16x32_bf16 v[76:79], v[156:159], v[40:43], v[76:79]
    ds_read_b64_tr_b16 v[36:37], v3 offset:25600
    v_mfma_f32_16x16x32_bf16 v[80:83], v[236:239], v[40:43], v[80:83]
    ds_read_b64_tr_b16 v[38:39], v3 offset:28160
    s_waitcnt lgkmcnt(12)
    v_mfma_f32_16x16x32_bf16 v[84:87], v[156:159], v[44:47], v[84:87]
    ds_read_b64_tr_b16 v[40:41], v3 offset:25632
    v_mfma_f32_16x16x32_bf16 v[88:91], v[236:239], v[44:47], v[88:91]
    ds_read_b64_tr_b16 v[42:43], v3 offset:28192
    s_waitcnt lgkmcnt(12)
    v_mfma_f32_16x16x32_bf16 v[48:51], v[240:243], v[16:19], v[48:51]
    ds_read_b64_tr_b16 v[44:45], v3 offset:25664
    v_mfma_f32_16x16x32_bf16 v[52:55], v[16:19], v[16:19], v[52:55]
    ds_read_b64_tr_b16 v[46:47], v3 offset:28224
    v_mfma_f32_16x16x32_bf16 v[56:59], v[10:13], v[16:19], v[56:59]
    s_waitcnt lgkmcnt(12)
    v_mfma_f32_16x16x32_bf16 v[60:63], v[160:163], v[20:23], v[60:63]
    ds_read_b64_tr_b16 v[16:17], v3 offset:25696
    v_mfma_f32_16x16x32_bf16 v[64:67], v[240:243], v[20:23], v[64:67]
    ds_read_b64_tr_b16 v[18:19], v3 offset:28256
    s_waitcnt lgkmcnt(12)
    v_mfma_f32_16x16x32_bf16 v[68:71], v[160:163], v[24:27], v[68:71]
    ds_read_b64_tr_b16 v[20:21], v3 offset:25728
    v_mfma_f32_16x16x32_bf16 v[72:75], v[240:243], v[24:27], v[72:75]
    ds_read_b64_tr_b16 v[22:23], v3 offset:28288
    s_waitcnt lgkmcnt(12)
    v_mfma_f32_16x16x32_bf16 v[76:79], v[160:163], v[28:31], v[76:79]
    ds_read_b64_tr_b16 v[24:25], v3 offset:30720
    v_mfma_f32_16x16x32_bf16 v[80:83], v[240:243], v[28:31], v[80:83]
    ds_read_b64_tr_b16 v[26:27], v3 offset:33280
    s_waitcnt lgkmcnt(12)
    v_mfma_f32_16x16x32_bf16 v[84:87], v[160:163], v[32:35], v[84:87]
    ds_read_b64_tr_b16 v[28:29], v3 offset:30752
    v_mfma_f32_16x16x32_bf16 v[88:91], v[240:243], v[32:35], v[88:91]
    ds_read_b64_tr_b16 v[30:31], v3 offset:33312
    s_waitcnt lgkmcnt(12)
    v_mfma_f32_16x16x32_bf16 v[48:51], v[244:247], v[36:39], v[48:51]
    ds_read_b64_tr_b16 v[32:33], v3 offset:30784
    v_mfma_f32_16x16x32_bf16 v[52:55], v[36:39], v[36:39], v[52:55]
    ds_read_b64_tr_b16 v[34:35], v3 offset:33344
    v_mfma_f32_16x16x32_bf16 v[56:59], v[10:13], v[36:39], v[56:59]
    s_waitcnt lgkmcnt(12)
    v_mfma_f32_16x16x32_bf16 v[60:63], v[164:167], v[40:43], v[60:63]
    ds_read_b64_tr_b16 v[36:37], v3 offset:30816
    v_mfma_f32_16x16x32_bf16 v[64:67], v[244:247], v[40:43], v[64:67]
    ds_read_b64_tr_b16 v[38:39], v3 offset:33376
    s_waitcnt lgkmcnt(12)
    v_mfma_f32_16x16x32_bf16 v[68:71], v[164:167], v[44:47], v[68:71]
    ds_read_b64_tr_b16 v[40:41], v3 offset:30848
    v_mfma_f32_16x16x32_bf16 v[72:75], v[244:247], v[44:47], v[72:75]
    ds_read_b64_tr_b16 v[42:43], v3 offset:33408
    s_waitcnt lgkmcnt(12)
    v_mfma_f32_16x16x32_bf16 v[76:79], v[164:167], v[16:19], v[76:79]
    ds_read_b64_tr_b16 v[44:45], v3 offset:35840
    v_mfma_f32_16x16x32_bf16 v[80:83], v[244:247], v[16:19], v[80:83]
    ds_read_b64_tr_b16 v[46:47], v3 offset:38400
    s_waitcnt lgkmcnt(12)
    v_mfma_f32_16x16x32_bf16 v[84:87], v[164:167], v[20:23], v[84:87]
    ds_read_b64_tr_b16 v[16:17], v3 offset:35872
    v_mfma_f32_16x16x32_bf16 v[88:91], v[244:247], v[20:23], v[88:91]
    ds_read_b64_tr_b16 v[18:19], v3 offset:38432
    s_waitcnt lgkmcnt(12)
    v_mfma_f32_16x16x32_bf16 v[48:51], v[248:251], v[24:27], v[48:51]
    ds_read_b64_tr_b16 v[20:21], v3 offset:35904
    v_mfma_f32_16x16x32_bf16 v[52:55], v[24:27], v[24:27], v[52:55]
    ds_read_b64_tr_b16 v[22:23], v3 offset:38464
    v_mfma_f32_16x16x32_bf16 v[56:59], v[10:13], v[24:27], v[56:59]
    s_waitcnt lgkmcnt(12)
    v_mfma_f32_16x16x32_bf16 v[60:63], v[168:171], v[28:31], v[60:63]
    ds_read_b64_tr_b16 v[24:25], v3 offset:35936
    v_mfma_f32_16x16x32_bf16 v[64:67], v[248:251], v[28:31], v[64:67]
    ds_read_b64_tr_b16 v[26:27], v3 offset:38496
    s_waitcnt lgkmcnt(12)
    v_mfma_f32_16x16x32_bf16 v[68:71], v[168:171], v[32:35], v[68:71]
    ds_read_b64_tr_b16 v[28:29], v3 offset:35968
    v_mfma_f32_16x16x32_bf16 v[72:75], v[248:251], v[32:35], v[72:75]
    ds_read_b64_tr_b16 v[30:31], v3 offset:38528
    s_waitcnt lgkmcnt(12)
    v_mfma_f32_16x16x32_bf16 v[76:79], v[168:171], v[36:39], v[76:79]
    v_mfma_f32_16x16x32_bf16 v[80:83], v[248:251], v[36:39], v[80:83]
    s_waitcnt lgkmcnt(10)
    v_mfma_f32_16x16x32_bf16 v[84:87], v[168:171], v[40:43], v[84:87]
    v_mfma_f32_16x16x32_bf16 v[88:91], v[248:251], v[40:43], v[88:91]
    s_waitcnt lgkmcnt(8)
    v_mfma_f32_16x16x32_bf16 v[48:51], v[252:255], v[44:47], v[48:51]
    v_mfma_f32_16x16x32_bf16 v[52:55], v[44:47], v[44:47], v[52:55]
    v_mfma_f32_16x16x32_bf16 v[56:59], v[10:13], v[44:47], v[56:59]
    s_waitcnt lgkmcnt(6)
    v_mfma_f32_16x16x32_bf16 v[60:63], v[172:175], v[16:19], v[60:63]
    v_mfma_f32_16x16x32_bf16 v[64:67], v[252:255], v[16:19], v[64:67]
    s_waitcnt lgkmcnt(4)
    v_mfma_f32_16x16x32_bf16 v[68:71], v[172:175], v[20:23], v[68:71]
    v_mfma_f32_16x16x32_bf16 v[72:75], v[252:255], v[20:23], v[72:75]
    s_waitcnt lgkmcnt(2)
    v_mfma_f32_16x16x32_bf16 v[76:79], v[172:175], v[24:27], v[76:79]
    v_mfma_f32_16x16x32_bf16 v[80:83], v[252:255], v[24:27], v[80:83]
    s_waitcnt lgkmcnt(0)
    v_mfma_f32_16x16x32_bf16 v[84:87], v[172:175], v[28:31], v[84:87]
    v_mfma_f32_16x16x32_bf16 v[88:91], v[252:255], v[28:31], v[88:91]
    ds_read_b64 v[10:11], v7
    ds_read_b64 v[12:13], v8
    ds_read_b64 v[14:15], v9
    v_and_b32 v16, 15, v1
    v_lshrrev_b32 v17, 4, v1
    v_and_b32 v18, 3, v1
    v_lshrrev_b32 v19, 2, v16
    v_cmp_eq_u32 s[42:43], 1, v18
    v_cmp_eq_u32 s[44:45], 2, v18
    v_cmp_eq_u32 s[46:47], 3, v18
    v_cmp_eq_u32 s[54:55], v19, v17
    v_lshlrev_b32 v18, 3, v16
    v_add_u32 v18, 45376, v18
    v_cndmask_b32 v52, v52, v53, s[42:43]
    v_cndmask_b32 v52, v52, v54, s[44:45]
    v_cndmask_b32 v52, v52, v55, s[46:47]
    v_mul_f32 v56, 0x3acccccd, v56
    v_mul_f32 v52, 0x3acccccd, v52
    v_fma_f32 v52, -v56, v56, v52
    v_max_f32 v52, 0, v52
    v_cvt_pk_bf16_f32 v56, v56, v52
    v_and_b32 v52, 0xffff0000, v56
    v_lshlrev_b32 v56, 16, v56
    v_add_f32 v52, 0x3727c5ac, v52
    v_cvt_pk_bf16_f32 v52, v52, v52
    v_lshlrev_b32 v52, 16, v52
    v_sqrt_f32 v52, v52
    s_nop 0
    v_cvt_pk_bf16_f32 v52, v52, v52
    v_lshlrev_b32 v52, 16, v52
    v_rcp_f32 v57, v52
    s_mov_b64 exec, s[54:55]
    ds_write_b64 v18, v[56:57] offset:0
    s_mov_b64 exec, -1
    s_lshl_b32 s42, s3, 7
    s_add_u32 s42, s42, 46016
    v_lshl_add_u32 v19, v17, 4, s42
    s_lshl_b32 s42, s3, 6
    s_cmp_eq_u32 s3, 2
    s_cselect_b32 s42, 192, s42
    s_cmp_eq_u32 s3, 3
    s_cselect_b32 s42, 128, s42
    s_add_u32 s42, s42, 61440
    v_mul_u32_u24 v20, 496, v16
    v_and_b32 v21, 1, v17
    v_lshl_add_u32 v20, v21, 4, v20
    v_lshrrev_b32 v21, 1, v17
    v_lshl_add_u32 v20, v21, 3, v20
    v_add_u32 v20, s42, v20
    v_lshlrev_b32 v18, 3, v16
    v_add_u32 v18, 45376, v18
    s_waitcnt lgkmcnt(0)
    s_barrier
    ds_read_b64 v[24:25], v18 offset:0
    ds_read_b64 v[26:27], v18 offset:128
    ds_read_b64 v[28:29], v18 offset:256
    ds_read_b64 v[30:31], v18 offset:384
    ds_read_b64 v[32:33], v18 offset:512
    ds_read_b128 v[36:39], v19 offset:0
    ds_read_b128 v[40:43], v19 offset:64
    s_waitcnt lgkmcnt(0)
    v_fma_f32 v48, -v24, v40, v48
    v_fma_f32 v49, -v24, v41, v49
    v_fma_f32 v50, -v24, v42, v50
    v_fma_f32 v51, -v24, v43, v51
    v_fma_f32 v60, -v26, v36, v60
    v_fma_f32 v61, -v26, v37, v61
    v_fma_f32 v62, -v26, v38, v62
    v_fma_f32 v63, -v26, v39, v63
    v_fma_f32 v64, -v26, v40, v64
    v_fma_f32 v65, -v26, v41, v65
    v_fma_f32 v66, -v26, v42, v66
    v_fma_f32 v67, -v26, v43, v67
    v_fma_f32 v68, -v28, v36, v68
    v_fma_f32 v69, -v28, v37, v69
    v_fma_f32 v70, -v28, v38, v70
    v_fma_f32 v71, -v28, v39, v71
    v_fma_f32 v72, -v28, v40, v72
    v_fma_f32 v73, -v28, v41, v73
    v_fma_f32 v74, -v28, v42, v74
    v_fma_f32 v75, -v28, v43, v75
    v_fma_f32 v76, -v30, v36, v76
    v_fma_f32 v77, -v30, v37, v77
    v_fma_f32 v78, -v30, v38, v78
    v_fma_f32 v79, -v30, v39, v79
    v_fma_f32 v80, -v30, v40, v80
    v_fma_f32 v81, -v30, v41, v81
    v_fma_f32 v82, -v30, v42, v82
    v_fma_f32 v83, -v30, v43, v83
    v_fma_f32 v84, -v32, v36, v84
    v_fma_f32 v85, -v32, v37, v85
    v_fma_f32 v86, -v32, v38, v86
    v_fma_f32 v87, -v32, v39, v87
    v_fma_f32 v88, -v32, v40, v88
    v_fma_f32 v89, -v32, v41, v89
    v_fma_f32 v90, -v32, v42, v90
    v_fma_f32 v91, -v32, v43, v91
    v_mul_f32 v48, v48, v25
    v_mul_f32 v49, v49, v25
    v_mul_f32 v50, v50, v25
    v_mul_f32 v51, v51, v25
    v_mul_f32 v60, v60, v27
    v_mul_f32 v61, v61, v27
    v_mul_f32 v62, v62, v27
    v_mul_f32 v63, v63, v27
    v_mul_f32 v64, v64, v27
    v_mul_f32 v65, v65, v27
    v_mul_f32 v66, v66, v27
    v_mul_f32 v67, v67, v27
    v_mul_f32 v68, v68, v29
    v_mul_f32 v69, v69, v29
    v_mul_f32 v70, v70, v29
    v_mul_f32 v71, v71, v29
    v_mul_f32 v72, v72, v29
    v_mul_f32 v73, v73, v29
    v_mul_f32 v74, v74, v29
    v_mul_f32 v75, v75, v29
    v_mul_f32 v76, v76, v31
    v_mul_f32 v77, v77, v31
    v_mul_f32 v78, v78, v31
    v_mul_f32 v79, v79, v31
    v_mul_f32 v80, v80, v31
    v_mul_f32 v81, v81, v31
    v_mul_f32 v82, v82, v31
    v_mul_f32 v83, v83, v31
    v_mul_f32 v84, v84, v33
    v_mul_f32 v85, v85, v33
    v_mul_f32 v86, v86, v33
    v_mul_f32 v87, v87, v33
    v_mul_f32 v88, v88, v33
    v_mul_f32 v89, v89, v33
    v_mul_f32 v90, v90, v33
    v_mul_f32 v91, v91, v33
    v_permlane32_swap_b32 v48, v50
    v_permlane32_swap_b32 v49, v51
    v_permlane32_swap_b32 v60, v62
    v_permlane32_swap_b32 v61, v63
    v_permlane32_swap_b32 v64, v66
    v_permlane32_swap_b32 v65, v67
    v_permlane32_swap_b32 v68, v70
    v_permlane32_swap_b32 v69, v71
    v_permlane32_swap_b32 v72, v74
    v_permlane32_swap_b32 v73, v75
    v_permlane32_swap_b32 v76, v78
    v_permlane32_swap_b32 v77, v79
    v_permlane32_swap_b32 v80, v82
    v_permlane32_swap_b32 v81, v83
    v_permlane32_swap_b32 v84, v86
    v_permlane32_swap_b32 v85, v87
    v_permlane32_swap_b32 v88, v90
    v_permlane32_swap_b32 v89, v91
    v_cvt_pk_bf16_f32 v48, v48, v50
    v_cvt_pk_bf16_f32 v49, v49, v51
    ds_write_b64 v20, v[48:49] offset:32
    v_cvt_pk_bf16_f32 v60, v60, v62
    v_cvt_pk_bf16_f32 v61, v61, v63
    ds_write_b64 v20, v[60:61] offset:7936
    v_cvt_pk_bf16_f32 v64, v64, v66
    v_cvt_pk_bf16_f32 v65, v65, v67
    ds_write_b64 v20, v[64:65] offset:7968
    v_cvt_pk_bf16_f32 v68, v68, v70
    v_cvt_pk_bf16_f32 v69, v69, v71
    ds_write_b64 v20, v[68:69] offset:15872
    v_cvt_pk_bf16_f32 v72, v72, v74
    v_cvt_pk_bf16_f32 v73, v73, v75
    ds_write_b64 v20, v[72:73] offset:15904
    v_cvt_pk_bf16_f32 v76, v76, v78
    v_cvt_pk_bf16_f32 v77, v77, v79
    ds_write_b64 v20, v[76:77] offset:23808
    v_cvt_pk_bf16_f32 v80, v80, v82
    v_cvt_pk_bf16_f32 v81, v81, v83
    ds_write_b64 v20, v[80:81] offset:23840
    v_cvt_pk_bf16_f32 v84, v84, v86
    v_cvt_pk_bf16_f32 v85, v85, v87
    ds_write_b64 v20, v[84:85] offset:31744
    v_cvt_pk_bf16_f32 v88, v88, v90
    v_cvt_pk_bf16_f32 v89, v89, v91
    ds_write_b64 v20, v[88:89] offset:31776
    s_branch L_a1_post
L_g2E:
    s_waitcnt vmcnt(3)
    s_barrier
    ds_read_b64_tr_b16 v[16:17], v2 offset:0
    ds_read_b64_tr_b16 v[18:19], v2 offset:2560
    ds_read_b64_tr_b16 v[20:21], v2 offset:32
    ds_read_b64_tr_b16 v[22:23], v2 offset:2592
    ds_read_b64_tr_b16 v[24:25], v2 offset:64
    ds_read_b64_tr_b16 v[26:27], v2 offset:2624
    ds_read_b64_tr_b16 v[28:29], v2 offset:96
    ds_read_b64_tr_b16 v[30:31], v2 offset:2656
    ds_read_b64_tr_b16 v[32:33], v2 offset:128
    ds_read_b64_tr_b16 v[34:35], v2 offset:2688
    s_waitcnt vmcnt(2)
    s_barrier
    ds_read_b64_tr_b16 v[36:37], v2 offset:5120
    ds_read_b64_tr_b16 v[38:39], v2 offset:7680
    ds_read_b64_tr_b16 v[40:41], v2 offset:5152
    ds_read_b64_tr_b16 v[42:43], v2 offset:7712
    s_waitcnt lgkmcnt(12)
    v_mfma_f32_16x16x32_bf16 v[48:51], v[96:99], v[16:19], 0
    ds_read_b64_tr_b16 v[44:45], v2 offset:5184
    ds_read_b64_tr_b16 v[46:47], v2 offset:7744
    s_waitcnt lgkmcnt(12)
    v_mfma_f32_16x16x32_bf16 v[52:55], v[96:99], v[20:23], 0
    ds_read_b64_tr_b16 v[16:17], v2 offset:5216
    ds_read_b64_tr_b16 v[18:19], v2 offset:7776
    s_waitcnt lgkmcnt(12)
    v_mfma_f32_16x16x32_bf16 v[56:59], v[96:99], v[24:27], 0
    s_add_u32 m0, s52, 94208
    s_nop 0
    global_load_lds_dwordx4 v14, s[50:51] sc1
    ds_read_b64_tr_b16 v[20:21], v2 offset:5248
    s_waitcnt lgkmcnt(11)
    v_mfma_f32_16x16x32_bf16 v[60:63], v[96:99], v[28:31], 0
    ds_read_b64_tr_b16 v[22:23], v2 offset:7808
    s_add_u32 m0, s52, 98304
    s_nop 0
    global_load_lds_dwordx4 v15, s[50:51] sc1
    v_mfma_f32_16x16x32_bf16 v[64:67], v[28:31], v[28:31], 0
    ds_read_b64_tr_b16 v[24:25], v2 offset:10240
    v_mfma_f32_16x16x32_bf16 v[68:71], v[10:13], v[28:31], 0
    ds_read_b64_tr_b16 v[26:27], v2 offset:12800
    s_waitcnt lgkmcnt(12)
    v_mfma_f32_16x16x32_bf16 v[72:75], v[96:99], v[32:35], 0
    ds_read_b64_tr_b16 v[28:29], v2 offset:10272
    v_mfma_f32_16x16x32_bf16 v[76:79], v[32:35], v[32:35], 0
    ds_read_b64_tr_b16 v[30:31], v2 offset:12832
    v_mfma_f32_16x16x32_bf16 v[80:83], v[10:13], v[32:35], 0
    s_waitcnt lgkmcnt(12)
    v_mfma_f32_16x16x32_bf16 v[48:51], v[100:103], v[36:39], v[48:51]
    ds_read_b64_tr_b16 v[32:33], v2 offset:10304
    ds_read_b64_tr_b16 v[34:35], v2 offset:12864
    s_waitcnt lgkmcnt(12)
    v_mfma_f32_16x16x32_bf16 v[52:55], v[100:103], v[40:43], v[52:55]
    ds_read_b64_tr_b16 v[36:37], v2 offset:10336
    ds_read_b64_tr_b16 v[38:39], v2 offset:12896
    s_waitcnt lgkmcnt(12)
    v_mfma_f32_16x16x32_bf16 v[56:59], v[100:103], v[44:47], v[56:59]
    s_add_u32 m0, s52, 102400
    s_add_u32 s50, s50, 524288
    s_addc_u32 s51, s51, 0
    global_load_lds_dwordx4 v4, s[50:51] sc1
    ds_read_b64_tr_b16 v[40:41], v2 offset:10368
    s_waitcnt lgkmcnt(11)
    v_mfma_f32_16x16x32_bf16 v[60:63], v[100:103], v[16:19], v[60:63]
    ds_read_b64_tr_b16 v[42:43], v2 offset:12928
    s_add_u32 m0, s52, 106496
    s_nop 0
    global_load_lds_dwordx4 v5, s[50:51] sc1
    v_mfma_f32_16x16x32_bf16 v[64:67], v[16:19], v[16:19], v[64:67]
    s_waitcnt vmcnt(4)
    s_barrier
    ds_read_b64_tr_b16 v[44:45], v2 offset:15360
    v_mfma_f32_16x16x32_bf16 v[68:71], v[10:13], v[16:19], v[68:71]
    ds_read_b64_tr_b16 v[46:47], v2 offset:17920
    s_waitcnt lgkmcnt(12)
    v_mfma_f32_16x16x32_bf16 v[72:75], v[100:103], v[20:23], v[72:75]
    ds_read_b64_tr_b16 v[16:17], v2 offset:15392
    v_mfma_f32_16x16x32_bf16 v[76:79], v[20:23], v[20:23], v[76:79]
    ds_read_b64_tr_b16 v[18:19], v2 offset:17952
    v_mfma_f32_16x16x32_bf16 v[80:83], v[10:13], v[20:23], v[80:83]
    s_waitcnt lgkmcnt(12)
    v_mfma_f32_16x16x32_bf16 v[48:51], v[104:107], v[24:27], v[48:51]
    ds_read_b64_tr_b16 v[20:21], v2 offset:15424
    ds_read_b64_tr_b16 v[22:23], v2 offset:17984
    s_waitcnt lgkmcnt(12)
    v_mfma_f32_16x16x32_bf16 v[52:55], v[104:107], v[28:31], v[52:55]
    ds_read_b64_tr_b16 v[24:25], v2 offset:15456
    ds_read_b64_tr_b16 v[26:27], v2 offset:18016
    s_waitcnt lgkmcnt(12)
    v_mfma_f32_16x16x32_bf16 v[56:59], v[104:107], v[32:35], v[56:59]
    s_add_u32 m0, s52, 110592
    s_nop 0
    global_load_lds_dwordx4 v6, s[50:51] sc1
    ds_read_b64_tr_b16 v[28:29], v2 offset:15488
    s_waitcnt lgkmcnt(11)
    v_mfma_f32_16x16x32_bf16 v[60:63], v[104:107], v[36:39], v[60:63]
    ds_read_b64_tr_b16 v[30:31], v2 offset:18048
    s_add_u32 m0, s52, 114688
    s_nop 0
    global_load_lds_dwordx4 v14, s[50:51] sc1
    v_mfma_f32_16x16x32_bf16 v[64:67], v[36:39], v[36:39], v[64:67]
    ds_read_b64_tr_b16 v[32:33], v2 offset:20480
    v_mfma_f32_16x16x32_bf16 v[68:71], v[10:13], v[36:39], v[68:71]
    ds_read_b64_tr_b16 v[34:35], v2 offset:23040
    s_waitcnt lgkmcnt(12)
    v_mfma_f32_16x16x32_bf16 v[72:75], v[104:107], v[40:43], v[72:75]
    ds_read_b64_tr_b16 v[36:37], v2 offset:20512
    v_mfma_f32_16x16x32_bf16 v[76:79], v[40:43], v[40:43], v[76:79]
    ds_read_b64_tr_b16 v[38:39], v2 offset:23072
    v_mfma_f32_16x16x32_bf16 v[80:83], v[10:13], v[40:43], v[80:83]
    s_waitcnt lgkmcnt(12)
    v_mfma_f32_16x16x32_bf16 v[48:51], v[108:111], v[44:47], v[48:51]
    ds_read_b64_tr_b16 v[40:41], v2 offset:20544
    ds_read_b64_tr_b16 v[42:43], v2 offset:23104
    s_waitcnt lgkmcnt(12)
    v_mfma_f32_16x16x32_bf16 v[52:55], v[108:111], v[16:19], v[52:55]
    ds_read_b64_tr_b16 v[44:45], v2 offset:20576
    ds_read_b64_tr_b16 v[46:47], v2 offset:23136
    s_waitcnt lgkmcnt(12)
    v_mfma_f32_16x16x32_bf16 v[56:59], v[108:111], v[20:23], v[56:59]
    s_add_u32 m0, s52, 118784
    s_nop 0
    global_load_lds_dwordx4 v15, s[50:51] sc1
    ds_read_b64_tr_b16 v[16:17], v2 offset:20608
    s_waitcnt lgkmcnt(11)
    v_mfma_f32_16x16x32_bf16 v[60:63], v[108:111], v[24:27], v[60:63]
    ds_read_b64_tr_b16 v[18:19], v2 offset:23168
    s_add_u32 m0, s52, 122880
    s_add_u32 s50, s50, 524288
    s_addc_u32 s51, s51, 0
    global_load_lds_dwordx4 v4, s[50:51] sc1
    v_mfma_f32_16x16x32_bf16 v[64:67], v[24:27], v[24:27], v[64:67]
    ds_read_b64_tr_b16 v[20:21], v2 offset:25600
    v_mfma_f32_16x16x32_bf16 v[68:71], v[10:13], v[24:27], v[68:71]
    ds_read_b64_tr_b16 v[22:23], v2 offset:28160
    s_waitcnt lgkmcnt(12)
    v_mfma_f32_16x16x32_bf16 v[72:75], v[108:111], v[28:31], v[72:75]
    ds_read_b64_tr_b16 v[24:25], v2 offset:25632
    v_mfma_f32_16x16x32_bf16 v[76:79], v[28:31], v[28:31], v[76:79]
    ds_read_b64_tr_b16 v[26:27], v2 offset:28192
    v_mfma_f32_16x16x32_bf16 v[80:83], v[10:13], v[28:31], v[80:83]
    s_waitcnt lgkmcnt(12)
    v_mfma_f32_16x16x32_bf16 v[48:51], v[112:115], v[32:35], v[48:51]
    ds_read_b64_tr_b16 v[28:29], v2 offset:25664
    ds_read_b64_tr_b16 v[30:31], v2 offset:28224
    s_waitcnt lgkmcnt(12)
    v_mfma_f32_16x16x32_bf16 v[52:55], v[112:115], v[36:39], v[52:55]
    ds_read_b64_tr_b16 v[32:33], v2 offset:25696
    ds_read_b64_tr_b16 v[34:35], v2 offset:28256
    s_waitcnt lgkmcnt(12)
    v_mfma_f32_16x16x32_bf16 v[56:59], v[112:115], v[40:43], v[56:59]
    s_add_u32 m0, s52, 126976
    s_nop 0
    global_load_lds_dwordx4 v5, s[50:51] sc1
    ds_read_b64_tr_b16 v[36:37], v2 offset:25728
    s_waitcnt lgkmcnt(11)
    v_mfma_f32_16x16x32_bf16 v[60:63], v[112:115], v[44:47], v[60:63]
    ds_read_b64_tr_b16 v[38:39], v2 offset:28288
    s_add_u32 m0, s52, 131072
    s_nop 0
    global_load_lds_dwordx4 v6, s[50:51] sc1
    v_mfma_f32_16x16x32_bf16 v[64:67], v[44:47], v[44:47], v[64:67]
    s_waitcnt vmcnt(4)
    s_barrier
    ds_read_b64_tr_b16 v[40:41], v2 offset:30720
    v_mfma_f32_16x16x32_bf16 v[68:71], v[10:13], v[44:47], v[68:71]
    ds_read_b64_tr_b16 v[42:43], v2 offset:33280
    s_waitcnt lgkmcnt(12)
    v_mfma_f32_16x16x32_bf16 v[72:75], v[112:115], v[16:19], v[72:75]
    ds_read_b64_tr_b16 v[44:45], v2 offset:30752
    v_mfma_f32_16x16x32_bf16 v[76:79], v[16:19], v[16:19], v[76:79]
    ds_read_b64_tr_b16 v[46:47], v2 offset:33312
    v_mfma_f32_16x16x32_bf16 v[80:83], v[10:13], v[16:19], v[80:83]
    s_waitcnt lgkmcnt(12)
    v_mfma_f32_16x16x32_bf16 v[48:51], v[116:119], v[20:23], v[48:51]
    ds_read_b64_tr_b16 v[16:17], v2 offset:30784
    ds_read_b64_tr_b16 v[18:19], v2 offset:33344
    s_waitcnt lgkmcnt(12)
    v_mfma_f32_16x16x32_bf16 v[52:55], v[116:119], v[24:27], v[52:55]
    ds_read_b64_tr_b16 v[20:21], v2 offset:30816
    ds_read_b64_tr_b16 v[22:23], v2 offset:33376
    s_waitcnt lgkmcnt(12)
    v_mfma_f32_16x16x32_bf16 v[56:59], v[116:119], v[28:31], v[56:59]
    s_add_u32 m0, s52, 135168
    s_nop 0
    global_load_lds_dwordx4 v14, s[50:51] sc1
    ds_read_b64_tr_b16 v[24:25], v2 offset:30848
    s_waitcnt lgkmcnt(11)
    v_mfma_f32_16x16x32_bf16 v[60:63], v[116:119], v[32:35], v[60:63]
    ds_read_b64_tr_b16 v[26:27], v2 offset:33408
    s_add_u32 m0, s52, 139264
    s_nop 0
    global_load_lds_dwordx4 v15, s[50:51] sc1
    v_mfma_f32_16x16x32_bf16 v[64:67], v[32:35], v[32:35], v[64:67]
    ds_read_b64_tr_b16 v[28:29], v2 offset:35840
    v_mfma_f32_16x16x32_bf16 v[68:71], v[10:13], v[32:35], v[68:71]
    ds_read_b64_tr_b16 v[30:31], v2 offset:38400
    s_waitcnt lgkmcnt(12)
    v_mfma_f32_16x16x32_bf16 v[72:75], v[116:119], v[36:39], v[72:75]
    ds_read_b64_tr_b16 v[32:33], v2 offset:35872
    v_mfma_f32_16x16x32_bf16 v[76:79], v[36:39], v[36:39], v[76:79]
    ds_read_b64_tr_b16 v[34:35], v2 offset:38432
    v_mfma_f32_16x16x32_bf16 v[80:83], v[10:13], v[36:39], v[80:83]
    s_waitcnt lgkmcnt(12)
    v_mfma_f32_16x16x32_bf16 v[48:51], v[120:123], v[40:43], v[48:51]
    ds_read_b64_tr_b16 v[36:37], v2 offset:35904
    ds_read_b64_tr_b16 v[38:39], v2 offset:38464
    s_waitcnt lgkmcnt(12)
    v_mfma_f32_16x16x32_bf16 v[52:55], v[120:123], v[44:47], v[52:55]
    ds_read_b64_tr_b16 v[40:41], v2 offset:35936
    ds_read_b64_tr_b16 v[42:43], v2 offset:38496
    s_waitcnt lgkmcnt(12)
    v_mfma_f32_16x16x32_bf16 v[56:59], v[120:123], v[16:19], v[56:59]
    s_add_u32 m0, s52, 143360
    s_add_u32 s50, s50, 524288
    s_addc_u32 s51, s51, 0
    global_load_lds_dwordx4 v4, s[50:51] sc1
    ds_read_b64_tr_b16 v[44:45], v2 offset:35968
    s_waitcnt lgkmcnt(11)
    v_mfma_f32_16x16x32_bf16 v[60:63], v[120:123], v[20:23], v[60:63]
    ds_read_b64_tr_b16 v[46:47], v2 offset:38528
    s_add_u32 m0, s52, 147456
    s_nop 0
    global_load_lds_dwordx4 v5, s[50:51] sc1
    v_mfma_f32_16x16x32_bf16 v[64:67], v[20:23], v[20:23], v[64:67]
    ds_read_b64_tr_b16 v[16:17], v2 offset:40960
    v_mfma_f32_16x16x32_bf16 v[68:71], v[10:13], v[20:23], v[68:71]
    ds_read_b64_tr_b16 v[18:19], v2 offset:43520
    s_waitcnt lgkmcnt(12)
    v_mfma_f32_16x16x32_bf16 v[72:75], v[120:123], v[24:27], v[72:75]
    ds_read_b64_tr_b16 v[20:21], v2 offset:40992
    v_mfma_f32_16x16x32_bf16 v[76:79], v[24:27], v[24:27], v[76:79]
    ds_read_b64_tr_b16 v[22:23], v2 offset:43552
    v_mfma_f32_16x16x32_bf16 v[80:83], v[10:13], v[24:27], v[80:83]
    s_waitcnt lgkmcnt(12)
    v_mfma_f32_16x16x32_bf16 v[48:51], v[124:127], v[28:31], v[48:51]
    ds_read_b64_tr_b16 v[24:25], v2 offset:41024
    ds_read_b64_tr_b16 v[26:27], v2 offset:43584
    s_waitcnt lgkmcnt(12)
    v_mfma_f32_16x16x32_bf16 v[52:55], v[124:127], v[32:35], v[52:55]
    ds_read_b64_tr_b16 v[28:29], v2 offset:41056
    ds_read_b64_tr_b16 v[30:31], v2 offset:43616
    s_waitcnt lgkmcnt(12)
    v_mfma_f32_16x16x32_bf16 v[56:59], v[124:127], v[36:39], v[56:59]
    s_add_u32 m0, s52, 151552
    s_nop 0
    global_load_lds_dwordx4 v6, s[50:51] sc1
    ds_read_b64_tr_b16 v[32:33], v2 offset:41088
    s_waitcnt lgkmcnt(11)
    v_mfma_f32_16x16x32_bf16 v[60:63], v[124:127], v[40:43], v[60:63]
    ds_read_b64_tr_b16 v[34:35], v2 offset:43648
    s_add_u32 m0, s52, 155648
    s_nop 0
    global_load_lds_dwordx4 v14, s[50:51] sc1
    v_mfma_f32_16x16x32_bf16 v[64:67], v[40:43], v[40:43], v[64:67]
    ds_read_b64_tr_b16 v[36:37], v2 offset:46080
    v_mfma_f32_16x16x32_bf16 v[68:71], v[10:13], v[40:43], v[68:71]
    ds_read_b64_tr_b16 v[38:39], v2 offset:48640
    s_waitcnt lgkmcnt(12)
    v_mfma_f32_16x16x32_bf16 v[72:75], v[124:127], v[44:47], v[72:75]
    ds_read_b64_tr_b16 v[40:41], v2 offset:46112
    v_mfma_f32_16x16x32_bf16 v[76:79], v[44:47], v[44:47], v[76:79]
    ds_read_b64_tr_b16 v[42:43], v2 offset:48672
    v_mfma_f32_16x16x32_bf16 v[80:83], v[10:13], v[44:47], v[80:83]
    s_waitcnt lgkmcnt(12)
    v_mfma_f32_16x16x32_bf16 v[48:51], v[128:131], v[16:19], v[48:51]
    ds_read_b64_tr_b16 v[44:45], v2 offset:46144
    ds_read_b64_tr_b16 v[46:47], v2 offset:48704
    s_waitcnt lgkmcnt(12)
    v_mfma_f32_16x16x32_bf16 v[52:55], v[128:131], v[20:23], v[52:55]
    ds_read_b64_tr_b16 v[16:17], v2 offset:46176
    ds_read_b64_tr_b16 v[18:19], v2 offset:48736
    s_waitcnt lgkmcnt(12)
    v_mfma_f32_16x16x32_bf16 v[56:59], v[128:131], v[24:27], v[56:59]
    s_add_u32 m0, s52, 159744
    s_nop 0
    global_load_lds_dwordx4 v15, s[50:51] sc1
    ds_read_b64_tr_b16 v[20:21], v2 offset:46208
    s_waitcnt lgkmcnt(11)
    v_mfma_f32_16x16x32_bf16 v[60:63], v[128:131], v[28:31], v[60:63]
    ds_read_b64_tr_b16 v[22:23], v2 offset:48768
    v_mfma_f32_16x16x32_bf16 v[64:67], v[28:31], v[28:31], v[64:67]
    ds_read_b64_tr_b16 v[24:25], v2 offset:51200
    v_mfma_f32_16x16x32_bf16 v[68:71], v[10:13], v[28:31], v[68:71]
    ds_read_b64_tr_b16 v[26:27], v2 offset:53760
    s_waitcnt lgkmcnt(12)
    v_mfma_f32_16x16x32_bf16 v[72:75], v[128:131], v[32:35], v[72:75]
    ds_read_b64_tr_b16 v[28:29], v2 offset:51232
    v_mfma_f32_16x16x32_bf16 v[76:79], v[32:35], v[32:35], v[76:79]
    ds_read_b64_tr_b16 v[30:31], v2 offset:53792
    v_mfma_f32_16x16x32_bf16 v[80:83], v[10:13], v[32:35], v[80:83]
    s_waitcnt lgkmcnt(12)
    v_mfma_f32_16x16x32_bf16 v[48:51], v[132:135], v[36:39], v[48:51]
    ds_read_b64_tr_b16 v[32:33], v2 offset:51264
    ds_read_b64_tr_b16 v[34:35], v2 offset:53824
    s_waitcnt lgkmcnt(12)
    v_mfma_f32_16x16x32_bf16 v[52:55], v[132:135], v[40:43], v[52:55]
    ds_read_b64_tr_b16 v[36:37], v2 offset:51296
    ds_read_b64_tr_b16 v[38:39], v2 offset:53856
    s_waitcnt lgkmcnt(12)
    v_mfma_f32_16x16x32_bf16 v[56:59], v[132:135], v[44:47], v[56:59]
    ds_read_b64_tr_b16 v[40:41], v2 offset:51328
    ds_read_b64_tr_b16 v[42:43], v2 offset:53888
    s_waitcnt lgkmcnt(12)
    v_mfma_f32_16x16x32_bf16 v[60:63], v[132:135], v[16:19], v[60:63]
    s_waitcnt vmcnt(0)
    s_barrier
    v_mfma_f32_16x16x32_bf16 v[64:67], v[16:19], v[16:19], v[64:67]
    ds_read_b64_tr_b16 v[44:45], v2 offset:56320
    v_mfma_f32_16x16x32_bf16 v[68:71], v[10:13], v[16:19], v[68:71]
    ds_read_b64_tr_b16 v[46:47], v2 offset:58880
    s_waitcnt lgkmcnt(12)
    v_mfma_f32_16x16x32_bf16 v[72:75], v[132:135], v[20:23], v[72:75]
    ds_read_b64_tr_b16 v[16:17], v2 offset:56352
    v_mfma_f32_16x16x32_bf16 v[76:79], v[20:23], v[20:23], v[76:79]
    ds_read_b64_tr_b16 v[18:19], v2 offset:58912
    v_mfma_f32_16x16x32_bf16 v[80:83], v[10:13], v[20:23], v[80:83]
    s_waitcnt lgkmcnt(12)
    v_mfma_f32_16x16x32_bf16 v[48:51], v[136:139], v[24:27], v[48:51]
    ds_read_b64_tr_b16 v[20:21], v2 offset:56384
    ds_read_b64_tr_b16 v[22:23], v2 offset:58944
    s_waitcnt lgkmcnt(12)
    v_mfma_f32_16x16x32_bf16 v[52:55], v[136:139], v[28:31], v[52:55]
    ds_read_b64_tr_b16 v[24:25], v2 offset:56416
    ds_read_b64_tr_b16 v[26:27], v2 offset:58976
    s_waitcnt lgkmcnt(12)
    v_mfma_f32_16x16x32_bf16 v[56:59], v[136:139], v[32:35], v[56:59]
    ds_read_b64_tr_b16 v[28:29], v2 offset:56448
    ds_read_b64_tr_b16 v[30:31], v2 offset:59008
    s_waitcnt lgkmcnt(12)
    v_mfma_f32_16x16x32_bf16 v[60:63], v[136:139], v[36:39], v[60:63]
    ds_read_b64_tr_b16 v[32:33], v3 offset:0
    v_mfma_f32_16x16x32_bf16 v[64:67], v[36:39], v[36:39], v[64:67]
    ds_read_b64_tr_b16 v[34:35], v3 offset:2560
    v_mfma_f32_16x16x32_bf16 v[68:71], v[10:13], v[36:39], v[68:71]
    s_waitcnt lgkmcnt(12)
    v_mfma_f32_16x16x32_bf16 v[72:75], v[136:139], v[40:43], v[72:75]
    ds_read_b64_tr_b16 v[36:37], v3 offset:32
    v_mfma_f32_16x16x32_bf16 v[76:79], v[40:43], v[40:43], v[76:79]
    ds_read_b64_tr_b16 v[38:39], v3 offset:2592
    v_mfma_f32_16x16x32_bf16 v[80:83], v[10:13], v[40:43], v[80:83]
    s_waitcnt lgkmcnt(12)
    v_mfma_f32_16x16x32_bf16 v[48:51], v[140:143], v[44:47], v[48:51]
    ds_read_b64_tr_b16 v[40:41], v3 offset:64
    ds_read_b64_tr_b16 v[42:43], v3 offset:2624
    s_waitcnt lgkmcnt(12)
    v_mfma_f32_16x16x32_bf16 v[52:55], v[140:143], v[16:19], v[52:55]
    ds_read_b64_tr_b16 v[44:45], v3 offset:96
    ds_read_b64_tr_b16 v[46:47], v3 offset:2656
    s_waitcnt lgkmcnt(12)
    v_mfma_f32_16x16x32_bf16 v[56:59], v[140:143], v[20:23], v[56:59]
    ds_read_b64_tr_b16 v[16:17], v3 offset:128
    ds_read_b64_tr_b16 v[18:19], v3 offset:2688
    s_waitcnt lgkmcnt(12)
    v_mfma_f32_16x16x32_bf16 v[60:63], v[140:143], v[24:27], v[60:63]
    ds_read_b64_tr_b16 v[20:21], v3 offset:5120
    v_mfma_f32_16x16x32_bf16 v[64:67], v[24:27], v[24:27], v[64:67]
    ds_read_b64_tr_b16 v[22:23], v3 offset:7680
    v_mfma_f32_16x16x32_bf16 v[68:71], v[10:13], v[24:27], v[68:71]
    s_waitcnt lgkmcnt(12)
    v_mfma_f32_16x16x32_bf16 v[72:75], v[140:143], v[28:31], v[72:75]
    ds_read_b64_tr_b16 v[24:25], v3 offset:5152
    v_mfma_f32_16x16x32_bf16 v[76:79], v[28:31], v[28:31], v[76:79]
    ds_read_b64_tr_b16 v[26:27], v3 offset:7712
    v_mfma_f32_16x16x32_bf16 v[80:83], v[10:13], v[28:31], v[80:83]
    s_waitcnt lgkmcnt(12)
    v_mfma_f32_16x16x32_bf16 v[48:51], v[144:147], v[32:35], v[48:51]
    ds_read_b64_tr_b16 v[28:29], v3 offset:5184
    ds_read_b64_tr_b16 v[30:31], v3 offset:7744
    s_waitcnt lgkmcnt(12)
    v_mfma_f32_16x16x32_bf16 v[52:55], v[144:147], v[36:39], v[52:55]
    ds_read_b64_tr_b16 v[32:33], v3 offset:5216
    ds_read_b64_tr_b16 v[34:35], v3 offset:7776
    s_waitcnt lgkmcnt(12)
    v_mfma_f32_16x16x32_bf16 v[56:59], v[144:147], v[40:43], v[56:59]
    ds_read_b64_tr_b16 v[36:37], v3 offset:5248
    ds_read_b64_tr_b16 v[38:39], v3 offset:7808
    s_waitcnt lgkmcnt(12)
    v_mfma_f32_16x16x32_bf16 v[60:63], v[144:147], v[44:47], v[60:63]
    ds_read_b64_tr_b16 v[40:41], v3 offset:10240
    v_mfma_f32_16x16x32_bf16 v[64:67], v[44:47], v[44:47], v[64:67]
    ds_read_b64_tr_b16 v[42:43], v3 offset:12800
    v_mfma_f32_16x16x32_bf16 v[68:71], v[10:13], v[44:47], v[68:71]
    s_waitcnt lgkmcnt(12)
    v_mfma_f32_16x16x32_bf16 v[72:75], v[144:147], v[16:19], v[72:75]
    ds_read_b64_tr_b16 v[44:45], v3 offset:10272
    v_mfma_f32_16x16x32_bf16 v[76:79], v[16:19], v[16:19], v[76:79]
    ds_read_b64_tr_b16 v[46:47], v3 offset:12832
    v_mfma_f32_16x16x32_bf16 v[80:83], v[10:13], v[16:19], v[80:83]
    s_waitcnt lgkmcnt(12)
    v_mfma_f32_16x16x32_bf16 v[48:51], v[148:151], v[20:23], v[48:51]
    ds_read_b64_tr_b16 v[16:17], v3 offset:10304
    ds_read_b64_tr_b16 v[18:19], v3 offset:12864
    s_waitcnt lgkmcnt(12)
    v_mfma_f32_16x16x32_bf16 v[52:55], v[148:151], v[24:27], v[52:55]
    ds_read_b64_tr_b16 v[20:21], v3 offset:10336
    ds_read_b64_tr_b16 v[22:23], v3 offset:12896
    s_waitcnt lgkmcnt(12)
    v_mfma_f32_16x16x32_bf16 v[56:59], v[148:151], v[28:31], v[56:59]
    ds_read_b64_tr_b16 v[24:25], v3 offset:10368
    ds_read_b64_tr_b16 v[26:27], v3 offset:12928
    s_waitcnt lgkmcnt(12)
    v_mfma_f32_16x16x32_bf16 v[60:63], v[148:151], v[32:35], v[60:63]
    ds_read_b64_tr_b16 v[28:29], v3 offset:15360
    v_mfma_f32_16x16x32_bf16 v[64:67], v[32:35], v[32:35], v[64:67]
    ds_read_b64_tr_b16 v[30:31], v3 offset:17920
    v_mfma_f32_16x16x32_bf16 v[68:71], v[10:13], v[32:35], v[68:71]
    s_waitcnt lgkmcnt(12)
    v_mfma_f32_16x16x32_bf16 v[72:75], v[148:151], v[36:39], v[72:75]
    ds_read_b64_tr_b16 v[32:33], v3 offset:15392
    v_mfma_f32_16x16x32_bf16 v[76:79], v[36:39], v[36:39], v[76:79]
    ds_read_b64_tr_b16 v[34:35], v3 offset:17952
    v_mfma_f32_16x16x32_bf16 v[80:83], v[10:13], v[36:39], v[80:83]
    s_waitcnt lgkmcnt(12)
    v_mfma_f32_16x16x32_bf16 v[48:51], v[152:155], v[40:43], v[48:51]
    ds_read_b64_tr_b16 v[36:37], v3 offset:15424
    ds_read_b64_tr_b16 v[38:39], v3 offset:17984
    s_waitcnt lgkmcnt(12)
    v_mfma_f32_16x16x32_bf16 v[52:55], v[152:155], v[44:47], v[52:55]
    ds_read_b64_tr_b16 v[40:41], v3 offset:15456
    ds_read_b64_tr_b16 v[42:43], v3 offset:18016
    s_waitcnt lgkmcnt(12)
    v_mfma_f32_16x16x32_bf16 v[56:59], v[152:155], v[16:19], v[56:59]
    ds_read_b64_tr_b16 v[44:45], v3 offset:15488
    ds_read_b64_tr_b16 v[46:47], v3 offset:18048
    s_waitcnt lgkmcnt(12)
    v_mfma_f32_16x16x32_bf16 v[60:63], v[152:155], v[20:23], v[60:63]
    ds_read_b64_tr_b16 v[16:17], v3 offset:20480
    v_mfma_f32_16x16x32_bf16 v[64:67], v[20:23], v[20:23], v[64:67]
    ds_read_b64_tr_b16 v[18:19], v3 offset:23040
    v_mfma_f32_16x16x32_bf16 v[68:71], v[10:13], v[20:23], v[68:71]
    s_waitcnt lgkmcnt(12)
    v_mfma_f32_16x16x32_bf16 v[72:75], v[152:155], v[24:27], v[72:75]
    ds_read_b64_tr_b16 v[20:21], v3 offset:20512
    v_mfma_f32_16x16x32_bf16 v[76:79], v[24:27], v[24:27], v[76:79]
    ds_read_b64_tr_b16 v[22:23], v3 offset:23072
    v_mfma_f32_16x16x32_bf16 v[80:83], v[10:13], v[24:27], v[80:83]
    s_waitcnt lgkmcnt(12)
    v_mfma_f32_16x16x32_bf16 v[48:51], v[156:159], v[28:31], v[48:51]
    ds_read_b64_tr_b16 v[24:25], v3 offset:20544
    ds_read_b64_tr_b16 v[26:27], v3 offset:23104
    s_waitcnt lgkmcnt(12)
    v_mfma_f32_16x16x32_bf16 v[52:55], v[156:159], v[32:35], v[52:55]
    ds_read_b64_tr_b16 v[28:29], v3 offset:20576
    ds_read_b64_tr_b16 v[30:31], v3 offset:23136
    s_waitcnt lgkmcnt(12)
    v_mfma_f32_16x16x32_bf16 v[56:59], v[156:159], v[36:39], v[56:59]
    ds_read_b64_tr_b16 v[32:33], v3 offset:20608
    ds_read_b64_tr_b16 v[34:35], v3 offset:23168
    s_waitcnt lgkmcnt(12)
    v_mfma_f32_16x16x32_bf16 v[60:63], v[156:159], v[40:43], v[60:63]
    ds_read_b64_tr_b16 v[36:37], v3 offset:25600
    v_mfma_f32_16x16x32_bf16 v[64:67], v[40:43], v[40:43], v[64:67]
    ds_read_b64_tr_b16 v[38:39], v3 offset:28160
    v_mfma_f32_16x16x32_bf16 v[68:71], v[10:13], v[40:43], v[68:71]
    s_waitcnt lgkmcnt(12)
    v_mfma_f32_16x16x32_bf16 v[72:75], v[156:159], v[44:47], v[72:75]
    ds_read_b64_tr_b16 v[40:41], v3 offset:25632
    v_mfma_f32_16x16x32_bf16 v[76:79], v[44:47], v[44:47], v[76:79]
    ds_read_b64_tr_b16 v[42:43], v3 offset:28192
    v_mfma_f32_16x16x32_bf16 v[80:83], v[10:13], v[44:47], v[80:83]
    s_waitcnt lgkmcnt(12)
    v_mfma_f32_16x16x32_bf16 v[48:51], v[160:163], v[16:19], v[48:51]
    ds_read_b64_tr_b16 v[44:45], v3 offset:25664
    ds_read_b64_tr_b16 v[46:47], v3 offset:28224
    s_waitcnt lgkmcnt(12)
    v_mfma_f32_16x16x32_bf16 v[52:55], v[160:163], v[20:23], v[52:55]
    ds_read_b64_tr_b16 v[16:17], v3 offset:25696
    ds_read_b64_tr_b16 v[18:19], v3 offset:28256
    s_waitcnt lgkmcnt(12)
    v_mfma_f32_16x16x32_bf16 v[56:59], v[160:163], v[24:27], v[56:59]
    ds_read_b64_tr_b16 v[20:21], v3 offset:25728
    ds_read_b64_tr_b16 v[22:23], v3 offset:28288
    s_waitcnt lgkmcnt(12)
    v_mfma_f32_16x16x32_bf16 v[60:63], v[160:163], v[28:31], v[60:63]
    ds_read_b64_tr_b16 v[24:25], v3 offset:30720
    v_mfma_f32_16x16x32_bf16 v[64:67], v[28:31], v[28:31], v[64:67]
    ds_read_b64_tr_b16 v[26:27], v3 offset:33280
    v_mfma_f32_16x16x32_bf16 v[68:71], v[10:13], v[28:31], v[68:71]
    s_waitcnt lgkmcnt(12)
    v_mfma_f32_16x16x32_bf16 v[72:75], v[160:163], v[32:35], v[72:75]
    ds_read_b64_tr_b16 v[28:29], v3 offset:30752
    v_mfma_f32_16x16x32_bf16 v[76:79], v[32:35], v[32:35], v[76:79]
    ds_read_b64_tr_b16 v[30:31], v3 offset:33312
    v_mfma_f32_16x16x32_bf16 v[80:83], v[10:13], v[32:35], v[80:83]
    s_waitcnt lgkmcnt(12)
    v_mfma_f32_16x16x32_bf16 v[48:51], v[164:167], v[36:39], v[48:51]
    ds_read_b64_tr_b16 v[32:33], v3 offset:30784
    ds_read_b64_tr_b16 v[34:35], v3 offset:33344
    s_waitcnt lgkmcnt(12)
    v_mfma_f32_16x16x32_bf16 v[52:55], v[164:167], v[40:43], v[52:55]
    ds_read_b64_tr_b16 v[36:37], v3 offset:30816
    ds_read_b64_tr_b16 v[38:39], v3 offset:33376
    s_waitcnt lgkmcnt(12)
    v_mfma_f32_16x16x32_bf16 v[56:59], v[164:167], v[44:47], v[56:59]
    ds_read_b64_tr_b16 v[40:41], v3 offset:30848
    ds_read_b64_tr_b16 v[42:43], v3 offset:33408
    s_waitcnt lgkmcnt(12)
    v_mfma_f32_16x16x32_bf16 v[60:63], v[164:167], v[16:19], v[60:63]
    ds_read_b64_tr_b16 v[44:45], v3 offset:35840
    v_mfma_f32_16x16x32_bf16 v[64:67], v[16:19], v[16:19], v[64:67]
    ds_read_b64_tr_b16 v[46:47], v3 offset:38400
    v_mfma_f32_16x16x32_bf16 v[68:71], v[10:13], v[16:19], v[68:71]
    s_waitcnt lgkmcnt(12)
    v_mfma_f32_16x16x32_bf16 v[72:75], v[164:167], v[20:23], v[72:75]
    ds_read_b64_tr_b16 v[16:17], v3 offset:35872
    v_mfma_f32_16x16x32_bf16 v[76:79], v[20:23], v[20:23], v[76:79]
    ds_read_b64_tr_b16 v[18:19], v3 offset:38432
    v_mfma_f32_16x16x32_bf16 v[80:83], v[10:13], v[20:23], v[80:83]
    s_waitcnt lgkmcnt(12)
    v_mfma_f32_16x16x32_bf16 v[48:51], v[168:171], v[24:27], v[48:51]
    ds_read_b64_tr_b16 v[20:21], v3 offset:35904
    ds_read_b64_tr_b16 v[22:23], v3 offset:38464
    s_waitcnt lgkmcnt(12)
    v_mfma_f32_16x16x32_bf16 v[52:55], v[168:171], v[28:31], v[52:55]
    ds_read_b64_tr_b16 v[24:25], v3 offset:35936
    ds_read_b64_tr_b16 v[26:27], v3 offset:38496
    s_waitcnt lgkmcnt(12)
    v_mfma_f32_16x16x32_bf16 v[56:59], v[168:171], v[32:35], v[56:59]
    ds_read_b64_tr_b16 v[28:29], v3 offset:35968
    ds_read_b64_tr_b16 v[30:31], v3 offset:38528
    s_waitcnt lgkmcnt(12)
    v_mfma_f32_16x16x32_bf16 v[60:63], v[168:171], v[36:39], v[60:63]
    v_mfma_f32_16x16x32_bf16 v[64:67], v[36:39], v[36:39], v[64:67]
    v_mfma_f32_16x16x32_bf16 v[68:71], v[10:13], v[36:39], v[68:71]
    s_waitcnt lgkmcnt(10)
    v_mfma_f32_16x16x32_bf16 v[72:75], v[168:171], v[40:43], v[72:75]
    v_mfma_f32_16x16x32_bf16 v[76:79], v[40:43], v[40:43], v[76:79]
    v_mfma_f32_16x16x32_bf16 v[80:83], v[10:13], v[40:43], v[80:83]
    s_waitcnt lgkmcnt(8)
    v_mfma_f32_16x16x32_bf16 v[48:51], v[172:175], v[44:47], v[48:51]
    s_waitcnt lgkmcnt(6)
    v_mfma_f32_16x16x32_bf16 v[52:55], v[172:175], v[16:19], v[52:55]
    s_waitcnt lgkmcnt(4)
    v_mfma_f32_16x16x32_bf16 v[56:59], v[172:175], v[20:23], v[56:59]
    s_waitcnt lgkmcnt(2)
    v_mfma_f32_16x16x32_bf16 v[60:63], v[172:175], v[24:27], v[60:63]
    v_mfma_f32_16x16x32_bf16 v[64:67], v[24:27], v[24:27], v[64:67]
    v_mfma_f32_16x16x32_bf16 v[68:71], v[10:13], v[24:27], v[68:71]
    s_waitcnt lgkmcnt(0)
    v_mfma_f32_16x16x32_bf16 v[72:75], v[172:175], v[28:31], v[72:75]
    v_mfma_f32_16x16x32_bf16 v[76:79], v[28:31], v[28:31], v[76:79]
    v_mfma_f32_16x16x32_bf16 v[80:83], v[10:13], v[28:31], v[80:83]
    ds_read_b64 v[10:11], v7
    ds_read_b64 v[12:13], v8
    ds_read_b64 v[14:15], v9
    v_and_b32 v16, 15, v1
    v_lshrrev_b32 v17, 4, v1
    v_and_b32 v18, 3, v1
    v_lshrrev_b32 v19, 2, v16
    v_cmp_eq_u32 s[42:43], 1, v18
    v_cmp_eq_u32 s[44:45], 2, v18
    v_cmp_eq_u32 s[46:47], 3, v18
    v_cmp_eq_u32 s[54:55], v19, v17
    v_lshlrev_b32 v18, 3, v16
    v_add_u32 v18, 45376, v18
    v_cndmask_b32 v64, v64, v65, s[42:43]
    v_cndmask_b32 v76, v76, v77, s[42:43]
    v_cndmask_b32 v64, v64, v66, s[44:45]
    v_cndmask_b32 v76, v76, v78, s[44:45]
    v_cndmask_b32 v64, v64, v67, s[46:47]
    v_cndmask_b32 v76, v76, v79, s[46:47]
    v_mul_f32 v68, 0x3acccccd, v68
    v_mul_f32 v64, 0x3acccccd, v64
    v_mul_f32 v80, 0x3acccccd, v80
    v_mul_f32 v76, 0x3acccccd, v76
    v_fma_f32 v64, -v68, v68, v64
    v_fma_f32 v76, -v80, v80, v76
    v_max_f32 v64, 0, v64
    v_max_f32 v76, 0, v76
    v_cvt_pk_bf16_f32 v68, v68, v64
    v_cvt_pk_bf16_f32 v80, v80, v76
    v_and_b32 v64, 0xffff0000, v68
    v_lshlrev_b32 v68, 16, v68
    v_and_b32 v76, 0xffff0000, v80
    v_lshlrev_b32 v80, 16, v80
    v_add_f32 v64, 0x3727c5ac, v64
    v_add_f32 v76, 0x3727c5ac, v76
    v_cvt_pk_bf16_f32 v64, v64, v64
    v_cvt_pk_bf16_f32 v76, v76, v76
    v_lshlrev_b32 v64, 16, v64
    v_lshlrev_b32 v76, 16, v76
    v_sqrt_f32 v64, v64
    v_sqrt_f32 v76, v76
    v_cvt_pk_bf16_f32 v64, v64, v64
    v_cvt_pk_bf16_f32 v76, v76, v76
    v_lshlrev_b32 v64, 16, v64
    v_lshlrev_b32 v76, 16, v76
    v_rcp_f32 v69, v64
    v_rcp_f32 v81, v76
    s_mov_b64 exec, s[54:55]
    ds_write_b64 v18, v[68:69] offset:384
    ds_write_b64 v18, v[80:81] offset:512
    s_mov_b64 exec, -1
    s_lshl_b32 s42, s3, 7
    s_add_u32 s42, s42, 46016
    v_lshl_add_u32 v19, v17, 4, s42
    s_lshl_b32 s42, s3, 6
    s_cmp_eq_u32 s3, 2
    s_cselect_b32 s42, 192, s42
    s_cmp_eq_u32 s3, 3
    s_cselect_b32 s42, 128, s42
    s_add_u32 s42, s42, 61440
    v_mul_u32_u24 v20, 496, v16
    v_and_b32 v21, 1, v17
    v_lshl_add_u32 v20, v21, 4, v20
    v_lshrrev_b32 v21, 1, v17
    v_lshl_add_u32 v20, v21, 3, v20
    v_add_u32 v20, s42, v20
    v_lshlrev_b32 v18, 3, v16
    v_add_u32 v18, 45376, v18
    s_waitcnt lgkmcnt(0)
    s_barrier
    ds_read_b64 v[24:25], v18 offset:0
    ds_read_b64 v[26:27], v18 offset:128
    ds_read_b64 v[28:29], v18 offset:256
    ds_read_b64 v[30:31], v18 offset:384
    ds_read_b64 v[32:33], v18 offset:512
    ds_read_b128 v[36:39], v19 offset:0
    s_waitcnt lgkmcnt(0)
    v_fma_f32 v48, -v24, v36, v48
    v_fma_f32 v49, -v24, v37, v49
    v_fma_f32 v50, -v24, v38, v50
    v_fma_f32 v51, -v24, v39, v51
    v_fma_f32 v52, -v26, v36, v52
    v_fma_f32 v53, -v26, v37, v53
    v_fma_f32 v54, -v26, v38, v54
    v_fma_f32 v55, -v26, v39, v55
    v_fma_f32 v56, -v28, v36, v56
    v_fma_f32 v57, -v28, v37, v57
    v_fma_f32 v58, -v28, v38, v58
    v_fma_f32 v59, -v28, v39, v59
    v_fma_f32 v60, -v30, v36, v60
    v_fma_f32 v61, -v30, v37, v61
    v_fma_f32 v62, -v30, v38, v62
    v_fma_f32 v63, -v30, v39, v63
    v_fma_f32 v72, -v32, v36, v72
    v_fma_f32 v73, -v32, v37, v73
    v_fma_f32 v74, -v32, v38, v74
    v_fma_f32 v75, -v32, v39, v75
    v_mul_f32 v48, v48, v25
    v_mul_f32 v49, v49, v25
    v_mul_f32 v50, v50, v25
    v_mul_f32 v51, v51, v25
    v_mul_f32 v52, v52, v27
    v_mul_f32 v53, v53, v27
    v_mul_f32 v54, v54, v27
    v_mul_f32 v55, v55, v27
    v_mul_f32 v56, v56, v29
    v_mul_f32 v57, v57, v29
    v_mul_f32 v58, v58, v29
    v_mul_f32 v59, v59, v29
    v_mul_f32 v60, v60, v31
    v_mul_f32 v61, v61, v31
    v_mul_f32 v62, v62, v31
    v_mul_f32 v63, v63, v31
    v_mul_f32 v72, v72, v33
    v_mul_f32 v73, v73, v33
    v_mul_f32 v74, v74, v33
    v_mul_f32 v75, v75, v33
    v_permlane32_swap_b32 v48, v50
    v_permlane32_swap_b32 v49, v51
    v_permlane32_swap_b32 v52, v54
    v_permlane32_swap_b32 v53, v55
    v_permlane32_swap_b32 v56, v58
    v_permlane32_swap_b32 v57, v59
    v_permlane32_swap_b32 v60, v62
    v_permlane32_swap_b32 v61, v63
    v_permlane32_swap_b32 v72, v74
    v_permlane32_swap_b32 v73, v75
    v_cvt_pk_bf16_f32 v48, v48, v50
    v_cvt_pk_bf16_f32 v49, v49, v51
    ds_write_b64 v20, v[48:49] offset:0
    v_cvt_pk_bf16_f32 v52, v52, v54
    v_cvt_pk_bf16_f32 v53, v53, v55
    ds_write_b64 v20, v[52:53] offset:7936
    v_cvt_pk_bf16_f32 v56, v56, v58
    v_cvt_pk_bf16_f32 v57, v57, v59
    ds_write_b64 v20, v[56:57] offset:15872
    v_cvt_pk_bf16_f32 v60, v60, v62
    v_cvt_pk_bf16_f32 v61, v61, v63
    ds_write_b64 v20, v[60:61] offset:23808
    v_cvt_pk_bf16_f32 v72, v72, v74
    v_cvt_pk_bf16_f32 v73, v73, v75
    ds_write_b64 v20, v[72:73] offset:31744
    s_branch L_a1_post
L_final:
    s_mul_i32 s42, s2, 205
    s_lshr_b32 s42, s42, 11
    s_mul_i32 s43, s42, 10
    s_sub_u32 s43, s2, s43
    s_lshl_b32 s44, s43, 18
    s_lshl_b32 s45, s42, 8
    s_add_u32 s44, s44, s45
    s_lshl_b32 s45, s3, 15
    s_add_u32 s44, s44, s45
    s_add_u32 s44, s44, 22544384
    v_and_b32 v2, 15, v1
    v_lshrrev_b32 v3, 4, v1
    v_lshlrev_b32 v4, 12, v3
    v_lshl_add_u32 v4, v2, 4, v4
    v_add_u32 v4, s44, v4
    v_add_u32 v5, 16384, v4
    s_lshl_b32 s44, s3, 5
    s_add_u32 s44, s44, 61440
    v_lshrrev_b32 v6, 2, v2
    v_lshl_add_u32 v6, v3, 3, v6
    v_lshlrev_b32 v6, 8, v6
    v_and_b32 v7, 3, v1
    v_lshl_add_u32 v6, v7, 3, v6
    v_add_u32 v6, s44, v6
    s_lshl_b32 s44, s42, 3
    s_add_u32 s44, s44, s3
    s_mul_i32 s44, s44, 20480
    s_lshl_b32 s45, s43, 7
    s_add_u32 s44, s44, s45
    v_and_b32 v7, 7, v2
    v_mul_u32_u24 v7, 1280, v7
    v_lshl_add_u32 v7, v3, 4, v7
    v_and_b32 v9, 8, v2
    v_lshl_add_u32 v7, v9, 3, v7
    v_add_u32 v7, s44, v7
    v_add_u32 v9, 10240, v7
    s_lshl_b32 s46, s3, 11
    s_mul_i32 s44, s43, 13120
    s_lshr_b32 s44, s44, 10
    s_lshl_b32 s44, s44, 1
    v_min_u32 v8, 27, v1
    v_add_u32 v8, s44, v8
    v_min_u32 v8, 255, v8
    v_lshlrev_b32 v8, 7, v8
    v_add_u32 v8, 200704, v8
    s_lshl_b32 s44, s14, 7
    s_add_u32 s44, s44, 200704
    s_waitcnt vmcnt(0)
    s_barrier
    s_cmp_eq_u32 s3, 0
    s_cbranch_scc0 L_f_np
    v_lshl_add_u32 v24, v1, 4, s44
    v_mov_b32 v28, s34
    v_mov_b32 v29, s35
    v_mov_b32 v30, s34
    v_mov_b32 v31, s35
    s_mov_b64 exec, 0xff
    global_store_dwordx4 v24, v[28:31], s[32:33] sc1
    s_mov_b64 exec, -1
L_f_np:
    s_cmp_ge_u32 s2, 160
    s_cbranch_scc1 L_fin
    s_cmp_eq_u32 s3, 0
    s_cbranch_scc0 L_f_go
    s_mov_b32 s57, 0
L_poll18:
    s_sleep 4
    global_load_dwordx2 v[10:11], v8, s[32:33] sc1
    s_add_u32 s57, s57, 1
    s_waitcnt vmcnt(0)
    v_cmp_ne_u64 vcc, s[34:35], v[10:11]
    s_cmp_gt_u32 s57, 200000
    s_nop 2
    s_cbranch_scc1 L_end
    s_cbranch_vccnz L_poll18
L_f_go:
    s_barrier
    s_add_u32 m0, s46, 61440
    s_nop 0
    global_load_lds_dwordx4 v4, s[32:33] sc1
    s_add_u32 m0, s46, 62464
    s_nop 0
    global_load_lds_dwordx4 v5, s[32:33] sc1
    s_waitcnt vmcnt(0)
    s_barrier
    ds_read_b64_tr_b16 v[12:13], v6
    ds_read_b64_tr_b16 v[14:15], v6 offset:1024
    ds_read_b64_tr_b16 v[16:17], v6 offset:8192
    ds_read_b64_tr_b16 v[18:19], v6 offset:9216
    s_waitcnt lgkmcnt(0)
    v_mov_b32 v20, v12
    v_mov_b32 v21, v13
    v_mov_b32 v22, v14
    v_mov_b32 v23, v15
    v_mov_b32_dpp v12, v16 row_ror:8 row_mask:0xf bank_mask:0xc
    v_mov_b32_dpp v13, v17 row_ror:8 row_mask:0xf bank_mask:0xc
    v_mov_b32_dpp v14, v18 row_ror:8 row_mask:0xf bank_mask:0xc
    v_mov_b32_dpp v15, v19 row_ror:8 row_mask:0xf bank_mask:0xc
    v_mov_b32_dpp v16, v20 row_ror:8 row_mask:0xf bank_mask:0x3
    v_mov_b32_dpp v17, v21 row_ror:8 row_mask:0xf bank_mask:0x3
    v_mov_b32_dpp v18, v22 row_ror:8 row_mask:0xf bank_mask:0x3
    v_mov_b32_dpp v19, v23 row_ror:8 row_mask:0xf bank_mask:0x3
    global_store_dwordx4 v7, v[12:15], s[28:29]
    global_store_dwordx4 v9, v[16:19], s[28:29]
L_fin:
    s_or_b32 s42, s2, s3
    s_cmp_eq_u32 s42, 0
    s_cbranch_scc0 L_fin2
    s_mov_b32 s42, 0
    v_lshl_add_u32 v2, v1, 4, s42
    v_mov_b32 v4, s34
    v_mov_b32 v5, s35
    v_mov_b32 v6, s34
    v_mov_b32 v7, s35
    s_mov_b64 exec, 0xff
    global_store_dwordx4 v2, v[4:7], s[32:33] sc1
    s_mov_b64 exec, -1
L_fin2:
L_end:
    s_endpgm
.p2align 7
L_tab1:
.short 3072, 3072, 3072, 3072, 3072, 3072, 3072, 3072, 3072, 3072, 3072, 3072, 3072, 3072, 3072, 3072
.short 3072, 3072, 3072, 3072, 3072, 3072, 3072, 3072, 3072, 3072, 3072, 3072, 2048, 2048, 3072, 3072
.short 3072, 3072, 3072, 3072, 3072, 3072, 3072, 3072, 3072, 3072, 3072, 3072, 3072, 3072, 3072, 3072
.short 3072, 3072, 3072, 3072, 3072, 3072, 3072, 3072, 3072, 3072, 3072, 3072, 3072, 3072, 1536, 1536
.short 1536, 1536, 1532, 1528, 1528, 1528, 1524, 1520, 1520, 1520, 1516, 1512, 1512, 1512, 1508, 1504
.short 1504, 1504, 1500, 1496, 1496, 1496, 1492, 1488, 1488, 1488, 1484, 1480, 1480, 1480, 1476, 1472
.short 1472, 1472, 1468, 1464, 1464, 1464, 1460, 1456, 1456, 1456, 1452, 1448, 1448, 1448, 1444, 1440
.short 1440, 1440, 1436, 1432, 1432, 1432, 1428, 1424, 1424, 1424, 1420, 1416, 1416, 1416, 1412, 1408
.short 1408, 1408, 1404, 1400, 1400, 1400, 1396, 1392, 1392, 1392, 1388, 1384, 1384, 1384, 1380, 1376
.short 1376, 1376, 1372, 1368, 1368, 1368, 1364, 1360, 1360, 1360, 1356, 1352, 1352, 1352, 1348, 1344
.short 1344, 1344, 1340, 1336, 1336, 1336, 1332, 1328, 1328, 1328, 1324, 1320, 1320, 1320, 1316, 1312
.short 1312, 1312, 1308, 1304, 1304, 1304, 1300, 1296, 1296, 1296, 1292, 1288, 1288, 1288, 1284, 1280
.short 1280, 1280, 1276, 1272, 1272, 1272, 1268, 1264, 1264, 1264, 1260, 1256, 1256, 1256, 1252, 1248
.short 1248, 1248, 1244, 1240, 1240, 1240, 1236, 1232, 1232, 1232, 1228, 1224, 1224, 1224, 1220, 1216
.short 1216, 1216, 1212, 1208, 1208, 1208, 1204, 1200, 1200, 1200, 1196, 1192, 1192, 1192, 1188, 1184
.short 1184, 1184, 1180, 1176, 1176, 1176, 1172, 1168, 1168, 1168, 1164, 1160, 1160, 1160, 1156, 1152
.short 1152, 1152, 1148, 1144, 1144, 1144, 1140, 1136, 1136, 1136, 1132, 1128, 1128, 1128, 1124, 1120
.short 1120, 1120, 1116, 1112, 1112, 1112, 1108, 1104, 1104, 1104, 1100, 1096, 1096, 1096, 1092, 1088
.short 1088, 1088, 1084, 1080, 1080, 1080, 1076, 1072, 1072, 1072, 1068, 1064, 1064, 1064, 1060, 1056
.short 1056, 1056, 1052, 1048, 1048, 1048, 1044, 1040, 1040, 1040, 1036, 1032, 1032, 1032, 1028, 1024
.short 1024, 1020, 1016, 1012, 1008, 764, 760, 756, 752, 1004, 1000, 996, 992, 748, 744, 740
.short 736, 988, 984, 980, 976, 732, 728, 724, 720, 972, 968, 964, 960, 716, 712, 708
.short 704, 956, 952, 948, 944, 700, 696, 692, 688, 940, 936, 932, 928, 684, 680, 676
.short 672, 924, 920, 916, 912, 668, 664, 660, 656, 908, 904, 900, 896, 652, 648, 644
.short 640, 892, 888, 884, 880, 636, 632, 628, 624, 876, 872, 868, 864, 620, 616, 612
.short 608, 860, 856, 852, 848, 604, 600, 596, 592, 844, 840, 836, 832, 588, 584, 580
.short 576, 828, 824, 820, 816, 572, 568, 564, 560, 812, 808, 804, 800, 556, 552, 548
.short 544, 796, 792, 788, 784, 540, 536, 532, 528, 780, 776, 772, 768, 524, 520, 516
.short 512, 508, 504, 500, 496, 252, 248, 244, 240, 492, 488, 484, 480, 236, 232, 228
.short 224, 476, 472, 468, 464, 220, 216, 212, 208, 460, 456, 452, 448, 204, 200, 196
.short 192, 444, 440, 436, 432, 188, 184, 180, 176, 428, 424, 420, 416, 172, 168, 164
.short 160, 412, 408, 404, 400, 156, 152, 148, 144, 396, 392, 388, 384, 140, 136, 132
.short 128, 380, 376, 372, 368, 124, 120, 116, 112, 364, 360, 356, 352, 108, 104, 100
.short 96, 348, 344, 340, 336, 92, 88, 84, 80, 332, 328, 324, 320, 76, 72, 68
.short 64, 316, 312, 308, 304, 60, 56, 52, 48, 300, 296, 292, 288, 44, 40, 36
.short 32, 284, 280, 276, 272, 28, 24, 20, 16, 268, 264, 260, 256, 12, 8, 4
.short 0, 3072, 3072, 3072, 3072, 3072, 3072, 3072, 3072, 3072, 3072, 3072, 3072, 3072, 3072, 3072
.short 3072, 3072, 3072, 3072, 3072, 3072, 3072, 3072, 3072, 2560, 2540, 2508, 2476, 2444, 2412, 2380
.short 2348, 2316, 2536, 2504, 2472, 2440, 2408, 2376, 2344, 2312, 2532, 2500, 2468, 2436, 2404, 2372
.short 2340, 2308, 2528, 2496, 2464, 2432, 2400, 2368, 2336, 2304, 2284, 2252, 2220, 2188, 2156, 2124
.short 2092, 2060, 2280, 2248, 2216, 2184, 2152, 2120, 2088, 2056, 2276, 2244, 2212, 2180, 2148, 2116
.short 2084, 2052, 2272, 2240, 2208, 2176, 2144, 2112, 2080, 3072, 3072, 3072, 3072, 3072, 3072, 3072
.short 3072, 3072, 3072, 3072, 3072, 3072, 3072, 3072, 3072, 3072, 3072, 3072, 3072, 3072, 3072, 3072
.short 3072, 3072, 3072, 3072, 3072, 3072, 3072, 3072, 3072, 3072, 3072, 3072, 3072, 3072, 3072, 3072
.short 3072, 2556, 2524, 2492, 2460, 2428, 2396, 2364, 2332, 2552, 2520, 2488, 2456, 2424, 2392, 2360
.short 2328, 2548, 2516, 2484, 2452, 2420, 2388, 2356, 2324, 2544, 2512, 2480, 2448, 2416, 2384, 2352
.short 2320, 2300, 2268, 2236, 2204, 2172, 2140, 2108, 2076, 2296, 2264, 2232, 2200, 2168, 2136, 2104
.short 2072, 2292, 2260, 2228, 2196, 2164, 2132, 2100, 2068, 2288, 2256, 2224, 2192, 2160, 2128, 2096
.short 2064, 3072, 3072, 3072, 3072, 3072, 3072, 3072, 3072, 3072, 3072, 3072, 3072, 3072, 3072, 3072
.short 3072, 3072, 3072, 3072, 3072, 3072, 3072, 3072, 3072, 3072, 3072, 3072, 3072, 3072, 3072, 3072
.short 3072, 3072, 3072, 3072, 3072, 3072, 3072, 3072, 3072, 3072, 3072, 3072, 3072, 3072, 3072, 3072
.short 3072, 3072, 3072, 3072, 3072, 3072, 3072, 3072, 3072, 3072, 3072, 3072, 3072, 3072, 3072, 3072
.short 3072, 3072, 3072, 3072, 3072, 3072, 3072, 3072, 3072, 3072, 2048, 2040, 2024, 2008, 1992, 1976
.short 1960, 1944, 1928, 1912, 1896, 1880, 1864, 1848, 1832, 1816, 1800, 2032, 2016, 2000, 1984, 1968
.short 1952, 1936, 1920, 1904, 1888, 1872, 1856, 1840, 1824, 1808, 1792, 1784, 1768, 1752, 1736, 1720
.short 1704, 1688, 1672, 1656, 1640, 1624, 1608, 1592, 1576, 1560, 1544, 1776, 1760, 1744, 1728, 1712
.short 1696, 1680, 1664, 1648, 1632, 1616, 1600, 1584, 1568, 1552, 3072, 3072, 3072, 3072, 3072, 3072
.short 3072, 3072, 3072, 3072, 3072, 3072, 3072, 3072, 3072, 3072, 3072, 3072, 3072, 3072, 3072, 3072
.short 3072, 3072, 3072, 3072, 3072, 3072, 3072, 3072, 3072, 3072, 3072, 3072, 3072, 3072, 3072, 3072
.short 3072, 3072, 3072, 3072, 3072, 3072, 3072, 3072, 3072, 3072, 3072, 3072, 3072, 3072, 3072, 3072
.short 3072, 3072, 3072, 3072, 3072, 3072, 3072, 3072, 3072, 3072, 3072, 3072, 3072, 3072, 3072, 3072
.short 3072, 3072, 2044, 2028, 2012, 1996, 1980, 1964, 1948, 1932, 1916, 1900, 1884, 1868, 1852, 1836
.short 1820, 1804, 2036, 2020, 2004, 1988, 1972, 1956, 1940, 1924, 1908, 1892, 1876, 1860, 1844, 1828
.short 1812, 1796, 1788, 1772, 1756, 1740, 1724, 1708, 1692, 1676, 1660, 1644, 1628, 1612, 1596, 1580
.short 1564, 1548, 1780, 1764, 1748, 1732, 1716, 1700, 1684, 1668, 1652, 1636, 1620, 1604, 1588, 1572
.short 1556, 1540, 3072, 3072, 3072, 3072, 3072, 3072, 3072, 3072, 3072, 3072, 3072, 3072, 3072, 3072
.short 3072, 3072, 3072, 3072, 3072, 3072, 3072, 3072, 3072, 3072, 3072, 3072, 3072, 3072, 3072, 3072
.short 3072, 3072, 3072, 3072, 3072, 3072, 3072, 3072, 3072, 3072, 3072, 3072, 3072, 3072, 3072, 3072
L_tab2:
.long 16, 1048608, 2097200, 3145792, 4194384, 5242976, 6291568, 7340160
.long 8388752, 9437344, 10485936, 11534528, 12583120, 13631712, 14680304, 15728896
.long 16777488, 17826080, 18874672, 19923264, 20971856, 22020448, 23069040, 24117632
.long 25166224, 26214816, 27263408, 28312000, 29360592, 30409184, 31457776, 32506368
.long 33554960, 34603552, 35652144, 36700736, 37749328, 38797920, 39846512, 40895104
.long 41943696, 42992288, 44040880, 45089472, 46138064, 47186656, 48235248, 49283840
.long 50332432, 51381024, 52429616, 53478208, 54526800, 55575392, 56623984, 57672576
.long 58721168, 59769760, 60818352, 61866944, 62915536, 63964128, 65012720, 66061312
.long 67109904, 68158496, 69207088, 70255680, 71304272, 72352864, 73401456, 74450048
.long 75498640, 76547264, 88081808, 77595856, 89130400, 78644448, 90178992, 79693040
.long 91227584, 80741632, 92276176, 81790224, 93324768, 82838816, 94373360, 83887408
.long 95421952, 84936000, 96470544, 85984592, 97519136, 87033184, 98567728, 104859920
.long 105908512, 106957104, 108005696, 109054288, 110102880, 111151472, 112200064, 113248656
.long 114297248, 115345840, 116394432, 117443024, 118491616, 119540208, 120588800, 121637392
.long 122685984, 123734576, 124783168, 125831760, 126880352, 127928944, 128977536, 130026128
.long 131074720, 132123312, 133171904, 134220496, 135269088, 136317680, 137366272, 138414864
.long 139463456, 140512048, 141560640, 142609232, 143657824, 144706416, 145755008, 146803600
.long 147852192, 148900784, 149949376, 150997968, 152046560, 153095152, 154143744, 155192336
.long 156240928, 157289520, 158338112, 159386704, 160435296, 161483888, 162532480, 163581072
.long 164629664, 165678256, 166726848, 167775440, 168824032, 169872624, 170921216, 171969808
.long 173018400, 174066992, 175115584, 176164176, 177212768, 178261360, 179309952, 180358544
.long 181407168, 192941712, 182455760, 193990304, 183504352, 195038896, 184552944, 196087488
.long 185601536, 197136080, 186650128, 198184672, 187698720, 199233264, 188747312, 200281856
.long 189795904, 201330448, 190844496, 202379040, 191893088, 203427632, 209715212, 210763804
.long 211812396, 212860988, 213909580, 214958172, 216006764, 217055356, 218103948, 219152540
.long 220201132, 221249724, 222298316, 223346908, 224395500, 225444092, 226492684, 227541276
.long 228589868, 229638460, 230687052, 231735644, 232784236, 233832828, 234881420, 235930012
.long 236978604, 238027196, 239075788, 240124380, 241172972, 242221564, 243270156, 244318748
.long 245367340, 246415932, 247464524, 248513116, 249561708, 250610300, 251658892, 252707484
.long 253756076, 254804668, 255853260, 256901852, 257950444, 258999036, 260047628, 261096220
.long 262144812, 263193404, 264241996, 265290588, 266339180, 267387772, 268436364, 269484956
.long 270533548, 271582140, 272630732, 273679324, 274727916, 275776508, 276825100, 277873692
.long 278922284, 279970876, 281019468, 282068060, 283116652, 284165244, 285213836, 286262460
.long 297797004, 287311052, 298845596, 288359644, 299894188, 289408236, 300942780, 290456828
.long 301991372, 291505420, 303039964, 292554012, 304088556, 293602604, 305137148, 294651196
.long 306185740, 295699788, 307234332, 296748380, 308282924, 314575116, 315623708, 316672300
.long 317720892, 318769484, 319818076, 320866668, 321915260, 322963852, 324012444, 325061036
.long 326109628, 327158220, 328206812, 329255404, 330303996, 331352588, 332401180, 333449772
.long 334498364, 335546956, 336595548, 337644140, 338692732, 339741324, 340789916, 341838508
.long 342887100, 343935692, 344984284, 346032876, 347081468, 348130060, 349178652, 350227244
.long 351275836, 352324428, 353373020, 354421612, 355470204, 356518796, 357567388, 358615980
.long 359664572, 360713164, 361761756, 362810348, 363858940, 364907532, 365956124, 367004716
.long 368053308, 369101900, 370150492, 371199084, 372247676, 373296268, 374344860, 375393452
.long 376442044, 377490636, 378539228, 379587820, 380636412, 381685004, 382733596, 383782188
.long 384830780, 385879372, 386927964, 387976556, 389025148, 390073740, 391122364, 402656908
.long 392170956, 403705500, 393219548, 404754092, 394268140, 405802684, 395316732, 406851276
.long 396365324, 407899868, 397413916, 408948460, 398462508, 409997052, 399511100, 411045644
.long 400559692, 412094236, 401608284, 413142828, 419430408, 420479000, 421527592, 422576184
.long 423624776, 424673368, 425721960, 426770552, 427819144, 428867736, 429916328, 430964920
.long 432013512, 433062104, 434110696, 435159288, 436207880, 437256472, 438305064, 439353656
.long 440402248, 441450840, 442499432, 443548024, 444596616, 445645208, 446693800, 447742392
.long 448790984, 449839576, 450888168, 451936760, 452985352, 454033944, 455082536, 456131128
.long 457179720, 458228312, 459276904, 460325496, 461374088, 462422680, 463471272, 464519864
.long 465568456, 466617048, 467665640, 468714232, 469762824, 470811416, 471860008, 472908600
.long 473957192, 475005784, 476054376, 477102968, 478151560, 479200152, 480248744, 481297336
.long 482345928, 483394520, 484443112, 485491704, 486540296, 487588888, 488637480, 489686072
.long 490734664, 491783256, 492831848, 493880440, 494929032, 495977656, 507512200, 497026248
.long 508560792, 498074840, 509609384, 499123432, 510657976, 500172024, 511706568, 501220616
.long 512755160, 502269208, 513803752, 503317800, 514852344, 504366392, 515900936, 505414984
.long 516949528, 506463576, 517998120, 524290312, 525338904, 526387496, 527436088, 528484680
.long 529533272, 530581864, 531630456, 532679048, 533727640, 534776232, 535824824, 536873416
.long 537922008, 538970600, 540019192, 541067784, 542116376, 543164968, 544213560, 545262152
.long 546310744, 547359336, 548407928, 549456520, 550505112, 551553704, 552602296, 553650888
.long 554699480, 555748072, 556796664, 557845256, 558893848, 559942440, 560991032, 562039624
.long 563088216, 564136808, 565185400, 566233992, 567282584, 568331176, 569379768, 570428360
.long 571476952, 572525544, 573574136, 574622728, 575671320, 576719912, 577768504, 578817096
.long 579865688, 580914280, 581962872, 583011464, 584060056, 585108648, 586157240, 587205832
.long 588254424, 589303016, 590351608, 591400200, 592448792, 593497384, 594545976, 595594568
.long 596643160, 597691752, 598740344, 599788936, 600837560, 612372104, 601886152, 613420696
.long 602934744, 614469288, 603983336, 615517880, 605031928, 616566472, 606080520, 617615064
.long 607129112, 618663656, 608177704, 619712248, 609226296, 620760840, 610274888, 621809432
.long 611323480, 622858024, 629145604, 630194196, 631242788, 632291380, 633339972, 634388564
.long 635437156, 636485748, 637534340, 638582932, 639631524, 640680116, 641728708, 642777300
.long 643825892, 644874484, 645923076, 646971668, 648020260, 649068852, 650117444, 651166036
.long 652214628, 653263220, 654311812, 655360404, 656408996, 657457588, 658506180, 659554772
.long 660603364, 661651956, 662700548, 663749140, 664797732, 665846324, 666894916, 667943508
.long 668992100, 670040692, 671089284, 672137876, 673186468, 674235060, 675283652, 676332244
.long 677380836, 678429428, 679478020, 680526612, 681575204, 682623796, 683672388, 684720980
.long 685769572, 686818164, 687866756, 688915348, 689963940, 691012532, 692061124, 693109716
.long 694158308, 695206900, 696255492, 697304084, 698352676, 699401268, 700449860, 701498452
.long 702547044, 703595636, 704644228, 705692852, 717227396, 706741444, 718275988, 707790036
.long 719324580, 708838628, 720373172, 709887220, 721421764, 710935812, 722470356, 711984404
.long 723518948, 713032996, 724567540, 714081588, 725616132, 715130180, 726664724, 716178772
.long 727713316, 734005508, 735054100, 736102692, 737151284, 738199876, 739248468, 740297060
.long 741345652, 742394244, 743442836, 744491428, 745540020, 746588612, 747637204, 748685796
.long 749734388, 750782980, 751831572, 752880164, 753928756, 754977348, 756025940, 757074532
.long 758123124, 759171716, 760220308, 761268900, 762317492, 763366084, 764414676, 765463268
.long 766511860, 767560452, 768609044, 769657636, 770706228, 771754820, 772803412, 773852004
.long 774900596, 775949188, 776997780, 778046372, 779094964, 780143556, 781192148, 782240740
.long 783289332, 784337924, 785386516, 786435108, 787483700, 788532292, 789580884, 790629476
.long 791678068, 792726660, 793775252, 794823844, 795872436, 796921028, 797969620, 799018212
.long 800066804, 801115396, 802163988, 803212580, 804261172, 805309764, 806358356, 807406948
.long 808455540, 809504132, 810552756, 822087300, 811601348, 823135892, 812649940, 824184484
.long 813698532, 825233076, 814747124, 826281668, 815795716, 827330260, 816844308, 828378852
.long 817892900, 829427444, 818941492, 830476036, 819990084, 831524628, 821038676, 832573220
.long 838862432, 854591344, 839911024, 855639936, 840959616, 856688528, 842008208, 857737120
.long 843056800, 858785712, 844105392, 859834304, 845153984, 860882896, 846202576, 861931488
.long 847251168, 862980080, 848299760, 864028672, 849348352, 865077264, 850396944, 866125856
.long 851445536, 867174448, 852494128, 868223040, 853542720, 869271632, 876611164, 892340076
.long 877659756, 893388668, 878708348, 894437260, 879756940, 895485852, 880805532, 896534444
.long 881854124, 897583036, 882902716, 898631628, 883951308, 899680220, 884999900, 900728812
.long 886048492, 901777404, 887097084, 902825996, 888145676, 903874588, 889194268, 904923180
.long 890242860, 905971772, 891291452, 907020364, 914359896, 930088808, 915408488, 931137400
.long 916457080, 932185992, 917505672, 933234584, 918554264, 934283176, 919602856, 935331768
.long 920651448, 936380360, 921700040, 937428952, 922748632, 938477544, 923797224, 939526136
.long 924845816, 940574728, 925894408, 941623320, 926943000, 942671912, 927991592, 943720504
.long 929040184, 944769096, 952108628, 967837540, 953157220, 968886132, 954205812, 969934724
.long 955254404, 970983316, 956302996, 972031908, 957351588, 973080500, 958400180, 974129092
.long 959448772, 975177684, 960497364, 976226276, 961545956, 977274868, 962594548, 978323460
.long 963643140, 979372052, 964691732, 980420644, 965740324, 981469236, 966788916, 982517828
.long 982517828, 982517828, 982517828, 982517828, 982517828, 982517828, 982517828, 982517828
.long 982517828, 982517828, 982517828, 982517828, 982517828, 982517828, 982517828, 982517828
.long 982517828, 982517828, 982517828, 982517828, 982517828, 982517828, 982517828, 982517828
.long 982517828, 982517828, 982517828, 982517828, 982517828, 982517828, 982517828, 982517828
.long 982517828, 982517828, 982517828, 982517828, 982517828, 982517828, 982517828, 982517828
.long 982517828, 982517828, 982517828, 982517828, 982517828, 982517828, 982517828, 982517828
.long 982517828, 982517828, 982517828, 982517828, 982517828, 982517828, 982517828, 982517828
.long 982517828, 982517828, 982517828, 982517828, 982517828, 982517828, 982517828, 982517828
.long 982517828, 982517828, 982517828, 982517828, 982517828, 982517828, 982517828, 982517828
.long 982517828, 982517828, 982517828, 982517828, 982517828, 982517828, 982517828, 982517828
.long 982517828, 982517828, 982517828, 982517828, 982517828, 982517828, 982517828, 982517828
.long 982517828, 982517828, 982517828, 982517828, 982517828, 982517828, 982517828, 982517828
.long 982517828, 982517828, 982517828, 982517828, 982517828, 982517828, 982517828, 982517828
.long 982517828, 982517828, 982517828, 982517828, 982517828, 982517828, 982517828, 982517828
.long 982517828, 982517828, 982517828, 982517828, 982517828, 982517828, 982517828, 982517828
.long 982517828, 982517828, 982517828, 982517828, 982517828, 982517828, 982517828, 982517828
.long 982517828, 982517828, 982517828, 982517828, 982517828, 982517828, 982517828, 982517828
.long 982517828, 982517828, 982517828, 982517828, 982517828, 982517828, 982517828, 982517828
.fill 32, 4, 0
L_code_end:
.section .rodata,"a"
.p2align 6
.amdhsa_kernel interleave_layers__sliding_local_dilated__ssm_conv_s4d__prompt_kernel
  .amdhsa_next_free_vgpr 256
  .amdhsa_next_free_sgpr 102
  .amdhsa_accum_offset 256
  .amdhsa_group_segment_fixed_size 0
  .amdhsa_kernarg_size 104
  .amdhsa_user_sgpr_count 2
  .amdhsa_user_sgpr_kernarg_segment_ptr 1
  .amdhsa_system_sgpr_workgroup_id_x 1
.end_amdhsa_kernel
```
